```python
import torch

def _softmax(x, axis=-1):
    return torch.softmax(x, dim=axis)
def _gelu(x):
    return torch.nn.functional.gelu(x, approximate="tanh")
def _silu(x):
    return torch.nn.functional.silu(x)
def _sigmoid(x):
    return torch.sigmoid(x)
def _layernorm(x, axis=-1, eps=1e-5):
    m = x.mean(dim=axis, keepdim=True)
    v = x.var(dim=axis, keepdim=True, unbiased=False)
    return (x - m) / torch.sqrt(v + eps)
def _scatter_add(tgt, idx, src, axis=0):
    return tgt.clone().index_add_(axis, idx, src)
def _segment_sum(src, seg, n):
    out = torch.zeros((n,) + src.shape[1:], dtype=src.dtype)
    return out.index_add_(0, seg, src)
def _pad(x, pw):
    flat = tuple(v for pair in reversed(pw) for v in pair)
    return torch.nn.functional.pad(x, flat)

kernel_name = 'concat_heads__linear_kernel_hedgehog__compressed_kv_cla__prompt'

def setup_inputs():

    _w = (lambda a: (lambda t: t.to(torch.bfloat16) if t.is_floating_point() else t)(torch.as_tensor(a)))
    def _A_setup():
        B, S, D, H = 1, 2048, 512, 32
        Dh = D // H
        return {
            "x": _w((lambda *s: torch.randn(*s, dtype=torch.bfloat16) * 0.4)(B, S, D)),
            "wqkv": _w((lambda *s: torch.randn(*s, dtype=torch.bfloat16) * 0.4)(D, 3 * D)),
            "w_phi": _w((lambda *s: torch.randn(*s, dtype=torch.bfloat16) * 0.4)(H, Dh, Dh) * (Dh ** -0.5)),
            "wo": _w((lambda *s: torch.randn(*s, dtype=torch.bfloat16) * 0.05)(D, D)),
        }
    _A_in = _A_setup()

    def _B_setup():
        B, H, Sq, Sk, D, M = 1, 32, 2048, 2048, 128, 512
        Dc = 4 * D
        return {
            "x": _w((lambda *s: torch.randn(*s, dtype=torch.bfloat16) * 0.8)(B, Sq, M)),
            "c_kv": _w((lambda *s: torch.randn(*s, dtype=torch.bfloat16) * 0.4)(B, Sk, Dc)),
            "w_q": _w((lambda *s: torch.randn(*s, dtype=torch.bfloat16) * 6.4)(M, H, D) * (M ** -0.5)),
            "w_uk": _w((lambda *s: torch.randn(*s, dtype=torch.bfloat16) * 6.4)(Dc, H, D) * (Dc ** -0.5)),
            "w_uv": _w((lambda *s: torch.randn(*s, dtype=torch.bfloat16) * 0.4)(Dc, H, D) * (Dc ** -0.5)),
            "w_o": _w((lambda *s: torch.randn(*s, dtype=torch.bfloat16) * 0.4)(H, D, M) * ((H * D) ** -0.5)),
        }
    _B_in = _B_setup()

    return {
        "A_x": _A_in["x"],
        "A_wqkv": _A_in["wqkv"],
        "A_w_phi": _A_in["w_phi"],
        "A_wo": _A_in["wo"],
        "B_x": _B_in["x"],
        "B_c_kv": _B_in["c_kv"],
        "B_w_q": _B_in["w_q"],
        "B_w_uk": _B_in["w_uk"],
        "B_w_uv": _B_in["w_uv"],
        "B_w_o": _B_in["w_o"],
    }

def reference(A_x, A_wqkv, A_w_phi, A_wo, B_x, B_c_kv, B_w_q, B_w_uk, B_w_uv, B_w_o):
    def _A_ref(x, wqkv, w_phi, wo):
        B, S, D = x.shape
        H = 32; Dh = D // H
        qkv = (lambda x, *d: x.permute(*d))((x @ wqkv).reshape(B, S, 3, H, Dh), 2, 0, 3, 1, 4)
        q, k, v = qkv[0], qkv[1], qkv[2]
        pq = torch.einsum("bhsd,hdf->bhsf", q, w_phi)
        pk = torch.einsum("bhsd,hdf->bhsf", k, w_phi)
        phi_q = torch.concatenate([_softmax(pq, axis=-1), _softmax(-pq, axis=-1)], axis=-1)
        phi_k = torch.concatenate([_softmax(pk, axis=-1), _softmax(-pk, axis=-1)], axis=-1)
        kv = torch.einsum("bhsf,bhsd->bhfd", phi_k, v)
        z  = torch.einsum("bhsf->bhf", phi_k)
        num = torch.einsum("bhqf,bhfd->bhqd", phi_q, kv)
        den = torch.einsum("bhqf,bhf->bhq", phi_q, z)[..., None] + 1e-6
        o = num / den
        return (lambda x, *d: x.permute(*d))(o, 0, 2, 1, 3).reshape(B, S, D) @ wo

    def _B_ref(x, c_kv, w_q, w_uk, w_uv, w_o):
        B, Sq, M = x.shape[0], x.shape[1], x.shape[2]
        Sk = c_kv.shape[1]
        H, D = w_q.shape[1], w_q.shape[2]
        q = torch.einsum("bqm,mhd->bhqd", x, w_q)
        k = torch.einsum("bkc,chd->bhkd", c_kv, w_uk)
        v = torch.einsum("bkc,chd->bhkd", c_kv, w_uv)
        scores = torch.einsum("bhqd,bhkd->bhqk", q, k) * (D ** -0.5)
        off = Sk - Sq
        qi = torch.arange(Sq)[:, None]
        kj = torch.arange(Sk)[None, :]
        cmask = kj <= (qi + off)
        scores = torch.where(cmask[None, None], scores, -1e9)
        p = _softmax(scores, axis=-1)
        ctx = torch.einsum("bhqk,bhkd->bhqd", p, v)
        return torch.einsum("bhqd,hdm->bqm", ctx, w_o)

    a = _A_ref(A_x, A_wqkv, A_w_phi, A_wo)
    b = _B_ref(B_x, B_c_kv, B_w_q, B_w_uk, B_w_uv, B_w_o)
    return torch.concatenate([a, b], axis=-1)
```

```asm
; @launch grid=(256,1,1) block=(256,1,1) lds=163840
.amdgcn_target "amdgcn-amd-amdhsa--gfx950"
.text
.globl concat_heads__linear_kernel_hedgehog__compressed_kv_cla__prompt_kernel
.p2align 8
.type concat_heads__linear_kernel_hedgehog__compressed_kv_cla__prompt_kernel,@function
concat_heads__linear_kernel_hedgehog__compressed_kv_cla__prompt_kernel:
    s_cmp_ge_u32 s2, 256
    s_cbranch_scc1 L_exit
    s_load_dwordx2 s[78:79], s[0:1], 16
    s_load_dwordx2 s[76:77], s[0:1], 96
    s_load_dwordx2 s[64:65], s[0:1], 32
    s_load_dwordx2 s[68:69], s[0:1], 48
    s_load_dwordx4 s[72:75], s[0:1], 72
    s_load_dwordx2 s[60:61], s[0:1], 88
    s_load_dwordx2 s[38:39], s[0:1], 24
    s_getpc_b64 s[4:5]
L_pc:
    s_lshr_b32 s6, s2, 3
    s_lshl_b32 s6, s6, 15
    v_lshl_add_u32 v228, v0, 7, s6
    v_min_u32 v228, L_code_end-L_pc-4, v228
    v_mov_b32 v229, s5
    v_add_co_u32 v228, vcc, s4, v228
    s_nop 1
    v_addc_co_u32 v229, vcc, 0, v229, vcc
    global_load_dword v226, v[228:229], off
    s_and_b32 s3, s2, 7
    s_lshr_b32 s30, s3, 1
    s_lshl_b32 s30, s30, 3
    s_lshr_b32 s5, s2, 5
    s_add_u32 s30, s30, s5
    s_cmp_lt_u32 s30, 13
    s_cselect_b32 s4, 56, 64
    s_cselect_b32 s25, 0, 13
    s_cmp_lt_u32 s30, 26
    s_cselect_b32 s4, s4, 8
    s_cselect_b32 s5, 40, 0
    s_load_dwordx2 s[8:9], s[0:1], s5
    s_load_dwordx2 s[12:13], s[0:1], s4
    v_lshrrev_b32 v1, 6, v0
    v_and_b32 v0, 63, v0
    v_readfirstlane_b32 s20, v1
    s_and_b32 s29, s3, 1
    s_lshl_b32 s29, s29, 2
    s_bfe_u32 s5, s2, 0x20003
    s_add_u32 s29, s29, s5
    v_lshrrev_b32 v28, 3, v0
    v_lshlrev_b32 v31, 10, v28
    v_lshrrev_b32 v29, 4, v0
    v_and_b32 v30, 7, v0
    v_xor_b32 v29, v29, v30
    v_lshl_add_u32 v10, v29, 4, v31
    v_xor_b32 v11, 64, v10
    v_add_u32 v11, 7168, v11
    v_add_u32 v12, 14336, v10
    v_add_u32 v13, 14336, v11
    s_lshl_b32 s32, s29, 2
    s_add_u32 s32, s32, s20
    s_lshl_b32 s28, s32, 16
    s_cmp_lt_u32 s30, 26
    s_cselect_b32 s4, 0x10000, 0
    s_cselect_b32 s5, 0, 0x18000
    s_mul_i32 s27, s20, 24576
    s_add_u32 s27, s27, s4
    s_lshl_b32 s26, s20, 12
    s_add_u32 s26, s26, s5
    s_mov_b32 s10, 0x200000
    s_mov_b32 s11, 0x20000
    s_mov_b32 s15, 0x20000
    s_add_u32 s56, s30, s29
    s_and_b32 s56, s56, 3
    s_lshl_b32 s56, s56, 8
    s_waitcnt lgkmcnt(0)
    s_and_b32 s9, s9, 0xffff
    s_and_b32 s13, s13, 0xffff
    s_add_u32 m0, s27, 0
    s_add_u32 s33, s56, 0
    s_and_b32 s33, s33, 1023
    s_add_u32 s33, s33, s28
    buffer_load_dwordx4 v10, s[8:11], s33 offen offset:0 lds
    buffer_load_dwordx4 v11, s[8:11], s33 offen offset:1024 lds
    buffer_load_dwordx4 v12, s[8:11], s33 offen offset:2048 lds
    buffer_load_dwordx4 v13, s[8:11], s33 offen offset:3072 lds
    s_add_u32 m0, s27, 4096
    s_add_u32 s33, s33, 32768
    buffer_load_dwordx4 v10, s[8:11], s33 offen offset:0 lds
    buffer_load_dwordx4 v11, s[8:11], s33 offen offset:1024 lds
    buffer_load_dwordx4 v12, s[8:11], s33 offen offset:2048 lds
    buffer_load_dwordx4 v13, s[8:11], s33 offen offset:3072 lds
    s_sub_u32 s24, s30, s25
    s_mul_i32 s31, s24, 5
    s_lshl_b32 s21, s31, 7
    s_sub_u32 s4, s30, 26
    s_mul_i32 s5, s4, 3
    s_lshl_b32 s25, s4, 1
    s_add_u32 s33, s25, 4
    s_sub_u32 s25, s25, 4
    s_cmp_lt_u32 s4, 4
    s_cselect_b32 s5, s5, s33
    s_cselect_b32 s58, s4, s25
    s_cselect_b32 s6, 2, 1
    s_cselect_b32 s48, 0, 1
    s_lshl_b32 s7, s5, 6
    s_add_u32 s7, s7, 1024
    s_cmp_lt_u32 s30, 26
    s_cselect_b32 s31, s31, s5
    s_cselect_b32 s24, s24, s6
    s_cselect_b32 s21, s21, s7
    s_movk_i32 s5, 3072
    s_cselect_b32 s4, 0x2000, s5
    s_cselect_b32 s5, 1, 2
    s_cselect_b32 s6, 6, 10
    s_cselect_b32 s7, 1, 0
    s_lshl_b32 s14, s4, 9
    s_lshr_b32 s3, s4, 1
    s_add_u32 s44, s56, 0
    s_and_b32 s44, s44, 1023
    s_mul_i32 s44, s44, s3
    s_add_u32 s45, s56, 256
    s_and_b32 s45, s45, 1023
    s_mul_i32 s45, s45, s3
    s_add_u32 s50, s56, 512
    s_and_b32 s50, s50, 1023
    s_mul_i32 s50, s50, s3
    s_add_u32 s51, s56, 768
    s_and_b32 s51, s51, 1023
    s_mul_i32 s51, s51, s3
    s_lshl_b32 s25, s20, 5
    v_add_u32 v28, s25, v28
    v_mul_lo_u32 v28, v28, s4
    v_bfe_u32 v29, v0, 4, 1
    v_lshlrev_b32 v29, s5, v29
    v_xor_b32 v29, v29, v30
    v_and_b32 v30, 3, v29
    v_lshl_add_u32 v28, v30, 4, v28
    v_lshrrev_b32 v30, 2, v29
    v_xor_b32 v31, s7, v30
    v_lshl_add_u32 v6, v30, s6, v28
    v_lshl_add_u32 v7, v31, s6, v28
    v_mul_u32_u24 v26, 960, v30
    s_lshl_b32 s4, s4, 3
    s_sub_u32 s4, s4, 1024
    s_lshl_b32 s5, s4, 1
    v_add_u32 v7, s4, v7
    v_add_u32 v8, s5, v6
    v_add_u32 v9, s5, v7
    s_add_u32 m0, s26, 0
    s_add_u32 s25, s21, s44
    buffer_load_dwordx4 v6, s[12:15], s25 offen offset:0 lds
    buffer_load_dwordx4 v7, s[12:15], s25 offen offset:1024 lds
    buffer_load_dwordx4 v8, s[12:15], s25 offen offset:2048 lds
    buffer_load_dwordx4 v9, s[12:15], s25 offen offset:3072 lds
    s_add_u32 m0, s27, 8192
    s_add_u32 s33, s56, 128
    s_and_b32 s33, s33, 1023
    s_add_u32 s33, s33, s28
    buffer_load_dwordx4 v10, s[8:11], s33 offen offset:0 lds
    buffer_load_dwordx4 v11, s[8:11], s33 offen offset:1024 lds
    buffer_load_dwordx4 v12, s[8:11], s33 offen offset:2048 lds
    buffer_load_dwordx4 v13, s[8:11], s33 offen offset:3072 lds
    s_add_u32 m0, s27, 12288
    s_add_u32 s33, s33, 32768
    buffer_load_dwordx4 v10, s[8:11], s33 offen offset:0 lds
    buffer_load_dwordx4 v11, s[8:11], s33 offen offset:1024 lds
    buffer_load_dwordx4 v12, s[8:11], s33 offen offset:2048 lds
    buffer_load_dwordx4 v13, s[8:11], s33 offen offset:3072 lds
    s_mov_b32 s16, s76
    s_and_b32 s17, s77, 0xffff
    s_mov_b32 s18, 0x4400000
    s_mov_b32 s19, 0x20000
    s_mov_b32 s100, s20
    v_lshlrev_b32 v28, 8, v0
    v_mov_b32 v29, 0
    s_add_u32 s25, s2, s20
    s_mov_b32 s33, 0x40000000
    s_cmp_eq_u32 s25, 0
    s_cselect_b32 s25, 0x3700000, s33
    s_cselect_b32 s35, 0, s33
    buffer_store_dword v29, v28, s[16:19], s25 offen sc1
    s_add_u32 s25, s25, 0x4000
    buffer_store_dword v29, v28, s[16:19], s25 offen sc1
    s_add_u32 s25, s25, 0x4000
    buffer_store_dword v29, v28, s[16:19], s25 offen sc1
    s_and_b32 s61, s61, 0xffff
    s_mov_b32 s62, 256
    s_mov_b32 s63, 0x20000
    s_cmp_lt_u32 s30, 26
    s_cbranch_scc0 L1_A
    s_movk_i32 s3, 128
    s_cmp_eq_u32 s24, 12
    s_cselect_b32 s59, 0x40000000, s3
    s_mov_b32 s24, 2
    s_add_u32 s48, s26, 0x10000
    s_add_u32 s22, s21, 128
    v_lshrrev_b32 v28, 4, v0
    v_lshlrev_b32 v28, 10, v28
    v_bfe_u32 v29, v0, 2, 2
    v_lshl_add_u32 v28, v29, 7, v28
    v_bfe_u32 v29, v0, 3, 2
    v_lshl_add_u32 v28, v29, 5, v28
    v_and_b32 v29, 3, v0
    v_lshl_add_u32 v2, v29, 3, v28
    v_xor_b32 v3, 32, v2
    v_xor_b32 v4, 64, v2
    v_xor_b32 v5, 96, v2
    v_and_b32 v28, 15, v0
    v_lshlrev_b32 v29, 7, v28
    v_add_u32 v29, s27, v29
    v_bfe_u32 v28, v0, 1, 3
    v_lshrrev_b32 v30, 4, v0
    v_xor_b32 v28, v28, v30
    v_lshl_add_u32 v14, v28, 4, v29
    v_xor_b32 v28, 4, v28
    v_lshl_add_u32 v15, v28, 4, v29
    v_lshlrev_b32 v18, 4, v0
    v_add_u32 v19, 4096, v18
    v_add_u32 v20, 8192, v18
    v_add_u32 v21, 12288, v18
    s_lshl_b32 s32, s32, 15
    s_lshl_b32 s57, s100, 15
    s_sub_u32 s57, 98304, s57
    v_mov_b32 v222, v10
    v_add_u32 v224, s57, v12
    v_mov_b32 v223, v11
    v_add_u32 v225, s57, v13
    s_and_b32 s65, s65, 0xffff
    s_mov_b32 s66, 0x200000
    s_mov_b32 s67, 0x20000
    s_and_b32 s69, s69, 0xffff
    s_mov_b32 s70, 0x400000
    s_mov_b32 s71, 0x20000
    s_and_b32 s53, s2, 1
    s_lshl_b32 s53, s53, 2
    s_lshr_b32 s57, s2, 6
    s_add_u32 s53, s53, s57
    s_lshl_b32 s57, s100, 14
    s_lshl_b32 s46, s53, 17
    s_add_u32 s46, s46, s57
    s_sub_u32 s47, 15, s53
    s_lshl_b32 s47, s47, 17
    s_add_u32 s47, s47, s57
    s_bfe_u32 s57, s2, 0x30003
    s_and_b32 s52, s2, 6
    s_lshl_b32 s52, s52, 2
    s_add_u32 s52, s52, s57
    s_lshl_b32 s52, s52, 8
    s_lshl_b32 s53, s53, 1
    s_add_u32 s53, s53, s57
    s_and_b32 s53, s53, 7
    s_lshl_b32 s53, s53, 7
    s_lshl_b32 s54, s100, 13
    s_lshl_b32 s55, s100, 12
    v_lshrrev_b32 v28, 4, v0
    s_lshl_b32 s57, s100, 4
    v_add_u32 v29, s57, v28
    v_lshlrev_b32 v29, 13, v29
    v_lshlrev_b32 v28, 1, v28
    v_and_b32 v30, 15, v0
    v_xor_b32 v28, v28, v30
    v_lshl_add_u32 v252, v28, 4, v29
    v_add_u32 v253, 31744, v252
    v_xor_b32 v254, 128, v252
    v_add_u32 v254, 63488, v254
    v_add_u32 v255, 31744, v254
    s_lshr_b32 s3, s2, 3
    s_lshl_b32 s3, s3, 2
    s_add_u32 s3, s3, s20
    s_cmp_ge_u32 s30, 24
    s_cselect_b32 s4, 3, 0
    s_cselect_b32 s5, 63, 7
    s_cselect_b32 s6, 15, 127
    s_and_b32 s3, s3, s6
    s_lshl_b32 s3, s3, s4
    s_cmp_eq_u32 s30, 24
    s_cselect_b32 s3, 0x4000, s3
    s_lshl_b32 s6, s3, 13
    s_add_u32 s6, s6, 384
    s_lshl_b32 s7, s3, 14
    s_and_b32 s3, s2, 7
    s_lshl_b32 s3, s3, 10
    s_add_u32 s7, s7, s3
    s_add_u32 s7, s7, 384
    v_and_b32 v228, s5, v0
    v_lshrrev_b32 v229, 2, v228
    v_lshlrev_b32 v229, 13, v229
    v_lshlrev_b32 v228, 10, v228
    v_mov_b32 v230, 1
    v_lshlrev_b32 v231, 8, v0
    s_mov_b32 s40, s72
    s_and_b32 s41, s73, 0xffff
    s_mov_b32 s42, 0x400000
    s_mov_b32 s43, 0x20000
    s_mul_i32 s4, s29, 26
    s_add_u32 s4, s4, s30
    s_lshl_b32 s4, s4, 2
    s_add_u32 s5, s4, s20
    s_mul_i32 s4, s5, 5120
    v_min_u32 v227, 13, v0
    v_lshlrev_b32 v227, 7, v227
    v_min_u32 v234, 512, v227
    s_mul_i32 s58, s5, 640
    s_mov_b32 s36, s38
    s_and_b32 s37, s39, 0xffff
    s_mov_b32 s38, 0x80000
    s_mov_b32 s39, 0x20000
    s_cmp_lt_u32 s30, 13
    s_cbranch_scc0 L1_V
    s_mov_b32 s34, 0x3e0293ee
    v_mov_b32 v232, s34
    v_mov_b32 v233, s34
    s_waitcnt vmcnt(15)
    ds_read_b128 a[0:3], v14 offset:0
    ds_read_b128 a[64:67], v14 offset:2048
    ds_read_b128 a[128:131], v14 offset:4096
    ds_read_b128 a[192:195], v14 offset:6144
    ds_read_b128 a[4:7], v15 offset:0
    ds_read_b128 a[68:71], v15 offset:2048
    ds_read_b128 a[132:135], v15 offset:4096
    ds_read_b128 a[196:199], v15 offset:6144
    s_add_u32 m0, s27, 16384
    s_add_u32 s33, s56, 256
    s_and_b32 s33, s33, 1023
    s_add_u32 s33, s33, s28
    buffer_load_dwordx4 v10, s[8:11], s33 offen offset:0 lds
    buffer_load_dwordx4 v11, s[8:11], s33 offen offset:1024 lds
    buffer_load_dwordx4 v12, s[8:11], s33 offen offset:2048 lds
    buffer_load_dwordx4 v13, s[8:11], s33 offen offset:3072 lds
    s_add_u32 m0, s27, 20480
    s_add_u32 s33, s33, 32768
    buffer_load_dwordx4 v10, s[8:11], s33 offen offset:0 lds
    buffer_load_dwordx4 v11, s[8:11], s33 offen offset:1024 lds
    buffer_load_dwordx4 v12, s[8:11], s33 offen offset:2048 lds
    buffer_load_dwordx4 v13, s[8:11], s33 offen offset:3072 lds
    s_waitcnt vmcnt(19)
    s_barrier
    ds_read_b64_tr_b16 v[92:93], v2 offset:0
    ds_read_b64_tr_b16 v[94:95], v2 offset:512
    ds_read_b64_tr_b16 v[96:97], v3 offset:0
    ds_read_b64_tr_b16 v[98:99], v3 offset:512
    ds_read_b64_tr_b16 v[100:101], v4 offset:0
    ds_read_b64_tr_b16 v[102:103], v4 offset:512
    ds_read_b64_tr_b16 v[104:105], v5 offset:0
    ds_read_b64_tr_b16 v[106:107], v5 offset:512
    s_add_u32 m0, s26, 16384
    s_add_u32 s25, s21, s45
    buffer_load_dwordx4 v6, s[12:15], s25 offen offset:0 lds
    buffer_load_dwordx4 v7, s[12:15], s25 offen offset:1024 lds
    buffer_load_dwordx4 v8, s[12:15], s25 offen offset:2048 lds
    buffer_load_dwordx4 v9, s[12:15], s25 offen offset:3072 lds
    s_add_u32 m0, s26, 32768
    s_add_u32 s25, s21, s50
    buffer_load_dwordx4 v6, s[12:15], s25 offen offset:0 lds
    buffer_load_dwordx4 v7, s[12:15], s25 offen offset:1024 lds
    buffer_load_dwordx4 v8, s[12:15], s25 offen offset:2048 lds
    buffer_load_dwordx4 v9, s[12:15], s25 offen offset:3072 lds
    s_waitcnt lgkmcnt(4)
    v_mfma_f32_16x16x32_bf16 v[28:31], v[92:95], a[0:3], 0
    s_add_u32 m0, s27, 0
    s_add_u32 s33, s56, 384
    s_and_b32 s33, s33, 1023
    s_add_u32 s33, s33, s28
    ds_read_b64_tr_b16 v[108:109], v2 offset:4096
    v_mfma_f32_16x16x32_bf16 v[32:35], v[92:95], a[64:67], 0
    buffer_load_dwordx4 v10, s[8:11], s33 offen offset:0 lds
    v_mfma_f32_16x16x32_bf16 v[36:39], v[92:95], a[128:131], 0
    ds_read_b64_tr_b16 v[110:111], v2 offset:4608
    v_mfma_f32_16x16x32_bf16 v[40:43], v[92:95], a[192:195], 0
    buffer_load_dwordx4 v11, s[8:11], s33 offen offset:1024 lds
    buffer_load_dwordx4 v12, s[8:11], s33 offen offset:2048 lds
    v_mfma_f32_16x16x32_bf16 v[44:47], v[96:99], a[0:3], 0
    ds_read_b64_tr_b16 v[112:113], v3 offset:4096
    v_mfma_f32_16x16x32_bf16 v[48:51], v[96:99], a[64:67], 0
    buffer_load_dwordx4 v13, s[8:11], s33 offen offset:3072 lds
    v_mfma_f32_16x16x32_bf16 v[52:55], v[96:99], a[128:131], 0
    s_add_u32 m0, s27, 4096
    s_add_u32 s33, s33, 32768
    ds_read_b64_tr_b16 v[114:115], v3 offset:4608
    v_mfma_f32_16x16x32_bf16 v[56:59], v[96:99], a[192:195], 0
    s_waitcnt lgkmcnt(4)
    buffer_load_dwordx4 v10, s[8:11], s33 offen offset:0 lds
    v_mfma_f32_16x16x32_bf16 v[60:63], v[100:103], a[0:3], 0
    ds_read_b64_tr_b16 v[116:117], v4 offset:4096
    v_mfma_f32_16x16x32_bf16 v[64:67], v[100:103], a[64:67], 0
    buffer_load_dwordx4 v11, s[8:11], s33 offen offset:1024 lds
    buffer_load_dwordx4 v12, s[8:11], s33 offen offset:2048 lds
    v_mfma_f32_16x16x32_bf16 v[68:71], v[100:103], a[128:131], 0
    ds_read_b64_tr_b16 v[118:119], v4 offset:4608
    v_mfma_f32_16x16x32_bf16 v[72:75], v[100:103], a[192:195], 0
    buffer_load_dwordx4 v13, s[8:11], s33 offen offset:3072 lds
    v_mfma_f32_16x16x32_bf16 v[76:79], v[104:107], a[0:3], 0
    ds_read_b64_tr_b16 v[120:121], v5 offset:4096
    v_mfma_f32_16x16x32_bf16 v[80:83], v[104:107], a[64:67], 0
    v_mfma_f32_16x16x32_bf16 v[84:87], v[104:107], a[128:131], 0
    ds_read_b64_tr_b16 v[122:123], v5 offset:4608
    v_mfma_f32_16x16x32_bf16 v[88:91], v[104:107], a[192:195], 0
    s_waitcnt lgkmcnt(4)
    v_mfma_f32_16x16x32_bf16 v[28:31], v[108:111], a[4:7], v[28:31]
    ds_read_b64_tr_b16 v[92:93], v2 offset:8192
    v_mfma_f32_16x16x32_bf16 v[32:35], v[108:111], a[68:71], v[32:35]
    s_waitcnt vmcnt(27)
    v_mfma_f32_16x16x32_bf16 v[36:39], v[108:111], a[132:135], v[36:39]
    ds_read_b64_tr_b16 v[94:95], v2 offset:8704
    ds_read_b128 a[8:11], v14 offset:8192
    v_mfma_f32_16x16x32_bf16 v[40:43], v[108:111], a[196:199], v[40:43]
    v_mfma_f32_16x16x32_bf16 v[44:47], v[112:115], a[4:7], v[44:47]
    ds_read_b64_tr_b16 v[96:97], v3 offset:8192
    ds_read_b128 a[72:75], v14 offset:10240
    v_mfma_f32_16x16x32_bf16 v[48:51], v[112:115], a[68:71], v[48:51]
    v_mfma_f32_16x16x32_bf16 v[52:55], v[112:115], a[132:135], v[52:55]
    ds_read_b64_tr_b16 v[98:99], v3 offset:8704
    ds_read_b128 a[136:139], v14 offset:12288
    v_mfma_f32_16x16x32_bf16 v[56:59], v[112:115], a[196:199], v[56:59]
    s_waitcnt lgkmcnt(7)
    v_mfma_f32_16x16x32_bf16 v[60:63], v[116:119], a[4:7], v[60:63]
    ds_read_b128 a[200:203], v14 offset:14336
    ds_read_b64_tr_b16 v[100:101], v4 offset:8192
    v_mfma_f32_16x16x32_bf16 v[64:67], v[116:119], a[68:71], v[64:67]
    ds_read_b128 a[12:15], v15 offset:8192
    v_mfma_f32_16x16x32_bf16 v[68:71], v[116:119], a[132:135], v[68:71]
    ds_read_b128 a[76:79], v15 offset:10240
    ds_read_b64_tr_b16 v[102:103], v4 offset:8704
    v_mfma_f32_16x16x32_bf16 v[72:75], v[116:119], a[196:199], v[72:75]
    ds_read_b128 a[140:143], v15 offset:12288
    v_mfma_f32_16x16x32_bf16 v[76:79], v[120:123], a[4:7], v[76:79]
    ds_read_b128 a[204:207], v15 offset:14336
    ds_read_b64_tr_b16 v[104:105], v5 offset:8192
    v_mfma_f32_16x16x32_bf16 v[80:83], v[120:123], a[68:71], v[80:83]
    v_mfma_f32_16x16x32_bf16 v[84:87], v[120:123], a[132:135], v[84:87]
    ds_read_b64_tr_b16 v[106:107], v5 offset:8704
    v_mfma_f32_16x16x32_bf16 v[88:91], v[120:123], a[196:199], v[88:91]
    s_waitcnt lgkmcnt(2)
    v_mfma_f32_16x16x32_bf16 v[28:31], v[92:95], a[8:11], v[28:31]
    s_add_u32 m0, s27, 8192
    s_add_u32 s33, s56, 512
    s_and_b32 s33, s33, 1023
    s_add_u32 s33, s33, s28
    ds_read_b64_tr_b16 v[108:109], v2 offset:12288
    v_mfma_f32_16x16x32_bf16 v[32:35], v[92:95], a[72:75], v[32:35]
    buffer_load_dwordx4 v10, s[8:11], s33 offen offset:0 lds
    v_mfma_f32_16x16x32_bf16 v[36:39], v[92:95], a[136:139], v[36:39]
    ds_read_b64_tr_b16 v[110:111], v2 offset:12800
    v_mfma_f32_16x16x32_bf16 v[40:43], v[92:95], a[200:203], v[40:43]
    buffer_load_dwordx4 v11, s[8:11], s33 offen offset:1024 lds
    buffer_load_dwordx4 v12, s[8:11], s33 offen offset:2048 lds
    v_mfma_f32_16x16x32_bf16 v[44:47], v[96:99], a[8:11], v[44:47]
    ds_read_b64_tr_b16 v[112:113], v3 offset:12288
    v_mfma_f32_16x16x32_bf16 v[48:51], v[96:99], a[72:75], v[48:51]
    buffer_load_dwordx4 v13, s[8:11], s33 offen offset:3072 lds
    v_mfma_f32_16x16x32_bf16 v[52:55], v[96:99], a[136:139], v[52:55]
    s_add_u32 m0, s27, 12288
    s_add_u32 s33, s33, 32768
    ds_read_b64_tr_b16 v[114:115], v3 offset:12800
    v_mfma_f32_16x16x32_bf16 v[56:59], v[96:99], a[200:203], v[56:59]
    s_waitcnt lgkmcnt(4)
    buffer_load_dwordx4 v10, s[8:11], s33 offen offset:0 lds
    v_mfma_f32_16x16x32_bf16 v[60:63], v[100:103], a[8:11], v[60:63]
    ds_read_b64_tr_b16 v[116:117], v4 offset:12288
    v_mfma_f32_16x16x32_bf16 v[64:67], v[100:103], a[72:75], v[64:67]
    buffer_load_dwordx4 v11, s[8:11], s33 offen offset:1024 lds
    buffer_load_dwordx4 v12, s[8:11], s33 offen offset:2048 lds
    v_mfma_f32_16x16x32_bf16 v[68:71], v[100:103], a[136:139], v[68:71]
    ds_read_b64_tr_b16 v[118:119], v4 offset:12800
    v_mfma_f32_16x16x32_bf16 v[72:75], v[100:103], a[200:203], v[72:75]
    buffer_load_dwordx4 v13, s[8:11], s33 offen offset:3072 lds
    v_mfma_f32_16x16x32_bf16 v[76:79], v[104:107], a[8:11], v[76:79]
    s_add_u32 m0, s26, 49152
    ds_read_b64_tr_b16 v[120:121], v5 offset:12288
    v_mfma_f32_16x16x32_bf16 v[80:83], v[104:107], a[72:75], v[80:83]
    s_add_u32 s25, s21, s51
    v_mfma_f32_16x16x32_bf16 v[84:87], v[104:107], a[136:139], v[84:87]
    s_waitcnt vmcnt(20)
    ds_read_b64_tr_b16 v[122:123], v5 offset:12800
    v_mfma_f32_16x16x32_bf16 v[88:91], v[104:107], a[200:203], v[88:91]
    s_waitcnt lgkmcnt(4)
    v_mfma_f32_16x16x32_bf16 v[28:31], v[108:111], a[12:15], v[28:31]
    s_barrier
    ds_read_b64_tr_b16 v[92:93], v2 offset:16384
    v_mfma_f32_16x16x32_bf16 v[32:35], v[108:111], a[76:79], v[32:35]
    buffer_load_dwordx4 v6, s[12:15], s25 offen offset:0 lds
    v_mfma_f32_16x16x32_bf16 v[36:39], v[108:111], a[140:143], v[36:39]
    ds_read_b64_tr_b16 v[94:95], v2 offset:16896
    ds_read_b128 a[16:19], v14 offset:16384
    v_mfma_f32_16x16x32_bf16 v[40:43], v[108:111], a[204:207], v[40:43]
    buffer_load_dwordx4 v7, s[12:15], s25 offen offset:1024 lds
    v_mfma_f32_16x16x32_bf16 v[44:47], v[112:115], a[12:15], v[44:47]
    ds_read_b64_tr_b16 v[96:97], v3 offset:16384
    ds_read_b128 a[80:83], v14 offset:18432
    v_mfma_f32_16x16x32_bf16 v[48:51], v[112:115], a[76:79], v[48:51]
    buffer_load_dwordx4 v8, s[12:15], s25 offen offset:2048 lds
    v_mfma_f32_16x16x32_bf16 v[52:55], v[112:115], a[140:143], v[52:55]
    ds_read_b64_tr_b16 v[98:99], v3 offset:16896
    ds_read_b128 a[144:147], v14 offset:20480
    v_mfma_f32_16x16x32_bf16 v[56:59], v[112:115], a[204:207], v[56:59]
    s_waitcnt lgkmcnt(7)
    buffer_load_dwordx4 v9, s[12:15], s25 offen offset:3072 lds
    v_mfma_f32_16x16x32_bf16 v[60:63], v[116:119], a[12:15], v[60:63]
    ds_read_b128 a[208:211], v14 offset:22528
    ds_read_b64_tr_b16 v[100:101], v4 offset:16384
    v_mfma_f32_16x16x32_bf16 v[64:67], v[116:119], a[76:79], v[64:67]
    ds_read_b128 a[20:23], v15 offset:16384
    v_mfma_f32_16x16x32_bf16 v[68:71], v[116:119], a[140:143], v[68:71]
    ds_read_b128 a[84:87], v15 offset:18432
    ds_read_b64_tr_b16 v[102:103], v4 offset:16896
    v_mfma_f32_16x16x32_bf16 v[72:75], v[116:119], a[204:207], v[72:75]
    ds_read_b128 a[148:151], v15 offset:20480
    v_mfma_f32_16x16x32_bf16 v[76:79], v[120:123], a[12:15], v[76:79]
    ds_read_b128 a[212:215], v15 offset:22528
    ds_read_b64_tr_b16 v[104:105], v5 offset:16384
    v_mfma_f32_16x16x32_bf16 v[80:83], v[120:123], a[76:79], v[80:83]
    v_mfma_f32_16x16x32_bf16 v[84:87], v[120:123], a[140:143], v[84:87]
    ds_read_b64_tr_b16 v[106:107], v5 offset:16896
    v_mfma_f32_16x16x32_bf16 v[88:91], v[120:123], a[204:207], v[88:91]
    s_waitcnt lgkmcnt(2)
    v_mfma_f32_16x16x32_bf16 v[28:31], v[92:95], a[16:19], v[28:31]
    s_add_u32 m0, s27, 16384
    s_add_u32 s33, s56, 640
    s_and_b32 s33, s33, 1023
    s_add_u32 s33, s33, s28
    ds_read_b64_tr_b16 v[108:109], v2 offset:20480
    v_mfma_f32_16x16x32_bf16 v[32:35], v[92:95], a[80:83], v[32:35]
    buffer_load_dwordx4 v10, s[8:11], s33 offen offset:0 lds
    v_mfma_f32_16x16x32_bf16 v[36:39], v[92:95], a[144:147], v[36:39]
    ds_read_b64_tr_b16 v[110:111], v2 offset:20992
    v_mfma_f32_16x16x32_bf16 v[40:43], v[92:95], a[208:211], v[40:43]
    buffer_load_dwordx4 v11, s[8:11], s33 offen offset:1024 lds
    buffer_load_dwordx4 v12, s[8:11], s33 offen offset:2048 lds
    v_mfma_f32_16x16x32_bf16 v[44:47], v[96:99], a[16:19], v[44:47]
    ds_read_b64_tr_b16 v[112:113], v3 offset:20480
    v_mfma_f32_16x16x32_bf16 v[48:51], v[96:99], a[80:83], v[48:51]
    buffer_load_dwordx4 v13, s[8:11], s33 offen offset:3072 lds
    v_mfma_f32_16x16x32_bf16 v[52:55], v[96:99], a[144:147], v[52:55]
    s_add_u32 m0, s27, 20480
    s_add_u32 s33, s33, 32768
    ds_read_b64_tr_b16 v[114:115], v3 offset:20992
    v_mfma_f32_16x16x32_bf16 v[56:59], v[96:99], a[208:211], v[56:59]
    s_waitcnt lgkmcnt(4)
    buffer_load_dwordx4 v10, s[8:11], s33 offen offset:0 lds
    v_mfma_f32_16x16x32_bf16 v[60:63], v[100:103], a[16:19], v[60:63]
    ds_read_b64_tr_b16 v[116:117], v4 offset:20480
    v_mfma_f32_16x16x32_bf16 v[64:67], v[100:103], a[80:83], v[64:67]
    buffer_load_dwordx4 v11, s[8:11], s33 offen offset:1024 lds
    buffer_load_dwordx4 v12, s[8:11], s33 offen offset:2048 lds
    v_mfma_f32_16x16x32_bf16 v[68:71], v[100:103], a[144:147], v[68:71]
    ds_read_b64_tr_b16 v[118:119], v4 offset:20992
    v_mfma_f32_16x16x32_bf16 v[72:75], v[100:103], a[208:211], v[72:75]
    buffer_load_dwordx4 v13, s[8:11], s33 offen offset:3072 lds
    v_mfma_f32_16x16x32_bf16 v[76:79], v[104:107], a[16:19], v[76:79]
    ds_read_b64_tr_b16 v[120:121], v5 offset:20480
    v_mfma_f32_16x16x32_bf16 v[80:83], v[104:107], a[80:83], v[80:83]
    v_mfma_f32_16x16x32_bf16 v[84:87], v[104:107], a[144:147], v[84:87]
    ds_read_b64_tr_b16 v[122:123], v5 offset:20992
    v_mfma_f32_16x16x32_bf16 v[88:91], v[104:107], a[208:211], v[88:91]
    s_waitcnt lgkmcnt(4)
    v_mfma_f32_16x16x32_bf16 v[28:31], v[108:111], a[20:23], v[28:31]
    ds_read_b64_tr_b16 v[92:93], v2 offset:24576
    v_mfma_f32_16x16x32_bf16 v[32:35], v[108:111], a[84:87], v[32:35]
    s_waitcnt vmcnt(20)
    v_mfma_f32_16x16x32_bf16 v[36:39], v[108:111], a[148:151], v[36:39]
    ds_read_b64_tr_b16 v[94:95], v2 offset:25088
    ds_read_b128 a[24:27], v14 offset:0
    v_mfma_f32_16x16x32_bf16 v[40:43], v[108:111], a[212:215], v[40:43]
    v_mfma_f32_16x16x32_bf16 v[44:47], v[112:115], a[20:23], v[44:47]
    ds_read_b64_tr_b16 v[96:97], v3 offset:24576
    ds_read_b128 a[88:91], v14 offset:2048
    v_mfma_f32_16x16x32_bf16 v[48:51], v[112:115], a[84:87], v[48:51]
    v_mfma_f32_16x16x32_bf16 v[52:55], v[112:115], a[148:151], v[52:55]
    ds_read_b64_tr_b16 v[98:99], v3 offset:25088
    ds_read_b128 a[152:155], v14 offset:4096
    v_mfma_f32_16x16x32_bf16 v[56:59], v[112:115], a[212:215], v[56:59]
    s_waitcnt lgkmcnt(7)
    v_mfma_f32_16x16x32_bf16 v[60:63], v[116:119], a[20:23], v[60:63]
    ds_read_b128 a[216:219], v14 offset:6144
    ds_read_b64_tr_b16 v[100:101], v4 offset:24576
    v_mfma_f32_16x16x32_bf16 v[64:67], v[116:119], a[84:87], v[64:67]
    ds_read_b128 a[28:31], v15 offset:0
    v_mfma_f32_16x16x32_bf16 v[68:71], v[116:119], a[148:151], v[68:71]
    ds_read_b128 a[92:95], v15 offset:2048
    ds_read_b64_tr_b16 v[102:103], v4 offset:25088
    v_mfma_f32_16x16x32_bf16 v[72:75], v[116:119], a[212:215], v[72:75]
    ds_read_b128 a[156:159], v15 offset:4096
    v_mfma_f32_16x16x32_bf16 v[76:79], v[120:123], a[20:23], v[76:79]
    ds_read_b128 a[220:223], v15 offset:6144
    ds_read_b64_tr_b16 v[104:105], v5 offset:24576
    v_mfma_f32_16x16x32_bf16 v[80:83], v[120:123], a[84:87], v[80:83]
    v_mfma_f32_16x16x32_bf16 v[84:87], v[120:123], a[148:151], v[84:87]
    ds_read_b64_tr_b16 v[106:107], v5 offset:25088
    v_mfma_f32_16x16x32_bf16 v[88:91], v[120:123], a[212:215], v[88:91]
    s_waitcnt lgkmcnt(2)
    v_mfma_f32_16x16x32_bf16 v[28:31], v[92:95], a[24:27], v[28:31]
    s_add_u32 m0, s27, 0
    s_add_u32 s33, s56, 768
    s_and_b32 s33, s33, 1023
    s_add_u32 s33, s33, s28
    ds_read_b64_tr_b16 v[108:109], v2 offset:28672
    v_mfma_f32_16x16x32_bf16 v[32:35], v[92:95], a[88:91], v[32:35]
    buffer_load_dwordx4 v10, s[8:11], s33 offen offset:0 lds
    v_mfma_f32_16x16x32_bf16 v[36:39], v[92:95], a[152:155], v[36:39]
    ds_read_b64_tr_b16 v[110:111], v2 offset:29184
    v_mfma_f32_16x16x32_bf16 v[40:43], v[92:95], a[216:219], v[40:43]
    buffer_load_dwordx4 v11, s[8:11], s33 offen offset:1024 lds
    buffer_load_dwordx4 v12, s[8:11], s33 offen offset:2048 lds
    v_mfma_f32_16x16x32_bf16 v[44:47], v[96:99], a[24:27], v[44:47]
    ds_read_b64_tr_b16 v[112:113], v3 offset:28672
    v_mfma_f32_16x16x32_bf16 v[48:51], v[96:99], a[88:91], v[48:51]
    buffer_load_dwordx4 v13, s[8:11], s33 offen offset:3072 lds
    buffer_store_dword v230, v231, s[60:63], s35 offen sc1
    v_mfma_f32_16x16x32_bf16 v[52:55], v[96:99], a[152:155], v[52:55]
    s_add_u32 m0, s27, 4096
    s_add_u32 s33, s33, 32768
    ds_read_b64_tr_b16 v[114:115], v3 offset:29184
    v_mfma_f32_16x16x32_bf16 v[56:59], v[96:99], a[216:219], v[56:59]
    s_waitcnt lgkmcnt(4)
    buffer_load_dwordx4 v10, s[8:11], s33 offen offset:0 lds
    v_mfma_f32_16x16x32_bf16 v[60:63], v[100:103], a[24:27], v[60:63]
    ds_read_b64_tr_b16 v[116:117], v4 offset:28672
    v_mfma_f32_16x16x32_bf16 v[64:67], v[100:103], a[88:91], v[64:67]
    buffer_load_dwordx4 v11, s[8:11], s33 offen offset:1024 lds
    buffer_load_dwordx4 v12, s[8:11], s33 offen offset:2048 lds
    v_mfma_f32_16x16x32_bf16 v[68:71], v[100:103], a[152:155], v[68:71]
    ds_read_b64_tr_b16 v[118:119], v4 offset:29184
    v_mfma_f32_16x16x32_bf16 v[72:75], v[100:103], a[216:219], v[72:75]
    buffer_load_dwordx4 v13, s[8:11], s33 offen offset:3072 lds
    v_mfma_f32_16x16x32_bf16 v[76:79], v[104:107], a[24:27], v[76:79]
    s_add_u32 m0, s26, 0
    ds_read_b64_tr_b16 v[120:121], v5 offset:28672
    v_mfma_f32_16x16x32_bf16 v[80:83], v[104:107], a[88:91], v[80:83]
    s_add_u32 s25, s22, s44
    v_mfma_f32_16x16x32_bf16 v[84:87], v[104:107], a[152:155], v[84:87]
    ds_read_b64_tr_b16 v[122:123], v5 offset:29184
    v_mfma_f32_16x16x32_bf16 v[88:91], v[104:107], a[216:219], v[88:91]
    s_waitcnt lgkmcnt(4)
    v_mfma_f32_16x16x32_bf16 v[28:31], v[108:111], a[28:31], v[28:31]
    s_barrier
    ds_read_b64_tr_b16 v[92:93], v2 offset:32768
    v_mfma_f32_16x16x32_bf16 v[32:35], v[108:111], a[92:95], v[32:35]
    s_waitcnt vmcnt(21)
    buffer_load_dwordx4 v6, s[12:15], s25 offen offset:0 lds
    v_mfma_f32_16x16x32_bf16 v[36:39], v[108:111], a[156:159], v[36:39]
    ds_read_b64_tr_b16 v[94:95], v2 offset:33280
    ds_read_b128 a[32:35], v14 offset:8192
    v_mfma_f32_16x16x32_bf16 v[40:43], v[108:111], a[220:223], v[40:43]
    buffer_load_dwordx4 v7, s[12:15], s25 offen offset:1024 lds
    v_mfma_f32_16x16x32_bf16 v[44:47], v[112:115], a[28:31], v[44:47]
    ds_read_b64_tr_b16 v[96:97], v3 offset:32768
    ds_read_b128 a[96:99], v14 offset:10240
    v_mfma_f32_16x16x32_bf16 v[48:51], v[112:115], a[92:95], v[48:51]
    buffer_load_dwordx4 v8, s[12:15], s25 offen offset:2048 lds
    v_mfma_f32_16x16x32_bf16 v[52:55], v[112:115], a[156:159], v[52:55]
    ds_read_b64_tr_b16 v[98:99], v3 offset:33280
    ds_read_b128 a[160:163], v14 offset:12288
    v_mfma_f32_16x16x32_bf16 v[56:59], v[112:115], a[220:223], v[56:59]
    s_waitcnt lgkmcnt(7)
    buffer_load_dwordx4 v9, s[12:15], s25 offen offset:3072 lds
    v_mfma_f32_16x16x32_bf16 v[60:63], v[116:119], a[28:31], v[60:63]
    ds_read_b128 a[224:227], v14 offset:14336
    ds_read_b64_tr_b16 v[100:101], v4 offset:32768
    v_mfma_f32_16x16x32_bf16 v[64:67], v[116:119], a[92:95], v[64:67]
    ds_read_b128 a[36:39], v15 offset:8192
    v_mfma_f32_16x16x32_bf16 v[68:71], v[116:119], a[156:159], v[68:71]
    ds_read_b128 a[100:103], v15 offset:10240
    ds_read_b64_tr_b16 v[102:103], v4 offset:33280
    v_mfma_f32_16x16x32_bf16 v[72:75], v[116:119], a[220:223], v[72:75]
    ds_read_b128 a[164:167], v15 offset:12288
    v_mfma_f32_16x16x32_bf16 v[76:79], v[120:123], a[28:31], v[76:79]
    ds_read_b128 a[228:231], v15 offset:14336
    ds_read_b64_tr_b16 v[104:105], v5 offset:32768
    v_mfma_f32_16x16x32_bf16 v[80:83], v[120:123], a[92:95], v[80:83]
    v_mfma_f32_16x16x32_bf16 v[84:87], v[120:123], a[156:159], v[84:87]
    ds_read_b64_tr_b16 v[106:107], v5 offset:33280
    v_mfma_f32_16x16x32_bf16 v[88:91], v[120:123], a[220:223], v[88:91]
    s_waitcnt lgkmcnt(2)
    v_mfma_f32_16x16x32_bf16 v[28:31], v[92:95], a[32:35], v[28:31]
    s_add_u32 m0, s27, 8192
    s_add_u32 s33, s56, 896
    s_and_b32 s33, s33, 1023
    s_add_u32 s33, s33, s28
    ds_read_b64_tr_b16 v[108:109], v2 offset:36864
    v_mfma_f32_16x16x32_bf16 v[32:35], v[92:95], a[96:99], v[32:35]
    buffer_load_dwordx4 v10, s[8:11], s33 offen offset:0 lds
    v_mfma_f32_16x16x32_bf16 v[36:39], v[92:95], a[160:163], v[36:39]
    ds_read_b64_tr_b16 v[110:111], v2 offset:37376
    v_mfma_f32_16x16x32_bf16 v[40:43], v[92:95], a[224:227], v[40:43]
    buffer_load_dwordx4 v11, s[8:11], s33 offen offset:1024 lds
    buffer_load_dwordx4 v12, s[8:11], s33 offen offset:2048 lds
    v_mfma_f32_16x16x32_bf16 v[44:47], v[96:99], a[32:35], v[44:47]
    ds_read_b64_tr_b16 v[112:113], v3 offset:36864
    v_mfma_f32_16x16x32_bf16 v[48:51], v[96:99], a[96:99], v[48:51]
    buffer_load_dwordx4 v13, s[8:11], s33 offen offset:3072 lds
    v_mfma_f32_16x16x32_bf16 v[52:55], v[96:99], a[160:163], v[52:55]
    s_add_u32 m0, s27, 12288
    s_add_u32 s33, s33, 32768
    ds_read_b64_tr_b16 v[114:115], v3 offset:37376
    v_mfma_f32_16x16x32_bf16 v[56:59], v[96:99], a[224:227], v[56:59]
    s_waitcnt lgkmcnt(4)
    buffer_load_dwordx4 v10, s[8:11], s33 offen offset:0 lds
    v_mfma_f32_16x16x32_bf16 v[60:63], v[100:103], a[32:35], v[60:63]
    ds_read_b64_tr_b16 v[116:117], v4 offset:36864
    v_mfma_f32_16x16x32_bf16 v[64:67], v[100:103], a[96:99], v[64:67]
    buffer_load_dwordx4 v11, s[8:11], s33 offen offset:1024 lds
    buffer_load_dwordx4 v12, s[8:11], s33 offen offset:2048 lds
    v_mfma_f32_16x16x32_bf16 v[68:71], v[100:103], a[160:163], v[68:71]
    ds_read_b64_tr_b16 v[118:119], v4 offset:37376
    v_mfma_f32_16x16x32_bf16 v[72:75], v[100:103], a[224:227], v[72:75]
    buffer_load_dwordx4 v13, s[8:11], s33 offen offset:3072 lds
    v_mfma_f32_16x16x32_bf16 v[76:79], v[104:107], a[32:35], v[76:79]
    ds_read_b64_tr_b16 v[120:121], v5 offset:36864
    v_mfma_f32_16x16x32_bf16 v[80:83], v[104:107], a[96:99], v[80:83]
    v_mfma_f32_16x16x32_bf16 v[84:87], v[104:107], a[160:163], v[84:87]
    ds_read_b64_tr_b16 v[122:123], v5 offset:37376
    v_mfma_f32_16x16x32_bf16 v[88:91], v[104:107], a[224:227], v[88:91]
    s_waitcnt lgkmcnt(4)
    v_mfma_f32_16x16x32_bf16 v[28:31], v[108:111], a[36:39], v[28:31]
    ds_read_b64_tr_b16 v[92:93], v2 offset:40960
    v_mfma_f32_16x16x32_bf16 v[32:35], v[108:111], a[100:103], v[32:35]
    s_waitcnt vmcnt(21)
    v_mfma_f32_16x16x32_bf16 v[36:39], v[108:111], a[164:167], v[36:39]
    ds_read_b64_tr_b16 v[94:95], v2 offset:41472
    ds_read_b128 a[40:43], v14 offset:16384
    v_mfma_f32_16x16x32_bf16 v[40:43], v[108:111], a[228:231], v[40:43]
    v_mfma_f32_16x16x32_bf16 v[44:47], v[112:115], a[36:39], v[44:47]
    ds_read_b64_tr_b16 v[96:97], v3 offset:40960
    ds_read_b128 a[104:107], v14 offset:18432
    v_mfma_f32_16x16x32_bf16 v[48:51], v[112:115], a[100:103], v[48:51]
    v_mfma_f32_16x16x32_bf16 v[52:55], v[112:115], a[164:167], v[52:55]
    ds_read_b64_tr_b16 v[98:99], v3 offset:41472
    ds_read_b128 a[168:171], v14 offset:20480
    v_mfma_f32_16x16x32_bf16 v[56:59], v[112:115], a[228:231], v[56:59]
    s_waitcnt lgkmcnt(7)
    v_mfma_f32_16x16x32_bf16 v[60:63], v[116:119], a[36:39], v[60:63]
    ds_read_b128 a[232:235], v14 offset:22528
    ds_read_b64_tr_b16 v[100:101], v4 offset:40960
    v_mfma_f32_16x16x32_bf16 v[64:67], v[116:119], a[100:103], v[64:67]
    ds_read_b128 a[44:47], v15 offset:16384
    v_mfma_f32_16x16x32_bf16 v[68:71], v[116:119], a[164:167], v[68:71]
    ds_read_b128 a[108:111], v15 offset:18432
    ds_read_b64_tr_b16 v[102:103], v4 offset:41472
    v_mfma_f32_16x16x32_bf16 v[72:75], v[116:119], a[228:231], v[72:75]
    ds_read_b128 a[172:175], v15 offset:20480
    v_mfma_f32_16x16x32_bf16 v[76:79], v[120:123], a[36:39], v[76:79]
    ds_read_b128 a[236:239], v15 offset:22528
    ds_read_b64_tr_b16 v[104:105], v5 offset:40960
    v_mfma_f32_16x16x32_bf16 v[80:83], v[120:123], a[100:103], v[80:83]
    v_mfma_f32_16x16x32_bf16 v[84:87], v[120:123], a[164:167], v[84:87]
    ds_read_b64_tr_b16 v[106:107], v5 offset:41472
    v_mfma_f32_16x16x32_bf16 v[88:91], v[120:123], a[228:231], v[88:91]
    s_waitcnt lgkmcnt(2)
    v_mfma_f32_16x16x32_bf16 v[28:31], v[92:95], a[40:43], v[28:31]
    ds_read_b64_tr_b16 v[108:109], v2 offset:45056
    v_mfma_f32_16x16x32_bf16 v[32:35], v[92:95], a[104:107], v[32:35]
    v_mfma_f32_16x16x32_bf16 v[36:39], v[92:95], a[168:171], v[36:39]
    ds_read_b64_tr_b16 v[110:111], v2 offset:45568
    v_mfma_f32_16x16x32_bf16 v[40:43], v[92:95], a[232:235], v[40:43]
    v_mfma_f32_16x16x32_bf16 v[44:47], v[96:99], a[40:43], v[44:47]
    ds_read_b64_tr_b16 v[112:113], v3 offset:45056
    v_mfma_f32_16x16x32_bf16 v[48:51], v[96:99], a[104:107], v[48:51]
    v_mfma_f32_16x16x32_bf16 v[52:55], v[96:99], a[168:171], v[52:55]
    ds_read_b64_tr_b16 v[114:115], v3 offset:45568
    v_mfma_f32_16x16x32_bf16 v[56:59], v[96:99], a[232:235], v[56:59]
    s_waitcnt lgkmcnt(4)
    v_mfma_f32_16x16x32_bf16 v[60:63], v[100:103], a[40:43], v[60:63]
    ds_read_b64_tr_b16 v[116:117], v4 offset:45056
    v_mfma_f32_16x16x32_bf16 v[64:67], v[100:103], a[104:107], v[64:67]
    v_mfma_f32_16x16x32_bf16 v[68:71], v[100:103], a[168:171], v[68:71]
    ds_read_b64_tr_b16 v[118:119], v4 offset:45568
    v_mfma_f32_16x16x32_bf16 v[72:75], v[100:103], a[232:235], v[72:75]
    v_mfma_f32_16x16x32_bf16 v[76:79], v[104:107], a[40:43], v[76:79]
    s_add_u32 m0, s26, 16384
    ds_read_b64_tr_b16 v[120:121], v5 offset:45056
    v_mfma_f32_16x16x32_bf16 v[80:83], v[104:107], a[104:107], v[80:83]
    s_add_u32 s25, s22, s45
    v_mfma_f32_16x16x32_bf16 v[84:87], v[104:107], a[168:171], v[84:87]
    ds_read_b64_tr_b16 v[122:123], v5 offset:45568
    v_mfma_f32_16x16x32_bf16 v[88:91], v[104:107], a[232:235], v[88:91]
    s_waitcnt lgkmcnt(4)
    v_mfma_f32_16x16x32_bf16 v[28:31], v[108:111], a[44:47], v[28:31]
    s_barrier
    ds_read_b64_tr_b16 v[92:93], v2 offset:49152
    v_mfma_f32_16x16x32_bf16 v[32:35], v[108:111], a[108:111], v[32:35]
    s_waitcnt vmcnt(12)
    buffer_load_dwordx4 v6, s[12:15], s25 offen offset:0 lds
    v_mfma_f32_16x16x32_bf16 v[36:39], v[108:111], a[172:175], v[36:39]
    ds_read_b64_tr_b16 v[94:95], v2 offset:49664
    ds_read_b128 a[48:51], v14 offset:0
    v_mfma_f32_16x16x32_bf16 v[40:43], v[108:111], a[236:239], v[40:43]
    buffer_load_dwordx4 v7, s[12:15], s25 offen offset:1024 lds
    v_mfma_f32_16x16x32_bf16 v[44:47], v[112:115], a[44:47], v[44:47]
    ds_read_b64_tr_b16 v[96:97], v3 offset:49152
    ds_read_b128 a[112:115], v14 offset:2048
    v_mfma_f32_16x16x32_bf16 v[48:51], v[112:115], a[108:111], v[48:51]
    buffer_load_dwordx4 v8, s[12:15], s25 offen offset:2048 lds
    v_mfma_f32_16x16x32_bf16 v[52:55], v[112:115], a[172:175], v[52:55]
    ds_read_b64_tr_b16 v[98:99], v3 offset:49664
    ds_read_b128 a[176:179], v14 offset:4096
    v_mfma_f32_16x16x32_bf16 v[56:59], v[112:115], a[236:239], v[56:59]
    s_waitcnt lgkmcnt(7)
    buffer_load_dwordx4 v9, s[12:15], s25 offen offset:3072 lds
    v_and_b32 v236, 15, v0
    v_lshlrev_b32 v236, 13, v236
    v_mfma_f32_16x16x32_bf16 v[60:63], v[116:119], a[44:47], v[60:63]
    ds_read_b128 a[240:243], v14 offset:6144
    ds_read_b64_tr_b16 v[100:101], v4 offset:49152
    v_mfma_f32_16x16x32_bf16 v[64:67], v[116:119], a[108:111], v[64:67]
    s_lshl_b32 s3, s32, 2
    ds_read_b128 a[52:55], v15 offset:0
    v_lshrrev_b32 v237, 4, v0
    v_min_u32 v237, 2, v237
    v_mfma_f32_16x16x32_bf16 v[68:71], v[116:119], a[172:175], v[68:71]
    s_and_b32 s3, s3, 0x3e0000
    ds_read_b128 a[116:119], v15 offset:2048
    ds_read_b64_tr_b16 v[102:103], v4 offset:49664
    v_mfma_f32_16x16x32_bf16 v[72:75], v[116:119], a[236:239], v[72:75]
    s_add_u32 s3, s3, s21
    ds_read_b128 a[180:183], v15 offset:4096
    v_lshl_add_u32 v236, v237, 7, v236
    v_mfma_f32_16x16x32_bf16 v[76:79], v[120:123], a[44:47], v[76:79]
    ds_read_b128 a[244:247], v15 offset:6144
    ds_read_b64_tr_b16 v[104:105], v5 offset:49152
    v_mfma_f32_16x16x32_bf16 v[80:83], v[120:123], a[108:111], v[80:83]
    buffer_load_dword v226, v236, s[12:15], s3 offen offset:256
    v_mfma_f32_16x16x32_bf16 v[84:87], v[120:123], a[172:175], v[84:87]
    ds_read_b64_tr_b16 v[106:107], v5 offset:49664
    v_mfma_f32_16x16x32_bf16 v[88:91], v[120:123], a[236:239], v[88:91]
    s_waitcnt lgkmcnt(2)
    v_mfma_f32_16x16x32_bf16 v[28:31], v[92:95], a[48:51], v[28:31]
    ds_read_b64_tr_b16 v[108:109], v2 offset:53248
    v_mfma_f32_16x16x32_bf16 v[32:35], v[92:95], a[112:115], v[32:35]
    v_mfma_f32_16x16x32_bf16 v[36:39], v[92:95], a[176:179], v[36:39]
    ds_read_b64_tr_b16 v[110:111], v2 offset:53760
    v_mfma_f32_16x16x32_bf16 v[40:43], v[92:95], a[240:243], v[40:43]
    v_mfma_f32_16x16x32_bf16 v[44:47], v[96:99], a[48:51], v[44:47]
    ds_read_b64_tr_b16 v[112:113], v3 offset:53248
    v_mfma_f32_16x16x32_bf16 v[48:51], v[96:99], a[112:115], v[48:51]
    v_mfma_f32_16x16x32_bf16 v[52:55], v[96:99], a[176:179], v[52:55]
    ds_read_b64_tr_b16 v[114:115], v3 offset:53760
    v_mfma_f32_16x16x32_bf16 v[56:59], v[96:99], a[240:243], v[56:59]
    s_waitcnt lgkmcnt(4)
    v_mfma_f32_16x16x32_bf16 v[60:63], v[100:103], a[48:51], v[60:63]
    ds_read_b64_tr_b16 v[116:117], v4 offset:53248
    v_mfma_f32_16x16x32_bf16 v[64:67], v[100:103], a[112:115], v[64:67]
    v_mfma_f32_16x16x32_bf16 v[68:71], v[100:103], a[176:179], v[68:71]
    ds_read_b64_tr_b16 v[118:119], v4 offset:53760
    v_mfma_f32_16x16x32_bf16 v[72:75], v[100:103], a[240:243], v[72:75]
    v_mfma_f32_16x16x32_bf16 v[76:79], v[104:107], a[48:51], v[76:79]
    ds_read_b64_tr_b16 v[120:121], v5 offset:53248
    v_mfma_f32_16x16x32_bf16 v[80:83], v[104:107], a[112:115], v[80:83]
    v_mfma_f32_16x16x32_bf16 v[84:87], v[104:107], a[176:179], v[84:87]
    ds_read_b64_tr_b16 v[122:123], v5 offset:53760
    v_mfma_f32_16x16x32_bf16 v[88:91], v[104:107], a[240:243], v[88:91]
    s_waitcnt lgkmcnt(4)
    v_mfma_f32_16x16x32_bf16 v[28:31], v[108:111], a[52:55], v[28:31]
    ds_read_b64_tr_b16 v[92:93], v2 offset:57344
    v_mfma_f32_16x16x32_bf16 v[32:35], v[108:111], a[116:119], v[32:35]
    s_waitcnt vmcnt(5)
    v_mfma_f32_16x16x32_bf16 v[36:39], v[108:111], a[180:183], v[36:39]
    ds_read_b64_tr_b16 v[94:95], v2 offset:57856
    ds_read_b128 a[56:59], v14 offset:8192
    v_mfma_f32_16x16x32_bf16 v[40:43], v[108:111], a[244:247], v[40:43]
    v_mfma_f32_16x16x32_bf16 v[44:47], v[112:115], a[52:55], v[44:47]
    ds_read_b64_tr_b16 v[96:97], v3 offset:57344
    ds_read_b128 a[120:123], v14 offset:10240
    v_mfma_f32_16x16x32_bf16 v[48:51], v[112:115], a[116:119], v[48:51]
    v_mfma_f32_16x16x32_bf16 v[52:55], v[112:115], a[180:183], v[52:55]
    ds_read_b64_tr_b16 v[98:99], v3 offset:57856
    ds_read_b128 a[184:187], v14 offset:12288
    v_mfma_f32_16x16x32_bf16 v[56:59], v[112:115], a[244:247], v[56:59]
    s_waitcnt lgkmcnt(7)
    v_mfma_f32_16x16x32_bf16 v[60:63], v[116:119], a[52:55], v[60:63]
    ds_read_b128 a[248:251], v14 offset:14336
    ds_read_b64_tr_b16 v[100:101], v4 offset:57344
    v_mfma_f32_16x16x32_bf16 v[64:67], v[116:119], a[116:119], v[64:67]
    ds_read_b128 a[60:63], v15 offset:8192
    v_mfma_f32_16x16x32_bf16 v[68:71], v[116:119], a[180:183], v[68:71]
    ds_read_b128 a[124:127], v15 offset:10240
    ds_read_b64_tr_b16 v[102:103], v4 offset:57856
    v_mfma_f32_16x16x32_bf16 v[72:75], v[116:119], a[244:247], v[72:75]
    ds_read_b128 a[188:191], v15 offset:12288
    v_mfma_f32_16x16x32_bf16 v[76:79], v[120:123], a[52:55], v[76:79]
    ds_read_b128 a[252:255], v15 offset:14336
    ds_read_b64_tr_b16 v[104:105], v5 offset:57344
    v_mfma_f32_16x16x32_bf16 v[80:83], v[120:123], a[116:119], v[80:83]
    v_mfma_f32_16x16x32_bf16 v[84:87], v[120:123], a[180:183], v[84:87]
    ds_read_b64_tr_b16 v[106:107], v5 offset:57856
    v_mfma_f32_16x16x32_bf16 v[88:91], v[120:123], a[244:247], v[88:91]
    s_waitcnt lgkmcnt(2)
    v_mfma_f32_16x16x32_bf16 v[28:31], v[92:95], a[56:59], v[28:31]
    ds_read_b64_tr_b16 v[108:109], v2 offset:61440
    v_mfma_f32_16x16x32_bf16 v[32:35], v[92:95], a[120:123], v[32:35]
    v_mfma_f32_16x16x32_bf16 v[36:39], v[92:95], a[184:187], v[36:39]
    ds_read_b64_tr_b16 v[110:111], v2 offset:61952
    v_mfma_f32_16x16x32_bf16 v[40:43], v[92:95], a[248:251], v[40:43]
    v_mfma_f32_16x16x32_bf16 v[44:47], v[96:99], a[56:59], v[44:47]
    ds_read_b64_tr_b16 v[112:113], v3 offset:61440
    v_mfma_f32_16x16x32_bf16 v[48:51], v[96:99], a[120:123], v[48:51]
    v_mfma_f32_16x16x32_bf16 v[52:55], v[96:99], a[184:187], v[52:55]
    ds_read_b64_tr_b16 v[114:115], v3 offset:61952
    v_mfma_f32_16x16x32_bf16 v[56:59], v[96:99], a[248:251], v[56:59]
    s_waitcnt lgkmcnt(4)
    v_mfma_f32_16x16x32_bf16 v[60:63], v[100:103], a[56:59], v[60:63]
    ds_read_b64_tr_b16 v[116:117], v4 offset:61440
    v_mfma_f32_16x16x32_bf16 v[64:67], v[100:103], a[120:123], v[64:67]
    v_mfma_f32_16x16x32_bf16 v[68:71], v[100:103], a[184:187], v[68:71]
    ds_read_b64_tr_b16 v[118:119], v4 offset:61952
    v_mfma_f32_16x16x32_bf16 v[72:75], v[100:103], a[248:251], v[72:75]
    v_mfma_f32_16x16x32_bf16 v[76:79], v[104:107], a[56:59], v[76:79]
    s_add_u32 m0, s26, 32768
    ds_read_b64_tr_b16 v[120:121], v5 offset:61440
    v_mfma_f32_16x16x32_bf16 v[80:83], v[104:107], a[120:123], v[80:83]
    s_add_u32 s25, s22, s50
    v_mfma_f32_16x16x32_bf16 v[84:87], v[104:107], a[184:187], v[84:87]
    ds_read_b64_tr_b16 v[122:123], v5 offset:61952
    v_mfma_f32_16x16x32_bf16 v[88:91], v[104:107], a[248:251], v[88:91]
    s_waitcnt lgkmcnt(4)
    v_mfma_f32_16x16x32_bf16 v[28:31], v[108:111], a[60:63], v[28:31]
    s_barrier
    ds_read_b64_tr_b16 v[92:93], v2 offset:0
    v_mfma_f32_16x16x32_bf16 v[32:35], v[108:111], a[124:127], v[32:35]
    buffer_load_dwordx4 v6, s[12:15], s25 offen offset:0 lds
    v_mfma_f32_16x16x32_bf16 v[36:39], v[108:111], a[188:191], v[36:39]
    ds_read_b64_tr_b16 v[94:95], v2 offset:512
    v_mfma_f32_16x16x32_bf16 v[40:43], v[108:111], a[252:255], v[40:43]
    buffer_load_dwordx4 v7, s[12:15], s25 offen offset:1024 lds
    v_mfma_f32_16x16x32_bf16 v[44:47], v[112:115], a[60:63], v[44:47]
    s_mov_b32 s21, s22
    ds_read_b64_tr_b16 v[96:97], v3 offset:0
    v_mfma_f32_16x16x32_bf16 v[48:51], v[112:115], a[124:127], v[48:51]
    s_add_u32 s22, s22, 128
    buffer_load_dwordx4 v8, s[12:15], s25 offen offset:2048 lds
    v_mfma_f32_16x16x32_bf16 v[52:55], v[112:115], a[188:191], v[52:55]
    ds_read_b64_tr_b16 v[98:99], v3 offset:512
    v_mfma_f32_16x16x32_bf16 v[56:59], v[112:115], a[252:255], v[56:59]
    s_waitcnt lgkmcnt(4)
    buffer_load_dwordx4 v9, s[12:15], s25 offen offset:3072 lds
    v_mfma_f32_16x16x32_bf16 v[60:63], v[116:119], a[60:63], v[60:63]
    ds_read_b64_tr_b16 v[100:101], v4 offset:0
    v_mfma_f32_16x16x32_bf16 v[64:67], v[116:119], a[124:127], v[64:67]
    v_mfma_f32_16x16x32_bf16 v[68:71], v[116:119], a[188:191], v[68:71]
    ds_read_b64_tr_b16 v[102:103], v4 offset:512
    v_mfma_f32_16x16x32_bf16 v[72:75], v[116:119], a[252:255], v[72:75]
    v_mfma_f32_16x16x32_bf16 v[76:79], v[120:123], a[60:63], v[76:79]
    ds_read_b64_tr_b16 v[104:105], v5 offset:0
    v_mfma_f32_16x16x32_bf16 v[80:83], v[120:123], a[124:127], v[80:83]
    v_mfma_f32_16x16x32_bf16 v[84:87], v[120:123], a[188:191], v[84:87]
    ds_read_b64_tr_b16 v[106:107], v5 offset:512
    v_mfma_f32_16x16x32_bf16 v[88:91], v[120:123], a[252:255], v[88:91]
    s_waitcnt lgkmcnt(4)
    v_mfma_f32_16x16x32_bf16 v[156:159], v[92:95], a[0:3], 0
    s_lshr_b32 s23, s31, 1
    ds_read_b64_tr_b16 v[108:109], v2 offset:4096
    v_mul_f32 v28, s34, v28
    v_mfma_f32_16x16x32_bf16 v[160:163], v[92:95], a[64:67], 0
    s_lshl_b32 s23, s23, 20
    v_mul_f32 v29, s34, v29
    v_mul_f32 v30, s34, v30
    v_mfma_f32_16x16x32_bf16 v[164:167], v[92:95], a[128:131], 0
    s_add_u32 s23, s23, s32
    ds_read_b64_tr_b16 v[110:111], v2 offset:4608
    v_mul_f32 v31, s34, v31
    v_mfma_f32_16x16x32_bf16 v[168:171], v[92:95], a[192:195], 0
    s_and_b32 s33, s31, 1
    v_cvt_pk_bf16_f32 v124, v28, v29
    v_cvt_pk_bf16_f32 v125, v30, v31
    v_mfma_f32_16x16x32_bf16 v[172:175], v[96:99], a[0:3], 0
    s_lshl_b32 s33, s33, 11
    ds_read_b64_tr_b16 v[112:113], v3 offset:4096
    v_mul_f32 v32, s34, v32
    v_mfma_f32_16x16x32_bf16 v[176:179], v[96:99], a[64:67], 0
    s_add_u32 s23, s23, s33
    v_mul_f32 v33, s34, v33
    v_mul_f32 v34, s34, v34
    v_mfma_f32_16x16x32_bf16 v[180:183], v[96:99], a[128:131], 0
    s_add_u32 s31, s31, 1
    ds_read_b64_tr_b16 v[114:115], v3 offset:4608
    v_mul_f32 v35, s34, v35
    v_mfma_f32_16x16x32_bf16 v[184:187], v[96:99], a[192:195], 0
    s_waitcnt lgkmcnt(4)
    v_cvt_pk_bf16_f32 v132, v32, v33
    v_cvt_pk_bf16_f32 v133, v34, v35
    v_mfma_f32_16x16x32_bf16 v[188:191], v[100:103], a[0:3], 0
    s_add_u32 m0, s48, 0
    ds_read_b64_tr_b16 v[116:117], v4 offset:4096
    v_mul_f32 v36, s34, v36
    v_mfma_f32_16x16x32_bf16 v[192:195], v[100:103], a[64:67], 0
    s_add_u32 s25, s22, s44
    v_mul_f32 v37, s34, v37
    v_mul_f32 v38, s34, v38
    v_mfma_f32_16x16x32_bf16 v[196:199], v[100:103], a[128:131], 0
    ds_read_b64_tr_b16 v[118:119], v4 offset:4608
    v_mul_f32 v39, s34, v39
    v_mfma_f32_16x16x32_bf16 v[200:203], v[100:103], a[192:195], 0
    buffer_load_dwordx4 v6, s[12:15], s25 offen offset:0 lds
    v_cvt_pk_bf16_f32 v140, v36, v37
    v_mfma_f32_16x16x32_bf16 v[204:207], v[104:107], a[0:3], 0
    ds_read_b64_tr_b16 v[120:121], v5 offset:4096
    v_cvt_pk_bf16_f32 v141, v38, v39
    v_mfma_f32_16x16x32_bf16 v[208:211], v[104:107], a[64:67], 0
    v_mul_f32 v40, s34, v40
    v_mul_f32 v41, s34, v41
    v_mfma_f32_16x16x32_bf16 v[212:215], v[104:107], a[128:131], 0
    ds_read_b64_tr_b16 v[122:123], v5 offset:4608
    v_mul_f32 v42, s34, v42
    v_mfma_f32_16x16x32_bf16 v[216:219], v[104:107], a[192:195], 0
    s_waitcnt lgkmcnt(4)
    buffer_load_dwordx4 v7, s[12:15], s25 offen offset:1024 lds
    v_mul_f32 v43, s34, v43
    v_mfma_f32_16x16x32_bf16 v[156:159], v[108:111], a[4:7], v[156:159]
    ds_read_b64_tr_b16 v[92:93], v2 offset:8192
    v_cvt_pk_bf16_f32 v148, v40, v41
    v_mfma_f32_16x16x32_bf16 v[160:163], v[108:111], a[68:71], v[160:163]
    v_cvt_pk_bf16_f32 v149, v42, v43
    v_mul_f32 v44, s34, v44
    v_mfma_f32_16x16x32_bf16 v[164:167], v[108:111], a[132:135], v[164:167]
    ds_read_b64_tr_b16 v[94:95], v2 offset:8704
    v_mul_f32 v45, s34, v45
    v_mfma_f32_16x16x32_bf16 v[168:171], v[108:111], a[196:199], v[168:171]
    buffer_load_dwordx4 v8, s[12:15], s25 offen offset:2048 lds
    v_mul_f32 v46, s34, v46
    v_mfma_f32_16x16x32_bf16 v[172:175], v[112:115], a[4:7], v[172:175]
    ds_read_b64_tr_b16 v[96:97], v3 offset:8192
    v_mul_f32 v47, s34, v47
    v_mfma_f32_16x16x32_bf16 v[176:179], v[112:115], a[68:71], v[176:179]
    v_cvt_pk_bf16_f32 v126, v44, v45
    v_cvt_pk_bf16_f32 v127, v46, v47
    v_mfma_f32_16x16x32_bf16 v[180:183], v[112:115], a[132:135], v[180:183]
    ds_read_b64_tr_b16 v[98:99], v3 offset:8704
    v_mul_f32 v48, s34, v48
    v_mfma_f32_16x16x32_bf16 v[184:187], v[112:115], a[196:199], v[184:187]
    s_waitcnt lgkmcnt(4)
    buffer_load_dwordx4 v9, s[12:15], s25 offen offset:3072 lds
    v_mul_f32 v49, s34, v49
    v_mfma_f32_16x16x32_bf16 v[188:191], v[116:119], a[4:7], v[188:191]
    ds_read_b64_tr_b16 v[100:101], v4 offset:8192
    v_mul_f32 v50, s34, v50
    v_mfma_f32_16x16x32_bf16 v[192:195], v[116:119], a[68:71], v[192:195]
    v_mul_f32 v51, s34, v51
    v_cvt_pk_bf16_f32 v134, v48, v49
    v_mfma_f32_16x16x32_bf16 v[196:199], v[116:119], a[132:135], v[196:199]
    s_add_u32 m0, s48, 16384
    ds_read_b64_tr_b16 v[102:103], v4 offset:8704
    v_cvt_pk_bf16_f32 v135, v50, v51
    v_mfma_f32_16x16x32_bf16 v[200:203], v[116:119], a[196:199], v[200:203]
    s_add_u32 s25, s22, s45
    v_mul_f32 v52, s34, v52
    v_mul_f32 v53, s34, v53
    v_mfma_f32_16x16x32_bf16 v[204:207], v[120:123], a[4:7], v[204:207]
    ds_read_b64_tr_b16 v[104:105], v5 offset:8192
    v_mul_f32 v54, s34, v54
    v_mfma_f32_16x16x32_bf16 v[208:211], v[120:123], a[68:71], v[208:211]
    buffer_load_dwordx4 v6, s[12:15], s25 offen offset:0 lds
    v_mul_f32 v55, s34, v55
    v_mfma_f32_16x16x32_bf16 v[212:215], v[120:123], a[132:135], v[212:215]
    ds_read_b64_tr_b16 v[106:107], v5 offset:8704
    v_cvt_pk_bf16_f32 v142, v52, v53
    v_mfma_f32_16x16x32_bf16 v[216:219], v[120:123], a[196:199], v[216:219]
    s_waitcnt lgkmcnt(4)
    v_cvt_pk_bf16_f32 v143, v54, v55
    v_mul_f32 v56, s34, v56
    v_mfma_f32_16x16x32_bf16 v[156:159], v[92:95], a[8:11], v[156:159]
    ds_read_b64_tr_b16 v[108:109], v2 offset:12288
    v_mul_f32 v57, s34, v57
    v_mfma_f32_16x16x32_bf16 v[160:163], v[92:95], a[72:75], v[160:163]
    buffer_load_dwordx4 v7, s[12:15], s25 offen offset:1024 lds
    v_mul_f32 v58, s34, v58
    v_mfma_f32_16x16x32_bf16 v[164:167], v[92:95], a[136:139], v[164:167]
    ds_read_b64_tr_b16 v[110:111], v2 offset:12800
    v_mul_f32 v59, s34, v59
    v_mfma_f32_16x16x32_bf16 v[168:171], v[92:95], a[200:203], v[168:171]
    v_cvt_pk_bf16_f32 v150, v56, v57
    v_cvt_pk_bf16_f32 v151, v58, v59
    v_mfma_f32_16x16x32_bf16 v[172:175], v[96:99], a[8:11], v[172:175]
    ds_read_b64_tr_b16 v[112:113], v3 offset:12288
    v_mul_f32 v60, s34, v60
    v_mfma_f32_16x16x32_bf16 v[176:179], v[96:99], a[72:75], v[176:179]
    buffer_load_dwordx4 v8, s[12:15], s25 offen offset:2048 lds
    v_mul_f32 v61, s34, v61
    v_mfma_f32_16x16x32_bf16 v[180:183], v[96:99], a[136:139], v[180:183]
    ds_read_b64_tr_b16 v[114:115], v3 offset:12800
    v_mul_f32 v62, s34, v62
    v_mfma_f32_16x16x32_bf16 v[184:187], v[96:99], a[200:203], v[184:187]
    s_waitcnt lgkmcnt(4)
    v_mul_f32 v63, s34, v63
    v_cvt_pk_bf16_f32 v128, v60, v61
    v_mfma_f32_16x16x32_bf16 v[188:191], v[100:103], a[8:11], v[188:191]
    ds_read_b64_tr_b16 v[116:117], v4 offset:12288
    v_cvt_pk_bf16_f32 v129, v62, v63
    v_mfma_f32_16x16x32_bf16 v[192:195], v[100:103], a[72:75], v[192:195]
    buffer_load_dwordx4 v9, s[12:15], s25 offen offset:3072 lds
    v_mul_f32 v64, s34, v64
    v_mfma_f32_16x16x32_bf16 v[196:199], v[100:103], a[136:139], v[196:199]
    ds_read_b64_tr_b16 v[118:119], v4 offset:12800
    v_mul_f32 v65, s34, v65
    v_mfma_f32_16x16x32_bf16 v[200:203], v[100:103], a[200:203], v[200:203]
    v_mul_f32 v66, s34, v66
    v_mul_f32 v67, s34, v67
    v_mfma_f32_16x16x32_bf16 v[204:207], v[104:107], a[8:11], v[204:207]
    s_add_u32 m0, s26, 49152
    ds_read_b64_tr_b16 v[120:121], v5 offset:12288
    v_cvt_pk_bf16_f32 v136, v64, v65
    v_mfma_f32_16x16x32_bf16 v[208:211], v[104:107], a[72:75], v[208:211]
    s_add_u32 s25, s21, s51
    v_cvt_pk_bf16_f32 v137, v66, v67
    v_mul_f32 v68, s34, v68
    v_mfma_f32_16x16x32_bf16 v[212:215], v[104:107], a[136:139], v[212:215]
    s_waitcnt vmcnt(13)
    ds_read_b64_tr_b16 v[122:123], v5 offset:12800
    v_mul_f32 v69, s34, v69
    v_mfma_f32_16x16x32_bf16 v[216:219], v[104:107], a[200:203], v[216:219]
    s_waitcnt lgkmcnt(4)
    v_mul_f32 v70, s34, v70
    v_mul_f32 v71, s34, v71
    v_mfma_f32_16x16x32_bf16 v[156:159], v[108:111], a[12:15], v[156:159]
    s_barrier
    ds_read_b64_tr_b16 v[92:93], v2 offset:16384
    v_cvt_pk_bf16_f32 v144, v68, v69
    v_mfma_f32_16x16x32_bf16 v[160:163], v[108:111], a[76:79], v[160:163]
    buffer_load_dwordx4 v6, s[12:15], s25 offen offset:0 lds
    v_cvt_pk_bf16_f32 v145, v70, v71
    v_mfma_f32_16x16x32_bf16 v[164:167], v[108:111], a[140:143], v[164:167]
    ds_read_b64_tr_b16 v[94:95], v2 offset:16896
    v_mul_f32 v72, s34, v72
    v_mfma_f32_16x16x32_bf16 v[168:171], v[108:111], a[204:207], v[168:171]
    buffer_load_dwordx4 v7, s[12:15], s25 offen offset:1024 lds
    v_mul_f32 v73, s34, v73
    v_mfma_f32_16x16x32_bf16 v[172:175], v[112:115], a[12:15], v[172:175]
    ds_read_b64_tr_b16 v[96:97], v3 offset:16384
    v_mul_f32 v74, s34, v74
    v_mfma_f32_16x16x32_bf16 v[176:179], v[112:115], a[76:79], v[176:179]
    buffer_load_dwordx4 v8, s[12:15], s25 offen offset:2048 lds
    v_mul_f32 v75, s34, v75
    v_mfma_f32_16x16x32_bf16 v[180:183], v[112:115], a[140:143], v[180:183]
    ds_read_b64_tr_b16 v[98:99], v3 offset:16896
    v_cvt_pk_bf16_f32 v152, v72, v73
    v_mfma_f32_16x16x32_bf16 v[184:187], v[112:115], a[204:207], v[184:187]
    s_waitcnt lgkmcnt(4)
    buffer_load_dwordx4 v9, s[12:15], s25 offen offset:3072 lds
    v_cvt_pk_bf16_f32 v153, v74, v75
    v_mfma_f32_16x16x32_bf16 v[188:191], v[116:119], a[12:15], v[188:191]
    ds_read_b64_tr_b16 v[100:101], v4 offset:16384
    v_mul_f32 v76, s34, v76
    v_mfma_f32_16x16x32_bf16 v[192:195], v[116:119], a[76:79], v[192:195]
    v_mul_f32 v77, s34, v77
    v_mul_f32 v78, s34, v78
    v_mfma_f32_16x16x32_bf16 v[196:199], v[116:119], a[140:143], v[196:199]
    s_add_u32 m0, s48, 32768
    ds_read_b64_tr_b16 v[102:103], v4 offset:16896
    v_mul_f32 v79, s34, v79
    v_mfma_f32_16x16x32_bf16 v[200:203], v[116:119], a[204:207], v[200:203]
    s_add_u32 s25, s22, s50
    v_cvt_pk_bf16_f32 v130, v76, v77
    v_cvt_pk_bf16_f32 v131, v78, v79
    v_mfma_f32_16x16x32_bf16 v[204:207], v[120:123], a[12:15], v[204:207]
    ds_read_b64_tr_b16 v[104:105], v5 offset:16384
    v_mul_f32 v80, s34, v80
    v_mfma_f32_16x16x32_bf16 v[208:211], v[120:123], a[76:79], v[208:211]
    buffer_load_dwordx4 v6, s[12:15], s25 offen offset:0 lds
    v_mul_f32 v81, s34, v81
    v_mfma_f32_16x16x32_bf16 v[212:215], v[120:123], a[140:143], v[212:215]
    ds_read_b64_tr_b16 v[106:107], v5 offset:16896
    v_mul_f32 v82, s34, v82
    v_mfma_f32_16x16x32_bf16 v[216:219], v[120:123], a[204:207], v[216:219]
    s_waitcnt lgkmcnt(4)
    v_mul_f32 v83, s34, v83
    v_cvt_pk_bf16_f32 v138, v80, v81
    v_mfma_f32_16x16x32_bf16 v[156:159], v[92:95], a[16:19], v[156:159]
    ds_read_b64_tr_b16 v[108:109], v2 offset:20480
    v_cvt_pk_bf16_f32 v139, v82, v83
    v_mfma_f32_16x16x32_bf16 v[160:163], v[92:95], a[80:83], v[160:163]
    buffer_load_dwordx4 v7, s[12:15], s25 offen offset:1024 lds
    v_mul_f32 v84, s34, v84
    v_mfma_f32_16x16x32_bf16 v[164:167], v[92:95], a[144:147], v[164:167]
    ds_read_b64_tr_b16 v[110:111], v2 offset:20992
    v_mul_f32 v85, s34, v85
    v_mfma_f32_16x16x32_bf16 v[168:171], v[92:95], a[208:211], v[168:171]
    v_mul_f32 v86, s34, v86
    v_mul_f32 v87, s34, v87
    v_mfma_f32_16x16x32_bf16 v[172:175], v[96:99], a[16:19], v[172:175]
    ds_read_b64_tr_b16 v[112:113], v3 offset:20480
    v_cvt_pk_bf16_f32 v146, v84, v85
    v_mfma_f32_16x16x32_bf16 v[176:179], v[96:99], a[80:83], v[176:179]
    buffer_load_dwordx4 v8, s[12:15], s25 offen offset:2048 lds
    v_cvt_pk_bf16_f32 v147, v86, v87
    v_mfma_f32_16x16x32_bf16 v[180:183], v[96:99], a[144:147], v[180:183]
    ds_read_b64_tr_b16 v[114:115], v3 offset:20992
    v_mul_f32 v88, s34, v88
    v_mfma_f32_16x16x32_bf16 v[184:187], v[96:99], a[208:211], v[184:187]
    s_waitcnt lgkmcnt(4)
    v_mul_f32 v89, s34, v89
    v_mul_f32 v90, s34, v90
    v_mfma_f32_16x16x32_bf16 v[188:191], v[100:103], a[16:19], v[188:191]
    ds_read_b64_tr_b16 v[116:117], v4 offset:20480
    v_mul_f32 v91, s34, v91
    v_mfma_f32_16x16x32_bf16 v[192:195], v[100:103], a[80:83], v[192:195]
    buffer_load_dwordx4 v9, s[12:15], s25 offen offset:3072 lds
    v_cvt_pk_bf16_f32 v154, v88, v89
    v_mfma_f32_16x16x32_bf16 v[196:199], v[100:103], a[144:147], v[196:199]
    ds_read_b64_tr_b16 v[118:119], v4 offset:20992
    v_cvt_pk_bf16_f32 v155, v90, v91
    v_mfma_f32_16x16x32_bf16 v[200:203], v[100:103], a[208:211], v[200:203]
    v_mfma_f32_16x16x32_bf16 v[204:207], v[104:107], a[16:19], v[204:207]
    ds_read_b64_tr_b16 v[120:121], v5 offset:20480
    v_mfma_f32_16x16x32_bf16 v[208:211], v[104:107], a[80:83], v[208:211]
    v_mfma_f32_16x16x32_bf16 v[212:215], v[104:107], a[144:147], v[212:215]
    ds_read_b64_tr_b16 v[122:123], v5 offset:20992
    v_mfma_f32_16x16x32_bf16 v[216:219], v[104:107], a[208:211], v[216:219]
    s_waitcnt lgkmcnt(4)
    v_mfma_f32_16x16x32_bf16 v[156:159], v[108:111], a[20:23], v[156:159]
    ds_read_b64_tr_b16 v[92:93], v2 offset:24576
    v_mfma_f32_16x16x32_bf16 v[160:163], v[108:111], a[84:87], v[160:163]
    v_mfma_f32_16x16x32_bf16 v[164:167], v[108:111], a[148:151], v[164:167]
    s_add_u32 m0, s48, 49152
    ds_read_b64_tr_b16 v[94:95], v2 offset:25088
    v_mfma_f32_16x16x32_bf16 v[168:171], v[108:111], a[212:215], v[168:171]
    s_add_u32 s25, s22, s51
    v_mfma_f32_16x16x32_bf16 v[172:175], v[112:115], a[20:23], v[172:175]
    ds_read_b64_tr_b16 v[96:97], v3 offset:24576
    v_mfma_f32_16x16x32_bf16 v[176:179], v[112:115], a[84:87], v[176:179]
    buffer_load_dwordx4 v6, s[12:15], s25 offen offset:0 lds
    v_mfma_f32_16x16x32_bf16 v[180:183], v[112:115], a[148:151], v[180:183]
    ds_read_b64_tr_b16 v[98:99], v3 offset:25088
    v_mfma_f32_16x16x32_bf16 v[184:187], v[112:115], a[212:215], v[184:187]
    s_waitcnt lgkmcnt(4)
    v_mfma_f32_16x16x32_bf16 v[188:191], v[116:119], a[20:23], v[188:191]
    ds_read_b64_tr_b16 v[100:101], v4 offset:24576
    v_mfma_f32_16x16x32_bf16 v[192:195], v[116:119], a[84:87], v[192:195]
    buffer_load_dwordx4 v7, s[12:15], s25 offen offset:1024 lds
    v_mfma_f32_16x16x32_bf16 v[196:199], v[116:119], a[148:151], v[196:199]
    ds_read_b64_tr_b16 v[102:103], v4 offset:25088
    v_mfma_f32_16x16x32_bf16 v[200:203], v[116:119], a[212:215], v[200:203]
    v_mfma_f32_16x16x32_bf16 v[204:207], v[120:123], a[20:23], v[204:207]
    ds_read_b64_tr_b16 v[104:105], v5 offset:24576
    v_mfma_f32_16x16x32_bf16 v[208:211], v[120:123], a[84:87], v[208:211]
    buffer_load_dwordx4 v8, s[12:15], s25 offen offset:2048 lds
    v_mfma_f32_16x16x32_bf16 v[212:215], v[120:123], a[148:151], v[212:215]
    ds_read_b64_tr_b16 v[106:107], v5 offset:25088
    v_mfma_f32_16x16x32_bf16 v[216:219], v[120:123], a[212:215], v[216:219]
    s_waitcnt lgkmcnt(4)
    v_mfma_f32_16x16x32_bf16 v[156:159], v[92:95], a[24:27], v[156:159]
    ds_read_b64_tr_b16 v[108:109], v2 offset:28672
    v_mfma_f32_16x16x32_bf16 v[160:163], v[92:95], a[88:91], v[160:163]
    buffer_load_dwordx4 v9, s[12:15], s25 offen offset:3072 lds
    v_mfma_f32_16x16x32_bf16 v[164:167], v[92:95], a[152:155], v[164:167]
    ds_read_b64_tr_b16 v[110:111], v2 offset:29184
    v_mfma_f32_16x16x32_bf16 v[168:171], v[92:95], a[216:219], v[168:171]
    v_mfma_f32_16x16x32_bf16 v[172:175], v[96:99], a[24:27], v[172:175]
    ds_read_b64_tr_b16 v[112:113], v3 offset:28672
    v_mfma_f32_16x16x32_bf16 v[176:179], v[96:99], a[88:91], v[176:179]
    v_mfma_f32_16x16x32_bf16 v[180:183], v[96:99], a[152:155], v[180:183]
    ds_read_b64_tr_b16 v[114:115], v3 offset:29184
    v_mfma_f32_16x16x32_bf16 v[184:187], v[96:99], a[216:219], v[184:187]
    s_waitcnt lgkmcnt(4)
    v_mfma_f32_16x16x32_bf16 v[188:191], v[100:103], a[24:27], v[188:191]
    ds_read_b64_tr_b16 v[116:117], v4 offset:28672
    v_mfma_f32_16x16x32_bf16 v[192:195], v[100:103], a[88:91], v[192:195]
    v_mfma_f32_16x16x32_bf16 v[196:199], v[100:103], a[152:155], v[196:199]
    ds_read_b64_tr_b16 v[118:119], v4 offset:29184
    v_mfma_f32_16x16x32_bf16 v[200:203], v[100:103], a[216:219], v[200:203]
    v_mfma_f32_16x16x32_bf16 v[204:207], v[104:107], a[24:27], v[204:207]
    ds_read_b64_tr_b16 v[120:121], v5 offset:28672
    v_mfma_f32_16x16x32_bf16 v[208:211], v[104:107], a[88:91], v[208:211]
    buffer_store_dwordx4 v[124:127], v18, s[16:19], s23 offen offset:0 sc1
    v_mfma_f32_16x16x32_bf16 v[212:215], v[104:107], a[152:155], v[212:215]
    s_waitcnt vmcnt(21)
    ds_read_b64_tr_b16 v[122:123], v5 offset:29184
    v_mfma_f32_16x16x32_bf16 v[216:219], v[104:107], a[216:219], v[216:219]
    s_waitcnt lgkmcnt(4)
    v_mfma_f32_16x16x32_bf16 v[156:159], v[108:111], a[28:31], v[156:159]
    s_barrier
    ds_read_b64_tr_b16 v[92:93], v2 offset:32768
    v_mfma_f32_16x16x32_bf16 v[160:163], v[108:111], a[92:95], v[160:163]
    v_mfma_f32_16x16x32_bf16 v[164:167], v[108:111], a[156:159], v[164:167]
    ds_read_b64_tr_b16 v[94:95], v2 offset:33280
    v_mfma_f32_16x16x32_bf16 v[168:171], v[108:111], a[220:223], v[168:171]
    v_mfma_f32_16x16x32_bf16 v[172:175], v[112:115], a[28:31], v[172:175]
    ds_read_b64_tr_b16 v[96:97], v3 offset:32768
    v_mfma_f32_16x16x32_bf16 v[176:179], v[112:115], a[92:95], v[176:179]
    v_mfma_f32_16x16x32_bf16 v[180:183], v[112:115], a[156:159], v[180:183]
    ds_read_b64_tr_b16 v[98:99], v3 offset:33280
    v_mfma_f32_16x16x32_bf16 v[184:187], v[112:115], a[220:223], v[184:187]
    s_waitcnt lgkmcnt(4)
    v_mfma_f32_16x16x32_bf16 v[188:191], v[116:119], a[28:31], v[188:191]
    ds_read_b64_tr_b16 v[100:101], v4 offset:32768
    v_mfma_f32_16x16x32_bf16 v[192:195], v[116:119], a[92:95], v[192:195]
    v_mfma_f32_16x16x32_bf16 v[196:199], v[116:119], a[156:159], v[196:199]
    ds_read_b64_tr_b16 v[102:103], v4 offset:33280
    v_mfma_f32_16x16x32_bf16 v[200:203], v[116:119], a[220:223], v[200:203]
    v_mfma_f32_16x16x32_bf16 v[204:207], v[120:123], a[28:31], v[204:207]
    ds_read_b64_tr_b16 v[104:105], v5 offset:32768
    v_mfma_f32_16x16x32_bf16 v[208:211], v[120:123], a[92:95], v[208:211]
    buffer_store_dwordx4 v[128:131], v18, s[16:19], s23 offen offset:1024 sc1
    v_mfma_f32_16x16x32_bf16 v[212:215], v[120:123], a[156:159], v[212:215]
    ds_read_b64_tr_b16 v[106:107], v5 offset:33280
    v_mfma_f32_16x16x32_bf16 v[216:219], v[120:123], a[220:223], v[216:219]
    s_waitcnt lgkmcnt(4)
    v_mfma_f32_16x16x32_bf16 v[156:159], v[92:95], a[32:35], v[156:159]
    ds_read_b64_tr_b16 v[108:109], v2 offset:36864
    v_mfma_f32_16x16x32_bf16 v[160:163], v[92:95], a[96:99], v[160:163]
    v_mfma_f32_16x16x32_bf16 v[164:167], v[92:95], a[160:163], v[164:167]
    ds_read_b64_tr_b16 v[110:111], v2 offset:37376
    v_mfma_f32_16x16x32_bf16 v[168:171], v[92:95], a[224:227], v[168:171]
    v_mfma_f32_16x16x32_bf16 v[172:175], v[96:99], a[32:35], v[172:175]
    ds_read_b64_tr_b16 v[112:113], v3 offset:36864
    v_mfma_f32_16x16x32_bf16 v[176:179], v[96:99], a[96:99], v[176:179]
    v_mfma_f32_16x16x32_bf16 v[180:183], v[96:99], a[160:163], v[180:183]
    ds_read_b64_tr_b16 v[114:115], v3 offset:37376
    v_mfma_f32_16x16x32_bf16 v[184:187], v[96:99], a[224:227], v[184:187]
    s_waitcnt lgkmcnt(4)
    v_mfma_f32_16x16x32_bf16 v[188:191], v[100:103], a[32:35], v[188:191]
    ds_read_b64_tr_b16 v[116:117], v4 offset:36864
    v_mfma_f32_16x16x32_bf16 v[192:195], v[100:103], a[96:99], v[192:195]
    v_mfma_f32_16x16x32_bf16 v[196:199], v[100:103], a[160:163], v[196:199]
    ds_read_b64_tr_b16 v[118:119], v4 offset:37376
    v_mfma_f32_16x16x32_bf16 v[200:203], v[100:103], a[224:227], v[200:203]
    v_mfma_f32_16x16x32_bf16 v[204:207], v[104:107], a[32:35], v[204:207]
    ds_read_b64_tr_b16 v[120:121], v5 offset:36864
    v_mfma_f32_16x16x32_bf16 v[208:211], v[104:107], a[96:99], v[208:211]
    buffer_store_dwordx4 v[132:135], v19, s[16:19], s23 offen offset:0 sc1
    v_mfma_f32_16x16x32_bf16 v[212:215], v[104:107], a[160:163], v[212:215]
    ds_read_b64_tr_b16 v[122:123], v5 offset:37376
    v_mfma_f32_16x16x32_bf16 v[216:219], v[104:107], a[224:227], v[216:219]
    s_waitcnt lgkmcnt(4)
    v_mfma_f32_16x16x32_bf16 v[156:159], v[108:111], a[36:39], v[156:159]
    ds_read_b64_tr_b16 v[92:93], v2 offset:40960
    v_mfma_f32_16x16x32_bf16 v[160:163], v[108:111], a[100:103], v[160:163]
    v_mfma_f32_16x16x32_bf16 v[164:167], v[108:111], a[164:167], v[164:167]
    ds_read_b64_tr_b16 v[94:95], v2 offset:41472
    v_mfma_f32_16x16x32_bf16 v[168:171], v[108:111], a[228:231], v[168:171]
    v_mfma_f32_16x16x32_bf16 v[172:175], v[112:115], a[36:39], v[172:175]
    ds_read_b64_tr_b16 v[96:97], v3 offset:40960
    v_mfma_f32_16x16x32_bf16 v[176:179], v[112:115], a[100:103], v[176:179]
    buffer_load_dword v226, v227, s[40:43], s4 offen
    v_mfma_f32_16x16x32_bf16 v[180:183], v[112:115], a[164:167], v[180:183]
    s_add_u32 s4, s4, 1792
    ds_read_b64_tr_b16 v[98:99], v3 offset:41472
    v_mfma_f32_16x16x32_bf16 v[184:187], v[112:115], a[228:231], v[184:187]
    s_waitcnt lgkmcnt(4)
    v_mfma_f32_16x16x32_bf16 v[188:191], v[116:119], a[36:39], v[188:191]
    ds_read_b64_tr_b16 v[100:101], v4 offset:40960
    v_mfma_f32_16x16x32_bf16 v[192:195], v[116:119], a[100:103], v[192:195]
    v_mfma_f32_16x16x32_bf16 v[196:199], v[116:119], a[164:167], v[196:199]
    ds_read_b64_tr_b16 v[102:103], v4 offset:41472
    v_mfma_f32_16x16x32_bf16 v[200:203], v[116:119], a[228:231], v[200:203]
    v_mfma_f32_16x16x32_bf16 v[204:207], v[120:123], a[36:39], v[204:207]
    ds_read_b64_tr_b16 v[104:105], v5 offset:40960
    v_mfma_f32_16x16x32_bf16 v[208:211], v[120:123], a[100:103], v[208:211]
    buffer_store_dwordx4 v[136:139], v19, s[16:19], s23 offen offset:1024 sc1
    v_mfma_f32_16x16x32_bf16 v[212:215], v[120:123], a[164:167], v[212:215]
    ds_read_b64_tr_b16 v[106:107], v5 offset:41472
    v_mfma_f32_16x16x32_bf16 v[216:219], v[120:123], a[228:231], v[216:219]
    s_waitcnt lgkmcnt(4)
    v_mfma_f32_16x16x32_bf16 v[156:159], v[92:95], a[40:43], v[156:159]
    ds_read_b64_tr_b16 v[108:109], v2 offset:45056
    v_mfma_f32_16x16x32_bf16 v[160:163], v[92:95], a[104:107], v[160:163]
    v_mfma_f32_16x16x32_bf16 v[164:167], v[92:95], a[168:171], v[164:167]
    ds_read_b64_tr_b16 v[110:111], v2 offset:45568
    v_mfma_f32_16x16x32_bf16 v[168:171], v[92:95], a[232:235], v[168:171]
    v_mfma_f32_16x16x32_bf16 v[172:175], v[96:99], a[40:43], v[172:175]
    ds_read_b64_tr_b16 v[112:113], v3 offset:45056
    v_mfma_f32_16x16x32_bf16 v[176:179], v[96:99], a[104:107], v[176:179]
    buffer_load_dword v226, v234, s[36:39], s58 offen
    v_mfma_f32_16x16x32_bf16 v[180:183], v[96:99], a[168:171], v[180:183]
    ds_read_b64_tr_b16 v[114:115], v3 offset:45568
    v_mfma_f32_16x16x32_bf16 v[184:187], v[96:99], a[232:235], v[184:187]
    s_waitcnt lgkmcnt(4)
    v_mfma_f32_16x16x32_bf16 v[188:191], v[100:103], a[40:43], v[188:191]
    ds_read_b64_tr_b16 v[116:117], v4 offset:45056
    v_mfma_f32_16x16x32_bf16 v[192:195], v[100:103], a[104:107], v[192:195]
    v_mfma_f32_16x16x32_bf16 v[196:199], v[100:103], a[168:171], v[196:199]
    ds_read_b64_tr_b16 v[118:119], v4 offset:45568
    v_mfma_f32_16x16x32_bf16 v[200:203], v[100:103], a[232:235], v[200:203]
    v_mfma_f32_16x16x32_bf16 v[204:207], v[104:107], a[40:43], v[204:207]
    ds_read_b64_tr_b16 v[120:121], v5 offset:45056
    v_mfma_f32_16x16x32_bf16 v[208:211], v[104:107], a[104:107], v[208:211]
    buffer_store_dwordx4 v[140:143], v20, s[16:19], s23 offen offset:0 sc1
    v_mfma_f32_16x16x32_bf16 v[212:215], v[104:107], a[168:171], v[212:215]
    s_waitcnt vmcnt(15)
    ds_read_b64_tr_b16 v[122:123], v5 offset:45568
    v_mfma_f32_16x16x32_bf16 v[216:219], v[104:107], a[232:235], v[216:219]
    s_waitcnt lgkmcnt(4)
    v_mfma_f32_16x16x32_bf16 v[156:159], v[108:111], a[44:47], v[156:159]
    s_barrier
    ds_read_b64_tr_b16 v[92:93], v2 offset:49152
    v_mfma_f32_16x16x32_bf16 v[160:163], v[108:111], a[108:111], v[160:163]
    v_mfma_f32_16x16x32_bf16 v[164:167], v[108:111], a[172:175], v[164:167]
    ds_read_b64_tr_b16 v[94:95], v2 offset:49664
    v_mfma_f32_16x16x32_bf16 v[168:171], v[108:111], a[236:239], v[168:171]
    v_mfma_f32_16x16x32_bf16 v[172:175], v[112:115], a[44:47], v[172:175]
    ds_read_b64_tr_b16 v[96:97], v3 offset:49152
    v_mfma_f32_16x16x32_bf16 v[176:179], v[112:115], a[108:111], v[176:179]
    v_mfma_f32_16x16x32_bf16 v[180:183], v[112:115], a[172:175], v[180:183]
    ds_read_b64_tr_b16 v[98:99], v3 offset:49664
    v_mfma_f32_16x16x32_bf16 v[184:187], v[112:115], a[236:239], v[184:187]
    s_waitcnt lgkmcnt(4)
    v_mfma_f32_16x16x32_bf16 v[188:191], v[116:119], a[44:47], v[188:191]
    ds_read_b64_tr_b16 v[100:101], v4 offset:49152
    v_mfma_f32_16x16x32_bf16 v[192:195], v[116:119], a[108:111], v[192:195]
    v_mfma_f32_16x16x32_bf16 v[196:199], v[116:119], a[172:175], v[196:199]
    ds_read_b64_tr_b16 v[102:103], v4 offset:49664
    v_mfma_f32_16x16x32_bf16 v[200:203], v[116:119], a[236:239], v[200:203]
    v_mfma_f32_16x16x32_bf16 v[204:207], v[120:123], a[44:47], v[204:207]
    ds_read_b64_tr_b16 v[104:105], v5 offset:49152
    v_mfma_f32_16x16x32_bf16 v[208:211], v[120:123], a[108:111], v[208:211]
    buffer_store_dwordx4 v[144:147], v20, s[16:19], s23 offen offset:1024 sc1
    v_mfma_f32_16x16x32_bf16 v[212:215], v[120:123], a[172:175], v[212:215]
    ds_read_b64_tr_b16 v[106:107], v5 offset:49664
    v_mfma_f32_16x16x32_bf16 v[216:219], v[120:123], a[236:239], v[216:219]
    s_waitcnt lgkmcnt(4)
    v_mfma_f32_16x16x32_bf16 v[156:159], v[92:95], a[48:51], v[156:159]
    ds_read_b64_tr_b16 v[108:109], v2 offset:53248
    v_mfma_f32_16x16x32_bf16 v[160:163], v[92:95], a[112:115], v[160:163]
    v_mfma_f32_16x16x32_bf16 v[164:167], v[92:95], a[176:179], v[164:167]
    ds_read_b64_tr_b16 v[110:111], v2 offset:53760
    v_mfma_f32_16x16x32_bf16 v[168:171], v[92:95], a[240:243], v[168:171]
    v_mfma_f32_16x16x32_bf16 v[172:175], v[96:99], a[48:51], v[172:175]
    ds_read_b64_tr_b16 v[112:113], v3 offset:53248
    v_mfma_f32_16x16x32_bf16 v[176:179], v[96:99], a[112:115], v[176:179]
    v_mfma_f32_16x16x32_bf16 v[180:183], v[96:99], a[176:179], v[180:183]
    ds_read_b64_tr_b16 v[114:115], v3 offset:53760
    v_mfma_f32_16x16x32_bf16 v[184:187], v[96:99], a[240:243], v[184:187]
    s_waitcnt lgkmcnt(4)
    v_mfma_f32_16x16x32_bf16 v[188:191], v[100:103], a[48:51], v[188:191]
    ds_read_b64_tr_b16 v[116:117], v4 offset:53248
    v_mfma_f32_16x16x32_bf16 v[192:195], v[100:103], a[112:115], v[192:195]
    v_mfma_f32_16x16x32_bf16 v[196:199], v[100:103], a[176:179], v[196:199]
    ds_read_b64_tr_b16 v[118:119], v4 offset:53760
    v_mfma_f32_16x16x32_bf16 v[200:203], v[100:103], a[240:243], v[200:203]
    v_mfma_f32_16x16x32_bf16 v[204:207], v[104:107], a[48:51], v[204:207]
    ds_read_b64_tr_b16 v[120:121], v5 offset:53248
    v_mfma_f32_16x16x32_bf16 v[208:211], v[104:107], a[112:115], v[208:211]
    buffer_store_dwordx4 v[148:151], v21, s[16:19], s23 offen offset:0 sc1
    v_mfma_f32_16x16x32_bf16 v[212:215], v[104:107], a[176:179], v[212:215]
    ds_read_b64_tr_b16 v[122:123], v5 offset:53760
    v_mfma_f32_16x16x32_bf16 v[216:219], v[104:107], a[240:243], v[216:219]
    s_waitcnt lgkmcnt(4)
    v_mfma_f32_16x16x32_bf16 v[156:159], v[108:111], a[52:55], v[156:159]
    ds_read_b64_tr_b16 v[92:93], v2 offset:57344
    v_mfma_f32_16x16x32_bf16 v[160:163], v[108:111], a[116:119], v[160:163]
    v_mfma_f32_16x16x32_bf16 v[164:167], v[108:111], a[180:183], v[164:167]
    ds_read_b64_tr_b16 v[94:95], v2 offset:57856
    v_mfma_f32_16x16x32_bf16 v[168:171], v[108:111], a[244:247], v[168:171]
    v_mfma_f32_16x16x32_bf16 v[172:175], v[112:115], a[52:55], v[172:175]
    ds_read_b64_tr_b16 v[96:97], v3 offset:57344
    v_mfma_f32_16x16x32_bf16 v[176:179], v[112:115], a[116:119], v[176:179]
    v_mfma_f32_16x16x32_bf16 v[180:183], v[112:115], a[180:183], v[180:183]
    ds_read_b64_tr_b16 v[98:99], v3 offset:57856
    v_mfma_f32_16x16x32_bf16 v[184:187], v[112:115], a[244:247], v[184:187]
    s_waitcnt lgkmcnt(4)
    v_mfma_f32_16x16x32_bf16 v[188:191], v[116:119], a[52:55], v[188:191]
    ds_read_b64_tr_b16 v[100:101], v4 offset:57344
    v_mfma_f32_16x16x32_bf16 v[192:195], v[116:119], a[116:119], v[192:195]
    v_mfma_f32_16x16x32_bf16 v[196:199], v[116:119], a[180:183], v[196:199]
    ds_read_b64_tr_b16 v[102:103], v4 offset:57856
    v_mfma_f32_16x16x32_bf16 v[200:203], v[116:119], a[244:247], v[200:203]
    v_mfma_f32_16x16x32_bf16 v[204:207], v[120:123], a[52:55], v[204:207]
    ds_read_b64_tr_b16 v[104:105], v5 offset:57344
    v_mfma_f32_16x16x32_bf16 v[208:211], v[120:123], a[116:119], v[208:211]
    buffer_store_dwordx4 v[152:155], v21, s[16:19], s23 offen offset:1024 sc1
    v_mfma_f32_16x16x32_bf16 v[212:215], v[120:123], a[180:183], v[212:215]
    ds_read_b64_tr_b16 v[106:107], v5 offset:57856
    v_mfma_f32_16x16x32_bf16 v[216:219], v[120:123], a[244:247], v[216:219]
    s_waitcnt lgkmcnt(4)
    v_mfma_f32_16x16x32_bf16 v[156:159], v[92:95], a[56:59], v[156:159]
    ds_read_b64_tr_b16 v[108:109], v2 offset:61440
    v_mfma_f32_16x16x32_bf16 v[160:163], v[92:95], a[120:123], v[160:163]
    v_mfma_f32_16x16x32_bf16 v[164:167], v[92:95], a[184:187], v[164:167]
    ds_read_b64_tr_b16 v[110:111], v2 offset:61952
    v_mfma_f32_16x16x32_bf16 v[168:171], v[92:95], a[248:251], v[168:171]
    v_mfma_f32_16x16x32_bf16 v[172:175], v[96:99], a[56:59], v[172:175]
    ds_read_b64_tr_b16 v[112:113], v3 offset:61440
    v_mfma_f32_16x16x32_bf16 v[176:179], v[96:99], a[120:123], v[176:179]
    v_mfma_f32_16x16x32_bf16 v[180:183], v[96:99], a[184:187], v[180:183]
    ds_read_b64_tr_b16 v[114:115], v3 offset:61952
    v_mfma_f32_16x16x32_bf16 v[184:187], v[96:99], a[248:251], v[184:187]
    s_waitcnt lgkmcnt(4)
    v_mfma_f32_16x16x32_bf16 v[188:191], v[100:103], a[56:59], v[188:191]
    ds_read_b64_tr_b16 v[116:117], v4 offset:61440
    v_mfma_f32_16x16x32_bf16 v[192:195], v[100:103], a[120:123], v[192:195]
    v_mfma_f32_16x16x32_bf16 v[196:199], v[100:103], a[184:187], v[196:199]
    ds_read_b64_tr_b16 v[118:119], v4 offset:61952
    v_mfma_f32_16x16x32_bf16 v[200:203], v[100:103], a[248:251], v[200:203]
    v_mfma_f32_16x16x32_bf16 v[204:207], v[104:107], a[56:59], v[204:207]
    ds_read_b64_tr_b16 v[120:121], v5 offset:61440
    v_mfma_f32_16x16x32_bf16 v[208:211], v[104:107], a[120:123], v[208:211]
    v_mfma_f32_16x16x32_bf16 v[212:215], v[104:107], a[184:187], v[212:215]
    s_waitcnt vmcnt(10)
    ds_read_b64_tr_b16 v[122:123], v5 offset:61952
    v_mfma_f32_16x16x32_bf16 v[216:219], v[104:107], a[248:251], v[216:219]
    s_waitcnt lgkmcnt(4)
    v_xor_b32 v2, 0x10000, v2
    v_xor_b32 v3, 0x10000, v3
    v_mfma_f32_16x16x32_bf16 v[156:159], v[108:111], a[60:63], v[156:159]
    s_barrier
    ds_read_b64_tr_b16 v[92:93], v2 offset:0
    v_mfma_f32_16x16x32_bf16 v[160:163], v[108:111], a[124:127], v[160:163]
    v_xor_b32 v4, 0x10000, v4
    v_xor_b32 v5, 0x10000, v5
    v_mfma_f32_16x16x32_bf16 v[164:167], v[108:111], a[188:191], v[164:167]
    s_xor_b32 s48, s48, 0x10000
    ds_read_b64_tr_b16 v[94:95], v2 offset:512
    v_mfma_f32_16x16x32_bf16 v[168:171], v[108:111], a[252:255], v[168:171]
    v_mfma_f32_16x16x32_bf16 v[172:175], v[112:115], a[60:63], v[172:175]
    s_mov_b32 s21, s22
    ds_read_b64_tr_b16 v[96:97], v3 offset:0
    v_mfma_f32_16x16x32_bf16 v[176:179], v[112:115], a[124:127], v[176:179]
    s_add_u32 s22, s22, 128
    v_mfma_f32_16x16x32_bf16 v[180:183], v[112:115], a[188:191], v[180:183]
    ds_read_b64_tr_b16 v[98:99], v3 offset:512
    v_mfma_f32_16x16x32_bf16 v[184:187], v[112:115], a[252:255], v[184:187]
    s_waitcnt lgkmcnt(4)
    v_mfma_f32_16x16x32_bf16 v[188:191], v[116:119], a[60:63], v[188:191]
    ds_read_b64_tr_b16 v[100:101], v4 offset:0
    v_mfma_f32_16x16x32_bf16 v[192:195], v[116:119], a[124:127], v[192:195]
    v_mfma_f32_16x16x32_bf16 v[196:199], v[116:119], a[188:191], v[196:199]
    ds_read_b64_tr_b16 v[102:103], v4 offset:512
    v_mfma_f32_16x16x32_bf16 v[200:203], v[116:119], a[252:255], v[200:203]
    v_mfma_f32_16x16x32_bf16 v[204:207], v[120:123], a[60:63], v[204:207]
    ds_read_b64_tr_b16 v[104:105], v5 offset:0
    v_mfma_f32_16x16x32_bf16 v[208:211], v[120:123], a[124:127], v[208:211]
    v_mfma_f32_16x16x32_bf16 v[212:215], v[120:123], a[188:191], v[212:215]
    ds_read_b64_tr_b16 v[106:107], v5 offset:512
    v_mfma_f32_16x16x32_bf16 v[216:219], v[120:123], a[252:255], v[216:219]
    s_waitcnt lgkmcnt(4)
    v_mfma_f32_16x16x32_bf16 v[28:31], v[92:95], a[0:3], 0
    s_lshr_b32 s23, s31, 1
    ds_read_b64_tr_b16 v[108:109], v2 offset:4096
    v_mul_f32 v156, s34, v156
    v_mfma_f32_16x16x32_bf16 v[32:35], v[92:95], a[64:67], 0
    s_lshl_b32 s23, s23, 20
    v_mul_f32 v157, s34, v157
    v_mul_f32 v158, s34, v158
    v_mfma_f32_16x16x32_bf16 v[36:39], v[92:95], a[128:131], 0
    s_add_u32 s23, s23, s32
    ds_read_b64_tr_b16 v[110:111], v2 offset:4608
    v_mul_f32 v159, s34, v159
    v_mfma_f32_16x16x32_bf16 v[40:43], v[92:95], a[192:195], 0
    s_and_b32 s33, s31, 1
    v_cvt_pk_bf16_f32 v124, v156, v157
    v_cvt_pk_bf16_f32 v125, v158, v159
    v_mfma_f32_16x16x32_bf16 v[44:47], v[96:99], a[0:3], 0
    s_lshl_b32 s33, s33, 11
    ds_read_b64_tr_b16 v[112:113], v3 offset:4096
    v_mul_f32 v160, s34, v160
    v_mfma_f32_16x16x32_bf16 v[48:51], v[96:99], a[64:67], 0
    s_add_u32 s23, s23, s33
    v_mul_f32 v161, s34, v161
    v_mul_f32 v162, s34, v162
    v_mfma_f32_16x16x32_bf16 v[52:55], v[96:99], a[128:131], 0
    s_add_u32 s31, s31, 1
    ds_read_b64_tr_b16 v[114:115], v3 offset:4608
    v_mul_f32 v163, s34, v163
    v_mfma_f32_16x16x32_bf16 v[56:59], v[96:99], a[192:195], 0
    s_waitcnt lgkmcnt(4)
    v_cvt_pk_bf16_f32 v132, v160, v161
    v_cvt_pk_bf16_f32 v133, v162, v163
    v_mfma_f32_16x16x32_bf16 v[60:63], v[100:103], a[0:3], 0
    s_barrier
    ds_read_b64_tr_b16 v[116:117], v4 offset:4096
    v_mul_f32 v164, s34, v164
    v_mfma_f32_16x16x32_bf16 v[64:67], v[100:103], a[64:67], 0
    v_mul_f32 v165, s34, v165
    v_mul_f32 v166, s34, v166
    v_mfma_f32_16x16x32_bf16 v[68:71], v[100:103], a[128:131], 0
    s_add_u32 m0, s48, 0
    ds_read_b64_tr_b16 v[118:119], v4 offset:4608
    v_mul_f32 v167, s34, v167
    v_mfma_f32_16x16x32_bf16 v[72:75], v[100:103], a[192:195], 0
    s_add_u32 s25, s22, s44
    v_cvt_pk_bf16_f32 v140, v164, v165
    v_cvt_pk_bf16_f32 v141, v166, v167
    v_mfma_f32_16x16x32_bf16 v[76:79], v[104:107], a[0:3], 0
    ds_read_b64_tr_b16 v[120:121], v5 offset:4096
    v_mul_f32 v168, s34, v168
    v_mfma_f32_16x16x32_bf16 v[80:83], v[104:107], a[64:67], 0
    buffer_load_dwordx4 v6, s[12:15], s25 offen offset:0 lds
    v_mul_f32 v169, s34, v169
    v_mfma_f32_16x16x32_bf16 v[84:87], v[104:107], a[128:131], 0
    ds_read_b64_tr_b16 v[122:123], v5 offset:4608
    v_mul_f32 v170, s34, v170
    v_mfma_f32_16x16x32_bf16 v[88:91], v[104:107], a[192:195], 0
    s_waitcnt lgkmcnt(4)
    v_mul_f32 v171, s34, v171
    v_cvt_pk_bf16_f32 v148, v168, v169
    v_mfma_f32_16x16x32_bf16 v[28:31], v[108:111], a[4:7], v[28:31]
    ds_read_b64_tr_b16 v[92:93], v2 offset:8192
    v_cvt_pk_bf16_f32 v149, v170, v171
    v_mfma_f32_16x16x32_bf16 v[32:35], v[108:111], a[68:71], v[32:35]
    v_mul_f32 v172, s34, v172
    v_mul_f32 v173, s34, v173
    v_mfma_f32_16x16x32_bf16 v[36:39], v[108:111], a[132:135], v[36:39]
    ds_read_b64_tr_b16 v[94:95], v2 offset:8704
    v_mul_f32 v174, s34, v174
    v_mfma_f32_16x16x32_bf16 v[40:43], v[108:111], a[196:199], v[40:43]
    buffer_load_dwordx4 v7, s[12:15], s25 offen offset:1024 lds
    v_mul_f32 v175, s34, v175
    v_mfma_f32_16x16x32_bf16 v[44:47], v[112:115], a[4:7], v[44:47]
    ds_read_b64_tr_b16 v[96:97], v3 offset:8192
    v_cvt_pk_bf16_f32 v126, v172, v173
    v_mfma_f32_16x16x32_bf16 v[48:51], v[112:115], a[68:71], v[48:51]
    v_cvt_pk_bf16_f32 v127, v174, v175
    v_mul_f32 v176, s34, v176
    v_mfma_f32_16x16x32_bf16 v[52:55], v[112:115], a[132:135], v[52:55]
    ds_read_b64_tr_b16 v[98:99], v3 offset:8704
    v_mul_f32 v177, s34, v177
    v_mfma_f32_16x16x32_bf16 v[56:59], v[112:115], a[196:199], v[56:59]
    s_waitcnt lgkmcnt(4)
    v_mul_f32 v178, s34, v178
    v_mul_f32 v179, s34, v179
    v_mfma_f32_16x16x32_bf16 v[60:63], v[116:119], a[4:7], v[60:63]
    ds_read_b64_tr_b16 v[100:101], v4 offset:8192
    v_cvt_pk_bf16_f32 v134, v176, v177
    v_mfma_f32_16x16x32_bf16 v[64:67], v[116:119], a[68:71], v[64:67]
    buffer_load_dwordx4 v8, s[12:15], s25 offen offset:2048 lds
    v_cvt_pk_bf16_f32 v135, v178, v179
    v_mfma_f32_16x16x32_bf16 v[68:71], v[116:119], a[132:135], v[68:71]
    ds_read_b64_tr_b16 v[102:103], v4 offset:8704
    v_mul_f32 v180, s34, v180
    v_mfma_f32_16x16x32_bf16 v[72:75], v[116:119], a[196:199], v[72:75]
    v_mul_f32 v181, s34, v181
    v_mul_f32 v182, s34, v182
    v_mfma_f32_16x16x32_bf16 v[76:79], v[120:123], a[4:7], v[76:79]
    ds_read_b64_tr_b16 v[104:105], v5 offset:8192
    v_mul_f32 v183, s34, v183
    v_mfma_f32_16x16x32_bf16 v[80:83], v[120:123], a[68:71], v[80:83]
    v_cvt_pk_bf16_f32 v142, v180, v181
    v_cvt_pk_bf16_f32 v143, v182, v183
    v_mfma_f32_16x16x32_bf16 v[84:87], v[120:123], a[132:135], v[84:87]
    ds_read_b64_tr_b16 v[106:107], v5 offset:8704
    v_mul_f32 v184, s34, v184
    v_mfma_f32_16x16x32_bf16 v[88:91], v[120:123], a[196:199], v[88:91]
    s_waitcnt lgkmcnt(4)
    buffer_load_dwordx4 v9, s[12:15], s25 offen offset:3072 lds
    v_mul_f32 v185, s34, v185
    v_mfma_f32_16x16x32_bf16 v[28:31], v[92:95], a[8:11], v[28:31]
    ds_read_b64_tr_b16 v[108:109], v2 offset:12288
    v_mul_f32 v186, s34, v186
    v_mfma_f32_16x16x32_bf16 v[32:35], v[92:95], a[72:75], v[32:35]
    v_mul_f32 v187, s34, v187
    v_cvt_pk_bf16_f32 v150, v184, v185
    v_mfma_f32_16x16x32_bf16 v[36:39], v[92:95], a[136:139], v[36:39]
    s_add_u32 m0, s48, 16384
    ds_read_b64_tr_b16 v[110:111], v2 offset:12800
    v_cvt_pk_bf16_f32 v151, v186, v187
    v_mfma_f32_16x16x32_bf16 v[40:43], v[92:95], a[200:203], v[40:43]
    s_add_u32 s25, s22, s45
    v_mul_f32 v188, s34, v188
    v_mul_f32 v189, s34, v189
    v_mfma_f32_16x16x32_bf16 v[44:47], v[96:99], a[8:11], v[44:47]
    ds_read_b64_tr_b16 v[112:113], v3 offset:12288
    v_mul_f32 v190, s34, v190
    v_mfma_f32_16x16x32_bf16 v[48:51], v[96:99], a[72:75], v[48:51]
    buffer_load_dwordx4 v6, s[12:15], s25 offen offset:0 lds
    v_mul_f32 v191, s34, v191
    v_mfma_f32_16x16x32_bf16 v[52:55], v[96:99], a[136:139], v[52:55]
    ds_read_b64_tr_b16 v[114:115], v3 offset:12800
    v_cvt_pk_bf16_f32 v128, v188, v189
    v_mfma_f32_16x16x32_bf16 v[56:59], v[96:99], a[200:203], v[56:59]
    s_waitcnt lgkmcnt(4)
    v_cvt_pk_bf16_f32 v129, v190, v191
    v_mul_f32 v192, s34, v192
    v_mfma_f32_16x16x32_bf16 v[60:63], v[100:103], a[8:11], v[60:63]
    ds_read_b64_tr_b16 v[116:117], v4 offset:12288
    v_mul_f32 v193, s34, v193
    v_mfma_f32_16x16x32_bf16 v[64:67], v[100:103], a[72:75], v[64:67]
    v_mul_f32 v194, s34, v194
    v_mul_f32 v195, s34, v195
    v_mfma_f32_16x16x32_bf16 v[68:71], v[100:103], a[136:139], v[68:71]
    ds_read_b64_tr_b16 v[118:119], v4 offset:12800
    v_cvt_pk_bf16_f32 v136, v192, v193
    v_mfma_f32_16x16x32_bf16 v[72:75], v[100:103], a[200:203], v[72:75]
    buffer_load_dwordx4 v7, s[12:15], s25 offen offset:1024 lds
    v_cvt_pk_bf16_f32 v137, v194, v195
    v_mfma_f32_16x16x32_bf16 v[76:79], v[104:107], a[8:11], v[76:79]
    ds_read_b64_tr_b16 v[120:121], v5 offset:12288
    v_mul_f32 v196, s34, v196
    v_mfma_f32_16x16x32_bf16 v[80:83], v[104:107], a[72:75], v[80:83]
    v_mul_f32 v197, s34, v197
    v_mul_f32 v198, s34, v198
    v_mfma_f32_16x16x32_bf16 v[84:87], v[104:107], a[136:139], v[84:87]
    ds_read_b64_tr_b16 v[122:123], v5 offset:12800
    v_mul_f32 v199, s34, v199
    v_mfma_f32_16x16x32_bf16 v[88:91], v[104:107], a[200:203], v[88:91]
    s_waitcnt lgkmcnt(4)
    v_cvt_pk_bf16_f32 v144, v196, v197
    v_cvt_pk_bf16_f32 v145, v198, v199
    v_mfma_f32_16x16x32_bf16 v[28:31], v[108:111], a[12:15], v[28:31]
    ds_read_b64_tr_b16 v[92:93], v2 offset:16384
    v_mul_f32 v200, s34, v200
    v_mfma_f32_16x16x32_bf16 v[32:35], v[108:111], a[76:79], v[32:35]
    buffer_load_dwordx4 v8, s[12:15], s25 offen offset:2048 lds
    v_mul_f32 v201, s34, v201
    v_mfma_f32_16x16x32_bf16 v[36:39], v[108:111], a[140:143], v[36:39]
    ds_read_b64_tr_b16 v[94:95], v2 offset:16896
    v_mul_f32 v202, s34, v202
    v_mfma_f32_16x16x32_bf16 v[40:43], v[108:111], a[204:207], v[40:43]
    v_mul_f32 v203, s34, v203
    v_cvt_pk_bf16_f32 v152, v200, v201
    v_mfma_f32_16x16x32_bf16 v[44:47], v[112:115], a[12:15], v[44:47]
    ds_read_b64_tr_b16 v[96:97], v3 offset:16384
    v_cvt_pk_bf16_f32 v153, v202, v203
    v_mfma_f32_16x16x32_bf16 v[48:51], v[112:115], a[76:79], v[48:51]
    v_mul_f32 v204, s34, v204
    v_mul_f32 v205, s34, v205
    v_mfma_f32_16x16x32_bf16 v[52:55], v[112:115], a[140:143], v[52:55]
    ds_read_b64_tr_b16 v[98:99], v3 offset:16896
    v_mul_f32 v206, s34, v206
    v_mfma_f32_16x16x32_bf16 v[56:59], v[112:115], a[204:207], v[56:59]
    s_waitcnt lgkmcnt(4)
    buffer_load_dwordx4 v9, s[12:15], s25 offen offset:3072 lds
    v_mul_f32 v207, s34, v207
    v_mfma_f32_16x16x32_bf16 v[60:63], v[116:119], a[12:15], v[60:63]
    ds_read_b64_tr_b16 v[100:101], v4 offset:16384
    v_cvt_pk_bf16_f32 v130, v204, v205
    v_mfma_f32_16x16x32_bf16 v[64:67], v[116:119], a[76:79], v[64:67]
    v_cvt_pk_bf16_f32 v131, v206, v207
    v_mul_f32 v208, s34, v208
    v_mfma_f32_16x16x32_bf16 v[68:71], v[116:119], a[140:143], v[68:71]
    s_add_u32 m0, s48, 32768
    ds_read_b64_tr_b16 v[102:103], v4 offset:16896
    v_mul_f32 v209, s34, v209
    v_mfma_f32_16x16x32_bf16 v[72:75], v[116:119], a[204:207], v[72:75]
    s_add_u32 s25, s22, s50
    v_mul_f32 v210, s34, v210
    v_mul_f32 v211, s34, v211
    v_mfma_f32_16x16x32_bf16 v[76:79], v[120:123], a[12:15], v[76:79]
    ds_read_b64_tr_b16 v[104:105], v5 offset:16384
    v_cvt_pk_bf16_f32 v138, v208, v209
    v_mfma_f32_16x16x32_bf16 v[80:83], v[120:123], a[76:79], v[80:83]
    buffer_load_dwordx4 v6, s[12:15], s25 offen offset:0 lds
    v_cvt_pk_bf16_f32 v139, v210, v211
    v_mfma_f32_16x16x32_bf16 v[84:87], v[120:123], a[140:143], v[84:87]
    ds_read_b64_tr_b16 v[106:107], v5 offset:16896
    v_mul_f32 v212, s34, v212
    v_mfma_f32_16x16x32_bf16 v[88:91], v[120:123], a[204:207], v[88:91]
    s_waitcnt lgkmcnt(4)
    v_mul_f32 v213, s34, v213
    v_mul_f32 v214, s34, v214
    v_mfma_f32_16x16x32_bf16 v[28:31], v[92:95], a[16:19], v[28:31]
    ds_read_b64_tr_b16 v[108:109], v2 offset:20480
    v_mul_f32 v215, s34, v215
    v_mfma_f32_16x16x32_bf16 v[32:35], v[92:95], a[80:83], v[32:35]
    v_cvt_pk_bf16_f32 v146, v212, v213
    v_cvt_pk_bf16_f32 v147, v214, v215
    v_mfma_f32_16x16x32_bf16 v[36:39], v[92:95], a[144:147], v[36:39]
    ds_read_b64_tr_b16 v[110:111], v2 offset:20992
    v_mul_f32 v216, s34, v216
    v_mfma_f32_16x16x32_bf16 v[40:43], v[92:95], a[208:211], v[40:43]
    buffer_load_dwordx4 v7, s[12:15], s25 offen offset:1024 lds
    v_mul_f32 v217, s34, v217
    v_mfma_f32_16x16x32_bf16 v[44:47], v[96:99], a[16:19], v[44:47]
    ds_read_b64_tr_b16 v[112:113], v3 offset:20480
    v_mul_f32 v218, s34, v218
    v_mfma_f32_16x16x32_bf16 v[48:51], v[96:99], a[80:83], v[48:51]
    v_mul_f32 v219, s34, v219
    v_cvt_pk_bf16_f32 v154, v216, v217
    v_mfma_f32_16x16x32_bf16 v[52:55], v[96:99], a[144:147], v[52:55]
    ds_read_b64_tr_b16 v[114:115], v3 offset:20992
    v_cvt_pk_bf16_f32 v155, v218, v219
    v_mfma_f32_16x16x32_bf16 v[56:59], v[96:99], a[208:211], v[56:59]
    s_waitcnt lgkmcnt(4)
    v_mfma_f32_16x16x32_bf16 v[60:63], v[100:103], a[16:19], v[60:63]
    ds_read_b64_tr_b16 v[116:117], v4 offset:20480
    v_mfma_f32_16x16x32_bf16 v[64:67], v[100:103], a[80:83], v[64:67]
    buffer_load_dwordx4 v8, s[12:15], s25 offen offset:2048 lds
    v_mfma_f32_16x16x32_bf16 v[68:71], v[100:103], a[144:147], v[68:71]
    ds_read_b64_tr_b16 v[118:119], v4 offset:20992
    v_mfma_f32_16x16x32_bf16 v[72:75], v[100:103], a[208:211], v[72:75]
    v_mfma_f32_16x16x32_bf16 v[76:79], v[104:107], a[16:19], v[76:79]
    ds_read_b64_tr_b16 v[120:121], v5 offset:20480
    v_mfma_f32_16x16x32_bf16 v[80:83], v[104:107], a[80:83], v[80:83]
    v_mfma_f32_16x16x32_bf16 v[84:87], v[104:107], a[144:147], v[84:87]
    ds_read_b64_tr_b16 v[122:123], v5 offset:20992
    v_mfma_f32_16x16x32_bf16 v[88:91], v[104:107], a[208:211], v[88:91]
    s_waitcnt lgkmcnt(4)
    buffer_load_dwordx4 v9, s[12:15], s25 offen offset:3072 lds
    v_mfma_f32_16x16x32_bf16 v[28:31], v[108:111], a[20:23], v[28:31]
    ds_read_b64_tr_b16 v[92:93], v2 offset:24576
    v_mfma_f32_16x16x32_bf16 v[32:35], v[108:111], a[84:87], v[32:35]
    v_mfma_f32_16x16x32_bf16 v[36:39], v[108:111], a[148:151], v[36:39]
    s_add_u32 m0, s48, 49152
    ds_read_b64_tr_b16 v[94:95], v2 offset:25088
    v_mfma_f32_16x16x32_bf16 v[40:43], v[108:111], a[212:215], v[40:43]
    s_add_u32 s25, s22, s51
    v_mfma_f32_16x16x32_bf16 v[44:47], v[112:115], a[20:23], v[44:47]
    ds_read_b64_tr_b16 v[96:97], v3 offset:24576
    v_mfma_f32_16x16x32_bf16 v[48:51], v[112:115], a[84:87], v[48:51]
    buffer_load_dwordx4 v6, s[12:15], s25 offen offset:0 lds
    v_mfma_f32_16x16x32_bf16 v[52:55], v[112:115], a[148:151], v[52:55]
    ds_read_b64_tr_b16 v[98:99], v3 offset:25088
    v_mfma_f32_16x16x32_bf16 v[56:59], v[112:115], a[212:215], v[56:59]
    s_waitcnt lgkmcnt(4)
    v_mfma_f32_16x16x32_bf16 v[60:63], v[116:119], a[20:23], v[60:63]
    ds_read_b64_tr_b16 v[100:101], v4 offset:24576
    v_mfma_f32_16x16x32_bf16 v[64:67], v[116:119], a[84:87], v[64:67]
    v_mfma_f32_16x16x32_bf16 v[68:71], v[116:119], a[148:151], v[68:71]
    ds_read_b64_tr_b16 v[102:103], v4 offset:25088
    v_mfma_f32_16x16x32_bf16 v[72:75], v[116:119], a[212:215], v[72:75]
    buffer_load_dwordx4 v7, s[12:15], s25 offen offset:1024 lds
    v_mfma_f32_16x16x32_bf16 v[76:79], v[120:123], a[20:23], v[76:79]
    ds_read_b64_tr_b16 v[104:105], v5 offset:24576
    v_mfma_f32_16x16x32_bf16 v[80:83], v[120:123], a[84:87], v[80:83]
    v_mfma_f32_16x16x32_bf16 v[84:87], v[120:123], a[148:151], v[84:87]
    ds_read_b64_tr_b16 v[106:107], v5 offset:25088
    v_mfma_f32_16x16x32_bf16 v[88:91], v[120:123], a[212:215], v[88:91]
    s_waitcnt lgkmcnt(4)
    v_mfma_f32_16x16x32_bf16 v[28:31], v[92:95], a[24:27], v[28:31]
    ds_read_b64_tr_b16 v[108:109], v2 offset:28672
    v_mfma_f32_16x16x32_bf16 v[32:35], v[92:95], a[88:91], v[32:35]
    buffer_load_dwordx4 v8, s[12:15], s25 offen offset:2048 lds
    v_mfma_f32_16x16x32_bf16 v[36:39], v[92:95], a[152:155], v[36:39]
    ds_read_b64_tr_b16 v[110:111], v2 offset:29184
    v_mfma_f32_16x16x32_bf16 v[40:43], v[92:95], a[216:219], v[40:43]
    v_mfma_f32_16x16x32_bf16 v[44:47], v[96:99], a[24:27], v[44:47]
    ds_read_b64_tr_b16 v[112:113], v3 offset:28672
    v_mfma_f32_16x16x32_bf16 v[48:51], v[96:99], a[88:91], v[48:51]
    v_mfma_f32_16x16x32_bf16 v[52:55], v[96:99], a[152:155], v[52:55]
    ds_read_b64_tr_b16 v[114:115], v3 offset:29184
    v_mfma_f32_16x16x32_bf16 v[56:59], v[96:99], a[216:219], v[56:59]
    s_waitcnt lgkmcnt(4)
    buffer_load_dwordx4 v9, s[12:15], s25 offen offset:3072 lds
    v_mfma_f32_16x16x32_bf16 v[60:63], v[100:103], a[24:27], v[60:63]
    ds_read_b64_tr_b16 v[116:117], v4 offset:28672
    v_mfma_f32_16x16x32_bf16 v[64:67], v[100:103], a[88:91], v[64:67]
    v_mfma_f32_16x16x32_bf16 v[68:71], v[100:103], a[152:155], v[68:71]
    ds_read_b64_tr_b16 v[118:119], v4 offset:29184
    v_mfma_f32_16x16x32_bf16 v[72:75], v[100:103], a[216:219], v[72:75]
    v_mfma_f32_16x16x32_bf16 v[76:79], v[104:107], a[24:27], v[76:79]
    ds_read_b64_tr_b16 v[120:121], v5 offset:28672
    v_mfma_f32_16x16x32_bf16 v[80:83], v[104:107], a[88:91], v[80:83]
    buffer_store_dwordx4 v[124:127], v18, s[16:19], s23 offen offset:0 sc1
    v_mfma_f32_16x16x32_bf16 v[84:87], v[104:107], a[152:155], v[84:87]
    ds_read_b64_tr_b16 v[122:123], v5 offset:29184
    v_mfma_f32_16x16x32_bf16 v[88:91], v[104:107], a[216:219], v[88:91]
    s_waitcnt lgkmcnt(4)
    v_mfma_f32_16x16x32_bf16 v[28:31], v[108:111], a[28:31], v[28:31]
    ds_read_b64_tr_b16 v[92:93], v2 offset:32768
    v_mfma_f32_16x16x32_bf16 v[32:35], v[108:111], a[92:95], v[32:35]
    v_mfma_f32_16x16x32_bf16 v[36:39], v[108:111], a[156:159], v[36:39]
    ds_read_b64_tr_b16 v[94:95], v2 offset:33280
    v_mfma_f32_16x16x32_bf16 v[40:43], v[108:111], a[220:223], v[40:43]
    v_mfma_f32_16x16x32_bf16 v[44:47], v[112:115], a[28:31], v[44:47]
    ds_read_b64_tr_b16 v[96:97], v3 offset:32768
    v_mfma_f32_16x16x32_bf16 v[48:51], v[112:115], a[92:95], v[48:51]
    v_mfma_f32_16x16x32_bf16 v[52:55], v[112:115], a[156:159], v[52:55]
    ds_read_b64_tr_b16 v[98:99], v3 offset:33280
    v_mfma_f32_16x16x32_bf16 v[56:59], v[112:115], a[220:223], v[56:59]
    s_waitcnt lgkmcnt(4)
    v_mfma_f32_16x16x32_bf16 v[60:63], v[116:119], a[28:31], v[60:63]
    ds_read_b64_tr_b16 v[100:101], v4 offset:32768
    v_mfma_f32_16x16x32_bf16 v[64:67], v[116:119], a[92:95], v[64:67]
    v_mfma_f32_16x16x32_bf16 v[68:71], v[116:119], a[156:159], v[68:71]
    ds_read_b64_tr_b16 v[102:103], v4 offset:33280
    v_mfma_f32_16x16x32_bf16 v[72:75], v[116:119], a[220:223], v[72:75]
    v_mfma_f32_16x16x32_bf16 v[76:79], v[120:123], a[28:31], v[76:79]
    ds_read_b64_tr_b16 v[104:105], v5 offset:32768
    v_mfma_f32_16x16x32_bf16 v[80:83], v[120:123], a[92:95], v[80:83]
    buffer_store_dwordx4 v[128:131], v18, s[16:19], s23 offen offset:1024 sc1
    v_mfma_f32_16x16x32_bf16 v[84:87], v[120:123], a[156:159], v[84:87]
    ds_read_b64_tr_b16 v[106:107], v5 offset:33280
    v_mfma_f32_16x16x32_bf16 v[88:91], v[120:123], a[220:223], v[88:91]
    s_waitcnt lgkmcnt(4)
    v_mfma_f32_16x16x32_bf16 v[28:31], v[92:95], a[32:35], v[28:31]
    ds_read_b64_tr_b16 v[108:109], v2 offset:36864
    v_mfma_f32_16x16x32_bf16 v[32:35], v[92:95], a[96:99], v[32:35]
    v_mfma_f32_16x16x32_bf16 v[36:39], v[92:95], a[160:163], v[36:39]
    ds_read_b64_tr_b16 v[110:111], v2 offset:37376
    v_mfma_f32_16x16x32_bf16 v[40:43], v[92:95], a[224:227], v[40:43]
    v_mfma_f32_16x16x32_bf16 v[44:47], v[96:99], a[32:35], v[44:47]
    ds_read_b64_tr_b16 v[112:113], v3 offset:36864
    v_mfma_f32_16x16x32_bf16 v[48:51], v[96:99], a[96:99], v[48:51]
    v_mfma_f32_16x16x32_bf16 v[52:55], v[96:99], a[160:163], v[52:55]
    ds_read_b64_tr_b16 v[114:115], v3 offset:37376
    v_mfma_f32_16x16x32_bf16 v[56:59], v[96:99], a[224:227], v[56:59]
    s_waitcnt lgkmcnt(4)
    v_mfma_f32_16x16x32_bf16 v[60:63], v[100:103], a[32:35], v[60:63]
    ds_read_b64_tr_b16 v[116:117], v4 offset:36864
    v_mfma_f32_16x16x32_bf16 v[64:67], v[100:103], a[96:99], v[64:67]
    v_mfma_f32_16x16x32_bf16 v[68:71], v[100:103], a[160:163], v[68:71]
    ds_read_b64_tr_b16 v[118:119], v4 offset:37376
    v_mfma_f32_16x16x32_bf16 v[72:75], v[100:103], a[224:227], v[72:75]
    v_mfma_f32_16x16x32_bf16 v[76:79], v[104:107], a[32:35], v[76:79]
    ds_read_b64_tr_b16 v[120:121], v5 offset:36864
    v_mfma_f32_16x16x32_bf16 v[80:83], v[104:107], a[96:99], v[80:83]
    buffer_store_dwordx4 v[132:135], v19, s[16:19], s23 offen offset:0 sc1
    v_mfma_f32_16x16x32_bf16 v[84:87], v[104:107], a[160:163], v[84:87]
    ds_read_b64_tr_b16 v[122:123], v5 offset:37376
    v_mfma_f32_16x16x32_bf16 v[88:91], v[104:107], a[224:227], v[88:91]
    s_waitcnt lgkmcnt(4)
    v_mfma_f32_16x16x32_bf16 v[28:31], v[108:111], a[36:39], v[28:31]
    ds_read_b64_tr_b16 v[92:93], v2 offset:40960
    v_mfma_f32_16x16x32_bf16 v[32:35], v[108:111], a[100:103], v[32:35]
    v_mfma_f32_16x16x32_bf16 v[36:39], v[108:111], a[164:167], v[36:39]
    ds_read_b64_tr_b16 v[94:95], v2 offset:41472
    v_mfma_f32_16x16x32_bf16 v[40:43], v[108:111], a[228:231], v[40:43]
    v_mfma_f32_16x16x32_bf16 v[44:47], v[112:115], a[36:39], v[44:47]
    ds_read_b64_tr_b16 v[96:97], v3 offset:40960
    v_mfma_f32_16x16x32_bf16 v[48:51], v[112:115], a[100:103], v[48:51]
    buffer_load_dword v226, v227, s[40:43], s4 offen
    v_mfma_f32_16x16x32_bf16 v[52:55], v[112:115], a[164:167], v[52:55]
    s_add_u32 s4, s4, 1792
    ds_read_b64_tr_b16 v[98:99], v3 offset:41472
    v_mfma_f32_16x16x32_bf16 v[56:59], v[112:115], a[228:231], v[56:59]
    s_waitcnt lgkmcnt(4)
    v_mfma_f32_16x16x32_bf16 v[60:63], v[116:119], a[36:39], v[60:63]
    ds_read_b64_tr_b16 v[100:101], v4 offset:40960
    v_mfma_f32_16x16x32_bf16 v[64:67], v[116:119], a[100:103], v[64:67]
    v_mfma_f32_16x16x32_bf16 v[68:71], v[116:119], a[164:167], v[68:71]
    ds_read_b64_tr_b16 v[102:103], v4 offset:41472
    v_mfma_f32_16x16x32_bf16 v[72:75], v[116:119], a[228:231], v[72:75]
    v_mfma_f32_16x16x32_bf16 v[76:79], v[120:123], a[36:39], v[76:79]
    ds_read_b64_tr_b16 v[104:105], v5 offset:40960
    v_mfma_f32_16x16x32_bf16 v[80:83], v[120:123], a[100:103], v[80:83]
    buffer_store_dwordx4 v[136:139], v19, s[16:19], s23 offen offset:1024 sc1
    v_mfma_f32_16x16x32_bf16 v[84:87], v[120:123], a[164:167], v[84:87]
    ds_read_b64_tr_b16 v[106:107], v5 offset:41472
    v_mfma_f32_16x16x32_bf16 v[88:91], v[120:123], a[228:231], v[88:91]
    s_waitcnt lgkmcnt(4)
    v_mfma_f32_16x16x32_bf16 v[28:31], v[92:95], a[40:43], v[28:31]
    ds_read_b64_tr_b16 v[108:109], v2 offset:45056
    v_mfma_f32_16x16x32_bf16 v[32:35], v[92:95], a[104:107], v[32:35]
    v_mfma_f32_16x16x32_bf16 v[36:39], v[92:95], a[168:171], v[36:39]
    ds_read_b64_tr_b16 v[110:111], v2 offset:45568
    v_mfma_f32_16x16x32_bf16 v[40:43], v[92:95], a[232:235], v[40:43]
    v_mfma_f32_16x16x32_bf16 v[44:47], v[96:99], a[40:43], v[44:47]
    ds_read_b64_tr_b16 v[112:113], v3 offset:45056
    v_mfma_f32_16x16x32_bf16 v[48:51], v[96:99], a[104:107], v[48:51]
    v_mfma_f32_16x16x32_bf16 v[52:55], v[96:99], a[168:171], v[52:55]
    ds_read_b64_tr_b16 v[114:115], v3 offset:45568
    v_mfma_f32_16x16x32_bf16 v[56:59], v[96:99], a[232:235], v[56:59]
    s_waitcnt lgkmcnt(4)
    v_mfma_f32_16x16x32_bf16 v[60:63], v[100:103], a[40:43], v[60:63]
    ds_read_b64_tr_b16 v[116:117], v4 offset:45056
    v_mfma_f32_16x16x32_bf16 v[64:67], v[100:103], a[104:107], v[64:67]
    v_mfma_f32_16x16x32_bf16 v[68:71], v[100:103], a[168:171], v[68:71]
    ds_read_b64_tr_b16 v[118:119], v4 offset:45568
    v_mfma_f32_16x16x32_bf16 v[72:75], v[100:103], a[232:235], v[72:75]
    v_mfma_f32_16x16x32_bf16 v[76:79], v[104:107], a[40:43], v[76:79]
    ds_read_b64_tr_b16 v[120:121], v5 offset:45056
    v_mfma_f32_16x16x32_bf16 v[80:83], v[104:107], a[104:107], v[80:83]
    buffer_store_dwordx4 v[140:143], v20, s[16:19], s23 offen offset:0 sc1
    v_mfma_f32_16x16x32_bf16 v[84:87], v[104:107], a[168:171], v[84:87]
    ds_read_b64_tr_b16 v[122:123], v5 offset:45568
    v_mfma_f32_16x16x32_bf16 v[88:91], v[104:107], a[232:235], v[88:91]
    s_waitcnt lgkmcnt(4)
    v_mfma_f32_16x16x32_bf16 v[28:31], v[108:111], a[44:47], v[28:31]
    ds_read_b64_tr_b16 v[92:93], v2 offset:49152
    v_mfma_f32_16x16x32_bf16 v[32:35], v[108:111], a[108:111], v[32:35]
    v_mfma_f32_16x16x32_bf16 v[36:39], v[108:111], a[172:175], v[36:39]
    ds_read_b64_tr_b16 v[94:95], v2 offset:49664
    v_mfma_f32_16x16x32_bf16 v[40:43], v[108:111], a[236:239], v[40:43]
    v_mfma_f32_16x16x32_bf16 v[44:47], v[112:115], a[44:47], v[44:47]
    ds_read_b64_tr_b16 v[96:97], v3 offset:49152
    v_mfma_f32_16x16x32_bf16 v[48:51], v[112:115], a[108:111], v[48:51]
    v_mfma_f32_16x16x32_bf16 v[52:55], v[112:115], a[172:175], v[52:55]
    ds_read_b64_tr_b16 v[98:99], v3 offset:49664
    v_mfma_f32_16x16x32_bf16 v[56:59], v[112:115], a[236:239], v[56:59]
    s_waitcnt lgkmcnt(4)
    v_mfma_f32_16x16x32_bf16 v[60:63], v[116:119], a[44:47], v[60:63]
    ds_read_b64_tr_b16 v[100:101], v4 offset:49152
    v_mfma_f32_16x16x32_bf16 v[64:67], v[116:119], a[108:111], v[64:67]
    v_mfma_f32_16x16x32_bf16 v[68:71], v[116:119], a[172:175], v[68:71]
    ds_read_b64_tr_b16 v[102:103], v4 offset:49664
    v_mfma_f32_16x16x32_bf16 v[72:75], v[116:119], a[236:239], v[72:75]
    v_mfma_f32_16x16x32_bf16 v[76:79], v[120:123], a[44:47], v[76:79]
    ds_read_b64_tr_b16 v[104:105], v5 offset:49152
    v_mfma_f32_16x16x32_bf16 v[80:83], v[120:123], a[108:111], v[80:83]
    buffer_store_dwordx4 v[144:147], v20, s[16:19], s23 offen offset:1024 sc1
    v_mfma_f32_16x16x32_bf16 v[84:87], v[120:123], a[172:175], v[84:87]
    ds_read_b64_tr_b16 v[106:107], v5 offset:49664
    v_mfma_f32_16x16x32_bf16 v[88:91], v[120:123], a[236:239], v[88:91]
    s_waitcnt lgkmcnt(4)
    v_mfma_f32_16x16x32_bf16 v[28:31], v[92:95], a[48:51], v[28:31]
    ds_read_b64_tr_b16 v[108:109], v2 offset:53248
    v_mfma_f32_16x16x32_bf16 v[32:35], v[92:95], a[112:115], v[32:35]
    v_mfma_f32_16x16x32_bf16 v[36:39], v[92:95], a[176:179], v[36:39]
    ds_read_b64_tr_b16 v[110:111], v2 offset:53760
    v_mfma_f32_16x16x32_bf16 v[40:43], v[92:95], a[240:243], v[40:43]
    v_mfma_f32_16x16x32_bf16 v[44:47], v[96:99], a[48:51], v[44:47]
    ds_read_b64_tr_b16 v[112:113], v3 offset:53248
    v_mfma_f32_16x16x32_bf16 v[48:51], v[96:99], a[112:115], v[48:51]
    v_mfma_f32_16x16x32_bf16 v[52:55], v[96:99], a[176:179], v[52:55]
    ds_read_b64_tr_b16 v[114:115], v3 offset:53760
    v_mfma_f32_16x16x32_bf16 v[56:59], v[96:99], a[240:243], v[56:59]
    s_waitcnt lgkmcnt(4)
    v_mfma_f32_16x16x32_bf16 v[60:63], v[100:103], a[48:51], v[60:63]
    ds_read_b64_tr_b16 v[116:117], v4 offset:53248
    v_mfma_f32_16x16x32_bf16 v[64:67], v[100:103], a[112:115], v[64:67]
    v_mfma_f32_16x16x32_bf16 v[68:71], v[100:103], a[176:179], v[68:71]
    ds_read_b64_tr_b16 v[118:119], v4 offset:53760
    v_mfma_f32_16x16x32_bf16 v[72:75], v[100:103], a[240:243], v[72:75]
    v_mfma_f32_16x16x32_bf16 v[76:79], v[104:107], a[48:51], v[76:79]
    ds_read_b64_tr_b16 v[120:121], v5 offset:53248
    v_mfma_f32_16x16x32_bf16 v[80:83], v[104:107], a[112:115], v[80:83]
    buffer_store_dwordx4 v[148:151], v21, s[16:19], s23 offen offset:0 sc1
    v_mfma_f32_16x16x32_bf16 v[84:87], v[104:107], a[176:179], v[84:87]
    ds_read_b64_tr_b16 v[122:123], v5 offset:53760
    v_mfma_f32_16x16x32_bf16 v[88:91], v[104:107], a[240:243], v[88:91]
    s_waitcnt lgkmcnt(4)
    v_mfma_f32_16x16x32_bf16 v[28:31], v[108:111], a[52:55], v[28:31]
    ds_read_b64_tr_b16 v[92:93], v2 offset:57344
    v_mfma_f32_16x16x32_bf16 v[32:35], v[108:111], a[116:119], v[32:35]
    v_mfma_f32_16x16x32_bf16 v[36:39], v[108:111], a[180:183], v[36:39]
    ds_read_b64_tr_b16 v[94:95], v2 offset:57856
    v_mfma_f32_16x16x32_bf16 v[40:43], v[108:111], a[244:247], v[40:43]
    v_mfma_f32_16x16x32_bf16 v[44:47], v[112:115], a[52:55], v[44:47]
    ds_read_b64_tr_b16 v[96:97], v3 offset:57344
    v_mfma_f32_16x16x32_bf16 v[48:51], v[112:115], a[116:119], v[48:51]
    v_mfma_f32_16x16x32_bf16 v[52:55], v[112:115], a[180:183], v[52:55]
    ds_read_b64_tr_b16 v[98:99], v3 offset:57856
    v_mfma_f32_16x16x32_bf16 v[56:59], v[112:115], a[244:247], v[56:59]
    s_waitcnt lgkmcnt(4)
    v_mfma_f32_16x16x32_bf16 v[60:63], v[116:119], a[52:55], v[60:63]
    ds_read_b64_tr_b16 v[100:101], v4 offset:57344
    v_mfma_f32_16x16x32_bf16 v[64:67], v[116:119], a[116:119], v[64:67]
    v_mfma_f32_16x16x32_bf16 v[68:71], v[116:119], a[180:183], v[68:71]
    ds_read_b64_tr_b16 v[102:103], v4 offset:57856
    v_mfma_f32_16x16x32_bf16 v[72:75], v[116:119], a[244:247], v[72:75]
    v_mfma_f32_16x16x32_bf16 v[76:79], v[120:123], a[52:55], v[76:79]
    ds_read_b64_tr_b16 v[104:105], v5 offset:57344
    v_mfma_f32_16x16x32_bf16 v[80:83], v[120:123], a[116:119], v[80:83]
    buffer_store_dwordx4 v[152:155], v21, s[16:19], s23 offen offset:1024 sc1
    v_mfma_f32_16x16x32_bf16 v[84:87], v[120:123], a[180:183], v[84:87]
    ds_read_b64_tr_b16 v[106:107], v5 offset:57856
    v_mfma_f32_16x16x32_bf16 v[88:91], v[120:123], a[244:247], v[88:91]
    s_waitcnt lgkmcnt(4)
    v_mfma_f32_16x16x32_bf16 v[28:31], v[92:95], a[56:59], v[28:31]
    ds_read_b64_tr_b16 v[108:109], v2 offset:61440
    v_mfma_f32_16x16x32_bf16 v[32:35], v[92:95], a[120:123], v[32:35]
    v_mfma_f32_16x16x32_bf16 v[36:39], v[92:95], a[184:187], v[36:39]
    ds_read_b64_tr_b16 v[110:111], v2 offset:61952
    v_mfma_f32_16x16x32_bf16 v[40:43], v[92:95], a[248:251], v[40:43]
    v_mfma_f32_16x16x32_bf16 v[44:47], v[96:99], a[56:59], v[44:47]
    ds_read_b64_tr_b16 v[112:113], v3 offset:61440
    v_mfma_f32_16x16x32_bf16 v[48:51], v[96:99], a[120:123], v[48:51]
    v_mfma_f32_16x16x32_bf16 v[52:55], v[96:99], a[184:187], v[52:55]
    ds_read_b64_tr_b16 v[114:115], v3 offset:61952
    v_mfma_f32_16x16x32_bf16 v[56:59], v[96:99], a[248:251], v[56:59]
    s_waitcnt lgkmcnt(4)
    v_mfma_f32_16x16x32_bf16 v[60:63], v[100:103], a[56:59], v[60:63]
    ds_read_b64_tr_b16 v[116:117], v4 offset:61440
    v_mfma_f32_16x16x32_bf16 v[64:67], v[100:103], a[120:123], v[64:67]
    v_mfma_f32_16x16x32_bf16 v[68:71], v[100:103], a[184:187], v[68:71]
    ds_read_b64_tr_b16 v[118:119], v4 offset:61952
    v_mfma_f32_16x16x32_bf16 v[72:75], v[100:103], a[248:251], v[72:75]
    v_mfma_f32_16x16x32_bf16 v[76:79], v[104:107], a[56:59], v[76:79]
    ds_read_b64_tr_b16 v[120:121], v5 offset:61440
    v_mfma_f32_16x16x32_bf16 v[80:83], v[104:107], a[120:123], v[80:83]
    v_mfma_f32_16x16x32_bf16 v[84:87], v[104:107], a[184:187], v[84:87]
    s_waitcnt vmcnt(9)
    ds_read_b64_tr_b16 v[122:123], v5 offset:61952
    v_mfma_f32_16x16x32_bf16 v[88:91], v[104:107], a[248:251], v[88:91]
    s_waitcnt lgkmcnt(4)
    v_xor_b32 v2, 0x10000, v2
    v_xor_b32 v3, 0x10000, v3
    v_mfma_f32_16x16x32_bf16 v[28:31], v[108:111], a[60:63], v[28:31]
    s_barrier
    ds_read_b64_tr_b16 v[92:93], v2 offset:0
    v_mfma_f32_16x16x32_bf16 v[32:35], v[108:111], a[124:127], v[32:35]
    v_xor_b32 v4, 0x10000, v4
    v_xor_b32 v5, 0x10000, v5
    v_mfma_f32_16x16x32_bf16 v[36:39], v[108:111], a[188:191], v[36:39]
    s_xor_b32 s48, s48, 0x10000
    ds_read_b64_tr_b16 v[94:95], v2 offset:512
    v_mfma_f32_16x16x32_bf16 v[40:43], v[108:111], a[252:255], v[40:43]
    v_mfma_f32_16x16x32_bf16 v[44:47], v[112:115], a[60:63], v[44:47]
    s_add_u32 s22, s22, s59
    ds_read_b64_tr_b16 v[96:97], v3 offset:0
    v_mfma_f32_16x16x32_bf16 v[48:51], v[112:115], a[124:127], v[48:51]
    v_mfma_f32_16x16x32_bf16 v[52:55], v[112:115], a[188:191], v[52:55]
    ds_read_b64_tr_b16 v[98:99], v3 offset:512
    v_mfma_f32_16x16x32_bf16 v[56:59], v[112:115], a[252:255], v[56:59]
    s_waitcnt lgkmcnt(4)
    v_mfma_f32_16x16x32_bf16 v[60:63], v[116:119], a[60:63], v[60:63]
    ds_read_b64_tr_b16 v[100:101], v4 offset:0
    v_mfma_f32_16x16x32_bf16 v[64:67], v[116:119], a[124:127], v[64:67]
    v_mfma_f32_16x16x32_bf16 v[68:71], v[116:119], a[188:191], v[68:71]
    ds_read_b64_tr_b16 v[102:103], v4 offset:512
    v_mfma_f32_16x16x32_bf16 v[72:75], v[116:119], a[252:255], v[72:75]
    v_mfma_f32_16x16x32_bf16 v[76:79], v[120:123], a[60:63], v[76:79]
    ds_read_b64_tr_b16 v[104:105], v5 offset:0
    v_mfma_f32_16x16x32_bf16 v[80:83], v[120:123], a[124:127], v[80:83]
    v_mfma_f32_16x16x32_bf16 v[84:87], v[120:123], a[188:191], v[84:87]
    ds_read_b64_tr_b16 v[106:107], v5 offset:512
    v_mfma_f32_16x16x32_bf16 v[88:91], v[120:123], a[252:255], v[88:91]
    s_waitcnt lgkmcnt(4)
    v_mfma_f32_16x16x32_bf16 v[156:159], v[92:95], a[0:3], 0
    s_lshr_b32 s23, s31, 1
    ds_read_b64_tr_b16 v[108:109], v2 offset:4096
    v_mul_f32 v28, s34, v28
    v_mfma_f32_16x16x32_bf16 v[160:163], v[92:95], a[64:67], 0
    s_lshl_b32 s23, s23, 20
    v_mul_f32 v29, s34, v29
    v_mul_f32 v30, s34, v30
    v_mfma_f32_16x16x32_bf16 v[164:167], v[92:95], a[128:131], 0
    s_add_u32 s23, s23, s32
    ds_read_b64_tr_b16 v[110:111], v2 offset:4608
    v_mul_f32 v31, s34, v31
    v_mfma_f32_16x16x32_bf16 v[168:171], v[92:95], a[192:195], 0
    s_and_b32 s33, s31, 1
    v_cvt_pk_bf16_f32 v124, v28, v29
    v_cvt_pk_bf16_f32 v125, v30, v31
    v_mfma_f32_16x16x32_bf16 v[172:175], v[96:99], a[0:3], 0
    s_lshl_b32 s33, s33, 11
    ds_read_b64_tr_b16 v[112:113], v3 offset:4096
    v_mul_f32 v32, s34, v32
    v_mfma_f32_16x16x32_bf16 v[176:179], v[96:99], a[64:67], 0
    s_add_u32 s23, s23, s33
    v_mul_f32 v33, s34, v33
    v_mul_f32 v34, s34, v34
    v_mfma_f32_16x16x32_bf16 v[180:183], v[96:99], a[128:131], 0
    s_add_u32 s31, s31, 1
    ds_read_b64_tr_b16 v[114:115], v3 offset:4608
    v_mul_f32 v35, s34, v35
    v_mfma_f32_16x16x32_bf16 v[184:187], v[96:99], a[192:195], 0
    s_waitcnt lgkmcnt(4)
    v_cvt_pk_bf16_f32 v132, v32, v33
    v_cvt_pk_bf16_f32 v133, v34, v35
    v_mfma_f32_16x16x32_bf16 v[188:191], v[100:103], a[0:3], 0
    s_barrier
    ds_read_b64_tr_b16 v[116:117], v4 offset:4096
    v_mul_f32 v36, s34, v36
    v_mfma_f32_16x16x32_bf16 v[192:195], v[100:103], a[64:67], 0
    v_mul_f32 v37, s34, v37
    v_mul_f32 v38, s34, v38
    v_mfma_f32_16x16x32_bf16 v[196:199], v[100:103], a[128:131], 0
    s_add_u32 m0, s48, 0
    ds_read_b64_tr_b16 v[118:119], v4 offset:4608
    v_mul_f32 v39, s34, v39
    v_mfma_f32_16x16x32_bf16 v[200:203], v[100:103], a[192:195], 0
    s_add_u32 s25, s22, s44
    v_cvt_pk_bf16_f32 v140, v36, v37
    v_cvt_pk_bf16_f32 v141, v38, v39
    v_mfma_f32_16x16x32_bf16 v[204:207], v[104:107], a[0:3], 0
    ds_read_b64_tr_b16 v[120:121], v5 offset:4096
    v_mul_f32 v40, s34, v40
    v_mfma_f32_16x16x32_bf16 v[208:211], v[104:107], a[64:67], 0
    buffer_load_dwordx4 v6, s[12:15], s25 offen offset:0 lds
    v_mul_f32 v41, s34, v41
    v_mfma_f32_16x16x32_bf16 v[212:215], v[104:107], a[128:131], 0
    ds_read_b64_tr_b16 v[122:123], v5 offset:4608
    v_mul_f32 v42, s34, v42
    v_mfma_f32_16x16x32_bf16 v[216:219], v[104:107], a[192:195], 0
    s_waitcnt lgkmcnt(4)
    v_mul_f32 v43, s34, v43
    v_cvt_pk_bf16_f32 v148, v40, v41
    v_mfma_f32_16x16x32_bf16 v[156:159], v[108:111], a[4:7], v[156:159]
    ds_read_b64_tr_b16 v[92:93], v2 offset:8192
    v_cvt_pk_bf16_f32 v149, v42, v43
    v_mfma_f32_16x16x32_bf16 v[160:163], v[108:111], a[68:71], v[160:163]
    v_mul_f32 v44, s34, v44
    v_mul_f32 v45, s34, v45
    v_mfma_f32_16x16x32_bf16 v[164:167], v[108:111], a[132:135], v[164:167]
    ds_read_b64_tr_b16 v[94:95], v2 offset:8704
    v_mul_f32 v46, s34, v46
    v_mfma_f32_16x16x32_bf16 v[168:171], v[108:111], a[196:199], v[168:171]
    buffer_load_dwordx4 v7, s[12:15], s25 offen offset:1024 lds
    v_mul_f32 v47, s34, v47
    v_mfma_f32_16x16x32_bf16 v[172:175], v[112:115], a[4:7], v[172:175]
    ds_read_b64_tr_b16 v[96:97], v3 offset:8192
    v_cvt_pk_bf16_f32 v126, v44, v45
    v_mfma_f32_16x16x32_bf16 v[176:179], v[112:115], a[68:71], v[176:179]
    v_cvt_pk_bf16_f32 v127, v46, v47
    v_mul_f32 v48, s34, v48
    v_mfma_f32_16x16x32_bf16 v[180:183], v[112:115], a[132:135], v[180:183]
    ds_read_b64_tr_b16 v[98:99], v3 offset:8704
    v_mul_f32 v49, s34, v49
    v_mfma_f32_16x16x32_bf16 v[184:187], v[112:115], a[196:199], v[184:187]
    s_waitcnt lgkmcnt(4)
    v_mul_f32 v50, s34, v50
    v_mul_f32 v51, s34, v51
    v_mfma_f32_16x16x32_bf16 v[188:191], v[116:119], a[4:7], v[188:191]
    ds_read_b64_tr_b16 v[100:101], v4 offset:8192
    v_cvt_pk_bf16_f32 v134, v48, v49
    v_mfma_f32_16x16x32_bf16 v[192:195], v[116:119], a[68:71], v[192:195]
    buffer_load_dwordx4 v8, s[12:15], s25 offen offset:2048 lds
    v_cvt_pk_bf16_f32 v135, v50, v51
    v_mfma_f32_16x16x32_bf16 v[196:199], v[116:119], a[132:135], v[196:199]
    ds_read_b64_tr_b16 v[102:103], v4 offset:8704
    v_mul_f32 v52, s34, v52
    v_mfma_f32_16x16x32_bf16 v[200:203], v[116:119], a[196:199], v[200:203]
    v_mul_f32 v53, s34, v53
    v_mul_f32 v54, s34, v54
    v_mfma_f32_16x16x32_bf16 v[204:207], v[120:123], a[4:7], v[204:207]
    ds_read_b64_tr_b16 v[104:105], v5 offset:8192
    v_mul_f32 v55, s34, v55
    v_mfma_f32_16x16x32_bf16 v[208:211], v[120:123], a[68:71], v[208:211]
    v_cvt_pk_bf16_f32 v142, v52, v53
    v_cvt_pk_bf16_f32 v143, v54, v55
    v_mfma_f32_16x16x32_bf16 v[212:215], v[120:123], a[132:135], v[212:215]
    ds_read_b64_tr_b16 v[106:107], v5 offset:8704
    v_mul_f32 v56, s34, v56
    v_mfma_f32_16x16x32_bf16 v[216:219], v[120:123], a[196:199], v[216:219]
    s_waitcnt lgkmcnt(4)
    buffer_load_dwordx4 v9, s[12:15], s25 offen offset:3072 lds
    v_mul_f32 v57, s34, v57
    v_mfma_f32_16x16x32_bf16 v[156:159], v[92:95], a[8:11], v[156:159]
    ds_read_b64_tr_b16 v[108:109], v2 offset:12288
    v_mul_f32 v58, s34, v58
    v_mfma_f32_16x16x32_bf16 v[160:163], v[92:95], a[72:75], v[160:163]
    v_mul_f32 v59, s34, v59
    v_cvt_pk_bf16_f32 v150, v56, v57
    v_mfma_f32_16x16x32_bf16 v[164:167], v[92:95], a[136:139], v[164:167]
    s_add_u32 m0, s48, 16384
    ds_read_b64_tr_b16 v[110:111], v2 offset:12800
    v_cvt_pk_bf16_f32 v151, v58, v59
    v_mfma_f32_16x16x32_bf16 v[168:171], v[92:95], a[200:203], v[168:171]
    s_add_u32 s25, s22, s45
    v_mul_f32 v60, s34, v60
    v_mul_f32 v61, s34, v61
    v_mfma_f32_16x16x32_bf16 v[172:175], v[96:99], a[8:11], v[172:175]
    ds_read_b64_tr_b16 v[112:113], v3 offset:12288
    v_mul_f32 v62, s34, v62
    v_mfma_f32_16x16x32_bf16 v[176:179], v[96:99], a[72:75], v[176:179]
    buffer_load_dwordx4 v6, s[12:15], s25 offen offset:0 lds
    v_mul_f32 v63, s34, v63
    v_mfma_f32_16x16x32_bf16 v[180:183], v[96:99], a[136:139], v[180:183]
    ds_read_b64_tr_b16 v[114:115], v3 offset:12800
    v_cvt_pk_bf16_f32 v128, v60, v61
    v_mfma_f32_16x16x32_bf16 v[184:187], v[96:99], a[200:203], v[184:187]
    s_waitcnt lgkmcnt(4)
    v_cvt_pk_bf16_f32 v129, v62, v63
    v_mul_f32 v64, s34, v64
    v_mfma_f32_16x16x32_bf16 v[188:191], v[100:103], a[8:11], v[188:191]
    ds_read_b64_tr_b16 v[116:117], v4 offset:12288
    v_mul_f32 v65, s34, v65
    v_mfma_f32_16x16x32_bf16 v[192:195], v[100:103], a[72:75], v[192:195]
    v_mul_f32 v66, s34, v66
    v_mul_f32 v67, s34, v67
    v_mfma_f32_16x16x32_bf16 v[196:199], v[100:103], a[136:139], v[196:199]
    ds_read_b64_tr_b16 v[118:119], v4 offset:12800
    v_cvt_pk_bf16_f32 v136, v64, v65
    v_mfma_f32_16x16x32_bf16 v[200:203], v[100:103], a[200:203], v[200:203]
    buffer_load_dwordx4 v7, s[12:15], s25 offen offset:1024 lds
    v_cvt_pk_bf16_f32 v137, v66, v67
    v_mfma_f32_16x16x32_bf16 v[204:207], v[104:107], a[8:11], v[204:207]
    ds_read_b64_tr_b16 v[120:121], v5 offset:12288
    v_mul_f32 v68, s34, v68
    v_mfma_f32_16x16x32_bf16 v[208:211], v[104:107], a[72:75], v[208:211]
    v_mul_f32 v69, s34, v69
    v_mul_f32 v70, s34, v70
    v_mfma_f32_16x16x32_bf16 v[212:215], v[104:107], a[136:139], v[212:215]
    ds_read_b64_tr_b16 v[122:123], v5 offset:12800
    v_mul_f32 v71, s34, v71
    v_mfma_f32_16x16x32_bf16 v[216:219], v[104:107], a[200:203], v[216:219]
    s_waitcnt lgkmcnt(4)
    v_cvt_pk_bf16_f32 v144, v68, v69
    v_cvt_pk_bf16_f32 v145, v70, v71
    v_mfma_f32_16x16x32_bf16 v[156:159], v[108:111], a[12:15], v[156:159]
    ds_read_b64_tr_b16 v[92:93], v2 offset:16384
    v_mul_f32 v72, s34, v72
    v_mfma_f32_16x16x32_bf16 v[160:163], v[108:111], a[76:79], v[160:163]
    buffer_load_dwordx4 v8, s[12:15], s25 offen offset:2048 lds
    v_mul_f32 v73, s34, v73
    v_mfma_f32_16x16x32_bf16 v[164:167], v[108:111], a[140:143], v[164:167]
    ds_read_b64_tr_b16 v[94:95], v2 offset:16896
    v_mul_f32 v74, s34, v74
    v_mfma_f32_16x16x32_bf16 v[168:171], v[108:111], a[204:207], v[168:171]
    v_mul_f32 v75, s34, v75
    v_cvt_pk_bf16_f32 v152, v72, v73
    v_mfma_f32_16x16x32_bf16 v[172:175], v[112:115], a[12:15], v[172:175]
    ds_read_b64_tr_b16 v[96:97], v3 offset:16384
    v_cvt_pk_bf16_f32 v153, v74, v75
    v_mfma_f32_16x16x32_bf16 v[176:179], v[112:115], a[76:79], v[176:179]
    v_mul_f32 v76, s34, v76
    v_mul_f32 v77, s34, v77
    v_mfma_f32_16x16x32_bf16 v[180:183], v[112:115], a[140:143], v[180:183]
    ds_read_b64_tr_b16 v[98:99], v3 offset:16896
    v_mul_f32 v78, s34, v78
    v_mfma_f32_16x16x32_bf16 v[184:187], v[112:115], a[204:207], v[184:187]
    s_waitcnt lgkmcnt(4)
    buffer_load_dwordx4 v9, s[12:15], s25 offen offset:3072 lds
    v_mul_f32 v79, s34, v79
    v_mfma_f32_16x16x32_bf16 v[188:191], v[116:119], a[12:15], v[188:191]
    ds_read_b64_tr_b16 v[100:101], v4 offset:16384
    v_cvt_pk_bf16_f32 v130, v76, v77
    v_mfma_f32_16x16x32_bf16 v[192:195], v[116:119], a[76:79], v[192:195]
    v_cvt_pk_bf16_f32 v131, v78, v79
    v_mul_f32 v80, s34, v80
    v_mfma_f32_16x16x32_bf16 v[196:199], v[116:119], a[140:143], v[196:199]
    s_add_u32 m0, s48, 32768
    ds_read_b64_tr_b16 v[102:103], v4 offset:16896
    v_mul_f32 v81, s34, v81
    v_mfma_f32_16x16x32_bf16 v[200:203], v[116:119], a[204:207], v[200:203]
    s_add_u32 s25, s22, s50
    v_mul_f32 v82, s34, v82
    v_mul_f32 v83, s34, v83
    v_mfma_f32_16x16x32_bf16 v[204:207], v[120:123], a[12:15], v[204:207]
    ds_read_b64_tr_b16 v[104:105], v5 offset:16384
    v_cvt_pk_bf16_f32 v138, v80, v81
    v_mfma_f32_16x16x32_bf16 v[208:211], v[120:123], a[76:79], v[208:211]
    buffer_load_dwordx4 v6, s[12:15], s25 offen offset:0 lds
    v_cvt_pk_bf16_f32 v139, v82, v83
    v_mfma_f32_16x16x32_bf16 v[212:215], v[120:123], a[140:143], v[212:215]
    ds_read_b64_tr_b16 v[106:107], v5 offset:16896
    v_mul_f32 v84, s34, v84
    v_mfma_f32_16x16x32_bf16 v[216:219], v[120:123], a[204:207], v[216:219]
    s_waitcnt lgkmcnt(4)
    v_mul_f32 v85, s34, v85
    v_mul_f32 v86, s34, v86
    v_mfma_f32_16x16x32_bf16 v[156:159], v[92:95], a[16:19], v[156:159]
    ds_read_b64_tr_b16 v[108:109], v2 offset:20480
    v_mul_f32 v87, s34, v87
    v_mfma_f32_16x16x32_bf16 v[160:163], v[92:95], a[80:83], v[160:163]
    v_cvt_pk_bf16_f32 v146, v84, v85
    v_cvt_pk_bf16_f32 v147, v86, v87
    v_mfma_f32_16x16x32_bf16 v[164:167], v[92:95], a[144:147], v[164:167]
    ds_read_b64_tr_b16 v[110:111], v2 offset:20992
    v_mul_f32 v88, s34, v88
    v_mfma_f32_16x16x32_bf16 v[168:171], v[92:95], a[208:211], v[168:171]
    buffer_load_dwordx4 v7, s[12:15], s25 offen offset:1024 lds
    v_mul_f32 v89, s34, v89
    v_mfma_f32_16x16x32_bf16 v[172:175], v[96:99], a[16:19], v[172:175]
    ds_read_b64_tr_b16 v[112:113], v3 offset:20480
    v_mul_f32 v90, s34, v90
    v_mfma_f32_16x16x32_bf16 v[176:179], v[96:99], a[80:83], v[176:179]
    v_mul_f32 v91, s34, v91
    v_cvt_pk_bf16_f32 v154, v88, v89
    v_mfma_f32_16x16x32_bf16 v[180:183], v[96:99], a[144:147], v[180:183]
    ds_read_b64_tr_b16 v[114:115], v3 offset:20992
    v_cvt_pk_bf16_f32 v155, v90, v91
    v_mfma_f32_16x16x32_bf16 v[184:187], v[96:99], a[208:211], v[184:187]
    s_waitcnt lgkmcnt(4)
    v_mfma_f32_16x16x32_bf16 v[188:191], v[100:103], a[16:19], v[188:191]
    ds_read_b64_tr_b16 v[116:117], v4 offset:20480
    v_mfma_f32_16x16x32_bf16 v[192:195], v[100:103], a[80:83], v[192:195]
    buffer_load_dwordx4 v8, s[12:15], s25 offen offset:2048 lds
    v_mfma_f32_16x16x32_bf16 v[196:199], v[100:103], a[144:147], v[196:199]
    ds_read_b64_tr_b16 v[118:119], v4 offset:20992
    v_mfma_f32_16x16x32_bf16 v[200:203], v[100:103], a[208:211], v[200:203]
    v_mfma_f32_16x16x32_bf16 v[204:207], v[104:107], a[16:19], v[204:207]
    ds_read_b64_tr_b16 v[120:121], v5 offset:20480
    v_mfma_f32_16x16x32_bf16 v[208:211], v[104:107], a[80:83], v[208:211]
    v_mfma_f32_16x16x32_bf16 v[212:215], v[104:107], a[144:147], v[212:215]
    ds_read_b64_tr_b16 v[122:123], v5 offset:20992
    v_mfma_f32_16x16x32_bf16 v[216:219], v[104:107], a[208:211], v[216:219]
    s_waitcnt lgkmcnt(4)
    buffer_load_dwordx4 v9, s[12:15], s25 offen offset:3072 lds
    v_mfma_f32_16x16x32_bf16 v[156:159], v[108:111], a[20:23], v[156:159]
    ds_read_b64_tr_b16 v[92:93], v2 offset:24576
    v_mfma_f32_16x16x32_bf16 v[160:163], v[108:111], a[84:87], v[160:163]
    v_mfma_f32_16x16x32_bf16 v[164:167], v[108:111], a[148:151], v[164:167]
    s_add_u32 m0, s48, 49152
    ds_read_b64_tr_b16 v[94:95], v2 offset:25088
    v_mfma_f32_16x16x32_bf16 v[168:171], v[108:111], a[212:215], v[168:171]
    s_add_u32 s25, s22, s51
    v_mfma_f32_16x16x32_bf16 v[172:175], v[112:115], a[20:23], v[172:175]
    ds_read_b64_tr_b16 v[96:97], v3 offset:24576
    v_mfma_f32_16x16x32_bf16 v[176:179], v[112:115], a[84:87], v[176:179]
    buffer_load_dwordx4 v6, s[12:15], s25 offen offset:0 lds
    v_mfma_f32_16x16x32_bf16 v[180:183], v[112:115], a[148:151], v[180:183]
    ds_read_b64_tr_b16 v[98:99], v3 offset:25088
    v_mfma_f32_16x16x32_bf16 v[184:187], v[112:115], a[212:215], v[184:187]
    s_waitcnt lgkmcnt(4)
    v_mfma_f32_16x16x32_bf16 v[188:191], v[116:119], a[20:23], v[188:191]
    ds_read_b64_tr_b16 v[100:101], v4 offset:24576
    v_mfma_f32_16x16x32_bf16 v[192:195], v[116:119], a[84:87], v[192:195]
    v_mfma_f32_16x16x32_bf16 v[196:199], v[116:119], a[148:151], v[196:199]
    ds_read_b64_tr_b16 v[102:103], v4 offset:25088
    v_mfma_f32_16x16x32_bf16 v[200:203], v[116:119], a[212:215], v[200:203]
    buffer_load_dwordx4 v7, s[12:15], s25 offen offset:1024 lds
    v_mfma_f32_16x16x32_bf16 v[204:207], v[120:123], a[20:23], v[204:207]
    ds_read_b64_tr_b16 v[104:105], v5 offset:24576
    v_mfma_f32_16x16x32_bf16 v[208:211], v[120:123], a[84:87], v[208:211]
    v_mfma_f32_16x16x32_bf16 v[212:215], v[120:123], a[148:151], v[212:215]
    ds_read_b64_tr_b16 v[106:107], v5 offset:25088
    v_mfma_f32_16x16x32_bf16 v[216:219], v[120:123], a[212:215], v[216:219]
    s_waitcnt lgkmcnt(4)
    v_mfma_f32_16x16x32_bf16 v[156:159], v[92:95], a[24:27], v[156:159]
    ds_read_b64_tr_b16 v[108:109], v2 offset:28672
    v_mfma_f32_16x16x32_bf16 v[160:163], v[92:95], a[88:91], v[160:163]
    buffer_load_dwordx4 v8, s[12:15], s25 offen offset:2048 lds
    v_mfma_f32_16x16x32_bf16 v[164:167], v[92:95], a[152:155], v[164:167]
    ds_read_b64_tr_b16 v[110:111], v2 offset:29184
    v_mfma_f32_16x16x32_bf16 v[168:171], v[92:95], a[216:219], v[168:171]
    v_mfma_f32_16x16x32_bf16 v[172:175], v[96:99], a[24:27], v[172:175]
    ds_read_b64_tr_b16 v[112:113], v3 offset:28672
    v_mfma_f32_16x16x32_bf16 v[176:179], v[96:99], a[88:91], v[176:179]
    v_mfma_f32_16x16x32_bf16 v[180:183], v[96:99], a[152:155], v[180:183]
    ds_read_b64_tr_b16 v[114:115], v3 offset:29184
    v_mfma_f32_16x16x32_bf16 v[184:187], v[96:99], a[216:219], v[184:187]
    s_waitcnt lgkmcnt(4)
    buffer_load_dwordx4 v9, s[12:15], s25 offen offset:3072 lds
    v_mfma_f32_16x16x32_bf16 v[188:191], v[100:103], a[24:27], v[188:191]
    ds_read_b64_tr_b16 v[116:117], v4 offset:28672
    v_mfma_f32_16x16x32_bf16 v[192:195], v[100:103], a[88:91], v[192:195]
    v_mfma_f32_16x16x32_bf16 v[196:199], v[100:103], a[152:155], v[196:199]
    s_add_u32 m0, s54, 131072
    ds_read_b64_tr_b16 v[118:119], v4 offset:29184
    v_mfma_f32_16x16x32_bf16 v[200:203], v[100:103], a[216:219], v[200:203]
    s_add_u32 s49, s53, 128
    v_mfma_f32_16x16x32_bf16 v[204:207], v[104:107], a[24:27], v[204:207]
    s_and_b32 s49, s49, 1023
    ds_read_b64_tr_b16 v[120:121], v5 offset:28672
    v_mfma_f32_16x16x32_bf16 v[208:211], v[104:107], a[88:91], v[208:211]
    s_add_u32 s57, s46, s49
    buffer_store_dwordx4 v[124:127], v18, s[16:19], s23 offen offset:0 sc1
    v_mfma_f32_16x16x32_bf16 v[212:215], v[104:107], a[152:155], v[212:215]
    ds_read_b64_tr_b16 v[122:123], v5 offset:29184
    v_mfma_f32_16x16x32_bf16 v[216:219], v[104:107], a[216:219], v[216:219]
    s_waitcnt lgkmcnt(4)
    v_mfma_f32_16x16x32_bf16 v[156:159], v[108:111], a[28:31], v[156:159]
    ds_read_b64_tr_b16 v[92:93], v2 offset:32768
    v_mfma_f32_16x16x32_bf16 v[160:163], v[108:111], a[92:95], v[160:163]
    buffer_load_dwordx4 v222, s[64:67], s57 offen offset:0 lds
    v_mfma_f32_16x16x32_bf16 v[164:167], v[108:111], a[156:159], v[164:167]
    ds_read_b64_tr_b16 v[94:95], v2 offset:33280
    v_mfma_f32_16x16x32_bf16 v[168:171], v[108:111], a[220:223], v[168:171]
    v_mfma_f32_16x16x32_bf16 v[172:175], v[112:115], a[28:31], v[172:175]
    ds_read_b64_tr_b16 v[96:97], v3 offset:32768
    v_mfma_f32_16x16x32_bf16 v[176:179], v[112:115], a[92:95], v[176:179]
    v_mfma_f32_16x16x32_bf16 v[180:183], v[112:115], a[156:159], v[180:183]
    ds_read_b64_tr_b16 v[98:99], v3 offset:33280
    v_mfma_f32_16x16x32_bf16 v[184:187], v[112:115], a[220:223], v[184:187]
    s_waitcnt lgkmcnt(4)
    v_mfma_f32_16x16x32_bf16 v[188:191], v[116:119], a[28:31], v[188:191]
    ds_read_b64_tr_b16 v[100:101], v4 offset:32768
    v_mfma_f32_16x16x32_bf16 v[192:195], v[116:119], a[92:95], v[192:195]
    v_mfma_f32_16x16x32_bf16 v[196:199], v[116:119], a[156:159], v[196:199]
    ds_read_b64_tr_b16 v[102:103], v4 offset:33280
    v_mfma_f32_16x16x32_bf16 v[200:203], v[116:119], a[220:223], v[200:203]
    v_mfma_f32_16x16x32_bf16 v[204:207], v[120:123], a[28:31], v[204:207]
    ds_read_b64_tr_b16 v[104:105], v5 offset:32768
    v_mfma_f32_16x16x32_bf16 v[208:211], v[120:123], a[92:95], v[208:211]
    buffer_store_dwordx4 v[128:131], v18, s[16:19], s23 offen offset:1024 sc1
    v_mfma_f32_16x16x32_bf16 v[212:215], v[120:123], a[156:159], v[212:215]
    ds_read_b64_tr_b16 v[106:107], v5 offset:33280
    v_mfma_f32_16x16x32_bf16 v[216:219], v[120:123], a[220:223], v[216:219]
    s_waitcnt lgkmcnt(4)
    v_mfma_f32_16x16x32_bf16 v[156:159], v[92:95], a[32:35], v[156:159]
    ds_read_b64_tr_b16 v[108:109], v2 offset:36864
    v_mfma_f32_16x16x32_bf16 v[160:163], v[92:95], a[96:99], v[160:163]
    buffer_load_dwordx4 v223, s[64:67], s57 offen offset:1024 lds
    v_mfma_f32_16x16x32_bf16 v[164:167], v[92:95], a[160:163], v[164:167]
    ds_read_b64_tr_b16 v[110:111], v2 offset:37376
    v_mfma_f32_16x16x32_bf16 v[168:171], v[92:95], a[224:227], v[168:171]
    v_mfma_f32_16x16x32_bf16 v[172:175], v[96:99], a[32:35], v[172:175]
    ds_read_b64_tr_b16 v[112:113], v3 offset:36864
    v_mfma_f32_16x16x32_bf16 v[176:179], v[96:99], a[96:99], v[176:179]
    v_mfma_f32_16x16x32_bf16 v[180:183], v[96:99], a[160:163], v[180:183]
    ds_read_b64_tr_b16 v[114:115], v3 offset:37376
    v_mfma_f32_16x16x32_bf16 v[184:187], v[96:99], a[224:227], v[184:187]
    s_waitcnt lgkmcnt(4)
    v_mfma_f32_16x16x32_bf16 v[188:191], v[100:103], a[32:35], v[188:191]
    ds_read_b64_tr_b16 v[116:117], v4 offset:36864
    v_mfma_f32_16x16x32_bf16 v[192:195], v[100:103], a[96:99], v[192:195]
    v_mfma_f32_16x16x32_bf16 v[196:199], v[100:103], a[160:163], v[196:199]
    ds_read_b64_tr_b16 v[118:119], v4 offset:37376
    v_mfma_f32_16x16x32_bf16 v[200:203], v[100:103], a[224:227], v[200:203]
    v_mfma_f32_16x16x32_bf16 v[204:207], v[104:107], a[32:35], v[204:207]
    ds_read_b64_tr_b16 v[120:121], v5 offset:36864
    v_mfma_f32_16x16x32_bf16 v[208:211], v[104:107], a[96:99], v[208:211]
    buffer_store_dwordx4 v[132:135], v19, s[16:19], s23 offen offset:0 sc1
    v_mfma_f32_16x16x32_bf16 v[212:215], v[104:107], a[160:163], v[212:215]
    ds_read_b64_tr_b16 v[122:123], v5 offset:37376
    v_mfma_f32_16x16x32_bf16 v[216:219], v[104:107], a[224:227], v[216:219]
    s_waitcnt lgkmcnt(4)
    v_mfma_f32_16x16x32_bf16 v[156:159], v[108:111], a[36:39], v[156:159]
    ds_read_b64_tr_b16 v[92:93], v2 offset:40960
    v_mfma_f32_16x16x32_bf16 v[160:163], v[108:111], a[100:103], v[160:163]
    buffer_load_dwordx4 v224, s[64:67], s57 offen offset:2048 lds
    v_mfma_f32_16x16x32_bf16 v[164:167], v[108:111], a[164:167], v[164:167]
    ds_read_b64_tr_b16 v[94:95], v2 offset:41472
    v_mfma_f32_16x16x32_bf16 v[168:171], v[108:111], a[228:231], v[168:171]
    v_mfma_f32_16x16x32_bf16 v[172:175], v[112:115], a[36:39], v[172:175]
    ds_read_b64_tr_b16 v[96:97], v3 offset:40960
    v_mfma_f32_16x16x32_bf16 v[176:179], v[112:115], a[100:103], v[176:179]
    buffer_load_dword v226, v227, s[40:43], s4 offen
    v_mfma_f32_16x16x32_bf16 v[180:183], v[112:115], a[164:167], v[180:183]
    s_add_u32 s4, s4, 1792
    ds_read_b64_tr_b16 v[98:99], v3 offset:41472
    v_mfma_f32_16x16x32_bf16 v[184:187], v[112:115], a[228:231], v[184:187]
    s_waitcnt lgkmcnt(4)
    v_mfma_f32_16x16x32_bf16 v[188:191], v[116:119], a[36:39], v[188:191]
    ds_read_b64_tr_b16 v[100:101], v4 offset:40960
    v_mfma_f32_16x16x32_bf16 v[192:195], v[116:119], a[100:103], v[192:195]
    v_mfma_f32_16x16x32_bf16 v[196:199], v[116:119], a[164:167], v[196:199]
    ds_read_b64_tr_b16 v[102:103], v4 offset:41472
    v_mfma_f32_16x16x32_bf16 v[200:203], v[116:119], a[228:231], v[200:203]
    v_mfma_f32_16x16x32_bf16 v[204:207], v[120:123], a[36:39], v[204:207]
    ds_read_b64_tr_b16 v[104:105], v5 offset:40960
    v_mfma_f32_16x16x32_bf16 v[208:211], v[120:123], a[100:103], v[208:211]
    buffer_store_dwordx4 v[136:139], v19, s[16:19], s23 offen offset:1024 sc1
    v_mfma_f32_16x16x32_bf16 v[212:215], v[120:123], a[164:167], v[212:215]
    ds_read_b64_tr_b16 v[106:107], v5 offset:41472
    v_mfma_f32_16x16x32_bf16 v[216:219], v[120:123], a[228:231], v[216:219]
    s_waitcnt lgkmcnt(4)
    v_mfma_f32_16x16x32_bf16 v[156:159], v[92:95], a[40:43], v[156:159]
    ds_read_b64_tr_b16 v[108:109], v2 offset:45056
    v_mfma_f32_16x16x32_bf16 v[160:163], v[92:95], a[104:107], v[160:163]
    buffer_load_dwordx4 v225, s[64:67], s57 offen offset:3072 lds
    v_mfma_f32_16x16x32_bf16 v[164:167], v[92:95], a[168:171], v[164:167]
    ds_read_b64_tr_b16 v[110:111], v2 offset:45568
    v_mfma_f32_16x16x32_bf16 v[168:171], v[92:95], a[232:235], v[168:171]
    v_mfma_f32_16x16x32_bf16 v[172:175], v[96:99], a[40:43], v[172:175]
    ds_read_b64_tr_b16 v[112:113], v3 offset:45056
    v_mfma_f32_16x16x32_bf16 v[176:179], v[96:99], a[104:107], v[176:179]
    v_mfma_f32_16x16x32_bf16 v[180:183], v[96:99], a[168:171], v[180:183]
    ds_read_b64_tr_b16 v[114:115], v3 offset:45568
    v_mfma_f32_16x16x32_bf16 v[184:187], v[96:99], a[232:235], v[184:187]
    s_waitcnt lgkmcnt(4)
    v_mfma_f32_16x16x32_bf16 v[188:191], v[100:103], a[40:43], v[188:191]
    ds_read_b64_tr_b16 v[116:117], v4 offset:45056
    v_mfma_f32_16x16x32_bf16 v[192:195], v[100:103], a[104:107], v[192:195]
    v_mfma_f32_16x16x32_bf16 v[196:199], v[100:103], a[168:171], v[196:199]
    s_add_u32 m0, s54, 135168
    ds_read_b64_tr_b16 v[118:119], v4 offset:45568
    v_mfma_f32_16x16x32_bf16 v[200:203], v[100:103], a[232:235], v[200:203]
    s_add_u32 s57, s47, s49
    v_mfma_f32_16x16x32_bf16 v[204:207], v[104:107], a[40:43], v[204:207]
    ds_read_b64_tr_b16 v[120:121], v5 offset:45056
    v_mfma_f32_16x16x32_bf16 v[208:211], v[104:107], a[104:107], v[208:211]
    buffer_store_dwordx4 v[140:143], v20, s[16:19], s23 offen offset:0 sc1
    v_mfma_f32_16x16x32_bf16 v[212:215], v[104:107], a[168:171], v[212:215]
    ds_read_b64_tr_b16 v[122:123], v5 offset:45568
    v_mfma_f32_16x16x32_bf16 v[216:219], v[104:107], a[232:235], v[216:219]
    s_waitcnt lgkmcnt(4)
    v_mfma_f32_16x16x32_bf16 v[156:159], v[108:111], a[44:47], v[156:159]
    ds_read_b64_tr_b16 v[92:93], v2 offset:49152
    v_mfma_f32_16x16x32_bf16 v[160:163], v[108:111], a[108:111], v[160:163]
    buffer_load_dwordx4 v222, s[64:67], s57 offen offset:0 lds
    v_mfma_f32_16x16x32_bf16 v[164:167], v[108:111], a[172:175], v[164:167]
    ds_read_b64_tr_b16 v[94:95], v2 offset:49664
    v_mfma_f32_16x16x32_bf16 v[168:171], v[108:111], a[236:239], v[168:171]
    v_mfma_f32_16x16x32_bf16 v[172:175], v[112:115], a[44:47], v[172:175]
    ds_read_b64_tr_b16 v[96:97], v3 offset:49152
    v_mfma_f32_16x16x32_bf16 v[176:179], v[112:115], a[108:111], v[176:179]
    v_mfma_f32_16x16x32_bf16 v[180:183], v[112:115], a[172:175], v[180:183]
    ds_read_b64_tr_b16 v[98:99], v3 offset:49664
    v_mfma_f32_16x16x32_bf16 v[184:187], v[112:115], a[236:239], v[184:187]
    s_waitcnt lgkmcnt(4)
    v_mfma_f32_16x16x32_bf16 v[188:191], v[116:119], a[44:47], v[188:191]
    ds_read_b64_tr_b16 v[100:101], v4 offset:49152
    v_mfma_f32_16x16x32_bf16 v[192:195], v[116:119], a[108:111], v[192:195]
    v_mfma_f32_16x16x32_bf16 v[196:199], v[116:119], a[172:175], v[196:199]
    ds_read_b64_tr_b16 v[102:103], v4 offset:49664
    v_mfma_f32_16x16x32_bf16 v[200:203], v[116:119], a[236:239], v[200:203]
    v_mfma_f32_16x16x32_bf16 v[204:207], v[120:123], a[44:47], v[204:207]
    ds_read_b64_tr_b16 v[104:105], v5 offset:49152
    v_mfma_f32_16x16x32_bf16 v[208:211], v[120:123], a[108:111], v[208:211]
    buffer_store_dwordx4 v[144:147], v20, s[16:19], s23 offen offset:1024 sc1
    v_mfma_f32_16x16x32_bf16 v[212:215], v[120:123], a[172:175], v[212:215]
    ds_read_b64_tr_b16 v[106:107], v5 offset:49664
    v_mfma_f32_16x16x32_bf16 v[216:219], v[120:123], a[236:239], v[216:219]
    s_waitcnt lgkmcnt(4)
    v_mfma_f32_16x16x32_bf16 v[156:159], v[92:95], a[48:51], v[156:159]
    ds_read_b64_tr_b16 v[108:109], v2 offset:53248
    v_mfma_f32_16x16x32_bf16 v[160:163], v[92:95], a[112:115], v[160:163]
    buffer_load_dwordx4 v223, s[64:67], s57 offen offset:1024 lds
    v_mfma_f32_16x16x32_bf16 v[164:167], v[92:95], a[176:179], v[164:167]
    ds_read_b64_tr_b16 v[110:111], v2 offset:53760
    v_mfma_f32_16x16x32_bf16 v[168:171], v[92:95], a[240:243], v[168:171]
    v_mfma_f32_16x16x32_bf16 v[172:175], v[96:99], a[48:51], v[172:175]
    ds_read_b64_tr_b16 v[112:113], v3 offset:53248
    v_mfma_f32_16x16x32_bf16 v[176:179], v[96:99], a[112:115], v[176:179]
    v_mfma_f32_16x16x32_bf16 v[180:183], v[96:99], a[176:179], v[180:183]
    ds_read_b64_tr_b16 v[114:115], v3 offset:53760
    v_mfma_f32_16x16x32_bf16 v[184:187], v[96:99], a[240:243], v[184:187]
    s_waitcnt lgkmcnt(4)
    v_mfma_f32_16x16x32_bf16 v[188:191], v[100:103], a[48:51], v[188:191]
    ds_read_b64_tr_b16 v[116:117], v4 offset:53248
    v_mfma_f32_16x16x32_bf16 v[192:195], v[100:103], a[112:115], v[192:195]
    v_mfma_f32_16x16x32_bf16 v[196:199], v[100:103], a[176:179], v[196:199]
    ds_read_b64_tr_b16 v[118:119], v4 offset:53760
    v_mfma_f32_16x16x32_bf16 v[200:203], v[100:103], a[240:243], v[200:203]
    v_mfma_f32_16x16x32_bf16 v[204:207], v[104:107], a[48:51], v[204:207]
    ds_read_b64_tr_b16 v[120:121], v5 offset:53248
    v_mfma_f32_16x16x32_bf16 v[208:211], v[104:107], a[112:115], v[208:211]
    buffer_store_dwordx4 v[148:151], v21, s[16:19], s23 offen offset:0 sc1
    v_mfma_f32_16x16x32_bf16 v[212:215], v[104:107], a[176:179], v[212:215]
    ds_read_b64_tr_b16 v[122:123], v5 offset:53760
    v_mfma_f32_16x16x32_bf16 v[216:219], v[104:107], a[240:243], v[216:219]
    s_waitcnt lgkmcnt(4)
    v_mfma_f32_16x16x32_bf16 v[156:159], v[108:111], a[52:55], v[156:159]
    ds_read_b64_tr_b16 v[92:93], v2 offset:57344
    v_mfma_f32_16x16x32_bf16 v[160:163], v[108:111], a[116:119], v[160:163]
    buffer_load_dwordx4 v224, s[64:67], s57 offen offset:2048 lds
    v_mfma_f32_16x16x32_bf16 v[164:167], v[108:111], a[180:183], v[164:167]
    ds_read_b64_tr_b16 v[94:95], v2 offset:57856
    v_mfma_f32_16x16x32_bf16 v[168:171], v[108:111], a[244:247], v[168:171]
    v_mfma_f32_16x16x32_bf16 v[172:175], v[112:115], a[52:55], v[172:175]
    ds_read_b64_tr_b16 v[96:97], v3 offset:57344
    v_mfma_f32_16x16x32_bf16 v[176:179], v[112:115], a[116:119], v[176:179]
    v_mfma_f32_16x16x32_bf16 v[180:183], v[112:115], a[180:183], v[180:183]
    ds_read_b64_tr_b16 v[98:99], v3 offset:57856
    v_mfma_f32_16x16x32_bf16 v[184:187], v[112:115], a[244:247], v[184:187]
    s_waitcnt lgkmcnt(4)
    v_mfma_f32_16x16x32_bf16 v[188:191], v[116:119], a[52:55], v[188:191]
    ds_read_b64_tr_b16 v[100:101], v4 offset:57344
    v_mfma_f32_16x16x32_bf16 v[192:195], v[116:119], a[116:119], v[192:195]
    v_mfma_f32_16x16x32_bf16 v[196:199], v[116:119], a[180:183], v[196:199]
    ds_read_b64_tr_b16 v[102:103], v4 offset:57856
    v_mfma_f32_16x16x32_bf16 v[200:203], v[116:119], a[244:247], v[200:203]
    v_mfma_f32_16x16x32_bf16 v[204:207], v[120:123], a[52:55], v[204:207]
    ds_read_b64_tr_b16 v[104:105], v5 offset:57344
    v_mfma_f32_16x16x32_bf16 v[208:211], v[120:123], a[116:119], v[208:211]
    buffer_store_dwordx4 v[152:155], v21, s[16:19], s23 offen offset:1024 sc1
    v_mfma_f32_16x16x32_bf16 v[212:215], v[120:123], a[180:183], v[212:215]
    ds_read_b64_tr_b16 v[106:107], v5 offset:57856
    v_mfma_f32_16x16x32_bf16 v[216:219], v[120:123], a[244:247], v[216:219]
    s_waitcnt lgkmcnt(4)
    v_mfma_f32_16x16x32_bf16 v[156:159], v[92:95], a[56:59], v[156:159]
    ds_read_b64_tr_b16 v[108:109], v2 offset:61440
    v_mfma_f32_16x16x32_bf16 v[160:163], v[92:95], a[120:123], v[160:163]
    buffer_load_dwordx4 v225, s[64:67], s57 offen offset:3072 lds
    v_mfma_f32_16x16x32_bf16 v[164:167], v[92:95], a[184:187], v[164:167]
    ds_read_b64_tr_b16 v[110:111], v2 offset:61952
    v_mfma_f32_16x16x32_bf16 v[168:171], v[92:95], a[248:251], v[168:171]
    v_mfma_f32_16x16x32_bf16 v[172:175], v[96:99], a[56:59], v[172:175]
    ds_read_b64_tr_b16 v[112:113], v3 offset:61440
    v_mfma_f32_16x16x32_bf16 v[176:179], v[96:99], a[120:123], v[176:179]
    v_mfma_f32_16x16x32_bf16 v[180:183], v[96:99], a[184:187], v[180:183]
    ds_read_b64_tr_b16 v[114:115], v3 offset:61952
    v_mfma_f32_16x16x32_bf16 v[184:187], v[96:99], a[248:251], v[184:187]
    s_waitcnt lgkmcnt(4)
    v_mfma_f32_16x16x32_bf16 v[188:191], v[100:103], a[56:59], v[188:191]
    ds_read_b64_tr_b16 v[116:117], v4 offset:61440
    v_mfma_f32_16x16x32_bf16 v[192:195], v[100:103], a[120:123], v[192:195]
    v_mfma_f32_16x16x32_bf16 v[196:199], v[100:103], a[184:187], v[196:199]
    ds_read_b64_tr_b16 v[118:119], v4 offset:61952
    v_mfma_f32_16x16x32_bf16 v[200:203], v[100:103], a[248:251], v[200:203]
    v_mfma_f32_16x16x32_bf16 v[204:207], v[104:107], a[56:59], v[204:207]
    ds_read_b64_tr_b16 v[120:121], v5 offset:61440
    v_mfma_f32_16x16x32_bf16 v[208:211], v[104:107], a[120:123], v[208:211]
    v_mfma_f32_16x16x32_bf16 v[212:215], v[104:107], a[184:187], v[212:215]
    s_waitcnt vmcnt(17)
    ds_read_b64_tr_b16 v[122:123], v5 offset:61952
    v_mfma_f32_16x16x32_bf16 v[216:219], v[104:107], a[248:251], v[216:219]
    s_waitcnt lgkmcnt(4)
    v_xor_b32 v2, 0x10000, v2
    v_xor_b32 v3, 0x10000, v3
    v_mfma_f32_16x16x32_bf16 v[156:159], v[108:111], a[60:63], v[156:159]
    s_barrier
    ds_read_b64_tr_b16 v[92:93], v2 offset:0
    v_mfma_f32_16x16x32_bf16 v[160:163], v[108:111], a[124:127], v[160:163]
    v_xor_b32 v4, 0x10000, v4
    v_xor_b32 v5, 0x10000, v5
    v_mfma_f32_16x16x32_bf16 v[164:167], v[108:111], a[188:191], v[164:167]
    s_xor_b32 s48, s48, 0x10000
    ds_read_b64_tr_b16 v[94:95], v2 offset:512
    v_mfma_f32_16x16x32_bf16 v[168:171], v[108:111], a[252:255], v[168:171]
    v_mfma_f32_16x16x32_bf16 v[172:175], v[112:115], a[60:63], v[172:175]
    s_add_u32 s22, s22, s59
    ds_read_b64_tr_b16 v[96:97], v3 offset:0
    v_mfma_f32_16x16x32_bf16 v[176:179], v[112:115], a[124:127], v[176:179]
    v_mfma_f32_16x16x32_bf16 v[180:183], v[112:115], a[188:191], v[180:183]
    ds_read_b64_tr_b16 v[98:99], v3 offset:512
    v_mfma_f32_16x16x32_bf16 v[184:187], v[112:115], a[252:255], v[184:187]
    s_waitcnt lgkmcnt(4)
    v_mfma_f32_16x16x32_bf16 v[188:191], v[116:119], a[60:63], v[188:191]
    ds_read_b64_tr_b16 v[100:101], v4 offset:0
    v_mfma_f32_16x16x32_bf16 v[192:195], v[116:119], a[124:127], v[192:195]
    v_mfma_f32_16x16x32_bf16 v[196:199], v[116:119], a[188:191], v[196:199]
    ds_read_b64_tr_b16 v[102:103], v4 offset:512
    v_mfma_f32_16x16x32_bf16 v[200:203], v[116:119], a[252:255], v[200:203]
    v_mfma_f32_16x16x32_bf16 v[204:207], v[120:123], a[60:63], v[204:207]
    ds_read_b64_tr_b16 v[104:105], v5 offset:0
    v_mfma_f32_16x16x32_bf16 v[208:211], v[120:123], a[124:127], v[208:211]
    v_mfma_f32_16x16x32_bf16 v[212:215], v[120:123], a[188:191], v[212:215]
    ds_read_b64_tr_b16 v[106:107], v5 offset:512
    v_mfma_f32_16x16x32_bf16 v[216:219], v[120:123], a[252:255], v[216:219]
    s_waitcnt lgkmcnt(4)
    s_cmp_lg_u32 s59, 128
    s_cbranch_scc0 L1K_last
    v_pk_mul_f32 v[156:157], v[156:157], v[232:233]
    v_pk_mul_f32 v[158:159], v[158:159], v[232:233]
    v_cvt_pk_bf16_f32 v124, v156, v157
    v_cvt_pk_bf16_f32 v125, v158, v159
    v_pk_mul_f32 v[160:161], v[160:161], v[232:233]
    v_pk_mul_f32 v[162:163], v[162:163], v[232:233]
    v_cvt_pk_bf16_f32 v132, v160, v161
    v_cvt_pk_bf16_f32 v133, v162, v163
    v_pk_mul_f32 v[164:165], v[164:165], v[232:233]
    v_pk_mul_f32 v[166:167], v[166:167], v[232:233]
    v_cvt_pk_bf16_f32 v140, v164, v165
    v_cvt_pk_bf16_f32 v141, v166, v167
    v_pk_mul_f32 v[168:169], v[168:169], v[232:233]
    v_pk_mul_f32 v[170:171], v[170:171], v[232:233]
    v_cvt_pk_bf16_f32 v148, v168, v169
    v_cvt_pk_bf16_f32 v149, v170, v171
    v_pk_mul_f32 v[172:173], v[172:173], v[232:233]
    v_pk_mul_f32 v[174:175], v[174:175], v[232:233]
    v_cvt_pk_bf16_f32 v126, v172, v173
    v_cvt_pk_bf16_f32 v127, v174, v175
    v_pk_mul_f32 v[176:177], v[176:177], v[232:233]
    v_pk_mul_f32 v[178:179], v[178:179], v[232:233]
    v_cvt_pk_bf16_f32 v134, v176, v177
    v_cvt_pk_bf16_f32 v135, v178, v179
    v_pk_mul_f32 v[180:181], v[180:181], v[232:233]
    v_pk_mul_f32 v[182:183], v[182:183], v[232:233]
    v_cvt_pk_bf16_f32 v142, v180, v181
    v_cvt_pk_bf16_f32 v143, v182, v183
    v_pk_mul_f32 v[184:185], v[184:185], v[232:233]
    v_pk_mul_f32 v[186:187], v[186:187], v[232:233]
    v_cvt_pk_bf16_f32 v150, v184, v185
    v_cvt_pk_bf16_f32 v151, v186, v187
    v_pk_mul_f32 v[188:189], v[188:189], v[232:233]
    v_pk_mul_f32 v[190:191], v[190:191], v[232:233]
    v_cvt_pk_bf16_f32 v128, v188, v189
    v_cvt_pk_bf16_f32 v129, v190, v191
    v_pk_mul_f32 v[192:193], v[192:193], v[232:233]
    v_pk_mul_f32 v[194:195], v[194:195], v[232:233]
    v_cvt_pk_bf16_f32 v136, v192, v193
    v_cvt_pk_bf16_f32 v137, v194, v195
    v_pk_mul_f32 v[196:197], v[196:197], v[232:233]
    v_pk_mul_f32 v[198:199], v[198:199], v[232:233]
    v_cvt_pk_bf16_f32 v144, v196, v197
    v_cvt_pk_bf16_f32 v145, v198, v199
    v_pk_mul_f32 v[200:201], v[200:201], v[232:233]
    v_pk_mul_f32 v[202:203], v[202:203], v[232:233]
    v_cvt_pk_bf16_f32 v152, v200, v201
    v_cvt_pk_bf16_f32 v153, v202, v203
    v_pk_mul_f32 v[204:205], v[204:205], v[232:233]
    v_pk_mul_f32 v[206:207], v[206:207], v[232:233]
    v_cvt_pk_bf16_f32 v130, v204, v205
    v_cvt_pk_bf16_f32 v131, v206, v207
    v_pk_mul_f32 v[208:209], v[208:209], v[232:233]
    v_pk_mul_f32 v[210:211], v[210:211], v[232:233]
    v_cvt_pk_bf16_f32 v138, v208, v209
    v_cvt_pk_bf16_f32 v139, v210, v211
    v_pk_mul_f32 v[212:213], v[212:213], v[232:233]
    v_pk_mul_f32 v[214:215], v[214:215], v[232:233]
    v_cvt_pk_bf16_f32 v146, v212, v213
    v_cvt_pk_bf16_f32 v147, v214, v215
    v_pk_mul_f32 v[216:217], v[216:217], v[232:233]
    v_pk_mul_f32 v[218:219], v[218:219], v[232:233]
    v_cvt_pk_bf16_f32 v154, v216, v217
    v_cvt_pk_bf16_f32 v155, v218, v219
    s_branch L1K_fin
L1K_last:
    v_mfma_f32_16x16x32_bf16 v[28:31], v[92:95], a[0:3], 0
    s_lshr_b32 s23, s31, 1
    ds_read_b64_tr_b16 v[108:109], v2 offset:4096
    v_mul_f32 v156, s34, v156
    v_mfma_f32_16x16x32_bf16 v[32:35], v[92:95], a[64:67], 0
    s_lshl_b32 s23, s23, 20
    v_mul_f32 v157, s34, v157
    v_mul_f32 v158, s34, v158
    v_mfma_f32_16x16x32_bf16 v[36:39], v[92:95], a[128:131], 0
    s_add_u32 s23, s23, s32
    ds_read_b64_tr_b16 v[110:111], v2 offset:4608
    v_mul_f32 v159, s34, v159
    v_mfma_f32_16x16x32_bf16 v[40:43], v[92:95], a[192:195], 0
    s_and_b32 s33, s31, 1
    v_cvt_pk_bf16_f32 v124, v156, v157
    v_cvt_pk_bf16_f32 v125, v158, v159
    v_mfma_f32_16x16x32_bf16 v[44:47], v[96:99], a[0:3], 0
    s_lshl_b32 s33, s33, 11
    ds_read_b64_tr_b16 v[112:113], v3 offset:4096
    v_mul_f32 v160, s34, v160
    v_mfma_f32_16x16x32_bf16 v[48:51], v[96:99], a[64:67], 0
    s_add_u32 s23, s23, s33
    v_mul_f32 v161, s34, v161
    v_mul_f32 v162, s34, v162
    v_mfma_f32_16x16x32_bf16 v[52:55], v[96:99], a[128:131], 0
    s_add_u32 s31, s31, 1
    ds_read_b64_tr_b16 v[114:115], v3 offset:4608
    v_mul_f32 v163, s34, v163
    v_mfma_f32_16x16x32_bf16 v[56:59], v[96:99], a[192:195], 0
    s_waitcnt lgkmcnt(4)
    v_cvt_pk_bf16_f32 v132, v160, v161
    v_cvt_pk_bf16_f32 v133, v162, v163
    v_mfma_f32_16x16x32_bf16 v[60:63], v[100:103], a[0:3], 0
    s_barrier
    ds_read_b64_tr_b16 v[116:117], v4 offset:4096
    v_mul_f32 v164, s34, v164
    v_mfma_f32_16x16x32_bf16 v[64:67], v[100:103], a[64:67], 0
    v_mul_f32 v165, s34, v165
    v_mul_f32 v166, s34, v166
    v_mfma_f32_16x16x32_bf16 v[68:71], v[100:103], a[128:131], 0
    s_add_u32 m0, s54, 0
    ds_read_b64_tr_b16 v[118:119], v4 offset:4608
    v_mul_f32 v167, s34, v167
    v_mfma_f32_16x16x32_bf16 v[72:75], v[100:103], a[192:195], 0
    s_add_u32 s49, s53, 0
    v_cvt_pk_bf16_f32 v140, v164, v165
    v_cvt_pk_bf16_f32 v141, v166, v167
    v_mfma_f32_16x16x32_bf16 v[76:79], v[104:107], a[0:3], 0
    s_and_b32 s49, s49, 1023
    ds_read_b64_tr_b16 v[120:121], v5 offset:4096
    v_mul_f32 v168, s34, v168
    v_mfma_f32_16x16x32_bf16 v[80:83], v[104:107], a[64:67], 0
    s_add_u32 s57, s46, s49
    v_mul_f32 v169, s34, v169
    v_mul_f32 v170, s34, v170
    v_mfma_f32_16x16x32_bf16 v[84:87], v[104:107], a[128:131], 0
    ds_read_b64_tr_b16 v[122:123], v5 offset:4608
    v_mul_f32 v171, s34, v171
    v_mfma_f32_16x16x32_bf16 v[88:91], v[104:107], a[192:195], 0
    s_waitcnt lgkmcnt(4)
    v_cvt_pk_bf16_f32 v148, v168, v169
    v_cvt_pk_bf16_f32 v149, v170, v171
    v_mfma_f32_16x16x32_bf16 v[28:31], v[108:111], a[4:7], v[28:31]
    ds_read_b64_tr_b16 v[92:93], v2 offset:8192
    v_mul_f32 v172, s34, v172
    v_mfma_f32_16x16x32_bf16 v[32:35], v[108:111], a[68:71], v[32:35]
    buffer_load_dwordx4 v222, s[64:67], s57 offen offset:0 lds
    v_mul_f32 v173, s34, v173
    v_mfma_f32_16x16x32_bf16 v[36:39], v[108:111], a[132:135], v[36:39]
    ds_read_b64_tr_b16 v[94:95], v2 offset:8704
    v_mul_f32 v174, s34, v174
    v_mfma_f32_16x16x32_bf16 v[40:43], v[108:111], a[196:199], v[40:43]
    v_mul_f32 v175, s34, v175
    v_cvt_pk_bf16_f32 v126, v172, v173
    v_mfma_f32_16x16x32_bf16 v[44:47], v[112:115], a[4:7], v[44:47]
    ds_read_b64_tr_b16 v[96:97], v3 offset:8192
    v_cvt_pk_bf16_f32 v127, v174, v175
    v_mfma_f32_16x16x32_bf16 v[48:51], v[112:115], a[68:71], v[48:51]
    v_mul_f32 v176, s34, v176
    v_mul_f32 v177, s34, v177
    v_mfma_f32_16x16x32_bf16 v[52:55], v[112:115], a[132:135], v[52:55]
    ds_read_b64_tr_b16 v[98:99], v3 offset:8704
    v_mul_f32 v178, s34, v178
    v_mfma_f32_16x16x32_bf16 v[56:59], v[112:115], a[196:199], v[56:59]
    s_waitcnt lgkmcnt(4)
    buffer_load_dwordx4 v223, s[64:67], s57 offen offset:1024 lds
    v_mul_f32 v179, s34, v179
    v_mfma_f32_16x16x32_bf16 v[60:63], v[116:119], a[4:7], v[60:63]
    ds_read_b64_tr_b16 v[100:101], v4 offset:8192
    v_cvt_pk_bf16_f32 v134, v176, v177
    v_mfma_f32_16x16x32_bf16 v[64:67], v[116:119], a[68:71], v[64:67]
    v_cvt_pk_bf16_f32 v135, v178, v179
    v_mul_f32 v180, s34, v180
    v_mfma_f32_16x16x32_bf16 v[68:71], v[116:119], a[132:135], v[68:71]
    ds_read_b64_tr_b16 v[102:103], v4 offset:8704
    v_mul_f32 v181, s34, v181
    v_mfma_f32_16x16x32_bf16 v[72:75], v[116:119], a[196:199], v[72:75]
    v_mul_f32 v182, s34, v182
    v_mul_f32 v183, s34, v183
    v_mfma_f32_16x16x32_bf16 v[76:79], v[120:123], a[4:7], v[76:79]
    ds_read_b64_tr_b16 v[104:105], v5 offset:8192
    v_cvt_pk_bf16_f32 v142, v180, v181
    v_mfma_f32_16x16x32_bf16 v[80:83], v[120:123], a[68:71], v[80:83]
    v_cvt_pk_bf16_f32 v143, v182, v183
    v_mul_f32 v184, s34, v184
    v_mfma_f32_16x16x32_bf16 v[84:87], v[120:123], a[132:135], v[84:87]
    ds_read_b64_tr_b16 v[106:107], v5 offset:8704
    v_mul_f32 v185, s34, v185
    v_mfma_f32_16x16x32_bf16 v[88:91], v[120:123], a[196:199], v[88:91]
    s_waitcnt lgkmcnt(4)
    buffer_load_dwordx4 v224, s[64:67], s57 offen offset:2048 lds
    v_mul_f32 v186, s34, v186
    v_mfma_f32_16x16x32_bf16 v[28:31], v[92:95], a[8:11], v[28:31]
    ds_read_b64_tr_b16 v[108:109], v2 offset:12288
    v_mul_f32 v187, s34, v187
    v_mfma_f32_16x16x32_bf16 v[32:35], v[92:95], a[72:75], v[32:35]
    v_cvt_pk_bf16_f32 v150, v184, v185
    v_cvt_pk_bf16_f32 v151, v186, v187
    v_mfma_f32_16x16x32_bf16 v[36:39], v[92:95], a[136:139], v[36:39]
    ds_read_b64_tr_b16 v[110:111], v2 offset:12800
    v_mul_f32 v188, s34, v188
    v_mfma_f32_16x16x32_bf16 v[40:43], v[92:95], a[200:203], v[40:43]
    v_mul_f32 v189, s34, v189
    v_mul_f32 v190, s34, v190
    v_mfma_f32_16x16x32_bf16 v[44:47], v[96:99], a[8:11], v[44:47]
    ds_read_b64_tr_b16 v[112:113], v3 offset:12288
    v_mul_f32 v191, s34, v191
    v_mfma_f32_16x16x32_bf16 v[48:51], v[96:99], a[72:75], v[48:51]
    v_cvt_pk_bf16_f32 v128, v188, v189
    v_cvt_pk_bf16_f32 v129, v190, v191
    v_mfma_f32_16x16x32_bf16 v[52:55], v[96:99], a[136:139], v[52:55]
    ds_read_b64_tr_b16 v[114:115], v3 offset:12800
    v_mul_f32 v192, s34, v192
    v_mfma_f32_16x16x32_bf16 v[56:59], v[96:99], a[200:203], v[56:59]
    s_waitcnt lgkmcnt(4)
    buffer_load_dwordx4 v225, s[64:67], s57 offen offset:3072 lds
    v_mul_f32 v193, s34, v193
    v_mfma_f32_16x16x32_bf16 v[60:63], v[100:103], a[8:11], v[60:63]
    ds_read_b64_tr_b16 v[116:117], v4 offset:12288
    v_mul_f32 v194, s34, v194
    v_mfma_f32_16x16x32_bf16 v[64:67], v[100:103], a[72:75], v[64:67]
    v_mul_f32 v195, s34, v195
    v_cvt_pk_bf16_f32 v136, v192, v193
    v_mfma_f32_16x16x32_bf16 v[68:71], v[100:103], a[136:139], v[68:71]
    s_add_u32 m0, s54, 4096
    ds_read_b64_tr_b16 v[118:119], v4 offset:12800
    v_cvt_pk_bf16_f32 v137, v194, v195
    v_mfma_f32_16x16x32_bf16 v[72:75], v[100:103], a[200:203], v[72:75]
    s_add_u32 s57, s47, s49
    v_mul_f32 v196, s34, v196
    v_mul_f32 v197, s34, v197
    v_mfma_f32_16x16x32_bf16 v[76:79], v[104:107], a[8:11], v[76:79]
    ds_read_b64_tr_b16 v[120:121], v5 offset:12288
    v_mul_f32 v198, s34, v198
    v_mfma_f32_16x16x32_bf16 v[80:83], v[104:107], a[72:75], v[80:83]
    v_mul_f32 v199, s34, v199
    v_cvt_pk_bf16_f32 v144, v196, v197
    v_mfma_f32_16x16x32_bf16 v[84:87], v[104:107], a[136:139], v[84:87]
    ds_read_b64_tr_b16 v[122:123], v5 offset:12800
    v_cvt_pk_bf16_f32 v145, v198, v199
    v_mfma_f32_16x16x32_bf16 v[88:91], v[104:107], a[200:203], v[88:91]
    s_waitcnt lgkmcnt(4)
    v_mul_f32 v200, s34, v200
    v_mul_f32 v201, s34, v201
    v_mfma_f32_16x16x32_bf16 v[28:31], v[108:111], a[12:15], v[28:31]
    ds_read_b64_tr_b16 v[92:93], v2 offset:16384
    v_mul_f32 v202, s34, v202
    v_mfma_f32_16x16x32_bf16 v[32:35], v[108:111], a[76:79], v[32:35]
    buffer_load_dwordx4 v222, s[64:67], s57 offen offset:0 lds
    v_mul_f32 v203, s34, v203
    v_mfma_f32_16x16x32_bf16 v[36:39], v[108:111], a[140:143], v[36:39]
    ds_read_b64_tr_b16 v[94:95], v2 offset:16896
    v_cvt_pk_bf16_f32 v152, v200, v201
    v_mfma_f32_16x16x32_bf16 v[40:43], v[108:111], a[204:207], v[40:43]
    v_cvt_pk_bf16_f32 v153, v202, v203
    v_mul_f32 v204, s34, v204
    v_mfma_f32_16x16x32_bf16 v[44:47], v[112:115], a[12:15], v[44:47]
    ds_read_b64_tr_b16 v[96:97], v3 offset:16384
    v_mul_f32 v205, s34, v205
    v_mfma_f32_16x16x32_bf16 v[48:51], v[112:115], a[76:79], v[48:51]
    v_mul_f32 v206, s34, v206
    v_mul_f32 v207, s34, v207
    v_mfma_f32_16x16x32_bf16 v[52:55], v[112:115], a[140:143], v[52:55]
    ds_read_b64_tr_b16 v[98:99], v3 offset:16896
    v_cvt_pk_bf16_f32 v130, v204, v205
    v_mfma_f32_16x16x32_bf16 v[56:59], v[112:115], a[204:207], v[56:59]
    s_waitcnt lgkmcnt(4)
    buffer_load_dwordx4 v223, s[64:67], s57 offen offset:1024 lds
    v_cvt_pk_bf16_f32 v131, v206, v207
    v_mfma_f32_16x16x32_bf16 v[60:63], v[116:119], a[12:15], v[60:63]
    ds_read_b64_tr_b16 v[100:101], v4 offset:16384
    v_mul_f32 v208, s34, v208
    v_mfma_f32_16x16x32_bf16 v[64:67], v[116:119], a[76:79], v[64:67]
    v_mul_f32 v209, s34, v209
    v_mul_f32 v210, s34, v210
    v_mfma_f32_16x16x32_bf16 v[68:71], v[116:119], a[140:143], v[68:71]
    ds_read_b64_tr_b16 v[102:103], v4 offset:16896
    v_mul_f32 v211, s34, v211
    v_mfma_f32_16x16x32_bf16 v[72:75], v[116:119], a[204:207], v[72:75]
    v_cvt_pk_bf16_f32 v138, v208, v209
    v_cvt_pk_bf16_f32 v139, v210, v211
    v_mfma_f32_16x16x32_bf16 v[76:79], v[120:123], a[12:15], v[76:79]
    ds_read_b64_tr_b16 v[104:105], v5 offset:16384
    v_mul_f32 v212, s34, v212
    v_mfma_f32_16x16x32_bf16 v[80:83], v[120:123], a[76:79], v[80:83]
    v_mul_f32 v213, s34, v213
    v_mul_f32 v214, s34, v214
    v_mfma_f32_16x16x32_bf16 v[84:87], v[120:123], a[140:143], v[84:87]
    ds_read_b64_tr_b16 v[106:107], v5 offset:16896
    v_mul_f32 v215, s34, v215
    v_mfma_f32_16x16x32_bf16 v[88:91], v[120:123], a[204:207], v[88:91]
    s_waitcnt lgkmcnt(4)
    buffer_load_dwordx4 v224, s[64:67], s57 offen offset:2048 lds
    v_cvt_pk_bf16_f32 v146, v212, v213
    v_mfma_f32_16x16x32_bf16 v[28:31], v[92:95], a[16:19], v[28:31]
    ds_read_b64_tr_b16 v[108:109], v2 offset:20480
    v_cvt_pk_bf16_f32 v147, v214, v215
    v_mfma_f32_16x16x32_bf16 v[32:35], v[92:95], a[80:83], v[32:35]
    v_mul_f32 v216, s34, v216
    v_mul_f32 v217, s34, v217
    v_mfma_f32_16x16x32_bf16 v[36:39], v[92:95], a[144:147], v[36:39]
    ds_read_b64_tr_b16 v[110:111], v2 offset:20992
    v_mul_f32 v218, s34, v218
    v_mfma_f32_16x16x32_bf16 v[40:43], v[92:95], a[208:211], v[40:43]
    v_mul_f32 v219, s34, v219
    v_cvt_pk_bf16_f32 v154, v216, v217
    v_mfma_f32_16x16x32_bf16 v[44:47], v[96:99], a[16:19], v[44:47]
    ds_read_b64_tr_b16 v[112:113], v3 offset:20480
    v_cvt_pk_bf16_f32 v155, v218, v219
    v_mfma_f32_16x16x32_bf16 v[48:51], v[96:99], a[80:83], v[48:51]
    v_mfma_f32_16x16x32_bf16 v[52:55], v[96:99], a[144:147], v[52:55]
    ds_read_b64_tr_b16 v[114:115], v3 offset:20992
    v_mfma_f32_16x16x32_bf16 v[56:59], v[96:99], a[208:211], v[56:59]
    s_waitcnt lgkmcnt(4)
    buffer_load_dwordx4 v225, s[64:67], s57 offen offset:3072 lds
    v_mfma_f32_16x16x32_bf16 v[60:63], v[100:103], a[16:19], v[60:63]
    ds_read_b64_tr_b16 v[116:117], v4 offset:20480
    v_mfma_f32_16x16x32_bf16 v[64:67], v[100:103], a[80:83], v[64:67]
    v_mfma_f32_16x16x32_bf16 v[68:71], v[100:103], a[144:147], v[68:71]
    s_add_u32 m0, s55, 32768
    ds_read_b64_tr_b16 v[118:119], v4 offset:20992
    v_mfma_f32_16x16x32_bf16 v[72:75], v[100:103], a[208:211], v[72:75]
    s_lshl_b32 s57, s49, 12
    v_mfma_f32_16x16x32_bf16 v[76:79], v[104:107], a[16:19], v[76:79]
    s_add_u32 s57, s57, s52
    ds_read_b64_tr_b16 v[120:121], v5 offset:20480
    v_mfma_f32_16x16x32_bf16 v[80:83], v[104:107], a[80:83], v[80:83]
    v_mfma_f32_16x16x32_bf16 v[84:87], v[104:107], a[144:147], v[84:87]
    ds_read_b64_tr_b16 v[122:123], v5 offset:20992
    v_mfma_f32_16x16x32_bf16 v[88:91], v[104:107], a[208:211], v[88:91]
    s_waitcnt lgkmcnt(4)
    v_mfma_f32_16x16x32_bf16 v[28:31], v[108:111], a[20:23], v[28:31]
    ds_read_b64_tr_b16 v[92:93], v2 offset:24576
    v_mfma_f32_16x16x32_bf16 v[32:35], v[108:111], a[84:87], v[32:35]
    buffer_load_dwordx4 v252, s[68:71], s57 offen offset:0 lds
    v_mfma_f32_16x16x32_bf16 v[36:39], v[108:111], a[148:151], v[36:39]
    ds_read_b64_tr_b16 v[94:95], v2 offset:25088
    v_mfma_f32_16x16x32_bf16 v[40:43], v[108:111], a[212:215], v[40:43]
    v_mfma_f32_16x16x32_bf16 v[44:47], v[112:115], a[20:23], v[44:47]
    ds_read_b64_tr_b16 v[96:97], v3 offset:24576
    v_mfma_f32_16x16x32_bf16 v[48:51], v[112:115], a[84:87], v[48:51]
    v_mfma_f32_16x16x32_bf16 v[52:55], v[112:115], a[148:151], v[52:55]
    ds_read_b64_tr_b16 v[98:99], v3 offset:25088
    v_mfma_f32_16x16x32_bf16 v[56:59], v[112:115], a[212:215], v[56:59]
    s_waitcnt lgkmcnt(4)
    buffer_load_dwordx4 v253, s[68:71], s57 offen offset:1024 lds
    v_mfma_f32_16x16x32_bf16 v[60:63], v[116:119], a[20:23], v[60:63]
    ds_read_b64_tr_b16 v[100:101], v4 offset:24576
    v_mfma_f32_16x16x32_bf16 v[64:67], v[116:119], a[84:87], v[64:67]
    v_mfma_f32_16x16x32_bf16 v[68:71], v[116:119], a[148:151], v[68:71]
    ds_read_b64_tr_b16 v[102:103], v4 offset:25088
    v_mfma_f32_16x16x32_bf16 v[72:75], v[116:119], a[212:215], v[72:75]
    v_mfma_f32_16x16x32_bf16 v[76:79], v[120:123], a[20:23], v[76:79]
    ds_read_b64_tr_b16 v[104:105], v5 offset:24576
    v_mfma_f32_16x16x32_bf16 v[80:83], v[120:123], a[84:87], v[80:83]
    v_mfma_f32_16x16x32_bf16 v[84:87], v[120:123], a[148:151], v[84:87]
    ds_read_b64_tr_b16 v[106:107], v5 offset:25088
    v_mfma_f32_16x16x32_bf16 v[88:91], v[120:123], a[212:215], v[88:91]
    s_waitcnt lgkmcnt(4)
    buffer_load_dwordx4 v254, s[68:71], s57 offen offset:2048 lds
    v_mfma_f32_16x16x32_bf16 v[28:31], v[92:95], a[24:27], v[28:31]
    ds_read_b64_tr_b16 v[108:109], v2 offset:28672
    v_mfma_f32_16x16x32_bf16 v[32:35], v[92:95], a[88:91], v[32:35]
    v_mfma_f32_16x16x32_bf16 v[36:39], v[92:95], a[152:155], v[36:39]
    ds_read_b64_tr_b16 v[110:111], v2 offset:29184
    v_mfma_f32_16x16x32_bf16 v[40:43], v[92:95], a[216:219], v[40:43]
    v_mfma_f32_16x16x32_bf16 v[44:47], v[96:99], a[24:27], v[44:47]
    ds_read_b64_tr_b16 v[112:113], v3 offset:28672
    v_mfma_f32_16x16x32_bf16 v[48:51], v[96:99], a[88:91], v[48:51]
    v_mfma_f32_16x16x32_bf16 v[52:55], v[96:99], a[152:155], v[52:55]
    ds_read_b64_tr_b16 v[114:115], v3 offset:29184
    v_mfma_f32_16x16x32_bf16 v[56:59], v[96:99], a[216:219], v[56:59]
    s_waitcnt lgkmcnt(4)
    buffer_load_dwordx4 v255, s[68:71], s57 offen offset:3072 lds
    v_mfma_f32_16x16x32_bf16 v[60:63], v[100:103], a[24:27], v[60:63]
    ds_read_b64_tr_b16 v[116:117], v4 offset:28672
    v_mfma_f32_16x16x32_bf16 v[64:67], v[100:103], a[88:91], v[64:67]
    v_mfma_f32_16x16x32_bf16 v[68:71], v[100:103], a[152:155], v[68:71]
    s_add_u32 m0, s55, 49152
    ds_read_b64_tr_b16 v[118:119], v4 offset:29184
    v_mfma_f32_16x16x32_bf16 v[72:75], v[100:103], a[216:219], v[72:75]
    s_add_u32 s49, s53, 128
    v_mfma_f32_16x16x32_bf16 v[76:79], v[104:107], a[24:27], v[76:79]
    s_and_b32 s49, s49, 1023
    ds_read_b64_tr_b16 v[120:121], v5 offset:28672
    v_mfma_f32_16x16x32_bf16 v[80:83], v[104:107], a[88:91], v[80:83]
    s_lshl_b32 s57, s49, 12
    v_mfma_f32_16x16x32_bf16 v[84:87], v[104:107], a[152:155], v[84:87]
    s_add_u32 s57, s57, s52
    ds_read_b64_tr_b16 v[122:123], v5 offset:29184
    v_mfma_f32_16x16x32_bf16 v[88:91], v[104:107], a[216:219], v[88:91]
    s_waitcnt lgkmcnt(4)
    v_mfma_f32_16x16x32_bf16 v[28:31], v[108:111], a[28:31], v[28:31]
    ds_read_b64_tr_b16 v[92:93], v2 offset:32768
    v_mfma_f32_16x16x32_bf16 v[32:35], v[108:111], a[92:95], v[32:35]
    buffer_load_dwordx4 v252, s[68:71], s57 offen offset:0 lds
    v_mfma_f32_16x16x32_bf16 v[36:39], v[108:111], a[156:159], v[36:39]
    ds_read_b64_tr_b16 v[94:95], v2 offset:33280
    v_mfma_f32_16x16x32_bf16 v[40:43], v[108:111], a[220:223], v[40:43]
    v_mfma_f32_16x16x32_bf16 v[44:47], v[112:115], a[28:31], v[44:47]
    ds_read_b64_tr_b16 v[96:97], v3 offset:32768
    v_mfma_f32_16x16x32_bf16 v[48:51], v[112:115], a[92:95], v[48:51]
    v_mfma_f32_16x16x32_bf16 v[52:55], v[112:115], a[156:159], v[52:55]
    ds_read_b64_tr_b16 v[98:99], v3 offset:33280
    v_mfma_f32_16x16x32_bf16 v[56:59], v[112:115], a[220:223], v[56:59]
    s_waitcnt lgkmcnt(4)
    buffer_load_dwordx4 v253, s[68:71], s57 offen offset:1024 lds
    v_mfma_f32_16x16x32_bf16 v[60:63], v[116:119], a[28:31], v[60:63]
    ds_read_b64_tr_b16 v[100:101], v4 offset:32768
    v_mfma_f32_16x16x32_bf16 v[64:67], v[116:119], a[92:95], v[64:67]
    v_mfma_f32_16x16x32_bf16 v[68:71], v[116:119], a[156:159], v[68:71]
    ds_read_b64_tr_b16 v[102:103], v4 offset:33280
    v_mfma_f32_16x16x32_bf16 v[72:75], v[116:119], a[220:223], v[72:75]
    v_mfma_f32_16x16x32_bf16 v[76:79], v[120:123], a[28:31], v[76:79]
    ds_read_b64_tr_b16 v[104:105], v5 offset:32768
    v_mfma_f32_16x16x32_bf16 v[80:83], v[120:123], a[92:95], v[80:83]
    v_mfma_f32_16x16x32_bf16 v[84:87], v[120:123], a[156:159], v[84:87]
    ds_read_b64_tr_b16 v[106:107], v5 offset:33280
    v_mfma_f32_16x16x32_bf16 v[88:91], v[120:123], a[220:223], v[88:91]
    s_waitcnt lgkmcnt(4)
    buffer_load_dwordx4 v254, s[68:71], s57 offen offset:2048 lds
    v_mfma_f32_16x16x32_bf16 v[28:31], v[92:95], a[32:35], v[28:31]
    ds_read_b64_tr_b16 v[108:109], v2 offset:36864
    v_mfma_f32_16x16x32_bf16 v[32:35], v[92:95], a[96:99], v[32:35]
    v_mfma_f32_16x16x32_bf16 v[36:39], v[92:95], a[160:163], v[36:39]
    ds_read_b64_tr_b16 v[110:111], v2 offset:37376
    v_mfma_f32_16x16x32_bf16 v[40:43], v[92:95], a[224:227], v[40:43]
    v_mfma_f32_16x16x32_bf16 v[44:47], v[96:99], a[32:35], v[44:47]
    ds_read_b64_tr_b16 v[112:113], v3 offset:36864
    v_mfma_f32_16x16x32_bf16 v[48:51], v[96:99], a[96:99], v[48:51]
    v_mfma_f32_16x16x32_bf16 v[52:55], v[96:99], a[160:163], v[52:55]
    ds_read_b64_tr_b16 v[114:115], v3 offset:37376
    v_mfma_f32_16x16x32_bf16 v[56:59], v[96:99], a[224:227], v[56:59]
    s_waitcnt lgkmcnt(4)
    buffer_load_dwordx4 v255, s[68:71], s57 offen offset:3072 lds
    v_mfma_f32_16x16x32_bf16 v[60:63], v[100:103], a[32:35], v[60:63]
    ds_read_b64_tr_b16 v[116:117], v4 offset:36864
    v_mfma_f32_16x16x32_bf16 v[64:67], v[100:103], a[96:99], v[64:67]
    v_mfma_f32_16x16x32_bf16 v[68:71], v[100:103], a[160:163], v[68:71]
    ds_read_b64_tr_b16 v[118:119], v4 offset:37376
    v_mfma_f32_16x16x32_bf16 v[72:75], v[100:103], a[224:227], v[72:75]
    v_mfma_f32_16x16x32_bf16 v[76:79], v[104:107], a[32:35], v[76:79]
    ds_read_b64_tr_b16 v[120:121], v5 offset:36864
    v_mfma_f32_16x16x32_bf16 v[80:83], v[104:107], a[96:99], v[80:83]
    v_mfma_f32_16x16x32_bf16 v[84:87], v[104:107], a[160:163], v[84:87]
    ds_read_b64_tr_b16 v[122:123], v5 offset:37376
    v_mfma_f32_16x16x32_bf16 v[88:91], v[104:107], a[224:227], v[88:91]
    s_waitcnt lgkmcnt(4)
    v_mfma_f32_16x16x32_bf16 v[28:31], v[108:111], a[36:39], v[28:31]
    ds_read_b64_tr_b16 v[92:93], v2 offset:40960
    v_mfma_f32_16x16x32_bf16 v[32:35], v[108:111], a[100:103], v[32:35]
    buffer_store_dwordx4 v[124:127], v18, s[16:19], s23 offen offset:0 sc1
    v_mfma_f32_16x16x32_bf16 v[36:39], v[108:111], a[164:167], v[36:39]
    ds_read_b64_tr_b16 v[94:95], v2 offset:41472
    v_mfma_f32_16x16x32_bf16 v[40:43], v[108:111], a[228:231], v[40:43]
    v_mfma_f32_16x16x32_bf16 v[44:47], v[112:115], a[36:39], v[44:47]
    ds_read_b64_tr_b16 v[96:97], v3 offset:40960
    v_mfma_f32_16x16x32_bf16 v[48:51], v[112:115], a[100:103], v[48:51]
    v_mfma_f32_16x16x32_bf16 v[52:55], v[112:115], a[164:167], v[52:55]
    ds_read_b64_tr_b16 v[98:99], v3 offset:41472
    v_mfma_f32_16x16x32_bf16 v[56:59], v[112:115], a[228:231], v[56:59]
    s_waitcnt lgkmcnt(4)
    v_mfma_f32_16x16x32_bf16 v[60:63], v[116:119], a[36:39], v[60:63]
    ds_read_b64_tr_b16 v[100:101], v4 offset:40960
    v_mfma_f32_16x16x32_bf16 v[64:67], v[116:119], a[100:103], v[64:67]
    v_mfma_f32_16x16x32_bf16 v[68:71], v[116:119], a[164:167], v[68:71]
    ds_read_b64_tr_b16 v[102:103], v4 offset:41472
    v_mfma_f32_16x16x32_bf16 v[72:75], v[116:119], a[228:231], v[72:75]
    v_mfma_f32_16x16x32_bf16 v[76:79], v[120:123], a[36:39], v[76:79]
    ds_read_b64_tr_b16 v[104:105], v5 offset:40960
    v_mfma_f32_16x16x32_bf16 v[80:83], v[120:123], a[100:103], v[80:83]
    buffer_store_dwordx4 v[128:131], v18, s[16:19], s23 offen offset:1024 sc1
    v_mfma_f32_16x16x32_bf16 v[84:87], v[120:123], a[164:167], v[84:87]
    ds_read_b64_tr_b16 v[106:107], v5 offset:41472
    v_mfma_f32_16x16x32_bf16 v[88:91], v[120:123], a[228:231], v[88:91]
    s_waitcnt lgkmcnt(4)
    v_mfma_f32_16x16x32_bf16 v[28:31], v[92:95], a[40:43], v[28:31]
    ds_read_b64_tr_b16 v[108:109], v2 offset:45056
    v_mfma_f32_16x16x32_bf16 v[32:35], v[92:95], a[104:107], v[32:35]
    v_mfma_f32_16x16x32_bf16 v[36:39], v[92:95], a[168:171], v[36:39]
    ds_read_b64_tr_b16 v[110:111], v2 offset:45568
    v_mfma_f32_16x16x32_bf16 v[40:43], v[92:95], a[232:235], v[40:43]
    v_mfma_f32_16x16x32_bf16 v[44:47], v[96:99], a[40:43], v[44:47]
    ds_read_b64_tr_b16 v[112:113], v3 offset:45056
    v_mfma_f32_16x16x32_bf16 v[48:51], v[96:99], a[104:107], v[48:51]
    v_mfma_f32_16x16x32_bf16 v[52:55], v[96:99], a[168:171], v[52:55]
    ds_read_b64_tr_b16 v[114:115], v3 offset:45568
    v_mfma_f32_16x16x32_bf16 v[56:59], v[96:99], a[232:235], v[56:59]
    s_waitcnt lgkmcnt(4)
    v_mfma_f32_16x16x32_bf16 v[60:63], v[100:103], a[40:43], v[60:63]
    ds_read_b64_tr_b16 v[116:117], v4 offset:45056
    v_mfma_f32_16x16x32_bf16 v[64:67], v[100:103], a[104:107], v[64:67]
    buffer_store_dwordx4 v[132:135], v19, s[16:19], s23 offen offset:0 sc1
    v_mfma_f32_16x16x32_bf16 v[68:71], v[100:103], a[168:171], v[68:71]
    ds_read_b64_tr_b16 v[118:119], v4 offset:45568
    v_mfma_f32_16x16x32_bf16 v[72:75], v[100:103], a[232:235], v[72:75]
    v_mfma_f32_16x16x32_bf16 v[76:79], v[104:107], a[40:43], v[76:79]
    ds_read_b64_tr_b16 v[120:121], v5 offset:45056
    v_mfma_f32_16x16x32_bf16 v[80:83], v[104:107], a[104:107], v[80:83]
    v_mfma_f32_16x16x32_bf16 v[84:87], v[104:107], a[168:171], v[84:87]
    ds_read_b64_tr_b16 v[122:123], v5 offset:45568
    v_mfma_f32_16x16x32_bf16 v[88:91], v[104:107], a[232:235], v[88:91]
    s_waitcnt lgkmcnt(4)
    v_mfma_f32_16x16x32_bf16 v[28:31], v[108:111], a[44:47], v[28:31]
    ds_read_b64_tr_b16 v[92:93], v2 offset:49152
    v_mfma_f32_16x16x32_bf16 v[32:35], v[108:111], a[108:111], v[32:35]
    v_mfma_f32_16x16x32_bf16 v[36:39], v[108:111], a[172:175], v[36:39]
    ds_read_b64_tr_b16 v[94:95], v2 offset:49664
    v_mfma_f32_16x16x32_bf16 v[40:43], v[108:111], a[236:239], v[40:43]
    v_mfma_f32_16x16x32_bf16 v[44:47], v[112:115], a[44:47], v[44:47]
    ds_read_b64_tr_b16 v[96:97], v3 offset:49152
    v_mfma_f32_16x16x32_bf16 v[48:51], v[112:115], a[108:111], v[48:51]
    buffer_store_dwordx4 v[136:139], v19, s[16:19], s23 offen offset:1024 sc1
    v_mfma_f32_16x16x32_bf16 v[52:55], v[112:115], a[172:175], v[52:55]
    ds_read_b64_tr_b16 v[98:99], v3 offset:49664
    v_mfma_f32_16x16x32_bf16 v[56:59], v[112:115], a[236:239], v[56:59]
    s_waitcnt lgkmcnt(4)
    v_mfma_f32_16x16x32_bf16 v[60:63], v[116:119], a[44:47], v[60:63]
    ds_read_b64_tr_b16 v[100:101], v4 offset:49152
    v_mfma_f32_16x16x32_bf16 v[64:67], v[116:119], a[108:111], v[64:67]
    v_mfma_f32_16x16x32_bf16 v[68:71], v[116:119], a[172:175], v[68:71]
    ds_read_b64_tr_b16 v[102:103], v4 offset:49664
    v_mfma_f32_16x16x32_bf16 v[72:75], v[116:119], a[236:239], v[72:75]
    v_mfma_f32_16x16x32_bf16 v[76:79], v[120:123], a[44:47], v[76:79]
    ds_read_b64_tr_b16 v[104:105], v5 offset:49152
    v_mfma_f32_16x16x32_bf16 v[80:83], v[120:123], a[108:111], v[80:83]
    v_mfma_f32_16x16x32_bf16 v[84:87], v[120:123], a[172:175], v[84:87]
    ds_read_b64_tr_b16 v[106:107], v5 offset:49664
    v_mfma_f32_16x16x32_bf16 v[88:91], v[120:123], a[236:239], v[88:91]
    s_waitcnt lgkmcnt(4)
    v_mfma_f32_16x16x32_bf16 v[28:31], v[92:95], a[48:51], v[28:31]
    ds_read_b64_tr_b16 v[108:109], v2 offset:53248
    v_mfma_f32_16x16x32_bf16 v[32:35], v[92:95], a[112:115], v[32:35]
    buffer_store_dwordx4 v[140:143], v20, s[16:19], s23 offen offset:0 sc1
    v_mfma_f32_16x16x32_bf16 v[36:39], v[92:95], a[176:179], v[36:39]
    ds_read_b64_tr_b16 v[110:111], v2 offset:53760
    v_mfma_f32_16x16x32_bf16 v[40:43], v[92:95], a[240:243], v[40:43]
    v_mfma_f32_16x16x32_bf16 v[44:47], v[96:99], a[48:51], v[44:47]
    ds_read_b64_tr_b16 v[112:113], v3 offset:53248
    v_mfma_f32_16x16x32_bf16 v[48:51], v[96:99], a[112:115], v[48:51]
    v_mfma_f32_16x16x32_bf16 v[52:55], v[96:99], a[176:179], v[52:55]
    ds_read_b64_tr_b16 v[114:115], v3 offset:53760
    v_mfma_f32_16x16x32_bf16 v[56:59], v[96:99], a[240:243], v[56:59]
    s_waitcnt lgkmcnt(4)
    v_mfma_f32_16x16x32_bf16 v[60:63], v[100:103], a[48:51], v[60:63]
    ds_read_b64_tr_b16 v[116:117], v4 offset:53248
    v_mfma_f32_16x16x32_bf16 v[64:67], v[100:103], a[112:115], v[64:67]
    v_mfma_f32_16x16x32_bf16 v[68:71], v[100:103], a[176:179], v[68:71]
    ds_read_b64_tr_b16 v[118:119], v4 offset:53760
    v_mfma_f32_16x16x32_bf16 v[72:75], v[100:103], a[240:243], v[72:75]
    v_mfma_f32_16x16x32_bf16 v[76:79], v[104:107], a[48:51], v[76:79]
    ds_read_b64_tr_b16 v[120:121], v5 offset:53248
    v_mfma_f32_16x16x32_bf16 v[80:83], v[104:107], a[112:115], v[80:83]
    buffer_store_dwordx4 v[144:147], v20, s[16:19], s23 offen offset:1024 sc1
    v_mfma_f32_16x16x32_bf16 v[84:87], v[104:107], a[176:179], v[84:87]
    ds_read_b64_tr_b16 v[122:123], v5 offset:53760
    v_mfma_f32_16x16x32_bf16 v[88:91], v[104:107], a[240:243], v[88:91]
    s_waitcnt lgkmcnt(4)
    v_mfma_f32_16x16x32_bf16 v[28:31], v[108:111], a[52:55], v[28:31]
    ds_read_b64_tr_b16 v[92:93], v2 offset:57344
    v_mfma_f32_16x16x32_bf16 v[32:35], v[108:111], a[116:119], v[32:35]
    v_mfma_f32_16x16x32_bf16 v[36:39], v[108:111], a[180:183], v[36:39]
    ds_read_b64_tr_b16 v[94:95], v2 offset:57856
    v_mfma_f32_16x16x32_bf16 v[40:43], v[108:111], a[244:247], v[40:43]
    v_mfma_f32_16x16x32_bf16 v[44:47], v[112:115], a[52:55], v[44:47]
    ds_read_b64_tr_b16 v[96:97], v3 offset:57344
    v_mfma_f32_16x16x32_bf16 v[48:51], v[112:115], a[116:119], v[48:51]
    v_mfma_f32_16x16x32_bf16 v[52:55], v[112:115], a[180:183], v[52:55]
    ds_read_b64_tr_b16 v[98:99], v3 offset:57856
    v_mfma_f32_16x16x32_bf16 v[56:59], v[112:115], a[244:247], v[56:59]
    s_waitcnt lgkmcnt(4)
    v_mfma_f32_16x16x32_bf16 v[60:63], v[116:119], a[52:55], v[60:63]
    ds_read_b64_tr_b16 v[100:101], v4 offset:57344
    v_mfma_f32_16x16x32_bf16 v[64:67], v[116:119], a[116:119], v[64:67]
    buffer_store_dwordx4 v[148:151], v21, s[16:19], s23 offen offset:0 sc1
    v_mfma_f32_16x16x32_bf16 v[68:71], v[116:119], a[180:183], v[68:71]
    ds_read_b64_tr_b16 v[102:103], v4 offset:57856
    v_mfma_f32_16x16x32_bf16 v[72:75], v[116:119], a[244:247], v[72:75]
    v_mfma_f32_16x16x32_bf16 v[76:79], v[120:123], a[52:55], v[76:79]
    ds_read_b64_tr_b16 v[104:105], v5 offset:57344
    v_mfma_f32_16x16x32_bf16 v[80:83], v[120:123], a[116:119], v[80:83]
    v_mfma_f32_16x16x32_bf16 v[84:87], v[120:123], a[180:183], v[84:87]
    ds_read_b64_tr_b16 v[106:107], v5 offset:57856
    v_mfma_f32_16x16x32_bf16 v[88:91], v[120:123], a[244:247], v[88:91]
    s_waitcnt lgkmcnt(4)
    v_mfma_f32_16x16x32_bf16 v[28:31], v[92:95], a[56:59], v[28:31]
    ds_read_b64_tr_b16 v[108:109], v2 offset:61440
    v_mfma_f32_16x16x32_bf16 v[32:35], v[92:95], a[120:123], v[32:35]
    v_mfma_f32_16x16x32_bf16 v[36:39], v[92:95], a[184:187], v[36:39]
    ds_read_b64_tr_b16 v[110:111], v2 offset:61952
    v_mfma_f32_16x16x32_bf16 v[40:43], v[92:95], a[248:251], v[40:43]
    v_mfma_f32_16x16x32_bf16 v[44:47], v[96:99], a[56:59], v[44:47]
    ds_read_b64_tr_b16 v[112:113], v3 offset:61440
    v_mfma_f32_16x16x32_bf16 v[48:51], v[96:99], a[120:123], v[48:51]
    buffer_store_dwordx4 v[152:155], v21, s[16:19], s23 offen offset:1024 sc1
    v_mfma_f32_16x16x32_bf16 v[52:55], v[96:99], a[184:187], v[52:55]
    ds_read_b64_tr_b16 v[114:115], v3 offset:61952
    v_mfma_f32_16x16x32_bf16 v[56:59], v[96:99], a[248:251], v[56:59]
    s_waitcnt lgkmcnt(4)
    v_mfma_f32_16x16x32_bf16 v[60:63], v[100:103], a[56:59], v[60:63]
    ds_read_b64_tr_b16 v[116:117], v4 offset:61440
    v_mfma_f32_16x16x32_bf16 v[64:67], v[100:103], a[120:123], v[64:67]
    v_mfma_f32_16x16x32_bf16 v[68:71], v[100:103], a[184:187], v[68:71]
    ds_read_b64_tr_b16 v[118:119], v4 offset:61952
    v_mfma_f32_16x16x32_bf16 v[72:75], v[100:103], a[248:251], v[72:75]
    v_mfma_f32_16x16x32_bf16 v[76:79], v[104:107], a[56:59], v[76:79]
    ds_read_b64_tr_b16 v[120:121], v5 offset:61440
    v_mfma_f32_16x16x32_bf16 v[80:83], v[104:107], a[120:123], v[80:83]
    v_mfma_f32_16x16x32_bf16 v[84:87], v[104:107], a[184:187], v[84:87]
    ds_read_b64_tr_b16 v[122:123], v5 offset:61952
    v_mfma_f32_16x16x32_bf16 v[88:91], v[104:107], a[248:251], v[88:91]
    s_waitcnt lgkmcnt(4)
    v_mfma_f32_16x16x32_bf16 v[28:31], v[108:111], a[60:63], v[28:31]
    v_mfma_f32_16x16x32_bf16 v[32:35], v[108:111], a[124:127], v[32:35]
    v_mfma_f32_16x16x32_bf16 v[36:39], v[108:111], a[188:191], v[36:39]
    v_mfma_f32_16x16x32_bf16 v[40:43], v[108:111], a[252:255], v[40:43]
    v_mfma_f32_16x16x32_bf16 v[44:47], v[112:115], a[60:63], v[44:47]
    v_mfma_f32_16x16x32_bf16 v[48:51], v[112:115], a[124:127], v[48:51]
    v_mfma_f32_16x16x32_bf16 v[52:55], v[112:115], a[188:191], v[52:55]
    v_mfma_f32_16x16x32_bf16 v[56:59], v[112:115], a[252:255], v[56:59]
    s_waitcnt lgkmcnt(0)
    v_mul_f32 v28, s34, v28
    v_mul_f32 v29, s34, v29
    v_mfma_f32_16x16x32_bf16 v[60:63], v[116:119], a[60:63], v[60:63]
    v_mul_f32 v30, s34, v30
    v_mul_f32 v31, s34, v31
    v_mfma_f32_16x16x32_bf16 v[64:67], v[116:119], a[124:127], v[64:67]
    v_cvt_pk_bf16_f32 v124, v28, v29
    v_cvt_pk_bf16_f32 v125, v30, v31
    v_mfma_f32_16x16x32_bf16 v[68:71], v[116:119], a[188:191], v[68:71]
    v_mul_f32 v32, s34, v32
    v_mul_f32 v33, s34, v33
    v_mfma_f32_16x16x32_bf16 v[72:75], v[116:119], a[252:255], v[72:75]
    v_mul_f32 v34, s34, v34
    v_mul_f32 v35, s34, v35
    v_mfma_f32_16x16x32_bf16 v[76:79], v[120:123], a[60:63], v[76:79]
    v_cvt_pk_bf16_f32 v132, v32, v33
    v_cvt_pk_bf16_f32 v133, v34, v35
    v_mfma_f32_16x16x32_bf16 v[80:83], v[120:123], a[124:127], v[80:83]
    v_mul_f32 v36, s34, v36
    v_mul_f32 v37, s34, v37
    v_mfma_f32_16x16x32_bf16 v[84:87], v[120:123], a[188:191], v[84:87]
    v_mul_f32 v38, s34, v38
    v_mul_f32 v39, s34, v39
    v_mfma_f32_16x16x32_bf16 v[88:91], v[120:123], a[252:255], v[88:91]
    v_cvt_pk_bf16_f32 v140, v36, v37
    v_cvt_pk_bf16_f32 v141, v38, v39
    v_pk_mul_f32 v[40:41], v[40:41], v[232:233]
    v_pk_mul_f32 v[42:43], v[42:43], v[232:233]
    v_cvt_pk_bf16_f32 v148, v40, v41
    v_cvt_pk_bf16_f32 v149, v42, v43
    v_pk_mul_f32 v[44:45], v[44:45], v[232:233]
    v_pk_mul_f32 v[46:47], v[46:47], v[232:233]
    v_cvt_pk_bf16_f32 v126, v44, v45
    v_cvt_pk_bf16_f32 v127, v46, v47
    v_pk_mul_f32 v[48:49], v[48:49], v[232:233]
    v_pk_mul_f32 v[50:51], v[50:51], v[232:233]
    v_cvt_pk_bf16_f32 v134, v48, v49
    v_cvt_pk_bf16_f32 v135, v50, v51
    v_pk_mul_f32 v[52:53], v[52:53], v[232:233]
    v_pk_mul_f32 v[54:55], v[54:55], v[232:233]
    v_cvt_pk_bf16_f32 v142, v52, v53
    v_cvt_pk_bf16_f32 v143, v54, v55
    v_pk_mul_f32 v[56:57], v[56:57], v[232:233]
    v_pk_mul_f32 v[58:59], v[58:59], v[232:233]
    v_cvt_pk_bf16_f32 v150, v56, v57
    v_cvt_pk_bf16_f32 v151, v58, v59
    v_pk_mul_f32 v[60:61], v[60:61], v[232:233]
    v_pk_mul_f32 v[62:63], v[62:63], v[232:233]
    v_cvt_pk_bf16_f32 v128, v60, v61
    v_cvt_pk_bf16_f32 v129, v62, v63
    v_pk_mul_f32 v[64:65], v[64:65], v[232:233]
    v_pk_mul_f32 v[66:67], v[66:67], v[232:233]
    v_cvt_pk_bf16_f32 v136, v64, v65
    v_cvt_pk_bf16_f32 v137, v66, v67
    v_pk_mul_f32 v[68:69], v[68:69], v[232:233]
    v_pk_mul_f32 v[70:71], v[70:71], v[232:233]
    v_cvt_pk_bf16_f32 v144, v68, v69
    v_cvt_pk_bf16_f32 v145, v70, v71
    v_pk_mul_f32 v[72:73], v[72:73], v[232:233]
    v_pk_mul_f32 v[74:75], v[74:75], v[232:233]
    v_cvt_pk_bf16_f32 v152, v72, v73
    v_cvt_pk_bf16_f32 v153, v74, v75
    v_pk_mul_f32 v[76:77], v[76:77], v[232:233]
    v_pk_mul_f32 v[78:79], v[78:79], v[232:233]
    v_cvt_pk_bf16_f32 v130, v76, v77
    v_cvt_pk_bf16_f32 v131, v78, v79
    v_pk_mul_f32 v[80:81], v[80:81], v[232:233]
    v_pk_mul_f32 v[82:83], v[82:83], v[232:233]
    v_cvt_pk_bf16_f32 v138, v80, v81
    v_cvt_pk_bf16_f32 v139, v82, v83
    v_pk_mul_f32 v[84:85], v[84:85], v[232:233]
    v_pk_mul_f32 v[86:87], v[86:87], v[232:233]
    v_cvt_pk_bf16_f32 v146, v84, v85
    v_cvt_pk_bf16_f32 v147, v86, v87
    v_pk_mul_f32 v[88:89], v[88:89], v[232:233]
    v_pk_mul_f32 v[90:91], v[90:91], v[232:233]
    v_cvt_pk_bf16_f32 v154, v88, v89
    v_cvt_pk_bf16_f32 v155, v90, v91
    s_waitcnt vmcnt(12)
L1K_fin:
    s_lshr_b32 s23, s31, 1
    s_lshl_b32 s23, s23, 20
    s_add_u32 s23, s23, s32
    s_and_b32 s33, s31, 1
    s_lshl_b32 s33, s33, 11
    s_add_u32 s23, s23, s33
    s_add_u32 s31, s31, 1
    buffer_store_dwordx4 v[124:127], v18, s[16:19], s23 offen offset:0 sc1
    buffer_store_dwordx4 v[128:131], v18, s[16:19], s23 offen offset:1024 sc1
    buffer_store_dwordx4 v[132:135], v19, s[16:19], s23 offen offset:0 sc1
    buffer_store_dwordx4 v[136:139], v19, s[16:19], s23 offen offset:1024 sc1
    buffer_store_dwordx4 v[140:143], v20, s[16:19], s23 offen offset:0 sc1
    buffer_store_dwordx4 v[144:147], v20, s[16:19], s23 offen offset:1024 sc1
    buffer_store_dwordx4 v[148:151], v21, s[16:19], s23 offen offset:0 sc1
    buffer_store_dwordx4 v[152:155], v21, s[16:19], s23 offen offset:1024 sc1
    s_mov_b32 s38, s36
    s_mov_b32 s39, s37
    s_mov_b32 s101, s30
    s_waitcnt lgkmcnt(0)
    s_barrier
    s_cmp_lg_u32 s59, 128
    s_cbranch_scc1 P2_q0
    s_branch P2_entry
L1_V:
    s_add_u32 s32, s32, 16384
    s_mov_b32 s34, 0x58800000
    v_mov_b32 v232, s34
    v_mov_b32 v233, s34
    s_waitcnt vmcnt(15)
    ds_read_b128 a[0:3], v14 offset:0
    ds_read_b128 a[64:67], v14 offset:2048
    ds_read_b128 a[128:131], v14 offset:4096
    ds_read_b128 a[192:195], v14 offset:6144
    ds_read_b128 a[4:7], v15 offset:0
    ds_read_b128 a[68:71], v15 offset:2048
    ds_read_b128 a[132:135], v15 offset:4096
    ds_read_b128 a[196:199], v15 offset:6144
    s_add_u32 m0, s27, 16384
    s_add_u32 s33, s56, 256
    s_and_b32 s33, s33, 1023
    s_add_u32 s33, s33, s28
    buffer_load_dwordx4 v10, s[8:11], s33 offen offset:0 lds
    buffer_load_dwordx4 v11, s[8:11], s33 offen offset:1024 lds
    buffer_load_dwordx4 v12, s[8:11], s33 offen offset:2048 lds
    buffer_load_dwordx4 v13, s[8:11], s33 offen offset:3072 lds
    s_add_u32 m0, s27, 20480
    s_add_u32 s33, s33, 32768
    buffer_load_dwordx4 v10, s[8:11], s33 offen offset:0 lds
    buffer_load_dwordx4 v11, s[8:11], s33 offen offset:1024 lds
    buffer_load_dwordx4 v12, s[8:11], s33 offen offset:2048 lds
    buffer_load_dwordx4 v13, s[8:11], s33 offen offset:3072 lds
    s_waitcnt vmcnt(19)
    s_barrier
    ds_read_b64_tr_b16 v[92:93], v2 offset:0
    ds_read_b64_tr_b16 v[94:95], v2 offset:512
    ds_read_b64_tr_b16 v[96:97], v3 offset:0
    ds_read_b64_tr_b16 v[98:99], v3 offset:512
    ds_read_b64_tr_b16 v[100:101], v4 offset:0
    ds_read_b64_tr_b16 v[102:103], v4 offset:512
    ds_read_b64_tr_b16 v[104:105], v5 offset:0
    ds_read_b64_tr_b16 v[106:107], v5 offset:512
    s_add_u32 m0, s26, 16384
    s_add_u32 s25, s21, s45
    buffer_load_dwordx4 v6, s[12:15], s25 offen offset:0 lds
    buffer_load_dwordx4 v7, s[12:15], s25 offen offset:1024 lds
    buffer_load_dwordx4 v8, s[12:15], s25 offen offset:2048 lds
    buffer_load_dwordx4 v9, s[12:15], s25 offen offset:3072 lds
    s_add_u32 m0, s26, 32768
    s_add_u32 s25, s21, s50
    buffer_load_dwordx4 v6, s[12:15], s25 offen offset:0 lds
    buffer_load_dwordx4 v7, s[12:15], s25 offen offset:1024 lds
    buffer_load_dwordx4 v8, s[12:15], s25 offen offset:2048 lds
    buffer_load_dwordx4 v9, s[12:15], s25 offen offset:3072 lds
    s_waitcnt lgkmcnt(4)
    v_mfma_f32_16x16x32_bf16 v[28:31], a[0:3], v[92:95], 0
    s_add_u32 m0, s27, 0
    s_add_u32 s33, s56, 384
    s_and_b32 s33, s33, 1023
    s_add_u32 s33, s33, s28
    ds_read_b64_tr_b16 v[108:109], v2 offset:4096
    v_mfma_f32_16x16x32_bf16 v[32:35], a[64:67], v[92:95], 0
    buffer_load_dwordx4 v10, s[8:11], s33 offen offset:0 lds
    v_mfma_f32_16x16x32_bf16 v[36:39], a[128:131], v[92:95], 0
    ds_read_b64_tr_b16 v[110:111], v2 offset:4608
    v_mfma_f32_16x16x32_bf16 v[40:43], a[192:195], v[92:95], 0
    buffer_load_dwordx4 v11, s[8:11], s33 offen offset:1024 lds
    buffer_load_dwordx4 v12, s[8:11], s33 offen offset:2048 lds
    v_mfma_f32_16x16x32_bf16 v[44:47], a[0:3], v[96:99], 0
    ds_read_b64_tr_b16 v[112:113], v3 offset:4096
    v_mfma_f32_16x16x32_bf16 v[48:51], a[64:67], v[96:99], 0
    buffer_load_dwordx4 v13, s[8:11], s33 offen offset:3072 lds
    v_mfma_f32_16x16x32_bf16 v[52:55], a[128:131], v[96:99], 0
    s_add_u32 m0, s27, 4096
    s_add_u32 s33, s33, 32768
    ds_read_b64_tr_b16 v[114:115], v3 offset:4608
    v_mfma_f32_16x16x32_bf16 v[56:59], a[192:195], v[96:99], 0
    s_waitcnt lgkmcnt(4)
    buffer_load_dwordx4 v10, s[8:11], s33 offen offset:0 lds
    v_mfma_f32_16x16x32_bf16 v[60:63], a[0:3], v[100:103], 0
    ds_read_b64_tr_b16 v[116:117], v4 offset:4096
    v_mfma_f32_16x16x32_bf16 v[64:67], a[64:67], v[100:103], 0
    buffer_load_dwordx4 v11, s[8:11], s33 offen offset:1024 lds
    buffer_load_dwordx4 v12, s[8:11], s33 offen offset:2048 lds
    v_mfma_f32_16x16x32_bf16 v[68:71], a[128:131], v[100:103], 0
    ds_read_b64_tr_b16 v[118:119], v4 offset:4608
    v_mfma_f32_16x16x32_bf16 v[72:75], a[192:195], v[100:103], 0
    buffer_load_dwordx4 v13, s[8:11], s33 offen offset:3072 lds
    v_mfma_f32_16x16x32_bf16 v[76:79], a[0:3], v[104:107], 0
    ds_read_b64_tr_b16 v[120:121], v5 offset:4096
    v_mfma_f32_16x16x32_bf16 v[80:83], a[64:67], v[104:107], 0
    v_mfma_f32_16x16x32_bf16 v[84:87], a[128:131], v[104:107], 0
    ds_read_b64_tr_b16 v[122:123], v5 offset:4608
    v_mfma_f32_16x16x32_bf16 v[88:91], a[192:195], v[104:107], 0
    s_waitcnt lgkmcnt(4)
    v_mfma_f32_16x16x32_bf16 v[28:31], a[4:7], v[108:111], v[28:31]
    ds_read_b64_tr_b16 v[92:93], v2 offset:8192
    v_mfma_f32_16x16x32_bf16 v[32:35], a[68:71], v[108:111], v[32:35]
    s_waitcnt vmcnt(27)
    v_mfma_f32_16x16x32_bf16 v[36:39], a[132:135], v[108:111], v[36:39]
    ds_read_b64_tr_b16 v[94:95], v2 offset:8704
    ds_read_b128 a[8:11], v14 offset:8192
    v_mfma_f32_16x16x32_bf16 v[40:43], a[196:199], v[108:111], v[40:43]
    v_mfma_f32_16x16x32_bf16 v[44:47], a[4:7], v[112:115], v[44:47]
    ds_read_b64_tr_b16 v[96:97], v3 offset:8192
    ds_read_b128 a[72:75], v14 offset:10240
    v_mfma_f32_16x16x32_bf16 v[48:51], a[68:71], v[112:115], v[48:51]
    v_mfma_f32_16x16x32_bf16 v[52:55], a[132:135], v[112:115], v[52:55]
    ds_read_b64_tr_b16 v[98:99], v3 offset:8704
    ds_read_b128 a[136:139], v14 offset:12288
    v_mfma_f32_16x16x32_bf16 v[56:59], a[196:199], v[112:115], v[56:59]
    s_waitcnt lgkmcnt(7)
    v_mfma_f32_16x16x32_bf16 v[60:63], a[4:7], v[116:119], v[60:63]
    ds_read_b128 a[200:203], v14 offset:14336
    ds_read_b64_tr_b16 v[100:101], v4 offset:8192
    v_mfma_f32_16x16x32_bf16 v[64:67], a[68:71], v[116:119], v[64:67]
    ds_read_b128 a[12:15], v15 offset:8192
    v_mfma_f32_16x16x32_bf16 v[68:71], a[132:135], v[116:119], v[68:71]
    ds_read_b128 a[76:79], v15 offset:10240
    ds_read_b64_tr_b16 v[102:103], v4 offset:8704
    v_mfma_f32_16x16x32_bf16 v[72:75], a[196:199], v[116:119], v[72:75]
    ds_read_b128 a[140:143], v15 offset:12288
    v_mfma_f32_16x16x32_bf16 v[76:79], a[4:7], v[120:123], v[76:79]
    ds_read_b128 a[204:207], v15 offset:14336
    ds_read_b64_tr_b16 v[104:105], v5 offset:8192
    v_mfma_f32_16x16x32_bf16 v[80:83], a[68:71], v[120:123], v[80:83]
    v_mfma_f32_16x16x32_bf16 v[84:87], a[132:135], v[120:123], v[84:87]
    ds_read_b64_tr_b16 v[106:107], v5 offset:8704
    v_mfma_f32_16x16x32_bf16 v[88:91], a[196:199], v[120:123], v[88:91]
    s_waitcnt lgkmcnt(2)
    v_mfma_f32_16x16x32_bf16 v[28:31], a[8:11], v[92:95], v[28:31]
    s_add_u32 m0, s27, 8192
    s_add_u32 s33, s56, 512
    s_and_b32 s33, s33, 1023
    s_add_u32 s33, s33, s28
    ds_read_b64_tr_b16 v[108:109], v2 offset:12288
    v_mfma_f32_16x16x32_bf16 v[32:35], a[72:75], v[92:95], v[32:35]
    buffer_load_dwordx4 v10, s[8:11], s33 offen offset:0 lds
    v_mfma_f32_16x16x32_bf16 v[36:39], a[136:139], v[92:95], v[36:39]
    ds_read_b64_tr_b16 v[110:111], v2 offset:12800
    v_mfma_f32_16x16x32_bf16 v[40:43], a[200:203], v[92:95], v[40:43]
    buffer_load_dwordx4 v11, s[8:11], s33 offen offset:1024 lds
    buffer_load_dwordx4 v12, s[8:11], s33 offen offset:2048 lds
    v_mfma_f32_16x16x32_bf16 v[44:47], a[8:11], v[96:99], v[44:47]
    ds_read_b64_tr_b16 v[112:113], v3 offset:12288
    v_mfma_f32_16x16x32_bf16 v[48:51], a[72:75], v[96:99], v[48:51]
    buffer_load_dwordx4 v13, s[8:11], s33 offen offset:3072 lds
    v_mfma_f32_16x16x32_bf16 v[52:55], a[136:139], v[96:99], v[52:55]
    s_add_u32 m0, s27, 12288
    s_add_u32 s33, s33, 32768
    ds_read_b64_tr_b16 v[114:115], v3 offset:12800
    v_mfma_f32_16x16x32_bf16 v[56:59], a[200:203], v[96:99], v[56:59]
    s_waitcnt lgkmcnt(4)
    buffer_load_dwordx4 v10, s[8:11], s33 offen offset:0 lds
    v_mfma_f32_16x16x32_bf16 v[60:63], a[8:11], v[100:103], v[60:63]
    ds_read_b64_tr_b16 v[116:117], v4 offset:12288
    v_mfma_f32_16x16x32_bf16 v[64:67], a[72:75], v[100:103], v[64:67]
    buffer_load_dwordx4 v11, s[8:11], s33 offen offset:1024 lds
    buffer_load_dwordx4 v12, s[8:11], s33 offen offset:2048 lds
    v_mfma_f32_16x16x32_bf16 v[68:71], a[136:139], v[100:103], v[68:71]
    ds_read_b64_tr_b16 v[118:119], v4 offset:12800
    v_mfma_f32_16x16x32_bf16 v[72:75], a[200:203], v[100:103], v[72:75]
    buffer_load_dwordx4 v13, s[8:11], s33 offen offset:3072 lds
    v_mfma_f32_16x16x32_bf16 v[76:79], a[8:11], v[104:107], v[76:79]
    s_add_u32 m0, s26, 49152
    ds_read_b64_tr_b16 v[120:121], v5 offset:12288
    v_mfma_f32_16x16x32_bf16 v[80:83], a[72:75], v[104:107], v[80:83]
    s_add_u32 s25, s21, s51
    v_mfma_f32_16x16x32_bf16 v[84:87], a[136:139], v[104:107], v[84:87]
    s_waitcnt vmcnt(20)
    ds_read_b64_tr_b16 v[122:123], v5 offset:12800
    v_mfma_f32_16x16x32_bf16 v[88:91], a[200:203], v[104:107], v[88:91]
    s_waitcnt lgkmcnt(4)
    v_mfma_f32_16x16x32_bf16 v[28:31], a[12:15], v[108:111], v[28:31]
    s_barrier
    ds_read_b64_tr_b16 v[92:93], v2 offset:16384
    v_mfma_f32_16x16x32_bf16 v[32:35], a[76:79], v[108:111], v[32:35]
    buffer_load_dwordx4 v6, s[12:15], s25 offen offset:0 lds
    v_mfma_f32_16x16x32_bf16 v[36:39], a[140:143], v[108:111], v[36:39]
    ds_read_b64_tr_b16 v[94:95], v2 offset:16896
    ds_read_b128 a[16:19], v14 offset:16384
    v_mfma_f32_16x16x32_bf16 v[40:43], a[204:207], v[108:111], v[40:43]
    buffer_load_dwordx4 v7, s[12:15], s25 offen offset:1024 lds
    v_mfma_f32_16x16x32_bf16 v[44:47], a[12:15], v[112:115], v[44:47]
    ds_read_b64_tr_b16 v[96:97], v3 offset:16384
    ds_read_b128 a[80:83], v14 offset:18432
    v_mfma_f32_16x16x32_bf16 v[48:51], a[76:79], v[112:115], v[48:51]
    buffer_load_dwordx4 v8, s[12:15], s25 offen offset:2048 lds
    v_mfma_f32_16x16x32_bf16 v[52:55], a[140:143], v[112:115], v[52:55]
    ds_read_b64_tr_b16 v[98:99], v3 offset:16896
    ds_read_b128 a[144:147], v14 offset:20480
    v_mfma_f32_16x16x32_bf16 v[56:59], a[204:207], v[112:115], v[56:59]
    s_waitcnt lgkmcnt(7)
    buffer_load_dwordx4 v9, s[12:15], s25 offen offset:3072 lds
    v_mfma_f32_16x16x32_bf16 v[60:63], a[12:15], v[116:119], v[60:63]
    ds_read_b128 a[208:211], v14 offset:22528
    ds_read_b64_tr_b16 v[100:101], v4 offset:16384
    v_mfma_f32_16x16x32_bf16 v[64:67], a[76:79], v[116:119], v[64:67]
    ds_read_b128 a[20:23], v15 offset:16384
    v_mfma_f32_16x16x32_bf16 v[68:71], a[140:143], v[116:119], v[68:71]
    ds_read_b128 a[84:87], v15 offset:18432
    ds_read_b64_tr_b16 v[102:103], v4 offset:16896
    v_mfma_f32_16x16x32_bf16 v[72:75], a[204:207], v[116:119], v[72:75]
    ds_read_b128 a[148:151], v15 offset:20480
    v_mfma_f32_16x16x32_bf16 v[76:79], a[12:15], v[120:123], v[76:79]
    ds_read_b128 a[212:215], v15 offset:22528
    ds_read_b64_tr_b16 v[104:105], v5 offset:16384
    v_mfma_f32_16x16x32_bf16 v[80:83], a[76:79], v[120:123], v[80:83]
    v_mfma_f32_16x16x32_bf16 v[84:87], a[140:143], v[120:123], v[84:87]
    ds_read_b64_tr_b16 v[106:107], v5 offset:16896
    v_mfma_f32_16x16x32_bf16 v[88:91], a[204:207], v[120:123], v[88:91]
    s_waitcnt lgkmcnt(2)
    v_mfma_f32_16x16x32_bf16 v[28:31], a[16:19], v[92:95], v[28:31]
    s_add_u32 m0, s27, 16384
    s_add_u32 s33, s56, 640
    s_and_b32 s33, s33, 1023
    s_add_u32 s33, s33, s28
    ds_read_b64_tr_b16 v[108:109], v2 offset:20480
    v_mfma_f32_16x16x32_bf16 v[32:35], a[80:83], v[92:95], v[32:35]
    buffer_load_dwordx4 v10, s[8:11], s33 offen offset:0 lds
    v_mfma_f32_16x16x32_bf16 v[36:39], a[144:147], v[92:95], v[36:39]
    ds_read_b64_tr_b16 v[110:111], v2 offset:20992
    v_mfma_f32_16x16x32_bf16 v[40:43], a[208:211], v[92:95], v[40:43]
    buffer_load_dwordx4 v11, s[8:11], s33 offen offset:1024 lds
    buffer_load_dwordx4 v12, s[8:11], s33 offen offset:2048 lds
    v_mfma_f32_16x16x32_bf16 v[44:47], a[16:19], v[96:99], v[44:47]
    ds_read_b64_tr_b16 v[112:113], v3 offset:20480
    v_mfma_f32_16x16x32_bf16 v[48:51], a[80:83], v[96:99], v[48:51]
    buffer_load_dwordx4 v13, s[8:11], s33 offen offset:3072 lds
    v_mfma_f32_16x16x32_bf16 v[52:55], a[144:147], v[96:99], v[52:55]
    s_add_u32 m0, s27, 20480
    s_add_u32 s33, s33, 32768
    ds_read_b64_tr_b16 v[114:115], v3 offset:20992
    v_mfma_f32_16x16x32_bf16 v[56:59], a[208:211], v[96:99], v[56:59]
    s_waitcnt lgkmcnt(4)
    buffer_load_dwordx4 v10, s[8:11], s33 offen offset:0 lds
    v_mfma_f32_16x16x32_bf16 v[60:63], a[16:19], v[100:103], v[60:63]
    ds_read_b64_tr_b16 v[116:117], v4 offset:20480
    v_mfma_f32_16x16x32_bf16 v[64:67], a[80:83], v[100:103], v[64:67]
    buffer_load_dwordx4 v11, s[8:11], s33 offen offset:1024 lds
    buffer_load_dwordx4 v12, s[8:11], s33 offen offset:2048 lds
    v_mfma_f32_16x16x32_bf16 v[68:71], a[144:147], v[100:103], v[68:71]
    ds_read_b64_tr_b16 v[118:119], v4 offset:20992
    v_mfma_f32_16x16x32_bf16 v[72:75], a[208:211], v[100:103], v[72:75]
    buffer_load_dwordx4 v13, s[8:11], s33 offen offset:3072 lds
    v_mfma_f32_16x16x32_bf16 v[76:79], a[16:19], v[104:107], v[76:79]
    ds_read_b64_tr_b16 v[120:121], v5 offset:20480
    v_mfma_f32_16x16x32_bf16 v[80:83], a[80:83], v[104:107], v[80:83]
    v_mfma_f32_16x16x32_bf16 v[84:87], a[144:147], v[104:107], v[84:87]
    ds_read_b64_tr_b16 v[122:123], v5 offset:20992
    v_mfma_f32_16x16x32_bf16 v[88:91], a[208:211], v[104:107], v[88:91]
    s_waitcnt lgkmcnt(4)
    v_mfma_f32_16x16x32_bf16 v[28:31], a[20:23], v[108:111], v[28:31]
    ds_read_b64_tr_b16 v[92:93], v2 offset:24576
    v_mfma_f32_16x16x32_bf16 v[32:35], a[84:87], v[108:111], v[32:35]
    s_waitcnt vmcnt(20)
    v_mfma_f32_16x16x32_bf16 v[36:39], a[148:151], v[108:111], v[36:39]
    ds_read_b64_tr_b16 v[94:95], v2 offset:25088
    ds_read_b128 a[24:27], v14 offset:0
    v_mfma_f32_16x16x32_bf16 v[40:43], a[212:215], v[108:111], v[40:43]
    v_mfma_f32_16x16x32_bf16 v[44:47], a[20:23], v[112:115], v[44:47]
    ds_read_b64_tr_b16 v[96:97], v3 offset:24576
    ds_read_b128 a[88:91], v14 offset:2048
    v_mfma_f32_16x16x32_bf16 v[48:51], a[84:87], v[112:115], v[48:51]
    v_mfma_f32_16x16x32_bf16 v[52:55], a[148:151], v[112:115], v[52:55]
    ds_read_b64_tr_b16 v[98:99], v3 offset:25088
    ds_read_b128 a[152:155], v14 offset:4096
    v_mfma_f32_16x16x32_bf16 v[56:59], a[212:215], v[112:115], v[56:59]
    s_waitcnt lgkmcnt(7)
    v_mfma_f32_16x16x32_bf16 v[60:63], a[20:23], v[116:119], v[60:63]
    ds_read_b128 a[216:219], v14 offset:6144
    ds_read_b64_tr_b16 v[100:101], v4 offset:24576
    v_mfma_f32_16x16x32_bf16 v[64:67], a[84:87], v[116:119], v[64:67]
    ds_read_b128 a[28:31], v15 offset:0
    v_mfma_f32_16x16x32_bf16 v[68:71], a[148:151], v[116:119], v[68:71]
    ds_read_b128 a[92:95], v15 offset:2048
    ds_read_b64_tr_b16 v[102:103], v4 offset:25088
    v_mfma_f32_16x16x32_bf16 v[72:75], a[212:215], v[116:119], v[72:75]
    ds_read_b128 a[156:159], v15 offset:4096
    v_mfma_f32_16x16x32_bf16 v[76:79], a[20:23], v[120:123], v[76:79]
    ds_read_b128 a[220:223], v15 offset:6144
    ds_read_b64_tr_b16 v[104:105], v5 offset:24576
    v_mfma_f32_16x16x32_bf16 v[80:83], a[84:87], v[120:123], v[80:83]
    v_mfma_f32_16x16x32_bf16 v[84:87], a[148:151], v[120:123], v[84:87]
    ds_read_b64_tr_b16 v[106:107], v5 offset:25088
    v_mfma_f32_16x16x32_bf16 v[88:91], a[212:215], v[120:123], v[88:91]
    s_waitcnt lgkmcnt(2)
    v_mfma_f32_16x16x32_bf16 v[28:31], a[24:27], v[92:95], v[28:31]
    s_add_u32 m0, s27, 0
    s_add_u32 s33, s56, 768
    s_and_b32 s33, s33, 1023
    s_add_u32 s33, s33, s28
    ds_read_b64_tr_b16 v[108:109], v2 offset:28672
    v_mfma_f32_16x16x32_bf16 v[32:35], a[88:91], v[92:95], v[32:35]
    buffer_load_dwordx4 v10, s[8:11], s33 offen offset:0 lds
    v_mfma_f32_16x16x32_bf16 v[36:39], a[152:155], v[92:95], v[36:39]
    ds_read_b64_tr_b16 v[110:111], v2 offset:29184
    v_mfma_f32_16x16x32_bf16 v[40:43], a[216:219], v[92:95], v[40:43]
    buffer_load_dwordx4 v11, s[8:11], s33 offen offset:1024 lds
    buffer_load_dwordx4 v12, s[8:11], s33 offen offset:2048 lds
    v_mfma_f32_16x16x32_bf16 v[44:47], a[24:27], v[96:99], v[44:47]
    ds_read_b64_tr_b16 v[112:113], v3 offset:28672
    v_mfma_f32_16x16x32_bf16 v[48:51], a[88:91], v[96:99], v[48:51]
    buffer_load_dwordx4 v13, s[8:11], s33 offen offset:3072 lds
    v_mfma_f32_16x16x32_bf16 v[52:55], a[152:155], v[96:99], v[52:55]
    s_add_u32 m0, s27, 4096
    s_add_u32 s33, s33, 32768
    ds_read_b64_tr_b16 v[114:115], v3 offset:29184
    v_mfma_f32_16x16x32_bf16 v[56:59], a[216:219], v[96:99], v[56:59]
    s_waitcnt lgkmcnt(4)
    buffer_load_dwordx4 v10, s[8:11], s33 offen offset:0 lds
    v_mfma_f32_16x16x32_bf16 v[60:63], a[24:27], v[100:103], v[60:63]
    ds_read_b64_tr_b16 v[116:117], v4 offset:28672
    v_mfma_f32_16x16x32_bf16 v[64:67], a[88:91], v[100:103], v[64:67]
    buffer_load_dwordx4 v11, s[8:11], s33 offen offset:1024 lds
    buffer_load_dwordx4 v12, s[8:11], s33 offen offset:2048 lds
    v_mfma_f32_16x16x32_bf16 v[68:71], a[152:155], v[100:103], v[68:71]
    ds_read_b64_tr_b16 v[118:119], v4 offset:29184
    v_mfma_f32_16x16x32_bf16 v[72:75], a[216:219], v[100:103], v[72:75]
    buffer_load_dwordx4 v13, s[8:11], s33 offen offset:3072 lds
    v_mfma_f32_16x16x32_bf16 v[76:79], a[24:27], v[104:107], v[76:79]
    s_add_u32 m0, s26, 0
    ds_read_b64_tr_b16 v[120:121], v5 offset:28672
    v_mfma_f32_16x16x32_bf16 v[80:83], a[88:91], v[104:107], v[80:83]
    s_add_u32 s25, s22, s44
    v_mfma_f32_16x16x32_bf16 v[84:87], a[152:155], v[104:107], v[84:87]
    ds_read_b64_tr_b16 v[122:123], v5 offset:29184
    v_mfma_f32_16x16x32_bf16 v[88:91], a[216:219], v[104:107], v[88:91]
    s_waitcnt lgkmcnt(4)
    v_mfma_f32_16x16x32_bf16 v[28:31], a[28:31], v[108:111], v[28:31]
    s_barrier
    ds_read_b64_tr_b16 v[92:93], v2 offset:32768
    v_mfma_f32_16x16x32_bf16 v[32:35], a[92:95], v[108:111], v[32:35]
    s_waitcnt vmcnt(20)
    buffer_load_dwordx4 v6, s[12:15], s25 offen offset:0 lds
    v_mfma_f32_16x16x32_bf16 v[36:39], a[156:159], v[108:111], v[36:39]
    ds_read_b64_tr_b16 v[94:95], v2 offset:33280
    ds_read_b128 a[32:35], v14 offset:8192
    v_mfma_f32_16x16x32_bf16 v[40:43], a[220:223], v[108:111], v[40:43]
    buffer_load_dwordx4 v7, s[12:15], s25 offen offset:1024 lds
    v_mfma_f32_16x16x32_bf16 v[44:47], a[28:31], v[112:115], v[44:47]
    ds_read_b64_tr_b16 v[96:97], v3 offset:32768
    ds_read_b128 a[96:99], v14 offset:10240
    v_mfma_f32_16x16x32_bf16 v[48:51], a[92:95], v[112:115], v[48:51]
    buffer_load_dwordx4 v8, s[12:15], s25 offen offset:2048 lds
    v_mfma_f32_16x16x32_bf16 v[52:55], a[156:159], v[112:115], v[52:55]
    ds_read_b64_tr_b16 v[98:99], v3 offset:33280
    ds_read_b128 a[160:163], v14 offset:12288
    v_mfma_f32_16x16x32_bf16 v[56:59], a[220:223], v[112:115], v[56:59]
    s_waitcnt lgkmcnt(7)
    buffer_load_dwordx4 v9, s[12:15], s25 offen offset:3072 lds
    v_mfma_f32_16x16x32_bf16 v[60:63], a[28:31], v[116:119], v[60:63]
    ds_read_b128 a[224:227], v14 offset:14336
    ds_read_b64_tr_b16 v[100:101], v4 offset:32768
    v_mfma_f32_16x16x32_bf16 v[64:67], a[92:95], v[116:119], v[64:67]
    ds_read_b128 a[36:39], v15 offset:8192
    v_mfma_f32_16x16x32_bf16 v[68:71], a[156:159], v[116:119], v[68:71]
    ds_read_b128 a[100:103], v15 offset:10240
    ds_read_b64_tr_b16 v[102:103], v4 offset:33280
    v_mfma_f32_16x16x32_bf16 v[72:75], a[220:223], v[116:119], v[72:75]
    ds_read_b128 a[164:167], v15 offset:12288
    v_mfma_f32_16x16x32_bf16 v[76:79], a[28:31], v[120:123], v[76:79]
    ds_read_b128 a[228:231], v15 offset:14336
    ds_read_b64_tr_b16 v[104:105], v5 offset:32768
    v_mfma_f32_16x16x32_bf16 v[80:83], a[92:95], v[120:123], v[80:83]
    v_mfma_f32_16x16x32_bf16 v[84:87], a[156:159], v[120:123], v[84:87]
    ds_read_b64_tr_b16 v[106:107], v5 offset:33280
    v_mfma_f32_16x16x32_bf16 v[88:91], a[220:223], v[120:123], v[88:91]
    s_waitcnt lgkmcnt(2)
    v_mfma_f32_16x16x32_bf16 v[28:31], a[32:35], v[92:95], v[28:31]
    s_add_u32 m0, s27, 8192
    s_add_u32 s33, s56, 896
    s_and_b32 s33, s33, 1023
    s_add_u32 s33, s33, s28
    ds_read_b64_tr_b16 v[108:109], v2 offset:36864
    v_mfma_f32_16x16x32_bf16 v[32:35], a[96:99], v[92:95], v[32:35]
    buffer_load_dwordx4 v10, s[8:11], s33 offen offset:0 lds
    v_mfma_f32_16x16x32_bf16 v[36:39], a[160:163], v[92:95], v[36:39]
    ds_read_b64_tr_b16 v[110:111], v2 offset:37376
    v_mfma_f32_16x16x32_bf16 v[40:43], a[224:227], v[92:95], v[40:43]
    buffer_load_dwordx4 v11, s[8:11], s33 offen offset:1024 lds
    buffer_load_dwordx4 v12, s[8:11], s33 offen offset:2048 lds
    v_mfma_f32_16x16x32_bf16 v[44:47], a[32:35], v[96:99], v[44:47]
    ds_read_b64_tr_b16 v[112:113], v3 offset:36864
    v_mfma_f32_16x16x32_bf16 v[48:51], a[96:99], v[96:99], v[48:51]
    buffer_load_dwordx4 v13, s[8:11], s33 offen offset:3072 lds
    v_mfma_f32_16x16x32_bf16 v[52:55], a[160:163], v[96:99], v[52:55]
    s_add_u32 m0, s27, 12288
    s_add_u32 s33, s33, 32768
    ds_read_b64_tr_b16 v[114:115], v3 offset:37376
    v_mfma_f32_16x16x32_bf16 v[56:59], a[224:227], v[96:99], v[56:59]
    s_waitcnt lgkmcnt(4)
    buffer_load_dwordx4 v10, s[8:11], s33 offen offset:0 lds
    v_mfma_f32_16x16x32_bf16 v[60:63], a[32:35], v[100:103], v[60:63]
    ds_read_b64_tr_b16 v[116:117], v4 offset:36864
    v_mfma_f32_16x16x32_bf16 v[64:67], a[96:99], v[100:103], v[64:67]
    buffer_load_dwordx4 v11, s[8:11], s33 offen offset:1024 lds
    buffer_load_dwordx4 v12, s[8:11], s33 offen offset:2048 lds
    v_mfma_f32_16x16x32_bf16 v[68:71], a[160:163], v[100:103], v[68:71]
    ds_read_b64_tr_b16 v[118:119], v4 offset:37376
    v_mfma_f32_16x16x32_bf16 v[72:75], a[224:227], v[100:103], v[72:75]
    buffer_load_dwordx4 v13, s[8:11], s33 offen offset:3072 lds
    v_mfma_f32_16x16x32_bf16 v[76:79], a[32:35], v[104:107], v[76:79]
    ds_read_b64_tr_b16 v[120:121], v5 offset:36864
    v_mfma_f32_16x16x32_bf16 v[80:83], a[96:99], v[104:107], v[80:83]
    v_mfma_f32_16x16x32_bf16 v[84:87], a[160:163], v[104:107], v[84:87]
    ds_read_b64_tr_b16 v[122:123], v5 offset:37376
    v_mfma_f32_16x16x32_bf16 v[88:91], a[224:227], v[104:107], v[88:91]
    s_waitcnt lgkmcnt(4)
    v_mfma_f32_16x16x32_bf16 v[28:31], a[36:39], v[108:111], v[28:31]
    ds_read_b64_tr_b16 v[92:93], v2 offset:40960
    v_mfma_f32_16x16x32_bf16 v[32:35], a[100:103], v[108:111], v[32:35]
    s_waitcnt vmcnt(20)
    v_mfma_f32_16x16x32_bf16 v[36:39], a[164:167], v[108:111], v[36:39]
    ds_read_b64_tr_b16 v[94:95], v2 offset:41472
    ds_read_b128 a[40:43], v14 offset:16384
    v_mfma_f32_16x16x32_bf16 v[40:43], a[228:231], v[108:111], v[40:43]
    v_mfma_f32_16x16x32_bf16 v[44:47], a[36:39], v[112:115], v[44:47]
    ds_read_b64_tr_b16 v[96:97], v3 offset:40960
    ds_read_b128 a[104:107], v14 offset:18432
    v_mfma_f32_16x16x32_bf16 v[48:51], a[100:103], v[112:115], v[48:51]
    v_mfma_f32_16x16x32_bf16 v[52:55], a[164:167], v[112:115], v[52:55]
    ds_read_b64_tr_b16 v[98:99], v3 offset:41472
    ds_read_b128 a[168:171], v14 offset:20480
    v_mfma_f32_16x16x32_bf16 v[56:59], a[228:231], v[112:115], v[56:59]
    s_waitcnt lgkmcnt(7)
    v_mfma_f32_16x16x32_bf16 v[60:63], a[36:39], v[116:119], v[60:63]
    ds_read_b128 a[232:235], v14 offset:22528
    ds_read_b64_tr_b16 v[100:101], v4 offset:40960
    v_mfma_f32_16x16x32_bf16 v[64:67], a[100:103], v[116:119], v[64:67]
    ds_read_b128 a[44:47], v15 offset:16384
    v_mfma_f32_16x16x32_bf16 v[68:71], a[164:167], v[116:119], v[68:71]
    ds_read_b128 a[108:111], v15 offset:18432
    ds_read_b64_tr_b16 v[102:103], v4 offset:41472
    v_mfma_f32_16x16x32_bf16 v[72:75], a[228:231], v[116:119], v[72:75]
    ds_read_b128 a[172:175], v15 offset:20480
    v_mfma_f32_16x16x32_bf16 v[76:79], a[36:39], v[120:123], v[76:79]
    ds_read_b128 a[236:239], v15 offset:22528
    ds_read_b64_tr_b16 v[104:105], v5 offset:40960
    v_mfma_f32_16x16x32_bf16 v[80:83], a[100:103], v[120:123], v[80:83]
    v_mfma_f32_16x16x32_bf16 v[84:87], a[164:167], v[120:123], v[84:87]
    ds_read_b64_tr_b16 v[106:107], v5 offset:41472
    v_mfma_f32_16x16x32_bf16 v[88:91], a[228:231], v[120:123], v[88:91]
    s_waitcnt lgkmcnt(2)
    v_mfma_f32_16x16x32_bf16 v[28:31], a[40:43], v[92:95], v[28:31]
    ds_read_b64_tr_b16 v[108:109], v2 offset:45056
    v_mfma_f32_16x16x32_bf16 v[32:35], a[104:107], v[92:95], v[32:35]
    v_mfma_f32_16x16x32_bf16 v[36:39], a[168:171], v[92:95], v[36:39]
    ds_read_b64_tr_b16 v[110:111], v2 offset:45568
    v_mfma_f32_16x16x32_bf16 v[40:43], a[232:235], v[92:95], v[40:43]
    v_mfma_f32_16x16x32_bf16 v[44:47], a[40:43], v[96:99], v[44:47]
    ds_read_b64_tr_b16 v[112:113], v3 offset:45056
    v_mfma_f32_16x16x32_bf16 v[48:51], a[104:107], v[96:99], v[48:51]
    v_mfma_f32_16x16x32_bf16 v[52:55], a[168:171], v[96:99], v[52:55]
    ds_read_b64_tr_b16 v[114:115], v3 offset:45568
    v_mfma_f32_16x16x32_bf16 v[56:59], a[232:235], v[96:99], v[56:59]
    s_waitcnt lgkmcnt(4)
    v_mfma_f32_16x16x32_bf16 v[60:63], a[40:43], v[100:103], v[60:63]
    ds_read_b64_tr_b16 v[116:117], v4 offset:45056
    v_mfma_f32_16x16x32_bf16 v[64:67], a[104:107], v[100:103], v[64:67]
    v_mfma_f32_16x16x32_bf16 v[68:71], a[168:171], v[100:103], v[68:71]
    ds_read_b64_tr_b16 v[118:119], v4 offset:45568
    v_mfma_f32_16x16x32_bf16 v[72:75], a[232:235], v[100:103], v[72:75]
    v_mfma_f32_16x16x32_bf16 v[76:79], a[40:43], v[104:107], v[76:79]
    s_add_u32 m0, s26, 16384
    ds_read_b64_tr_b16 v[120:121], v5 offset:45056
    v_mfma_f32_16x16x32_bf16 v[80:83], a[104:107], v[104:107], v[80:83]
    s_add_u32 s25, s22, s45
    v_mfma_f32_16x16x32_bf16 v[84:87], a[168:171], v[104:107], v[84:87]
    ds_read_b64_tr_b16 v[122:123], v5 offset:45568
    v_mfma_f32_16x16x32_bf16 v[88:91], a[232:235], v[104:107], v[88:91]
    s_waitcnt lgkmcnt(4)
    v_mfma_f32_16x16x32_bf16 v[28:31], a[44:47], v[108:111], v[28:31]
    s_barrier
    ds_read_b64_tr_b16 v[92:93], v2 offset:49152
    v_mfma_f32_16x16x32_bf16 v[32:35], a[108:111], v[108:111], v[32:35]
    s_waitcnt vmcnt(12)
    buffer_load_dwordx4 v6, s[12:15], s25 offen offset:0 lds
    v_mfma_f32_16x16x32_bf16 v[36:39], a[172:175], v[108:111], v[36:39]
    ds_read_b64_tr_b16 v[94:95], v2 offset:49664
    ds_read_b128 a[48:51], v14 offset:0
    v_mfma_f32_16x16x32_bf16 v[40:43], a[236:239], v[108:111], v[40:43]
    buffer_load_dwordx4 v7, s[12:15], s25 offen offset:1024 lds
    v_mfma_f32_16x16x32_bf16 v[44:47], a[44:47], v[112:115], v[44:47]
    ds_read_b64_tr_b16 v[96:97], v3 offset:49152
    ds_read_b128 a[112:115], v14 offset:2048
    v_mfma_f32_16x16x32_bf16 v[48:51], a[108:111], v[112:115], v[48:51]
    buffer_load_dwordx4 v8, s[12:15], s25 offen offset:2048 lds
    v_mfma_f32_16x16x32_bf16 v[52:55], a[172:175], v[112:115], v[52:55]
    ds_read_b64_tr_b16 v[98:99], v3 offset:49664
    ds_read_b128 a[176:179], v14 offset:4096
    v_mfma_f32_16x16x32_bf16 v[56:59], a[236:239], v[112:115], v[56:59]
    s_waitcnt lgkmcnt(7)
    buffer_load_dwordx4 v9, s[12:15], s25 offen offset:3072 lds
    v_and_b32 v236, 15, v0
    v_lshlrev_b32 v236, 13, v236
    v_mfma_f32_16x16x32_bf16 v[60:63], a[44:47], v[116:119], v[60:63]
    ds_read_b128 a[240:243], v14 offset:6144
    ds_read_b64_tr_b16 v[100:101], v4 offset:49152
    v_mfma_f32_16x16x32_bf16 v[64:67], a[108:111], v[116:119], v[64:67]
    s_lshl_b32 s3, s32, 2
    ds_read_b128 a[52:55], v15 offset:0
    v_lshrrev_b32 v237, 4, v0
    v_min_u32 v237, 2, v237
    v_mfma_f32_16x16x32_bf16 v[68:71], a[172:175], v[116:119], v[68:71]
    s_and_b32 s3, s3, 0x3e0000
    ds_read_b128 a[116:119], v15 offset:2048
    ds_read_b64_tr_b16 v[102:103], v4 offset:49664
    v_mfma_f32_16x16x32_bf16 v[72:75], a[236:239], v[116:119], v[72:75]
    s_add_u32 s3, s3, s21
    ds_read_b128 a[180:183], v15 offset:4096
    v_lshl_add_u32 v236, v237, 7, v236
    v_mfma_f32_16x16x32_bf16 v[76:79], a[44:47], v[120:123], v[76:79]
    ds_read_b128 a[244:247], v15 offset:6144
    ds_read_b64_tr_b16 v[104:105], v5 offset:49152
    v_mfma_f32_16x16x32_bf16 v[80:83], a[108:111], v[120:123], v[80:83]
    buffer_load_dword v226, v236, s[12:15], s3 offen offset:256
    v_mfma_f32_16x16x32_bf16 v[84:87], a[172:175], v[120:123], v[84:87]
    ds_read_b64_tr_b16 v[106:107], v5 offset:49664
    v_mfma_f32_16x16x32_bf16 v[88:91], a[236:239], v[120:123], v[88:91]
    s_waitcnt lgkmcnt(2)
    v_mfma_f32_16x16x32_bf16 v[28:31], a[48:51], v[92:95], v[28:31]
    ds_read_b64_tr_b16 v[108:109], v2 offset:53248
    v_mfma_f32_16x16x32_bf16 v[32:35], a[112:115], v[92:95], v[32:35]
    v_mfma_f32_16x16x32_bf16 v[36:39], a[176:179], v[92:95], v[36:39]
    ds_read_b64_tr_b16 v[110:111], v2 offset:53760
    v_mfma_f32_16x16x32_bf16 v[40:43], a[240:243], v[92:95], v[40:43]
    v_mfma_f32_16x16x32_bf16 v[44:47], a[48:51], v[96:99], v[44:47]
    ds_read_b64_tr_b16 v[112:113], v3 offset:53248
    v_mfma_f32_16x16x32_bf16 v[48:51], a[112:115], v[96:99], v[48:51]
    v_mfma_f32_16x16x32_bf16 v[52:55], a[176:179], v[96:99], v[52:55]
    ds_read_b64_tr_b16 v[114:115], v3 offset:53760
    v_mfma_f32_16x16x32_bf16 v[56:59], a[240:243], v[96:99], v[56:59]
    s_waitcnt lgkmcnt(4)
    v_mfma_f32_16x16x32_bf16 v[60:63], a[48:51], v[100:103], v[60:63]
    ds_read_b64_tr_b16 v[116:117], v4 offset:53248
    v_mfma_f32_16x16x32_bf16 v[64:67], a[112:115], v[100:103], v[64:67]
    v_mfma_f32_16x16x32_bf16 v[68:71], a[176:179], v[100:103], v[68:71]
    ds_read_b64_tr_b16 v[118:119], v4 offset:53760
    v_mfma_f32_16x16x32_bf16 v[72:75], a[240:243], v[100:103], v[72:75]
    v_mfma_f32_16x16x32_bf16 v[76:79], a[48:51], v[104:107], v[76:79]
    ds_read_b64_tr_b16 v[120:121], v5 offset:53248
    v_mfma_f32_16x16x32_bf16 v[80:83], a[112:115], v[104:107], v[80:83]
    v_mfma_f32_16x16x32_bf16 v[84:87], a[176:179], v[104:107], v[84:87]
    ds_read_b64_tr_b16 v[122:123], v5 offset:53760
    v_mfma_f32_16x16x32_bf16 v[88:91], a[240:243], v[104:107], v[88:91]
    s_waitcnt lgkmcnt(4)
    v_mfma_f32_16x16x32_bf16 v[28:31], a[52:55], v[108:111], v[28:31]
    ds_read_b64_tr_b16 v[92:93], v2 offset:57344
    v_mfma_f32_16x16x32_bf16 v[32:35], a[116:119], v[108:111], v[32:35]
    s_waitcnt vmcnt(5)
    v_mfma_f32_16x16x32_bf16 v[36:39], a[180:183], v[108:111], v[36:39]
    ds_read_b64_tr_b16 v[94:95], v2 offset:57856
    ds_read_b128 a[56:59], v14 offset:8192
    v_mfma_f32_16x16x32_bf16 v[40:43], a[244:247], v[108:111], v[40:43]
    v_mfma_f32_16x16x32_bf16 v[44:47], a[52:55], v[112:115], v[44:47]
    ds_read_b64_tr_b16 v[96:97], v3 offset:57344
    ds_read_b128 a[120:123], v14 offset:10240
    v_mfma_f32_16x16x32_bf16 v[48:51], a[116:119], v[112:115], v[48:51]
    v_mfma_f32_16x16x32_bf16 v[52:55], a[180:183], v[112:115], v[52:55]
    ds_read_b64_tr_b16 v[98:99], v3 offset:57856
    ds_read_b128 a[184:187], v14 offset:12288
    v_mfma_f32_16x16x32_bf16 v[56:59], a[244:247], v[112:115], v[56:59]
    s_waitcnt lgkmcnt(7)
    v_mfma_f32_16x16x32_bf16 v[60:63], a[52:55], v[116:119], v[60:63]
    ds_read_b128 a[248:251], v14 offset:14336
    ds_read_b64_tr_b16 v[100:101], v4 offset:57344
    v_mfma_f32_16x16x32_bf16 v[64:67], a[116:119], v[116:119], v[64:67]
    ds_read_b128 a[60:63], v15 offset:8192
    v_mfma_f32_16x16x32_bf16 v[68:71], a[180:183], v[116:119], v[68:71]
    ds_read_b128 a[124:127], v15 offset:10240
    ds_read_b64_tr_b16 v[102:103], v4 offset:57856
    v_mfma_f32_16x16x32_bf16 v[72:75], a[244:247], v[116:119], v[72:75]
    ds_read_b128 a[188:191], v15 offset:12288
    v_mfma_f32_16x16x32_bf16 v[76:79], a[52:55], v[120:123], v[76:79]
    ds_read_b128 a[252:255], v15 offset:14336
    ds_read_b64_tr_b16 v[104:105], v5 offset:57344
    v_mfma_f32_16x16x32_bf16 v[80:83], a[116:119], v[120:123], v[80:83]
    v_mfma_f32_16x16x32_bf16 v[84:87], a[180:183], v[120:123], v[84:87]
    ds_read_b64_tr_b16 v[106:107], v5 offset:57856
    v_mfma_f32_16x16x32_bf16 v[88:91], a[244:247], v[120:123], v[88:91]
    s_waitcnt lgkmcnt(2)
    v_mfma_f32_16x16x32_bf16 v[28:31], a[56:59], v[92:95], v[28:31]
    ds_read_b64_tr_b16 v[108:109], v2 offset:61440
    v_mfma_f32_16x16x32_bf16 v[32:35], a[120:123], v[92:95], v[32:35]
    v_mfma_f32_16x16x32_bf16 v[36:39], a[184:187], v[92:95], v[36:39]
    ds_read_b64_tr_b16 v[110:111], v2 offset:61952
    v_mfma_f32_16x16x32_bf16 v[40:43], a[248:251], v[92:95], v[40:43]
    v_mfma_f32_16x16x32_bf16 v[44:47], a[56:59], v[96:99], v[44:47]
    ds_read_b64_tr_b16 v[112:113], v3 offset:61440
    v_mfma_f32_16x16x32_bf16 v[48:51], a[120:123], v[96:99], v[48:51]
    v_mfma_f32_16x16x32_bf16 v[52:55], a[184:187], v[96:99], v[52:55]
    ds_read_b64_tr_b16 v[114:115], v3 offset:61952
    v_mfma_f32_16x16x32_bf16 v[56:59], a[248:251], v[96:99], v[56:59]
    s_waitcnt lgkmcnt(4)
    v_mfma_f32_16x16x32_bf16 v[60:63], a[56:59], v[100:103], v[60:63]
    ds_read_b64_tr_b16 v[116:117], v4 offset:61440
    v_mfma_f32_16x16x32_bf16 v[64:67], a[120:123], v[100:103], v[64:67]
    v_mfma_f32_16x16x32_bf16 v[68:71], a[184:187], v[100:103], v[68:71]
    ds_read_b64_tr_b16 v[118:119], v4 offset:61952
    v_mfma_f32_16x16x32_bf16 v[72:75], a[248:251], v[100:103], v[72:75]
    v_mfma_f32_16x16x32_bf16 v[76:79], a[56:59], v[104:107], v[76:79]
    s_add_u32 m0, s26, 32768
    ds_read_b64_tr_b16 v[120:121], v5 offset:61440
    v_mfma_f32_16x16x32_bf16 v[80:83], a[120:123], v[104:107], v[80:83]
    s_add_u32 s25, s22, s50
    v_mfma_f32_16x16x32_bf16 v[84:87], a[184:187], v[104:107], v[84:87]
    ds_read_b64_tr_b16 v[122:123], v5 offset:61952
    v_mfma_f32_16x16x32_bf16 v[88:91], a[248:251], v[104:107], v[88:91]
    s_waitcnt lgkmcnt(4)
    v_mfma_f32_16x16x32_bf16 v[28:31], a[60:63], v[108:111], v[28:31]
    s_barrier
    ds_read_b64_tr_b16 v[92:93], v2 offset:0
    v_mfma_f32_16x16x32_bf16 v[32:35], a[124:127], v[108:111], v[32:35]
    buffer_load_dwordx4 v6, s[12:15], s25 offen offset:0 lds
    v_mfma_f32_16x16x32_bf16 v[36:39], a[188:191], v[108:111], v[36:39]
    ds_read_b64_tr_b16 v[94:95], v2 offset:512
    v_mfma_f32_16x16x32_bf16 v[40:43], a[252:255], v[108:111], v[40:43]
    buffer_load_dwordx4 v7, s[12:15], s25 offen offset:1024 lds
    v_mfma_f32_16x16x32_bf16 v[44:47], a[60:63], v[112:115], v[44:47]
    s_mov_b32 s21, s22
    ds_read_b64_tr_b16 v[96:97], v3 offset:0
    v_mfma_f32_16x16x32_bf16 v[48:51], a[124:127], v[112:115], v[48:51]
    s_add_u32 s22, s22, 128
    buffer_load_dwordx4 v8, s[12:15], s25 offen offset:2048 lds
    v_mfma_f32_16x16x32_bf16 v[52:55], a[188:191], v[112:115], v[52:55]
    ds_read_b64_tr_b16 v[98:99], v3 offset:512
    v_mfma_f32_16x16x32_bf16 v[56:59], a[252:255], v[112:115], v[56:59]
    s_waitcnt lgkmcnt(4)
    buffer_load_dwordx4 v9, s[12:15], s25 offen offset:3072 lds
    v_mfma_f32_16x16x32_bf16 v[60:63], a[60:63], v[116:119], v[60:63]
    ds_read_b64_tr_b16 v[100:101], v4 offset:0
    v_mfma_f32_16x16x32_bf16 v[64:67], a[124:127], v[116:119], v[64:67]
    v_mfma_f32_16x16x32_bf16 v[68:71], a[188:191], v[116:119], v[68:71]
    ds_read_b64_tr_b16 v[102:103], v4 offset:512
    v_mfma_f32_16x16x32_bf16 v[72:75], a[252:255], v[116:119], v[72:75]
    v_mfma_f32_16x16x32_bf16 v[76:79], a[60:63], v[120:123], v[76:79]
    ds_read_b64_tr_b16 v[104:105], v5 offset:0
    v_mfma_f32_16x16x32_bf16 v[80:83], a[124:127], v[120:123], v[80:83]
    v_mfma_f32_16x16x32_bf16 v[84:87], a[188:191], v[120:123], v[84:87]
    ds_read_b64_tr_b16 v[106:107], v5 offset:512
    v_mfma_f32_16x16x32_bf16 v[88:91], a[252:255], v[120:123], v[88:91]
    s_waitcnt lgkmcnt(4)
    v_mfma_f32_16x16x32_bf16 v[156:159], a[0:3], v[92:95], 0
    s_lshr_b32 s23, s31, 1
    ds_read_b64_tr_b16 v[108:109], v2 offset:4096
    v_mul_f32 v28, s34, v28
    v_mfma_f32_16x16x32_bf16 v[160:163], a[64:67], v[92:95], 0
    s_lshl_b32 s23, s23, 20
    v_mul_f32 v29, s34, v29
    v_mul_f32 v30, s34, v30
    v_mfma_f32_16x16x32_bf16 v[164:167], a[128:131], v[92:95], 0
    s_add_u32 s23, s23, s32
    ds_read_b64_tr_b16 v[110:111], v2 offset:4608
    v_mul_f32 v31, s34, v31
    v_mfma_f32_16x16x32_bf16 v[168:171], a[192:195], v[92:95], 0
    s_and_b32 s33, s31, 1
    v_cvt_pk_bf16_f32 v124, v28, v29
    v_cvt_pk_bf16_f32 v125, v30, v31
    v_mfma_f32_16x16x32_bf16 v[172:175], a[0:3], v[96:99], 0
    s_lshl_b32 s33, s33, 12
    ds_read_b64_tr_b16 v[112:113], v3 offset:4096
    v_mul_f32 v32, s34, v32
    v_mfma_f32_16x16x32_bf16 v[176:179], a[64:67], v[96:99], 0
    s_add_u32 s23, s23, s33
    v_mul_f32 v33, s34, v33
    v_mul_f32 v34, s34, v34
    v_mfma_f32_16x16x32_bf16 v[180:183], a[128:131], v[96:99], 0
    s_add_u32 s31, s31, 1
    ds_read_b64_tr_b16 v[114:115], v3 offset:4608
    v_mul_f32 v35, s34, v35
    v_mfma_f32_16x16x32_bf16 v[184:187], a[192:195], v[96:99], 0
    s_waitcnt lgkmcnt(4)
    v_cvt_pk_bf16_f32 v126, v32, v33
    v_cvt_pk_bf16_f32 v127, v34, v35
    v_mfma_f32_16x16x32_bf16 v[188:191], a[0:3], v[100:103], 0
    s_add_u32 m0, s48, 0
    ds_read_b64_tr_b16 v[116:117], v4 offset:4096
    v_mul_f32 v36, s34, v36
    v_mfma_f32_16x16x32_bf16 v[192:195], a[64:67], v[100:103], 0
    s_add_u32 s25, s22, s44
    v_mul_f32 v37, s34, v37
    v_mul_f32 v38, s34, v38
    v_mfma_f32_16x16x32_bf16 v[196:199], a[128:131], v[100:103], 0
    ds_read_b64_tr_b16 v[118:119], v4 offset:4608
    v_mul_f32 v39, s34, v39
    v_mfma_f32_16x16x32_bf16 v[200:203], a[192:195], v[100:103], 0
    buffer_load_dwordx4 v6, s[12:15], s25 offen offset:0 lds
    v_cvt_pk_bf16_f32 v140, v36, v37
    v_mfma_f32_16x16x32_bf16 v[204:207], a[0:3], v[104:107], 0
    ds_read_b64_tr_b16 v[120:121], v5 offset:4096
    v_cvt_pk_bf16_f32 v141, v38, v39
    v_mfma_f32_16x16x32_bf16 v[208:211], a[64:67], v[104:107], 0
    v_mul_f32 v40, s34, v40
    v_mul_f32 v41, s34, v41
    v_mfma_f32_16x16x32_bf16 v[212:215], a[128:131], v[104:107], 0
    ds_read_b64_tr_b16 v[122:123], v5 offset:4608
    v_mul_f32 v42, s34, v42
    v_mfma_f32_16x16x32_bf16 v[216:219], a[192:195], v[104:107], 0
    s_waitcnt lgkmcnt(4)
    buffer_load_dwordx4 v7, s[12:15], s25 offen offset:1024 lds
    v_mul_f32 v43, s34, v43
    v_mfma_f32_16x16x32_bf16 v[156:159], a[4:7], v[108:111], v[156:159]
    ds_read_b64_tr_b16 v[92:93], v2 offset:8192
    v_cvt_pk_bf16_f32 v142, v40, v41
    v_mfma_f32_16x16x32_bf16 v[160:163], a[68:71], v[108:111], v[160:163]
    v_cvt_pk_bf16_f32 v143, v42, v43
    v_mul_f32 v44, s34, v44
    v_mfma_f32_16x16x32_bf16 v[164:167], a[132:135], v[108:111], v[164:167]
    ds_read_b64_tr_b16 v[94:95], v2 offset:8704
    v_mul_f32 v45, s34, v45
    v_mfma_f32_16x16x32_bf16 v[168:171], a[196:199], v[108:111], v[168:171]
    buffer_load_dwordx4 v8, s[12:15], s25 offen offset:2048 lds
    v_mul_f32 v46, s34, v46
    v_mfma_f32_16x16x32_bf16 v[172:175], a[4:7], v[112:115], v[172:175]
    ds_read_b64_tr_b16 v[96:97], v3 offset:8192
    v_mul_f32 v47, s34, v47
    v_mfma_f32_16x16x32_bf16 v[176:179], a[68:71], v[112:115], v[176:179]
    v_cvt_pk_bf16_f32 v128, v44, v45
    v_cvt_pk_bf16_f32 v129, v46, v47
    v_mfma_f32_16x16x32_bf16 v[180:183], a[132:135], v[112:115], v[180:183]
    ds_read_b64_tr_b16 v[98:99], v3 offset:8704
    v_mul_f32 v48, s34, v48
    v_mfma_f32_16x16x32_bf16 v[184:187], a[196:199], v[112:115], v[184:187]
    s_waitcnt lgkmcnt(4)
    buffer_load_dwordx4 v9, s[12:15], s25 offen offset:3072 lds
    v_mul_f32 v49, s34, v49
    v_mfma_f32_16x16x32_bf16 v[188:191], a[4:7], v[116:119], v[188:191]
    ds_read_b64_tr_b16 v[100:101], v4 offset:8192
    v_mul_f32 v50, s34, v50
    v_mfma_f32_16x16x32_bf16 v[192:195], a[68:71], v[116:119], v[192:195]
    v_mul_f32 v51, s34, v51
    v_cvt_pk_bf16_f32 v130, v48, v49
    v_mfma_f32_16x16x32_bf16 v[196:199], a[132:135], v[116:119], v[196:199]
    s_add_u32 m0, s48, 16384
    ds_read_b64_tr_b16 v[102:103], v4 offset:8704
    v_cvt_pk_bf16_f32 v131, v50, v51
    v_mfma_f32_16x16x32_bf16 v[200:203], a[196:199], v[116:119], v[200:203]
    s_add_u32 s25, s22, s45
    v_mul_f32 v52, s34, v52
    v_mul_f32 v53, s34, v53
    v_mfma_f32_16x16x32_bf16 v[204:207], a[4:7], v[120:123], v[204:207]
    ds_read_b64_tr_b16 v[104:105], v5 offset:8192
    v_mul_f32 v54, s34, v54
    v_mfma_f32_16x16x32_bf16 v[208:211], a[68:71], v[120:123], v[208:211]
    buffer_load_dwordx4 v6, s[12:15], s25 offen offset:0 lds
    v_mul_f32 v55, s34, v55
    v_mfma_f32_16x16x32_bf16 v[212:215], a[132:135], v[120:123], v[212:215]
    ds_read_b64_tr_b16 v[106:107], v5 offset:8704
    v_cvt_pk_bf16_f32 v144, v52, v53
    v_mfma_f32_16x16x32_bf16 v[216:219], a[196:199], v[120:123], v[216:219]
    s_waitcnt lgkmcnt(4)
    v_cvt_pk_bf16_f32 v145, v54, v55
    v_mul_f32 v56, s34, v56
    v_mfma_f32_16x16x32_bf16 v[156:159], a[8:11], v[92:95], v[156:159]
    ds_read_b64_tr_b16 v[108:109], v2 offset:12288
    v_mul_f32 v57, s34, v57
    v_mfma_f32_16x16x32_bf16 v[160:163], a[72:75], v[92:95], v[160:163]
    buffer_load_dwordx4 v7, s[12:15], s25 offen offset:1024 lds
    v_mul_f32 v58, s34, v58
    v_mfma_f32_16x16x32_bf16 v[164:167], a[136:139], v[92:95], v[164:167]
    ds_read_b64_tr_b16 v[110:111], v2 offset:12800
    v_mul_f32 v59, s34, v59
    v_mfma_f32_16x16x32_bf16 v[168:171], a[200:203], v[92:95], v[168:171]
    v_cvt_pk_bf16_f32 v146, v56, v57
    v_cvt_pk_bf16_f32 v147, v58, v59
    v_mfma_f32_16x16x32_bf16 v[172:175], a[8:11], v[96:99], v[172:175]
    ds_read_b64_tr_b16 v[112:113], v3 offset:12288
    v_mul_f32 v60, s34, v60
    v_mfma_f32_16x16x32_bf16 v[176:179], a[72:75], v[96:99], v[176:179]
    buffer_load_dwordx4 v8, s[12:15], s25 offen offset:2048 lds
    v_mul_f32 v61, s34, v61
    v_mfma_f32_16x16x32_bf16 v[180:183], a[136:139], v[96:99], v[180:183]
    ds_read_b64_tr_b16 v[114:115], v3 offset:12800
    v_mul_f32 v62, s34, v62
    v_mfma_f32_16x16x32_bf16 v[184:187], a[200:203], v[96:99], v[184:187]
    s_waitcnt lgkmcnt(4)
    v_mul_f32 v63, s34, v63
    v_cvt_pk_bf16_f32 v132, v60, v61
    v_mfma_f32_16x16x32_bf16 v[188:191], a[8:11], v[100:103], v[188:191]
    ds_read_b64_tr_b16 v[116:117], v4 offset:12288
    v_cvt_pk_bf16_f32 v133, v62, v63
    v_mfma_f32_16x16x32_bf16 v[192:195], a[72:75], v[100:103], v[192:195]
    buffer_load_dwordx4 v9, s[12:15], s25 offen offset:3072 lds
    v_mul_f32 v64, s34, v64
    v_mfma_f32_16x16x32_bf16 v[196:199], a[136:139], v[100:103], v[196:199]
    ds_read_b64_tr_b16 v[118:119], v4 offset:12800
    v_mul_f32 v65, s34, v65
    v_mfma_f32_16x16x32_bf16 v[200:203], a[200:203], v[100:103], v[200:203]
    v_mul_f32 v66, s34, v66
    v_mul_f32 v67, s34, v67
    v_mfma_f32_16x16x32_bf16 v[204:207], a[8:11], v[104:107], v[204:207]
    s_add_u32 m0, s26, 49152
    ds_read_b64_tr_b16 v[120:121], v5 offset:12288
    v_cvt_pk_bf16_f32 v134, v64, v65
    v_mfma_f32_16x16x32_bf16 v[208:211], a[72:75], v[104:107], v[208:211]
    s_add_u32 s25, s21, s51
    v_cvt_pk_bf16_f32 v135, v66, v67
    v_mul_f32 v68, s34, v68
    v_mfma_f32_16x16x32_bf16 v[212:215], a[136:139], v[104:107], v[212:215]
    s_waitcnt vmcnt(13)
    ds_read_b64_tr_b16 v[122:123], v5 offset:12800
    v_mul_f32 v69, s34, v69
    v_mfma_f32_16x16x32_bf16 v[216:219], a[200:203], v[104:107], v[216:219]
    s_waitcnt lgkmcnt(4)
    v_mul_f32 v70, s34, v70
    v_mul_f32 v71, s34, v71
    v_mfma_f32_16x16x32_bf16 v[156:159], a[12:15], v[108:111], v[156:159]
    s_barrier
    ds_read_b64_tr_b16 v[92:93], v2 offset:16384
    v_cvt_pk_bf16_f32 v148, v68, v69
    v_mfma_f32_16x16x32_bf16 v[160:163], a[76:79], v[108:111], v[160:163]
    buffer_load_dwordx4 v6, s[12:15], s25 offen offset:0 lds
    v_cvt_pk_bf16_f32 v149, v70, v71
    v_mfma_f32_16x16x32_bf16 v[164:167], a[140:143], v[108:111], v[164:167]
    ds_read_b64_tr_b16 v[94:95], v2 offset:16896
    v_mul_f32 v72, s34, v72
    v_mfma_f32_16x16x32_bf16 v[168:171], a[204:207], v[108:111], v[168:171]
    buffer_load_dwordx4 v7, s[12:15], s25 offen offset:1024 lds
    v_mul_f32 v73, s34, v73
    v_mfma_f32_16x16x32_bf16 v[172:175], a[12:15], v[112:115], v[172:175]
    ds_read_b64_tr_b16 v[96:97], v3 offset:16384
    v_mul_f32 v74, s34, v74
    v_mfma_f32_16x16x32_bf16 v[176:179], a[76:79], v[112:115], v[176:179]
    buffer_load_dwordx4 v8, s[12:15], s25 offen offset:2048 lds
    v_mul_f32 v75, s34, v75
    v_mfma_f32_16x16x32_bf16 v[180:183], a[140:143], v[112:115], v[180:183]
    ds_read_b64_tr_b16 v[98:99], v3 offset:16896
    v_cvt_pk_bf16_f32 v150, v72, v73
    v_mfma_f32_16x16x32_bf16 v[184:187], a[204:207], v[112:115], v[184:187]
    s_waitcnt lgkmcnt(4)
    buffer_load_dwordx4 v9, s[12:15], s25 offen offset:3072 lds
    v_cvt_pk_bf16_f32 v151, v74, v75
    v_mfma_f32_16x16x32_bf16 v[188:191], a[12:15], v[116:119], v[188:191]
    ds_read_b64_tr_b16 v[100:101], v4 offset:16384
    v_mul_f32 v76, s34, v76
    v_mfma_f32_16x16x32_bf16 v[192:195], a[76:79], v[116:119], v[192:195]
    v_mul_f32 v77, s34, v77
    v_mul_f32 v78, s34, v78
    v_mfma_f32_16x16x32_bf16 v[196:199], a[140:143], v[116:119], v[196:199]
    s_add_u32 m0, s48, 32768
    ds_read_b64_tr_b16 v[102:103], v4 offset:16896
    v_mul_f32 v79, s34, v79
    v_mfma_f32_16x16x32_bf16 v[200:203], a[204:207], v[116:119], v[200:203]
    s_add_u32 s25, s22, s50
    v_cvt_pk_bf16_f32 v136, v76, v77
    v_cvt_pk_bf16_f32 v137, v78, v79
    v_mfma_f32_16x16x32_bf16 v[204:207], a[12:15], v[120:123], v[204:207]
    ds_read_b64_tr_b16 v[104:105], v5 offset:16384
    v_mul_f32 v80, s34, v80
    v_mfma_f32_16x16x32_bf16 v[208:211], a[76:79], v[120:123], v[208:211]
    buffer_load_dwordx4 v6, s[12:15], s25 offen offset:0 lds
    v_mul_f32 v81, s34, v81
    v_mfma_f32_16x16x32_bf16 v[212:215], a[140:143], v[120:123], v[212:215]
    ds_read_b64_tr_b16 v[106:107], v5 offset:16896
    v_mul_f32 v82, s34, v82
    v_mfma_f32_16x16x32_bf16 v[216:219], a[204:207], v[120:123], v[216:219]
    s_waitcnt lgkmcnt(4)
    v_mul_f32 v83, s34, v83
    v_cvt_pk_bf16_f32 v138, v80, v81
    v_mfma_f32_16x16x32_bf16 v[156:159], a[16:19], v[92:95], v[156:159]
    ds_read_b64_tr_b16 v[108:109], v2 offset:20480
    v_cvt_pk_bf16_f32 v139, v82, v83
    v_mfma_f32_16x16x32_bf16 v[160:163], a[80:83], v[92:95], v[160:163]
    buffer_load_dwordx4 v7, s[12:15], s25 offen offset:1024 lds
    v_mul_f32 v84, s34, v84
    v_mfma_f32_16x16x32_bf16 v[164:167], a[144:147], v[92:95], v[164:167]
    ds_read_b64_tr_b16 v[110:111], v2 offset:20992
    v_mul_f32 v85, s34, v85
    v_mfma_f32_16x16x32_bf16 v[168:171], a[208:211], v[92:95], v[168:171]
    v_mul_f32 v86, s34, v86
    v_mul_f32 v87, s34, v87
    v_mfma_f32_16x16x32_bf16 v[172:175], a[16:19], v[96:99], v[172:175]
    ds_read_b64_tr_b16 v[112:113], v3 offset:20480
    v_cvt_pk_bf16_f32 v152, v84, v85
    v_mfma_f32_16x16x32_bf16 v[176:179], a[80:83], v[96:99], v[176:179]
    buffer_load_dwordx4 v8, s[12:15], s25 offen offset:2048 lds
    v_cvt_pk_bf16_f32 v153, v86, v87
    v_mfma_f32_16x16x32_bf16 v[180:183], a[144:147], v[96:99], v[180:183]
    ds_read_b64_tr_b16 v[114:115], v3 offset:20992
    v_mul_f32 v88, s34, v88
    v_mfma_f32_16x16x32_bf16 v[184:187], a[208:211], v[96:99], v[184:187]
    s_waitcnt lgkmcnt(4)
    v_mul_f32 v89, s34, v89
    v_mul_f32 v90, s34, v90
    v_mfma_f32_16x16x32_bf16 v[188:191], a[16:19], v[100:103], v[188:191]
    ds_read_b64_tr_b16 v[116:117], v4 offset:20480
    v_mul_f32 v91, s34, v91
    v_mfma_f32_16x16x32_bf16 v[192:195], a[80:83], v[100:103], v[192:195]
    buffer_load_dwordx4 v9, s[12:15], s25 offen offset:3072 lds
    v_cvt_pk_bf16_f32 v154, v88, v89
    v_mfma_f32_16x16x32_bf16 v[196:199], a[144:147], v[100:103], v[196:199]
    ds_read_b64_tr_b16 v[118:119], v4 offset:20992
    v_cvt_pk_bf16_f32 v155, v90, v91
    v_mfma_f32_16x16x32_bf16 v[200:203], a[208:211], v[100:103], v[200:203]
    v_mfma_f32_16x16x32_bf16 v[204:207], a[16:19], v[104:107], v[204:207]
    ds_read_b64_tr_b16 v[120:121], v5 offset:20480
    v_mfma_f32_16x16x32_bf16 v[208:211], a[80:83], v[104:107], v[208:211]
    v_mfma_f32_16x16x32_bf16 v[212:215], a[144:147], v[104:107], v[212:215]
    ds_read_b64_tr_b16 v[122:123], v5 offset:20992
    v_mfma_f32_16x16x32_bf16 v[216:219], a[208:211], v[104:107], v[216:219]
    s_waitcnt lgkmcnt(4)
    v_mfma_f32_16x16x32_bf16 v[156:159], a[20:23], v[108:111], v[156:159]
    ds_read_b64_tr_b16 v[92:93], v2 offset:24576
    v_mfma_f32_16x16x32_bf16 v[160:163], a[84:87], v[108:111], v[160:163]
    v_mfma_f32_16x16x32_bf16 v[164:167], a[148:151], v[108:111], v[164:167]
    s_add_u32 m0, s48, 49152
    ds_read_b64_tr_b16 v[94:95], v2 offset:25088
    v_mfma_f32_16x16x32_bf16 v[168:171], a[212:215], v[108:111], v[168:171]
    s_add_u32 s25, s22, s51
    v_mfma_f32_16x16x32_bf16 v[172:175], a[20:23], v[112:115], v[172:175]
    ds_read_b64_tr_b16 v[96:97], v3 offset:24576
    v_mfma_f32_16x16x32_bf16 v[176:179], a[84:87], v[112:115], v[176:179]
    buffer_load_dwordx4 v6, s[12:15], s25 offen offset:0 lds
    v_mfma_f32_16x16x32_bf16 v[180:183], a[148:151], v[112:115], v[180:183]
    ds_read_b64_tr_b16 v[98:99], v3 offset:25088
    v_mfma_f32_16x16x32_bf16 v[184:187], a[212:215], v[112:115], v[184:187]
    s_waitcnt lgkmcnt(4)
    v_mfma_f32_16x16x32_bf16 v[188:191], a[20:23], v[116:119], v[188:191]
    ds_read_b64_tr_b16 v[100:101], v4 offset:24576
    v_mfma_f32_16x16x32_bf16 v[192:195], a[84:87], v[116:119], v[192:195]
    buffer_load_dwordx4 v7, s[12:15], s25 offen offset:1024 lds
    v_mfma_f32_16x16x32_bf16 v[196:199], a[148:151], v[116:119], v[196:199]
    ds_read_b64_tr_b16 v[102:103], v4 offset:25088
    v_mfma_f32_16x16x32_bf16 v[200:203], a[212:215], v[116:119], v[200:203]
    v_mfma_f32_16x16x32_bf16 v[204:207], a[20:23], v[120:123], v[204:207]
    ds_read_b64_tr_b16 v[104:105], v5 offset:24576
    v_mfma_f32_16x16x32_bf16 v[208:211], a[84:87], v[120:123], v[208:211]
    buffer_load_dwordx4 v8, s[12:15], s25 offen offset:2048 lds
    v_mfma_f32_16x16x32_bf16 v[212:215], a[148:151], v[120:123], v[212:215]
    ds_read_b64_tr_b16 v[106:107], v5 offset:25088
    v_mfma_f32_16x16x32_bf16 v[216:219], a[212:215], v[120:123], v[216:219]
    s_waitcnt lgkmcnt(4)
    v_mfma_f32_16x16x32_bf16 v[156:159], a[24:27], v[92:95], v[156:159]
    ds_read_b64_tr_b16 v[108:109], v2 offset:28672
    v_mfma_f32_16x16x32_bf16 v[160:163], a[88:91], v[92:95], v[160:163]
    buffer_load_dwordx4 v9, s[12:15], s25 offen offset:3072 lds
    v_mfma_f32_16x16x32_bf16 v[164:167], a[152:155], v[92:95], v[164:167]
    ds_read_b64_tr_b16 v[110:111], v2 offset:29184
    v_mfma_f32_16x16x32_bf16 v[168:171], a[216:219], v[92:95], v[168:171]
    v_mfma_f32_16x16x32_bf16 v[172:175], a[24:27], v[96:99], v[172:175]
    ds_read_b64_tr_b16 v[112:113], v3 offset:28672
    v_mfma_f32_16x16x32_bf16 v[176:179], a[88:91], v[96:99], v[176:179]
    v_mfma_f32_16x16x32_bf16 v[180:183], a[152:155], v[96:99], v[180:183]
    ds_read_b64_tr_b16 v[114:115], v3 offset:29184
    v_mfma_f32_16x16x32_bf16 v[184:187], a[216:219], v[96:99], v[184:187]
    s_waitcnt lgkmcnt(4)
    v_mfma_f32_16x16x32_bf16 v[188:191], a[24:27], v[100:103], v[188:191]
    ds_read_b64_tr_b16 v[116:117], v4 offset:28672
    v_mfma_f32_16x16x32_bf16 v[192:195], a[88:91], v[100:103], v[192:195]
    v_mfma_f32_16x16x32_bf16 v[196:199], a[152:155], v[100:103], v[196:199]
    ds_read_b64_tr_b16 v[118:119], v4 offset:29184
    v_mfma_f32_16x16x32_bf16 v[200:203], a[216:219], v[100:103], v[200:203]
    v_mfma_f32_16x16x32_bf16 v[204:207], a[24:27], v[104:107], v[204:207]
    ds_read_b64_tr_b16 v[120:121], v5 offset:28672
    v_mfma_f32_16x16x32_bf16 v[208:211], a[88:91], v[104:107], v[208:211]
    buffer_store_dwordx4 v[124:127], v18, s[16:19], s23 offen offset:0 sc1
    v_mfma_f32_16x16x32_bf16 v[212:215], a[152:155], v[104:107], v[212:215]
    s_waitcnt vmcnt(21)
    ds_read_b64_tr_b16 v[122:123], v5 offset:29184
    v_mfma_f32_16x16x32_bf16 v[216:219], a[216:219], v[104:107], v[216:219]
    s_waitcnt lgkmcnt(4)
    v_mfma_f32_16x16x32_bf16 v[156:159], a[28:31], v[108:111], v[156:159]
    s_barrier
    ds_read_b64_tr_b16 v[92:93], v2 offset:32768
    v_mfma_f32_16x16x32_bf16 v[160:163], a[92:95], v[108:111], v[160:163]
    v_mfma_f32_16x16x32_bf16 v[164:167], a[156:159], v[108:111], v[164:167]
    ds_read_b64_tr_b16 v[94:95], v2 offset:33280
    v_mfma_f32_16x16x32_bf16 v[168:171], a[220:223], v[108:111], v[168:171]
    v_mfma_f32_16x16x32_bf16 v[172:175], a[28:31], v[112:115], v[172:175]
    ds_read_b64_tr_b16 v[96:97], v3 offset:32768
    v_mfma_f32_16x16x32_bf16 v[176:179], a[92:95], v[112:115], v[176:179]
    v_mfma_f32_16x16x32_bf16 v[180:183], a[156:159], v[112:115], v[180:183]
    ds_read_b64_tr_b16 v[98:99], v3 offset:33280
    v_mfma_f32_16x16x32_bf16 v[184:187], a[220:223], v[112:115], v[184:187]
    s_waitcnt lgkmcnt(4)
    v_mfma_f32_16x16x32_bf16 v[188:191], a[28:31], v[116:119], v[188:191]
    ds_read_b64_tr_b16 v[100:101], v4 offset:32768
    v_mfma_f32_16x16x32_bf16 v[192:195], a[92:95], v[116:119], v[192:195]
    v_mfma_f32_16x16x32_bf16 v[196:199], a[156:159], v[116:119], v[196:199]
    ds_read_b64_tr_b16 v[102:103], v4 offset:33280
    v_mfma_f32_16x16x32_bf16 v[200:203], a[220:223], v[116:119], v[200:203]
    v_mfma_f32_16x16x32_bf16 v[204:207], a[28:31], v[120:123], v[204:207]
    ds_read_b64_tr_b16 v[104:105], v5 offset:32768
    v_mfma_f32_16x16x32_bf16 v[208:211], a[92:95], v[120:123], v[208:211]
    buffer_store_dwordx4 v[128:131], v18, s[16:19], s23 offen offset:1024 sc1
    v_mfma_f32_16x16x32_bf16 v[212:215], a[156:159], v[120:123], v[212:215]
    ds_read_b64_tr_b16 v[106:107], v5 offset:33280
    v_mfma_f32_16x16x32_bf16 v[216:219], a[220:223], v[120:123], v[216:219]
    s_waitcnt lgkmcnt(4)
    v_mfma_f32_16x16x32_bf16 v[156:159], a[32:35], v[92:95], v[156:159]
    ds_read_b64_tr_b16 v[108:109], v2 offset:36864
    v_mfma_f32_16x16x32_bf16 v[160:163], a[96:99], v[92:95], v[160:163]
    v_mfma_f32_16x16x32_bf16 v[164:167], a[160:163], v[92:95], v[164:167]
    ds_read_b64_tr_b16 v[110:111], v2 offset:37376
    v_mfma_f32_16x16x32_bf16 v[168:171], a[224:227], v[92:95], v[168:171]
    v_mfma_f32_16x16x32_bf16 v[172:175], a[32:35], v[96:99], v[172:175]
    ds_read_b64_tr_b16 v[112:113], v3 offset:36864
    v_mfma_f32_16x16x32_bf16 v[176:179], a[96:99], v[96:99], v[176:179]
    v_mfma_f32_16x16x32_bf16 v[180:183], a[160:163], v[96:99], v[180:183]
    ds_read_b64_tr_b16 v[114:115], v3 offset:37376
    v_mfma_f32_16x16x32_bf16 v[184:187], a[224:227], v[96:99], v[184:187]
    s_waitcnt lgkmcnt(4)
    v_mfma_f32_16x16x32_bf16 v[188:191], a[32:35], v[100:103], v[188:191]
    ds_read_b64_tr_b16 v[116:117], v4 offset:36864
    v_mfma_f32_16x16x32_bf16 v[192:195], a[96:99], v[100:103], v[192:195]
    v_mfma_f32_16x16x32_bf16 v[196:199], a[160:163], v[100:103], v[196:199]
    ds_read_b64_tr_b16 v[118:119], v4 offset:37376
    v_mfma_f32_16x16x32_bf16 v[200:203], a[224:227], v[100:103], v[200:203]
    v_mfma_f32_16x16x32_bf16 v[204:207], a[32:35], v[104:107], v[204:207]
    ds_read_b64_tr_b16 v[120:121], v5 offset:36864
    v_mfma_f32_16x16x32_bf16 v[208:211], a[96:99], v[104:107], v[208:211]
    buffer_store_dwordx4 v[132:135], v18, s[16:19], s23 offen offset:2048 sc1
    v_mfma_f32_16x16x32_bf16 v[212:215], a[160:163], v[104:107], v[212:215]
    ds_read_b64_tr_b16 v[122:123], v5 offset:37376
    v_mfma_f32_16x16x32_bf16 v[216:219], a[224:227], v[104:107], v[216:219]
    s_waitcnt lgkmcnt(4)
    v_mfma_f32_16x16x32_bf16 v[156:159], a[36:39], v[108:111], v[156:159]
    ds_read_b64_tr_b16 v[92:93], v2 offset:40960
    v_mfma_f32_16x16x32_bf16 v[160:163], a[100:103], v[108:111], v[160:163]
    v_mfma_f32_16x16x32_bf16 v[164:167], a[164:167], v[108:111], v[164:167]
    ds_read_b64_tr_b16 v[94:95], v2 offset:41472
    v_mfma_f32_16x16x32_bf16 v[168:171], a[228:231], v[108:111], v[168:171]
    v_mfma_f32_16x16x32_bf16 v[172:175], a[36:39], v[112:115], v[172:175]
    ds_read_b64_tr_b16 v[96:97], v3 offset:40960
    v_mfma_f32_16x16x32_bf16 v[176:179], a[100:103], v[112:115], v[176:179]
    buffer_load_dword v226, v227, s[40:43], s4 offen
    v_mfma_f32_16x16x32_bf16 v[180:183], a[164:167], v[112:115], v[180:183]
    s_add_u32 s4, s4, 1792
    ds_read_b64_tr_b16 v[98:99], v3 offset:41472
    v_mfma_f32_16x16x32_bf16 v[184:187], a[228:231], v[112:115], v[184:187]
    s_waitcnt lgkmcnt(4)
    v_mfma_f32_16x16x32_bf16 v[188:191], a[36:39], v[116:119], v[188:191]
    ds_read_b64_tr_b16 v[100:101], v4 offset:40960
    v_mfma_f32_16x16x32_bf16 v[192:195], a[100:103], v[116:119], v[192:195]
    v_mfma_f32_16x16x32_bf16 v[196:199], a[164:167], v[116:119], v[196:199]
    ds_read_b64_tr_b16 v[102:103], v4 offset:41472
    v_mfma_f32_16x16x32_bf16 v[200:203], a[228:231], v[116:119], v[200:203]
    v_mfma_f32_16x16x32_bf16 v[204:207], a[36:39], v[120:123], v[204:207]
    ds_read_b64_tr_b16 v[104:105], v5 offset:40960
    v_mfma_f32_16x16x32_bf16 v[208:211], a[100:103], v[120:123], v[208:211]
    buffer_store_dwordx4 v[136:139], v18, s[16:19], s23 offen offset:3072 sc1
    v_mfma_f32_16x16x32_bf16 v[212:215], a[164:167], v[120:123], v[212:215]
    ds_read_b64_tr_b16 v[106:107], v5 offset:41472
    v_mfma_f32_16x16x32_bf16 v[216:219], a[228:231], v[120:123], v[216:219]
    s_waitcnt lgkmcnt(4)
    v_mfma_f32_16x16x32_bf16 v[156:159], a[40:43], v[92:95], v[156:159]
    ds_read_b64_tr_b16 v[108:109], v2 offset:45056
    v_mfma_f32_16x16x32_bf16 v[160:163], a[104:107], v[92:95], v[160:163]
    v_mfma_f32_16x16x32_bf16 v[164:167], a[168:171], v[92:95], v[164:167]
    ds_read_b64_tr_b16 v[110:111], v2 offset:45568
    v_mfma_f32_16x16x32_bf16 v[168:171], a[232:235], v[92:95], v[168:171]
    v_mfma_f32_16x16x32_bf16 v[172:175], a[40:43], v[96:99], v[172:175]
    ds_read_b64_tr_b16 v[112:113], v3 offset:45056
    v_mfma_f32_16x16x32_bf16 v[176:179], a[104:107], v[96:99], v[176:179]
    buffer_load_dword v226, v234, s[36:39], s58 offen
    v_mfma_f32_16x16x32_bf16 v[180:183], a[168:171], v[96:99], v[180:183]
    ds_read_b64_tr_b16 v[114:115], v3 offset:45568
    v_mfma_f32_16x16x32_bf16 v[184:187], a[232:235], v[96:99], v[184:187]
    s_waitcnt lgkmcnt(4)
    v_mfma_f32_16x16x32_bf16 v[188:191], a[40:43], v[100:103], v[188:191]
    ds_read_b64_tr_b16 v[116:117], v4 offset:45056
    v_mfma_f32_16x16x32_bf16 v[192:195], a[104:107], v[100:103], v[192:195]
    v_mfma_f32_16x16x32_bf16 v[196:199], a[168:171], v[100:103], v[196:199]
    ds_read_b64_tr_b16 v[118:119], v4 offset:45568
    v_mfma_f32_16x16x32_bf16 v[200:203], a[232:235], v[100:103], v[200:203]
    v_mfma_f32_16x16x32_bf16 v[204:207], a[40:43], v[104:107], v[204:207]
    ds_read_b64_tr_b16 v[120:121], v5 offset:45056
    v_mfma_f32_16x16x32_bf16 v[208:211], a[104:107], v[104:107], v[208:211]
    buffer_store_dwordx4 v[140:143], v20, s[16:19], s23 offen offset:0 sc1
    v_mfma_f32_16x16x32_bf16 v[212:215], a[168:171], v[104:107], v[212:215]
    s_waitcnt vmcnt(15)
    ds_read_b64_tr_b16 v[122:123], v5 offset:45568
    v_mfma_f32_16x16x32_bf16 v[216:219], a[232:235], v[104:107], v[216:219]
    s_waitcnt lgkmcnt(4)
    v_mfma_f32_16x16x32_bf16 v[156:159], a[44:47], v[108:111], v[156:159]
    s_barrier
    ds_read_b64_tr_b16 v[92:93], v2 offset:49152
    v_mfma_f32_16x16x32_bf16 v[160:163], a[108:111], v[108:111], v[160:163]
    v_mfma_f32_16x16x32_bf16 v[164:167], a[172:175], v[108:111], v[164:167]
    ds_read_b64_tr_b16 v[94:95], v2 offset:49664
    v_mfma_f32_16x16x32_bf16 v[168:171], a[236:239], v[108:111], v[168:171]
    v_mfma_f32_16x16x32_bf16 v[172:175], a[44:47], v[112:115], v[172:175]
    ds_read_b64_tr_b16 v[96:97], v3 offset:49152
    v_mfma_f32_16x16x32_bf16 v[176:179], a[108:111], v[112:115], v[176:179]
    v_mfma_f32_16x16x32_bf16 v[180:183], a[172:175], v[112:115], v[180:183]
    ds_read_b64_tr_b16 v[98:99], v3 offset:49664
    v_mfma_f32_16x16x32_bf16 v[184:187], a[236:239], v[112:115], v[184:187]
    s_waitcnt lgkmcnt(4)
    v_mfma_f32_16x16x32_bf16 v[188:191], a[44:47], v[116:119], v[188:191]
    ds_read_b64_tr_b16 v[100:101], v4 offset:49152
    v_mfma_f32_16x16x32_bf16 v[192:195], a[108:111], v[116:119], v[192:195]
    v_mfma_f32_16x16x32_bf16 v[196:199], a[172:175], v[116:119], v[196:199]
    ds_read_b64_tr_b16 v[102:103], v4 offset:49664
    v_mfma_f32_16x16x32_bf16 v[200:203], a[236:239], v[116:119], v[200:203]
    v_mfma_f32_16x16x32_bf16 v[204:207], a[44:47], v[120:123], v[204:207]
    ds_read_b64_tr_b16 v[104:105], v5 offset:49152
    v_mfma_f32_16x16x32_bf16 v[208:211], a[108:111], v[120:123], v[208:211]
    buffer_store_dwordx4 v[144:147], v20, s[16:19], s23 offen offset:1024 sc1
    v_mfma_f32_16x16x32_bf16 v[212:215], a[172:175], v[120:123], v[212:215]
    ds_read_b64_tr_b16 v[106:107], v5 offset:49664
    v_mfma_f32_16x16x32_bf16 v[216:219], a[236:239], v[120:123], v[216:219]
    s_waitcnt lgkmcnt(4)
    v_mfma_f32_16x16x32_bf16 v[156:159], a[48:51], v[92:95], v[156:159]
    ds_read_b64_tr_b16 v[108:109], v2 offset:53248
    v_mfma_f32_16x16x32_bf16 v[160:163], a[112:115], v[92:95], v[160:163]
    v_mfma_f32_16x16x32_bf16 v[164:167], a[176:179], v[92:95], v[164:167]
    ds_read_b64_tr_b16 v[110:111], v2 offset:53760
    v_mfma_f32_16x16x32_bf16 v[168:171], a[240:243], v[92:95], v[168:171]
    v_mfma_f32_16x16x32_bf16 v[172:175], a[48:51], v[96:99], v[172:175]
    ds_read_b64_tr_b16 v[112:113], v3 offset:53248
    v_mfma_f32_16x16x32_bf16 v[176:179], a[112:115], v[96:99], v[176:179]
    v_mfma_f32_16x16x32_bf16 v[180:183], a[176:179], v[96:99], v[180:183]
    ds_read_b64_tr_b16 v[114:115], v3 offset:53760
    v_mfma_f32_16x16x32_bf16 v[184:187], a[240:243], v[96:99], v[184:187]
    s_waitcnt lgkmcnt(4)
    v_mfma_f32_16x16x32_bf16 v[188:191], a[48:51], v[100:103], v[188:191]
    ds_read_b64_tr_b16 v[116:117], v4 offset:53248
    v_mfma_f32_16x16x32_bf16 v[192:195], a[112:115], v[100:103], v[192:195]
    v_mfma_f32_16x16x32_bf16 v[196:199], a[176:179], v[100:103], v[196:199]
    ds_read_b64_tr_b16 v[118:119], v4 offset:53760
    v_mfma_f32_16x16x32_bf16 v[200:203], a[240:243], v[100:103], v[200:203]
    v_mfma_f32_16x16x32_bf16 v[204:207], a[48:51], v[104:107], v[204:207]
    ds_read_b64_tr_b16 v[120:121], v5 offset:53248
    v_mfma_f32_16x16x32_bf16 v[208:211], a[112:115], v[104:107], v[208:211]
    buffer_store_dwordx4 v[148:151], v20, s[16:19], s23 offen offset:2048 sc1
    v_mfma_f32_16x16x32_bf16 v[212:215], a[176:179], v[104:107], v[212:215]
    ds_read_b64_tr_b16 v[122:123], v5 offset:53760
    v_mfma_f32_16x16x32_bf16 v[216:219], a[240:243], v[104:107], v[216:219]
    s_waitcnt lgkmcnt(4)
    v_mfma_f32_16x16x32_bf16 v[156:159], a[52:55], v[108:111], v[156:159]
    ds_read_b64_tr_b16 v[92:93], v2 offset:57344
    v_mfma_f32_16x16x32_bf16 v[160:163], a[116:119], v[108:111], v[160:163]
    v_mfma_f32_16x16x32_bf16 v[164:167], a[180:183], v[108:111], v[164:167]
    ds_read_b64_tr_b16 v[94:95], v2 offset:57856
    v_mfma_f32_16x16x32_bf16 v[168:171], a[244:247], v[108:111], v[168:171]
    v_mfma_f32_16x16x32_bf16 v[172:175], a[52:55], v[112:115], v[172:175]
    ds_read_b64_tr_b16 v[96:97], v3 offset:57344
    v_mfma_f32_16x16x32_bf16 v[176:179], a[116:119], v[112:115], v[176:179]
    v_mfma_f32_16x16x32_bf16 v[180:183], a[180:183], v[112:115], v[180:183]
    ds_read_b64_tr_b16 v[98:99], v3 offset:57856
    v_mfma_f32_16x16x32_bf16 v[184:187], a[244:247], v[112:115], v[184:187]
    s_waitcnt lgkmcnt(4)
    v_mfma_f32_16x16x32_bf16 v[188:191], a[52:55], v[116:119], v[188:191]
    ds_read_b64_tr_b16 v[100:101], v4 offset:57344
    v_mfma_f32_16x16x32_bf16 v[192:195], a[116:119], v[116:119], v[192:195]
    v_mfma_f32_16x16x32_bf16 v[196:199], a[180:183], v[116:119], v[196:199]
    ds_read_b64_tr_b16 v[102:103], v4 offset:57856
    v_mfma_f32_16x16x32_bf16 v[200:203], a[244:247], v[116:119], v[200:203]
    v_mfma_f32_16x16x32_bf16 v[204:207], a[52:55], v[120:123], v[204:207]
    ds_read_b64_tr_b16 v[104:105], v5 offset:57344
    v_mfma_f32_16x16x32_bf16 v[208:211], a[116:119], v[120:123], v[208:211]
    buffer_store_dwordx4 v[152:155], v20, s[16:19], s23 offen offset:3072 sc1
    v_mfma_f32_16x16x32_bf16 v[212:215], a[180:183], v[120:123], v[212:215]
    ds_read_b64_tr_b16 v[106:107], v5 offset:57856
    v_mfma_f32_16x16x32_bf16 v[216:219], a[244:247], v[120:123], v[216:219]
    s_waitcnt lgkmcnt(4)
    v_mfma_f32_16x16x32_bf16 v[156:159], a[56:59], v[92:95], v[156:159]
    ds_read_b64_tr_b16 v[108:109], v2 offset:61440
    v_mfma_f32_16x16x32_bf16 v[160:163], a[120:123], v[92:95], v[160:163]
    v_mfma_f32_16x16x32_bf16 v[164:167], a[184:187], v[92:95], v[164:167]
    ds_read_b64_tr_b16 v[110:111], v2 offset:61952
    v_mfma_f32_16x16x32_bf16 v[168:171], a[248:251], v[92:95], v[168:171]
    v_mfma_f32_16x16x32_bf16 v[172:175], a[56:59], v[96:99], v[172:175]
    ds_read_b64_tr_b16 v[112:113], v3 offset:61440
    v_mfma_f32_16x16x32_bf16 v[176:179], a[120:123], v[96:99], v[176:179]
    v_mfma_f32_16x16x32_bf16 v[180:183], a[184:187], v[96:99], v[180:183]
    ds_read_b64_tr_b16 v[114:115], v3 offset:61952
    v_mfma_f32_16x16x32_bf16 v[184:187], a[248:251], v[96:99], v[184:187]
    s_waitcnt lgkmcnt(4)
    v_mfma_f32_16x16x32_bf16 v[188:191], a[56:59], v[100:103], v[188:191]
    ds_read_b64_tr_b16 v[116:117], v4 offset:61440
    v_mfma_f32_16x16x32_bf16 v[192:195], a[120:123], v[100:103], v[192:195]
    v_mfma_f32_16x16x32_bf16 v[196:199], a[184:187], v[100:103], v[196:199]
    ds_read_b64_tr_b16 v[118:119], v4 offset:61952
    v_mfma_f32_16x16x32_bf16 v[200:203], a[248:251], v[100:103], v[200:203]
    v_mfma_f32_16x16x32_bf16 v[204:207], a[56:59], v[104:107], v[204:207]
    ds_read_b64_tr_b16 v[120:121], v5 offset:61440
    v_mfma_f32_16x16x32_bf16 v[208:211], a[120:123], v[104:107], v[208:211]
    v_mfma_f32_16x16x32_bf16 v[212:215], a[184:187], v[104:107], v[212:215]
    s_waitcnt vmcnt(10)
    ds_read_b64_tr_b16 v[122:123], v5 offset:61952
    v_mfma_f32_16x16x32_bf16 v[216:219], a[248:251], v[104:107], v[216:219]
    s_waitcnt lgkmcnt(4)
    v_xor_b32 v2, 0x10000, v2
    v_xor_b32 v3, 0x10000, v3
    v_mfma_f32_16x16x32_bf16 v[156:159], a[60:63], v[108:111], v[156:159]
    s_barrier
    ds_read_b64_tr_b16 v[92:93], v2 offset:0
    v_mfma_f32_16x16x32_bf16 v[160:163], a[124:127], v[108:111], v[160:163]
    v_xor_b32 v4, 0x10000, v4
    v_xor_b32 v5, 0x10000, v5
    v_mfma_f32_16x16x32_bf16 v[164:167], a[188:191], v[108:111], v[164:167]
    s_xor_b32 s48, s48, 0x10000
    ds_read_b64_tr_b16 v[94:95], v2 offset:512
    v_mfma_f32_16x16x32_bf16 v[168:171], a[252:255], v[108:111], v[168:171]
    v_mfma_f32_16x16x32_bf16 v[172:175], a[60:63], v[112:115], v[172:175]
    s_mov_b32 s21, s22
    ds_read_b64_tr_b16 v[96:97], v3 offset:0
    v_mfma_f32_16x16x32_bf16 v[176:179], a[124:127], v[112:115], v[176:179]
    s_add_u32 s22, s22, 128
    v_mfma_f32_16x16x32_bf16 v[180:183], a[188:191], v[112:115], v[180:183]
    ds_read_b64_tr_b16 v[98:99], v3 offset:512
    v_mfma_f32_16x16x32_bf16 v[184:187], a[252:255], v[112:115], v[184:187]
    s_waitcnt lgkmcnt(4)
    v_mfma_f32_16x16x32_bf16 v[188:191], a[60:63], v[116:119], v[188:191]
    ds_read_b64_tr_b16 v[100:101], v4 offset:0
    v_mfma_f32_16x16x32_bf16 v[192:195], a[124:127], v[116:119], v[192:195]
    v_mfma_f32_16x16x32_bf16 v[196:199], a[188:191], v[116:119], v[196:199]
    ds_read_b64_tr_b16 v[102:103], v4 offset:512
    v_mfma_f32_16x16x32_bf16 v[200:203], a[252:255], v[116:119], v[200:203]
    v_mfma_f32_16x16x32_bf16 v[204:207], a[60:63], v[120:123], v[204:207]
    ds_read_b64_tr_b16 v[104:105], v5 offset:0
    v_mfma_f32_16x16x32_bf16 v[208:211], a[124:127], v[120:123], v[208:211]
    v_mfma_f32_16x16x32_bf16 v[212:215], a[188:191], v[120:123], v[212:215]
    ds_read_b64_tr_b16 v[106:107], v5 offset:512
    v_mfma_f32_16x16x32_bf16 v[216:219], a[252:255], v[120:123], v[216:219]
    s_waitcnt lgkmcnt(4)
    v_mfma_f32_16x16x32_bf16 v[28:31], a[0:3], v[92:95], 0
    s_lshr_b32 s23, s31, 1
    ds_read_b64_tr_b16 v[108:109], v2 offset:4096
    v_mul_f32 v156, s34, v156
    v_mfma_f32_16x16x32_bf16 v[32:35], a[64:67], v[92:95], 0
    s_lshl_b32 s23, s23, 20
    v_mul_f32 v157, s34, v157
    v_mul_f32 v158, s34, v158
    v_mfma_f32_16x16x32_bf16 v[36:39], a[128:131], v[92:95], 0
    s_add_u32 s23, s23, s32
    ds_read_b64_tr_b16 v[110:111], v2 offset:4608
    v_mul_f32 v159, s34, v159
    v_mfma_f32_16x16x32_bf16 v[40:43], a[192:195], v[92:95], 0
    s_and_b32 s33, s31, 1
    v_cvt_pk_bf16_f32 v124, v156, v157
    v_cvt_pk_bf16_f32 v125, v158, v159
    v_mfma_f32_16x16x32_bf16 v[44:47], a[0:3], v[96:99], 0
    s_lshl_b32 s33, s33, 12
    ds_read_b64_tr_b16 v[112:113], v3 offset:4096
    v_mul_f32 v160, s34, v160
    v_mfma_f32_16x16x32_bf16 v[48:51], a[64:67], v[96:99], 0
    s_add_u32 s23, s23, s33
    v_mul_f32 v161, s34, v161
    v_mul_f32 v162, s34, v162
    v_mfma_f32_16x16x32_bf16 v[52:55], a[128:131], v[96:99], 0
    s_add_u32 s31, s31, 1
    ds_read_b64_tr_b16 v[114:115], v3 offset:4608
    v_mul_f32 v163, s34, v163
    v_mfma_f32_16x16x32_bf16 v[56:59], a[192:195], v[96:99], 0
    s_waitcnt lgkmcnt(4)
    v_cvt_pk_bf16_f32 v126, v160, v161
    v_cvt_pk_bf16_f32 v127, v162, v163
    v_mfma_f32_16x16x32_bf16 v[60:63], a[0:3], v[100:103], 0
    s_barrier
    ds_read_b64_tr_b16 v[116:117], v4 offset:4096
    v_mul_f32 v164, s34, v164
    v_mfma_f32_16x16x32_bf16 v[64:67], a[64:67], v[100:103], 0
    v_mul_f32 v165, s34, v165
    v_mul_f32 v166, s34, v166
    v_mfma_f32_16x16x32_bf16 v[68:71], a[128:131], v[100:103], 0
    s_add_u32 m0, s48, 0
    ds_read_b64_tr_b16 v[118:119], v4 offset:4608
    v_mul_f32 v167, s34, v167
    v_mfma_f32_16x16x32_bf16 v[72:75], a[192:195], v[100:103], 0
    s_add_u32 s25, s22, s44
    v_cvt_pk_bf16_f32 v140, v164, v165
    v_cvt_pk_bf16_f32 v141, v166, v167
    v_mfma_f32_16x16x32_bf16 v[76:79], a[0:3], v[104:107], 0
    ds_read_b64_tr_b16 v[120:121], v5 offset:4096
    v_mul_f32 v168, s34, v168
    v_mfma_f32_16x16x32_bf16 v[80:83], a[64:67], v[104:107], 0
    buffer_load_dwordx4 v6, s[12:15], s25 offen offset:0 lds
    v_mul_f32 v169, s34, v169
    v_mfma_f32_16x16x32_bf16 v[84:87], a[128:131], v[104:107], 0
    ds_read_b64_tr_b16 v[122:123], v5 offset:4608
    v_mul_f32 v170, s34, v170
    v_mfma_f32_16x16x32_bf16 v[88:91], a[192:195], v[104:107], 0
    s_waitcnt lgkmcnt(4)
    v_mul_f32 v171, s34, v171
    v_cvt_pk_bf16_f32 v142, v168, v169
    v_mfma_f32_16x16x32_bf16 v[28:31], a[4:7], v[108:111], v[28:31]
    ds_read_b64_tr_b16 v[92:93], v2 offset:8192
    v_cvt_pk_bf16_f32 v143, v170, v171
    v_mfma_f32_16x16x32_bf16 v[32:35], a[68:71], v[108:111], v[32:35]
    v_mul_f32 v172, s34, v172
    v_mul_f32 v173, s34, v173
    v_mfma_f32_16x16x32_bf16 v[36:39], a[132:135], v[108:111], v[36:39]
    ds_read_b64_tr_b16 v[94:95], v2 offset:8704
    v_mul_f32 v174, s34, v174
    v_mfma_f32_16x16x32_bf16 v[40:43], a[196:199], v[108:111], v[40:43]
    buffer_load_dwordx4 v7, s[12:15], s25 offen offset:1024 lds
    v_mul_f32 v175, s34, v175
    v_mfma_f32_16x16x32_bf16 v[44:47], a[4:7], v[112:115], v[44:47]
    ds_read_b64_tr_b16 v[96:97], v3 offset:8192
    v_cvt_pk_bf16_f32 v128, v172, v173
    v_mfma_f32_16x16x32_bf16 v[48:51], a[68:71], v[112:115], v[48:51]
    v_cvt_pk_bf16_f32 v129, v174, v175
    v_mul_f32 v176, s34, v176
    v_mfma_f32_16x16x32_bf16 v[52:55], a[132:135], v[112:115], v[52:55]
    ds_read_b64_tr_b16 v[98:99], v3 offset:8704
    v_mul_f32 v177, s34, v177
    v_mfma_f32_16x16x32_bf16 v[56:59], a[196:199], v[112:115], v[56:59]
    s_waitcnt lgkmcnt(4)
    v_mul_f32 v178, s34, v178
    v_mul_f32 v179, s34, v179
    v_mfma_f32_16x16x32_bf16 v[60:63], a[4:7], v[116:119], v[60:63]
    ds_read_b64_tr_b16 v[100:101], v4 offset:8192
    v_cvt_pk_bf16_f32 v130, v176, v177
    v_mfma_f32_16x16x32_bf16 v[64:67], a[68:71], v[116:119], v[64:67]
    buffer_load_dwordx4 v8, s[12:15], s25 offen offset:2048 lds
    v_cvt_pk_bf16_f32 v131, v178, v179
    v_mfma_f32_16x16x32_bf16 v[68:71], a[132:135], v[116:119], v[68:71]
    ds_read_b64_tr_b16 v[102:103], v4 offset:8704
    v_mul_f32 v180, s34, v180
    v_mfma_f32_16x16x32_bf16 v[72:75], a[196:199], v[116:119], v[72:75]
    v_mul_f32 v181, s34, v181
    v_mul_f32 v182, s34, v182
    v_mfma_f32_16x16x32_bf16 v[76:79], a[4:7], v[120:123], v[76:79]
    ds_read_b64_tr_b16 v[104:105], v5 offset:8192
    v_mul_f32 v183, s34, v183
    v_mfma_f32_16x16x32_bf16 v[80:83], a[68:71], v[120:123], v[80:83]
    v_cvt_pk_bf16_f32 v144, v180, v181
    v_cvt_pk_bf16_f32 v145, v182, v183
    v_mfma_f32_16x16x32_bf16 v[84:87], a[132:135], v[120:123], v[84:87]
    ds_read_b64_tr_b16 v[106:107], v5 offset:8704
    v_mul_f32 v184, s34, v184
    v_mfma_f32_16x16x32_bf16 v[88:91], a[196:199], v[120:123], v[88:91]
    s_waitcnt lgkmcnt(4)
    buffer_load_dwordx4 v9, s[12:15], s25 offen offset:3072 lds
    v_mul_f32 v185, s34, v185
    v_mfma_f32_16x16x32_bf16 v[28:31], a[8:11], v[92:95], v[28:31]
    ds_read_b64_tr_b16 v[108:109], v2 offset:12288
    v_mul_f32 v186, s34, v186
    v_mfma_f32_16x16x32_bf16 v[32:35], a[72:75], v[92:95], v[32:35]
    v_mul_f32 v187, s34, v187
    v_cvt_pk_bf16_f32 v146, v184, v185
    v_mfma_f32_16x16x32_bf16 v[36:39], a[136:139], v[92:95], v[36:39]
    s_add_u32 m0, s48, 16384
    ds_read_b64_tr_b16 v[110:111], v2 offset:12800
    v_cvt_pk_bf16_f32 v147, v186, v187
    v_mfma_f32_16x16x32_bf16 v[40:43], a[200:203], v[92:95], v[40:43]
    s_add_u32 s25, s22, s45
    v_mul_f32 v188, s34, v188
    v_mul_f32 v189, s34, v189
    v_mfma_f32_16x16x32_bf16 v[44:47], a[8:11], v[96:99], v[44:47]
    ds_read_b64_tr_b16 v[112:113], v3 offset:12288
    v_mul_f32 v190, s34, v190
    v_mfma_f32_16x16x32_bf16 v[48:51], a[72:75], v[96:99], v[48:51]
    buffer_load_dwordx4 v6, s[12:15], s25 offen offset:0 lds
    v_mul_f32 v191, s34, v191
    v_mfma_f32_16x16x32_bf16 v[52:55], a[136:139], v[96:99], v[52:55]
    ds_read_b64_tr_b16 v[114:115], v3 offset:12800
    v_cvt_pk_bf16_f32 v132, v188, v189
    v_mfma_f32_16x16x32_bf16 v[56:59], a[200:203], v[96:99], v[56:59]
    s_waitcnt lgkmcnt(4)
    v_cvt_pk_bf16_f32 v133, v190, v191
    v_mul_f32 v192, s34, v192
    v_mfma_f32_16x16x32_bf16 v[60:63], a[8:11], v[100:103], v[60:63]
    ds_read_b64_tr_b16 v[116:117], v4 offset:12288
    v_mul_f32 v193, s34, v193
    v_mfma_f32_16x16x32_bf16 v[64:67], a[72:75], v[100:103], v[64:67]
    v_mul_f32 v194, s34, v194
    v_mul_f32 v195, s34, v195
    v_mfma_f32_16x16x32_bf16 v[68:71], a[136:139], v[100:103], v[68:71]
    ds_read_b64_tr_b16 v[118:119], v4 offset:12800
    v_cvt_pk_bf16_f32 v134, v192, v193
    v_mfma_f32_16x16x32_bf16 v[72:75], a[200:203], v[100:103], v[72:75]
    buffer_load_dwordx4 v7, s[12:15], s25 offen offset:1024 lds
    v_cvt_pk_bf16_f32 v135, v194, v195
    v_mfma_f32_16x16x32_bf16 v[76:79], a[8:11], v[104:107], v[76:79]
    ds_read_b64_tr_b16 v[120:121], v5 offset:12288
    v_mul_f32 v196, s34, v196
    v_mfma_f32_16x16x32_bf16 v[80:83], a[72:75], v[104:107], v[80:83]
    v_mul_f32 v197, s34, v197
    v_mul_f32 v198, s34, v198
    v_mfma_f32_16x16x32_bf16 v[84:87], a[136:139], v[104:107], v[84:87]
    ds_read_b64_tr_b16 v[122:123], v5 offset:12800
    v_mul_f32 v199, s34, v199
    v_mfma_f32_16x16x32_bf16 v[88:91], a[200:203], v[104:107], v[88:91]
    s_waitcnt lgkmcnt(4)
    v_cvt_pk_bf16_f32 v148, v196, v197
    v_cvt_pk_bf16_f32 v149, v198, v199
    v_mfma_f32_16x16x32_bf16 v[28:31], a[12:15], v[108:111], v[28:31]
    ds_read_b64_tr_b16 v[92:93], v2 offset:16384
    v_mul_f32 v200, s34, v200
    v_mfma_f32_16x16x32_bf16 v[32:35], a[76:79], v[108:111], v[32:35]
    buffer_load_dwordx4 v8, s[12:15], s25 offen offset:2048 lds
    v_mul_f32 v201, s34, v201
    v_mfma_f32_16x16x32_bf16 v[36:39], a[140:143], v[108:111], v[36:39]
    ds_read_b64_tr_b16 v[94:95], v2 offset:16896
    v_mul_f32 v202, s34, v202
    v_mfma_f32_16x16x32_bf16 v[40:43], a[204:207], v[108:111], v[40:43]
    v_mul_f32 v203, s34, v203
    v_cvt_pk_bf16_f32 v150, v200, v201
    v_mfma_f32_16x16x32_bf16 v[44:47], a[12:15], v[112:115], v[44:47]
    ds_read_b64_tr_b16 v[96:97], v3 offset:16384
    v_cvt_pk_bf16_f32 v151, v202, v203
    v_mfma_f32_16x16x32_bf16 v[48:51], a[76:79], v[112:115], v[48:51]
    v_mul_f32 v204, s34, v204
    v_mul_f32 v205, s34, v205
    v_mfma_f32_16x16x32_bf16 v[52:55], a[140:143], v[112:115], v[52:55]
    ds_read_b64_tr_b16 v[98:99], v3 offset:16896
    v_mul_f32 v206, s34, v206
    v_mfma_f32_16x16x32_bf16 v[56:59], a[204:207], v[112:115], v[56:59]
    s_waitcnt lgkmcnt(4)
    buffer_load_dwordx4 v9, s[12:15], s25 offen offset:3072 lds
    v_mul_f32 v207, s34, v207
    v_mfma_f32_16x16x32_bf16 v[60:63], a[12:15], v[116:119], v[60:63]
    ds_read_b64_tr_b16 v[100:101], v4 offset:16384
    v_cvt_pk_bf16_f32 v136, v204, v205
    v_mfma_f32_16x16x32_bf16 v[64:67], a[76:79], v[116:119], v[64:67]
    v_cvt_pk_bf16_f32 v137, v206, v207
    v_mul_f32 v208, s34, v208
    v_mfma_f32_16x16x32_bf16 v[68:71], a[140:143], v[116:119], v[68:71]
    s_add_u32 m0, s48, 32768
    ds_read_b64_tr_b16 v[102:103], v4 offset:16896
    v_mul_f32 v209, s34, v209
    v_mfma_f32_16x16x32_bf16 v[72:75], a[204:207], v[116:119], v[72:75]
    s_add_u32 s25, s22, s50
    v_mul_f32 v210, s34, v210
    v_mul_f32 v211, s34, v211
    v_mfma_f32_16x16x32_bf16 v[76:79], a[12:15], v[120:123], v[76:79]
    ds_read_b64_tr_b16 v[104:105], v5 offset:16384
    v_cvt_pk_bf16_f32 v138, v208, v209
    v_mfma_f32_16x16x32_bf16 v[80:83], a[76:79], v[120:123], v[80:83]
    buffer_load_dwordx4 v6, s[12:15], s25 offen offset:0 lds
    v_cvt_pk_bf16_f32 v139, v210, v211
    v_mfma_f32_16x16x32_bf16 v[84:87], a[140:143], v[120:123], v[84:87]
    ds_read_b64_tr_b16 v[106:107], v5 offset:16896
    v_mul_f32 v212, s34, v212
    v_mfma_f32_16x16x32_bf16 v[88:91], a[204:207], v[120:123], v[88:91]
    s_waitcnt lgkmcnt(4)
    v_mul_f32 v213, s34, v213
    v_mul_f32 v214, s34, v214
    v_mfma_f32_16x16x32_bf16 v[28:31], a[16:19], v[92:95], v[28:31]
    ds_read_b64_tr_b16 v[108:109], v2 offset:20480
    v_mul_f32 v215, s34, v215
    v_mfma_f32_16x16x32_bf16 v[32:35], a[80:83], v[92:95], v[32:35]
    v_cvt_pk_bf16_f32 v152, v212, v213
    v_cvt_pk_bf16_f32 v153, v214, v215
    v_mfma_f32_16x16x32_bf16 v[36:39], a[144:147], v[92:95], v[36:39]
    ds_read_b64_tr_b16 v[110:111], v2 offset:20992
    v_mul_f32 v216, s34, v216
    v_mfma_f32_16x16x32_bf16 v[40:43], a[208:211], v[92:95], v[40:43]
    buffer_load_dwordx4 v7, s[12:15], s25 offen offset:1024 lds
    v_mul_f32 v217, s34, v217
    v_mfma_f32_16x16x32_bf16 v[44:47], a[16:19], v[96:99], v[44:47]
    ds_read_b64_tr_b16 v[112:113], v3 offset:20480
    v_mul_f32 v218, s34, v218
    v_mfma_f32_16x16x32_bf16 v[48:51], a[80:83], v[96:99], v[48:51]
    v_mul_f32 v219, s34, v219
    v_cvt_pk_bf16_f32 v154, v216, v217
    v_mfma_f32_16x16x32_bf16 v[52:55], a[144:147], v[96:99], v[52:55]
    ds_read_b64_tr_b16 v[114:115], v3 offset:20992
    v_cvt_pk_bf16_f32 v155, v218, v219
    v_mfma_f32_16x16x32_bf16 v[56:59], a[208:211], v[96:99], v[56:59]
    s_waitcnt lgkmcnt(4)
    v_mfma_f32_16x16x32_bf16 v[60:63], a[16:19], v[100:103], v[60:63]
    ds_read_b64_tr_b16 v[116:117], v4 offset:20480
    v_mfma_f32_16x16x32_bf16 v[64:67], a[80:83], v[100:103], v[64:67]
    buffer_load_dwordx4 v8, s[12:15], s25 offen offset:2048 lds
    v_mfma_f32_16x16x32_bf16 v[68:71], a[144:147], v[100:103], v[68:71]
    ds_read_b64_tr_b16 v[118:119], v4 offset:20992
    v_mfma_f32_16x16x32_bf16 v[72:75], a[208:211], v[100:103], v[72:75]
    v_mfma_f32_16x16x32_bf16 v[76:79], a[16:19], v[104:107], v[76:79]
    ds_read_b64_tr_b16 v[120:121], v5 offset:20480
    v_mfma_f32_16x16x32_bf16 v[80:83], a[80:83], v[104:107], v[80:83]
    v_mfma_f32_16x16x32_bf16 v[84:87], a[144:147], v[104:107], v[84:87]
    ds_read_b64_tr_b16 v[122:123], v5 offset:20992
    v_mfma_f32_16x16x32_bf16 v[88:91], a[208:211], v[104:107], v[88:91]
    s_waitcnt lgkmcnt(4)
    buffer_load_dwordx4 v9, s[12:15], s25 offen offset:3072 lds
    v_mfma_f32_16x16x32_bf16 v[28:31], a[20:23], v[108:111], v[28:31]
    ds_read_b64_tr_b16 v[92:93], v2 offset:24576
    v_mfma_f32_16x16x32_bf16 v[32:35], a[84:87], v[108:111], v[32:35]
    v_mfma_f32_16x16x32_bf16 v[36:39], a[148:151], v[108:111], v[36:39]
    s_add_u32 m0, s48, 49152
    ds_read_b64_tr_b16 v[94:95], v2 offset:25088
    v_mfma_f32_16x16x32_bf16 v[40:43], a[212:215], v[108:111], v[40:43]
    s_add_u32 s25, s22, s51
    v_mfma_f32_16x16x32_bf16 v[44:47], a[20:23], v[112:115], v[44:47]
    ds_read_b64_tr_b16 v[96:97], v3 offset:24576
    v_mfma_f32_16x16x32_bf16 v[48:51], a[84:87], v[112:115], v[48:51]
    buffer_load_dwordx4 v6, s[12:15], s25 offen offset:0 lds
    v_mfma_f32_16x16x32_bf16 v[52:55], a[148:151], v[112:115], v[52:55]
    ds_read_b64_tr_b16 v[98:99], v3 offset:25088
    v_mfma_f32_16x16x32_bf16 v[56:59], a[212:215], v[112:115], v[56:59]
    s_waitcnt lgkmcnt(4)
    v_mfma_f32_16x16x32_bf16 v[60:63], a[20:23], v[116:119], v[60:63]
    ds_read_b64_tr_b16 v[100:101], v4 offset:24576
    v_mfma_f32_16x16x32_bf16 v[64:67], a[84:87], v[116:119], v[64:67]
    v_mfma_f32_16x16x32_bf16 v[68:71], a[148:151], v[116:119], v[68:71]
    ds_read_b64_tr_b16 v[102:103], v4 offset:25088
    v_mfma_f32_16x16x32_bf16 v[72:75], a[212:215], v[116:119], v[72:75]
    buffer_load_dwordx4 v7, s[12:15], s25 offen offset:1024 lds
    v_mfma_f32_16x16x32_bf16 v[76:79], a[20:23], v[120:123], v[76:79]
    ds_read_b64_tr_b16 v[104:105], v5 offset:24576
    v_mfma_f32_16x16x32_bf16 v[80:83], a[84:87], v[120:123], v[80:83]
    v_mfma_f32_16x16x32_bf16 v[84:87], a[148:151], v[120:123], v[84:87]
    ds_read_b64_tr_b16 v[106:107], v5 offset:25088
    v_mfma_f32_16x16x32_bf16 v[88:91], a[212:215], v[120:123], v[88:91]
    s_waitcnt lgkmcnt(4)
    v_mfma_f32_16x16x32_bf16 v[28:31], a[24:27], v[92:95], v[28:31]
    ds_read_b64_tr_b16 v[108:109], v2 offset:28672
    v_mfma_f32_16x16x32_bf16 v[32:35], a[88:91], v[92:95], v[32:35]
    buffer_load_dwordx4 v8, s[12:15], s25 offen offset:2048 lds
    v_mfma_f32_16x16x32_bf16 v[36:39], a[152:155], v[92:95], v[36:39]
    ds_read_b64_tr_b16 v[110:111], v2 offset:29184
    v_mfma_f32_16x16x32_bf16 v[40:43], a[216:219], v[92:95], v[40:43]
    v_mfma_f32_16x16x32_bf16 v[44:47], a[24:27], v[96:99], v[44:47]
    ds_read_b64_tr_b16 v[112:113], v3 offset:28672
    v_mfma_f32_16x16x32_bf16 v[48:51], a[88:91], v[96:99], v[48:51]
    v_mfma_f32_16x16x32_bf16 v[52:55], a[152:155], v[96:99], v[52:55]
    ds_read_b64_tr_b16 v[114:115], v3 offset:29184
    v_mfma_f32_16x16x32_bf16 v[56:59], a[216:219], v[96:99], v[56:59]
    s_waitcnt lgkmcnt(4)
    buffer_load_dwordx4 v9, s[12:15], s25 offen offset:3072 lds
    v_mfma_f32_16x16x32_bf16 v[60:63], a[24:27], v[100:103], v[60:63]
    ds_read_b64_tr_b16 v[116:117], v4 offset:28672
    v_mfma_f32_16x16x32_bf16 v[64:67], a[88:91], v[100:103], v[64:67]
    v_mfma_f32_16x16x32_bf16 v[68:71], a[152:155], v[100:103], v[68:71]
    ds_read_b64_tr_b16 v[118:119], v4 offset:29184
    v_mfma_f32_16x16x32_bf16 v[72:75], a[216:219], v[100:103], v[72:75]
    v_mfma_f32_16x16x32_bf16 v[76:79], a[24:27], v[104:107], v[76:79]
    ds_read_b64_tr_b16 v[120:121], v5 offset:28672
    v_mfma_f32_16x16x32_bf16 v[80:83], a[88:91], v[104:107], v[80:83]
    buffer_store_dwordx4 v[124:127], v18, s[16:19], s23 offen offset:0 sc1
    v_mfma_f32_16x16x32_bf16 v[84:87], a[152:155], v[104:107], v[84:87]
    ds_read_b64_tr_b16 v[122:123], v5 offset:29184
    v_mfma_f32_16x16x32_bf16 v[88:91], a[216:219], v[104:107], v[88:91]
    s_waitcnt lgkmcnt(4)
    v_mfma_f32_16x16x32_bf16 v[28:31], a[28:31], v[108:111], v[28:31]
    ds_read_b64_tr_b16 v[92:93], v2 offset:32768
    v_mfma_f32_16x16x32_bf16 v[32:35], a[92:95], v[108:111], v[32:35]
    v_mfma_f32_16x16x32_bf16 v[36:39], a[156:159], v[108:111], v[36:39]
    ds_read_b64_tr_b16 v[94:95], v2 offset:33280
    v_mfma_f32_16x16x32_bf16 v[40:43], a[220:223], v[108:111], v[40:43]
    v_mfma_f32_16x16x32_bf16 v[44:47], a[28:31], v[112:115], v[44:47]
    ds_read_b64_tr_b16 v[96:97], v3 offset:32768
    v_mfma_f32_16x16x32_bf16 v[48:51], a[92:95], v[112:115], v[48:51]
    v_mfma_f32_16x16x32_bf16 v[52:55], a[156:159], v[112:115], v[52:55]
    ds_read_b64_tr_b16 v[98:99], v3 offset:33280
    v_mfma_f32_16x16x32_bf16 v[56:59], a[220:223], v[112:115], v[56:59]
    s_waitcnt lgkmcnt(4)
    v_mfma_f32_16x16x32_bf16 v[60:63], a[28:31], v[116:119], v[60:63]
    ds_read_b64_tr_b16 v[100:101], v4 offset:32768
    v_mfma_f32_16x16x32_bf16 v[64:67], a[92:95], v[116:119], v[64:67]
    v_mfma_f32_16x16x32_bf16 v[68:71], a[156:159], v[116:119], v[68:71]
    ds_read_b64_tr_b16 v[102:103], v4 offset:33280
    v_mfma_f32_16x16x32_bf16 v[72:75], a[220:223], v[116:119], v[72:75]
    v_mfma_f32_16x16x32_bf16 v[76:79], a[28:31], v[120:123], v[76:79]
    ds_read_b64_tr_b16 v[104:105], v5 offset:32768
    v_mfma_f32_16x16x32_bf16 v[80:83], a[92:95], v[120:123], v[80:83]
    buffer_store_dwordx4 v[128:131], v18, s[16:19], s23 offen offset:1024 sc1
    v_mfma_f32_16x16x32_bf16 v[84:87], a[156:159], v[120:123], v[84:87]
    ds_read_b64_tr_b16 v[106:107], v5 offset:33280
    v_mfma_f32_16x16x32_bf16 v[88:91], a[220:223], v[120:123], v[88:91]
    s_waitcnt lgkmcnt(4)
    v_mfma_f32_16x16x32_bf16 v[28:31], a[32:35], v[92:95], v[28:31]
    ds_read_b64_tr_b16 v[108:109], v2 offset:36864
    v_mfma_f32_16x16x32_bf16 v[32:35], a[96:99], v[92:95], v[32:35]
    v_mfma_f32_16x16x32_bf16 v[36:39], a[160:163], v[92:95], v[36:39]
    ds_read_b64_tr_b16 v[110:111], v2 offset:37376
    v_mfma_f32_16x16x32_bf16 v[40:43], a[224:227], v[92:95], v[40:43]
    v_mfma_f32_16x16x32_bf16 v[44:47], a[32:35], v[96:99], v[44:47]
    ds_read_b64_tr_b16 v[112:113], v3 offset:36864
    v_mfma_f32_16x16x32_bf16 v[48:51], a[96:99], v[96:99], v[48:51]
    v_mfma_f32_16x16x32_bf16 v[52:55], a[160:163], v[96:99], v[52:55]
    ds_read_b64_tr_b16 v[114:115], v3 offset:37376
    v_mfma_f32_16x16x32_bf16 v[56:59], a[224:227], v[96:99], v[56:59]
    s_waitcnt lgkmcnt(4)
    v_mfma_f32_16x16x32_bf16 v[60:63], a[32:35], v[100:103], v[60:63]
    ds_read_b64_tr_b16 v[116:117], v4 offset:36864
    v_mfma_f32_16x16x32_bf16 v[64:67], a[96:99], v[100:103], v[64:67]
    v_mfma_f32_16x16x32_bf16 v[68:71], a[160:163], v[100:103], v[68:71]
    ds_read_b64_tr_b16 v[118:119], v4 offset:37376
    v_mfma_f32_16x16x32_bf16 v[72:75], a[224:227], v[100:103], v[72:75]
    v_mfma_f32_16x16x32_bf16 v[76:79], a[32:35], v[104:107], v[76:79]
    ds_read_b64_tr_b16 v[120:121], v5 offset:36864
    v_mfma_f32_16x16x32_bf16 v[80:83], a[96:99], v[104:107], v[80:83]
    buffer_store_dwordx4 v[132:135], v18, s[16:19], s23 offen offset:2048 sc1
    v_mfma_f32_16x16x32_bf16 v[84:87], a[160:163], v[104:107], v[84:87]
    ds_read_b64_tr_b16 v[122:123], v5 offset:37376
    v_mfma_f32_16x16x32_bf16 v[88:91], a[224:227], v[104:107], v[88:91]
    s_waitcnt lgkmcnt(4)
    v_mfma_f32_16x16x32_bf16 v[28:31], a[36:39], v[108:111], v[28:31]
    ds_read_b64_tr_b16 v[92:93], v2 offset:40960
    v_mfma_f32_16x16x32_bf16 v[32:35], a[100:103], v[108:111], v[32:35]
    v_mfma_f32_16x16x32_bf16 v[36:39], a[164:167], v[108:111], v[36:39]
    ds_read_b64_tr_b16 v[94:95], v2 offset:41472
    v_mfma_f32_16x16x32_bf16 v[40:43], a[228:231], v[108:111], v[40:43]
    v_mfma_f32_16x16x32_bf16 v[44:47], a[36:39], v[112:115], v[44:47]
    ds_read_b64_tr_b16 v[96:97], v3 offset:40960
    v_mfma_f32_16x16x32_bf16 v[48:51], a[100:103], v[112:115], v[48:51]
    buffer_load_dword v226, v227, s[40:43], s4 offen
    v_mfma_f32_16x16x32_bf16 v[52:55], a[164:167], v[112:115], v[52:55]
    s_add_u32 s4, s4, 1792
    ds_read_b64_tr_b16 v[98:99], v3 offset:41472
    v_mfma_f32_16x16x32_bf16 v[56:59], a[228:231], v[112:115], v[56:59]
    s_waitcnt lgkmcnt(4)
    v_mfma_f32_16x16x32_bf16 v[60:63], a[36:39], v[116:119], v[60:63]
    ds_read_b64_tr_b16 v[100:101], v4 offset:40960
    v_mfma_f32_16x16x32_bf16 v[64:67], a[100:103], v[116:119], v[64:67]
    v_mfma_f32_16x16x32_bf16 v[68:71], a[164:167], v[116:119], v[68:71]
    ds_read_b64_tr_b16 v[102:103], v4 offset:41472
    v_mfma_f32_16x16x32_bf16 v[72:75], a[228:231], v[116:119], v[72:75]
    v_mfma_f32_16x16x32_bf16 v[76:79], a[36:39], v[120:123], v[76:79]
    ds_read_b64_tr_b16 v[104:105], v5 offset:40960
    v_mfma_f32_16x16x32_bf16 v[80:83], a[100:103], v[120:123], v[80:83]
    buffer_store_dwordx4 v[136:139], v18, s[16:19], s23 offen offset:3072 sc1
    v_mfma_f32_16x16x32_bf16 v[84:87], a[164:167], v[120:123], v[84:87]
    ds_read_b64_tr_b16 v[106:107], v5 offset:41472
    v_mfma_f32_16x16x32_bf16 v[88:91], a[228:231], v[120:123], v[88:91]
    s_waitcnt lgkmcnt(4)
    v_mfma_f32_16x16x32_bf16 v[28:31], a[40:43], v[92:95], v[28:31]
    ds_read_b64_tr_b16 v[108:109], v2 offset:45056
    v_mfma_f32_16x16x32_bf16 v[32:35], a[104:107], v[92:95], v[32:35]
    v_mfma_f32_16x16x32_bf16 v[36:39], a[168:171], v[92:95], v[36:39]
    ds_read_b64_tr_b16 v[110:111], v2 offset:45568
    v_mfma_f32_16x16x32_bf16 v[40:43], a[232:235], v[92:95], v[40:43]
    v_mfma_f32_16x16x32_bf16 v[44:47], a[40:43], v[96:99], v[44:47]
    ds_read_b64_tr_b16 v[112:113], v3 offset:45056
    v_mfma_f32_16x16x32_bf16 v[48:51], a[104:107], v[96:99], v[48:51]
    v_mfma_f32_16x16x32_bf16 v[52:55], a[168:171], v[96:99], v[52:55]
    ds_read_b64_tr_b16 v[114:115], v3 offset:45568
    v_mfma_f32_16x16x32_bf16 v[56:59], a[232:235], v[96:99], v[56:59]
    s_waitcnt lgkmcnt(4)
    v_mfma_f32_16x16x32_bf16 v[60:63], a[40:43], v[100:103], v[60:63]
    ds_read_b64_tr_b16 v[116:117], v4 offset:45056
    v_mfma_f32_16x16x32_bf16 v[64:67], a[104:107], v[100:103], v[64:67]
    v_mfma_f32_16x16x32_bf16 v[68:71], a[168:171], v[100:103], v[68:71]
    ds_read_b64_tr_b16 v[118:119], v4 offset:45568
    v_mfma_f32_16x16x32_bf16 v[72:75], a[232:235], v[100:103], v[72:75]
    v_mfma_f32_16x16x32_bf16 v[76:79], a[40:43], v[104:107], v[76:79]
    ds_read_b64_tr_b16 v[120:121], v5 offset:45056
    v_mfma_f32_16x16x32_bf16 v[80:83], a[104:107], v[104:107], v[80:83]
    buffer_store_dwordx4 v[140:143], v20, s[16:19], s23 offen offset:0 sc1
    v_mfma_f32_16x16x32_bf16 v[84:87], a[168:171], v[104:107], v[84:87]
    ds_read_b64_tr_b16 v[122:123], v5 offset:45568
    v_mfma_f32_16x16x32_bf16 v[88:91], a[232:235], v[104:107], v[88:91]
    s_waitcnt lgkmcnt(4)
    v_mfma_f32_16x16x32_bf16 v[28:31], a[44:47], v[108:111], v[28:31]
    ds_read_b64_tr_b16 v[92:93], v2 offset:49152
    v_mfma_f32_16x16x32_bf16 v[32:35], a[108:111], v[108:111], v[32:35]
    v_mfma_f32_16x16x32_bf16 v[36:39], a[172:175], v[108:111], v[36:39]
    ds_read_b64_tr_b16 v[94:95], v2 offset:49664
    v_mfma_f32_16x16x32_bf16 v[40:43], a[236:239], v[108:111], v[40:43]
    v_mfma_f32_16x16x32_bf16 v[44:47], a[44:47], v[112:115], v[44:47]
    ds_read_b64_tr_b16 v[96:97], v3 offset:49152
    v_mfma_f32_16x16x32_bf16 v[48:51], a[108:111], v[112:115], v[48:51]
    v_mfma_f32_16x16x32_bf16 v[52:55], a[172:175], v[112:115], v[52:55]
    ds_read_b64_tr_b16 v[98:99], v3 offset:49664
    v_mfma_f32_16x16x32_bf16 v[56:59], a[236:239], v[112:115], v[56:59]
    s_waitcnt lgkmcnt(4)
    v_mfma_f32_16x16x32_bf16 v[60:63], a[44:47], v[116:119], v[60:63]
    ds_read_b64_tr_b16 v[100:101], v4 offset:49152
    v_mfma_f32_16x16x32_bf16 v[64:67], a[108:111], v[116:119], v[64:67]
    v_mfma_f32_16x16x32_bf16 v[68:71], a[172:175], v[116:119], v[68:71]
    ds_read_b64_tr_b16 v[102:103], v4 offset:49664
    v_mfma_f32_16x16x32_bf16 v[72:75], a[236:239], v[116:119], v[72:75]
    v_mfma_f32_16x16x32_bf16 v[76:79], a[44:47], v[120:123], v[76:79]
    ds_read_b64_tr_b16 v[104:105], v5 offset:49152
    v_mfma_f32_16x16x32_bf16 v[80:83], a[108:111], v[120:123], v[80:83]
    buffer_store_dwordx4 v[144:147], v20, s[16:19], s23 offen offset:1024 sc1
    v_mfma_f32_16x16x32_bf16 v[84:87], a[172:175], v[120:123], v[84:87]
    ds_read_b64_tr_b16 v[106:107], v5 offset:49664
    v_mfma_f32_16x16x32_bf16 v[88:91], a[236:239], v[120:123], v[88:91]
    s_waitcnt lgkmcnt(4)
    v_mfma_f32_16x16x32_bf16 v[28:31], a[48:51], v[92:95], v[28:31]
    ds_read_b64_tr_b16 v[108:109], v2 offset:53248
    v_mfma_f32_16x16x32_bf16 v[32:35], a[112:115], v[92:95], v[32:35]
    v_mfma_f32_16x16x32_bf16 v[36:39], a[176:179], v[92:95], v[36:39]
    ds_read_b64_tr_b16 v[110:111], v2 offset:53760
    v_mfma_f32_16x16x32_bf16 v[40:43], a[240:243], v[92:95], v[40:43]
    v_mfma_f32_16x16x32_bf16 v[44:47], a[48:51], v[96:99], v[44:47]
    ds_read_b64_tr_b16 v[112:113], v3 offset:53248
    v_mfma_f32_16x16x32_bf16 v[48:51], a[112:115], v[96:99], v[48:51]
    v_mfma_f32_16x16x32_bf16 v[52:55], a[176:179], v[96:99], v[52:55]
    ds_read_b64_tr_b16 v[114:115], v3 offset:53760
    v_mfma_f32_16x16x32_bf16 v[56:59], a[240:243], v[96:99], v[56:59]
    s_waitcnt lgkmcnt(4)
    v_mfma_f32_16x16x32_bf16 v[60:63], a[48:51], v[100:103], v[60:63]
    ds_read_b64_tr_b16 v[116:117], v4 offset:53248
    v_mfma_f32_16x16x32_bf16 v[64:67], a[112:115], v[100:103], v[64:67]
    v_mfma_f32_16x16x32_bf16 v[68:71], a[176:179], v[100:103], v[68:71]
    ds_read_b64_tr_b16 v[118:119], v4 offset:53760
    v_mfma_f32_16x16x32_bf16 v[72:75], a[240:243], v[100:103], v[72:75]
    v_mfma_f32_16x16x32_bf16 v[76:79], a[48:51], v[104:107], v[76:79]
    ds_read_b64_tr_b16 v[120:121], v5 offset:53248
    v_mfma_f32_16x16x32_bf16 v[80:83], a[112:115], v[104:107], v[80:83]
    buffer_store_dwordx4 v[148:151], v20, s[16:19], s23 offen offset:2048 sc1
    v_mfma_f32_16x16x32_bf16 v[84:87], a[176:179], v[104:107], v[84:87]
    ds_read_b64_tr_b16 v[122:123], v5 offset:53760
    v_mfma_f32_16x16x32_bf16 v[88:91], a[240:243], v[104:107], v[88:91]
    s_waitcnt lgkmcnt(4)
    v_mfma_f32_16x16x32_bf16 v[28:31], a[52:55], v[108:111], v[28:31]
    ds_read_b64_tr_b16 v[92:93], v2 offset:57344
    v_mfma_f32_16x16x32_bf16 v[32:35], a[116:119], v[108:111], v[32:35]
    v_mfma_f32_16x16x32_bf16 v[36:39], a[180:183], v[108:111], v[36:39]
    ds_read_b64_tr_b16 v[94:95], v2 offset:57856
    v_mfma_f32_16x16x32_bf16 v[40:43], a[244:247], v[108:111], v[40:43]
    v_mfma_f32_16x16x32_bf16 v[44:47], a[52:55], v[112:115], v[44:47]
    ds_read_b64_tr_b16 v[96:97], v3 offset:57344
    v_mfma_f32_16x16x32_bf16 v[48:51], a[116:119], v[112:115], v[48:51]
    v_mfma_f32_16x16x32_bf16 v[52:55], a[180:183], v[112:115], v[52:55]
    ds_read_b64_tr_b16 v[98:99], v3 offset:57856
    v_mfma_f32_16x16x32_bf16 v[56:59], a[244:247], v[112:115], v[56:59]
    s_waitcnt lgkmcnt(4)
    v_mfma_f32_16x16x32_bf16 v[60:63], a[52:55], v[116:119], v[60:63]
    ds_read_b64_tr_b16 v[100:101], v4 offset:57344
    v_mfma_f32_16x16x32_bf16 v[64:67], a[116:119], v[116:119], v[64:67]
    v_mfma_f32_16x16x32_bf16 v[68:71], a[180:183], v[116:119], v[68:71]
    ds_read_b64_tr_b16 v[102:103], v4 offset:57856
    v_mfma_f32_16x16x32_bf16 v[72:75], a[244:247], v[116:119], v[72:75]
    v_mfma_f32_16x16x32_bf16 v[76:79], a[52:55], v[120:123], v[76:79]
    ds_read_b64_tr_b16 v[104:105], v5 offset:57344
    v_mfma_f32_16x16x32_bf16 v[80:83], a[116:119], v[120:123], v[80:83]
    buffer_store_dwordx4 v[152:155], v20, s[16:19], s23 offen offset:3072 sc1
    v_mfma_f32_16x16x32_bf16 v[84:87], a[180:183], v[120:123], v[84:87]
    ds_read_b64_tr_b16 v[106:107], v5 offset:57856
    v_mfma_f32_16x16x32_bf16 v[88:91], a[244:247], v[120:123], v[88:91]
    s_waitcnt lgkmcnt(4)
    v_mfma_f32_16x16x32_bf16 v[28:31], a[56:59], v[92:95], v[28:31]
    ds_read_b64_tr_b16 v[108:109], v2 offset:61440
    v_mfma_f32_16x16x32_bf16 v[32:35], a[120:123], v[92:95], v[32:35]
    v_mfma_f32_16x16x32_bf16 v[36:39], a[184:187], v[92:95], v[36:39]
    ds_read_b64_tr_b16 v[110:111], v2 offset:61952
    v_mfma_f32_16x16x32_bf16 v[40:43], a[248:251], v[92:95], v[40:43]
    v_mfma_f32_16x16x32_bf16 v[44:47], a[56:59], v[96:99], v[44:47]
    ds_read_b64_tr_b16 v[112:113], v3 offset:61440
    v_mfma_f32_16x16x32_bf16 v[48:51], a[120:123], v[96:99], v[48:51]
    v_mfma_f32_16x16x32_bf16 v[52:55], a[184:187], v[96:99], v[52:55]
    ds_read_b64_tr_b16 v[114:115], v3 offset:61952
    v_mfma_f32_16x16x32_bf16 v[56:59], a[248:251], v[96:99], v[56:59]
    s_waitcnt lgkmcnt(4)
    v_mfma_f32_16x16x32_bf16 v[60:63], a[56:59], v[100:103], v[60:63]
    ds_read_b64_tr_b16 v[116:117], v4 offset:61440
    v_mfma_f32_16x16x32_bf16 v[64:67], a[120:123], v[100:103], v[64:67]
    v_mfma_f32_16x16x32_bf16 v[68:71], a[184:187], v[100:103], v[68:71]
    ds_read_b64_tr_b16 v[118:119], v4 offset:61952
    v_mfma_f32_16x16x32_bf16 v[72:75], a[248:251], v[100:103], v[72:75]
    v_mfma_f32_16x16x32_bf16 v[76:79], a[56:59], v[104:107], v[76:79]
    ds_read_b64_tr_b16 v[120:121], v5 offset:61440
    v_mfma_f32_16x16x32_bf16 v[80:83], a[120:123], v[104:107], v[80:83]
    v_mfma_f32_16x16x32_bf16 v[84:87], a[184:187], v[104:107], v[84:87]
    s_waitcnt vmcnt(9)
    ds_read_b64_tr_b16 v[122:123], v5 offset:61952
    v_mfma_f32_16x16x32_bf16 v[88:91], a[248:251], v[104:107], v[88:91]
    s_waitcnt lgkmcnt(4)
    v_xor_b32 v2, 0x10000, v2
    v_xor_b32 v3, 0x10000, v3
    v_mfma_f32_16x16x32_bf16 v[28:31], a[60:63], v[108:111], v[28:31]
    s_barrier
    ds_read_b64_tr_b16 v[92:93], v2 offset:0
    v_mfma_f32_16x16x32_bf16 v[32:35], a[124:127], v[108:111], v[32:35]
    v_xor_b32 v4, 0x10000, v4
    v_xor_b32 v5, 0x10000, v5
    v_mfma_f32_16x16x32_bf16 v[36:39], a[188:191], v[108:111], v[36:39]
    s_xor_b32 s48, s48, 0x10000
    ds_read_b64_tr_b16 v[94:95], v2 offset:512
    v_mfma_f32_16x16x32_bf16 v[40:43], a[252:255], v[108:111], v[40:43]
    v_mfma_f32_16x16x32_bf16 v[44:47], a[60:63], v[112:115], v[44:47]
    s_add_u32 s22, s22, s59
    ds_read_b64_tr_b16 v[96:97], v3 offset:0
    v_mfma_f32_16x16x32_bf16 v[48:51], a[124:127], v[112:115], v[48:51]
    v_mfma_f32_16x16x32_bf16 v[52:55], a[188:191], v[112:115], v[52:55]
    ds_read_b64_tr_b16 v[98:99], v3 offset:512
    v_mfma_f32_16x16x32_bf16 v[56:59], a[252:255], v[112:115], v[56:59]
    s_waitcnt lgkmcnt(4)
    v_mfma_f32_16x16x32_bf16 v[60:63], a[60:63], v[116:119], v[60:63]
    ds_read_b64_tr_b16 v[100:101], v4 offset:0
    v_mfma_f32_16x16x32_bf16 v[64:67], a[124:127], v[116:119], v[64:67]
    v_mfma_f32_16x16x32_bf16 v[68:71], a[188:191], v[116:119], v[68:71]
    ds_read_b64_tr_b16 v[102:103], v4 offset:512
    v_mfma_f32_16x16x32_bf16 v[72:75], a[252:255], v[116:119], v[72:75]
    v_mfma_f32_16x16x32_bf16 v[76:79], a[60:63], v[120:123], v[76:79]
    ds_read_b64_tr_b16 v[104:105], v5 offset:0
    v_mfma_f32_16x16x32_bf16 v[80:83], a[124:127], v[120:123], v[80:83]
    v_mfma_f32_16x16x32_bf16 v[84:87], a[188:191], v[120:123], v[84:87]
    ds_read_b64_tr_b16 v[106:107], v5 offset:512
    v_mfma_f32_16x16x32_bf16 v[88:91], a[252:255], v[120:123], v[88:91]
    s_waitcnt lgkmcnt(4)
    v_mfma_f32_16x16x32_bf16 v[156:159], a[0:3], v[92:95], 0
    s_lshr_b32 s23, s31, 1
    ds_read_b64_tr_b16 v[108:109], v2 offset:4096
    v_mul_f32 v28, s34, v28
    v_mfma_f32_16x16x32_bf16 v[160:163], a[64:67], v[92:95], 0
    s_lshl_b32 s23, s23, 20
    v_mul_f32 v29, s34, v29
    v_mul_f32 v30, s34, v30
    v_mfma_f32_16x16x32_bf16 v[164:167], a[128:131], v[92:95], 0
    s_add_u32 s23, s23, s32
    ds_read_b64_tr_b16 v[110:111], v2 offset:4608
    v_mul_f32 v31, s34, v31
    v_mfma_f32_16x16x32_bf16 v[168:171], a[192:195], v[92:95], 0
    s_and_b32 s33, s31, 1
    v_cvt_pk_bf16_f32 v124, v28, v29
    v_cvt_pk_bf16_f32 v125, v30, v31
    v_mfma_f32_16x16x32_bf16 v[172:175], a[0:3], v[96:99], 0
    s_lshl_b32 s33, s33, 12
    ds_read_b64_tr_b16 v[112:113], v3 offset:4096
    v_mul_f32 v32, s34, v32
    v_mfma_f32_16x16x32_bf16 v[176:179], a[64:67], v[96:99], 0
    s_add_u32 s23, s23, s33
    v_mul_f32 v33, s34, v33
    v_mul_f32 v34, s34, v34
    v_mfma_f32_16x16x32_bf16 v[180:183], a[128:131], v[96:99], 0
    s_add_u32 s31, s31, 1
    ds_read_b64_tr_b16 v[114:115], v3 offset:4608
    v_mul_f32 v35, s34, v35
    v_mfma_f32_16x16x32_bf16 v[184:187], a[192:195], v[96:99], 0
    s_waitcnt lgkmcnt(4)
    v_cvt_pk_bf16_f32 v126, v32, v33
    v_cvt_pk_bf16_f32 v127, v34, v35
    v_mfma_f32_16x16x32_bf16 v[188:191], a[0:3], v[100:103], 0
    s_barrier
    ds_read_b64_tr_b16 v[116:117], v4 offset:4096
    v_mul_f32 v36, s34, v36
    v_mfma_f32_16x16x32_bf16 v[192:195], a[64:67], v[100:103], 0
    v_mul_f32 v37, s34, v37
    v_mul_f32 v38, s34, v38
    v_mfma_f32_16x16x32_bf16 v[196:199], a[128:131], v[100:103], 0
    s_add_u32 m0, s48, 0
    ds_read_b64_tr_b16 v[118:119], v4 offset:4608
    v_mul_f32 v39, s34, v39
    v_mfma_f32_16x16x32_bf16 v[200:203], a[192:195], v[100:103], 0
    s_add_u32 s25, s22, s44
    v_cvt_pk_bf16_f32 v140, v36, v37
    v_cvt_pk_bf16_f32 v141, v38, v39
    v_mfma_f32_16x16x32_bf16 v[204:207], a[0:3], v[104:107], 0
    ds_read_b64_tr_b16 v[120:121], v5 offset:4096
    v_mul_f32 v40, s34, v40
    v_mfma_f32_16x16x32_bf16 v[208:211], a[64:67], v[104:107], 0
    buffer_load_dwordx4 v6, s[12:15], s25 offen offset:0 lds
    v_mul_f32 v41, s34, v41
    v_mfma_f32_16x16x32_bf16 v[212:215], a[128:131], v[104:107], 0
    ds_read_b64_tr_b16 v[122:123], v5 offset:4608
    v_mul_f32 v42, s34, v42
    v_mfma_f32_16x16x32_bf16 v[216:219], a[192:195], v[104:107], 0
    s_waitcnt lgkmcnt(4)
    v_mul_f32 v43, s34, v43
    v_cvt_pk_bf16_f32 v142, v40, v41
    v_mfma_f32_16x16x32_bf16 v[156:159], a[4:7], v[108:111], v[156:159]
    ds_read_b64_tr_b16 v[92:93], v2 offset:8192
    v_cvt_pk_bf16_f32 v143, v42, v43
    v_mfma_f32_16x16x32_bf16 v[160:163], a[68:71], v[108:111], v[160:163]
    v_mul_f32 v44, s34, v44
    v_mul_f32 v45, s34, v45
    v_mfma_f32_16x16x32_bf16 v[164:167], a[132:135], v[108:111], v[164:167]
    ds_read_b64_tr_b16 v[94:95], v2 offset:8704
    v_mul_f32 v46, s34, v46
    v_mfma_f32_16x16x32_bf16 v[168:171], a[196:199], v[108:111], v[168:171]
    buffer_load_dwordx4 v7, s[12:15], s25 offen offset:1024 lds
    v_mul_f32 v47, s34, v47
    v_mfma_f32_16x16x32_bf16 v[172:175], a[4:7], v[112:115], v[172:175]
    ds_read_b64_tr_b16 v[96:97], v3 offset:8192
    v_cvt_pk_bf16_f32 v128, v44, v45
    v_mfma_f32_16x16x32_bf16 v[176:179], a[68:71], v[112:115], v[176:179]
    v_cvt_pk_bf16_f32 v129, v46, v47
    v_mul_f32 v48, s34, v48
    v_mfma_f32_16x16x32_bf16 v[180:183], a[132:135], v[112:115], v[180:183]
    ds_read_b64_tr_b16 v[98:99], v3 offset:8704
    v_mul_f32 v49, s34, v49
    v_mfma_f32_16x16x32_bf16 v[184:187], a[196:199], v[112:115], v[184:187]
    s_waitcnt lgkmcnt(4)
    v_mul_f32 v50, s34, v50
    v_mul_f32 v51, s34, v51
    v_mfma_f32_16x16x32_bf16 v[188:191], a[4:7], v[116:119], v[188:191]
    ds_read_b64_tr_b16 v[100:101], v4 offset:8192
    v_cvt_pk_bf16_f32 v130, v48, v49
    v_mfma_f32_16x16x32_bf16 v[192:195], a[68:71], v[116:119], v[192:195]
    buffer_load_dwordx4 v8, s[12:15], s25 offen offset:2048 lds
    v_cvt_pk_bf16_f32 v131, v50, v51
    v_mfma_f32_16x16x32_bf16 v[196:199], a[132:135], v[116:119], v[196:199]
    ds_read_b64_tr_b16 v[102:103], v4 offset:8704
    v_mul_f32 v52, s34, v52
    v_mfma_f32_16x16x32_bf16 v[200:203], a[196:199], v[116:119], v[200:203]
    v_mul_f32 v53, s34, v53
    v_mul_f32 v54, s34, v54
    v_mfma_f32_16x16x32_bf16 v[204:207], a[4:7], v[120:123], v[204:207]
    ds_read_b64_tr_b16 v[104:105], v5 offset:8192
    v_mul_f32 v55, s34, v55
    v_mfma_f32_16x16x32_bf16 v[208:211], a[68:71], v[120:123], v[208:211]
    v_cvt_pk_bf16_f32 v144, v52, v53
    v_cvt_pk_bf16_f32 v145, v54, v55
    v_mfma_f32_16x16x32_bf16 v[212:215], a[132:135], v[120:123], v[212:215]
    ds_read_b64_tr_b16 v[106:107], v5 offset:8704
    v_mul_f32 v56, s34, v56
    v_mfma_f32_16x16x32_bf16 v[216:219], a[196:199], v[120:123], v[216:219]
    s_waitcnt lgkmcnt(4)
    buffer_load_dwordx4 v9, s[12:15], s25 offen offset:3072 lds
    v_mul_f32 v57, s34, v57
    v_mfma_f32_16x16x32_bf16 v[156:159], a[8:11], v[92:95], v[156:159]
    ds_read_b64_tr_b16 v[108:109], v2 offset:12288
    v_mul_f32 v58, s34, v58
    v_mfma_f32_16x16x32_bf16 v[160:163], a[72:75], v[92:95], v[160:163]
    v_mul_f32 v59, s34, v59
    v_cvt_pk_bf16_f32 v146, v56, v57
    v_mfma_f32_16x16x32_bf16 v[164:167], a[136:139], v[92:95], v[164:167]
    s_add_u32 m0, s48, 16384
    ds_read_b64_tr_b16 v[110:111], v2 offset:12800
    v_cvt_pk_bf16_f32 v147, v58, v59
    v_mfma_f32_16x16x32_bf16 v[168:171], a[200:203], v[92:95], v[168:171]
    s_add_u32 s25, s22, s45
    v_mul_f32 v60, s34, v60
    v_mul_f32 v61, s34, v61
    v_mfma_f32_16x16x32_bf16 v[172:175], a[8:11], v[96:99], v[172:175]
    ds_read_b64_tr_b16 v[112:113], v3 offset:12288
    v_mul_f32 v62, s34, v62
    v_mfma_f32_16x16x32_bf16 v[176:179], a[72:75], v[96:99], v[176:179]
    buffer_load_dwordx4 v6, s[12:15], s25 offen offset:0 lds
    v_mul_f32 v63, s34, v63
    v_mfma_f32_16x16x32_bf16 v[180:183], a[136:139], v[96:99], v[180:183]
    ds_read_b64_tr_b16 v[114:115], v3 offset:12800
    v_cvt_pk_bf16_f32 v132, v60, v61
    v_mfma_f32_16x16x32_bf16 v[184:187], a[200:203], v[96:99], v[184:187]
    s_waitcnt lgkmcnt(4)
    v_cvt_pk_bf16_f32 v133, v62, v63
    v_mul_f32 v64, s34, v64
    v_mfma_f32_16x16x32_bf16 v[188:191], a[8:11], v[100:103], v[188:191]
    ds_read_b64_tr_b16 v[116:117], v4 offset:12288
    v_mul_f32 v65, s34, v65
    v_mfma_f32_16x16x32_bf16 v[192:195], a[72:75], v[100:103], v[192:195]
    v_mul_f32 v66, s34, v66
    v_mul_f32 v67, s34, v67
    v_mfma_f32_16x16x32_bf16 v[196:199], a[136:139], v[100:103], v[196:199]
    ds_read_b64_tr_b16 v[118:119], v4 offset:12800
    v_cvt_pk_bf16_f32 v134, v64, v65
    v_mfma_f32_16x16x32_bf16 v[200:203], a[200:203], v[100:103], v[200:203]
    buffer_load_dwordx4 v7, s[12:15], s25 offen offset:1024 lds
    v_cvt_pk_bf16_f32 v135, v66, v67
    v_mfma_f32_16x16x32_bf16 v[204:207], a[8:11], v[104:107], v[204:207]
    ds_read_b64_tr_b16 v[120:121], v5 offset:12288
    v_mul_f32 v68, s34, v68
    v_mfma_f32_16x16x32_bf16 v[208:211], a[72:75], v[104:107], v[208:211]
    v_mul_f32 v69, s34, v69
    v_mul_f32 v70, s34, v70
    v_mfma_f32_16x16x32_bf16 v[212:215], a[136:139], v[104:107], v[212:215]
    ds_read_b64_tr_b16 v[122:123], v5 offset:12800
    v_mul_f32 v71, s34, v71
    v_mfma_f32_16x16x32_bf16 v[216:219], a[200:203], v[104:107], v[216:219]
    s_waitcnt lgkmcnt(4)
    v_cvt_pk_bf16_f32 v148, v68, v69
    v_cvt_pk_bf16_f32 v149, v70, v71
    v_mfma_f32_16x16x32_bf16 v[156:159], a[12:15], v[108:111], v[156:159]
    ds_read_b64_tr_b16 v[92:93], v2 offset:16384
    v_mul_f32 v72, s34, v72
    v_mfma_f32_16x16x32_bf16 v[160:163], a[76:79], v[108:111], v[160:163]
    buffer_load_dwordx4 v8, s[12:15], s25 offen offset:2048 lds
    v_mul_f32 v73, s34, v73
    v_mfma_f32_16x16x32_bf16 v[164:167], a[140:143], v[108:111], v[164:167]
    ds_read_b64_tr_b16 v[94:95], v2 offset:16896
    v_mul_f32 v74, s34, v74
    v_mfma_f32_16x16x32_bf16 v[168:171], a[204:207], v[108:111], v[168:171]
    v_mul_f32 v75, s34, v75
    v_cvt_pk_bf16_f32 v150, v72, v73
    v_mfma_f32_16x16x32_bf16 v[172:175], a[12:15], v[112:115], v[172:175]
    ds_read_b64_tr_b16 v[96:97], v3 offset:16384
    v_cvt_pk_bf16_f32 v151, v74, v75
    v_mfma_f32_16x16x32_bf16 v[176:179], a[76:79], v[112:115], v[176:179]
    v_mul_f32 v76, s34, v76
    v_mul_f32 v77, s34, v77
    v_mfma_f32_16x16x32_bf16 v[180:183], a[140:143], v[112:115], v[180:183]
    ds_read_b64_tr_b16 v[98:99], v3 offset:16896
    v_mul_f32 v78, s34, v78
    v_mfma_f32_16x16x32_bf16 v[184:187], a[204:207], v[112:115], v[184:187]
    s_waitcnt lgkmcnt(4)
    buffer_load_dwordx4 v9, s[12:15], s25 offen offset:3072 lds
    v_mul_f32 v79, s34, v79
    v_mfma_f32_16x16x32_bf16 v[188:191], a[12:15], v[116:119], v[188:191]
    ds_read_b64_tr_b16 v[100:101], v4 offset:16384
    v_cvt_pk_bf16_f32 v136, v76, v77
    v_mfma_f32_16x16x32_bf16 v[192:195], a[76:79], v[116:119], v[192:195]
    v_cvt_pk_bf16_f32 v137, v78, v79
    v_mul_f32 v80, s34, v80
    v_mfma_f32_16x16x32_bf16 v[196:199], a[140:143], v[116:119], v[196:199]
    s_add_u32 m0, s48, 32768
    ds_read_b64_tr_b16 v[102:103], v4 offset:16896
    v_mul_f32 v81, s34, v81
    v_mfma_f32_16x16x32_bf16 v[200:203], a[204:207], v[116:119], v[200:203]
    s_add_u32 s25, s22, s50
    v_mul_f32 v82, s34, v82
    v_mul_f32 v83, s34, v83
    v_mfma_f32_16x16x32_bf16 v[204:207], a[12:15], v[120:123], v[204:207]
    ds_read_b64_tr_b16 v[104:105], v5 offset:16384
    v_cvt_pk_bf16_f32 v138, v80, v81
    v_mfma_f32_16x16x32_bf16 v[208:211], a[76:79], v[120:123], v[208:211]
    buffer_load_dwordx4 v6, s[12:15], s25 offen offset:0 lds
    v_cvt_pk_bf16_f32 v139, v82, v83
    v_mfma_f32_16x16x32_bf16 v[212:215], a[140:143], v[120:123], v[212:215]
    ds_read_b64_tr_b16 v[106:107], v5 offset:16896
    v_mul_f32 v84, s34, v84
    v_mfma_f32_16x16x32_bf16 v[216:219], a[204:207], v[120:123], v[216:219]
    s_waitcnt lgkmcnt(4)
    v_mul_f32 v85, s34, v85
    v_mul_f32 v86, s34, v86
    v_mfma_f32_16x16x32_bf16 v[156:159], a[16:19], v[92:95], v[156:159]
    ds_read_b64_tr_b16 v[108:109], v2 offset:20480
    v_mul_f32 v87, s34, v87
    v_mfma_f32_16x16x32_bf16 v[160:163], a[80:83], v[92:95], v[160:163]
    v_cvt_pk_bf16_f32 v152, v84, v85
    v_cvt_pk_bf16_f32 v153, v86, v87
    v_mfma_f32_16x16x32_bf16 v[164:167], a[144:147], v[92:95], v[164:167]
    ds_read_b64_tr_b16 v[110:111], v2 offset:20992
    v_mul_f32 v88, s34, v88
    v_mfma_f32_16x16x32_bf16 v[168:171], a[208:211], v[92:95], v[168:171]
    buffer_load_dwordx4 v7, s[12:15], s25 offen offset:1024 lds
    v_mul_f32 v89, s34, v89
    v_mfma_f32_16x16x32_bf16 v[172:175], a[16:19], v[96:99], v[172:175]
    ds_read_b64_tr_b16 v[112:113], v3 offset:20480
    v_mul_f32 v90, s34, v90
    v_mfma_f32_16x16x32_bf16 v[176:179], a[80:83], v[96:99], v[176:179]
    v_mul_f32 v91, s34, v91
    v_cvt_pk_bf16_f32 v154, v88, v89
    v_mfma_f32_16x16x32_bf16 v[180:183], a[144:147], v[96:99], v[180:183]
    ds_read_b64_tr_b16 v[114:115], v3 offset:20992
    v_cvt_pk_bf16_f32 v155, v90, v91
    v_mfma_f32_16x16x32_bf16 v[184:187], a[208:211], v[96:99], v[184:187]
    s_waitcnt lgkmcnt(4)
    v_mfma_f32_16x16x32_bf16 v[188:191], a[16:19], v[100:103], v[188:191]
    ds_read_b64_tr_b16 v[116:117], v4 offset:20480
    v_mfma_f32_16x16x32_bf16 v[192:195], a[80:83], v[100:103], v[192:195]
    buffer_load_dwordx4 v8, s[12:15], s25 offen offset:2048 lds
    v_mfma_f32_16x16x32_bf16 v[196:199], a[144:147], v[100:103], v[196:199]
    ds_read_b64_tr_b16 v[118:119], v4 offset:20992
    v_mfma_f32_16x16x32_bf16 v[200:203], a[208:211], v[100:103], v[200:203]
    v_mfma_f32_16x16x32_bf16 v[204:207], a[16:19], v[104:107], v[204:207]
    ds_read_b64_tr_b16 v[120:121], v5 offset:20480
    v_mfma_f32_16x16x32_bf16 v[208:211], a[80:83], v[104:107], v[208:211]
    v_mfma_f32_16x16x32_bf16 v[212:215], a[144:147], v[104:107], v[212:215]
    ds_read_b64_tr_b16 v[122:123], v5 offset:20992
    v_mfma_f32_16x16x32_bf16 v[216:219], a[208:211], v[104:107], v[216:219]
    s_waitcnt lgkmcnt(4)
    buffer_load_dwordx4 v9, s[12:15], s25 offen offset:3072 lds
    v_mfma_f32_16x16x32_bf16 v[156:159], a[20:23], v[108:111], v[156:159]
    ds_read_b64_tr_b16 v[92:93], v2 offset:24576
    v_mfma_f32_16x16x32_bf16 v[160:163], a[84:87], v[108:111], v[160:163]
    v_mfma_f32_16x16x32_bf16 v[164:167], a[148:151], v[108:111], v[164:167]
    s_add_u32 m0, s48, 49152
    ds_read_b64_tr_b16 v[94:95], v2 offset:25088
    v_mfma_f32_16x16x32_bf16 v[168:171], a[212:215], v[108:111], v[168:171]
    s_add_u32 s25, s22, s51
    v_mfma_f32_16x16x32_bf16 v[172:175], a[20:23], v[112:115], v[172:175]
    ds_read_b64_tr_b16 v[96:97], v3 offset:24576
    v_mfma_f32_16x16x32_bf16 v[176:179], a[84:87], v[112:115], v[176:179]
    buffer_load_dwordx4 v6, s[12:15], s25 offen offset:0 lds
    v_mfma_f32_16x16x32_bf16 v[180:183], a[148:151], v[112:115], v[180:183]
    ds_read_b64_tr_b16 v[98:99], v3 offset:25088
    v_mfma_f32_16x16x32_bf16 v[184:187], a[212:215], v[112:115], v[184:187]
    s_waitcnt lgkmcnt(4)
    v_mfma_f32_16x16x32_bf16 v[188:191], a[20:23], v[116:119], v[188:191]
    ds_read_b64_tr_b16 v[100:101], v4 offset:24576
    v_mfma_f32_16x16x32_bf16 v[192:195], a[84:87], v[116:119], v[192:195]
    v_mfma_f32_16x16x32_bf16 v[196:199], a[148:151], v[116:119], v[196:199]
    ds_read_b64_tr_b16 v[102:103], v4 offset:25088
    v_mfma_f32_16x16x32_bf16 v[200:203], a[212:215], v[116:119], v[200:203]
    buffer_load_dwordx4 v7, s[12:15], s25 offen offset:1024 lds
    v_mfma_f32_16x16x32_bf16 v[204:207], a[20:23], v[120:123], v[204:207]
    ds_read_b64_tr_b16 v[104:105], v5 offset:24576
    v_mfma_f32_16x16x32_bf16 v[208:211], a[84:87], v[120:123], v[208:211]
    v_mfma_f32_16x16x32_bf16 v[212:215], a[148:151], v[120:123], v[212:215]
    ds_read_b64_tr_b16 v[106:107], v5 offset:25088
    v_mfma_f32_16x16x32_bf16 v[216:219], a[212:215], v[120:123], v[216:219]
    s_waitcnt lgkmcnt(4)
    v_mfma_f32_16x16x32_bf16 v[156:159], a[24:27], v[92:95], v[156:159]
    ds_read_b64_tr_b16 v[108:109], v2 offset:28672
    v_mfma_f32_16x16x32_bf16 v[160:163], a[88:91], v[92:95], v[160:163]
    buffer_load_dwordx4 v8, s[12:15], s25 offen offset:2048 lds
    v_mfma_f32_16x16x32_bf16 v[164:167], a[152:155], v[92:95], v[164:167]
    ds_read_b64_tr_b16 v[110:111], v2 offset:29184
    v_mfma_f32_16x16x32_bf16 v[168:171], a[216:219], v[92:95], v[168:171]
    v_mfma_f32_16x16x32_bf16 v[172:175], a[24:27], v[96:99], v[172:175]
    ds_read_b64_tr_b16 v[112:113], v3 offset:28672
    v_mfma_f32_16x16x32_bf16 v[176:179], a[88:91], v[96:99], v[176:179]
    v_mfma_f32_16x16x32_bf16 v[180:183], a[152:155], v[96:99], v[180:183]
    ds_read_b64_tr_b16 v[114:115], v3 offset:29184
    v_mfma_f32_16x16x32_bf16 v[184:187], a[216:219], v[96:99], v[184:187]
    s_waitcnt lgkmcnt(4)
    buffer_load_dwordx4 v9, s[12:15], s25 offen offset:3072 lds
    v_mfma_f32_16x16x32_bf16 v[188:191], a[24:27], v[100:103], v[188:191]
    ds_read_b64_tr_b16 v[116:117], v4 offset:28672
    v_mfma_f32_16x16x32_bf16 v[192:195], a[88:91], v[100:103], v[192:195]
    v_mfma_f32_16x16x32_bf16 v[196:199], a[152:155], v[100:103], v[196:199]
    s_add_u32 m0, s54, 131072
    ds_read_b64_tr_b16 v[118:119], v4 offset:29184
    v_mfma_f32_16x16x32_bf16 v[200:203], a[216:219], v[100:103], v[200:203]
    s_add_u32 s49, s53, 128
    v_mfma_f32_16x16x32_bf16 v[204:207], a[24:27], v[104:107], v[204:207]
    s_and_b32 s49, s49, 1023
    ds_read_b64_tr_b16 v[120:121], v5 offset:28672
    v_mfma_f32_16x16x32_bf16 v[208:211], a[88:91], v[104:107], v[208:211]
    s_add_u32 s57, s46, s49
    buffer_store_dwordx4 v[124:127], v18, s[16:19], s23 offen offset:0 sc1
    v_mfma_f32_16x16x32_bf16 v[212:215], a[152:155], v[104:107], v[212:215]
    ds_read_b64_tr_b16 v[122:123], v5 offset:29184
    v_mfma_f32_16x16x32_bf16 v[216:219], a[216:219], v[104:107], v[216:219]
    s_waitcnt lgkmcnt(4)
    v_mfma_f32_16x16x32_bf16 v[156:159], a[28:31], v[108:111], v[156:159]
    ds_read_b64_tr_b16 v[92:93], v2 offset:32768
    v_mfma_f32_16x16x32_bf16 v[160:163], a[92:95], v[108:111], v[160:163]
    buffer_load_dwordx4 v222, s[64:67], s57 offen offset:0 lds
    v_mfma_f32_16x16x32_bf16 v[164:167], a[156:159], v[108:111], v[164:167]
    ds_read_b64_tr_b16 v[94:95], v2 offset:33280
    v_mfma_f32_16x16x32_bf16 v[168:171], a[220:223], v[108:111], v[168:171]
    v_mfma_f32_16x16x32_bf16 v[172:175], a[28:31], v[112:115], v[172:175]
    ds_read_b64_tr_b16 v[96:97], v3 offset:32768
    v_mfma_f32_16x16x32_bf16 v[176:179], a[92:95], v[112:115], v[176:179]
    v_mfma_f32_16x16x32_bf16 v[180:183], a[156:159], v[112:115], v[180:183]
    ds_read_b64_tr_b16 v[98:99], v3 offset:33280
    v_mfma_f32_16x16x32_bf16 v[184:187], a[220:223], v[112:115], v[184:187]
    s_waitcnt lgkmcnt(4)
    v_mfma_f32_16x16x32_bf16 v[188:191], a[28:31], v[116:119], v[188:191]
    ds_read_b64_tr_b16 v[100:101], v4 offset:32768
    v_mfma_f32_16x16x32_bf16 v[192:195], a[92:95], v[116:119], v[192:195]
    v_mfma_f32_16x16x32_bf16 v[196:199], a[156:159], v[116:119], v[196:199]
    ds_read_b64_tr_b16 v[102:103], v4 offset:33280
    v_mfma_f32_16x16x32_bf16 v[200:203], a[220:223], v[116:119], v[200:203]
    v_mfma_f32_16x16x32_bf16 v[204:207], a[28:31], v[120:123], v[204:207]
    ds_read_b64_tr_b16 v[104:105], v5 offset:32768
    v_mfma_f32_16x16x32_bf16 v[208:211], a[92:95], v[120:123], v[208:211]
    buffer_store_dwordx4 v[128:131], v18, s[16:19], s23 offen offset:1024 sc1
    v_mfma_f32_16x16x32_bf16 v[212:215], a[156:159], v[120:123], v[212:215]
    ds_read_b64_tr_b16 v[106:107], v5 offset:33280
    v_mfma_f32_16x16x32_bf16 v[216:219], a[220:223], v[120:123], v[216:219]
    s_waitcnt lgkmcnt(4)
    v_mfma_f32_16x16x32_bf16 v[156:159], a[32:35], v[92:95], v[156:159]
    ds_read_b64_tr_b16 v[108:109], v2 offset:36864
    v_mfma_f32_16x16x32_bf16 v[160:163], a[96:99], v[92:95], v[160:163]
    buffer_load_dwordx4 v223, s[64:67], s57 offen offset:1024 lds
    v_mfma_f32_16x16x32_bf16 v[164:167], a[160:163], v[92:95], v[164:167]
    ds_read_b64_tr_b16 v[110:111], v2 offset:37376
    v_mfma_f32_16x16x32_bf16 v[168:171], a[224:227], v[92:95], v[168:171]
    v_mfma_f32_16x16x32_bf16 v[172:175], a[32:35], v[96:99], v[172:175]
    ds_read_b64_tr_b16 v[112:113], v3 offset:36864
    v_mfma_f32_16x16x32_bf16 v[176:179], a[96:99], v[96:99], v[176:179]
    v_mfma_f32_16x16x32_bf16 v[180:183], a[160:163], v[96:99], v[180:183]
    ds_read_b64_tr_b16 v[114:115], v3 offset:37376
    v_mfma_f32_16x16x32_bf16 v[184:187], a[224:227], v[96:99], v[184:187]
    s_waitcnt lgkmcnt(4)
    v_mfma_f32_16x16x32_bf16 v[188:191], a[32:35], v[100:103], v[188:191]
    ds_read_b64_tr_b16 v[116:117], v4 offset:36864
    v_mfma_f32_16x16x32_bf16 v[192:195], a[96:99], v[100:103], v[192:195]
    v_mfma_f32_16x16x32_bf16 v[196:199], a[160:163], v[100:103], v[196:199]
    ds_read_b64_tr_b16 v[118:119], v4 offset:37376
    v_mfma_f32_16x16x32_bf16 v[200:203], a[224:227], v[100:103], v[200:203]
    v_mfma_f32_16x16x32_bf16 v[204:207], a[32:35], v[104:107], v[204:207]
    ds_read_b64_tr_b16 v[120:121], v5 offset:36864
    v_mfma_f32_16x16x32_bf16 v[208:211], a[96:99], v[104:107], v[208:211]
    buffer_store_dwordx4 v[132:135], v18, s[16:19], s23 offen offset:2048 sc1
    v_mfma_f32_16x16x32_bf16 v[212:215], a[160:163], v[104:107], v[212:215]
    ds_read_b64_tr_b16 v[122:123], v5 offset:37376
    v_mfma_f32_16x16x32_bf16 v[216:219], a[224:227], v[104:107], v[216:219]
    s_waitcnt lgkmcnt(4)
    v_mfma_f32_16x16x32_bf16 v[156:159], a[36:39], v[108:111], v[156:159]
    ds_read_b64_tr_b16 v[92:93], v2 offset:40960
    v_mfma_f32_16x16x32_bf16 v[160:163], a[100:103], v[108:111], v[160:163]
    buffer_load_dwordx4 v224, s[64:67], s57 offen offset:2048 lds
    v_mfma_f32_16x16x32_bf16 v[164:167], a[164:167], v[108:111], v[164:167]
    ds_read_b64_tr_b16 v[94:95], v2 offset:41472
    v_mfma_f32_16x16x32_bf16 v[168:171], a[228:231], v[108:111], v[168:171]
    v_mfma_f32_16x16x32_bf16 v[172:175], a[36:39], v[112:115], v[172:175]
    ds_read_b64_tr_b16 v[96:97], v3 offset:40960
    v_mfma_f32_16x16x32_bf16 v[176:179], a[100:103], v[112:115], v[176:179]
    buffer_load_dword v226, v227, s[40:43], s4 offen
    v_mfma_f32_16x16x32_bf16 v[180:183], a[164:167], v[112:115], v[180:183]
    s_add_u32 s4, s4, 1792
    ds_read_b64_tr_b16 v[98:99], v3 offset:41472
    v_mfma_f32_16x16x32_bf16 v[184:187], a[228:231], v[112:115], v[184:187]
    s_waitcnt lgkmcnt(4)
    v_mfma_f32_16x16x32_bf16 v[188:191], a[36:39], v[116:119], v[188:191]
    ds_read_b64_tr_b16 v[100:101], v4 offset:40960
    v_mfma_f32_16x16x32_bf16 v[192:195], a[100:103], v[116:119], v[192:195]
    v_mfma_f32_16x16x32_bf16 v[196:199], a[164:167], v[116:119], v[196:199]
    ds_read_b64_tr_b16 v[102:103], v4 offset:41472
    v_mfma_f32_16x16x32_bf16 v[200:203], a[228:231], v[116:119], v[200:203]
    v_mfma_f32_16x16x32_bf16 v[204:207], a[36:39], v[120:123], v[204:207]
    ds_read_b64_tr_b16 v[104:105], v5 offset:40960
    v_mfma_f32_16x16x32_bf16 v[208:211], a[100:103], v[120:123], v[208:211]
    buffer_store_dwordx4 v[136:139], v18, s[16:19], s23 offen offset:3072 sc1
    v_mfma_f32_16x16x32_bf16 v[212:215], a[164:167], v[120:123], v[212:215]
    ds_read_b64_tr_b16 v[106:107], v5 offset:41472
    v_mfma_f32_16x16x32_bf16 v[216:219], a[228:231], v[120:123], v[216:219]
    s_waitcnt lgkmcnt(4)
    v_mfma_f32_16x16x32_bf16 v[156:159], a[40:43], v[92:95], v[156:159]
    ds_read_b64_tr_b16 v[108:109], v2 offset:45056
    v_mfma_f32_16x16x32_bf16 v[160:163], a[104:107], v[92:95], v[160:163]
    buffer_load_dwordx4 v225, s[64:67], s57 offen offset:3072 lds
    v_mfma_f32_16x16x32_bf16 v[164:167], a[168:171], v[92:95], v[164:167]
    ds_read_b64_tr_b16 v[110:111], v2 offset:45568
    v_mfma_f32_16x16x32_bf16 v[168:171], a[232:235], v[92:95], v[168:171]
    v_mfma_f32_16x16x32_bf16 v[172:175], a[40:43], v[96:99], v[172:175]
    ds_read_b64_tr_b16 v[112:113], v3 offset:45056
    v_mfma_f32_16x16x32_bf16 v[176:179], a[104:107], v[96:99], v[176:179]
    v_mfma_f32_16x16x32_bf16 v[180:183], a[168:171], v[96:99], v[180:183]
    ds_read_b64_tr_b16 v[114:115], v3 offset:45568
    v_mfma_f32_16x16x32_bf16 v[184:187], a[232:235], v[96:99], v[184:187]
    s_waitcnt lgkmcnt(4)
    v_mfma_f32_16x16x32_bf16 v[188:191], a[40:43], v[100:103], v[188:191]
    ds_read_b64_tr_b16 v[116:117], v4 offset:45056
    v_mfma_f32_16x16x32_bf16 v[192:195], a[104:107], v[100:103], v[192:195]
    v_mfma_f32_16x16x32_bf16 v[196:199], a[168:171], v[100:103], v[196:199]
    s_add_u32 m0, s54, 135168
    ds_read_b64_tr_b16 v[118:119], v4 offset:45568
    v_mfma_f32_16x16x32_bf16 v[200:203], a[232:235], v[100:103], v[200:203]
    s_add_u32 s57, s47, s49
    v_mfma_f32_16x16x32_bf16 v[204:207], a[40:43], v[104:107], v[204:207]
    ds_read_b64_tr_b16 v[120:121], v5 offset:45056
    v_mfma_f32_16x16x32_bf16 v[208:211], a[104:107], v[104:107], v[208:211]
    buffer_store_dwordx4 v[140:143], v20, s[16:19], s23 offen offset:0 sc1
    v_mfma_f32_16x16x32_bf16 v[212:215], a[168:171], v[104:107], v[212:215]
    ds_read_b64_tr_b16 v[122:123], v5 offset:45568
    v_mfma_f32_16x16x32_bf16 v[216:219], a[232:235], v[104:107], v[216:219]
    s_waitcnt lgkmcnt(4)
    v_mfma_f32_16x16x32_bf16 v[156:159], a[44:47], v[108:111], v[156:159]
    ds_read_b64_tr_b16 v[92:93], v2 offset:49152
    v_mfma_f32_16x16x32_bf16 v[160:163], a[108:111], v[108:111], v[160:163]
    buffer_load_dwordx4 v222, s[64:67], s57 offen offset:0 lds
    v_mfma_f32_16x16x32_bf16 v[164:167], a[172:175], v[108:111], v[164:167]
    ds_read_b64_tr_b16 v[94:95], v2 offset:49664
    v_mfma_f32_16x16x32_bf16 v[168:171], a[236:239], v[108:111], v[168:171]
    v_mfma_f32_16x16x32_bf16 v[172:175], a[44:47], v[112:115], v[172:175]
    ds_read_b64_tr_b16 v[96:97], v3 offset:49152
    v_mfma_f32_16x16x32_bf16 v[176:179], a[108:111], v[112:115], v[176:179]
    v_mfma_f32_16x16x32_bf16 v[180:183], a[172:175], v[112:115], v[180:183]
    ds_read_b64_tr_b16 v[98:99], v3 offset:49664
    v_mfma_f32_16x16x32_bf16 v[184:187], a[236:239], v[112:115], v[184:187]
    s_waitcnt lgkmcnt(4)
    v_mfma_f32_16x16x32_bf16 v[188:191], a[44:47], v[116:119], v[188:191]
    ds_read_b64_tr_b16 v[100:101], v4 offset:49152
    v_mfma_f32_16x16x32_bf16 v[192:195], a[108:111], v[116:119], v[192:195]
    v_mfma_f32_16x16x32_bf16 v[196:199], a[172:175], v[116:119], v[196:199]
    ds_read_b64_tr_b16 v[102:103], v4 offset:49664
    v_mfma_f32_16x16x32_bf16 v[200:203], a[236:239], v[116:119], v[200:203]
    v_mfma_f32_16x16x32_bf16 v[204:207], a[44:47], v[120:123], v[204:207]
    ds_read_b64_tr_b16 v[104:105], v5 offset:49152
    v_mfma_f32_16x16x32_bf16 v[208:211], a[108:111], v[120:123], v[208:211]
    buffer_store_dwordx4 v[144:147], v20, s[16:19], s23 offen offset:1024 sc1
    v_mfma_f32_16x16x32_bf16 v[212:215], a[172:175], v[120:123], v[212:215]
    ds_read_b64_tr_b16 v[106:107], v5 offset:49664
    v_mfma_f32_16x16x32_bf16 v[216:219], a[236:239], v[120:123], v[216:219]
    s_waitcnt lgkmcnt(4)
    v_mfma_f32_16x16x32_bf16 v[156:159], a[48:51], v[92:95], v[156:159]
    ds_read_b64_tr_b16 v[108:109], v2 offset:53248
    v_mfma_f32_16x16x32_bf16 v[160:163], a[112:115], v[92:95], v[160:163]
    buffer_load_dwordx4 v223, s[64:67], s57 offen offset:1024 lds
    v_mfma_f32_16x16x32_bf16 v[164:167], a[176:179], v[92:95], v[164:167]
    ds_read_b64_tr_b16 v[110:111], v2 offset:53760
    v_mfma_f32_16x16x32_bf16 v[168:171], a[240:243], v[92:95], v[168:171]
    v_mfma_f32_16x16x32_bf16 v[172:175], a[48:51], v[96:99], v[172:175]
    ds_read_b64_tr_b16 v[112:113], v3 offset:53248
    v_mfma_f32_16x16x32_bf16 v[176:179], a[112:115], v[96:99], v[176:179]
    v_mfma_f32_16x16x32_bf16 v[180:183], a[176:179], v[96:99], v[180:183]
    ds_read_b64_tr_b16 v[114:115], v3 offset:53760
    v_mfma_f32_16x16x32_bf16 v[184:187], a[240:243], v[96:99], v[184:187]
    s_waitcnt lgkmcnt(4)
    v_mfma_f32_16x16x32_bf16 v[188:191], a[48:51], v[100:103], v[188:191]
    ds_read_b64_tr_b16 v[116:117], v4 offset:53248
    v_mfma_f32_16x16x32_bf16 v[192:195], a[112:115], v[100:103], v[192:195]
    v_mfma_f32_16x16x32_bf16 v[196:199], a[176:179], v[100:103], v[196:199]
    ds_read_b64_tr_b16 v[118:119], v4 offset:53760
    v_mfma_f32_16x16x32_bf16 v[200:203], a[240:243], v[100:103], v[200:203]
    v_mfma_f32_16x16x32_bf16 v[204:207], a[48:51], v[104:107], v[204:207]
    ds_read_b64_tr_b16 v[120:121], v5 offset:53248
    v_mfma_f32_16x16x32_bf16 v[208:211], a[112:115], v[104:107], v[208:211]
    buffer_store_dwordx4 v[148:151], v20, s[16:19], s23 offen offset:2048 sc1
    v_mfma_f32_16x16x32_bf16 v[212:215], a[176:179], v[104:107], v[212:215]
    ds_read_b64_tr_b16 v[122:123], v5 offset:53760
    v_mfma_f32_16x16x32_bf16 v[216:219], a[240:243], v[104:107], v[216:219]
    s_waitcnt lgkmcnt(4)
    v_mfma_f32_16x16x32_bf16 v[156:159], a[52:55], v[108:111], v[156:159]
    ds_read_b64_tr_b16 v[92:93], v2 offset:57344
    v_mfma_f32_16x16x32_bf16 v[160:163], a[116:119], v[108:111], v[160:163]
    buffer_load_dwordx4 v224, s[64:67], s57 offen offset:2048 lds
    v_mfma_f32_16x16x32_bf16 v[164:167], a[180:183], v[108:111], v[164:167]
    ds_read_b64_tr_b16 v[94:95], v2 offset:57856
    v_mfma_f32_16x16x32_bf16 v[168:171], a[244:247], v[108:111], v[168:171]
    v_mfma_f32_16x16x32_bf16 v[172:175], a[52:55], v[112:115], v[172:175]
    ds_read_b64_tr_b16 v[96:97], v3 offset:57344
    v_mfma_f32_16x16x32_bf16 v[176:179], a[116:119], v[112:115], v[176:179]
    v_mfma_f32_16x16x32_bf16 v[180:183], a[180:183], v[112:115], v[180:183]
    ds_read_b64_tr_b16 v[98:99], v3 offset:57856
    v_mfma_f32_16x16x32_bf16 v[184:187], a[244:247], v[112:115], v[184:187]
    s_waitcnt lgkmcnt(4)
    v_mfma_f32_16x16x32_bf16 v[188:191], a[52:55], v[116:119], v[188:191]
    ds_read_b64_tr_b16 v[100:101], v4 offset:57344
    v_mfma_f32_16x16x32_bf16 v[192:195], a[116:119], v[116:119], v[192:195]
    v_mfma_f32_16x16x32_bf16 v[196:199], a[180:183], v[116:119], v[196:199]
    ds_read_b64_tr_b16 v[102:103], v4 offset:57856
    v_mfma_f32_16x16x32_bf16 v[200:203], a[244:247], v[116:119], v[200:203]
    v_mfma_f32_16x16x32_bf16 v[204:207], a[52:55], v[120:123], v[204:207]
    ds_read_b64_tr_b16 v[104:105], v5 offset:57344
    v_mfma_f32_16x16x32_bf16 v[208:211], a[116:119], v[120:123], v[208:211]
    buffer_store_dwordx4 v[152:155], v20, s[16:19], s23 offen offset:3072 sc1
    v_mfma_f32_16x16x32_bf16 v[212:215], a[180:183], v[120:123], v[212:215]
    ds_read_b64_tr_b16 v[106:107], v5 offset:57856
    v_mfma_f32_16x16x32_bf16 v[216:219], a[244:247], v[120:123], v[216:219]
    s_waitcnt lgkmcnt(4)
    v_mfma_f32_16x16x32_bf16 v[156:159], a[56:59], v[92:95], v[156:159]
    ds_read_b64_tr_b16 v[108:109], v2 offset:61440
    v_mfma_f32_16x16x32_bf16 v[160:163], a[120:123], v[92:95], v[160:163]
    buffer_load_dwordx4 v225, s[64:67], s57 offen offset:3072 lds
    v_mfma_f32_16x16x32_bf16 v[164:167], a[184:187], v[92:95], v[164:167]
    ds_read_b64_tr_b16 v[110:111], v2 offset:61952
    v_mfma_f32_16x16x32_bf16 v[168:171], a[248:251], v[92:95], v[168:171]
    v_mfma_f32_16x16x32_bf16 v[172:175], a[56:59], v[96:99], v[172:175]
    ds_read_b64_tr_b16 v[112:113], v3 offset:61440
    v_mfma_f32_16x16x32_bf16 v[176:179], a[120:123], v[96:99], v[176:179]
    v_mfma_f32_16x16x32_bf16 v[180:183], a[184:187], v[96:99], v[180:183]
    ds_read_b64_tr_b16 v[114:115], v3 offset:61952
    v_mfma_f32_16x16x32_bf16 v[184:187], a[248:251], v[96:99], v[184:187]
    s_waitcnt lgkmcnt(4)
    v_mfma_f32_16x16x32_bf16 v[188:191], a[56:59], v[100:103], v[188:191]
    ds_read_b64_tr_b16 v[116:117], v4 offset:61440
    v_mfma_f32_16x16x32_bf16 v[192:195], a[120:123], v[100:103], v[192:195]
    v_mfma_f32_16x16x32_bf16 v[196:199], a[184:187], v[100:103], v[196:199]
    ds_read_b64_tr_b16 v[118:119], v4 offset:61952
    v_mfma_f32_16x16x32_bf16 v[200:203], a[248:251], v[100:103], v[200:203]
    v_mfma_f32_16x16x32_bf16 v[204:207], a[56:59], v[104:107], v[204:207]
    ds_read_b64_tr_b16 v[120:121], v5 offset:61440
    v_mfma_f32_16x16x32_bf16 v[208:211], a[120:123], v[104:107], v[208:211]
    v_mfma_f32_16x16x32_bf16 v[212:215], a[184:187], v[104:107], v[212:215]
    s_waitcnt vmcnt(17)
    ds_read_b64_tr_b16 v[122:123], v5 offset:61952
    v_mfma_f32_16x16x32_bf16 v[216:219], a[248:251], v[104:107], v[216:219]
    s_waitcnt lgkmcnt(4)
    v_xor_b32 v2, 0x10000, v2
    v_xor_b32 v3, 0x10000, v3
    v_mfma_f32_16x16x32_bf16 v[156:159], a[60:63], v[108:111], v[156:159]
    s_barrier
    ds_read_b64_tr_b16 v[92:93], v2 offset:0
    v_mfma_f32_16x16x32_bf16 v[160:163], a[124:127], v[108:111], v[160:163]
    v_xor_b32 v4, 0x10000, v4
    v_xor_b32 v5, 0x10000, v5
    v_mfma_f32_16x16x32_bf16 v[164:167], a[188:191], v[108:111], v[164:167]
    s_xor_b32 s48, s48, 0x10000
    ds_read_b64_tr_b16 v[94:95], v2 offset:512
    v_mfma_f32_16x16x32_bf16 v[168:171], a[252:255], v[108:111], v[168:171]
    v_mfma_f32_16x16x32_bf16 v[172:175], a[60:63], v[112:115], v[172:175]
    s_add_u32 s22, s22, s59
    ds_read_b64_tr_b16 v[96:97], v3 offset:0
    v_mfma_f32_16x16x32_bf16 v[176:179], a[124:127], v[112:115], v[176:179]
    v_mfma_f32_16x16x32_bf16 v[180:183], a[188:191], v[112:115], v[180:183]
    ds_read_b64_tr_b16 v[98:99], v3 offset:512
    v_mfma_f32_16x16x32_bf16 v[184:187], a[252:255], v[112:115], v[184:187]
    s_waitcnt lgkmcnt(4)
    v_mfma_f32_16x16x32_bf16 v[188:191], a[60:63], v[116:119], v[188:191]
    ds_read_b64_tr_b16 v[100:101], v4 offset:0
    v_mfma_f32_16x16x32_bf16 v[192:195], a[124:127], v[116:119], v[192:195]
    v_mfma_f32_16x16x32_bf16 v[196:199], a[188:191], v[116:119], v[196:199]
    ds_read_b64_tr_b16 v[102:103], v4 offset:512
    v_mfma_f32_16x16x32_bf16 v[200:203], a[252:255], v[116:119], v[200:203]
    v_mfma_f32_16x16x32_bf16 v[204:207], a[60:63], v[120:123], v[204:207]
    ds_read_b64_tr_b16 v[104:105], v5 offset:0
    v_mfma_f32_16x16x32_bf16 v[208:211], a[124:127], v[120:123], v[208:211]
    v_mfma_f32_16x16x32_bf16 v[212:215], a[188:191], v[120:123], v[212:215]
    ds_read_b64_tr_b16 v[106:107], v5 offset:512
    v_mfma_f32_16x16x32_bf16 v[216:219], a[252:255], v[120:123], v[216:219]
    s_waitcnt lgkmcnt(4)
    s_cmp_lg_u32 s59, 128
    s_cbranch_scc0 L1V_last
    v_pk_mul_f32 v[156:157], v[156:157], v[232:233]
    v_pk_mul_f32 v[158:159], v[158:159], v[232:233]
    v_cvt_pk_bf16_f32 v124, v156, v157
    v_cvt_pk_bf16_f32 v125, v158, v159
    v_pk_mul_f32 v[160:161], v[160:161], v[232:233]
    v_pk_mul_f32 v[162:163], v[162:163], v[232:233]
    v_cvt_pk_bf16_f32 v126, v160, v161
    v_cvt_pk_bf16_f32 v127, v162, v163
    v_pk_mul_f32 v[164:165], v[164:165], v[232:233]
    v_pk_mul_f32 v[166:167], v[166:167], v[232:233]
    v_cvt_pk_bf16_f32 v140, v164, v165
    v_cvt_pk_bf16_f32 v141, v166, v167
    v_pk_mul_f32 v[168:169], v[168:169], v[232:233]
    v_pk_mul_f32 v[170:171], v[170:171], v[232:233]
    v_cvt_pk_bf16_f32 v142, v168, v169
    v_cvt_pk_bf16_f32 v143, v170, v171
    v_pk_mul_f32 v[172:173], v[172:173], v[232:233]
    v_pk_mul_f32 v[174:175], v[174:175], v[232:233]
    v_cvt_pk_bf16_f32 v128, v172, v173
    v_cvt_pk_bf16_f32 v129, v174, v175
    v_pk_mul_f32 v[176:177], v[176:177], v[232:233]
    v_pk_mul_f32 v[178:179], v[178:179], v[232:233]
    v_cvt_pk_bf16_f32 v130, v176, v177
    v_cvt_pk_bf16_f32 v131, v178, v179
    v_pk_mul_f32 v[180:181], v[180:181], v[232:233]
    v_pk_mul_f32 v[182:183], v[182:183], v[232:233]
    v_cvt_pk_bf16_f32 v144, v180, v181
    v_cvt_pk_bf16_f32 v145, v182, v183
    v_pk_mul_f32 v[184:185], v[184:185], v[232:233]
    v_pk_mul_f32 v[186:187], v[186:187], v[232:233]
    v_cvt_pk_bf16_f32 v146, v184, v185
    v_cvt_pk_bf16_f32 v147, v186, v187
    v_pk_mul_f32 v[188:189], v[188:189], v[232:233]
    v_pk_mul_f32 v[190:191], v[190:191], v[232:233]
    v_cvt_pk_bf16_f32 v132, v188, v189
    v_cvt_pk_bf16_f32 v133, v190, v191
    v_pk_mul_f32 v[192:193], v[192:193], v[232:233]
    v_pk_mul_f32 v[194:195], v[194:195], v[232:233]
    v_cvt_pk_bf16_f32 v134, v192, v193
    v_cvt_pk_bf16_f32 v135, v194, v195
    v_pk_mul_f32 v[196:197], v[196:197], v[232:233]
    v_pk_mul_f32 v[198:199], v[198:199], v[232:233]
    v_cvt_pk_bf16_f32 v148, v196, v197
    v_cvt_pk_bf16_f32 v149, v198, v199
    v_pk_mul_f32 v[200:201], v[200:201], v[232:233]
    v_pk_mul_f32 v[202:203], v[202:203], v[232:233]
    v_cvt_pk_bf16_f32 v150, v200, v201
    v_cvt_pk_bf16_f32 v151, v202, v203
    v_pk_mul_f32 v[204:205], v[204:205], v[232:233]
    v_pk_mul_f32 v[206:207], v[206:207], v[232:233]
    v_cvt_pk_bf16_f32 v136, v204, v205
    v_cvt_pk_bf16_f32 v137, v206, v207
    v_pk_mul_f32 v[208:209], v[208:209], v[232:233]
    v_pk_mul_f32 v[210:211], v[210:211], v[232:233]
    v_cvt_pk_bf16_f32 v138, v208, v209
    v_cvt_pk_bf16_f32 v139, v210, v211
    v_pk_mul_f32 v[212:213], v[212:213], v[232:233]
    v_pk_mul_f32 v[214:215], v[214:215], v[232:233]
    v_cvt_pk_bf16_f32 v152, v212, v213
    v_cvt_pk_bf16_f32 v153, v214, v215
    v_pk_mul_f32 v[216:217], v[216:217], v[232:233]
    v_pk_mul_f32 v[218:219], v[218:219], v[232:233]
    v_cvt_pk_bf16_f32 v154, v216, v217
    v_cvt_pk_bf16_f32 v155, v218, v219
    s_branch L1V_fin
L1V_last:
    v_mfma_f32_16x16x32_bf16 v[28:31], a[0:3], v[92:95], 0
    s_lshr_b32 s23, s31, 1
    ds_read_b64_tr_b16 v[108:109], v2 offset:4096
    v_mul_f32 v156, s34, v156
    v_mfma_f32_16x16x32_bf16 v[32:35], a[64:67], v[92:95], 0
    s_lshl_b32 s23, s23, 20
    v_mul_f32 v157, s34, v157
    v_mul_f32 v158, s34, v158
    v_mfma_f32_16x16x32_bf16 v[36:39], a[128:131], v[92:95], 0
    s_add_u32 s23, s23, s32
    ds_read_b64_tr_b16 v[110:111], v2 offset:4608
    v_mul_f32 v159, s34, v159
    v_mfma_f32_16x16x32_bf16 v[40:43], a[192:195], v[92:95], 0
    s_and_b32 s33, s31, 1
    v_cvt_pk_bf16_f32 v124, v156, v157
    v_cvt_pk_bf16_f32 v125, v158, v159
    v_mfma_f32_16x16x32_bf16 v[44:47], a[0:3], v[96:99], 0
    s_lshl_b32 s33, s33, 12
    ds_read_b64_tr_b16 v[112:113], v3 offset:4096
    v_mul_f32 v160, s34, v160
    v_mfma_f32_16x16x32_bf16 v[48:51], a[64:67], v[96:99], 0
    s_add_u32 s23, s23, s33
    v_mul_f32 v161, s34, v161
    v_mul_f32 v162, s34, v162
    v_mfma_f32_16x16x32_bf16 v[52:55], a[128:131], v[96:99], 0
    s_add_u32 s31, s31, 1
    ds_read_b64_tr_b16 v[114:115], v3 offset:4608
    v_mul_f32 v163, s34, v163
    v_mfma_f32_16x16x32_bf16 v[56:59], a[192:195], v[96:99], 0
    s_waitcnt lgkmcnt(4)
    v_cvt_pk_bf16_f32 v126, v160, v161
    v_cvt_pk_bf16_f32 v127, v162, v163
    v_mfma_f32_16x16x32_bf16 v[60:63], a[0:3], v[100:103], 0
    s_barrier
    ds_read_b64_tr_b16 v[116:117], v4 offset:4096
    v_mul_f32 v164, s34, v164
    v_mfma_f32_16x16x32_bf16 v[64:67], a[64:67], v[100:103], 0
    v_mul_f32 v165, s34, v165
    v_mul_f32 v166, s34, v166
    v_mfma_f32_16x16x32_bf16 v[68:71], a[128:131], v[100:103], 0
    s_add_u32 m0, s54, 0
    ds_read_b64_tr_b16 v[118:119], v4 offset:4608
    v_mul_f32 v167, s34, v167
    v_mfma_f32_16x16x32_bf16 v[72:75], a[192:195], v[100:103], 0
    s_add_u32 s49, s53, 0
    v_cvt_pk_bf16_f32 v140, v164, v165
    v_cvt_pk_bf16_f32 v141, v166, v167
    v_mfma_f32_16x16x32_bf16 v[76:79], a[0:3], v[104:107], 0
    s_and_b32 s49, s49, 1023
    ds_read_b64_tr_b16 v[120:121], v5 offset:4096
    v_mul_f32 v168, s34, v168
    v_mfma_f32_16x16x32_bf16 v[80:83], a[64:67], v[104:107], 0
    s_add_u32 s57, s46, s49
    v_mul_f32 v169, s34, v169
    v_mul_f32 v170, s34, v170
    v_mfma_f32_16x16x32_bf16 v[84:87], a[128:131], v[104:107], 0
    ds_read_b64_tr_b16 v[122:123], v5 offset:4608
    v_mul_f32 v171, s34, v171
    v_mfma_f32_16x16x32_bf16 v[88:91], a[192:195], v[104:107], 0
    s_waitcnt lgkmcnt(4)
    v_cvt_pk_bf16_f32 v142, v168, v169
    v_cvt_pk_bf16_f32 v143, v170, v171
    v_mfma_f32_16x16x32_bf16 v[28:31], a[4:7], v[108:111], v[28:31]
    ds_read_b64_tr_b16 v[92:93], v2 offset:8192
    v_mul_f32 v172, s34, v172
    v_mfma_f32_16x16x32_bf16 v[32:35], a[68:71], v[108:111], v[32:35]
    buffer_load_dwordx4 v222, s[64:67], s57 offen offset:0 lds
    v_mul_f32 v173, s34, v173
    v_mfma_f32_16x16x32_bf16 v[36:39], a[132:135], v[108:111], v[36:39]
    ds_read_b64_tr_b16 v[94:95], v2 offset:8704
    v_mul_f32 v174, s34, v174
    v_mfma_f32_16x16x32_bf16 v[40:43], a[196:199], v[108:111], v[40:43]
    v_mul_f32 v175, s34, v175
    v_cvt_pk_bf16_f32 v128, v172, v173
    v_mfma_f32_16x16x32_bf16 v[44:47], a[4:7], v[112:115], v[44:47]
    ds_read_b64_tr_b16 v[96:97], v3 offset:8192
    v_cvt_pk_bf16_f32 v129, v174, v175
    v_mfma_f32_16x16x32_bf16 v[48:51], a[68:71], v[112:115], v[48:51]
    v_mul_f32 v176, s34, v176
    v_mul_f32 v177, s34, v177
    v_mfma_f32_16x16x32_bf16 v[52:55], a[132:135], v[112:115], v[52:55]
    ds_read_b64_tr_b16 v[98:99], v3 offset:8704
    v_mul_f32 v178, s34, v178
    v_mfma_f32_16x16x32_bf16 v[56:59], a[196:199], v[112:115], v[56:59]
    s_waitcnt lgkmcnt(4)
    buffer_load_dwordx4 v223, s[64:67], s57 offen offset:1024 lds
    v_mul_f32 v179, s34, v179
    v_mfma_f32_16x16x32_bf16 v[60:63], a[4:7], v[116:119], v[60:63]
    ds_read_b64_tr_b16 v[100:101], v4 offset:8192
    v_cvt_pk_bf16_f32 v130, v176, v177
    v_mfma_f32_16x16x32_bf16 v[64:67], a[68:71], v[116:119], v[64:67]
    v_cvt_pk_bf16_f32 v131, v178, v179
    v_mul_f32 v180, s34, v180
    v_mfma_f32_16x16x32_bf16 v[68:71], a[132:135], v[116:119], v[68:71]
    ds_read_b64_tr_b16 v[102:103], v4 offset:8704
    v_mul_f32 v181, s34, v181
    v_mfma_f32_16x16x32_bf16 v[72:75], a[196:199], v[116:119], v[72:75]
    v_mul_f32 v182, s34, v182
    v_mul_f32 v183, s34, v183
    v_mfma_f32_16x16x32_bf16 v[76:79], a[4:7], v[120:123], v[76:79]
    ds_read_b64_tr_b16 v[104:105], v5 offset:8192
    v_cvt_pk_bf16_f32 v144, v180, v181
    v_mfma_f32_16x16x32_bf16 v[80:83], a[68:71], v[120:123], v[80:83]
    v_cvt_pk_bf16_f32 v145, v182, v183
    v_mul_f32 v184, s34, v184
    v_mfma_f32_16x16x32_bf16 v[84:87], a[132:135], v[120:123], v[84:87]
    ds_read_b64_tr_b16 v[106:107], v5 offset:8704
    v_mul_f32 v185, s34, v185
    v_mfma_f32_16x16x32_bf16 v[88:91], a[196:199], v[120:123], v[88:91]
    s_waitcnt lgkmcnt(4)
    buffer_load_dwordx4 v224, s[64:67], s57 offen offset:2048 lds
    v_mul_f32 v186, s34, v186
    v_mfma_f32_16x16x32_bf16 v[28:31], a[8:11], v[92:95], v[28:31]
    ds_read_b64_tr_b16 v[108:109], v2 offset:12288
    v_mul_f32 v187, s34, v187
    v_mfma_f32_16x16x32_bf16 v[32:35], a[72:75], v[92:95], v[32:35]
    v_cvt_pk_bf16_f32 v146, v184, v185
    v_cvt_pk_bf16_f32 v147, v186, v187
    v_mfma_f32_16x16x32_bf16 v[36:39], a[136:139], v[92:95], v[36:39]
    ds_read_b64_tr_b16 v[110:111], v2 offset:12800
    v_mul_f32 v188, s34, v188
    v_mfma_f32_16x16x32_bf16 v[40:43], a[200:203], v[92:95], v[40:43]
    v_mul_f32 v189, s34, v189
    v_mul_f32 v190, s34, v190
    v_mfma_f32_16x16x32_bf16 v[44:47], a[8:11], v[96:99], v[44:47]
    ds_read_b64_tr_b16 v[112:113], v3 offset:12288
    v_mul_f32 v191, s34, v191
    v_mfma_f32_16x16x32_bf16 v[48:51], a[72:75], v[96:99], v[48:51]
    v_cvt_pk_bf16_f32 v132, v188, v189
    v_cvt_pk_bf16_f32 v133, v190, v191
    v_mfma_f32_16x16x32_bf16 v[52:55], a[136:139], v[96:99], v[52:55]
    ds_read_b64_tr_b16 v[114:115], v3 offset:12800
    v_mul_f32 v192, s34, v192
    v_mfma_f32_16x16x32_bf16 v[56:59], a[200:203], v[96:99], v[56:59]
    s_waitcnt lgkmcnt(4)
    buffer_load_dwordx4 v225, s[64:67], s57 offen offset:3072 lds
    v_mul_f32 v193, s34, v193
    v_mfma_f32_16x16x32_bf16 v[60:63], a[8:11], v[100:103], v[60:63]
    ds_read_b64_tr_b16 v[116:117], v4 offset:12288
    v_mul_f32 v194, s34, v194
    v_mfma_f32_16x16x32_bf16 v[64:67], a[72:75], v[100:103], v[64:67]
    v_mul_f32 v195, s34, v195
    v_cvt_pk_bf16_f32 v134, v192, v193
    v_mfma_f32_16x16x32_bf16 v[68:71], a[136:139], v[100:103], v[68:71]
    s_add_u32 m0, s54, 4096
    ds_read_b64_tr_b16 v[118:119], v4 offset:12800
    v_cvt_pk_bf16_f32 v135, v194, v195
    v_mfma_f32_16x16x32_bf16 v[72:75], a[200:203], v[100:103], v[72:75]
    s_add_u32 s57, s47, s49
    v_mul_f32 v196, s34, v196
    v_mul_f32 v197, s34, v197
    v_mfma_f32_16x16x32_bf16 v[76:79], a[8:11], v[104:107], v[76:79]
    ds_read_b64_tr_b16 v[120:121], v5 offset:12288
    v_mul_f32 v198, s34, v198
    v_mfma_f32_16x16x32_bf16 v[80:83], a[72:75], v[104:107], v[80:83]
    v_mul_f32 v199, s34, v199
    v_cvt_pk_bf16_f32 v148, v196, v197
    v_mfma_f32_16x16x32_bf16 v[84:87], a[136:139], v[104:107], v[84:87]
    ds_read_b64_tr_b16 v[122:123], v5 offset:12800
    v_cvt_pk_bf16_f32 v149, v198, v199
    v_mfma_f32_16x16x32_bf16 v[88:91], a[200:203], v[104:107], v[88:91]
    s_waitcnt lgkmcnt(4)
    v_mul_f32 v200, s34, v200
    v_mul_f32 v201, s34, v201
    v_mfma_f32_16x16x32_bf16 v[28:31], a[12:15], v[108:111], v[28:31]
    ds_read_b64_tr_b16 v[92:93], v2 offset:16384
    v_mul_f32 v202, s34, v202
    v_mfma_f32_16x16x32_bf16 v[32:35], a[76:79], v[108:111], v[32:35]
    buffer_load_dwordx4 v222, s[64:67], s57 offen offset:0 lds
    v_mul_f32 v203, s34, v203
    v_mfma_f32_16x16x32_bf16 v[36:39], a[140:143], v[108:111], v[36:39]
    ds_read_b64_tr_b16 v[94:95], v2 offset:16896
    v_cvt_pk_bf16_f32 v150, v200, v201
    v_mfma_f32_16x16x32_bf16 v[40:43], a[204:207], v[108:111], v[40:43]
    v_cvt_pk_bf16_f32 v151, v202, v203
    v_mul_f32 v204, s34, v204
    v_mfma_f32_16x16x32_bf16 v[44:47], a[12:15], v[112:115], v[44:47]
    ds_read_b64_tr_b16 v[96:97], v3 offset:16384
    v_mul_f32 v205, s34, v205
    v_mfma_f32_16x16x32_bf16 v[48:51], a[76:79], v[112:115], v[48:51]
    v_mul_f32 v206, s34, v206
    v_mul_f32 v207, s34, v207
    v_mfma_f32_16x16x32_bf16 v[52:55], a[140:143], v[112:115], v[52:55]
    ds_read_b64_tr_b16 v[98:99], v3 offset:16896
    v_cvt_pk_bf16_f32 v136, v204, v205
    v_mfma_f32_16x16x32_bf16 v[56:59], a[204:207], v[112:115], v[56:59]
    s_waitcnt lgkmcnt(4)
    buffer_load_dwordx4 v223, s[64:67], s57 offen offset:1024 lds
    v_cvt_pk_bf16_f32 v137, v206, v207
    v_mfma_f32_16x16x32_bf16 v[60:63], a[12:15], v[116:119], v[60:63]
    ds_read_b64_tr_b16 v[100:101], v4 offset:16384
    v_mul_f32 v208, s34, v208
    v_mfma_f32_16x16x32_bf16 v[64:67], a[76:79], v[116:119], v[64:67]
    v_mul_f32 v209, s34, v209
    v_mul_f32 v210, s34, v210
    v_mfma_f32_16x16x32_bf16 v[68:71], a[140:143], v[116:119], v[68:71]
    ds_read_b64_tr_b16 v[102:103], v4 offset:16896
    v_mul_f32 v211, s34, v211
    v_mfma_f32_16x16x32_bf16 v[72:75], a[204:207], v[116:119], v[72:75]
    v_cvt_pk_bf16_f32 v138, v208, v209
    v_cvt_pk_bf16_f32 v139, v210, v211
    v_mfma_f32_16x16x32_bf16 v[76:79], a[12:15], v[120:123], v[76:79]
    ds_read_b64_tr_b16 v[104:105], v5 offset:16384
    v_mul_f32 v212, s34, v212
    v_mfma_f32_16x16x32_bf16 v[80:83], a[76:79], v[120:123], v[80:83]
    v_mul_f32 v213, s34, v213
    v_mul_f32 v214, s34, v214
    v_mfma_f32_16x16x32_bf16 v[84:87], a[140:143], v[120:123], v[84:87]
    ds_read_b64_tr_b16 v[106:107], v5 offset:16896
    v_mul_f32 v215, s34, v215
    v_mfma_f32_16x16x32_bf16 v[88:91], a[204:207], v[120:123], v[88:91]
    s_waitcnt lgkmcnt(4)
    buffer_load_dwordx4 v224, s[64:67], s57 offen offset:2048 lds
    v_cvt_pk_bf16_f32 v152, v212, v213
    v_mfma_f32_16x16x32_bf16 v[28:31], a[16:19], v[92:95], v[28:31]
    ds_read_b64_tr_b16 v[108:109], v2 offset:20480
    v_cvt_pk_bf16_f32 v153, v214, v215
    v_mfma_f32_16x16x32_bf16 v[32:35], a[80:83], v[92:95], v[32:35]
    v_mul_f32 v216, s34, v216
    v_mul_f32 v217, s34, v217
    v_mfma_f32_16x16x32_bf16 v[36:39], a[144:147], v[92:95], v[36:39]
    ds_read_b64_tr_b16 v[110:111], v2 offset:20992
    v_mul_f32 v218, s34, v218
    v_mfma_f32_16x16x32_bf16 v[40:43], a[208:211], v[92:95], v[40:43]
    v_mul_f32 v219, s34, v219
    v_cvt_pk_bf16_f32 v154, v216, v217
    v_mfma_f32_16x16x32_bf16 v[44:47], a[16:19], v[96:99], v[44:47]
    ds_read_b64_tr_b16 v[112:113], v3 offset:20480
    v_cvt_pk_bf16_f32 v155, v218, v219
    v_mfma_f32_16x16x32_bf16 v[48:51], a[80:83], v[96:99], v[48:51]
    v_mfma_f32_16x16x32_bf16 v[52:55], a[144:147], v[96:99], v[52:55]
    ds_read_b64_tr_b16 v[114:115], v3 offset:20992
    v_mfma_f32_16x16x32_bf16 v[56:59], a[208:211], v[96:99], v[56:59]
    s_waitcnt lgkmcnt(4)
    buffer_load_dwordx4 v225, s[64:67], s57 offen offset:3072 lds
    v_mfma_f32_16x16x32_bf16 v[60:63], a[16:19], v[100:103], v[60:63]
    ds_read_b64_tr_b16 v[116:117], v4 offset:20480
    v_mfma_f32_16x16x32_bf16 v[64:67], a[80:83], v[100:103], v[64:67]
    v_mfma_f32_16x16x32_bf16 v[68:71], a[144:147], v[100:103], v[68:71]
    s_add_u32 m0, s55, 32768
    ds_read_b64_tr_b16 v[118:119], v4 offset:20992
    v_mfma_f32_16x16x32_bf16 v[72:75], a[208:211], v[100:103], v[72:75]
    s_lshl_b32 s57, s49, 12
    v_mfma_f32_16x16x32_bf16 v[76:79], a[16:19], v[104:107], v[76:79]
    s_add_u32 s57, s57, s52
    ds_read_b64_tr_b16 v[120:121], v5 offset:20480
    v_mfma_f32_16x16x32_bf16 v[80:83], a[80:83], v[104:107], v[80:83]
    v_mfma_f32_16x16x32_bf16 v[84:87], a[144:147], v[104:107], v[84:87]
    ds_read_b64_tr_b16 v[122:123], v5 offset:20992
    v_mfma_f32_16x16x32_bf16 v[88:91], a[208:211], v[104:107], v[88:91]
    s_waitcnt lgkmcnt(4)
    v_mfma_f32_16x16x32_bf16 v[28:31], a[20:23], v[108:111], v[28:31]
    ds_read_b64_tr_b16 v[92:93], v2 offset:24576
    v_mfma_f32_16x16x32_bf16 v[32:35], a[84:87], v[108:111], v[32:35]
    buffer_load_dwordx4 v252, s[68:71], s57 offen offset:0 lds
    v_mfma_f32_16x16x32_bf16 v[36:39], a[148:151], v[108:111], v[36:39]
    ds_read_b64_tr_b16 v[94:95], v2 offset:25088
    v_mfma_f32_16x16x32_bf16 v[40:43], a[212:215], v[108:111], v[40:43]
    v_mfma_f32_16x16x32_bf16 v[44:47], a[20:23], v[112:115], v[44:47]
    ds_read_b64_tr_b16 v[96:97], v3 offset:24576
    v_mfma_f32_16x16x32_bf16 v[48:51], a[84:87], v[112:115], v[48:51]
    v_mfma_f32_16x16x32_bf16 v[52:55], a[148:151], v[112:115], v[52:55]
    ds_read_b64_tr_b16 v[98:99], v3 offset:25088
    v_mfma_f32_16x16x32_bf16 v[56:59], a[212:215], v[112:115], v[56:59]
    s_waitcnt lgkmcnt(4)
    buffer_load_dwordx4 v253, s[68:71], s57 offen offset:1024 lds
    v_mfma_f32_16x16x32_bf16 v[60:63], a[20:23], v[116:119], v[60:63]
    ds_read_b64_tr_b16 v[100:101], v4 offset:24576
    v_mfma_f32_16x16x32_bf16 v[64:67], a[84:87], v[116:119], v[64:67]
    v_mfma_f32_16x16x32_bf16 v[68:71], a[148:151], v[116:119], v[68:71]
    ds_read_b64_tr_b16 v[102:103], v4 offset:25088
    v_mfma_f32_16x16x32_bf16 v[72:75], a[212:215], v[116:119], v[72:75]
    v_mfma_f32_16x16x32_bf16 v[76:79], a[20:23], v[120:123], v[76:79]
    ds_read_b64_tr_b16 v[104:105], v5 offset:24576
    v_mfma_f32_16x16x32_bf16 v[80:83], a[84:87], v[120:123], v[80:83]
    v_mfma_f32_16x16x32_bf16 v[84:87], a[148:151], v[120:123], v[84:87]
    ds_read_b64_tr_b16 v[106:107], v5 offset:25088
    v_mfma_f32_16x16x32_bf16 v[88:91], a[212:215], v[120:123], v[88:91]
    s_waitcnt lgkmcnt(4)
    buffer_load_dwordx4 v254, s[68:71], s57 offen offset:2048 lds
    v_mfma_f32_16x16x32_bf16 v[28:31], a[24:27], v[92:95], v[28:31]
    ds_read_b64_tr_b16 v[108:109], v2 offset:28672
    v_mfma_f32_16x16x32_bf16 v[32:35], a[88:91], v[92:95], v[32:35]
    v_mfma_f32_16x16x32_bf16 v[36:39], a[152:155], v[92:95], v[36:39]
    ds_read_b64_tr_b16 v[110:111], v2 offset:29184
    v_mfma_f32_16x16x32_bf16 v[40:43], a[216:219], v[92:95], v[40:43]
    v_mfma_f32_16x16x32_bf16 v[44:47], a[24:27], v[96:99], v[44:47]
    ds_read_b64_tr_b16 v[112:113], v3 offset:28672
    v_mfma_f32_16x16x32_bf16 v[48:51], a[88:91], v[96:99], v[48:51]
    v_mfma_f32_16x16x32_bf16 v[52:55], a[152:155], v[96:99], v[52:55]
    ds_read_b64_tr_b16 v[114:115], v3 offset:29184
    v_mfma_f32_16x16x32_bf16 v[56:59], a[216:219], v[96:99], v[56:59]
    s_waitcnt lgkmcnt(4)
    buffer_load_dwordx4 v255, s[68:71], s57 offen offset:3072 lds
    v_mfma_f32_16x16x32_bf16 v[60:63], a[24:27], v[100:103], v[60:63]
    ds_read_b64_tr_b16 v[116:117], v4 offset:28672
    v_mfma_f32_16x16x32_bf16 v[64:67], a[88:91], v[100:103], v[64:67]
    v_mfma_f32_16x16x32_bf16 v[68:71], a[152:155], v[100:103], v[68:71]
    s_add_u32 m0, s55, 49152
    ds_read_b64_tr_b16 v[118:119], v4 offset:29184
    v_mfma_f32_16x16x32_bf16 v[72:75], a[216:219], v[100:103], v[72:75]
    s_add_u32 s49, s53, 128
    v_mfma_f32_16x16x32_bf16 v[76:79], a[24:27], v[104:107], v[76:79]
    s_and_b32 s49, s49, 1023
    ds_read_b64_tr_b16 v[120:121], v5 offset:28672
    v_mfma_f32_16x16x32_bf16 v[80:83], a[88:91], v[104:107], v[80:83]
    s_lshl_b32 s57, s49, 12
    v_mfma_f32_16x16x32_bf16 v[84:87], a[152:155], v[104:107], v[84:87]
    s_add_u32 s57, s57, s52
    ds_read_b64_tr_b16 v[122:123], v5 offset:29184
    v_mfma_f32_16x16x32_bf16 v[88:91], a[216:219], v[104:107], v[88:91]
    s_waitcnt lgkmcnt(4)
    v_mfma_f32_16x16x32_bf16 v[28:31], a[28:31], v[108:111], v[28:31]
    ds_read_b64_tr_b16 v[92:93], v2 offset:32768
    v_mfma_f32_16x16x32_bf16 v[32:35], a[92:95], v[108:111], v[32:35]
    buffer_load_dwordx4 v252, s[68:71], s57 offen offset:0 lds
    v_mfma_f32_16x16x32_bf16 v[36:39], a[156:159], v[108:111], v[36:39]
    ds_read_b64_tr_b16 v[94:95], v2 offset:33280
    v_mfma_f32_16x16x32_bf16 v[40:43], a[220:223], v[108:111], v[40:43]
    v_mfma_f32_16x16x32_bf16 v[44:47], a[28:31], v[112:115], v[44:47]
    ds_read_b64_tr_b16 v[96:97], v3 offset:32768
    v_mfma_f32_16x16x32_bf16 v[48:51], a[92:95], v[112:115], v[48:51]
    v_mfma_f32_16x16x32_bf16 v[52:55], a[156:159], v[112:115], v[52:55]
    ds_read_b64_tr_b16 v[98:99], v3 offset:33280
    v_mfma_f32_16x16x32_bf16 v[56:59], a[220:223], v[112:115], v[56:59]
    s_waitcnt lgkmcnt(4)
    buffer_load_dwordx4 v253, s[68:71], s57 offen offset:1024 lds
    v_mfma_f32_16x16x32_bf16 v[60:63], a[28:31], v[116:119], v[60:63]
    ds_read_b64_tr_b16 v[100:101], v4 offset:32768
    v_mfma_f32_16x16x32_bf16 v[64:67], a[92:95], v[116:119], v[64:67]
    v_mfma_f32_16x16x32_bf16 v[68:71], a[156:159], v[116:119], v[68:71]
    ds_read_b64_tr_b16 v[102:103], v4 offset:33280
    v_mfma_f32_16x16x32_bf16 v[72:75], a[220:223], v[116:119], v[72:75]
    v_mfma_f32_16x16x32_bf16 v[76:79], a[28:31], v[120:123], v[76:79]
    ds_read_b64_tr_b16 v[104:105], v5 offset:32768
    v_mfma_f32_16x16x32_bf16 v[80:83], a[92:95], v[120:123], v[80:83]
    v_mfma_f32_16x16x32_bf16 v[84:87], a[156:159], v[120:123], v[84:87]
    ds_read_b64_tr_b16 v[106:107], v5 offset:33280
    v_mfma_f32_16x16x32_bf16 v[88:91], a[220:223], v[120:123], v[88:91]
    s_waitcnt lgkmcnt(4)
    buffer_load_dwordx4 v254, s[68:71], s57 offen offset:2048 lds
    v_mfma_f32_16x16x32_bf16 v[28:31], a[32:35], v[92:95], v[28:31]
    ds_read_b64_tr_b16 v[108:109], v2 offset:36864
    v_mfma_f32_16x16x32_bf16 v[32:35], a[96:99], v[92:95], v[32:35]
    v_mfma_f32_16x16x32_bf16 v[36:39], a[160:163], v[92:95], v[36:39]
    ds_read_b64_tr_b16 v[110:111], v2 offset:37376
    v_mfma_f32_16x16x32_bf16 v[40:43], a[224:227], v[92:95], v[40:43]
    v_mfma_f32_16x16x32_bf16 v[44:47], a[32:35], v[96:99], v[44:47]
    ds_read_b64_tr_b16 v[112:113], v3 offset:36864
    v_mfma_f32_16x16x32_bf16 v[48:51], a[96:99], v[96:99], v[48:51]
    v_mfma_f32_16x16x32_bf16 v[52:55], a[160:163], v[96:99], v[52:55]
    ds_read_b64_tr_b16 v[114:115], v3 offset:37376
    v_mfma_f32_16x16x32_bf16 v[56:59], a[224:227], v[96:99], v[56:59]
    s_waitcnt lgkmcnt(4)
    buffer_load_dwordx4 v255, s[68:71], s57 offen offset:3072 lds
    v_mfma_f32_16x16x32_bf16 v[60:63], a[32:35], v[100:103], v[60:63]
    ds_read_b64_tr_b16 v[116:117], v4 offset:36864
    v_mfma_f32_16x16x32_bf16 v[64:67], a[96:99], v[100:103], v[64:67]
    v_mfma_f32_16x16x32_bf16 v[68:71], a[160:163], v[100:103], v[68:71]
    ds_read_b64_tr_b16 v[118:119], v4 offset:37376
    v_mfma_f32_16x16x32_bf16 v[72:75], a[224:227], v[100:103], v[72:75]
    v_mfma_f32_16x16x32_bf16 v[76:79], a[32:35], v[104:107], v[76:79]
    ds_read_b64_tr_b16 v[120:121], v5 offset:36864
    v_mfma_f32_16x16x32_bf16 v[80:83], a[96:99], v[104:107], v[80:83]
    v_mfma_f32_16x16x32_bf16 v[84:87], a[160:163], v[104:107], v[84:87]
    ds_read_b64_tr_b16 v[122:123], v5 offset:37376
    v_mfma_f32_16x16x32_bf16 v[88:91], a[224:227], v[104:107], v[88:91]
    s_waitcnt lgkmcnt(4)
    v_mfma_f32_16x16x32_bf16 v[28:31], a[36:39], v[108:111], v[28:31]
    ds_read_b64_tr_b16 v[92:93], v2 offset:40960
    v_mfma_f32_16x16x32_bf16 v[32:35], a[100:103], v[108:111], v[32:35]
    buffer_store_dwordx4 v[124:127], v18, s[16:19], s23 offen offset:0 sc1
    v_mfma_f32_16x16x32_bf16 v[36:39], a[164:167], v[108:111], v[36:39]
    ds_read_b64_tr_b16 v[94:95], v2 offset:41472
    v_mfma_f32_16x16x32_bf16 v[40:43], a[228:231], v[108:111], v[40:43]
    v_mfma_f32_16x16x32_bf16 v[44:47], a[36:39], v[112:115], v[44:47]
    ds_read_b64_tr_b16 v[96:97], v3 offset:40960
    v_mfma_f32_16x16x32_bf16 v[48:51], a[100:103], v[112:115], v[48:51]
    v_mfma_f32_16x16x32_bf16 v[52:55], a[164:167], v[112:115], v[52:55]
    ds_read_b64_tr_b16 v[98:99], v3 offset:41472
    v_mfma_f32_16x16x32_bf16 v[56:59], a[228:231], v[112:115], v[56:59]
    s_waitcnt lgkmcnt(4)
    v_mfma_f32_16x16x32_bf16 v[60:63], a[36:39], v[116:119], v[60:63]
    ds_read_b64_tr_b16 v[100:101], v4 offset:40960
    v_mfma_f32_16x16x32_bf16 v[64:67], a[100:103], v[116:119], v[64:67]
    v_mfma_f32_16x16x32_bf16 v[68:71], a[164:167], v[116:119], v[68:71]
    ds_read_b64_tr_b16 v[102:103], v4 offset:41472
    v_mfma_f32_16x16x32_bf16 v[72:75], a[228:231], v[116:119], v[72:75]
    v_mfma_f32_16x16x32_bf16 v[76:79], a[36:39], v[120:123], v[76:79]
    ds_read_b64_tr_b16 v[104:105], v5 offset:40960
    v_mfma_f32_16x16x32_bf16 v[80:83], a[100:103], v[120:123], v[80:83]
    buffer_store_dwordx4 v[128:131], v18, s[16:19], s23 offen offset:1024 sc1
    v_mfma_f32_16x16x32_bf16 v[84:87], a[164:167], v[120:123], v[84:87]
    ds_read_b64_tr_b16 v[106:107], v5 offset:41472
    v_mfma_f32_16x16x32_bf16 v[88:91], a[228:231], v[120:123], v[88:91]
    s_waitcnt lgkmcnt(4)
    v_mfma_f32_16x16x32_bf16 v[28:31], a[40:43], v[92:95], v[28:31]
    ds_read_b64_tr_b16 v[108:109], v2 offset:45056
    v_mfma_f32_16x16x32_bf16 v[32:35], a[104:107], v[92:95], v[32:35]
    v_mfma_f32_16x16x32_bf16 v[36:39], a[168:171], v[92:95], v[36:39]
    ds_read_b64_tr_b16 v[110:111], v2 offset:45568
    v_mfma_f32_16x16x32_bf16 v[40:43], a[232:235], v[92:95], v[40:43]
    v_mfma_f32_16x16x32_bf16 v[44:47], a[40:43], v[96:99], v[44:47]
    ds_read_b64_tr_b16 v[112:113], v3 offset:45056
    v_mfma_f32_16x16x32_bf16 v[48:51], a[104:107], v[96:99], v[48:51]
    v_mfma_f32_16x16x32_bf16 v[52:55], a[168:171], v[96:99], v[52:55]
    ds_read_b64_tr_b16 v[114:115], v3 offset:45568
    v_mfma_f32_16x16x32_bf16 v[56:59], a[232:235], v[96:99], v[56:59]
    s_waitcnt lgkmcnt(4)
    v_mfma_f32_16x16x32_bf16 v[60:63], a[40:43], v[100:103], v[60:63]
    ds_read_b64_tr_b16 v[116:117], v4 offset:45056
    v_mfma_f32_16x16x32_bf16 v[64:67], a[104:107], v[100:103], v[64:67]
    buffer_store_dwordx4 v[132:135], v18, s[16:19], s23 offen offset:2048 sc1
    v_mfma_f32_16x16x32_bf16 v[68:71], a[168:171], v[100:103], v[68:71]
    ds_read_b64_tr_b16 v[118:119], v4 offset:45568
    v_mfma_f32_16x16x32_bf16 v[72:75], a[232:235], v[100:103], v[72:75]
    v_mfma_f32_16x16x32_bf16 v[76:79], a[40:43], v[104:107], v[76:79]
    ds_read_b64_tr_b16 v[120:121], v5 offset:45056
    v_mfma_f32_16x16x32_bf16 v[80:83], a[104:107], v[104:107], v[80:83]
    v_mfma_f32_16x16x32_bf16 v[84:87], a[168:171], v[104:107], v[84:87]
    ds_read_b64_tr_b16 v[122:123], v5 offset:45568
    v_mfma_f32_16x16x32_bf16 v[88:91], a[232:235], v[104:107], v[88:91]
    s_waitcnt lgkmcnt(4)
    v_mfma_f32_16x16x32_bf16 v[28:31], a[44:47], v[108:111], v[28:31]
    ds_read_b64_tr_b16 v[92:93], v2 offset:49152
    v_mfma_f32_16x16x32_bf16 v[32:35], a[108:111], v[108:111], v[32:35]
    v_mfma_f32_16x16x32_bf16 v[36:39], a[172:175], v[108:111], v[36:39]
    ds_read_b64_tr_b16 v[94:95], v2 offset:49664
    v_mfma_f32_16x16x32_bf16 v[40:43], a[236:239], v[108:111], v[40:43]
    v_mfma_f32_16x16x32_bf16 v[44:47], a[44:47], v[112:115], v[44:47]
    ds_read_b64_tr_b16 v[96:97], v3 offset:49152
    v_mfma_f32_16x16x32_bf16 v[48:51], a[108:111], v[112:115], v[48:51]
    buffer_store_dwordx4 v[136:139], v18, s[16:19], s23 offen offset:3072 sc1
    v_mfma_f32_16x16x32_bf16 v[52:55], a[172:175], v[112:115], v[52:55]
    ds_read_b64_tr_b16 v[98:99], v3 offset:49664
    v_mfma_f32_16x16x32_bf16 v[56:59], a[236:239], v[112:115], v[56:59]
    s_waitcnt lgkmcnt(4)
    v_mfma_f32_16x16x32_bf16 v[60:63], a[44:47], v[116:119], v[60:63]
    ds_read_b64_tr_b16 v[100:101], v4 offset:49152
    v_mfma_f32_16x16x32_bf16 v[64:67], a[108:111], v[116:119], v[64:67]
    v_mfma_f32_16x16x32_bf16 v[68:71], a[172:175], v[116:119], v[68:71]
    ds_read_b64_tr_b16 v[102:103], v4 offset:49664
    v_mfma_f32_16x16x32_bf16 v[72:75], a[236:239], v[116:119], v[72:75]
    v_mfma_f32_16x16x32_bf16 v[76:79], a[44:47], v[120:123], v[76:79]
    ds_read_b64_tr_b16 v[104:105], v5 offset:49152
    v_mfma_f32_16x16x32_bf16 v[80:83], a[108:111], v[120:123], v[80:83]
    v_mfma_f32_16x16x32_bf16 v[84:87], a[172:175], v[120:123], v[84:87]
    ds_read_b64_tr_b16 v[106:107], v5 offset:49664
    v_mfma_f32_16x16x32_bf16 v[88:91], a[236:239], v[120:123], v[88:91]
    s_waitcnt lgkmcnt(4)
    v_mfma_f32_16x16x32_bf16 v[28:31], a[48:51], v[92:95], v[28:31]
    ds_read_b64_tr_b16 v[108:109], v2 offset:53248
    v_mfma_f32_16x16x32_bf16 v[32:35], a[112:115], v[92:95], v[32:35]
    buffer_store_dwordx4 v[140:143], v20, s[16:19], s23 offen offset:0 sc1
    v_mfma_f32_16x16x32_bf16 v[36:39], a[176:179], v[92:95], v[36:39]
    ds_read_b64_tr_b16 v[110:111], v2 offset:53760
    v_mfma_f32_16x16x32_bf16 v[40:43], a[240:243], v[92:95], v[40:43]
    v_mfma_f32_16x16x32_bf16 v[44:47], a[48:51], v[96:99], v[44:47]
    ds_read_b64_tr_b16 v[112:113], v3 offset:53248
    v_mfma_f32_16x16x32_bf16 v[48:51], a[112:115], v[96:99], v[48:51]
    v_mfma_f32_16x16x32_bf16 v[52:55], a[176:179], v[96:99], v[52:55]
    ds_read_b64_tr_b16 v[114:115], v3 offset:53760
    v_mfma_f32_16x16x32_bf16 v[56:59], a[240:243], v[96:99], v[56:59]
    s_waitcnt lgkmcnt(4)
    v_mfma_f32_16x16x32_bf16 v[60:63], a[48:51], v[100:103], v[60:63]
    ds_read_b64_tr_b16 v[116:117], v4 offset:53248
    v_mfma_f32_16x16x32_bf16 v[64:67], a[112:115], v[100:103], v[64:67]
    v_mfma_f32_16x16x32_bf16 v[68:71], a[176:179], v[100:103], v[68:71]
    ds_read_b64_tr_b16 v[118:119], v4 offset:53760
    v_mfma_f32_16x16x32_bf16 v[72:75], a[240:243], v[100:103], v[72:75]
    v_mfma_f32_16x16x32_bf16 v[76:79], a[48:51], v[104:107], v[76:79]
    ds_read_b64_tr_b16 v[120:121], v5 offset:53248
    v_mfma_f32_16x16x32_bf16 v[80:83], a[112:115], v[104:107], v[80:83]
    buffer_store_dwordx4 v[144:147], v20, s[16:19], s23 offen offset:1024 sc1
    v_mfma_f32_16x16x32_bf16 v[84:87], a[176:179], v[104:107], v[84:87]
    ds_read_b64_tr_b16 v[122:123], v5 offset:53760
    v_mfma_f32_16x16x32_bf16 v[88:91], a[240:243], v[104:107], v[88:91]
    s_waitcnt lgkmcnt(4)
    v_mfma_f32_16x16x32_bf16 v[28:31], a[52:55], v[108:111], v[28:31]
    ds_read_b64_tr_b16 v[92:93], v2 offset:57344
    v_mfma_f32_16x16x32_bf16 v[32:35], a[116:119], v[108:111], v[32:35]
    v_mfma_f32_16x16x32_bf16 v[36:39], a[180:183], v[108:111], v[36:39]
    ds_read_b64_tr_b16 v[94:95], v2 offset:57856
    v_mfma_f32_16x16x32_bf16 v[40:43], a[244:247], v[108:111], v[40:43]
    v_mfma_f32_16x16x32_bf16 v[44:47], a[52:55], v[112:115], v[44:47]
    ds_read_b64_tr_b16 v[96:97], v3 offset:57344
    v_mfma_f32_16x16x32_bf16 v[48:51], a[116:119], v[112:115], v[48:51]
    v_mfma_f32_16x16x32_bf16 v[52:55], a[180:183], v[112:115], v[52:55]
    ds_read_b64_tr_b16 v[98:99], v3 offset:57856
    v_mfma_f32_16x16x32_bf16 v[56:59], a[244:247], v[112:115], v[56:59]
    s_waitcnt lgkmcnt(4)
    v_mfma_f32_16x16x32_bf16 v[60:63], a[52:55], v[116:119], v[60:63]
    ds_read_b64_tr_b16 v[100:101], v4 offset:57344
    v_mfma_f32_16x16x32_bf16 v[64:67], a[116:119], v[116:119], v[64:67]
    buffer_store_dwordx4 v[148:151], v20, s[16:19], s23 offen offset:2048 sc1
    v_mfma_f32_16x16x32_bf16 v[68:71], a[180:183], v[116:119], v[68:71]
    ds_read_b64_tr_b16 v[102:103], v4 offset:57856
    v_mfma_f32_16x16x32_bf16 v[72:75], a[244:247], v[116:119], v[72:75]
    v_mfma_f32_16x16x32_bf16 v[76:79], a[52:55], v[120:123], v[76:79]
    ds_read_b64_tr_b16 v[104:105], v5 offset:57344
    v_mfma_f32_16x16x32_bf16 v[80:83], a[116:119], v[120:123], v[80:83]
    v_mfma_f32_16x16x32_bf16 v[84:87], a[180:183], v[120:123], v[84:87]
    ds_read_b64_tr_b16 v[106:107], v5 offset:57856
    v_mfma_f32_16x16x32_bf16 v[88:91], a[244:247], v[120:123], v[88:91]
    s_waitcnt lgkmcnt(4)
    v_mfma_f32_16x16x32_bf16 v[28:31], a[56:59], v[92:95], v[28:31]
    ds_read_b64_tr_b16 v[108:109], v2 offset:61440
    v_mfma_f32_16x16x32_bf16 v[32:35], a[120:123], v[92:95], v[32:35]
    v_mfma_f32_16x16x32_bf16 v[36:39], a[184:187], v[92:95], v[36:39]
    ds_read_b64_tr_b16 v[110:111], v2 offset:61952
    v_mfma_f32_16x16x32_bf16 v[40:43], a[248:251], v[92:95], v[40:43]
    v_mfma_f32_16x16x32_bf16 v[44:47], a[56:59], v[96:99], v[44:47]
    ds_read_b64_tr_b16 v[112:113], v3 offset:61440
    v_mfma_f32_16x16x32_bf16 v[48:51], a[120:123], v[96:99], v[48:51]
    buffer_store_dwordx4 v[152:155], v20, s[16:19], s23 offen offset:3072 sc1
    v_mfma_f32_16x16x32_bf16 v[52:55], a[184:187], v[96:99], v[52:55]
    ds_read_b64_tr_b16 v[114:115], v3 offset:61952
    v_mfma_f32_16x16x32_bf16 v[56:59], a[248:251], v[96:99], v[56:59]
    s_waitcnt lgkmcnt(4)
    v_mfma_f32_16x16x32_bf16 v[60:63], a[56:59], v[100:103], v[60:63]
    ds_read_b64_tr_b16 v[116:117], v4 offset:61440
    v_mfma_f32_16x16x32_bf16 v[64:67], a[120:123], v[100:103], v[64:67]
    v_mfma_f32_16x16x32_bf16 v[68:71], a[184:187], v[100:103], v[68:71]
    ds_read_b64_tr_b16 v[118:119], v4 offset:61952
    v_mfma_f32_16x16x32_bf16 v[72:75], a[248:251], v[100:103], v[72:75]
    v_mfma_f32_16x16x32_bf16 v[76:79], a[56:59], v[104:107], v[76:79]
    ds_read_b64_tr_b16 v[120:121], v5 offset:61440
    v_mfma_f32_16x16x32_bf16 v[80:83], a[120:123], v[104:107], v[80:83]
    v_mfma_f32_16x16x32_bf16 v[84:87], a[184:187], v[104:107], v[84:87]
    ds_read_b64_tr_b16 v[122:123], v5 offset:61952
    v_mfma_f32_16x16x32_bf16 v[88:91], a[248:251], v[104:107], v[88:91]
    s_waitcnt lgkmcnt(4)
    v_mfma_f32_16x16x32_bf16 v[28:31], a[60:63], v[108:111], v[28:31]
    v_mfma_f32_16x16x32_bf16 v[32:35], a[124:127], v[108:111], v[32:35]
    v_mfma_f32_16x16x32_bf16 v[36:39], a[188:191], v[108:111], v[36:39]
    v_mfma_f32_16x16x32_bf16 v[40:43], a[252:255], v[108:111], v[40:43]
    v_mfma_f32_16x16x32_bf16 v[44:47], a[60:63], v[112:115], v[44:47]
    v_mfma_f32_16x16x32_bf16 v[48:51], a[124:127], v[112:115], v[48:51]
    v_mfma_f32_16x16x32_bf16 v[52:55], a[188:191], v[112:115], v[52:55]
    v_mfma_f32_16x16x32_bf16 v[56:59], a[252:255], v[112:115], v[56:59]
    s_waitcnt lgkmcnt(0)
    v_mul_f32 v28, s34, v28
    v_mul_f32 v29, s34, v29
    v_mfma_f32_16x16x32_bf16 v[60:63], a[60:63], v[116:119], v[60:63]
    v_mul_f32 v30, s34, v30
    v_mul_f32 v31, s34, v31
    v_mfma_f32_16x16x32_bf16 v[64:67], a[124:127], v[116:119], v[64:67]
    v_cvt_pk_bf16_f32 v124, v28, v29
    v_cvt_pk_bf16_f32 v125, v30, v31
    v_mfma_f32_16x16x32_bf16 v[68:71], a[188:191], v[116:119], v[68:71]
    v_mul_f32 v32, s34, v32
    v_mul_f32 v33, s34, v33
    v_mfma_f32_16x16x32_bf16 v[72:75], a[252:255], v[116:119], v[72:75]
    v_mul_f32 v34, s34, v34
    v_mul_f32 v35, s34, v35
    v_mfma_f32_16x16x32_bf16 v[76:79], a[60:63], v[120:123], v[76:79]
    v_cvt_pk_bf16_f32 v126, v32, v33
    v_cvt_pk_bf16_f32 v127, v34, v35
    v_mfma_f32_16x16x32_bf16 v[80:83], a[124:127], v[120:123], v[80:83]
    v_mul_f32 v36, s34, v36
    v_mul_f32 v37, s34, v37
    v_mfma_f32_16x16x32_bf16 v[84:87], a[188:191], v[120:123], v[84:87]
    v_mul_f32 v38, s34, v38
    v_mul_f32 v39, s34, v39
    v_mfma_f32_16x16x32_bf16 v[88:91], a[252:255], v[120:123], v[88:91]
    v_cvt_pk_bf16_f32 v140, v36, v37
    v_cvt_pk_bf16_f32 v141, v38, v39
    v_pk_mul_f32 v[40:41], v[40:41], v[232:233]
    v_pk_mul_f32 v[42:43], v[42:43], v[232:233]
    v_cvt_pk_bf16_f32 v142, v40, v41
    v_cvt_pk_bf16_f32 v143, v42, v43
    v_pk_mul_f32 v[44:45], v[44:45], v[232:233]
    v_pk_mul_f32 v[46:47], v[46:47], v[232:233]
    v_cvt_pk_bf16_f32 v128, v44, v45
    v_cvt_pk_bf16_f32 v129, v46, v47
    v_pk_mul_f32 v[48:49], v[48:49], v[232:233]
    v_pk_mul_f32 v[50:51], v[50:51], v[232:233]
    v_cvt_pk_bf16_f32 v130, v48, v49
    v_cvt_pk_bf16_f32 v131, v50, v51
    v_pk_mul_f32 v[52:53], v[52:53], v[232:233]
    v_pk_mul_f32 v[54:55], v[54:55], v[232:233]
    v_cvt_pk_bf16_f32 v144, v52, v53
    v_cvt_pk_bf16_f32 v145, v54, v55
    v_pk_mul_f32 v[56:57], v[56:57], v[232:233]
    v_pk_mul_f32 v[58:59], v[58:59], v[232:233]
    v_cvt_pk_bf16_f32 v146, v56, v57
    v_cvt_pk_bf16_f32 v147, v58, v59
    v_pk_mul_f32 v[60:61], v[60:61], v[232:233]
    v_pk_mul_f32 v[62:63], v[62:63], v[232:233]
    v_cvt_pk_bf16_f32 v132, v60, v61
    v_cvt_pk_bf16_f32 v133, v62, v63
    v_pk_mul_f32 v[64:65], v[64:65], v[232:233]
    v_pk_mul_f32 v[66:67], v[66:67], v[232:233]
    v_cvt_pk_bf16_f32 v134, v64, v65
    v_cvt_pk_bf16_f32 v135, v66, v67
    v_pk_mul_f32 v[68:69], v[68:69], v[232:233]
    v_pk_mul_f32 v[70:71], v[70:71], v[232:233]
    v_cvt_pk_bf16_f32 v148, v68, v69
    v_cvt_pk_bf16_f32 v149, v70, v71
    v_pk_mul_f32 v[72:73], v[72:73], v[232:233]
    v_pk_mul_f32 v[74:75], v[74:75], v[232:233]
    v_cvt_pk_bf16_f32 v150, v72, v73
    v_cvt_pk_bf16_f32 v151, v74, v75
    v_pk_mul_f32 v[76:77], v[76:77], v[232:233]
    v_pk_mul_f32 v[78:79], v[78:79], v[232:233]
    v_cvt_pk_bf16_f32 v136, v76, v77
    v_cvt_pk_bf16_f32 v137, v78, v79
    v_pk_mul_f32 v[80:81], v[80:81], v[232:233]
    v_pk_mul_f32 v[82:83], v[82:83], v[232:233]
    v_cvt_pk_bf16_f32 v138, v80, v81
    v_cvt_pk_bf16_f32 v139, v82, v83
    v_pk_mul_f32 v[84:85], v[84:85], v[232:233]
    v_pk_mul_f32 v[86:87], v[86:87], v[232:233]
    v_cvt_pk_bf16_f32 v152, v84, v85
    v_cvt_pk_bf16_f32 v153, v86, v87
    v_pk_mul_f32 v[88:89], v[88:89], v[232:233]
    v_pk_mul_f32 v[90:91], v[90:91], v[232:233]
    v_cvt_pk_bf16_f32 v154, v88, v89
    v_cvt_pk_bf16_f32 v155, v90, v91
    s_waitcnt vmcnt(12)
L1V_fin:
    s_lshr_b32 s23, s31, 1
    s_lshl_b32 s23, s23, 20
    s_add_u32 s23, s23, s32
    s_and_b32 s33, s31, 1
    s_lshl_b32 s33, s33, 12
    s_add_u32 s23, s23, s33
    s_add_u32 s31, s31, 1
    buffer_store_dwordx4 v[124:127], v18, s[16:19], s23 offen offset:0 sc1
    buffer_store_dwordx4 v[128:131], v18, s[16:19], s23 offen offset:1024 sc1
    buffer_store_dwordx4 v[132:135], v18, s[16:19], s23 offen offset:2048 sc1
    buffer_store_dwordx4 v[136:139], v18, s[16:19], s23 offen offset:3072 sc1
    buffer_store_dwordx4 v[140:143], v20, s[16:19], s23 offen offset:0 sc1
    buffer_store_dwordx4 v[144:147], v20, s[16:19], s23 offen offset:1024 sc1
    buffer_store_dwordx4 v[148:151], v20, s[16:19], s23 offen offset:2048 sc1
    buffer_store_dwordx4 v[152:155], v20, s[16:19], s23 offen offset:3072 sc1
    s_mov_b32 s38, s36
    s_mov_b32 s39, s37
    s_mov_b32 s101, s30
    s_waitcnt lgkmcnt(0)
    s_barrier
    s_cmp_lg_u32 s59, 128
    s_cbranch_scc1 P2_q0
    s_branch P2_entry
L1_A:
    s_mov_b32 s40, s78
    s_and_b32 s41, s79, 0xffff
    s_mov_b32 s42, 0x4000
    s_mov_b32 s43, 0x20000
    s_add_u32 s22, s21, 64
    v_lshrrev_b32 v28, 5, v0
    v_lshlrev_b32 v28, 10, v28
    v_bfe_u32 v29, v0, 2, 2
    v_lshl_add_u32 v28, v29, 7, v28
    v_bfe_u32 v29, v0, 3, 1
    v_lshl_add_u32 v28, v29, 6, v28
    v_bfe_u32 v29, v0, 4, 1
    v_lshl_add_u32 v28, v29, 5, v28
    v_and_b32 v29, 3, v0
    v_lshl_add_u32 v28, v29, 3, v28
    v_add_u32 v2, 0x18000, v28
    v_xor_b32 v3, 64, v2
    v_and_b32 v28, 31, v0
    v_lshlrev_b32 v29, 7, v28
    v_add_u32 v29, s27, v29
    v_bfe_u32 v28, v0, 1, 3
    v_lshrrev_b32 v30, 5, v0
    v_xor_b32 v28, v28, v30
    v_xor_b32 v30, 0, v28
    v_lshl_add_u32 v14, v30, 4, v29
    v_xor_b32 v30, 2, v28
    v_lshl_add_u32 v15, v30, 4, v29
    v_xor_b32 v30, 4, v28
    v_lshl_add_u32 v16, v30, 4, v29
    v_xor_b32 v30, 6, v28
    v_lshl_add_u32 v17, v30, 4, v29
    s_waitcnt vmcnt(15)
    ds_read_b128 a[0:3], v14 offset:0
    ds_read_b128 a[128:131], v14 offset:4096
    ds_read_b128 a[4:7], v15 offset:0
    ds_read_b128 a[132:135], v15 offset:4096
    ds_read_b128 a[8:11], v16 offset:0
    ds_read_b128 a[136:139], v16 offset:4096
    ds_read_b128 a[12:15], v17 offset:0
    ds_read_b128 a[140:143], v17 offset:4096
    s_add_u32 m0, s27, 16384
    s_add_u32 s33, s56, 256
    s_and_b32 s33, s33, 1023
    s_add_u32 s33, s33, s28
    buffer_load_dwordx4 v10, s[8:11], s33 offen offset:0 lds
    buffer_load_dwordx4 v11, s[8:11], s33 offen offset:1024 lds
    buffer_load_dwordx4 v12, s[8:11], s33 offen offset:2048 lds
    buffer_load_dwordx4 v13, s[8:11], s33 offen offset:3072 lds
    s_add_u32 m0, s27, 20480
    s_add_u32 s33, s33, 32768
    buffer_load_dwordx4 v10, s[8:11], s33 offen offset:0 lds
    buffer_load_dwordx4 v11, s[8:11], s33 offen offset:1024 lds
    buffer_load_dwordx4 v12, s[8:11], s33 offen offset:2048 lds
    buffer_load_dwordx4 v13, s[8:11], s33 offen offset:3072 lds
    s_waitcnt vmcnt(19)
    s_barrier
    ds_read_b64_tr_b16 v[92:93], v2 offset:0
    ds_read_b64_tr_b16 v[94:95], v2 offset:512
    ds_read_b64_tr_b16 v[96:97], v2 offset:2048
    ds_read_b64_tr_b16 v[98:99], v2 offset:2560
    ds_read_b64_tr_b16 v[100:101], v3 offset:0
    ds_read_b64_tr_b16 v[102:103], v3 offset:512
    ds_read_b64_tr_b16 v[104:105], v3 offset:2048
    ds_read_b64_tr_b16 v[106:107], v3 offset:2560
    s_add_u32 m0, s26, 16384
    s_add_u32 s25, s21, s45
    buffer_load_dwordx4 v6, s[12:15], s25 offen offset:0 lds
    buffer_load_dwordx4 v7, s[12:15], s25 offen offset:1024 lds
    buffer_load_dwordx4 v8, s[12:15], s25 offen offset:2048 lds
    buffer_load_dwordx4 v9, s[12:15], s25 offen offset:3072 lds
    s_add_u32 m0, s26, 32768
    s_add_u32 s25, s21, s50
    buffer_load_dwordx4 v6, s[12:15], s25 offen offset:0 lds
    buffer_load_dwordx4 v7, s[12:15], s25 offen offset:1024 lds
    buffer_load_dwordx4 v8, s[12:15], s25 offen offset:2048 lds
    buffer_load_dwordx4 v9, s[12:15], s25 offen offset:3072 lds
    s_waitcnt lgkmcnt(4)
    v_mfma_f32_32x32x16_bf16 v[28:43], v[92:95], a[0:3], 0
    ds_read_b64_tr_b16 v[108:109], v2 offset:4096
    s_add_u32 m0, s27, 0
    s_add_u32 s33, s56, 384
    s_and_b32 s33, s33, 1023
    s_add_u32 s33, s33, s28
    buffer_load_dwordx4 v10, s[8:11], s33 offen offset:0 lds
    buffer_load_dwordx4 v11, s[8:11], s33 offen offset:1024 lds
    v_mfma_f32_32x32x16_bf16 v[28:43], v[96:99], a[4:7], v[28:43]
    ds_read_b64_tr_b16 v[110:111], v2 offset:4608
    buffer_load_dwordx4 v12, s[8:11], s33 offen offset:2048 lds
    buffer_load_dwordx4 v13, s[8:11], s33 offen offset:3072 lds
    v_lshlrev_b32 v18, 4, v0
    v_add_u32 v20, 0x8000, v18
    v_mfma_f32_32x32x16_bf16 v[44:59], v[92:95], a[128:131], 0
    ds_read_b64_tr_b16 v[112:113], v2 offset:6144
    s_add_u32 m0, s27, 4096
    s_add_u32 s33, s33, 32768
    buffer_load_dwordx4 v10, s[8:11], s33 offen offset:0 lds
    buffer_load_dwordx4 v11, s[8:11], s33 offen offset:1024 lds
    v_mfma_f32_32x32x16_bf16 v[44:59], v[96:99], a[132:135], v[44:59]
    s_waitcnt lgkmcnt(3)
    ds_read_b64_tr_b16 v[114:115], v2 offset:6656
    buffer_load_dwordx4 v12, s[8:11], s33 offen offset:2048 lds
    buffer_load_dwordx4 v13, s[8:11], s33 offen offset:3072 lds
    s_mov_b32 s34, 0x3fb8aa3b
    v_lshrrev_b32 v200, 5, v0
    v_mfma_f32_32x32x16_bf16 v[60:75], a[0:3], v[100:103], 0
    ds_read_b64_tr_b16 v[116:117], v3 offset:4096
    v_lshlrev_b32 v200, 7, v200
    v_bfe_u32 v201, v0, 2, 2
    v_lshl_add_u32 v200, v201, 5, v200
    v_and_b32 v201, 3, v0
    v_lshl_add_u32 v200, v201, 3, v200
    v_mfma_f32_32x32x16_bf16 v[60:75], a[4:7], v[104:107], v[60:75]
    ds_read_b64_tr_b16 v[118:119], v3 offset:4608
    v_add_u32 v200, s26, v200
    v_subrev_u32 v22, 49152, v200
    v_bfe_u32 v200, v0, 4, 1
    s_mov_b32 s3, 0x80008000
    v_mul_lo_u32 v23, v200, s3
    v_mfma_f32_32x32x16_bf16 v[76:91], a[128:131], v[100:103], 0
    ds_read_b64_tr_b16 v[120:121], v3 offset:6144
    s_mov_b32 s36, 0x0000ffff
    s_mov_b32 s37, 0x0000ffff
    s_mov_b32 s38, 0xffff0000
    s_mov_b32 s39, 0xffff0000
    v_and_b32 v200, 31, v0
    v_mfma_f32_32x32x16_bf16 v[76:91], a[132:135], v[104:107], v[76:91]
    s_waitcnt lgkmcnt(3)
    ds_read_b64_tr_b16 v[122:123], v3 offset:6656
    v_lshrrev_b32 v201, 5, v0
    v_lshlrev_b32 v201, 2, v201
    v_sub_u32 v200, v200, v201
    v_mov_b32 v202, 0x3f80
    v_mov_b32 v203, 0x3f800000
    v_mfma_f32_32x32x16_bf16 v[28:43], v[108:111], a[8:11], v[28:43]
    s_waitcnt vmcnt(27)
    ds_read_b64_tr_b16 v[92:93], v2 offset:8192
    ds_read_b128 a[16:19], v14 offset:8192
    v_mov_b32 v204, 0
    v_cmp_eq_u32 vcc, 0, v200
    v_cmp_eq_u32 s[4:5], 1, v200
    v_mfma_f32_32x32x16_bf16 v[28:43], v[112:115], a[12:15], v[28:43]
    ds_read_b64_tr_b16 v[94:95], v2 offset:8704
    ds_read_b128 a[144:147], v14 offset:12288
    v_cndmask_b32 v205, v204, v202, vcc
    v_cndmask_b32 v156, v205, v203, s[4:5]
    v_cmp_eq_u32 vcc, 2, v200
    v_cmp_eq_u32 s[4:5], 3, v200
    v_mfma_f32_32x32x16_bf16 v[44:59], v[108:111], a[136:139], v[44:59]
    ds_read_b64_tr_b16 v[96:97], v2 offset:10240
    ds_read_b128 a[20:23], v15 offset:8192
    v_cndmask_b32 v205, v204, v202, vcc
    v_cndmask_b32 v157, v205, v203, s[4:5]
    v_cmp_eq_u32 vcc, 8, v200
    v_cmp_eq_u32 s[4:5], 9, v200
    v_mfma_f32_32x32x16_bf16 v[44:59], v[112:115], a[140:143], v[44:59]
    s_waitcnt lgkmcnt(6)
    ds_read_b64_tr_b16 v[98:99], v2 offset:10752
    ds_read_b128 a[148:151], v15 offset:12288
    v_cndmask_b32 v205, v204, v202, vcc
    v_cndmask_b32 v158, v205, v203, s[4:5]
    v_cmp_eq_u32 vcc, 10, v200
    v_cmp_eq_u32 s[4:5], 11, v200
    v_mfma_f32_32x32x16_bf16 v[60:75], a[8:11], v[116:119], v[60:75]
    ds_read_b128 a[24:27], v16 offset:8192
    ds_read_b64_tr_b16 v[100:101], v3 offset:8192
    v_cndmask_b32 v205, v204, v202, vcc
    v_cndmask_b32 v159, v205, v203, s[4:5]
    v_cmp_eq_u32 vcc, 16, v200
    v_cmp_eq_u32 s[4:5], 17, v200
    v_mfma_f32_32x32x16_bf16 v[60:75], a[12:15], v[120:123], v[60:75]
    ds_read_b128 a[152:155], v16 offset:12288
    ds_read_b64_tr_b16 v[102:103], v3 offset:8704
    v_cndmask_b32 v205, v204, v202, vcc
    v_cndmask_b32 v160, v205, v203, s[4:5]
    v_cmp_eq_u32 vcc, 18, v200
    v_cmp_eq_u32 s[4:5], 19, v200
    v_mfma_f32_32x32x16_bf16 v[76:91], a[136:139], v[116:119], v[76:91]
    ds_read_b128 a[28:31], v17 offset:8192
    ds_read_b64_tr_b16 v[104:105], v3 offset:10240
    v_cndmask_b32 v205, v204, v202, vcc
    v_cndmask_b32 v161, v205, v203, s[4:5]
    v_cmp_eq_u32 vcc, 24, v200
    v_cmp_eq_u32 s[4:5], 25, v200
    v_mfma_f32_32x32x16_bf16 v[76:91], a[140:143], v[120:123], v[76:91]
    s_waitcnt lgkmcnt(1)
    ds_read_b128 a[156:159], v17 offset:12288
    ds_read_b64_tr_b16 v[106:107], v3 offset:10752
    v_cndmask_b32 v205, v204, v202, vcc
    v_cndmask_b32 v162, v205, v203, s[4:5]
    v_cmp_eq_u32 vcc, 26, v200
    v_cmp_eq_u32 s[4:5], 27, v200
    v_mfma_f32_32x32x16_bf16 v[28:43], v[92:95], a[16:19], v[28:43]
    ds_read_b64_tr_b16 v[108:109], v2 offset:12288
    s_add_u32 m0, s27, 8192
    s_add_u32 s33, s56, 512
    s_and_b32 s33, s33, 1023
    s_add_u32 s33, s33, s28
    buffer_load_dwordx4 v10, s[8:11], s33 offen offset:0 lds
    buffer_load_dwordx4 v11, s[8:11], s33 offen offset:1024 lds
    v_mfma_f32_32x32x16_bf16 v[28:43], v[96:99], a[20:23], v[28:43]
    ds_read_b64_tr_b16 v[110:111], v2 offset:12800
    buffer_load_dwordx4 v12, s[8:11], s33 offen offset:2048 lds
    buffer_load_dwordx4 v13, s[8:11], s33 offen offset:3072 lds
    v_cndmask_b32 v205, v204, v202, vcc
    v_cndmask_b32 v163, v205, v203, s[4:5]
    v_mfma_f32_32x32x16_bf16 v[44:59], v[92:95], a[144:147], v[44:59]
    ds_read_b64_tr_b16 v[112:113], v2 offset:14336
    s_add_u32 m0, s27, 12288
    s_add_u32 s33, s33, 32768
    buffer_load_dwordx4 v10, s[8:11], s33 offen offset:0 lds
    buffer_load_dwordx4 v11, s[8:11], s33 offen offset:1024 lds
    v_mfma_f32_32x32x16_bf16 v[44:59], v[96:99], a[148:151], v[44:59]
    s_waitcnt lgkmcnt(3)
    ds_read_b64_tr_b16 v[114:115], v2 offset:14848
    buffer_load_dwordx4 v12, s[8:11], s33 offen offset:2048 lds
    buffer_load_dwordx4 v13, s[8:11], s33 offen offset:3072 lds
    s_lshl_b32 s3, s20, 13
    s_add_u32 s3, s3, 65536
    v_mfma_f32_32x32x16_bf16 v[60:75], a[16:19], v[100:103], v[60:75]
    ds_read_b64_tr_b16 v[116:117], v3 offset:12288
    v_add_u32 v24, s3, v18
    s_lshl_b32 s3, s20, 11
    s_add_u32 s3, s3, 65536
    v_add_u32 v25, s3, v18
    s_lshl_b32 s35, s29, 17
    v_mfma_f32_32x32x16_bf16 v[60:75], a[20:23], v[104:107], v[60:75]
    ds_read_b64_tr_b16 v[118:119], v3 offset:12800
    s_lshl_b32 s3, s31, 13
    s_add_u32 s35, s35, s3
    s_lshl_b32 s3, s20, 11
    s_add_u32 s35, s35, s3
    s_add_u32 s35, s35, 0x3600000
    v_mfma_f32_32x32x16_bf16 v[76:91], a[144:147], v[100:103], v[76:91]
    ds_read_b64_tr_b16 v[120:121], v3 offset:14336
    s_mov_b32 s23, 0x40000000
    s_lshl_b32 s32, s32, 16
    s_lshl_b32 s3, s58, 12
    s_add_u32 s32, s32, s3
    s_add_u32 s32, s32, 0x3200000
    v_mfma_f32_32x32x16_bf16 v[76:91], a[148:151], v[104:107], v[76:91]
    s_waitcnt lgkmcnt(3)
    ds_read_b64_tr_b16 v[122:123], v3 offset:14848
    s_lshl_b32 s58, s58, 7
    v_mov_b32 v1, 0x3f803f80
    s_lshl_b32 s57, s100, 15
    s_sub_u32 s57, 98304, s57
    v_mov_b32 v222, v10
    v_mfma_f32_32x32x16_bf16 v[28:43], v[108:111], a[24:27], v[28:43]
    s_waitcnt vmcnt(24)
    s_waitcnt vmcnt(20)
    s_barrier
    s_add_u32 m0, s26, 49152
    s_add_u32 s25, s21, s51
    ds_read_b64_tr_b16 v[92:93], v2 offset:16384
    ds_read_b128 a[32:35], v14 offset:16384
    v_mfma_f32_32x32x16_bf16 v[28:43], v[112:115], a[28:31], v[28:43]
    buffer_load_dwordx4 v6, s[12:15], s25 offen offset:0 lds
    ds_read_b64_tr_b16 v[94:95], v2 offset:16896
    ds_read_b128 a[160:163], v14 offset:20480
    v_add_u32 v224, s57, v12
    v_mov_b32 v223, v11
    v_mfma_f32_32x32x16_bf16 v[44:59], v[108:111], a[152:155], v[44:59]
    buffer_load_dwordx4 v7, s[12:15], s25 offen offset:1024 lds
    ds_read_b64_tr_b16 v[96:97], v2 offset:18432
    ds_read_b128 a[36:39], v15 offset:16384
    v_add_u32 v225, s57, v13
    s_and_b32 s65, s65, 0xffff
    v_mfma_f32_32x32x16_bf16 v[44:59], v[112:115], a[156:159], v[44:59]
    s_waitcnt lgkmcnt(6)
    buffer_load_dwordx4 v8, s[12:15], s25 offen offset:2048 lds
    ds_read_b64_tr_b16 v[98:99], v2 offset:18944
    ds_read_b128 a[164:167], v15 offset:20480
    s_mov_b32 s66, 0x200000
    s_mov_b32 s67, 0x20000
    v_mfma_f32_32x32x16_bf16 v[60:75], a[24:27], v[116:119], v[60:75]
    buffer_load_dwordx4 v9, s[12:15], s25 offen offset:3072 lds
    ds_read_b128 a[40:43], v16 offset:16384
    ds_read_b64_tr_b16 v[100:101], v3 offset:16384
    s_and_b32 s69, s69, 0xffff
    s_mov_b32 s70, 0x400000
    v_mfma_f32_32x32x16_bf16 v[60:75], a[28:31], v[120:123], v[60:75]
    ds_read_b128 a[168:171], v16 offset:20480
    ds_read_b64_tr_b16 v[102:103], v3 offset:16896
    s_mov_b32 s71, 0x20000
    s_and_b32 s53, s2, 1
    s_lshl_b32 s53, s53, 2
    s_lshr_b32 s57, s2, 6
    v_mfma_f32_32x32x16_bf16 v[76:91], a[152:155], v[116:119], v[76:91]
    ds_read_b128 a[44:47], v17 offset:16384
    ds_read_b64_tr_b16 v[104:105], v3 offset:18432
    s_add_u32 s53, s53, s57
    s_lshl_b32 s57, s100, 14
    s_lshl_b32 s46, s53, 17
    s_add_u32 s46, s46, s57
    v_mfma_f32_32x32x16_bf16 v[76:91], a[156:159], v[120:123], v[76:91]
    s_waitcnt lgkmcnt(1)
    ds_read_b128 a[172:175], v17 offset:20480
    ds_read_b64_tr_b16 v[106:107], v3 offset:18944
    s_sub_u32 s47, 15, s53
    s_lshl_b32 s47, s47, 17
    s_add_u32 s47, s47, s57
    s_bfe_u32 s57, s2, 0x30003
    v_mfma_f32_32x32x16_bf16 v[28:43], v[92:95], a[32:35], v[28:43]
    ds_read_b64_tr_b16 v[108:109], v2 offset:20480
    s_add_u32 m0, s27, 16384
    s_add_u32 s33, s56, 640
    s_and_b32 s33, s33, 1023
    s_add_u32 s33, s33, s28
    buffer_load_dwordx4 v10, s[8:11], s33 offen offset:0 lds
    buffer_load_dwordx4 v11, s[8:11], s33 offen offset:1024 lds
    v_mfma_f32_32x32x16_bf16 v[28:43], v[96:99], a[36:39], v[28:43]
    ds_read_b64_tr_b16 v[110:111], v2 offset:20992
    buffer_load_dwordx4 v12, s[8:11], s33 offen offset:2048 lds
    buffer_load_dwordx4 v13, s[8:11], s33 offen offset:3072 lds
    s_and_b32 s52, s2, 6
    s_lshl_b32 s52, s52, 2
    v_mfma_f32_32x32x16_bf16 v[44:59], v[92:95], a[160:163], v[44:59]
    ds_read_b64_tr_b16 v[112:113], v2 offset:22528
    s_add_u32 m0, s27, 20480
    s_add_u32 s33, s33, 32768
    buffer_load_dwordx4 v10, s[8:11], s33 offen offset:0 lds
    buffer_load_dwordx4 v11, s[8:11], s33 offen offset:1024 lds
    v_mfma_f32_32x32x16_bf16 v[44:59], v[96:99], a[164:167], v[44:59]
    s_waitcnt lgkmcnt(3)
    ds_read_b64_tr_b16 v[114:115], v2 offset:23040
    buffer_load_dwordx4 v12, s[8:11], s33 offen offset:2048 lds
    buffer_load_dwordx4 v13, s[8:11], s33 offen offset:3072 lds
    s_add_u32 s52, s52, s57
    s_lshl_b32 s52, s52, 8
    v_mfma_f32_32x32x16_bf16 v[60:75], a[32:35], v[100:103], v[60:75]
    ds_read_b64_tr_b16 v[116:117], v3 offset:20480
    s_lshl_b32 s53, s53, 1
    s_add_u32 s53, s53, s57
    s_and_b32 s53, s53, 7
    s_lshl_b32 s53, s53, 7
    s_lshl_b32 s54, s100, 13
    v_mfma_f32_32x32x16_bf16 v[60:75], a[36:39], v[104:107], v[60:75]
    ds_read_b64_tr_b16 v[118:119], v3 offset:20992
    s_lshl_b32 s55, s100, 12
    v_lshrrev_b32 v200, 4, v0
    s_lshl_b32 s57, s100, 4
    v_add_u32 v201, s57, v200
    v_lshlrev_b32 v201, 13, v201
    v_mfma_f32_32x32x16_bf16 v[76:91], a[160:163], v[100:103], v[76:91]
    ds_read_b64_tr_b16 v[120:121], v3 offset:22528
    v_lshlrev_b32 v200, 1, v200
    v_and_b32 v202, 15, v0
    v_xor_b32 v200, v200, v202
    v_lshl_add_u32 v252, v200, 4, v201
    v_add_u32 v253, 31744, v252
    v_mfma_f32_32x32x16_bf16 v[76:91], a[164:167], v[104:107], v[76:91]
    s_waitcnt lgkmcnt(3)
    ds_read_b64_tr_b16 v[122:123], v3 offset:23040
    v_xor_b32 v254, 128, v252
    v_add_u32 v254, 63488, v254
    v_add_u32 v255, 31744, v254
    v_mfma_f32_32x32x16_bf16 v[28:43], v[108:111], a[40:43], v[28:43]
    s_waitcnt vmcnt(20)
    ds_read_b64_tr_b16 v[92:93], v2 offset:24576
    ds_read_b128 a[48:51], v14 offset:0
    v_mfma_f32_32x32x16_bf16 v[28:43], v[112:115], a[44:47], v[28:43]
    ds_read_b64_tr_b16 v[94:95], v2 offset:25088
    ds_read_b128 a[176:179], v14 offset:4096
    v_mfma_f32_32x32x16_bf16 v[44:59], v[108:111], a[168:171], v[44:59]
    ds_read_b64_tr_b16 v[96:97], v2 offset:26624
    ds_read_b128 a[52:55], v15 offset:0
    v_mfma_f32_32x32x16_bf16 v[44:59], v[112:115], a[172:175], v[44:59]
    s_waitcnt lgkmcnt(6)
    ds_read_b64_tr_b16 v[98:99], v2 offset:27136
    ds_read_b128 a[180:183], v15 offset:4096
    v_mfma_f32_32x32x16_bf16 v[60:75], a[40:43], v[116:119], v[60:75]
    ds_read_b128 a[56:59], v16 offset:0
    ds_read_b64_tr_b16 v[100:101], v3 offset:24576
    v_mfma_f32_32x32x16_bf16 v[60:75], a[44:47], v[120:123], v[60:75]
    ds_read_b128 a[184:187], v16 offset:4096
    ds_read_b64_tr_b16 v[102:103], v3 offset:25088
    v_mfma_f32_32x32x16_bf16 v[76:91], a[168:171], v[116:119], v[76:91]
    ds_read_b128 a[60:63], v17 offset:0
    ds_read_b64_tr_b16 v[104:105], v3 offset:26624
    v_mfma_f32_32x32x16_bf16 v[76:91], a[172:175], v[120:123], v[76:91]
    s_waitcnt lgkmcnt(1)
    ds_read_b128 a[188:191], v17 offset:4096
    ds_read_b64_tr_b16 v[106:107], v3 offset:27136
    v_mfma_f32_32x32x16_bf16 v[28:43], v[92:95], a[48:51], v[28:43]
    ds_read_b64_tr_b16 v[108:109], v2 offset:28672
    s_add_u32 m0, s27, 0
    s_add_u32 s33, s56, 768
    s_and_b32 s33, s33, 1023
    s_add_u32 s33, s33, s28
    buffer_load_dwordx4 v10, s[8:11], s33 offen offset:0 lds
    buffer_load_dwordx4 v11, s[8:11], s33 offen offset:1024 lds
    v_mfma_f32_32x32x16_bf16 v[28:43], v[96:99], a[52:55], v[28:43]
    ds_read_b64_tr_b16 v[110:111], v2 offset:29184
    buffer_load_dwordx4 v12, s[8:11], s33 offen offset:2048 lds
    buffer_load_dwordx4 v13, s[8:11], s33 offen offset:3072 lds
    v_mfma_f32_32x32x16_bf16 v[44:59], v[92:95], a[176:179], v[44:59]
    ds_read_b64_tr_b16 v[112:113], v2 offset:30720
    s_add_u32 m0, s27, 4096
    s_add_u32 s33, s33, 32768
    buffer_load_dwordx4 v10, s[8:11], s33 offen offset:0 lds
    buffer_load_dwordx4 v11, s[8:11], s33 offen offset:1024 lds
    v_mfma_f32_32x32x16_bf16 v[44:59], v[96:99], a[180:183], v[44:59]
    s_waitcnt lgkmcnt(3)
    ds_read_b64_tr_b16 v[114:115], v2 offset:31232
    buffer_load_dwordx4 v12, s[8:11], s33 offen offset:2048 lds
    buffer_load_dwordx4 v13, s[8:11], s33 offen offset:3072 lds
    v_mfma_f32_32x32x16_bf16 v[60:75], a[48:51], v[100:103], v[60:75]
    ds_read_b64_tr_b16 v[116:117], v3 offset:28672
    v_mfma_f32_32x32x16_bf16 v[60:75], a[52:55], v[104:107], v[60:75]
    ds_read_b64_tr_b16 v[118:119], v3 offset:29184
    v_mfma_f32_32x32x16_bf16 v[76:91], a[176:179], v[100:103], v[76:91]
    ds_read_b64_tr_b16 v[120:121], v3 offset:30720
    v_mfma_f32_32x32x16_bf16 v[76:91], a[180:183], v[104:107], v[76:91]
    s_waitcnt lgkmcnt(3)
    ds_read_b64_tr_b16 v[122:123], v3 offset:31232
    v_mfma_f32_32x32x16_bf16 v[28:43], v[108:111], a[56:59], v[28:43]
    s_waitcnt vmcnt(20)
    s_barrier
    s_add_u32 m0, s26, 0
    s_add_u32 s25, s22, s44
    ds_read_b64_tr_b16 v[92:93], v2 offset:32768
    ds_read_b128 a[64:67], v14 offset:8192
    v_mfma_f32_32x32x16_bf16 v[28:43], v[112:115], a[60:63], v[28:43]
    buffer_load_dwordx4 v6, s[12:15], s25 offen offset:0 lds
    ds_read_b64_tr_b16 v[94:95], v2 offset:33280
    ds_read_b128 a[192:195], v14 offset:12288
    v_mfma_f32_32x32x16_bf16 v[44:59], v[108:111], a[184:187], v[44:59]
    buffer_load_dwordx4 v7, s[12:15], s25 offen offset:1024 lds
    ds_read_b64_tr_b16 v[96:97], v2 offset:34816
    ds_read_b128 a[68:71], v15 offset:8192
    v_mfma_f32_32x32x16_bf16 v[44:59], v[112:115], a[188:191], v[44:59]
    s_waitcnt lgkmcnt(6)
    buffer_load_dwordx4 v8, s[12:15], s25 offen offset:2048 lds
    ds_read_b64_tr_b16 v[98:99], v2 offset:35328
    ds_read_b128 a[196:199], v15 offset:12288
    v_mfma_f32_32x32x16_bf16 v[60:75], a[56:59], v[116:119], v[60:75]
    buffer_load_dwordx4 v9, s[12:15], s25 offen offset:3072 lds
    ds_read_b128 a[72:75], v16 offset:8192
    ds_read_b64_tr_b16 v[100:101], v3 offset:32768
    v_mfma_f32_32x32x16_bf16 v[60:75], a[60:63], v[120:123], v[60:75]
    ds_read_b128 a[200:203], v16 offset:12288
    ds_read_b64_tr_b16 v[102:103], v3 offset:33280
    v_mfma_f32_32x32x16_bf16 v[76:91], a[184:187], v[116:119], v[76:91]
    ds_read_b128 a[76:79], v17 offset:8192
    ds_read_b64_tr_b16 v[104:105], v3 offset:34816
    v_mfma_f32_32x32x16_bf16 v[76:91], a[188:191], v[120:123], v[76:91]
    s_waitcnt lgkmcnt(1)
    ds_read_b128 a[204:207], v17 offset:12288
    ds_read_b64_tr_b16 v[106:107], v3 offset:35328
    v_mfma_f32_32x32x16_bf16 v[28:43], v[92:95], a[64:67], v[28:43]
    ds_read_b64_tr_b16 v[108:109], v2 offset:36864
    s_add_u32 m0, s27, 8192
    s_add_u32 s33, s56, 896
    s_and_b32 s33, s33, 1023
    s_add_u32 s33, s33, s28
    buffer_load_dwordx4 v10, s[8:11], s33 offen offset:0 lds
    buffer_load_dwordx4 v11, s[8:11], s33 offen offset:1024 lds
    v_mfma_f32_32x32x16_bf16 v[28:43], v[96:99], a[68:71], v[28:43]
    ds_read_b64_tr_b16 v[110:111], v2 offset:37376
    buffer_load_dwordx4 v12, s[8:11], s33 offen offset:2048 lds
    buffer_load_dwordx4 v13, s[8:11], s33 offen offset:3072 lds
    v_mfma_f32_32x32x16_bf16 v[44:59], v[92:95], a[192:195], v[44:59]
    ds_read_b64_tr_b16 v[112:113], v2 offset:38912
    s_add_u32 m0, s27, 12288
    s_add_u32 s33, s33, 32768
    buffer_load_dwordx4 v10, s[8:11], s33 offen offset:0 lds
    buffer_load_dwordx4 v11, s[8:11], s33 offen offset:1024 lds
    v_mfma_f32_32x32x16_bf16 v[44:59], v[96:99], a[196:199], v[44:59]
    s_waitcnt lgkmcnt(3)
    ds_read_b64_tr_b16 v[114:115], v2 offset:39424
    buffer_load_dwordx4 v12, s[8:11], s33 offen offset:2048 lds
    buffer_load_dwordx4 v13, s[8:11], s33 offen offset:3072 lds
    v_mfma_f32_32x32x16_bf16 v[60:75], a[64:67], v[100:103], v[60:75]
    ds_read_b64_tr_b16 v[116:117], v3 offset:36864
    v_mfma_f32_32x32x16_bf16 v[60:75], a[68:71], v[104:107], v[60:75]
    ds_read_b64_tr_b16 v[118:119], v3 offset:37376
    v_mfma_f32_32x32x16_bf16 v[76:91], a[192:195], v[100:103], v[76:91]
    ds_read_b64_tr_b16 v[120:121], v3 offset:38912
    v_mfma_f32_32x32x16_bf16 v[76:91], a[196:199], v[104:107], v[76:91]
    s_waitcnt lgkmcnt(3)
    ds_read_b64_tr_b16 v[122:123], v3 offset:39424
    v_mfma_f32_32x32x16_bf16 v[28:43], v[108:111], a[72:75], v[28:43]
    s_waitcnt vmcnt(20)
    ds_read_b64_tr_b16 v[92:93], v2 offset:40960
    ds_read_b128 a[80:83], v14 offset:16384
    v_mfma_f32_32x32x16_bf16 v[28:43], v[112:115], a[76:79], v[28:43]
    ds_read_b64_tr_b16 v[94:95], v2 offset:41472
    ds_read_b128 a[208:211], v14 offset:20480
    v_mfma_f32_32x32x16_bf16 v[44:59], v[108:111], a[200:203], v[44:59]
    ds_read_b64_tr_b16 v[96:97], v2 offset:43008
    ds_read_b128 a[84:87], v15 offset:16384
    v_mfma_f32_32x32x16_bf16 v[44:59], v[112:115], a[204:207], v[44:59]
    s_waitcnt lgkmcnt(6)
    ds_read_b64_tr_b16 v[98:99], v2 offset:43520
    ds_read_b128 a[212:215], v15 offset:20480
    v_mfma_f32_32x32x16_bf16 v[60:75], a[72:75], v[116:119], v[60:75]
    ds_read_b128 a[88:91], v16 offset:16384
    ds_read_b64_tr_b16 v[100:101], v3 offset:40960
    v_mfma_f32_32x32x16_bf16 v[60:75], a[76:79], v[120:123], v[60:75]
    ds_read_b128 a[216:219], v16 offset:20480
    ds_read_b64_tr_b16 v[102:103], v3 offset:41472
    v_mfma_f32_32x32x16_bf16 v[76:91], a[200:203], v[116:119], v[76:91]
    ds_read_b128 a[92:95], v17 offset:16384
    ds_read_b64_tr_b16 v[104:105], v3 offset:43008
    v_mfma_f32_32x32x16_bf16 v[76:91], a[204:207], v[120:123], v[76:91]
    s_waitcnt lgkmcnt(1)
    ds_read_b128 a[220:223], v17 offset:20480
    ds_read_b64_tr_b16 v[106:107], v3 offset:43520
    v_mfma_f32_32x32x16_bf16 v[28:43], v[92:95], a[80:83], v[28:43]
    ds_read_b64_tr_b16 v[108:109], v2 offset:45056
    v_mfma_f32_32x32x16_bf16 v[28:43], v[96:99], a[84:87], v[28:43]
    ds_read_b64_tr_b16 v[110:111], v2 offset:45568
    v_mfma_f32_32x32x16_bf16 v[44:59], v[92:95], a[208:211], v[44:59]
    ds_read_b64_tr_b16 v[112:113], v2 offset:47104
    v_mfma_f32_32x32x16_bf16 v[44:59], v[96:99], a[212:215], v[44:59]
    s_waitcnt lgkmcnt(3)
    ds_read_b64_tr_b16 v[114:115], v2 offset:47616
    v_mfma_f32_32x32x16_bf16 v[60:75], a[80:83], v[100:103], v[60:75]
    ds_read_b64_tr_b16 v[116:117], v3 offset:45056
    v_mfma_f32_32x32x16_bf16 v[60:75], a[84:87], v[104:107], v[60:75]
    ds_read_b64_tr_b16 v[118:119], v3 offset:45568
    v_mfma_f32_32x32x16_bf16 v[76:91], a[208:211], v[100:103], v[76:91]
    ds_read_b64_tr_b16 v[120:121], v3 offset:47104
    v_mfma_f32_32x32x16_bf16 v[76:91], a[212:215], v[104:107], v[76:91]
    s_waitcnt lgkmcnt(3)
    ds_read_b64_tr_b16 v[122:123], v3 offset:47616
    v_mfma_f32_32x32x16_bf16 v[28:43], v[108:111], a[88:91], v[28:43]
    s_waitcnt vmcnt(12)
    s_barrier
    s_add_u32 m0, s26, 16384
    s_add_u32 s25, s22, s45
    ds_read_b64_tr_b16 v[92:93], v2 offset:49152
    ds_read_b128 a[96:99], v14 offset:0
    v_mfma_f32_32x32x16_bf16 v[28:43], v[112:115], a[92:95], v[28:43]
    buffer_load_dwordx4 v6, s[12:15], s25 offen offset:0 lds
    ds_read_b64_tr_b16 v[94:95], v2 offset:49664
    ds_read_b128 a[224:227], v14 offset:4096
    v_mfma_f32_32x32x16_bf16 v[44:59], v[108:111], a[216:219], v[44:59]
    buffer_load_dwordx4 v7, s[12:15], s25 offen offset:1024 lds
    ds_read_b64_tr_b16 v[96:97], v2 offset:51200
    ds_read_b128 a[100:103], v15 offset:0
    v_mfma_f32_32x32x16_bf16 v[44:59], v[112:115], a[220:223], v[44:59]
    s_waitcnt lgkmcnt(6)
    buffer_load_dwordx4 v8, s[12:15], s25 offen offset:2048 lds
    ds_read_b64_tr_b16 v[98:99], v2 offset:51712
    ds_read_b128 a[228:231], v15 offset:4096
    v_mfma_f32_32x32x16_bf16 v[60:75], a[88:91], v[116:119], v[60:75]
    buffer_load_dwordx4 v9, s[12:15], s25 offen offset:3072 lds
    ds_read_b128 a[104:107], v16 offset:0
    ds_read_b64_tr_b16 v[100:101], v3 offset:49152
    v_mfma_f32_32x32x16_bf16 v[60:75], a[92:95], v[120:123], v[60:75]
    ds_read_b128 a[232:235], v16 offset:4096
    ds_read_b64_tr_b16 v[102:103], v3 offset:49664
    v_mfma_f32_32x32x16_bf16 v[76:91], a[216:219], v[116:119], v[76:91]
    ds_read_b128 a[108:111], v17 offset:0
    ds_read_b64_tr_b16 v[104:105], v3 offset:51200
    v_mfma_f32_32x32x16_bf16 v[76:91], a[220:223], v[120:123], v[76:91]
    s_waitcnt lgkmcnt(1)
    ds_read_b128 a[236:239], v17 offset:4096
    ds_read_b64_tr_b16 v[106:107], v3 offset:51712
    v_mfma_f32_32x32x16_bf16 v[28:43], v[92:95], a[96:99], v[28:43]
    ds_read_b64_tr_b16 v[108:109], v2 offset:53248
    v_mfma_f32_32x32x16_bf16 v[28:43], v[96:99], a[100:103], v[28:43]
    ds_read_b64_tr_b16 v[110:111], v2 offset:53760
    v_mfma_f32_32x32x16_bf16 v[44:59], v[92:95], a[224:227], v[44:59]
    ds_read_b64_tr_b16 v[112:113], v2 offset:55296
    v_mfma_f32_32x32x16_bf16 v[44:59], v[96:99], a[228:231], v[44:59]
    s_waitcnt lgkmcnt(3)
    ds_read_b64_tr_b16 v[114:115], v2 offset:55808
    v_mfma_f32_32x32x16_bf16 v[60:75], a[96:99], v[100:103], v[60:75]
    ds_read_b64_tr_b16 v[116:117], v3 offset:53248
    v_mfma_f32_32x32x16_bf16 v[60:75], a[100:103], v[104:107], v[60:75]
    ds_read_b64_tr_b16 v[118:119], v3 offset:53760
    v_mfma_f32_32x32x16_bf16 v[76:91], a[224:227], v[100:103], v[76:91]
    ds_read_b64_tr_b16 v[120:121], v3 offset:55296
    v_mfma_f32_32x32x16_bf16 v[76:91], a[228:231], v[104:107], v[76:91]
    s_waitcnt lgkmcnt(3)
    ds_read_b64_tr_b16 v[122:123], v3 offset:55808
    v_mfma_f32_32x32x16_bf16 v[28:43], v[108:111], a[104:107], v[28:43]
    s_waitcnt vmcnt(4)
    ds_read_b64_tr_b16 v[92:93], v2 offset:57344
    ds_read_b128 a[112:115], v14 offset:8192
    v_mfma_f32_32x32x16_bf16 v[28:43], v[112:115], a[108:111], v[28:43]
    ds_read_b64_tr_b16 v[94:95], v2 offset:57856
    ds_read_b128 a[240:243], v14 offset:12288
    v_mfma_f32_32x32x16_bf16 v[44:59], v[108:111], a[232:235], v[44:59]
    ds_read_b64_tr_b16 v[96:97], v2 offset:59392
    ds_read_b128 a[116:119], v15 offset:8192
    v_mfma_f32_32x32x16_bf16 v[44:59], v[112:115], a[236:239], v[44:59]
    s_waitcnt lgkmcnt(6)
    ds_read_b64_tr_b16 v[98:99], v2 offset:59904
    ds_read_b128 a[244:247], v15 offset:12288
    v_mfma_f32_32x32x16_bf16 v[60:75], a[104:107], v[116:119], v[60:75]
    ds_read_b128 a[120:123], v16 offset:8192
    ds_read_b64_tr_b16 v[100:101], v3 offset:57344
    v_mfma_f32_32x32x16_bf16 v[60:75], a[108:111], v[120:123], v[60:75]
    ds_read_b128 a[248:251], v16 offset:12288
    ds_read_b64_tr_b16 v[102:103], v3 offset:57856
    v_mfma_f32_32x32x16_bf16 v[76:91], a[232:235], v[116:119], v[76:91]
    ds_read_b128 a[124:127], v17 offset:8192
    ds_read_b64_tr_b16 v[104:105], v3 offset:59392
    v_mfma_f32_32x32x16_bf16 v[76:91], a[236:239], v[120:123], v[76:91]
    s_waitcnt lgkmcnt(1)
    ds_read_b128 a[252:255], v17 offset:12288
    ds_read_b64_tr_b16 v[106:107], v3 offset:59904
    v_mfma_f32_32x32x16_bf16 v[28:43], v[92:95], a[112:115], v[28:43]
    ds_read_b64_tr_b16 v[108:109], v2 offset:61440
    v_mfma_f32_32x32x16_bf16 v[28:43], v[96:99], a[116:119], v[28:43]
    ds_read_b64_tr_b16 v[110:111], v2 offset:61952
    v_mfma_f32_32x32x16_bf16 v[44:59], v[92:95], a[240:243], v[44:59]
    ds_read_b64_tr_b16 v[112:113], v2 offset:63488
    v_mfma_f32_32x32x16_bf16 v[44:59], v[96:99], a[244:247], v[44:59]
    s_waitcnt lgkmcnt(3)
    ds_read_b64_tr_b16 v[114:115], v2 offset:64000
    v_mfma_f32_32x32x16_bf16 v[60:75], a[112:115], v[100:103], v[60:75]
    ds_read_b64_tr_b16 v[116:117], v3 offset:61440
    v_mfma_f32_32x32x16_bf16 v[60:75], a[116:119], v[104:107], v[60:75]
    ds_read_b64_tr_b16 v[118:119], v3 offset:61952
    v_mfma_f32_32x32x16_bf16 v[76:91], a[240:243], v[100:103], v[76:91]
    ds_read_b64_tr_b16 v[120:121], v3 offset:63488
    v_mfma_f32_32x32x16_bf16 v[76:91], a[244:247], v[104:107], v[76:91]
    s_waitcnt lgkmcnt(3)
    ds_read_b64_tr_b16 v[122:123], v3 offset:64000
    v_mfma_f32_32x32x16_bf16 v[28:43], v[108:111], a[120:123], v[28:43]
    s_barrier
    s_add_u32 m0, s26, 32768
    s_add_u32 s25, s22, s50
    ds_read_b64_tr_b16 v[92:93], v2 offset:0
    v_mfma_f32_32x32x16_bf16 v[28:43], v[112:115], a[124:127], v[28:43]
    buffer_load_dwordx4 v6, s[12:15], s25 offen offset:0 lds
    ds_read_b64_tr_b16 v[94:95], v2 offset:512
    v_mfma_f32_32x32x16_bf16 v[44:59], v[108:111], a[248:251], v[44:59]
    buffer_load_dwordx4 v7, s[12:15], s25 offen offset:1024 lds
    ds_read_b64_tr_b16 v[96:97], v2 offset:2048
    v_mfma_f32_32x32x16_bf16 v[44:59], v[112:115], a[252:255], v[44:59]
    s_waitcnt lgkmcnt(3)
    buffer_load_dwordx4 v8, s[12:15], s25 offen offset:2048 lds
    ds_read_b64_tr_b16 v[98:99], v2 offset:2560
    v_mfma_f32_32x32x16_bf16 v[60:75], a[120:123], v[116:119], v[60:75]
    buffer_load_dwordx4 v9, s[12:15], s25 offen offset:3072 lds
    ds_read_b64_tr_b16 v[100:101], v3 offset:0
    v_mfma_f32_32x32x16_bf16 v[60:75], a[124:127], v[120:123], v[60:75]
    ds_read_b64_tr_b16 v[102:103], v3 offset:512
    s_sub_u32 m0, s26, 49152
    s_lshl_b32 s33, s31, 10
    v_cvt_pk_bf16_f32 v124, v28, v29
    v_cvt_pk_bf16_f32 v125, v30, v31
    v_cvt_pk_bf16_f32 v126, v32, v33
    v_cvt_pk_bf16_f32 v127, v34, v35
    v_mfma_f32_32x32x16_bf16 v[76:91], a[248:251], v[116:119], v[76:91]
    ds_read_b64_tr_b16 v[104:105], v3 offset:2048
    buffer_load_dwordx4 v18, s[40:43], s33 offen offset:0 lds
    buffer_load_dwordx4 v18, s[40:43], s33 offen offset:1024 lds
    buffer_load_dwordx4 v18, s[40:43], s33 offen offset:2048 lds
    s_mov_b32 s21, s22
    s_add_u32 s22, s22, 64
    v_cvt_pk_bf16_f32 v128, v36, v37
    v_cvt_pk_bf16_f32 v129, v38, v39
    v_cvt_pk_bf16_f32 v130, v40, v41
    v_cvt_pk_bf16_f32 v131, v42, v43
    v_mfma_f32_32x32x16_bf16 v[76:91], a[252:255], v[120:123], v[76:91]
    s_waitcnt lgkmcnt(3)
    ds_read_b64_tr_b16 v[106:107], v3 offset:2560
    v_cvt_pk_bf16_f32 v132, v44, v45
    v_cvt_pk_bf16_f32 v133, v46, v47
    v_cvt_pk_bf16_f32 v134, v48, v49
    v_cvt_pk_bf16_f32 v135, v50, v51
L1A_loop:
    v_mfma_f32_32x32x16_bf16 v[28:43], v[92:95], a[0:3], 0
    ds_read_b64_tr_b16 v[108:109], v2 offset:4096
    v_cvt_pk_bf16_f32 v136, v52, v53
    v_cvt_pk_bf16_f32 v137, v54, v55
    v_cvt_pk_bf16_f32 v138, v56, v57
    v_cvt_pk_bf16_f32 v139, v58, v59
    v_mfma_f32_32x32x16_bf16 v[28:43], v[96:99], a[4:7], v[28:43]
    ds_read_b64_tr_b16 v[110:111], v2 offset:4608
    v_cvt_pk_bf16_f32 v140, v60, v61
    v_cvt_pk_bf16_f32 v141, v62, v63
    v_cvt_pk_bf16_f32 v142, v64, v65
    v_cvt_pk_bf16_f32 v143, v66, v67
    v_mfma_f32_32x32x16_bf16 v[44:59], v[92:95], a[128:131], 0
    ds_read_b64_tr_b16 v[112:113], v2 offset:6144
    v_cvt_pk_bf16_f32 v144, v68, v69
    v_cvt_pk_bf16_f32 v145, v70, v71
    v_cvt_pk_bf16_f32 v146, v72, v73
    v_cvt_pk_bf16_f32 v147, v74, v75
    v_mfma_f32_32x32x16_bf16 v[44:59], v[96:99], a[132:135], v[44:59]
    s_waitcnt lgkmcnt(3)
    ds_read_b64_tr_b16 v[114:115], v2 offset:6656
    v_cvt_pk_bf16_f32 v148, v76, v77
    v_cvt_pk_bf16_f32 v149, v78, v79
    v_cvt_pk_bf16_f32 v150, v80, v81
    v_cvt_pk_bf16_f32 v151, v82, v83
    v_mfma_f32_32x32x16_bf16 v[60:75], a[0:3], v[100:103], 0
    ds_read_b64_tr_b16 v[116:117], v3 offset:4096
    v_cvt_pk_bf16_f32 v152, v84, v85
    v_cvt_pk_bf16_f32 v153, v86, v87
    v_cvt_pk_bf16_f32 v154, v88, v89
    v_cvt_pk_bf16_f32 v155, v90, v91
    v_mfma_f32_32x32x16_bf16 v[60:75], a[4:7], v[104:107], v[60:75]
    ds_read_b64_tr_b16 v[118:119], v3 offset:4608
    s_waitcnt vmcnt(0)
    ds_read_b64_tr_b16 v[10:11], v22 offset:0
    ds_read_b128 v[164:167], v25 offset:0
    ds_read_b64_tr_b16 v[12:13], v22 offset:256
    ds_read_b128 v[168:171], v25 offset:1024
    v_mfma_f32_32x32x16_bf16 v[76:91], a[128:131], v[100:103], 0
    ds_read_b64_tr_b16 v[120:121], v3 offset:6144
    ds_read_b128 v[172:175], v25 offset:8192
    ds_read_b128 v[176:179], v25 offset:9216
    ds_read_b128 v[180:183], v25 offset:16384
    ds_read_b128 v[184:187], v25 offset:17408
    ds_read_b128 v[188:191], v25 offset:24576
    v_mfma_f32_32x32x16_bf16 v[76:91], a[132:135], v[104:107], v[76:91]
    s_waitcnt lgkmcnt(12)
    ds_read_b64_tr_b16 v[122:123], v3 offset:6656
    ds_read_b128 v[192:195], v25 offset:25600
    v_mfma_f32_32x32x16_bf16 v[28:43], v[108:111], a[8:11], v[28:43]
    ds_read_b64_tr_b16 v[92:93], v2 offset:8192
    v_mfma_f32_32x32x16_bf16 v[28:43], v[112:115], a[12:15], v[28:43]
    ds_read_b64_tr_b16 v[94:95], v2 offset:8704
    v_mfma_f32_32x32x16_bf16 v[44:59], v[108:111], a[136:139], v[44:59]
    ds_read_b64_tr_b16 v[96:97], v2 offset:10240
    v_mfma_f32_32x32x16_bf16 v[44:59], v[112:115], a[140:143], v[44:59]
    s_waitcnt lgkmcnt(3)
    ds_read_b64_tr_b16 v[98:99], v2 offset:10752
    v_xor_b32 v10, v23, v10
    v_add_f32 v164, v164, v172
    v_xor_b32 v11, v23, v11
    v_add_f32 v165, v165, v173
    v_xor_b32 v12, v23, v12
    v_mfma_f32_32x32x16_bf16 v[60:75], a[8:11], v[116:119], v[60:75]
    ds_read_b64_tr_b16 v[100:101], v3 offset:8192
    v_xor_b32 v13, v23, v13
    v_add_f32 v166, v166, v174
    v_add_f32 v167, v167, v175
    v_mfma_f32_32x32x16_bf16 v[196:211], v[10:13], v[124:127], 0
    v_add_f32 v168, v168, v176
    v_add_f32 v169, v169, v177
    v_add_f32 v170, v170, v178
    v_add_f32 v171, v171, v179
    v_add_f32 v180, v180, v188
    v_add_f32 v181, v181, v189
    v_mfma_f32_32x32x16_bf16 v[60:75], a[12:15], v[120:123], v[60:75]
    ds_read_b64_tr_b16 v[102:103], v3 offset:8704
    v_add_f32 v182, v182, v190
    v_add_f32 v183, v183, v191
    v_add_f32 v184, v184, v192
    v_add_f32 v185, v185, v193
    v_max3_f32 v220, v196, v197, v198
    v_mfma_f32_32x32x16_bf16 v[76:91], a[136:139], v[116:119], v[76:91]
    ds_read_b64_tr_b16 v[104:105], v3 offset:10240
    v_max3_f32 v220, v220, v199, v200
    v_add_f32 v186, v186, v194
    v_max3_f32 v220, v220, v201, v202
    v_add_f32 v187, v187, v195
    v_max_f32 v220, v220, v203
    v_mfma_f32_32x32x16_bf16 v[76:91], a[140:143], v[120:123], v[76:91]
    s_waitcnt lgkmcnt(3)
    ds_read_b64_tr_b16 v[106:107], v3 offset:10752
    v_max3_f32 v221, v204, v205, v206
    v_add_f32 v164, v164, v180
    v_max3_f32 v221, v221, v207, v208
    v_add_f32 v165, v165, v181
    v_max3_f32 v221, v221, v209, v210
    v_mfma_f32_32x32x16_bf16 v[28:43], v[92:95], a[16:19], v[28:43]
    ds_read_b64_tr_b16 v[108:109], v2 offset:12288
    v_max_f32 v221, v221, v211
    v_add_f32 v166, v166, v182
    v_add_f32 v167, v167, v183
    v_permlane32_swap_b32 v220, v221
    v_mfma_f32_32x32x16_bf16 v[28:43], v[96:99], a[20:23], v[28:43]
    ds_read_b64_tr_b16 v[110:111], v2 offset:12800
    v_max_f32 v220, v220, v221
    v_add_f32 v168, v168, v184
    v_mul_f32 v220, s34, v220
    v_add_f32 v169, v169, v185
    v_mov_b32 v221, v220
    v_mfma_f32_32x32x16_bf16 v[44:59], v[92:95], a[144:147], v[44:59]
    ds_read_b64_tr_b16 v[112:113], v2 offset:14336
    v_permlane32_swap_b32 v220, v221
    v_add_f32 v170, v170, v186
    v_fma_f32 v196, v196, s34, -v220
    v_add_f32 v171, v171, v187
    v_mfma_f32_32x32x16_bf16 v[44:59], v[96:99], a[148:151], v[44:59]
    s_waitcnt lgkmcnt(3)
    ds_read_b64_tr_b16 v[114:115], v2 offset:14848
    v_fma_f32 v197, v197, s34, -v220
    buffer_store_dwordx4 v[164:167], v18, s[16:19], s23 offen offset:0 sc1
    v_mfma_f32_32x32x16_bf16 v[60:75], a[16:19], v[100:103], v[60:75]
    ds_read_b64_tr_b16 v[116:117], v3 offset:12288
    v_fma_f32 v198, v198, s34, -v220
    buffer_store_dwordx4 v[168:171], v18, s[16:19], s23 offen offset:1024 sc1
    v_mfma_f32_32x32x16_bf16 v[60:75], a[20:23], v[104:107], v[60:75]
    ds_read_b64_tr_b16 v[118:119], v3 offset:12800
    v_fma_f32 v199, v199, s34, -v220
    s_mov_b32 s23, s35
    v_fma_f32 v200, v200, s34, -v220
    s_add_u32 s35, s35, 8192
    v_fma_f32 v201, v201, s34, -v220
    v_mfma_f32_32x32x16_bf16 v[76:91], a[144:147], v[100:103], v[76:91]
    ds_read_b64_tr_b16 v[120:121], v3 offset:14336
    v_fma_f32 v202, v202, s34, -v220
    ds_read_b64_tr_b16 v[14:15], v22 offset:512
    v_fma_f32 v203, v203, s34, -v220
    v_mfma_f32_32x32x16_bf16 v[76:91], a[148:151], v[104:107], v[76:91]
    s_waitcnt lgkmcnt(4)
    ds_read_b64_tr_b16 v[122:123], v3 offset:14848
    v_fma_f32 v204, v204, s34, -v221
    ds_read_b64_tr_b16 v[16:17], v22 offset:768
    v_fma_f32 v205, v205, s34, -v221
    v_mfma_f32_32x32x16_bf16 v[28:43], v[108:111], a[24:27], v[28:43]
    s_waitcnt vmcnt(6)
    s_barrier
    s_add_u32 m0, s26, 49152
    s_add_u32 s25, s21, s51
    ds_read_b64_tr_b16 v[92:93], v2 offset:16384
    v_fma_f32 v206, v206, s34, -v221
    v_fma_f32 v207, v207, s34, -v221
    v_mfma_f32_32x32x16_bf16 v[28:43], v[112:115], a[28:31], v[28:43]
    buffer_load_dwordx4 v6, s[12:15], s25 offen offset:0 lds
    ds_read_b64_tr_b16 v[94:95], v2 offset:16896
    v_fma_f32 v208, v208, s34, -v221
    v_fma_f32 v209, v209, s34, -v221
    v_fma_f32 v210, v210, s34, -v221
    v_mfma_f32_32x32x16_bf16 v[44:59], v[108:111], a[152:155], v[44:59]
    buffer_load_dwordx4 v7, s[12:15], s25 offen offset:1024 lds
    ds_read_b64_tr_b16 v[96:97], v2 offset:18432
    v_fma_f32 v211, v211, s34, -v221
    v_exp_f32 v196, v196
    v_mfma_f32_32x32x16_bf16 v[44:59], v[112:115], a[156:159], v[44:59]
    s_waitcnt lgkmcnt(4)
    buffer_load_dwordx4 v8, s[12:15], s25 offen offset:2048 lds
    ds_read_b64_tr_b16 v[98:99], v2 offset:18944
    v_exp_f32 v197, v197
    v_mfma_f32_32x32x16_bf16 v[60:75], a[24:27], v[116:119], v[60:75]
    buffer_load_dwordx4 v9, s[12:15], s25 offen offset:3072 lds
    ds_read_b64_tr_b16 v[100:101], v3 offset:16384
    v_exp_f32 v198, v198
    s_waitcnt lgkmcnt(5)
    v_mfma_f32_32x32x16_bf16 v[60:75], a[28:31], v[120:123], v[60:75]
    ds_read_b64_tr_b16 v[102:103], v3 offset:16896
    v_exp_f32 v199, v199
    v_xor_b32 v14, v23, v14
    v_exp_f32 v200, v200
    v_mfma_f32_32x32x16_bf16 v[76:91], a[152:155], v[116:119], v[76:91]
    ds_read_b64_tr_b16 v[104:105], v3 offset:18432
    v_exp_f32 v201, v201
    v_xor_b32 v15, v23, v15
    v_exp_f32 v202, v202
    v_mfma_f32_32x32x16_bf16 v[76:91], a[156:159], v[120:123], v[76:91]
    s_waitcnt lgkmcnt(3)
    ds_read_b64_tr_b16 v[106:107], v3 offset:18944
    v_exp_f32 v203, v203
    v_xor_b32 v16, v23, v16
    v_exp_f32 v204, v204
    v_mfma_f32_32x32x16_bf16 v[28:43], v[92:95], a[32:35], v[28:43]
    ds_read_b64_tr_b16 v[108:109], v2 offset:20480
    s_cmp_eq_u32 s24, 1
    s_cselect_b32 s59, -1, 0
    s_cselect_b32 s22, s58, s22
    v_and_b32 v27, s59, v26
    v_xor_b32 v17, v23, v17
    v_mfma_f32_32x32x16_bf16 v[28:43], v[96:99], a[36:39], v[28:43]
    ds_read_b64_tr_b16 v[110:111], v2 offset:20992
    v_sub_u32 v6, v6, v27
    v_sub_u32 v7, v7, v27
    v_sub_u32 v8, v8, v27
    v_sub_u32 v9, v9, v27
    v_mfma_f32_32x32x16_bf16 v[226:241], v[14:17], v[128:131], 0
    v_exp_f32 v205, v205
    v_exp_f32 v206, v206
    v_exp_f32 v207, v207
    v_mfma_f32_32x32x16_bf16 v[44:59], v[92:95], a[160:163], v[44:59]
    ds_read_b64_tr_b16 v[112:113], v2 offset:22528
    v_exp_f32 v208, v208
    v_exp_f32 v209, v209
    v_mfma_f32_32x32x16_bf16 v[44:59], v[96:99], a[164:167], v[44:59]
    s_waitcnt lgkmcnt(3)
    ds_read_b64_tr_b16 v[114:115], v2 offset:23040
    v_exp_f32 v210, v210
    v_exp_f32 v211, v211
    v_max3_f32 v250, v226, v227, v228
    v_mfma_f32_32x32x16_bf16 v[60:75], a[32:35], v[100:103], v[60:75]
    ds_read_b64_tr_b16 v[116:117], v3 offset:20480
    v_add_f32 v220, v196, v197
    v_max3_f32 v250, v250, v229, v230
    v_add_f32 v220, v220, v198
    v_max3_f32 v250, v250, v231, v232
    v_add_f32 v220, v220, v199
    v_mfma_f32_32x32x16_bf16 v[60:75], a[36:39], v[104:107], v[60:75]
    ds_read_b64_tr_b16 v[118:119], v3 offset:20992
    v_add_f32 v220, v220, v200
    v_max_f32 v250, v250, v233
    v_add_f32 v220, v220, v201
    v_max3_f32 v251, v234, v235, v236
    v_add_f32 v220, v220, v202
    v_mfma_f32_32x32x16_bf16 v[76:91], a[160:163], v[100:103], v[76:91]
    ds_read_b64_tr_b16 v[120:121], v3 offset:22528
    v_add_f32 v220, v220, v203
    v_max3_f32 v251, v251, v237, v238
    v_add_f32 v221, v204, v205
    v_max3_f32 v251, v251, v239, v240
    v_add_f32 v221, v221, v206
    v_mfma_f32_32x32x16_bf16 v[76:91], a[164:167], v[104:107], v[76:91]
    s_waitcnt lgkmcnt(3)
    ds_read_b64_tr_b16 v[122:123], v3 offset:23040
    v_add_f32 v221, v221, v207
    v_max_f32 v251, v251, v241
    v_add_f32 v221, v221, v208
    v_add_f32 v221, v221, v209
    v_add_f32 v221, v221, v210
    v_mfma_f32_32x32x16_bf16 v[28:43], v[108:111], a[40:43], v[28:43]
    ds_read_b64_tr_b16 v[92:93], v2 offset:24576
    v_add_f32 v221, v221, v211
    v_permlane32_swap_b32 v250, v251
    v_max_f32 v250, v250, v251
    v_mul_f32 v250, s34, v250
    v_mfma_f32_32x32x16_bf16 v[28:43], v[112:115], a[44:47], v[28:43]
    ds_read_b64_tr_b16 v[94:95], v2 offset:25088
    v_permlane32_swap_b32 v220, v221
    v_mov_b32 v251, v250
    v_add_f32 v220, v220, v221
    v_mfma_f32_32x32x16_bf16 v[44:59], v[108:111], a[168:171], v[44:59]
    ds_read_b64_tr_b16 v[96:97], v2 offset:26624
    v_rcp_f32 v220, v220
    v_permlane32_swap_b32 v250, v251
    v_mov_b32 v221, v220
    v_mfma_f32_32x32x16_bf16 v[44:59], v[112:115], a[172:175], v[44:59]
    s_waitcnt lgkmcnt(3)
    ds_read_b64_tr_b16 v[98:99], v2 offset:27136
    v_permlane32_swap_b32 v220, v221
    v_fma_f32 v226, v226, s34, -v250
    v_mul_f32 v196, v196, v220
    v_fma_f32 v227, v227, s34, -v250
    v_mfma_f32_32x32x16_bf16 v[60:75], a[40:43], v[116:119], v[60:75]
    ds_read_b64_tr_b16 v[100:101], v3 offset:24576
    v_mul_f32 v197, v197, v220
    v_fma_f32 v228, v228, s34, -v250
    v_mul_f32 v198, v198, v220
    v_fma_f32 v229, v229, s34, -v250
    v_mul_f32 v199, v199, v220
    v_mfma_f32_32x32x16_bf16 v[60:75], a[44:47], v[120:123], v[60:75]
    ds_read_b64_tr_b16 v[102:103], v3 offset:25088
    v_mul_f32 v200, v200, v220
    v_fma_f32 v230, v230, s34, -v250
    v_mul_f32 v201, v201, v220
    v_fma_f32 v231, v231, s34, -v250
    v_mul_f32 v202, v202, v220
    v_mfma_f32_32x32x16_bf16 v[76:91], a[168:171], v[116:119], v[76:91]
    ds_read_b64_tr_b16 v[104:105], v3 offset:26624
    v_mul_f32 v203, v203, v220
    v_fma_f32 v232, v232, s34, -v250
    v_mul_f32 v204, v204, v221
    v_fma_f32 v233, v233, s34, -v250
    v_mul_f32 v205, v205, v221
    v_mfma_f32_32x32x16_bf16 v[76:91], a[172:175], v[120:123], v[76:91]
    s_waitcnt lgkmcnt(3)
    ds_read_b64_tr_b16 v[106:107], v3 offset:27136
    v_mul_f32 v206, v206, v221
    v_fma_f32 v234, v234, s34, -v251
    v_mul_f32 v207, v207, v221
    v_fma_f32 v235, v235, s34, -v251
    v_mul_f32 v208, v208, v221
    v_mfma_f32_32x32x16_bf16 v[28:43], v[92:95], a[48:51], v[28:43]
    ds_read_b64_tr_b16 v[108:109], v2 offset:28672
    v_mul_f32 v209, v209, v221
    v_fma_f32 v236, v236, s34, -v251
    v_mul_f32 v210, v210, v221
    v_fma_f32 v237, v237, s34, -v251
    v_mul_f32 v211, v211, v221
    v_mfma_f32_32x32x16_bf16 v[28:43], v[96:99], a[52:55], v[28:43]
    ds_read_b64_tr_b16 v[110:111], v2 offset:29184
    v_cvt_pk_bf16_f32 v212, v196, v197
    v_fma_f32 v238, v238, s34, -v251
    v_cvt_pk_bf16_f32 v213, v198, v199
    v_fma_f32 v239, v239, s34, -v251
    v_cvt_pk_bf16_f32 v214, v200, v201
    v_mfma_f32_32x32x16_bf16 v[44:59], v[92:95], a[176:179], v[44:59]
    ds_read_b64_tr_b16 v[112:113], v2 offset:30720
    v_cvt_pk_bf16_f32 v215, v202, v203
    v_fma_f32 v240, v240, s34, -v251
    v_cvt_pk_bf16_f32 v216, v204, v205
    v_fma_f32 v241, v241, s34, -v251
    v_cvt_pk_bf16_f32 v217, v206, v207
    v_mfma_f32_32x32x16_bf16 v[44:59], v[96:99], a[180:183], v[44:59]
    s_waitcnt lgkmcnt(3)
    ds_read_b64_tr_b16 v[114:115], v2 offset:31232
    v_cvt_pk_bf16_f32 v218, v208, v209
    v_exp_f32 v226, v226
    v_cvt_pk_bf16_f32 v219, v210, v211
    v_mfma_f32_32x32x16_bf16 v[196:211], v[212:215], v[156:159], 0
    v_exp_f32 v227, v227
    v_mfma_f32_32x32x16_bf16 v[196:211], v[216:219], v[160:163], v[196:211]
    v_exp_f32 v228, v228
    v_exp_f32 v229, v229
    v_exp_f32 v230, v230
    v_mfma_f32_32x32x16_bf16 v[60:75], a[48:51], v[100:103], v[60:75]
    ds_read_b64_tr_b16 v[116:117], v3 offset:28672
    v_exp_f32 v231, v231
    v_exp_f32 v232, v232
    v_mfma_f32_32x32x16_bf16 v[60:75], a[52:55], v[104:107], v[60:75]
    ds_read_b64_tr_b16 v[118:119], v3 offset:29184
    v_exp_f32 v233, v233
    v_exp_f32 v234, v234
    v_mfma_f32_32x32x16_bf16 v[76:91], a[176:179], v[100:103], v[76:91]
    ds_read_b64_tr_b16 v[120:121], v3 offset:30720
    v_cvt_pk_bf16_f32 v212, v196, v197
    v_exp_f32 v235, v235
    v_cvt_pk_bf16_f32 v213, v198, v199
    v_cvt_pk_bf16_f32 v214, v200, v201
    v_mfma_f32_32x32x16_bf16 v[76:91], a[180:183], v[104:107], v[76:91]
    s_waitcnt lgkmcnt(3)
    ds_read_b64_tr_b16 v[122:123], v3 offset:31232
    v_cvt_pk_bf16_f32 v215, v202, v203
    v_exp_f32 v236, v236
    v_cvt_pk_bf16_f32 v216, v204, v205
    v_cvt_pk_bf16_f32 v217, v206, v207
    v_mfma_f32_32x32x16_bf16 v[28:43], v[108:111], a[56:59], v[28:43]
    s_waitcnt vmcnt(6)
    s_barrier
    s_add_u32 m0, s26, 0
    s_add_u32 s25, s22, s44
    ds_read_b64_tr_b16 v[92:93], v2 offset:32768
    v_cvt_pk_bf16_f32 v218, v208, v209
    v_cvt_pk_bf16_f32 v219, v210, v211
    v_mfma_f32_32x32x16_bf16 v[28:43], v[112:115], a[60:63], v[28:43]
    buffer_load_dwordx4 v6, s[12:15], s25 offen offset:0 lds
    ds_read_b64_tr_b16 v[94:95], v2 offset:33280
    v_cndmask_b32 v196, v1, v140, s[36:37]
    v_exp_f32 v237, v237
    v_mfma_f32_32x32x16_bf16 v[44:59], v[108:111], a[184:187], v[44:59]
    buffer_load_dwordx4 v7, s[12:15], s25 offen offset:1024 lds
    ds_read_b64_tr_b16 v[96:97], v2 offset:34816
    v_cndmask_b32 v197, v1, v141, s[36:37]
    v_exp_f32 v238, v238
    v_mfma_f32_32x32x16_bf16 v[44:59], v[112:115], a[188:191], v[44:59]
    s_waitcnt lgkmcnt(3)
    buffer_load_dwordx4 v8, s[12:15], s25 offen offset:2048 lds
    ds_read_b64_tr_b16 v[98:99], v2 offset:35328
    v_cndmask_b32 v198, v1, v142, s[36:37]
    v_exp_f32 v239, v239
    v_mfma_f32_32x32x16_bf16 v[60:75], a[56:59], v[116:119], v[60:75]
    buffer_load_dwordx4 v9, s[12:15], s25 offen offset:3072 lds
    ds_read_b64_tr_b16 v[100:101], v3 offset:32768
    v_cndmask_b32 v199, v1, v143, s[36:37]
    v_exp_f32 v240, v240
    v_mfma_f32_32x32x16_bf16 v[60:75], a[60:63], v[120:123], v[60:75]
    ds_read_b64_tr_b16 v[102:103], v3 offset:33280
    v_cndmask_b32 v200, v1, v144, s[36:37]
    v_exp_f32 v241, v241
    v_cndmask_b32 v201, v1, v145, s[36:37]
    v_add_f32 v250, v226, v227
    v_mfma_f32_32x32x16_bf16 v[76:91], a[184:187], v[116:119], v[76:91]
    ds_read_b64_tr_b16 v[104:105], v3 offset:34816
    v_cndmask_b32 v202, v1, v146, s[36:37]
    v_add_f32 v250, v250, v228
    v_cndmask_b32 v203, v1, v147, s[36:37]
    v_add_f32 v250, v250, v229
    v_mfma_f32_32x32x16_bf16 v[164:179], v[212:215], v[196:199], 0
    v_add_f32 v250, v250, v230
    v_mfma_f32_32x32x16_bf16 v[164:179], v[216:219], v[200:203], v[164:179]
    v_add_f32 v250, v250, v231
    v_mfma_f32_32x32x16_bf16 v[196:211], v[10:13], v[132:135], 0
    v_add_f32 v250, v250, v232
    v_add_f32 v250, v250, v233
    v_add_f32 v251, v234, v235
    v_add_f32 v251, v251, v236
    v_add_f32 v251, v251, v237
    v_add_f32 v251, v251, v238
    v_mfma_f32_32x32x16_bf16 v[76:91], a[188:191], v[120:123], v[76:91]
    s_waitcnt lgkmcnt(3)
    ds_read_b64_tr_b16 v[106:107], v3 offset:35328
    v_add_f32 v251, v251, v239
    v_add_f32 v251, v251, v240
    v_add_f32 v251, v251, v241
    v_max3_f32 v220, v196, v197, v198
    v_max3_f32 v220, v220, v199, v200
    v_mfma_f32_32x32x16_bf16 v[28:43], v[92:95], a[64:67], v[28:43]
    ds_read_b64_tr_b16 v[108:109], v2 offset:36864
    v_max3_f32 v220, v220, v201, v202
    v_permlane32_swap_b32 v250, v251
    v_max_f32 v220, v220, v203
    v_add_f32 v250, v250, v251
    v_mfma_f32_32x32x16_bf16 v[28:43], v[96:99], a[68:71], v[28:43]
    ds_read_b64_tr_b16 v[110:111], v2 offset:37376
    v_max3_f32 v221, v204, v205, v206
    v_rcp_f32 v250, v250
    v_max3_f32 v221, v221, v207, v208
    v_mov_b32 v251, v250
    v_mfma_f32_32x32x16_bf16 v[44:59], v[92:95], a[192:195], v[44:59]
    ds_read_b64_tr_b16 v[112:113], v2 offset:38912
    v_max3_f32 v221, v221, v209, v210
    v_permlane32_swap_b32 v250, v251
    v_max_f32 v221, v221, v211
    v_mul_f32 v226, v226, v250
    v_mfma_f32_32x32x16_bf16 v[44:59], v[96:99], a[196:199], v[44:59]
    s_waitcnt lgkmcnt(3)
    ds_read_b64_tr_b16 v[114:115], v2 offset:39424
    v_permlane32_swap_b32 v220, v221
    v_mul_f32 v227, v227, v250
    v_max_f32 v220, v220, v221
    v_mul_f32 v228, v228, v250
    v_mfma_f32_32x32x16_bf16 v[60:75], a[64:67], v[100:103], v[60:75]
    ds_read_b64_tr_b16 v[116:117], v3 offset:36864
    v_mul_f32 v220, s34, v220
    v_mul_f32 v229, v229, v250
    v_mov_b32 v221, v220
    v_mul_f32 v230, v230, v250
    v_mul_f32 v231, v231, v250
    v_mfma_f32_32x32x16_bf16 v[60:75], a[68:71], v[104:107], v[60:75]
    ds_read_b64_tr_b16 v[118:119], v3 offset:37376
    v_permlane32_swap_b32 v220, v221
    v_mul_f32 v232, v232, v250
    v_fma_f32 v196, v196, s34, -v220
    v_mul_f32 v233, v233, v250
    v_mfma_f32_32x32x16_bf16 v[76:91], a[192:195], v[100:103], v[76:91]
    ds_read_b64_tr_b16 v[120:121], v3 offset:38912
    v_fma_f32 v197, v197, s34, -v220
    v_mul_f32 v234, v234, v251
    v_fma_f32 v198, v198, s34, -v220
    v_mul_f32 v235, v235, v251
    v_fma_f32 v199, v199, s34, -v220
    v_mfma_f32_32x32x16_bf16 v[76:91], a[196:199], v[104:107], v[76:91]
    s_waitcnt lgkmcnt(3)
    ds_read_b64_tr_b16 v[122:123], v3 offset:39424
    v_fma_f32 v200, v200, s34, -v220
    v_mul_f32 v236, v236, v251
    v_fma_f32 v201, v201, s34, -v220
    v_mul_f32 v237, v237, v251
    v_fma_f32 v202, v202, s34, -v220
    v_mfma_f32_32x32x16_bf16 v[28:43], v[108:111], a[72:75], v[28:43]
    ds_read_b64_tr_b16 v[92:93], v2 offset:40960
    v_fma_f32 v203, v203, s34, -v220
    v_mul_f32 v238, v238, v251
    v_fma_f32 v204, v204, s34, -v221
    v_mul_f32 v239, v239, v251
    v_fma_f32 v205, v205, s34, -v221
    v_mfma_f32_32x32x16_bf16 v[28:43], v[112:115], a[76:79], v[28:43]
    ds_read_b64_tr_b16 v[94:95], v2 offset:41472
    v_fma_f32 v206, v206, s34, -v221
    v_mul_f32 v240, v240, v251
    v_fma_f32 v207, v207, s34, -v221
    v_mul_f32 v241, v241, v251
    v_fma_f32 v208, v208, s34, -v221
    v_mfma_f32_32x32x16_bf16 v[44:59], v[108:111], a[200:203], v[44:59]
    ds_read_b64_tr_b16 v[96:97], v2 offset:43008
    v_fma_f32 v209, v209, s34, -v221
    v_cvt_pk_bf16_f32 v242, v226, v227
    v_fma_f32 v210, v210, s34, -v221
    v_cvt_pk_bf16_f32 v243, v228, v229
    v_fma_f32 v211, v211, s34, -v221
    v_mfma_f32_32x32x16_bf16 v[44:59], v[112:115], a[204:207], v[44:59]
    s_waitcnt lgkmcnt(3)
    ds_read_b64_tr_b16 v[98:99], v2 offset:43520
    v_exp_f32 v196, v196
    v_cvt_pk_bf16_f32 v244, v230, v231
    v_exp_f32 v197, v197
    v_mfma_f32_32x32x16_bf16 v[60:75], a[72:75], v[116:119], v[60:75]
    ds_read_b64_tr_b16 v[100:101], v3 offset:40960
    v_exp_f32 v198, v198
    v_cvt_pk_bf16_f32 v245, v232, v233
    v_exp_f32 v199, v199
    v_mfma_f32_32x32x16_bf16 v[60:75], a[76:79], v[120:123], v[60:75]
    ds_read_b64_tr_b16 v[102:103], v3 offset:41472
    v_exp_f32 v200, v200
    v_cvt_pk_bf16_f32 v246, v234, v235
    v_exp_f32 v201, v201
    v_mfma_f32_32x32x16_bf16 v[76:91], a[200:203], v[116:119], v[76:91]
    ds_read_b64_tr_b16 v[104:105], v3 offset:43008
    v_exp_f32 v202, v202
    v_cvt_pk_bf16_f32 v247, v236, v237
    v_exp_f32 v203, v203
    v_mfma_f32_32x32x16_bf16 v[76:91], a[204:207], v[120:123], v[76:91]
    s_waitcnt lgkmcnt(3)
    ds_read_b64_tr_b16 v[106:107], v3 offset:43520
    v_exp_f32 v204, v204
    v_cvt_pk_bf16_f32 v248, v238, v239
    v_exp_f32 v205, v205
    v_mfma_f32_32x32x16_bf16 v[28:43], v[92:95], a[80:83], v[28:43]
    ds_read_b64_tr_b16 v[108:109], v2 offset:45056
    v_exp_f32 v206, v206
    v_cvt_pk_bf16_f32 v249, v240, v241
    v_exp_f32 v207, v207
    v_mfma_f32_32x32x16_bf16 v[226:241], v[242:245], v[156:159], 0
    v_exp_f32 v208, v208
    v_mfma_f32_32x32x16_bf16 v[226:241], v[246:249], v[160:163], v[226:241]
    v_exp_f32 v209, v209
    v_exp_f32 v210, v210
    v_exp_f32 v211, v211
    v_mfma_f32_32x32x16_bf16 v[28:43], v[96:99], a[84:87], v[28:43]
    ds_read_b64_tr_b16 v[110:111], v2 offset:45568
    v_add_f32 v220, v196, v197
    v_add_f32 v220, v220, v198
    v_add_f32 v220, v220, v199
    v_add_f32 v220, v220, v200
    v_add_f32 v220, v220, v201
    v_mfma_f32_32x32x16_bf16 v[44:59], v[92:95], a[208:211], v[44:59]
    ds_read_b64_tr_b16 v[112:113], v2 offset:47104
    v_add_f32 v220, v220, v202
    v_cvt_pk_bf16_f32 v242, v226, v227
    v_add_f32 v220, v220, v203
    v_cvt_pk_bf16_f32 v243, v228, v229
    v_add_f32 v221, v204, v205
    v_mfma_f32_32x32x16_bf16 v[44:59], v[96:99], a[212:215], v[44:59]
    s_waitcnt lgkmcnt(3)
    ds_read_b64_tr_b16 v[114:115], v2 offset:47616
    v_add_f32 v221, v221, v206
    v_cvt_pk_bf16_f32 v244, v230, v231
    v_add_f32 v221, v221, v207
    v_cvt_pk_bf16_f32 v245, v232, v233
    v_add_f32 v221, v221, v208
    v_mfma_f32_32x32x16_bf16 v[60:75], a[80:83], v[100:103], v[60:75]
    ds_read_b64_tr_b16 v[116:117], v3 offset:45056
    v_add_f32 v221, v221, v209
    v_cvt_pk_bf16_f32 v246, v234, v235
    v_add_f32 v221, v221, v210
    v_cvt_pk_bf16_f32 v247, v236, v237
    v_add_f32 v221, v221, v211
    v_mfma_f32_32x32x16_bf16 v[60:75], a[84:87], v[104:107], v[60:75]
    ds_read_b64_tr_b16 v[118:119], v3 offset:45568
    v_permlane32_swap_b32 v220, v221
    v_cvt_pk_bf16_f32 v248, v238, v239
    v_add_f32 v220, v220, v221
    v_cvt_pk_bf16_f32 v249, v240, v241
    v_mfma_f32_32x32x16_bf16 v[76:91], a[208:211], v[100:103], v[76:91]
    ds_read_b64_tr_b16 v[120:121], v3 offset:47104
    v_rcp_f32 v220, v220
    v_cndmask_b32 v226, v1, v140, s[38:39]
    v_mov_b32 v221, v220
    v_cndmask_b32 v227, v1, v141, s[38:39]
    v_mfma_f32_32x32x16_bf16 v[76:91], a[212:215], v[104:107], v[76:91]
    s_waitcnt lgkmcnt(3)
    ds_read_b64_tr_b16 v[122:123], v3 offset:47616
    v_permlane32_swap_b32 v220, v221
    v_cndmask_b32 v228, v1, v142, s[38:39]
    v_mul_f32 v196, v196, v220
    v_cndmask_b32 v229, v1, v143, s[38:39]
    v_mfma_f32_32x32x16_bf16 v[28:43], v[108:111], a[88:91], v[28:43]
    s_waitcnt vmcnt(4)
    s_barrier
    s_add_u32 m0, s26, 16384
    s_add_u32 s25, s22, s45
    ds_read_b64_tr_b16 v[92:93], v2 offset:49152
    v_mul_f32 v197, v197, v220
    v_cndmask_b32 v230, v1, v144, s[38:39]
    v_mfma_f32_32x32x16_bf16 v[28:43], v[112:115], a[92:95], v[28:43]
    buffer_load_dwordx4 v6, s[12:15], s25 offen offset:0 lds
    ds_read_b64_tr_b16 v[94:95], v2 offset:49664
    v_mul_f32 v198, v198, v220
    v_cndmask_b32 v231, v1, v145, s[38:39]
    v_mul_f32 v199, v199, v220
    v_mfma_f32_32x32x16_bf16 v[44:59], v[108:111], a[216:219], v[44:59]
    buffer_load_dwordx4 v7, s[12:15], s25 offen offset:1024 lds
    ds_read_b64_tr_b16 v[96:97], v2 offset:51200
    v_mul_f32 v200, v200, v220
    v_cndmask_b32 v232, v1, v146, s[38:39]
    v_mul_f32 v201, v201, v220
    v_mfma_f32_32x32x16_bf16 v[44:59], v[112:115], a[220:223], v[44:59]
    s_waitcnt lgkmcnt(3)
    buffer_load_dwordx4 v8, s[12:15], s25 offen offset:2048 lds
    ds_read_b64_tr_b16 v[98:99], v2 offset:51712
    v_mul_f32 v202, v202, v220
    v_cndmask_b32 v233, v1, v147, s[38:39]
    v_mul_f32 v203, v203, v220
    v_mfma_f32_32x32x16_bf16 v[180:195], v[242:245], v[226:229], 0
    v_mul_f32 v204, v204, v221
    v_mfma_f32_32x32x16_bf16 v[180:195], v[246:249], v[230:233], v[180:195]
    v_mul_f32 v205, v205, v221
    v_mfma_f32_32x32x16_bf16 v[226:241], v[14:17], v[136:139], 0
    v_mul_f32 v206, v206, v221
    v_mul_f32 v207, v207, v221
    v_mul_f32 v208, v208, v221
    v_mul_f32 v209, v209, v221
    v_mul_f32 v210, v210, v221
    v_mul_f32 v211, v211, v221
    v_mfma_f32_32x32x16_bf16 v[60:75], a[88:91], v[116:119], v[60:75]
    buffer_load_dwordx4 v9, s[12:15], s25 offen offset:3072 lds
    ds_read_b64_tr_b16 v[100:101], v3 offset:49152
    v_cvt_pk_bf16_f32 v212, v196, v197
    v_cvt_pk_bf16_f32 v213, v198, v199
    v_cvt_pk_bf16_f32 v214, v200, v201
    v_mfma_f32_32x32x16_bf16 v[60:75], a[92:95], v[120:123], v[60:75]
    ds_read_b64_tr_b16 v[102:103], v3 offset:49664
    v_cvt_pk_bf16_f32 v215, v202, v203
    v_max3_f32 v250, v226, v227, v228
    v_cvt_pk_bf16_f32 v216, v204, v205
    v_max3_f32 v250, v250, v229, v230
    v_cvt_pk_bf16_f32 v217, v206, v207
    v_mfma_f32_32x32x16_bf16 v[76:91], a[216:219], v[116:119], v[76:91]
    ds_read_b64_tr_b16 v[104:105], v3 offset:51200
    v_cvt_pk_bf16_f32 v218, v208, v209
    v_max3_f32 v250, v250, v231, v232
    v_cvt_pk_bf16_f32 v219, v210, v211
    v_max_f32 v250, v250, v233
    v_mfma_f32_32x32x16_bf16 v[196:211], v[212:215], v[156:159], 0
    v_max3_f32 v251, v234, v235, v236
    v_mfma_f32_32x32x16_bf16 v[196:211], v[216:219], v[160:163], v[196:211]
    v_max3_f32 v251, v251, v237, v238
    v_max3_f32 v251, v251, v239, v240
    v_max_f32 v251, v251, v241
    v_mfma_f32_32x32x16_bf16 v[76:91], a[220:223], v[120:123], v[76:91]
    s_waitcnt lgkmcnt(3)
    ds_read_b64_tr_b16 v[106:107], v3 offset:51712
    v_permlane32_swap_b32 v250, v251
    v_max_f32 v250, v250, v251
    v_mul_f32 v250, s34, v250
    v_mov_b32 v251, v250
    v_mfma_f32_32x32x16_bf16 v[28:43], v[92:95], a[96:99], v[28:43]
    ds_read_b64_tr_b16 v[108:109], v2 offset:53248
    v_cvt_pk_bf16_f32 v212, v196, v197
    v_permlane32_swap_b32 v250, v251
    v_cvt_pk_bf16_f32 v213, v198, v199
    v_fma_f32 v226, v226, s34, -v250
    v_mfma_f32_32x32x16_bf16 v[28:43], v[96:99], a[100:103], v[28:43]
    ds_read_b64_tr_b16 v[110:111], v2 offset:53760
    v_cvt_pk_bf16_f32 v214, v200, v201
    v_fma_f32 v227, v227, s34, -v250
    v_cvt_pk_bf16_f32 v215, v202, v203
    v_fma_f32 v228, v228, s34, -v250
    v_cvt_pk_bf16_f32 v216, v204, v205
    v_mfma_f32_32x32x16_bf16 v[44:59], v[92:95], a[224:227], v[44:59]
    ds_read_b64_tr_b16 v[112:113], v2 offset:55296
    v_cvt_pk_bf16_f32 v217, v206, v207
    v_fma_f32 v229, v229, s34, -v250
    v_cvt_pk_bf16_f32 v218, v208, v209
    v_fma_f32 v230, v230, s34, -v250
    v_cvt_pk_bf16_f32 v219, v210, v211
    v_mfma_f32_32x32x16_bf16 v[44:59], v[96:99], a[228:231], v[44:59]
    s_waitcnt lgkmcnt(3)
    ds_read_b64_tr_b16 v[114:115], v2 offset:55808
    v_cndmask_b32 v196, v1, v148, s[36:37]
    v_fma_f32 v231, v231, s34, -v250
    v_cndmask_b32 v197, v1, v149, s[36:37]
    v_fma_f32 v232, v232, s34, -v250
    v_cndmask_b32 v198, v1, v150, s[36:37]
    v_mfma_f32_32x32x16_bf16 v[60:75], a[96:99], v[100:103], v[60:75]
    ds_read_b64_tr_b16 v[116:117], v3 offset:53248
    v_cndmask_b32 v199, v1, v151, s[36:37]
    v_fma_f32 v233, v233, s34, -v250
    v_cndmask_b32 v200, v1, v152, s[36:37]
    v_fma_f32 v234, v234, s34, -v251
    v_cndmask_b32 v201, v1, v153, s[36:37]
    v_mfma_f32_32x32x16_bf16 v[60:75], a[100:103], v[104:107], v[60:75]
    ds_read_b64_tr_b16 v[118:119], v3 offset:53760
    v_cndmask_b32 v202, v1, v154, s[36:37]
    v_fma_f32 v235, v235, s34, -v251
    v_cndmask_b32 v203, v1, v155, s[36:37]
    v_fma_f32 v236, v236, s34, -v251
    v_mfma_f32_32x32x16_bf16 v[164:179], v[212:215], v[196:199], v[164:179]
    v_fma_f32 v237, v237, s34, -v251
    v_mfma_f32_32x32x16_bf16 v[164:179], v[216:219], v[200:203], v[164:179]
    v_fma_f32 v238, v238, s34, -v251
    v_fma_f32 v239, v239, s34, -v251
    v_fma_f32 v240, v240, s34, -v251
    v_fma_f32 v241, v241, s34, -v251
    v_exp_f32 v226, v226
    v_mfma_f32_32x32x16_bf16 v[76:91], a[224:227], v[100:103], v[76:91]
    ds_read_b64_tr_b16 v[120:121], v3 offset:55296
    v_exp_f32 v227, v227
    v_exp_f32 v228, v228
    v_mfma_f32_32x32x16_bf16 v[76:91], a[228:231], v[104:107], v[76:91]
    s_waitcnt lgkmcnt(3)
    ds_read_b64_tr_b16 v[122:123], v3 offset:55808
    ds_write_b128 v24, v[164:167] offset:0
    v_exp_f32 v229, v229
    v_exp_f32 v230, v230
    v_mfma_f32_32x32x16_bf16 v[28:43], v[108:111], a[104:107], v[28:43]
    ds_read_b64_tr_b16 v[92:93], v2 offset:57344
    ds_write_b128 v24, v[168:171] offset:1024
    v_exp_f32 v231, v231
    v_exp_f32 v232, v232
    v_mfma_f32_32x32x16_bf16 v[28:43], v[112:115], a[108:111], v[28:43]
    ds_read_b64_tr_b16 v[94:95], v2 offset:57856
    ds_write_b128 v24, v[172:175] offset:2048
    v_exp_f32 v233, v233
    v_exp_f32 v234, v234
    v_mfma_f32_32x32x16_bf16 v[44:59], v[108:111], a[232:235], v[44:59]
    ds_read_b64_tr_b16 v[96:97], v2 offset:59392
    ds_write_b128 v24, v[176:179] offset:3072
    v_exp_f32 v235, v235
    v_exp_f32 v236, v236
    v_mfma_f32_32x32x16_bf16 v[44:59], v[112:115], a[236:239], v[44:59]
    s_waitcnt lgkmcnt(7)
    ds_read_b64_tr_b16 v[98:99], v2 offset:59904
    v_exp_f32 v237, v237
    v_exp_f32 v238, v238
    v_mfma_f32_32x32x16_bf16 v[60:75], a[104:107], v[116:119], v[60:75]
    ds_read_b64_tr_b16 v[100:101], v3 offset:57344
    v_exp_f32 v239, v239
    v_exp_f32 v240, v240
    v_mfma_f32_32x32x16_bf16 v[60:75], a[108:111], v[120:123], v[60:75]
    ds_read_b64_tr_b16 v[102:103], v3 offset:57856
    v_exp_f32 v241, v241
    v_add_f32 v250, v226, v227
    v_add_f32 v250, v250, v228
    v_add_f32 v250, v250, v229
    v_mfma_f32_32x32x16_bf16 v[76:91], a[232:235], v[116:119], v[76:91]
    ds_read_b64_tr_b16 v[104:105], v3 offset:59392
    v_add_f32 v250, v250, v230
    v_add_f32 v250, v250, v231
    v_add_f32 v250, v250, v232
    v_add_f32 v250, v250, v233
    v_add_f32 v251, v234, v235
    v_mfma_f32_32x32x16_bf16 v[76:91], a[236:239], v[120:123], v[76:91]
    s_waitcnt lgkmcnt(3)
    ds_read_b64_tr_b16 v[106:107], v3 offset:59904
    v_add_f32 v251, v251, v236
    v_add_f32 v251, v251, v237
    v_add_f32 v251, v251, v238
    v_add_f32 v251, v251, v239
    v_add_f32 v251, v251, v240
    v_mfma_f32_32x32x16_bf16 v[28:43], v[92:95], a[112:115], v[28:43]
    ds_read_b64_tr_b16 v[108:109], v2 offset:61440
    v_add_f32 v251, v251, v241
    v_mfma_f32_32x32x16_bf16 v[28:43], v[96:99], a[116:119], v[28:43]
    ds_read_b64_tr_b16 v[110:111], v2 offset:61952
    v_permlane32_swap_b32 v250, v251
    v_add_f32 v250, v250, v251
    v_rcp_f32 v250, v250
    v_mfma_f32_32x32x16_bf16 v[44:59], v[92:95], a[240:243], v[44:59]
    ds_read_b64_tr_b16 v[112:113], v2 offset:63488
    v_mov_b32 v251, v250
    v_mfma_f32_32x32x16_bf16 v[44:59], v[96:99], a[244:247], v[44:59]
    s_waitcnt lgkmcnt(3)
    ds_read_b64_tr_b16 v[114:115], v2 offset:64000
    v_permlane32_swap_b32 v250, v251
    v_mul_f32 v226, v226, v250
    v_mul_f32 v227, v227, v250
    v_mul_f32 v228, v228, v250
    v_mfma_f32_32x32x16_bf16 v[60:75], a[112:115], v[100:103], v[60:75]
    ds_read_b64_tr_b16 v[116:117], v3 offset:61440
    v_mul_f32 v229, v229, v250
    v_mul_f32 v230, v230, v250
    v_mul_f32 v231, v231, v250
    v_mul_f32 v232, v232, v250
    v_mul_f32 v233, v233, v250
    v_mfma_f32_32x32x16_bf16 v[60:75], a[116:119], v[104:107], v[60:75]
    ds_read_b64_tr_b16 v[118:119], v3 offset:61952
    v_mul_f32 v234, v234, v251
    v_mul_f32 v235, v235, v251
    v_mul_f32 v236, v236, v251
    v_mul_f32 v237, v237, v251
    v_mul_f32 v238, v238, v251
    v_mfma_f32_32x32x16_bf16 v[76:91], a[240:243], v[100:103], v[76:91]
    ds_read_b64_tr_b16 v[120:121], v3 offset:63488
    v_mul_f32 v239, v239, v251
    v_mul_f32 v240, v240, v251
    v_mul_f32 v241, v241, v251
    v_cvt_pk_bf16_f32 v242, v226, v227
    v_cvt_pk_bf16_f32 v243, v228, v229
    v_mfma_f32_32x32x16_bf16 v[76:91], a[244:247], v[104:107], v[76:91]
    s_waitcnt lgkmcnt(3)
    ds_read_b64_tr_b16 v[122:123], v3 offset:64000
    v_cvt_pk_bf16_f32 v244, v230, v231
    v_cvt_pk_bf16_f32 v245, v232, v233
    v_cvt_pk_bf16_f32 v246, v234, v235
    v_cvt_pk_bf16_f32 v247, v236, v237
    v_cvt_pk_bf16_f32 v248, v238, v239
    v_cvt_pk_bf16_f32 v249, v240, v241
    v_mfma_f32_32x32x16_bf16 v[226:241], v[242:245], v[156:159], 0
    s_nop 0
    v_mfma_f32_32x32x16_bf16 v[226:241], v[246:249], v[160:163], v[226:241]
    s_nop 11
    v_cvt_pk_bf16_f32 v242, v226, v227
    v_cvt_pk_bf16_f32 v243, v228, v229
    v_cvt_pk_bf16_f32 v244, v230, v231
    v_cvt_pk_bf16_f32 v245, v232, v233
    v_cvt_pk_bf16_f32 v246, v234, v235
    v_cvt_pk_bf16_f32 v247, v236, v237
    v_cvt_pk_bf16_f32 v248, v238, v239
    v_cvt_pk_bf16_f32 v249, v240, v241
    v_cndmask_b32 v226, v1, v148, s[38:39]
    v_cndmask_b32 v227, v1, v149, s[38:39]
    v_cndmask_b32 v228, v1, v150, s[38:39]
    v_cndmask_b32 v229, v1, v151, s[38:39]
    v_cndmask_b32 v230, v1, v152, s[38:39]
    v_cndmask_b32 v231, v1, v153, s[38:39]
    v_cndmask_b32 v232, v1, v154, s[38:39]
    v_cndmask_b32 v233, v1, v155, s[38:39]
    v_mfma_f32_32x32x16_bf16 v[180:195], v[242:245], v[226:229], v[180:195]
    s_nop 0
    v_mfma_f32_32x32x16_bf16 v[180:195], v[246:249], v[230:233], v[180:195]
    s_nop 11
    ds_write_b128 v24, v[180:183] offset:4096
    ds_write_b128 v24, v[184:187] offset:5120
    ds_write_b128 v24, v[188:191] offset:6144
    ds_write_b128 v24, v[192:195] offset:7168
    s_waitcnt lgkmcnt(0)
    v_add_u32 v22, 1024, v22
    v_mfma_f32_32x32x16_bf16 v[28:43], v[108:111], a[120:123], v[28:43]
    s_waitcnt vmcnt(4)
    s_barrier
    s_add_u32 m0, s26, 32768
    s_add_u32 s25, s22, s50
    ds_read_b64_tr_b16 v[92:93], v2 offset:0
    v_mfma_f32_32x32x16_bf16 v[28:43], v[112:115], a[124:127], v[28:43]
    buffer_load_dwordx4 v6, s[12:15], s25 offen offset:0 lds
    ds_read_b64_tr_b16 v[94:95], v2 offset:512
    v_mfma_f32_32x32x16_bf16 v[44:59], v[108:111], a[248:251], v[44:59]
    buffer_load_dwordx4 v7, s[12:15], s25 offen offset:1024 lds
    ds_read_b64_tr_b16 v[96:97], v2 offset:2048
    v_mfma_f32_32x32x16_bf16 v[44:59], v[112:115], a[252:255], v[44:59]
    buffer_load_dwordx4 v8, s[12:15], s25 offen offset:2048 lds
    ds_read_b64_tr_b16 v[98:99], v2 offset:2560
    v_mfma_f32_32x32x16_bf16 v[60:75], a[120:123], v[116:119], v[60:75]
    buffer_load_dwordx4 v9, s[12:15], s25 offen offset:3072 lds
    ds_read_b64_tr_b16 v[100:101], v3 offset:0
    v_mfma_f32_32x32x16_bf16 v[60:75], a[124:127], v[120:123], v[60:75]
    ds_read_b64_tr_b16 v[102:103], v3 offset:512
    v_cvt_pk_bf16_f32 v124, v28, v29
    v_cvt_pk_bf16_f32 v125, v30, v31
    v_cvt_pk_bf16_f32 v126, v32, v33
    v_cvt_pk_bf16_f32 v127, v34, v35
    v_mfma_f32_32x32x16_bf16 v[76:91], a[248:251], v[116:119], v[76:91]
    ds_read_b64_tr_b16 v[104:105], v3 offset:2048
    s_mov_b32 s21, s22
    s_add_u32 s22, s22, 64
    v_cvt_pk_bf16_f32 v128, v36, v37
    v_cvt_pk_bf16_f32 v129, v38, v39
    v_cvt_pk_bf16_f32 v130, v40, v41
    v_cvt_pk_bf16_f32 v131, v42, v43
    v_mfma_f32_32x32x16_bf16 v[76:91], a[252:255], v[120:123], v[76:91]
    s_waitcnt lgkmcnt(3)
    ds_read_b64_tr_b16 v[106:107], v3 offset:2560
    s_sub_u32 s24, s24, 1
    s_cmp_lg_u32 s24, 0
    v_cvt_pk_bf16_f32 v132, v44, v45
    v_cvt_pk_bf16_f32 v133, v46, v47
    v_cvt_pk_bf16_f32 v134, v48, v49
    v_cvt_pk_bf16_f32 v135, v50, v51
    s_cbranch_scc1 L1A_loop
    v_mfma_f32_32x32x16_bf16 v[28:43], v[92:95], a[0:3], 0
    ds_read_b64_tr_b16 v[108:109], v2 offset:4096
    v_cvt_pk_bf16_f32 v136, v52, v53
    v_cvt_pk_bf16_f32 v137, v54, v55
    v_cvt_pk_bf16_f32 v138, v56, v57
    v_cvt_pk_bf16_f32 v139, v58, v59
    v_mfma_f32_32x32x16_bf16 v[28:43], v[96:99], a[4:7], v[28:43]
    ds_read_b64_tr_b16 v[110:111], v2 offset:4608
    v_cvt_pk_bf16_f32 v140, v60, v61
    v_cvt_pk_bf16_f32 v141, v62, v63
    v_cvt_pk_bf16_f32 v142, v64, v65
    v_cvt_pk_bf16_f32 v143, v66, v67
    v_mfma_f32_32x32x16_bf16 v[44:59], v[92:95], a[128:131], 0
    ds_read_b64_tr_b16 v[112:113], v2 offset:6144
    v_cvt_pk_bf16_f32 v144, v68, v69
    v_cvt_pk_bf16_f32 v145, v70, v71
    v_cvt_pk_bf16_f32 v146, v72, v73
    v_cvt_pk_bf16_f32 v147, v74, v75
    v_mfma_f32_32x32x16_bf16 v[44:59], v[96:99], a[132:135], v[44:59]
    s_waitcnt lgkmcnt(3)
    ds_read_b64_tr_b16 v[114:115], v2 offset:6656
    v_cvt_pk_bf16_f32 v148, v76, v77
    v_cvt_pk_bf16_f32 v149, v78, v79
    v_cvt_pk_bf16_f32 v150, v80, v81
    v_cvt_pk_bf16_f32 v151, v82, v83
    v_mfma_f32_32x32x16_bf16 v[60:75], v[100:103], a[0:3], 0
    ds_read_b64_tr_b16 v[116:117], v3 offset:4096
    v_cvt_pk_bf16_f32 v152, v84, v85
    v_cvt_pk_bf16_f32 v153, v86, v87
    v_cvt_pk_bf16_f32 v154, v88, v89
    v_cvt_pk_bf16_f32 v155, v90, v91
    v_mfma_f32_32x32x16_bf16 v[60:75], v[104:107], a[4:7], v[60:75]
    ds_read_b64_tr_b16 v[118:119], v3 offset:4608
    ds_read_b64_tr_b16 v[10:11], v22 offset:0
    ds_read_b128 v[164:167], v25 offset:0
    ds_read_b64_tr_b16 v[12:13], v22 offset:256
    ds_read_b128 v[168:171], v25 offset:1024
    ds_read_b128 v[172:175], v25 offset:8192
    v_mfma_f32_32x32x16_bf16 v[76:91], v[100:103], a[128:131], 0
    ds_read_b64_tr_b16 v[120:121], v3 offset:6144
    ds_read_b128 v[176:179], v25 offset:9216
    ds_read_b128 v[180:183], v25 offset:16384
    ds_read_b128 v[184:187], v25 offset:17408
    ds_read_b128 v[188:191], v25 offset:24576
    ds_read_b128 v[192:195], v25 offset:25600
    v_mfma_f32_32x32x16_bf16 v[76:91], v[104:107], a[132:135], v[76:91]
    s_waitcnt lgkmcnt(13)
    ds_read_b64_tr_b16 v[122:123], v3 offset:6656
    v_mfma_f32_32x32x16_bf16 v[28:43], v[108:111], a[8:11], v[28:43]
    ds_read_b64_tr_b16 v[92:93], v2 offset:8192
    v_mfma_f32_32x32x16_bf16 v[28:43], v[112:115], a[12:15], v[28:43]
    ds_read_b64_tr_b16 v[94:95], v2 offset:8704
    v_mfma_f32_32x32x16_bf16 v[44:59], v[108:111], a[136:139], v[44:59]
    ds_read_b64_tr_b16 v[96:97], v2 offset:10240
    v_mfma_f32_32x32x16_bf16 v[44:59], v[112:115], a[140:143], v[44:59]
    s_waitcnt lgkmcnt(3)
    ds_read_b64_tr_b16 v[98:99], v2 offset:10752
    v_xor_b32 v10, v23, v10
    v_add_f32 v164, v164, v172
    v_xor_b32 v11, v23, v11
    v_add_f32 v165, v165, v173
    v_xor_b32 v12, v23, v12
    v_mfma_f32_32x32x16_bf16 v[60:75], v[116:119], a[8:11], v[60:75]
    ds_read_b64_tr_b16 v[100:101], v3 offset:8192
    v_xor_b32 v13, v23, v13
    v_add_f32 v166, v166, v174
    v_add_f32 v167, v167, v175
    v_mfma_f32_32x32x16_bf16 v[196:211], v[10:13], v[124:127], 0
    v_add_f32 v168, v168, v176
    v_add_f32 v169, v169, v177
    v_add_f32 v170, v170, v178
    v_add_f32 v171, v171, v179
    v_add_f32 v180, v180, v188
    v_add_f32 v181, v181, v189
    v_mfma_f32_32x32x16_bf16 v[60:75], v[120:123], a[12:15], v[60:75]
    ds_read_b64_tr_b16 v[102:103], v3 offset:8704
    v_add_f32 v182, v182, v190
    v_add_f32 v183, v183, v191
    v_add_f32 v184, v184, v192
    v_add_f32 v185, v185, v193
    v_max3_f32 v220, v196, v197, v198
    v_mfma_f32_32x32x16_bf16 v[76:91], v[116:119], a[136:139], v[76:91]
    ds_read_b64_tr_b16 v[104:105], v3 offset:10240
    v_max3_f32 v220, v220, v199, v200
    v_add_f32 v186, v186, v194
    v_max3_f32 v220, v220, v201, v202
    v_add_f32 v187, v187, v195
    v_max_f32 v220, v220, v203
    v_mfma_f32_32x32x16_bf16 v[76:91], v[120:123], a[140:143], v[76:91]
    s_waitcnt lgkmcnt(3)
    ds_read_b64_tr_b16 v[106:107], v3 offset:10752
    v_max3_f32 v221, v204, v205, v206
    v_add_f32 v164, v164, v180
    v_max3_f32 v221, v221, v207, v208
    v_add_f32 v165, v165, v181
    v_max3_f32 v221, v221, v209, v210
    v_mfma_f32_32x32x16_bf16 v[28:43], v[92:95], a[16:19], v[28:43]
    ds_read_b64_tr_b16 v[108:109], v2 offset:12288
    v_max_f32 v221, v221, v211
    v_add_f32 v166, v166, v182
    v_add_f32 v167, v167, v183
    v_permlane32_swap_b32 v220, v221
    v_mfma_f32_32x32x16_bf16 v[28:43], v[96:99], a[20:23], v[28:43]
    ds_read_b64_tr_b16 v[110:111], v2 offset:12800
    v_max_f32 v220, v220, v221
    v_add_f32 v168, v168, v184
    v_mul_f32 v220, s34, v220
    v_add_f32 v169, v169, v185
    v_mov_b32 v221, v220
    v_mfma_f32_32x32x16_bf16 v[44:59], v[92:95], a[144:147], v[44:59]
    ds_read_b64_tr_b16 v[112:113], v2 offset:14336
    v_permlane32_swap_b32 v220, v221
    v_add_f32 v170, v170, v186
    v_fma_f32 v196, v196, s34, -v220
    v_add_f32 v171, v171, v187
    v_mfma_f32_32x32x16_bf16 v[44:59], v[96:99], a[148:151], v[44:59]
    s_waitcnt lgkmcnt(3)
    ds_read_b64_tr_b16 v[114:115], v2 offset:14848
    v_fma_f32 v197, v197, s34, -v220
    buffer_store_dwordx4 v[164:167], v18, s[16:19], s23 offen offset:0 sc1
    v_mfma_f32_32x32x16_bf16 v[60:75], v[100:103], a[16:19], v[60:75]
    ds_read_b64_tr_b16 v[116:117], v3 offset:12288
    v_fma_f32 v198, v198, s34, -v220
    buffer_store_dwordx4 v[168:171], v18, s[16:19], s23 offen offset:1024 sc1
    v_mfma_f32_32x32x16_bf16 v[60:75], v[104:107], a[20:23], v[60:75]
    ds_read_b64_tr_b16 v[118:119], v3 offset:12800
    v_fma_f32 v199, v199, s34, -v220
    s_mov_b32 s23, s35
    v_fma_f32 v200, v200, s34, -v220
    s_add_u32 s35, s35, 8192
    v_fma_f32 v201, v201, s34, -v220
    v_mfma_f32_32x32x16_bf16 v[76:91], v[100:103], a[144:147], v[76:91]
    ds_read_b64_tr_b16 v[120:121], v3 offset:14336
    v_fma_f32 v202, v202, s34, -v220
    ds_read_b64_tr_b16 v[14:15], v22 offset:512
    v_fma_f32 v203, v203, s34, -v220
    v_mfma_f32_32x32x16_bf16 v[76:91], v[104:107], a[148:151], v[76:91]
    s_waitcnt lgkmcnt(4)
    ds_read_b64_tr_b16 v[122:123], v3 offset:14848
    v_fma_f32 v204, v204, s34, -v221
    ds_read_b64_tr_b16 v[16:17], v22 offset:768
    v_fma_f32 v205, v205, s34, -v221
    v_mfma_f32_32x32x16_bf16 v[28:43], v[108:111], a[24:27], v[28:43]
    s_waitcnt vmcnt(6)
    s_barrier
    s_add_u32 m0, s26, 49152
    s_add_u32 s25, s21, s51
    ds_read_b64_tr_b16 v[92:93], v2 offset:16384
    v_fma_f32 v206, v206, s34, -v221
    v_fma_f32 v207, v207, s34, -v221
    v_mfma_f32_32x32x16_bf16 v[28:43], v[112:115], a[28:31], v[28:43]
    buffer_load_dwordx4 v6, s[12:15], s25 offen offset:0 lds
    ds_read_b64_tr_b16 v[94:95], v2 offset:16896
    v_fma_f32 v208, v208, s34, -v221
    v_fma_f32 v209, v209, s34, -v221
    v_fma_f32 v210, v210, s34, -v221
    v_mfma_f32_32x32x16_bf16 v[44:59], v[108:111], a[152:155], v[44:59]
    buffer_load_dwordx4 v7, s[12:15], s25 offen offset:1024 lds
    ds_read_b64_tr_b16 v[96:97], v2 offset:18432
    v_fma_f32 v211, v211, s34, -v221
    v_exp_f32 v196, v196
    v_mfma_f32_32x32x16_bf16 v[44:59], v[112:115], a[156:159], v[44:59]
    s_waitcnt lgkmcnt(4)
    buffer_load_dwordx4 v8, s[12:15], s25 offen offset:2048 lds
    ds_read_b64_tr_b16 v[98:99], v2 offset:18944
    v_exp_f32 v197, v197
    v_mfma_f32_32x32x16_bf16 v[60:75], v[116:119], a[24:27], v[60:75]
    buffer_load_dwordx4 v9, s[12:15], s25 offen offset:3072 lds
    ds_read_b64_tr_b16 v[100:101], v3 offset:16384
    v_exp_f32 v198, v198
    s_waitcnt lgkmcnt(5)
    v_mfma_f32_32x32x16_bf16 v[60:75], v[120:123], a[28:31], v[60:75]
    ds_read_b64_tr_b16 v[102:103], v3 offset:16896
    v_exp_f32 v199, v199
    v_xor_b32 v14, v23, v14
    v_exp_f32 v200, v200
    v_mfma_f32_32x32x16_bf16 v[76:91], v[116:119], a[152:155], v[76:91]
    ds_read_b64_tr_b16 v[104:105], v3 offset:18432
    s_add_u32 m0, s54, 0
    s_add_u32 s49, s53, 0
    s_and_b32 s49, s49, 1023
    s_add_u32 s57, s46, s49
    s_add_u32 s22, s21, 128
    s_cmp_eq_u32 s48, 1
    s_cselect_b32 s22, s22, 0x40000000
    v_mfma_f32_32x32x16_bf16 v[76:91], v[120:123], a[156:159], v[76:91]
    s_waitcnt lgkmcnt(3)
    ds_read_b64_tr_b16 v[106:107], v3 offset:18944
    v_exp_f32 v201, v201
    v_xor_b32 v15, v23, v15
    v_exp_f32 v202, v202
    v_mfma_f32_32x32x16_bf16 v[28:43], v[92:95], a[32:35], v[28:43]
    ds_read_b64_tr_b16 v[108:109], v2 offset:20480
    buffer_load_dwordx4 v222, s[64:67], s57 offen offset:0 lds
    v_exp_f32 v203, v203
    v_xor_b32 v16, v23, v16
    v_mfma_f32_32x32x16_bf16 v[28:43], v[96:99], a[36:39], v[28:43]
    ds_read_b64_tr_b16 v[110:111], v2 offset:20992
    v_exp_f32 v204, v204
    v_xor_b32 v17, v23, v17
    v_exp_f32 v205, v205
    v_mfma_f32_32x32x16_bf16 v[44:59], v[92:95], a[160:163], v[44:59]
    ds_read_b64_tr_b16 v[112:113], v2 offset:22528
    v_exp_f32 v206, v206
    v_mfma_f32_32x32x16_bf16 v[226:241], v[14:17], v[128:131], 0
    v_exp_f32 v207, v207
    v_exp_f32 v208, v208
    v_exp_f32 v209, v209
    v_mfma_f32_32x32x16_bf16 v[44:59], v[96:99], a[164:167], v[44:59]
    s_waitcnt lgkmcnt(3)
    ds_read_b64_tr_b16 v[114:115], v2 offset:23040
    buffer_load_dwordx4 v223, s[64:67], s57 offen offset:1024 lds
    v_exp_f32 v210, v210
    v_mfma_f32_32x32x16_bf16 v[60:75], v[100:103], a[32:35], v[60:75]
    ds_read_b64_tr_b16 v[116:117], v3 offset:20480
    v_exp_f32 v211, v211
    v_add_f32 v220, v196, v197
    v_max3_f32 v250, v226, v227, v228
    v_add_f32 v220, v220, v198
    v_mfma_f32_32x32x16_bf16 v[60:75], v[104:107], a[36:39], v[60:75]
    ds_read_b64_tr_b16 v[118:119], v3 offset:20992
    v_add_f32 v220, v220, v199
    v_max3_f32 v250, v250, v229, v230
    v_add_f32 v220, v220, v200
    v_max3_f32 v250, v250, v231, v232
    v_add_f32 v220, v220, v201
    v_mfma_f32_32x32x16_bf16 v[76:91], v[100:103], a[160:163], v[76:91]
    ds_read_b64_tr_b16 v[120:121], v3 offset:22528
    buffer_load_dwordx4 v224, s[64:67], s57 offen offset:2048 lds
    v_add_f32 v220, v220, v202
    v_max_f32 v250, v250, v233
    v_add_f32 v220, v220, v203
    v_mfma_f32_32x32x16_bf16 v[76:91], v[104:107], a[164:167], v[76:91]
    s_waitcnt lgkmcnt(3)
    ds_read_b64_tr_b16 v[122:123], v3 offset:23040
    v_add_f32 v221, v204, v205
    v_max3_f32 v251, v234, v235, v236
    v_add_f32 v221, v221, v206
    v_max3_f32 v251, v251, v237, v238
    v_add_f32 v221, v221, v207
    v_mfma_f32_32x32x16_bf16 v[28:43], v[108:111], a[40:43], v[28:43]
    ds_read_b64_tr_b16 v[92:93], v2 offset:24576
    v_add_f32 v221, v221, v208
    v_max3_f32 v251, v251, v239, v240
    v_add_f32 v221, v221, v209
    v_max_f32 v251, v251, v241
    v_add_f32 v221, v221, v210
    v_mfma_f32_32x32x16_bf16 v[28:43], v[112:115], a[44:47], v[28:43]
    ds_read_b64_tr_b16 v[94:95], v2 offset:25088
    buffer_load_dwordx4 v225, s[64:67], s57 offen offset:3072 lds
    v_add_f32 v221, v221, v211
    v_permlane32_swap_b32 v250, v251
    v_mfma_f32_32x32x16_bf16 v[44:59], v[108:111], a[168:171], v[44:59]
    ds_read_b64_tr_b16 v[96:97], v2 offset:26624
    s_add_u32 m0, s54, 4096
    s_add_u32 s57, s47, s49
    v_permlane32_swap_b32 v220, v221
    v_max_f32 v250, v250, v251
    v_mfma_f32_32x32x16_bf16 v[44:59], v[112:115], a[172:175], v[44:59]
    s_waitcnt lgkmcnt(3)
    ds_read_b64_tr_b16 v[98:99], v2 offset:27136
    v_add_f32 v220, v220, v221
    v_mul_f32 v250, s34, v250
    v_rcp_f32 v220, v220
    v_mov_b32 v251, v250
    v_mfma_f32_32x32x16_bf16 v[60:75], v[116:119], a[40:43], v[60:75]
    ds_read_b64_tr_b16 v[100:101], v3 offset:24576
    buffer_load_dwordx4 v222, s[64:67], s57 offen offset:0 lds
    v_mov_b32 v221, v220
    v_permlane32_swap_b32 v250, v251
    v_mfma_f32_32x32x16_bf16 v[60:75], v[120:123], a[44:47], v[60:75]
    ds_read_b64_tr_b16 v[102:103], v3 offset:25088
    v_permlane32_swap_b32 v220, v221
    v_fma_f32 v226, v226, s34, -v250
    v_mul_f32 v196, v196, v220
    v_fma_f32 v227, v227, s34, -v250
    v_mfma_f32_32x32x16_bf16 v[76:91], v[116:119], a[168:171], v[76:91]
    ds_read_b64_tr_b16 v[104:105], v3 offset:26624
    v_mul_f32 v197, v197, v220
    v_fma_f32 v228, v228, s34, -v250
    v_mul_f32 v198, v198, v220
    v_fma_f32 v229, v229, s34, -v250
    v_mul_f32 v199, v199, v220
    v_mfma_f32_32x32x16_bf16 v[76:91], v[120:123], a[172:175], v[76:91]
    s_waitcnt lgkmcnt(3)
    ds_read_b64_tr_b16 v[106:107], v3 offset:27136
    buffer_load_dwordx4 v223, s[64:67], s57 offen offset:1024 lds
    v_mul_f32 v200, v200, v220
    v_fma_f32 v230, v230, s34, -v250
    v_mul_f32 v201, v201, v220
    v_mfma_f32_32x32x16_bf16 v[28:43], v[92:95], a[48:51], v[28:43]
    ds_read_b64_tr_b16 v[108:109], v2 offset:28672
    v_mul_f32 v202, v202, v220
    v_fma_f32 v231, v231, s34, -v250
    v_mul_f32 v203, v203, v220
    v_fma_f32 v232, v232, s34, -v250
    v_mul_f32 v204, v204, v221
    v_mfma_f32_32x32x16_bf16 v[28:43], v[96:99], a[52:55], v[28:43]
    ds_read_b64_tr_b16 v[110:111], v2 offset:29184
    v_mul_f32 v205, v205, v221
    v_fma_f32 v233, v233, s34, -v250
    v_mul_f32 v206, v206, v221
    v_fma_f32 v234, v234, s34, -v251
    v_mul_f32 v207, v207, v221
    v_mfma_f32_32x32x16_bf16 v[44:59], v[92:95], a[176:179], v[44:59]
    ds_read_b64_tr_b16 v[112:113], v2 offset:30720
    buffer_load_dwordx4 v224, s[64:67], s57 offen offset:2048 lds
    v_mul_f32 v208, v208, v221
    v_fma_f32 v235, v235, s34, -v251
    v_mul_f32 v209, v209, v221
    v_mfma_f32_32x32x16_bf16 v[44:59], v[96:99], a[180:183], v[44:59]
    s_waitcnt lgkmcnt(3)
    ds_read_b64_tr_b16 v[114:115], v2 offset:31232
    v_mul_f32 v210, v210, v221
    v_fma_f32 v236, v236, s34, -v251
    v_mul_f32 v211, v211, v221
    v_fma_f32 v237, v237, s34, -v251
    v_cvt_pk_bf16_f32 v212, v196, v197
    v_mfma_f32_32x32x16_bf16 v[60:75], v[100:103], a[48:51], v[60:75]
    ds_read_b64_tr_b16 v[116:117], v3 offset:28672
    v_cvt_pk_bf16_f32 v213, v198, v199
    v_fma_f32 v238, v238, s34, -v251
    v_cvt_pk_bf16_f32 v214, v200, v201
    v_fma_f32 v239, v239, s34, -v251
    v_cvt_pk_bf16_f32 v215, v202, v203
    v_mfma_f32_32x32x16_bf16 v[60:75], v[104:107], a[52:55], v[60:75]
    ds_read_b64_tr_b16 v[118:119], v3 offset:29184
    buffer_load_dwordx4 v225, s[64:67], s57 offen offset:3072 lds
    v_cvt_pk_bf16_f32 v216, v204, v205
    v_fma_f32 v240, v240, s34, -v251
    v_cvt_pk_bf16_f32 v217, v206, v207
    v_mfma_f32_32x32x16_bf16 v[76:91], v[100:103], a[176:179], v[76:91]
    ds_read_b64_tr_b16 v[120:121], v3 offset:30720
    v_cvt_pk_bf16_f32 v218, v208, v209
    v_fma_f32 v241, v241, s34, -v251
    v_cvt_pk_bf16_f32 v219, v210, v211
    v_exp_f32 v226, v226
    v_mfma_f32_32x32x16_bf16 v[196:211], v[212:215], v[156:159], 0
    v_exp_f32 v227, v227
    v_mfma_f32_32x32x16_bf16 v[196:211], v[216:219], v[160:163], v[196:211]
    v_exp_f32 v228, v228
    v_exp_f32 v229, v229
    v_exp_f32 v230, v230
    v_mfma_f32_32x32x16_bf16 v[76:91], v[104:107], a[180:183], v[76:91]
    s_waitcnt lgkmcnt(3)
    ds_read_b64_tr_b16 v[122:123], v3 offset:31232
    v_exp_f32 v231, v231
    v_exp_f32 v232, v232
    v_mfma_f32_32x32x16_bf16 v[28:43], v[108:111], a[56:59], v[28:43]
    s_waitcnt vmcnt(14)
    s_barrier
    s_add_u32 m0, s26, 0
    s_add_u32 s25, s22, s44
    ds_read_b64_tr_b16 v[92:93], v2 offset:32768
    v_cvt_pk_bf16_f32 v212, v196, v197
    v_cvt_pk_bf16_f32 v213, v198, v199
    v_mfma_f32_32x32x16_bf16 v[28:43], v[112:115], a[60:63], v[28:43]
    buffer_load_dwordx4 v6, s[12:15], s25 offen offset:0 lds
    ds_read_b64_tr_b16 v[94:95], v2 offset:33280
    v_cvt_pk_bf16_f32 v214, v200, v201
    v_exp_f32 v233, v233
    v_mfma_f32_32x32x16_bf16 v[44:59], v[108:111], a[184:187], v[44:59]
    buffer_load_dwordx4 v7, s[12:15], s25 offen offset:1024 lds
    ds_read_b64_tr_b16 v[96:97], v2 offset:34816
    v_cvt_pk_bf16_f32 v215, v202, v203
    v_exp_f32 v234, v234
    v_mfma_f32_32x32x16_bf16 v[44:59], v[112:115], a[188:191], v[44:59]
    s_waitcnt lgkmcnt(3)
    buffer_load_dwordx4 v8, s[12:15], s25 offen offset:2048 lds
    ds_read_b64_tr_b16 v[98:99], v2 offset:35328
    v_cvt_pk_bf16_f32 v216, v204, v205
    v_exp_f32 v235, v235
    v_mfma_f32_32x32x16_bf16 v[60:75], v[116:119], a[56:59], v[60:75]
    buffer_load_dwordx4 v9, s[12:15], s25 offen offset:3072 lds
    ds_read_b64_tr_b16 v[100:101], v3 offset:32768
    v_cvt_pk_bf16_f32 v217, v206, v207
    v_exp_f32 v236, v236
    v_mfma_f32_32x32x16_bf16 v[60:75], v[120:123], a[60:63], v[60:75]
    ds_read_b64_tr_b16 v[102:103], v3 offset:33280
    v_cvt_pk_bf16_f32 v218, v208, v209
    v_exp_f32 v237, v237
    v_cvt_pk_bf16_f32 v219, v210, v211
    v_cndmask_b32 v196, v1, v140, s[36:37]
    v_mfma_f32_32x32x16_bf16 v[76:91], v[116:119], a[184:187], v[76:91]
    ds_read_b64_tr_b16 v[104:105], v3 offset:34816
    s_add_u32 m0, s55, 32768
    s_lshl_b32 s57, s49, 12
    s_add_u32 s57, s57, s52
    v_cndmask_b32 v197, v1, v141, s[36:37]
    v_cndmask_b32 v198, v1, v142, s[36:37]
    v_mfma_f32_32x32x16_bf16 v[76:91], v[120:123], a[188:191], v[76:91]
    s_waitcnt lgkmcnt(3)
    ds_read_b64_tr_b16 v[106:107], v3 offset:35328
    v_cndmask_b32 v199, v1, v143, s[36:37]
    v_exp_f32 v238, v238
    v_cndmask_b32 v200, v1, v144, s[36:37]
    v_cndmask_b32 v201, v1, v145, s[36:37]
    v_mfma_f32_32x32x16_bf16 v[28:43], v[92:95], a[64:67], v[28:43]
    ds_read_b64_tr_b16 v[108:109], v2 offset:36864
    buffer_load_dwordx4 v252, s[68:71], s57 offen offset:0 lds
    v_cndmask_b32 v202, v1, v146, s[36:37]
    v_exp_f32 v239, v239
    v_mfma_f32_32x32x16_bf16 v[28:43], v[96:99], a[68:71], v[28:43]
    ds_read_b64_tr_b16 v[110:111], v2 offset:37376
    v_cndmask_b32 v203, v1, v147, s[36:37]
    v_exp_f32 v240, v240
    v_mfma_f32_32x32x16_bf16 v[164:179], v[212:215], v[196:199], 0
    v_exp_f32 v241, v241
    v_mfma_f32_32x32x16_bf16 v[164:179], v[216:219], v[200:203], v[164:179]
    v_add_f32 v250, v226, v227
    v_mfma_f32_32x32x16_bf16 v[196:211], v[10:13], v[132:135], 0
    v_add_f32 v250, v250, v228
    v_add_f32 v250, v250, v229
    v_add_f32 v250, v250, v230
    v_add_f32 v250, v250, v231
    v_add_f32 v250, v250, v232
    v_add_f32 v250, v250, v233
    v_mfma_f32_32x32x16_bf16 v[44:59], v[92:95], a[192:195], v[44:59]
    ds_read_b64_tr_b16 v[112:113], v2 offset:38912
    v_add_f32 v251, v234, v235
    v_add_f32 v251, v251, v236
    v_add_f32 v251, v251, v237
    v_add_f32 v251, v251, v238
    v_max3_f32 v220, v196, v197, v198
    v_mfma_f32_32x32x16_bf16 v[44:59], v[96:99], a[196:199], v[44:59]
    s_waitcnt lgkmcnt(3)
    ds_read_b64_tr_b16 v[114:115], v2 offset:39424
    buffer_load_dwordx4 v253, s[68:71], s57 offen offset:1024 lds
    v_max3_f32 v220, v220, v199, v200
    v_add_f32 v251, v251, v239
    v_max3_f32 v220, v220, v201, v202
    v_mfma_f32_32x32x16_bf16 v[60:75], v[100:103], a[64:67], v[60:75]
    ds_read_b64_tr_b16 v[116:117], v3 offset:36864
    v_max_f32 v220, v220, v203
    v_add_f32 v251, v251, v240
    v_max3_f32 v221, v204, v205, v206
    v_add_f32 v251, v251, v241
    v_max3_f32 v221, v221, v207, v208
    v_mfma_f32_32x32x16_bf16 v[60:75], v[104:107], a[68:71], v[60:75]
    ds_read_b64_tr_b16 v[118:119], v3 offset:37376
    v_max3_f32 v221, v221, v209, v210
    v_permlane32_swap_b32 v250, v251
    v_max_f32 v221, v221, v211
    v_add_f32 v250, v250, v251
    v_mfma_f32_32x32x16_bf16 v[76:91], v[100:103], a[192:195], v[76:91]
    ds_read_b64_tr_b16 v[120:121], v3 offset:38912
    buffer_load_dwordx4 v254, s[68:71], s57 offen offset:2048 lds
    v_permlane32_swap_b32 v220, v221
    v_max_f32 v220, v220, v221
    v_mfma_f32_32x32x16_bf16 v[76:91], v[104:107], a[196:199], v[76:91]
    s_waitcnt lgkmcnt(3)
    ds_read_b64_tr_b16 v[122:123], v3 offset:39424
    v_mul_f32 v220, s34, v220
    v_rcp_f32 v250, v250
    v_mov_b32 v221, v220
    v_mov_b32 v251, v250
    v_mfma_f32_32x32x16_bf16 v[28:43], v[108:111], a[72:75], v[28:43]
    ds_read_b64_tr_b16 v[92:93], v2 offset:40960
    v_permlane32_swap_b32 v220, v221
    v_permlane32_swap_b32 v250, v251
    v_fma_f32 v196, v196, s34, -v220
    v_mfma_f32_32x32x16_bf16 v[28:43], v[112:115], a[76:79], v[28:43]
    ds_read_b64_tr_b16 v[94:95], v2 offset:41472
    buffer_load_dwordx4 v255, s[68:71], s57 offen offset:3072 lds
    v_fma_f32 v197, v197, s34, -v220
    v_mul_f32 v226, v226, v250
    v_fma_f32 v198, v198, s34, -v220
    v_mfma_f32_32x32x16_bf16 v[44:59], v[108:111], a[200:203], v[44:59]
    ds_read_b64_tr_b16 v[96:97], v2 offset:43008
    v_fma_f32 v199, v199, s34, -v220
    v_mul_f32 v227, v227, v250
    v_fma_f32 v200, v200, s34, -v220
    v_mul_f32 v228, v228, v250
    v_fma_f32 v201, v201, s34, -v220
    v_mfma_f32_32x32x16_bf16 v[44:59], v[112:115], a[204:207], v[44:59]
    s_waitcnt lgkmcnt(3)
    ds_read_b64_tr_b16 v[98:99], v2 offset:43520
    v_fma_f32 v202, v202, s34, -v220
    v_mul_f32 v229, v229, v250
    v_fma_f32 v203, v203, s34, -v220
    v_mul_f32 v230, v230, v250
    v_fma_f32 v204, v204, s34, -v221
    v_mfma_f32_32x32x16_bf16 v[60:75], v[116:119], a[72:75], v[60:75]
    ds_read_b64_tr_b16 v[100:101], v3 offset:40960
    v_fma_f32 v205, v205, s34, -v221
    v_mul_f32 v231, v231, v250
    v_fma_f32 v206, v206, s34, -v221
    v_mul_f32 v232, v232, v250
    v_fma_f32 v207, v207, s34, -v221
    v_mfma_f32_32x32x16_bf16 v[60:75], v[120:123], a[76:79], v[60:75]
    ds_read_b64_tr_b16 v[102:103], v3 offset:41472
    v_fma_f32 v208, v208, s34, -v221
    v_mul_f32 v233, v233, v250
    v_fma_f32 v209, v209, s34, -v221
    v_mul_f32 v234, v234, v251
    v_fma_f32 v210, v210, s34, -v221
    v_mfma_f32_32x32x16_bf16 v[76:91], v[116:119], a[200:203], v[76:91]
    ds_read_b64_tr_b16 v[104:105], v3 offset:43008
    v_fma_f32 v211, v211, s34, -v221
    v_mul_f32 v235, v235, v251
    v_exp_f32 v196, v196
    v_mul_f32 v236, v236, v251
    v_mfma_f32_32x32x16_bf16 v[76:91], v[120:123], a[204:207], v[76:91]
    s_waitcnt lgkmcnt(3)
    ds_read_b64_tr_b16 v[106:107], v3 offset:43520
    v_exp_f32 v197, v197
    v_mul_f32 v237, v237, v251
    v_exp_f32 v198, v198
    v_mfma_f32_32x32x16_bf16 v[28:43], v[92:95], a[80:83], v[28:43]
    ds_read_b64_tr_b16 v[108:109], v2 offset:45056
    v_exp_f32 v199, v199
    v_mul_f32 v238, v238, v251
    v_exp_f32 v200, v200
    v_mfma_f32_32x32x16_bf16 v[28:43], v[96:99], a[84:87], v[28:43]
    ds_read_b64_tr_b16 v[110:111], v2 offset:45568
    v_exp_f32 v201, v201
    v_mul_f32 v239, v239, v251
    v_exp_f32 v202, v202
    v_mfma_f32_32x32x16_bf16 v[44:59], v[92:95], a[208:211], v[44:59]
    ds_read_b64_tr_b16 v[112:113], v2 offset:47104
    v_exp_f32 v203, v203
    v_mul_f32 v240, v240, v251
    v_exp_f32 v204, v204
    v_mfma_f32_32x32x16_bf16 v[44:59], v[96:99], a[212:215], v[44:59]
    s_waitcnt lgkmcnt(3)
    ds_read_b64_tr_b16 v[114:115], v2 offset:47616
    v_exp_f32 v205, v205
    v_mul_f32 v241, v241, v251
    v_exp_f32 v206, v206
    v_mfma_f32_32x32x16_bf16 v[60:75], v[100:103], a[80:83], v[60:75]
    ds_read_b64_tr_b16 v[116:117], v3 offset:45056
    v_exp_f32 v207, v207
    v_cvt_pk_bf16_f32 v242, v226, v227
    v_exp_f32 v208, v208
    v_mfma_f32_32x32x16_bf16 v[60:75], v[104:107], a[84:87], v[60:75]
    ds_read_b64_tr_b16 v[118:119], v3 offset:45568
    v_exp_f32 v209, v209
    v_cvt_pk_bf16_f32 v243, v228, v229
    v_exp_f32 v210, v210
    v_mfma_f32_32x32x16_bf16 v[76:91], v[100:103], a[208:211], v[76:91]
    ds_read_b64_tr_b16 v[120:121], v3 offset:47104
    v_exp_f32 v211, v211
    v_cvt_pk_bf16_f32 v244, v230, v231
    v_add_f32 v220, v196, v197
    v_cvt_pk_bf16_f32 v245, v232, v233
    v_mfma_f32_32x32x16_bf16 v[76:91], v[104:107], a[212:215], v[76:91]
    s_waitcnt lgkmcnt(3)
    ds_read_b64_tr_b16 v[122:123], v3 offset:47616
    v_add_f32 v220, v220, v198
    v_cvt_pk_bf16_f32 v246, v234, v235
    v_add_f32 v220, v220, v199
    v_cvt_pk_bf16_f32 v247, v236, v237
    v_add_f32 v220, v220, v200
    v_mfma_f32_32x32x16_bf16 v[28:43], v[108:111], a[88:91], v[28:43]
    s_waitcnt vmcnt(16)
    s_barrier
    s_add_u32 m0, s26, 16384
    s_add_u32 s25, s22, s45
    ds_read_b64_tr_b16 v[92:93], v2 offset:49152
    v_add_f32 v220, v220, v201
    v_cvt_pk_bf16_f32 v248, v238, v239
    v_mfma_f32_32x32x16_bf16 v[28:43], v[112:115], a[92:95], v[28:43]
    buffer_load_dwordx4 v6, s[12:15], s25 offen offset:0 lds
    ds_read_b64_tr_b16 v[94:95], v2 offset:49664
    v_add_f32 v220, v220, v202
    v_cvt_pk_bf16_f32 v249, v240, v241
    v_add_f32 v220, v220, v203
    v_mfma_f32_32x32x16_bf16 v[226:241], v[242:245], v[156:159], 0
    v_add_f32 v221, v204, v205
    v_mfma_f32_32x32x16_bf16 v[226:241], v[246:249], v[160:163], v[226:241]
    v_add_f32 v221, v221, v206
    v_add_f32 v221, v221, v207
    v_add_f32 v221, v221, v208
    v_add_f32 v221, v221, v209
    v_add_f32 v221, v221, v210
    v_add_f32 v221, v221, v211
    v_mfma_f32_32x32x16_bf16 v[44:59], v[108:111], a[216:219], v[44:59]
    buffer_load_dwordx4 v7, s[12:15], s25 offen offset:1024 lds
    ds_read_b64_tr_b16 v[96:97], v2 offset:51200
    v_permlane32_swap_b32 v220, v221
    v_add_f32 v220, v220, v221
    v_mfma_f32_32x32x16_bf16 v[44:59], v[112:115], a[220:223], v[44:59]
    s_waitcnt lgkmcnt(3)
    buffer_load_dwordx4 v8, s[12:15], s25 offen offset:2048 lds
    ds_read_b64_tr_b16 v[98:99], v2 offset:51712
    v_rcp_f32 v220, v220
    v_cvt_pk_bf16_f32 v242, v226, v227
    v_mfma_f32_32x32x16_bf16 v[60:75], v[116:119], a[88:91], v[60:75]
    buffer_load_dwordx4 v9, s[12:15], s25 offen offset:3072 lds
    ds_read_b64_tr_b16 v[100:101], v3 offset:49152
    v_mov_b32 v221, v220
    v_cvt_pk_bf16_f32 v243, v228, v229
    v_cvt_pk_bf16_f32 v244, v230, v231
    v_mfma_f32_32x32x16_bf16 v[60:75], v[120:123], a[92:95], v[60:75]
    ds_read_b64_tr_b16 v[102:103], v3 offset:49664
    v_permlane32_swap_b32 v220, v221
    v_cvt_pk_bf16_f32 v245, v232, v233
    v_mul_f32 v196, v196, v220
    v_cvt_pk_bf16_f32 v246, v234, v235
    v_mfma_f32_32x32x16_bf16 v[76:91], v[116:119], a[216:219], v[76:91]
    ds_read_b64_tr_b16 v[104:105], v3 offset:51200
    v_mul_f32 v197, v197, v220
    v_cvt_pk_bf16_f32 v247, v236, v237
    v_mul_f32 v198, v198, v220
    v_cvt_pk_bf16_f32 v248, v238, v239
    v_mul_f32 v199, v199, v220
    v_mfma_f32_32x32x16_bf16 v[76:91], v[120:123], a[220:223], v[76:91]
    s_waitcnt lgkmcnt(3)
    ds_read_b64_tr_b16 v[106:107], v3 offset:51712
    v_mul_f32 v200, v200, v220
    v_cvt_pk_bf16_f32 v249, v240, v241
    v_mul_f32 v201, v201, v220
    v_cndmask_b32 v226, v1, v140, s[38:39]
    v_mul_f32 v202, v202, v220
    v_mfma_f32_32x32x16_bf16 v[28:43], v[92:95], a[96:99], v[28:43]
    ds_read_b64_tr_b16 v[108:109], v2 offset:53248
    v_mul_f32 v203, v203, v220
    v_cndmask_b32 v227, v1, v141, s[38:39]
    v_mul_f32 v204, v204, v221
    v_cndmask_b32 v228, v1, v142, s[38:39]
    v_mul_f32 v205, v205, v221
    v_mfma_f32_32x32x16_bf16 v[28:43], v[96:99], a[100:103], v[28:43]
    ds_read_b64_tr_b16 v[110:111], v2 offset:53760
    v_mul_f32 v206, v206, v221
    v_cndmask_b32 v229, v1, v143, s[38:39]
    v_mul_f32 v207, v207, v221
    v_cndmask_b32 v230, v1, v144, s[38:39]
    v_mul_f32 v208, v208, v221
    v_mfma_f32_32x32x16_bf16 v[44:59], v[92:95], a[224:227], v[44:59]
    ds_read_b64_tr_b16 v[112:113], v2 offset:55296
    v_mul_f32 v209, v209, v221
    v_cndmask_b32 v231, v1, v145, s[38:39]
    v_mul_f32 v210, v210, v221
    v_cndmask_b32 v232, v1, v146, s[38:39]
    v_mul_f32 v211, v211, v221
    v_mfma_f32_32x32x16_bf16 v[44:59], v[96:99], a[228:231], v[44:59]
    s_waitcnt lgkmcnt(3)
    ds_read_b64_tr_b16 v[114:115], v2 offset:55808
    v_cvt_pk_bf16_f32 v212, v196, v197
    v_cndmask_b32 v233, v1, v147, s[38:39]
    v_cvt_pk_bf16_f32 v213, v198, v199
    v_mfma_f32_32x32x16_bf16 v[180:195], v[242:245], v[226:229], 0
    v_cvt_pk_bf16_f32 v214, v200, v201
    v_mfma_f32_32x32x16_bf16 v[180:195], v[246:249], v[230:233], v[180:195]
    v_cvt_pk_bf16_f32 v215, v202, v203
    v_mfma_f32_32x32x16_bf16 v[226:241], v[14:17], v[136:139], 0
    v_cvt_pk_bf16_f32 v216, v204, v205
    v_cvt_pk_bf16_f32 v217, v206, v207
    v_cvt_pk_bf16_f32 v218, v208, v209
    v_cvt_pk_bf16_f32 v219, v210, v211
    v_mfma_f32_32x32x16_bf16 v[196:211], v[212:215], v[156:159], 0
    v_mfma_f32_32x32x16_bf16 v[60:75], v[100:103], a[96:99], v[60:75]
    ds_read_b64_tr_b16 v[116:117], v3 offset:53248
    v_mfma_f32_32x32x16_bf16 v[196:211], v[216:219], v[160:163], v[196:211]
    v_mfma_f32_32x32x16_bf16 v[60:75], v[104:107], a[100:103], v[60:75]
    ds_read_b64_tr_b16 v[118:119], v3 offset:53760
    v_mfma_f32_32x32x16_bf16 v[76:91], v[100:103], a[224:227], v[76:91]
    ds_read_b64_tr_b16 v[120:121], v3 offset:55296
    v_max3_f32 v250, v226, v227, v228
    v_max3_f32 v250, v250, v229, v230
    v_max3_f32 v250, v250, v231, v232
    v_max_f32 v250, v250, v233
    v_max3_f32 v251, v234, v235, v236
    v_mfma_f32_32x32x16_bf16 v[76:91], v[104:107], a[228:231], v[76:91]
    s_waitcnt lgkmcnt(3)
    ds_read_b64_tr_b16 v[122:123], v3 offset:55808
    v_cvt_pk_bf16_f32 v212, v196, v197
    v_max3_f32 v251, v251, v237, v238
    v_cvt_pk_bf16_f32 v213, v198, v199
    v_max3_f32 v251, v251, v239, v240
    v_cvt_pk_bf16_f32 v214, v200, v201
    v_mfma_f32_32x32x16_bf16 v[28:43], v[108:111], a[104:107], v[28:43]
    ds_read_b64_tr_b16 v[92:93], v2 offset:57344
    v_cvt_pk_bf16_f32 v215, v202, v203
    v_max_f32 v251, v251, v241
    v_cvt_pk_bf16_f32 v216, v204, v205
    v_cvt_pk_bf16_f32 v217, v206, v207
    v_cvt_pk_bf16_f32 v218, v208, v209
    v_mfma_f32_32x32x16_bf16 v[28:43], v[112:115], a[108:111], v[28:43]
    ds_read_b64_tr_b16 v[94:95], v2 offset:57856
    v_cvt_pk_bf16_f32 v219, v210, v211
    v_permlane32_swap_b32 v250, v251
    v_cndmask_b32 v196, v1, v148, s[36:37]
    v_max_f32 v250, v250, v251
    v_mfma_f32_32x32x16_bf16 v[44:59], v[108:111], a[232:235], v[44:59]
    ds_read_b64_tr_b16 v[96:97], v2 offset:59392
    v_cndmask_b32 v197, v1, v149, s[36:37]
    v_mul_f32 v250, s34, v250
    v_cndmask_b32 v198, v1, v150, s[36:37]
    v_mov_b32 v251, v250
    v_cndmask_b32 v199, v1, v151, s[36:37]
    v_mfma_f32_32x32x16_bf16 v[44:59], v[112:115], a[236:239], v[44:59]
    s_waitcnt lgkmcnt(3)
    ds_read_b64_tr_b16 v[98:99], v2 offset:59904
    v_cndmask_b32 v200, v1, v152, s[36:37]
    v_permlane32_swap_b32 v250, v251
    v_cndmask_b32 v201, v1, v153, s[36:37]
    v_fma_f32 v226, v226, s34, -v250
    v_mfma_f32_32x32x16_bf16 v[60:75], v[116:119], a[104:107], v[60:75]
    ds_read_b64_tr_b16 v[100:101], v3 offset:57344
    v_cndmask_b32 v202, v1, v154, s[36:37]
    v_fma_f32 v227, v227, s34, -v250
    v_cndmask_b32 v203, v1, v155, s[36:37]
    v_fma_f32 v228, v228, s34, -v250
    v_mfma_f32_32x32x16_bf16 v[164:179], v[212:215], v[196:199], v[164:179]
    v_fma_f32 v229, v229, s34, -v250
    v_mfma_f32_32x32x16_bf16 v[164:179], v[216:219], v[200:203], v[164:179]
    v_fma_f32 v230, v230, s34, -v250
    v_fma_f32 v231, v231, s34, -v250
    v_fma_f32 v232, v232, s34, -v250
    v_fma_f32 v233, v233, s34, -v250
    v_fma_f32 v234, v234, s34, -v251
    v_fma_f32 v235, v235, s34, -v251
    v_mfma_f32_32x32x16_bf16 v[60:75], v[120:123], a[108:111], v[60:75]
    ds_read_b64_tr_b16 v[102:103], v3 offset:57856
    v_fma_f32 v236, v236, s34, -v251
    v_fma_f32 v237, v237, s34, -v251
    v_fma_f32 v238, v238, s34, -v251
    v_fma_f32 v239, v239, s34, -v251
    v_fma_f32 v240, v240, s34, -v251
    v_mfma_f32_32x32x16_bf16 v[76:91], v[116:119], a[232:235], v[76:91]
    ds_read_b64_tr_b16 v[104:105], v3 offset:59392
    ds_write_b128 v24, v[164:167] offset:0
    v_fma_f32 v241, v241, s34, -v251
    ds_write_b128 v24, v[168:171] offset:1024
    v_mfma_f32_32x32x16_bf16 v[76:91], v[120:123], a[236:239], v[76:91]
    s_waitcnt lgkmcnt(5)
    ds_read_b64_tr_b16 v[106:107], v3 offset:59904
    ds_write_b128 v24, v[172:175] offset:2048
    v_exp_f32 v226, v226
    v_exp_f32 v227, v227
    v_mfma_f32_32x32x16_bf16 v[28:43], v[92:95], a[112:115], v[28:43]
    ds_read_b64_tr_b16 v[108:109], v2 offset:61440
    ds_write_b128 v24, v[176:179] offset:3072
    v_exp_f32 v228, v228
    v_exp_f32 v229, v229
    v_mfma_f32_32x32x16_bf16 v[28:43], v[96:99], a[116:119], v[28:43]
    ds_read_b64_tr_b16 v[110:111], v2 offset:61952
    v_exp_f32 v230, v230
    v_exp_f32 v231, v231
    v_mfma_f32_32x32x16_bf16 v[44:59], v[92:95], a[240:243], v[44:59]
    ds_read_b64_tr_b16 v[112:113], v2 offset:63488
    v_exp_f32 v232, v232
    v_exp_f32 v233, v233
    v_mfma_f32_32x32x16_bf16 v[44:59], v[96:99], a[244:247], v[44:59]
    s_waitcnt lgkmcnt(5)
    ds_read_b64_tr_b16 v[114:115], v2 offset:64000
    v_exp_f32 v234, v234
    v_exp_f32 v235, v235
    v_mfma_f32_32x32x16_bf16 v[60:75], v[100:103], a[112:115], v[60:75]
    ds_read_b64_tr_b16 v[116:117], v3 offset:61440
    v_exp_f32 v236, v236
    v_exp_f32 v237, v237
    v_mfma_f32_32x32x16_bf16 v[60:75], v[104:107], a[116:119], v[60:75]
    ds_read_b64_tr_b16 v[118:119], v3 offset:61952
    v_exp_f32 v238, v238
    s_waitcnt lgkmcnt(5)
    v_exp_f32 v239, v239
    v_mfma_f32_32x32x16_bf16 v[76:91], v[100:103], a[240:243], v[76:91]
    ds_read_b64_tr_b16 v[120:121], v3 offset:63488
    v_exp_f32 v240, v240
    v_exp_f32 v241, v241
    v_add_f32 v250, v226, v227
    v_mfma_f32_32x32x16_bf16 v[76:91], v[104:107], a[244:247], v[76:91]
    s_waitcnt lgkmcnt(3)
    ds_read_b64_tr_b16 v[122:123], v3 offset:64000
    v_add_f32 v250, v250, v228
    v_add_f32 v250, v250, v229
    v_add_f32 v250, v250, v230
    v_add_f32 v250, v250, v231
    v_add_f32 v250, v250, v232
    v_add_f32 v250, v250, v233
    v_add_f32 v251, v234, v235
    v_add_f32 v251, v251, v236
    v_add_f32 v251, v251, v237
    v_add_f32 v251, v251, v238
    v_add_f32 v251, v251, v239
    v_add_f32 v251, v251, v240
    v_add_f32 v251, v251, v241
    s_nop 1
    v_permlane32_swap_b32 v250, v251
    v_add_f32 v250, v250, v251
    v_rcp_f32 v250, v250
    s_nop 0
    v_mov_b32 v251, v250
    s_nop 1
    v_permlane32_swap_b32 v250, v251
    v_mul_f32 v226, v226, v250
    v_mul_f32 v227, v227, v250
    v_mul_f32 v228, v228, v250
    v_mul_f32 v229, v229, v250
    v_mul_f32 v230, v230, v250
    v_mul_f32 v231, v231, v250
    v_mul_f32 v232, v232, v250
    v_mul_f32 v233, v233, v250
    v_mul_f32 v234, v234, v251
    v_mul_f32 v235, v235, v251
    v_mul_f32 v236, v236, v251
    v_mul_f32 v237, v237, v251
    v_mul_f32 v238, v238, v251
    v_mul_f32 v239, v239, v251
    v_mul_f32 v240, v240, v251
    v_mul_f32 v241, v241, v251
    v_cvt_pk_bf16_f32 v242, v226, v227
    v_cvt_pk_bf16_f32 v243, v228, v229
    v_cvt_pk_bf16_f32 v244, v230, v231
    v_cvt_pk_bf16_f32 v245, v232, v233
    v_cvt_pk_bf16_f32 v246, v234, v235
    v_cvt_pk_bf16_f32 v247, v236, v237
    v_cvt_pk_bf16_f32 v248, v238, v239
    v_cvt_pk_bf16_f32 v249, v240, v241
    v_mfma_f32_32x32x16_bf16 v[226:241], v[242:245], v[156:159], 0
    s_nop 0
    v_mfma_f32_32x32x16_bf16 v[226:241], v[246:249], v[160:163], v[226:241]
    s_nop 11
    v_cvt_pk_bf16_f32 v242, v226, v227
    v_cvt_pk_bf16_f32 v243, v228, v229
    v_cvt_pk_bf16_f32 v244, v230, v231
    v_cvt_pk_bf16_f32 v245, v232, v233
    v_cvt_pk_bf16_f32 v246, v234, v235
    v_cvt_pk_bf16_f32 v247, v236, v237
    v_cvt_pk_bf16_f32 v248, v238, v239
    v_cvt_pk_bf16_f32 v249, v240, v241
    v_cndmask_b32 v226, v1, v148, s[38:39]
    v_cndmask_b32 v227, v1, v149, s[38:39]
    v_cndmask_b32 v228, v1, v150, s[38:39]
    v_cndmask_b32 v229, v1, v151, s[38:39]
    v_cndmask_b32 v230, v1, v152, s[38:39]
    v_cndmask_b32 v231, v1, v153, s[38:39]
    v_cndmask_b32 v232, v1, v154, s[38:39]
    v_cndmask_b32 v233, v1, v155, s[38:39]
    v_mfma_f32_32x32x16_bf16 v[180:195], v[242:245], v[226:229], v[180:195]
    s_nop 0
    v_mfma_f32_32x32x16_bf16 v[180:195], v[246:249], v[230:233], v[180:195]
    s_nop 11
    ds_write_b128 v24, v[180:183] offset:4096
    ds_write_b128 v24, v[184:187] offset:5120
    ds_write_b128 v24, v[188:191] offset:6144
    ds_write_b128 v24, v[192:195] offset:7168
    s_waitcnt lgkmcnt(0)
    v_add_u32 v22, 1024, v22
    v_mfma_f32_32x32x16_bf16 v[28:43], v[108:111], a[120:123], v[28:43]
    s_waitcnt vmcnt(8)
    s_barrier
    s_add_u32 m0, s26, 32768
    s_add_u32 s25, s22, s50
    ds_read_b64_tr_b16 v[92:93], v2 offset:0
    v_mfma_f32_32x32x16_bf16 v[28:43], v[112:115], a[124:127], v[28:43]
    buffer_load_dwordx4 v6, s[12:15], s25 offen offset:0 lds
    ds_read_b64_tr_b16 v[94:95], v2 offset:512
    v_mfma_f32_32x32x16_bf16 v[44:59], v[108:111], a[248:251], v[44:59]
    buffer_load_dwordx4 v7, s[12:15], s25 offen offset:1024 lds
    ds_read_b64_tr_b16 v[96:97], v2 offset:2048
    v_mfma_f32_32x32x16_bf16 v[44:59], v[112:115], a[252:255], v[44:59]
    buffer_load_dwordx4 v8, s[12:15], s25 offen offset:2048 lds
    ds_read_b64_tr_b16 v[98:99], v2 offset:2560
    v_mfma_f32_32x32x16_bf16 v[60:75], v[116:119], a[120:123], v[60:75]
    buffer_load_dwordx4 v9, s[12:15], s25 offen offset:3072 lds
    ds_read_b64_tr_b16 v[100:101], v3 offset:0
    v_mfma_f32_32x32x16_bf16 v[60:75], v[120:123], a[124:127], v[60:75]
    ds_read_b64_tr_b16 v[102:103], v3 offset:512
    v_cvt_pk_bf16_f32 v124, v28, v29
    v_cvt_pk_bf16_f32 v125, v30, v31
    v_cvt_pk_bf16_f32 v126, v32, v33
    v_cvt_pk_bf16_f32 v127, v34, v35
    v_mfma_f32_32x32x16_bf16 v[76:91], v[116:119], a[248:251], v[76:91]
    ds_read_b64_tr_b16 v[104:105], v3 offset:2048
    s_mov_b32 s21, s22
    s_mov_b32 s22, 0x40000000
    v_cvt_pk_bf16_f32 v128, v36, v37
    v_cvt_pk_bf16_f32 v129, v38, v39
    v_cvt_pk_bf16_f32 v130, v40, v41
    v_cvt_pk_bf16_f32 v131, v42, v43
    v_mfma_f32_32x32x16_bf16 v[76:91], v[120:123], a[252:255], v[76:91]
    s_waitcnt lgkmcnt(3)
    ds_read_b64_tr_b16 v[106:107], v3 offset:2560
    s_cmp_eq_u32 s48, 0
    v_cvt_pk_bf16_f32 v132, v44, v45
    v_cvt_pk_bf16_f32 v133, v46, v47
    v_cvt_pk_bf16_f32 v134, v48, v49
    v_cvt_pk_bf16_f32 v135, v50, v51
    s_cbranch_scc1 L1A_fin
    v_mfma_f32_32x32x16_bf16 v[28:43], v[92:95], a[0:3], 0
    ds_read_b64_tr_b16 v[108:109], v2 offset:4096
    v_cvt_pk_bf16_f32 v136, v52, v53
    v_cvt_pk_bf16_f32 v137, v54, v55
    v_cvt_pk_bf16_f32 v138, v56, v57
    v_cvt_pk_bf16_f32 v139, v58, v59
    v_mfma_f32_32x32x16_bf16 v[28:43], v[96:99], a[4:7], v[28:43]
    ds_read_b64_tr_b16 v[110:111], v2 offset:4608
    v_cvt_pk_bf16_f32 v140, v60, v61
    v_cvt_pk_bf16_f32 v141, v62, v63
    v_cvt_pk_bf16_f32 v142, v64, v65
    v_cvt_pk_bf16_f32 v143, v66, v67
    v_mfma_f32_32x32x16_bf16 v[44:59], v[92:95], a[128:131], 0
    ds_read_b64_tr_b16 v[112:113], v2 offset:6144
    v_cvt_pk_bf16_f32 v144, v68, v69
    v_cvt_pk_bf16_f32 v145, v70, v71
    v_cvt_pk_bf16_f32 v146, v72, v73
    v_cvt_pk_bf16_f32 v147, v74, v75
    v_mfma_f32_32x32x16_bf16 v[44:59], v[96:99], a[132:135], v[44:59]
    s_waitcnt lgkmcnt(3)
    ds_read_b64_tr_b16 v[114:115], v2 offset:6656
    v_cvt_pk_bf16_f32 v148, v76, v77
    v_cvt_pk_bf16_f32 v149, v78, v79
    v_cvt_pk_bf16_f32 v150, v80, v81
    v_cvt_pk_bf16_f32 v151, v82, v83
    v_mfma_f32_32x32x16_bf16 v[60:75], v[100:103], a[0:3], 0
    ds_read_b64_tr_b16 v[116:117], v3 offset:4096
    v_cvt_pk_bf16_f32 v152, v84, v85
    v_cvt_pk_bf16_f32 v153, v86, v87
    v_cvt_pk_bf16_f32 v154, v88, v89
    v_cvt_pk_bf16_f32 v155, v90, v91
    v_mfma_f32_32x32x16_bf16 v[60:75], v[104:107], a[4:7], v[60:75]
    ds_read_b64_tr_b16 v[118:119], v3 offset:4608
    v_mfma_f32_32x32x16_bf16 v[76:91], v[100:103], a[128:131], 0
    ds_read_b64_tr_b16 v[120:121], v3 offset:6144
    v_mfma_f32_32x32x16_bf16 v[76:91], v[104:107], a[132:135], v[76:91]
    s_waitcnt lgkmcnt(3)
    ds_read_b64_tr_b16 v[122:123], v3 offset:6656
    v_mfma_f32_32x32x16_bf16 v[28:43], v[108:111], a[8:11], v[28:43]
    ds_read_b64_tr_b16 v[92:93], v2 offset:8192
    buffer_store_dwordx4 v[124:127], v18, s[16:19], s32 offen offset:0 sc1
    v_mfma_f32_32x32x16_bf16 v[28:43], v[112:115], a[12:15], v[28:43]
    ds_read_b64_tr_b16 v[94:95], v2 offset:8704
    v_mfma_f32_32x32x16_bf16 v[44:59], v[108:111], a[136:139], v[44:59]
    ds_read_b64_tr_b16 v[96:97], v2 offset:10240
    buffer_store_dwordx4 v[128:131], v18, s[16:19], s32 offen offset:1024 sc1
    v_mfma_f32_32x32x16_bf16 v[44:59], v[112:115], a[140:143], v[44:59]
    s_waitcnt lgkmcnt(3)
    ds_read_b64_tr_b16 v[98:99], v2 offset:10752
    v_mfma_f32_32x32x16_bf16 v[60:75], v[116:119], a[8:11], v[60:75]
    ds_read_b64_tr_b16 v[100:101], v3 offset:8192
    buffer_store_dwordx4 v[132:135], v20, s[16:19], s32 offen offset:0 sc1
    v_mfma_f32_32x32x16_bf16 v[60:75], v[120:123], a[12:15], v[60:75]
    ds_read_b64_tr_b16 v[102:103], v3 offset:8704
    v_mfma_f32_32x32x16_bf16 v[76:91], v[116:119], a[136:139], v[76:91]
    ds_read_b64_tr_b16 v[104:105], v3 offset:10240
    buffer_store_dwordx4 v[136:139], v20, s[16:19], s32 offen offset:1024 sc1
    v_mfma_f32_32x32x16_bf16 v[76:91], v[120:123], a[140:143], v[76:91]
    s_waitcnt lgkmcnt(3)
    ds_read_b64_tr_b16 v[106:107], v3 offset:10752
    v_mfma_f32_32x32x16_bf16 v[28:43], v[92:95], a[16:19], v[28:43]
    ds_read_b64_tr_b16 v[108:109], v2 offset:12288
    buffer_store_dwordx4 v[140:143], v18, s[16:19], s32 offen offset:2048 sc1
    v_mfma_f32_32x32x16_bf16 v[28:43], v[96:99], a[20:23], v[28:43]
    ds_read_b64_tr_b16 v[110:111], v2 offset:12800
    v_mfma_f32_32x32x16_bf16 v[44:59], v[92:95], a[144:147], v[44:59]
    ds_read_b64_tr_b16 v[112:113], v2 offset:14336
    buffer_store_dwordx4 v[144:147], v18, s[16:19], s32 offen offset:3072 sc1
    v_mfma_f32_32x32x16_bf16 v[44:59], v[96:99], a[148:151], v[44:59]
    s_waitcnt lgkmcnt(3)
    ds_read_b64_tr_b16 v[114:115], v2 offset:14848
    v_mfma_f32_32x32x16_bf16 v[60:75], v[100:103], a[16:19], v[60:75]
    ds_read_b64_tr_b16 v[116:117], v3 offset:12288
    buffer_store_dwordx4 v[148:151], v20, s[16:19], s32 offen offset:2048 sc1
    v_mfma_f32_32x32x16_bf16 v[60:75], v[104:107], a[20:23], v[60:75]
    ds_read_b64_tr_b16 v[118:119], v3 offset:12800
    v_mfma_f32_32x32x16_bf16 v[76:91], v[100:103], a[144:147], v[76:91]
    ds_read_b64_tr_b16 v[120:121], v3 offset:14336
    buffer_store_dwordx4 v[152:155], v20, s[16:19], s32 offen offset:3072 sc1
    v_mfma_f32_32x32x16_bf16 v[76:91], v[104:107], a[148:151], v[76:91]
    s_waitcnt lgkmcnt(3)
    ds_read_b64_tr_b16 v[122:123], v3 offset:14848
    v_mfma_f32_32x32x16_bf16 v[28:43], v[108:111], a[24:27], v[28:43]
    s_waitcnt vmcnt(12)
    s_barrier
    s_add_u32 m0, s26, 49152
    s_add_u32 s25, s21, s51
    ds_read_b64_tr_b16 v[92:93], v2 offset:16384
    s_add_u32 s32, s32, 4096
    v_mfma_f32_32x32x16_bf16 v[28:43], v[112:115], a[28:31], v[28:43]
    buffer_load_dwordx4 v6, s[12:15], s25 offen offset:0 lds
    ds_read_b64_tr_b16 v[94:95], v2 offset:16896
    v_mfma_f32_32x32x16_bf16 v[44:59], v[108:111], a[152:155], v[44:59]
    buffer_load_dwordx4 v7, s[12:15], s25 offen offset:1024 lds
    ds_read_b64_tr_b16 v[96:97], v2 offset:18432
    v_mfma_f32_32x32x16_bf16 v[44:59], v[112:115], a[156:159], v[44:59]
    s_waitcnt lgkmcnt(3)
    buffer_load_dwordx4 v8, s[12:15], s25 offen offset:2048 lds
    ds_read_b64_tr_b16 v[98:99], v2 offset:18944
    v_mfma_f32_32x32x16_bf16 v[60:75], v[116:119], a[24:27], v[60:75]
    buffer_load_dwordx4 v9, s[12:15], s25 offen offset:3072 lds
    ds_read_b64_tr_b16 v[100:101], v3 offset:16384
    v_mfma_f32_32x32x16_bf16 v[60:75], v[120:123], a[28:31], v[60:75]
    ds_read_b64_tr_b16 v[102:103], v3 offset:16896
    v_mfma_f32_32x32x16_bf16 v[76:91], v[116:119], a[152:155], v[76:91]
    ds_read_b64_tr_b16 v[104:105], v3 offset:18432
    v_mfma_f32_32x32x16_bf16 v[76:91], v[120:123], a[156:159], v[76:91]
    s_waitcnt lgkmcnt(3)
    ds_read_b64_tr_b16 v[106:107], v3 offset:18944
    v_mfma_f32_32x32x16_bf16 v[28:43], v[92:95], a[32:35], v[28:43]
    ds_read_b64_tr_b16 v[108:109], v2 offset:20480
    v_mfma_f32_32x32x16_bf16 v[28:43], v[96:99], a[36:39], v[28:43]
    ds_read_b64_tr_b16 v[110:111], v2 offset:20992
    v_mfma_f32_32x32x16_bf16 v[44:59], v[92:95], a[160:163], v[44:59]
    ds_read_b64_tr_b16 v[112:113], v2 offset:22528
    v_mfma_f32_32x32x16_bf16 v[44:59], v[96:99], a[164:167], v[44:59]
    s_waitcnt lgkmcnt(3)
    ds_read_b64_tr_b16 v[114:115], v2 offset:23040
    v_mfma_f32_32x32x16_bf16 v[60:75], v[100:103], a[32:35], v[60:75]
    ds_read_b64_tr_b16 v[116:117], v3 offset:20480
    v_mfma_f32_32x32x16_bf16 v[60:75], v[104:107], a[36:39], v[60:75]
    ds_read_b64_tr_b16 v[118:119], v3 offset:20992
    v_mfma_f32_32x32x16_bf16 v[76:91], v[100:103], a[160:163], v[76:91]
    ds_read_b64_tr_b16 v[120:121], v3 offset:22528
    v_mfma_f32_32x32x16_bf16 v[76:91], v[104:107], a[164:167], v[76:91]
    s_waitcnt lgkmcnt(3)
    ds_read_b64_tr_b16 v[122:123], v3 offset:23040
    v_mfma_f32_32x32x16_bf16 v[28:43], v[108:111], a[40:43], v[28:43]
    ds_read_b64_tr_b16 v[92:93], v2 offset:24576
    v_mfma_f32_32x32x16_bf16 v[28:43], v[112:115], a[44:47], v[28:43]
    ds_read_b64_tr_b16 v[94:95], v2 offset:25088
    v_mfma_f32_32x32x16_bf16 v[44:59], v[108:111], a[168:171], v[44:59]
    ds_read_b64_tr_b16 v[96:97], v2 offset:26624
    v_mfma_f32_32x32x16_bf16 v[44:59], v[112:115], a[172:175], v[44:59]
    s_waitcnt lgkmcnt(3)
    ds_read_b64_tr_b16 v[98:99], v2 offset:27136
    v_mfma_f32_32x32x16_bf16 v[60:75], v[116:119], a[40:43], v[60:75]
    ds_read_b64_tr_b16 v[100:101], v3 offset:24576
    v_mfma_f32_32x32x16_bf16 v[60:75], v[120:123], a[44:47], v[60:75]
    ds_read_b64_tr_b16 v[102:103], v3 offset:25088
    v_mfma_f32_32x32x16_bf16 v[76:91], v[116:119], a[168:171], v[76:91]
    ds_read_b64_tr_b16 v[104:105], v3 offset:26624
    v_mfma_f32_32x32x16_bf16 v[76:91], v[120:123], a[172:175], v[76:91]
    s_waitcnt lgkmcnt(3)
    ds_read_b64_tr_b16 v[106:107], v3 offset:27136
    v_mfma_f32_32x32x16_bf16 v[28:43], v[92:95], a[48:51], v[28:43]
    ds_read_b64_tr_b16 v[108:109], v2 offset:28672
    v_mfma_f32_32x32x16_bf16 v[28:43], v[96:99], a[52:55], v[28:43]
    ds_read_b64_tr_b16 v[110:111], v2 offset:29184
    v_mfma_f32_32x32x16_bf16 v[44:59], v[92:95], a[176:179], v[44:59]
    ds_read_b64_tr_b16 v[112:113], v2 offset:30720
    v_mfma_f32_32x32x16_bf16 v[44:59], v[96:99], a[180:183], v[44:59]
    s_waitcnt lgkmcnt(3)
    ds_read_b64_tr_b16 v[114:115], v2 offset:31232
    v_mfma_f32_32x32x16_bf16 v[60:75], v[100:103], a[48:51], v[60:75]
    ds_read_b64_tr_b16 v[116:117], v3 offset:28672
    v_mfma_f32_32x32x16_bf16 v[60:75], v[104:107], a[52:55], v[60:75]
    ds_read_b64_tr_b16 v[118:119], v3 offset:29184
    v_mfma_f32_32x32x16_bf16 v[76:91], v[100:103], a[176:179], v[76:91]
    ds_read_b64_tr_b16 v[120:121], v3 offset:30720
    v_mfma_f32_32x32x16_bf16 v[76:91], v[104:107], a[180:183], v[76:91]
    s_waitcnt lgkmcnt(3)
    ds_read_b64_tr_b16 v[122:123], v3 offset:31232
    v_mfma_f32_32x32x16_bf16 v[28:43], v[108:111], a[56:59], v[28:43]
    s_waitcnt vmcnt(12)
    s_barrier
    s_add_u32 m0, s26, 0
    s_add_u32 s25, s22, s44
    ds_read_b64_tr_b16 v[92:93], v2 offset:32768
    v_mfma_f32_32x32x16_bf16 v[28:43], v[112:115], a[60:63], v[28:43]
    buffer_load_dwordx4 v6, s[12:15], s25 offen offset:0 lds
    ds_read_b64_tr_b16 v[94:95], v2 offset:33280
    v_mfma_f32_32x32x16_bf16 v[44:59], v[108:111], a[184:187], v[44:59]
    buffer_load_dwordx4 v7, s[12:15], s25 offen offset:1024 lds
    ds_read_b64_tr_b16 v[96:97], v2 offset:34816
    v_mfma_f32_32x32x16_bf16 v[44:59], v[112:115], a[188:191], v[44:59]
    s_waitcnt lgkmcnt(3)
    buffer_load_dwordx4 v8, s[12:15], s25 offen offset:2048 lds
    ds_read_b64_tr_b16 v[98:99], v2 offset:35328
    v_mfma_f32_32x32x16_bf16 v[60:75], v[116:119], a[56:59], v[60:75]
    buffer_load_dwordx4 v9, s[12:15], s25 offen offset:3072 lds
    ds_read_b64_tr_b16 v[100:101], v3 offset:32768
    v_mfma_f32_32x32x16_bf16 v[60:75], v[120:123], a[60:63], v[60:75]
    ds_read_b64_tr_b16 v[102:103], v3 offset:33280
    v_mfma_f32_32x32x16_bf16 v[76:91], v[116:119], a[184:187], v[76:91]
    ds_read_b64_tr_b16 v[104:105], v3 offset:34816
    v_mfma_f32_32x32x16_bf16 v[76:91], v[120:123], a[188:191], v[76:91]
    s_waitcnt lgkmcnt(3)
    ds_read_b64_tr_b16 v[106:107], v3 offset:35328
    v_mfma_f32_32x32x16_bf16 v[28:43], v[92:95], a[64:67], v[28:43]
    ds_read_b64_tr_b16 v[108:109], v2 offset:36864
    v_mfma_f32_32x32x16_bf16 v[28:43], v[96:99], a[68:71], v[28:43]
    ds_read_b64_tr_b16 v[110:111], v2 offset:37376
    v_mfma_f32_32x32x16_bf16 v[44:59], v[92:95], a[192:195], v[44:59]
    ds_read_b64_tr_b16 v[112:113], v2 offset:38912
    v_mfma_f32_32x32x16_bf16 v[44:59], v[96:99], a[196:199], v[44:59]
    s_waitcnt lgkmcnt(3)
    ds_read_b64_tr_b16 v[114:115], v2 offset:39424
    v_mfma_f32_32x32x16_bf16 v[60:75], v[100:103], a[64:67], v[60:75]
    ds_read_b64_tr_b16 v[116:117], v3 offset:36864
    v_mfma_f32_32x32x16_bf16 v[60:75], v[104:107], a[68:71], v[60:75]
    ds_read_b64_tr_b16 v[118:119], v3 offset:37376
    v_mfma_f32_32x32x16_bf16 v[76:91], v[100:103], a[192:195], v[76:91]
    ds_read_b64_tr_b16 v[120:121], v3 offset:38912
    v_mfma_f32_32x32x16_bf16 v[76:91], v[104:107], a[196:199], v[76:91]
    s_waitcnt lgkmcnt(3)
    ds_read_b64_tr_b16 v[122:123], v3 offset:39424
    v_mfma_f32_32x32x16_bf16 v[28:43], v[108:111], a[72:75], v[28:43]
    ds_read_b64_tr_b16 v[92:93], v2 offset:40960
    v_mfma_f32_32x32x16_bf16 v[28:43], v[112:115], a[76:79], v[28:43]
    ds_read_b64_tr_b16 v[94:95], v2 offset:41472
    v_mfma_f32_32x32x16_bf16 v[44:59], v[108:111], a[200:203], v[44:59]
    ds_read_b64_tr_b16 v[96:97], v2 offset:43008
    v_mfma_f32_32x32x16_bf16 v[44:59], v[112:115], a[204:207], v[44:59]
    s_waitcnt lgkmcnt(3)
    ds_read_b64_tr_b16 v[98:99], v2 offset:43520
    v_mfma_f32_32x32x16_bf16 v[60:75], v[116:119], a[72:75], v[60:75]
    ds_read_b64_tr_b16 v[100:101], v3 offset:40960
    v_mfma_f32_32x32x16_bf16 v[60:75], v[120:123], a[76:79], v[60:75]
    ds_read_b64_tr_b16 v[102:103], v3 offset:41472
    v_mfma_f32_32x32x16_bf16 v[76:91], v[116:119], a[200:203], v[76:91]
    ds_read_b64_tr_b16 v[104:105], v3 offset:43008
    v_mfma_f32_32x32x16_bf16 v[76:91], v[120:123], a[204:207], v[76:91]
    s_waitcnt lgkmcnt(3)
    ds_read_b64_tr_b16 v[106:107], v3 offset:43520
    v_mfma_f32_32x32x16_bf16 v[28:43], v[92:95], a[80:83], v[28:43]
    ds_read_b64_tr_b16 v[108:109], v2 offset:45056
    v_mfma_f32_32x32x16_bf16 v[28:43], v[96:99], a[84:87], v[28:43]
    ds_read_b64_tr_b16 v[110:111], v2 offset:45568
    v_mfma_f32_32x32x16_bf16 v[44:59], v[92:95], a[208:211], v[44:59]
    ds_read_b64_tr_b16 v[112:113], v2 offset:47104
    v_mfma_f32_32x32x16_bf16 v[44:59], v[96:99], a[212:215], v[44:59]
    s_waitcnt lgkmcnt(3)
    ds_read_b64_tr_b16 v[114:115], v2 offset:47616
    v_mfma_f32_32x32x16_bf16 v[60:75], v[100:103], a[80:83], v[60:75]
    ds_read_b64_tr_b16 v[116:117], v3 offset:45056
    v_mfma_f32_32x32x16_bf16 v[60:75], v[104:107], a[84:87], v[60:75]
    ds_read_b64_tr_b16 v[118:119], v3 offset:45568
    v_mfma_f32_32x32x16_bf16 v[76:91], v[100:103], a[208:211], v[76:91]
    ds_read_b64_tr_b16 v[120:121], v3 offset:47104
    v_mfma_f32_32x32x16_bf16 v[76:91], v[104:107], a[212:215], v[76:91]
    s_waitcnt lgkmcnt(3)
    ds_read_b64_tr_b16 v[122:123], v3 offset:47616
    v_mfma_f32_32x32x16_bf16 v[28:43], v[108:111], a[88:91], v[28:43]
    s_waitcnt vmcnt(4)
    s_barrier
    s_add_u32 m0, s26, 16384
    s_add_u32 s25, s22, s45
    ds_read_b64_tr_b16 v[92:93], v2 offset:49152
    v_mfma_f32_32x32x16_bf16 v[28:43], v[112:115], a[92:95], v[28:43]
    buffer_load_dwordx4 v6, s[12:15], s25 offen offset:0 lds
    ds_read_b64_tr_b16 v[94:95], v2 offset:49664
    v_mfma_f32_32x32x16_bf16 v[44:59], v[108:111], a[216:219], v[44:59]
    buffer_load_dwordx4 v7, s[12:15], s25 offen offset:1024 lds
    ds_read_b64_tr_b16 v[96:97], v2 offset:51200
    v_mfma_f32_32x32x16_bf16 v[44:59], v[112:115], a[220:223], v[44:59]
    s_waitcnt lgkmcnt(3)
    buffer_load_dwordx4 v8, s[12:15], s25 offen offset:2048 lds
    ds_read_b64_tr_b16 v[98:99], v2 offset:51712
    v_mfma_f32_32x32x16_bf16 v[60:75], v[116:119], a[88:91], v[60:75]
    buffer_load_dwordx4 v9, s[12:15], s25 offen offset:3072 lds
    ds_read_b64_tr_b16 v[100:101], v3 offset:49152
    v_mfma_f32_32x32x16_bf16 v[60:75], v[120:123], a[92:95], v[60:75]
    ds_read_b64_tr_b16 v[102:103], v3 offset:49664
    v_mfma_f32_32x32x16_bf16 v[76:91], v[116:119], a[216:219], v[76:91]
    ds_read_b64_tr_b16 v[104:105], v3 offset:51200
    v_mfma_f32_32x32x16_bf16 v[76:91], v[120:123], a[220:223], v[76:91]
    s_waitcnt lgkmcnt(3)
    ds_read_b64_tr_b16 v[106:107], v3 offset:51712
    v_mfma_f32_32x32x16_bf16 v[28:43], v[92:95], a[96:99], v[28:43]
    ds_read_b64_tr_b16 v[108:109], v2 offset:53248
    v_mfma_f32_32x32x16_bf16 v[28:43], v[96:99], a[100:103], v[28:43]
    ds_read_b64_tr_b16 v[110:111], v2 offset:53760
    v_mfma_f32_32x32x16_bf16 v[44:59], v[92:95], a[224:227], v[44:59]
    ds_read_b64_tr_b16 v[112:113], v2 offset:55296
    v_mfma_f32_32x32x16_bf16 v[44:59], v[96:99], a[228:231], v[44:59]
    s_waitcnt lgkmcnt(3)
    ds_read_b64_tr_b16 v[114:115], v2 offset:55808
    v_mfma_f32_32x32x16_bf16 v[60:75], v[100:103], a[96:99], v[60:75]
    ds_read_b64_tr_b16 v[116:117], v3 offset:53248
    v_mfma_f32_32x32x16_bf16 v[60:75], v[104:107], a[100:103], v[60:75]
    ds_read_b64_tr_b16 v[118:119], v3 offset:53760
    v_mfma_f32_32x32x16_bf16 v[76:91], v[100:103], a[224:227], v[76:91]
    ds_read_b64_tr_b16 v[120:121], v3 offset:55296
    v_mfma_f32_32x32x16_bf16 v[76:91], v[104:107], a[228:231], v[76:91]
    s_waitcnt lgkmcnt(3)
    ds_read_b64_tr_b16 v[122:123], v3 offset:55808
    v_mfma_f32_32x32x16_bf16 v[28:43], v[108:111], a[104:107], v[28:43]
    ds_read_b64_tr_b16 v[92:93], v2 offset:57344
    v_mfma_f32_32x32x16_bf16 v[28:43], v[112:115], a[108:111], v[28:43]
    ds_read_b64_tr_b16 v[94:95], v2 offset:57856
    v_mfma_f32_32x32x16_bf16 v[44:59], v[108:111], a[232:235], v[44:59]
    ds_read_b64_tr_b16 v[96:97], v2 offset:59392
    v_mfma_f32_32x32x16_bf16 v[44:59], v[112:115], a[236:239], v[44:59]
    s_waitcnt lgkmcnt(3)
    ds_read_b64_tr_b16 v[98:99], v2 offset:59904
    v_mfma_f32_32x32x16_bf16 v[60:75], v[116:119], a[104:107], v[60:75]
    ds_read_b64_tr_b16 v[100:101], v3 offset:57344
    v_mfma_f32_32x32x16_bf16 v[60:75], v[120:123], a[108:111], v[60:75]
    ds_read_b64_tr_b16 v[102:103], v3 offset:57856
    v_mfma_f32_32x32x16_bf16 v[76:91], v[116:119], a[232:235], v[76:91]
    ds_read_b64_tr_b16 v[104:105], v3 offset:59392
    v_mfma_f32_32x32x16_bf16 v[76:91], v[120:123], a[236:239], v[76:91]
    s_waitcnt lgkmcnt(3)
    ds_read_b64_tr_b16 v[106:107], v3 offset:59904
    v_mfma_f32_32x32x16_bf16 v[28:43], v[92:95], a[112:115], v[28:43]
    ds_read_b64_tr_b16 v[108:109], v2 offset:61440
    v_mfma_f32_32x32x16_bf16 v[28:43], v[96:99], a[116:119], v[28:43]
    ds_read_b64_tr_b16 v[110:111], v2 offset:61952
    v_mfma_f32_32x32x16_bf16 v[44:59], v[92:95], a[240:243], v[44:59]
    ds_read_b64_tr_b16 v[112:113], v2 offset:63488
    v_mfma_f32_32x32x16_bf16 v[44:59], v[96:99], a[244:247], v[44:59]
    s_waitcnt lgkmcnt(3)
    ds_read_b64_tr_b16 v[114:115], v2 offset:64000
    v_mfma_f32_32x32x16_bf16 v[60:75], v[100:103], a[112:115], v[60:75]
    ds_read_b64_tr_b16 v[116:117], v3 offset:61440
    v_mfma_f32_32x32x16_bf16 v[60:75], v[104:107], a[116:119], v[60:75]
    ds_read_b64_tr_b16 v[118:119], v3 offset:61952
    v_mfma_f32_32x32x16_bf16 v[76:91], v[100:103], a[240:243], v[76:91]
    ds_read_b64_tr_b16 v[120:121], v3 offset:63488
    v_mfma_f32_32x32x16_bf16 v[76:91], v[104:107], a[244:247], v[76:91]
    s_waitcnt lgkmcnt(3)
    ds_read_b64_tr_b16 v[122:123], v3 offset:64000
    v_mfma_f32_32x32x16_bf16 v[28:43], v[108:111], a[120:123], v[28:43]
    s_waitcnt vmcnt(4)
    s_barrier
    s_add_u32 m0, s26, 32768
    s_add_u32 s25, s22, s50
    ds_read_b64_tr_b16 v[92:93], v2 offset:0
    v_mfma_f32_32x32x16_bf16 v[28:43], v[112:115], a[124:127], v[28:43]
    buffer_load_dwordx4 v6, s[12:15], s25 offen offset:0 lds
    ds_read_b64_tr_b16 v[94:95], v2 offset:512
    v_mfma_f32_32x32x16_bf16 v[44:59], v[108:111], a[248:251], v[44:59]
    buffer_load_dwordx4 v7, s[12:15], s25 offen offset:1024 lds
    ds_read_b64_tr_b16 v[96:97], v2 offset:2048
    v_mfma_f32_32x32x16_bf16 v[44:59], v[112:115], a[252:255], v[44:59]
    s_waitcnt lgkmcnt(3)
    buffer_load_dwordx4 v8, s[12:15], s25 offen offset:2048 lds
    ds_read_b64_tr_b16 v[98:99], v2 offset:2560
    v_mfma_f32_32x32x16_bf16 v[60:75], v[116:119], a[120:123], v[60:75]
    buffer_load_dwordx4 v9, s[12:15], s25 offen offset:3072 lds
    ds_read_b64_tr_b16 v[100:101], v3 offset:0
    v_mfma_f32_32x32x16_bf16 v[60:75], v[120:123], a[124:127], v[60:75]
    ds_read_b64_tr_b16 v[102:103], v3 offset:512
    v_cvt_pk_bf16_f32 v124, v28, v29
    v_cvt_pk_bf16_f32 v125, v30, v31
    v_cvt_pk_bf16_f32 v126, v32, v33
    v_cvt_pk_bf16_f32 v127, v34, v35
    v_mfma_f32_32x32x16_bf16 v[76:91], v[116:119], a[248:251], v[76:91]
    ds_read_b64_tr_b16 v[104:105], v3 offset:2048
    s_mov_b32 s21, s22
    s_mov_b32 s22, 0x40000000
    v_cvt_pk_bf16_f32 v128, v36, v37
    v_cvt_pk_bf16_f32 v129, v38, v39
    v_cvt_pk_bf16_f32 v130, v40, v41
    v_cvt_pk_bf16_f32 v131, v42, v43
    v_mfma_f32_32x32x16_bf16 v[76:91], v[120:123], a[252:255], v[76:91]
    s_waitcnt lgkmcnt(3)
    ds_read_b64_tr_b16 v[106:107], v3 offset:2560
    v_cvt_pk_bf16_f32 v132, v44, v45
    v_cvt_pk_bf16_f32 v133, v46, v47
    v_cvt_pk_bf16_f32 v134, v48, v49
    v_cvt_pk_bf16_f32 v135, v50, v51
L1A_fin:
    ds_read_b128 v[164:167], v25 offset:0
    v_cvt_pk_bf16_f32 v136, v52, v53
    ds_read_b128 v[168:171], v25 offset:1024
    v_cvt_pk_bf16_f32 v137, v54, v55
    ds_read_b128 v[172:175], v25 offset:8192
    v_cvt_pk_bf16_f32 v138, v56, v57
    ds_read_b128 v[176:179], v25 offset:9216
    v_cvt_pk_bf16_f32 v139, v58, v59
    ds_read_b128 v[180:183], v25 offset:16384
    v_cvt_pk_bf16_f32 v140, v60, v61
    ds_read_b128 v[184:187], v25 offset:17408
    v_cvt_pk_bf16_f32 v141, v62, v63
    ds_read_b128 v[188:191], v25 offset:24576
    v_cvt_pk_bf16_f32 v142, v64, v65
    ds_read_b128 v[192:195], v25 offset:25600
    v_cvt_pk_bf16_f32 v143, v66, v67
    s_waitcnt lgkmcnt(0)
    v_add_f32 v164, v164, v172
    v_cvt_pk_bf16_f32 v144, v68, v69
    v_add_f32 v165, v165, v173
    v_cvt_pk_bf16_f32 v145, v70, v71
    v_add_f32 v166, v166, v174
    v_cvt_pk_bf16_f32 v146, v72, v73
    v_add_f32 v167, v167, v175
    v_cvt_pk_bf16_f32 v147, v74, v75
    v_add_f32 v168, v168, v176
    v_cvt_pk_bf16_f32 v148, v76, v77
    v_add_f32 v169, v169, v177
    v_cvt_pk_bf16_f32 v149, v78, v79
    v_add_f32 v170, v170, v178
    v_cvt_pk_bf16_f32 v150, v80, v81
    v_add_f32 v171, v171, v179
    v_cvt_pk_bf16_f32 v151, v82, v83
    v_add_f32 v180, v180, v188
    v_cvt_pk_bf16_f32 v152, v84, v85
    v_add_f32 v181, v181, v189
    v_cvt_pk_bf16_f32 v153, v86, v87
    v_add_f32 v182, v182, v190
    v_cvt_pk_bf16_f32 v154, v88, v89
    v_add_f32 v183, v183, v191
    v_cvt_pk_bf16_f32 v155, v90, v91
    v_add_f32 v184, v184, v192
    buffer_store_dwordx4 v[124:127], v18, s[16:19], s32 offen offset:0 sc1
    v_add_f32 v185, v185, v193
    buffer_store_dwordx4 v[128:131], v18, s[16:19], s32 offen offset:1024 sc1
    v_add_f32 v186, v186, v194
    buffer_store_dwordx4 v[132:135], v20, s[16:19], s32 offen offset:0 sc1
    v_add_f32 v187, v187, v195
    buffer_store_dwordx4 v[136:139], v20, s[16:19], s32 offen offset:1024 sc1
    v_add_f32 v164, v164, v180
    buffer_store_dwordx4 v[140:143], v18, s[16:19], s32 offen offset:2048 sc1
    v_add_f32 v165, v165, v181
    buffer_store_dwordx4 v[144:147], v18, s[16:19], s32 offen offset:3072 sc1
    v_add_f32 v166, v166, v182
    buffer_store_dwordx4 v[148:151], v20, s[16:19], s32 offen offset:2048 sc1
    v_add_f32 v167, v167, v183
    buffer_store_dwordx4 v[152:155], v20, s[16:19], s32 offen offset:3072 sc1
    v_add_f32 v168, v168, v184
    s_add_u32 s32, s32, 4096
    v_add_f32 v169, v169, v185
    v_add_f32 v170, v170, v186
    v_add_f32 v171, v171, v187
    buffer_store_dwordx4 v[164:167], v18, s[16:19], s23 offen offset:0 sc1
    buffer_store_dwordx4 v[168:171], v18, s[16:19], s23 offen offset:1024 sc1
    s_mov_b32 s23, s35
    s_add_u32 s35, s35, 8192
    s_waitcnt vmcnt(10)
    s_load_dwordx2 s[38:39], s[0:1], 24
    s_mov_b32 s101, s30
    s_waitcnt lgkmcnt(0)
    s_barrier
    s_branch P2_q1
P2_q0:
    s_add_u32 m0, s54, 0
    s_add_u32 s49, s53, 0
    s_and_b32 s49, s49, 1023
    s_add_u32 s57, s46, s49
    buffer_load_dwordx4 v222, s[64:67], s57 offen offset:0 lds
    buffer_load_dwordx4 v223, s[64:67], s57 offen offset:1024 lds
    buffer_load_dwordx4 v224, s[64:67], s57 offen offset:2048 lds
    buffer_load_dwordx4 v225, s[64:67], s57 offen offset:3072 lds
    s_add_u32 m0, s54, 4096
    s_add_u32 s57, s47, s49
    buffer_load_dwordx4 v222, s[64:67], s57 offen offset:0 lds
    buffer_load_dwordx4 v223, s[64:67], s57 offen offset:1024 lds
    buffer_load_dwordx4 v224, s[64:67], s57 offen offset:2048 lds
    buffer_load_dwordx4 v225, s[64:67], s57 offen offset:3072 lds
    s_add_u32 m0, s55, 32768
    s_lshl_b32 s57, s49, 12
    s_add_u32 s57, s57, s52
    buffer_load_dwordx4 v252, s[68:71], s57 offen offset:0 lds
    buffer_load_dwordx4 v253, s[68:71], s57 offen offset:1024 lds
    buffer_load_dwordx4 v254, s[68:71], s57 offen offset:2048 lds
    buffer_load_dwordx4 v255, s[68:71], s57 offen offset:3072 lds
    s_add_u32 m0, s54, 131072
    s_add_u32 s49, s53, 128
    s_and_b32 s49, s49, 1023
    s_add_u32 s57, s46, s49
    buffer_load_dwordx4 v222, s[64:67], s57 offen offset:0 lds
    buffer_load_dwordx4 v223, s[64:67], s57 offen offset:1024 lds
    buffer_load_dwordx4 v224, s[64:67], s57 offen offset:2048 lds
    buffer_load_dwordx4 v225, s[64:67], s57 offen offset:3072 lds
    s_add_u32 m0, s54, 135168
    s_add_u32 s57, s47, s49
    buffer_load_dwordx4 v222, s[64:67], s57 offen offset:0 lds
    buffer_load_dwordx4 v223, s[64:67], s57 offen offset:1024 lds
    buffer_load_dwordx4 v224, s[64:67], s57 offen offset:2048 lds
    buffer_load_dwordx4 v225, s[64:67], s57 offen offset:3072 lds
    s_add_u32 m0, s55, 49152
    s_lshl_b32 s57, s49, 12
    s_add_u32 s57, s57, s52
    buffer_load_dwordx4 v252, s[68:71], s57 offen offset:0 lds
    buffer_load_dwordx4 v253, s[68:71], s57 offen offset:1024 lds
    buffer_load_dwordx4 v254, s[68:71], s57 offen offset:2048 lds
    buffer_load_dwordx4 v255, s[68:71], s57 offen offset:3072 lds
    s_waitcnt vmcnt(12)
    s_barrier
    s_branch P2_entry
P2_q1:
    s_add_u32 m0, s54, 131072
    s_add_u32 s49, s53, 128
    s_and_b32 s49, s49, 1023
    s_add_u32 s57, s46, s49
    buffer_load_dwordx4 v222, s[64:67], s57 offen offset:0 lds
    buffer_load_dwordx4 v223, s[64:67], s57 offen offset:1024 lds
    buffer_load_dwordx4 v224, s[64:67], s57 offen offset:2048 lds
    buffer_load_dwordx4 v225, s[64:67], s57 offen offset:3072 lds
    s_add_u32 m0, s54, 135168
    s_add_u32 s57, s47, s49
    buffer_load_dwordx4 v222, s[64:67], s57 offen offset:0 lds
    buffer_load_dwordx4 v223, s[64:67], s57 offen offset:1024 lds
    buffer_load_dwordx4 v224, s[64:67], s57 offen offset:2048 lds
    buffer_load_dwordx4 v225, s[64:67], s57 offen offset:3072 lds
    s_add_u32 m0, s55, 49152
    s_lshl_b32 s57, s49, 12
    s_add_u32 s57, s57, s52
    buffer_load_dwordx4 v252, s[68:71], s57 offen offset:0 lds
    buffer_load_dwordx4 v253, s[68:71], s57 offen offset:1024 lds
    buffer_load_dwordx4 v254, s[68:71], s57 offen offset:2048 lds
    buffer_load_dwordx4 v255, s[68:71], s57 offen offset:3072 lds
P2_entry:
    s_mov_b32 s24, s100
    v_and_b32 v8, 15, v0
    v_lshlrev_b32 v9, 7, v8
    v_add_u32 v9, s54, v9
    v_bfe_u32 v8, v0, 1, 3
    v_lshrrev_b32 v10, 4, v0
    v_xor_b32 v8, v8, v10
    v_lshl_add_u32 v218, v8, 4, v9
    v_xor_b32 v8, 4, v8
    v_lshl_add_u32 v219, v8, 4, v9
    v_lshlrev_b32 v8, 11, v10
    v_bfe_u32 v9, v0, 2, 2
    v_lshl_add_u32 v8, v9, 8, v8
    v_bfe_u32 v9, v0, 2, 3
    v_lshl_add_u32 v8, v9, 5, v8
    v_and_b32 v9, 3, v0
    v_lshl_add_u32 v8, v9, 3, v8
    v_add_u32 v228, 32768, v8
    v_xor_b32 v229, 32, v228
    v_xor_b32 v230, 64, v228
    v_xor_b32 v231, 96, v228
    v_xor_b32 v232, 128, v228
    v_xor_b32 v233, 160, v228
    v_xor_b32 v234, 192, v228
    v_xor_b32 v235, 224, v228
    s_cmp_eq_u32 s24, 0
    s_cselect_b32 s35, 0, 0x40000000
    ds_read_b128 a[140:143], v218 offset:0
    ds_read_b128 a[144:147], v218 offset:2048
    ds_read_b128 a[148:151], v218 offset:4096
    ds_read_b128 a[152:155], v218 offset:6144
    ds_read_b64_tr_b16 a[172:173], v228 offset:0
    ds_read_b64_tr_b16 a[174:175], v228 offset:1024
    ds_read_b64_tr_b16 a[176:177], v229 offset:0
    ds_read_b64_tr_b16 a[178:179], v229 offset:1024
    ds_read_b64_tr_b16 a[180:181], v230 offset:0
    ds_read_b64_tr_b16 a[182:183], v230 offset:1024
    ds_read_b64_tr_b16 a[184:185], v231 offset:0
    ds_read_b64_tr_b16 a[186:187], v231 offset:1024
    ds_read_b64_tr_b16 a[188:189], v232 offset:0
    ds_read_b64_tr_b16 a[190:191], v232 offset:1024
    ds_read_b64_tr_b16 a[192:193], v233 offset:0
    ds_read_b64_tr_b16 a[194:195], v233 offset:1024
    ds_read_b64_tr_b16 a[196:197], v234 offset:0
    ds_read_b64_tr_b16 a[198:199], v234 offset:1024
    ds_read_b64_tr_b16 a[200:201], v235 offset:0
    ds_read_b64_tr_b16 a[202:203], v235 offset:1024
    s_waitcnt lgkmcnt(8)
    v_mfma_f32_16x16x32_bf16 v[8:11], a[172:175], a[140:143], 0
    ds_read_b128 a[156:159], v219 offset:0
    buffer_load_dword v240, off, s[60:63], s35 sc1
    v_mfma_f32_16x16x32_bf16 v[40:43], a[172:175], a[144:147], 0
    s_add_u32 m0, s54, 81920
    s_add_u32 s49, s53, 256
    s_and_b32 s49, s49, 1023
    s_add_u32 s57, s46, s49
    ds_read_b128 a[160:163], v219 offset:2048
    v_mfma_f32_16x16x32_bf16 v[72:75], a[172:175], a[148:151], 0
    buffer_load_dwordx4 v222, s[64:67], s57 offen offset:0 lds
    v_add_u32 v216, 81920, v218
    v_mfma_f32_16x16x32_bf16 v[104:107], a[172:175], a[152:155], 0
    ds_read_b128 a[164:167], v219 offset:4096
    v_add_u32 v217, 81920, v219
    v_mfma_f32_16x16x32_bf16 v[12:15], a[176:179], a[140:143], 0
    ds_read_b128 a[168:171], v219 offset:6144
    s_mov_b32 s12, s76
    v_mfma_f32_16x16x32_bf16 v[44:47], a[176:179], a[144:147], 0
    buffer_load_dwordx4 v223, s[64:67], s57 offen offset:1024 lds
    s_and_b32 s13, s77, 0xffff
    v_mfma_f32_16x16x32_bf16 v[76:79], a[176:179], a[148:151], 0
    ds_read_b64_tr_b16 a[204:205], v228 offset:8192
    s_mov_b32 s14, 0x4400000
    v_mfma_f32_16x16x32_bf16 v[108:111], a[176:179], a[152:155], 0
    ds_read_b64_tr_b16 a[206:207], v228 offset:9216
    s_mov_b32 s15, 0x20000
    v_mfma_f32_16x16x32_bf16 v[16:19], a[180:183], a[140:143], 0
    buffer_load_dwordx4 v224, s[64:67], s57 offen offset:2048 lds
    s_lshl_b32 s36, s101, 8
    v_mfma_f32_16x16x32_bf16 v[48:51], a[180:183], a[144:147], 0
    ds_read_b64_tr_b16 a[208:209], v229 offset:8192
    s_add_u32 s36, s36, 0x3701000
    v_mfma_f32_16x16x32_bf16 v[80:83], a[180:183], a[148:151], 0
    ds_read_b64_tr_b16 a[210:211], v229 offset:9216
    s_add_u32 s36, s36, s35
    v_mfma_f32_16x16x32_bf16 v[112:115], a[180:183], a[152:155], 0
    buffer_load_dwordx4 v225, s[64:67], s57 offen offset:3072 lds
    s_add_u32 s29, s35, 0x3701000
    v_mfma_f32_16x16x32_bf16 v[20:23], a[184:187], a[140:143], 0
    s_add_u32 m0, s54, 86016
    ds_read_b64_tr_b16 a[212:213], v230 offset:8192
    v_min_u32 v237, 1, v0
    v_mfma_f32_16x16x32_bf16 v[52:55], a[184:187], a[144:147], 0
    s_add_u32 s57, s47, s49
    ds_read_b64_tr_b16 a[214:215], v230 offset:9216
    v_lshlrev_b32 v237, 29, v237
    v_mfma_f32_16x16x32_bf16 v[84:87], a[184:187], a[148:151], 0
    s_waitcnt lgkmcnt(10)
    buffer_load_dwordx4 v222, s[64:67], s57 offen offset:0 lds
    v_mov_b32 v238, 1
    v_mfma_f32_16x16x32_bf16 v[116:119], a[184:187], a[152:155], 0
    ds_read_b64_tr_b16 a[216:217], v231 offset:8192
    v_mfma_f32_16x16x32_bf16 v[24:27], a[188:191], a[140:143], 0
    ds_read_b64_tr_b16 a[218:219], v231 offset:9216
    v_mfma_f32_16x16x32_bf16 v[56:59], a[188:191], a[144:147], 0
    buffer_load_dwordx4 v223, s[64:67], s57 offen offset:1024 lds
    v_mfma_f32_16x16x32_bf16 v[88:91], a[188:191], a[148:151], 0
    ds_read_b64_tr_b16 a[220:221], v232 offset:8192
    v_mfma_f32_16x16x32_bf16 v[120:123], a[188:191], a[152:155], 0
    ds_read_b64_tr_b16 a[222:223], v232 offset:9216
    v_mfma_f32_16x16x32_bf16 v[28:31], a[192:195], a[140:143], 0
    buffer_load_dwordx4 v224, s[64:67], s57 offen offset:2048 lds
    v_mfma_f32_16x16x32_bf16 v[60:63], a[192:195], a[144:147], 0
    ds_read_b64_tr_b16 a[224:225], v233 offset:8192
    v_mfma_f32_16x16x32_bf16 v[92:95], a[192:195], a[148:151], 0
    ds_read_b64_tr_b16 a[226:227], v233 offset:9216
    v_mfma_f32_16x16x32_bf16 v[124:127], a[192:195], a[152:155], 0
    buffer_load_dwordx4 v225, s[64:67], s57 offen offset:3072 lds
    v_mfma_f32_16x16x32_bf16 v[32:35], a[196:199], a[140:143], 0
    s_add_u32 m0, s55, 65536
    ds_read_b64_tr_b16 a[228:229], v234 offset:8192
    v_mfma_f32_16x16x32_bf16 v[64:67], a[196:199], a[144:147], 0
    s_lshl_b32 s57, s49, 12
    s_add_u32 s57, s57, s52
    ds_read_b64_tr_b16 a[230:231], v234 offset:9216
    v_mfma_f32_16x16x32_bf16 v[96:99], a[196:199], a[148:151], 0
    buffer_load_dwordx4 v252, s[68:71], s57 offen offset:0 lds
    v_mfma_f32_16x16x32_bf16 v[128:131], a[196:199], a[152:155], 0
    ds_read_b64_tr_b16 a[232:233], v235 offset:8192
    v_mfma_f32_16x16x32_bf16 v[36:39], a[200:203], a[140:143], 0
    ds_read_b64_tr_b16 a[234:235], v235 offset:9216
    v_mfma_f32_16x16x32_bf16 v[68:71], a[200:203], a[144:147], 0
    buffer_load_dwordx4 v253, s[68:71], s57 offen offset:1024 lds
    v_mfma_f32_16x16x32_bf16 v[100:103], a[200:203], a[148:151], 0
    buffer_load_dwordx4 v254, s[68:71], s57 offen offset:2048 lds
    v_mfma_f32_16x16x32_bf16 v[132:135], a[200:203], a[152:155], 0
    s_waitcnt lgkmcnt(8)
    buffer_load_dwordx4 v255, s[68:71], s57 offen offset:3072 lds
    v_mfma_f32_16x16x32_bf16 v[8:11], a[204:207], a[156:159], v[8:11]
    s_waitcnt lgkmcnt(0)
    v_mfma_f32_16x16x32_bf16 v[40:43], a[204:207], a[160:163], v[40:43]
    s_waitcnt vmcnt(12)
    v_mfma_f32_16x16x32_bf16 v[72:75], a[204:207], a[164:167], v[72:75]
    s_barrier
    s_cmp_lg_u32 s24, 0
    s_cbranch_scc1 L2_noz
    s_mov_b32 s34, 0
SP_concat_1:
    v_readlane_b32 s27, v240, 0
    s_nop 0
    s_cmp_ge_u32 s27, 1
    s_cbranch_scc1 SD_concat_2
    s_add_u32 s34, s34, 1
    s_cmp_ge_u32 s34, 200000
    s_cbranch_scc1 SD_concat_2
    s_sleep 4
    buffer_load_dword v240, off, s[60:63], s35 sc1
    s_waitcnt vmcnt(0)
    s_branch SP_concat_1
SD_concat_2:
L2_noz:
    buffer_atomic_add v238, v237, s[12:15], s36 offen
    v_mfma_f32_16x16x32_bf16 v[104:107], a[204:207], a[168:171], v[104:107]
    s_add_u32 m0, s54, 0
    ds_read_b128 a[140:143], v216 offset:49152
    v_mfma_f32_16x16x32_bf16 v[12:15], a[208:211], a[156:159], v[12:15]
    s_add_u32 s49, s53, 384
    s_and_b32 s49, s49, 1023
    s_add_u32 s57, s46, s49
    ds_read_b128 a[144:147], v216 offset:51200
    v_mfma_f32_16x16x32_bf16 v[44:47], a[208:211], a[160:163], v[44:47]
    buffer_load_dwordx4 v222, s[64:67], s57 offen offset:0 lds
    v_mfma_f32_16x16x32_bf16 v[76:79], a[208:211], a[164:167], v[76:79]
    ds_read_b128 a[148:151], v216 offset:53248
    v_mfma_f32_16x16x32_bf16 v[108:111], a[208:211], a[168:171], v[108:111]
    ds_read_b128 a[152:155], v216 offset:55296
    v_mfma_f32_16x16x32_bf16 v[16:19], a[212:215], a[156:159], v[16:19]
    ds_read_b64_tr_b16 a[172:173], v228 offset:16384
    v_mfma_f32_16x16x32_bf16 v[48:51], a[212:215], a[160:163], v[48:51]
    buffer_load_dwordx4 v223, s[64:67], s57 offen offset:1024 lds
    v_mfma_f32_16x16x32_bf16 v[80:83], a[212:215], a[164:167], v[80:83]
    ds_read_b64_tr_b16 a[174:175], v228 offset:17408
    v_mfma_f32_16x16x32_bf16 v[112:115], a[212:215], a[168:171], v[112:115]
    ds_read_b64_tr_b16 a[176:177], v229 offset:16384
    v_mfma_f32_16x16x32_bf16 v[20:23], a[216:219], a[156:159], v[20:23]
    ds_read_b64_tr_b16 a[178:179], v229 offset:17408
    v_mfma_f32_16x16x32_bf16 v[52:55], a[216:219], a[160:163], v[52:55]
    buffer_load_dwordx4 v224, s[64:67], s57 offen offset:2048 lds
    v_mfma_f32_16x16x32_bf16 v[84:87], a[216:219], a[164:167], v[84:87]
    ds_read_b64_tr_b16 a[180:181], v230 offset:16384
    v_mfma_f32_16x16x32_bf16 v[116:119], a[216:219], a[168:171], v[116:119]
    ds_read_b64_tr_b16 a[182:183], v230 offset:17408
    v_mfma_f32_16x16x32_bf16 v[24:27], a[220:223], a[156:159], v[24:27]
    ds_read_b64_tr_b16 a[184:185], v231 offset:16384
    v_mfma_f32_16x16x32_bf16 v[56:59], a[220:223], a[160:163], v[56:59]
    buffer_load_dwordx4 v225, s[64:67], s57 offen offset:3072 lds
    v_mfma_f32_16x16x32_bf16 v[88:91], a[220:223], a[164:167], v[88:91]
    s_add_u32 m0, s54, 4096
    ds_read_b64_tr_b16 a[186:187], v231 offset:17408
    v_mfma_f32_16x16x32_bf16 v[120:123], a[220:223], a[168:171], v[120:123]
    s_add_u32 s57, s47, s49
    ds_read_b64_tr_b16 a[188:189], v232 offset:16384
    v_mfma_f32_16x16x32_bf16 v[28:31], a[224:227], a[156:159], v[28:31]
    ds_read_b64_tr_b16 a[190:191], v232 offset:17408
    v_mfma_f32_16x16x32_bf16 v[60:63], a[224:227], a[160:163], v[60:63]
    buffer_load_dwordx4 v222, s[64:67], s57 offen offset:0 lds
    v_mfma_f32_16x16x32_bf16 v[92:95], a[224:227], a[164:167], v[92:95]
    ds_read_b64_tr_b16 a[192:193], v233 offset:16384
    v_mfma_f32_16x16x32_bf16 v[124:127], a[224:227], a[168:171], v[124:127]
    ds_read_b64_tr_b16 a[194:195], v233 offset:17408
    v_mfma_f32_16x16x32_bf16 v[32:35], a[228:231], a[156:159], v[32:35]
    ds_read_b64_tr_b16 a[196:197], v234 offset:16384
    v_mfma_f32_16x16x32_bf16 v[64:67], a[228:231], a[160:163], v[64:67]
    buffer_load_dwordx4 v223, s[64:67], s57 offen offset:1024 lds
    v_mfma_f32_16x16x32_bf16 v[96:99], a[228:231], a[164:167], v[96:99]
    ds_read_b64_tr_b16 a[198:199], v234 offset:17408
    v_mfma_f32_16x16x32_bf16 v[128:131], a[228:231], a[168:171], v[128:131]
    ds_read_b64_tr_b16 a[200:201], v235 offset:16384
    v_mfma_f32_16x16x32_bf16 v[36:39], a[232:235], a[156:159], v[36:39]
    ds_read_b64_tr_b16 a[202:203], v235 offset:17408
    v_mfma_f32_16x16x32_bf16 v[68:71], a[232:235], a[160:163], v[68:71]
    v_mfma_f32_16x16x32_bf16 v[100:103], a[232:235], a[164:167], v[100:103]
    v_mfma_f32_16x16x32_bf16 v[132:135], a[232:235], a[168:171], v[132:135]
    s_waitcnt lgkmcnt(8)
    v_mfma_f32_16x16x32_bf16 v[8:11], a[172:175], a[140:143], v[8:11]
    ds_read_b128 a[156:159], v217 offset:49152
    s_and_b32 s25, s2, 6
    v_mfma_f32_16x16x32_bf16 v[40:43], a[172:175], a[144:147], v[40:43]
    ds_read_b128 a[160:163], v217 offset:51200
    s_lshl_b32 s25, s25, 2
    v_mfma_f32_16x16x32_bf16 v[72:75], a[172:175], a[148:151], v[72:75]
    ds_read_b128 a[164:167], v217 offset:53248
    s_bfe_u32 s27, s2, 0x30003
    v_mfma_f32_16x16x32_bf16 v[104:107], a[172:175], a[152:155], v[104:107]
    buffer_load_dwordx4 v224, s[64:67], s57 offen offset:2048 lds
    s_add_u32 s25, s25, s27
    v_mfma_f32_16x16x32_bf16 v[12:15], a[176:179], a[140:143], v[12:15]
    ds_read_b128 a[168:171], v217 offset:55296
    s_and_b32 s26, s2, 1
    v_mfma_f32_16x16x32_bf16 v[44:47], a[176:179], a[144:147], v[44:47]
    ds_read_b64_tr_b16 a[204:205], v228 offset:24576
    s_lshl_b32 s26, s26, 2
    v_mfma_f32_16x16x32_bf16 v[76:79], a[176:179], a[148:151], v[76:79]
    ds_read_b64_tr_b16 a[206:207], v228 offset:25600
    s_lshr_b32 s27, s2, 6
    v_mfma_f32_16x16x32_bf16 v[108:111], a[176:179], a[152:155], v[108:111]
    buffer_load_dwordx4 v225, s[64:67], s57 offen offset:3072 lds
    s_add_u32 s26, s26, s27
    v_mfma_f32_16x16x32_bf16 v[16:19], a[180:183], a[140:143], v[16:19]
    s_add_u32 m0, s55, 32768
    ds_read_b64_tr_b16 a[208:209], v229 offset:24576
    s_mov_b32 s4, s78
    v_mfma_f32_16x16x32_bf16 v[48:51], a[180:183], a[144:147], v[48:51]
    s_lshl_b32 s57, s49, 12
    ds_read_b64_tr_b16 a[210:211], v229 offset:25600
    s_and_b32 s5, s79, 0xffff
    v_mfma_f32_16x16x32_bf16 v[80:83], a[180:183], a[148:151], v[80:83]
    s_add_u32 s57, s57, s52
    ds_read_b64_tr_b16 a[212:213], v230 offset:24576
    s_mov_b32 s6, 0x4000
    v_mfma_f32_16x16x32_bf16 v[112:115], a[180:183], a[152:155], v[112:115]
    buffer_load_dwordx4 v252, s[68:71], s57 offen offset:0 lds
    s_mov_b32 s7, 0x20000
    v_mfma_f32_16x16x32_bf16 v[20:23], a[184:187], a[140:143], v[20:23]
    ds_read_b64_tr_b16 a[214:215], v230 offset:25600
    v_lshlrev_b32 v2, 4, v0
    v_mfma_f32_16x16x32_bf16 v[52:55], a[184:187], a[144:147], v[52:55]
    ds_read_b64_tr_b16 a[216:217], v231 offset:24576
    v_add_u32 v3, 4096, v2
    v_mfma_f32_16x16x32_bf16 v[84:87], a[184:187], a[148:151], v[84:87]
    s_waitcnt lgkmcnt(11)
    ds_read_b64_tr_b16 a[218:219], v231 offset:25600
    s_lshl_b32 s27, s24, 18
    v_mfma_f32_16x16x32_bf16 v[116:119], a[184:187], a[152:155], v[116:119]
    buffer_load_dwordx4 v253, s[68:71], s57 offen offset:1024 lds
    s_sub_u32 s27, 0xe0000, s27
    v_mfma_f32_16x16x32_bf16 v[24:27], a[188:191], a[140:143], v[24:27]
    ds_read_b64_tr_b16 a[220:221], v232 offset:24576
    v_add_u32 v4, s27, v2
    v_mfma_f32_16x16x32_bf16 v[56:59], a[188:191], a[144:147], v[56:59]
    ds_read_b64_tr_b16 a[222:223], v232 offset:25600
    s_mov_b64 s[50:51], 0
    v_mfma_f32_16x16x32_bf16 v[88:91], a[188:191], a[148:151], v[88:91]
    ds_read_b64_tr_b16 a[224:225], v233 offset:24576
    s_lshl_b32 s27, s25, 1
    v_mfma_f32_16x16x32_bf16 v[120:123], a[188:191], a[152:155], v[120:123]
    buffer_load_dwordx4 v254, s[68:71], s57 offen offset:2048 lds
    s_add_u32 s27, s27, 0
    v_mfma_f32_16x16x32_bf16 v[28:31], a[192:195], a[140:143], v[28:31]
    ds_read_b64_tr_b16 a[226:227], v233 offset:25600
    s_mul_i32 s27, s27, 52429
    v_mfma_f32_16x16x32_bf16 v[60:63], a[192:195], a[144:147], v[60:63]
    ds_read_b64_tr_b16 a[228:229], v234 offset:24576
    s_lshr_b32 s27, s27, 18
    v_mfma_f32_16x16x32_bf16 v[92:95], a[192:195], a[148:151], v[92:95]
    ds_read_b64_tr_b16 a[230:231], v234 offset:25600
    s_bitset1_b32 s50, s27
    v_mfma_f32_16x16x32_bf16 v[124:127], a[192:195], a[152:155], v[124:127]
    buffer_load_dwordx4 v255, s[68:71], s57 offen offset:3072 lds
    s_add_u32 s27, s27, 13
    v_mfma_f32_16x16x32_bf16 v[32:35], a[196:199], a[140:143], v[32:35]
    ds_read_b64_tr_b16 a[232:233], v235 offset:24576
    s_bitset1_b32 s50, s27
    v_mfma_f32_16x16x32_bf16 v[64:67], a[196:199], a[144:147], v[64:67]
    ds_read_b64_tr_b16 a[234:235], v235 offset:25600
    s_lshl_b32 s27, s25, 1
    v_mfma_f32_16x16x32_bf16 v[96:99], a[196:199], a[148:151], v[96:99]
    s_add_u32 s27, s27, 1
    s_mul_i32 s27, s27, 52429
    s_lshr_b32 s27, s27, 18
    v_mfma_f32_16x16x32_bf16 v[128:131], a[196:199], a[152:155], v[128:131]
    s_bitset1_b32 s50, s27
    s_add_u32 s27, s27, 13
    s_bitset1_b32 s50, s27
    v_mfma_f32_16x16x32_bf16 v[36:39], a[200:203], a[140:143], v[36:39]
    v_lshlrev_b32 v140, 8, v0
    v_mov_b32 v141, 0x20000000
    v_mfma_f32_16x16x32_bf16 v[68:71], a[200:203], a[144:147], v[68:71]
    v_cndmask_b32 v236, v141, v140, s[50:51]
    s_lshl_b32 s27, s25, 20
    v_mfma_f32_16x16x32_bf16 v[100:103], a[200:203], a[148:151], v[100:103]
    s_add_u32 s8, s76, s27
    s_addc_u32 s9, s77, 0
    s_and_b32 s9, s9, 0xffff
    v_mfma_f32_16x16x32_bf16 v[132:135], a[200:203], a[152:155], v[132:135]
    s_waitcnt lgkmcnt(8)
    s_sub_u32 s10, 16, s26
    s_lshl_b32 s10, s10, 16
    v_mfma_f32_16x16x32_bf16 v[8:11], a[204:207], a[156:159], v[8:11]
    s_waitcnt lgkmcnt(0)
    s_mov_b32 s11, 0x20000
    s_add_u32 s32, s26, 1
    v_mfma_f32_16x16x32_bf16 v[40:43], a[204:207], a[160:163], v[40:43]
    s_waitcnt vmcnt(13)
    s_lshl_b32 s32, s32, 16
    s_mov_b32 s16, 0xf0000
    v_mfma_f32_16x16x32_bf16 v[72:75], a[204:207], a[164:167], v[72:75]
    s_barrier
    s_mov_b32 s17, 0xfff00ff
    s_mov_b32 s18, 0x1f0001
    v_mfma_f32_16x16x32_bf16 v[104:107], a[204:207], a[168:171], v[104:107]
    s_add_u32 m0, s54, 131072
    ds_read_b128 a[140:143], v216 offset:0
    s_mov_b32 s19, 0x1fff01ff
    v_mfma_f32_16x16x32_bf16 v[12:15], a[208:211], a[156:159], v[12:15]
    s_add_u32 s49, s53, 512
    s_and_b32 s49, s49, 1023
    s_add_u32 s57, s46, s49
    ds_read_b128 a[144:147], v216 offset:2048
    v_mfma_f32_16x16x32_bf16 v[44:47], a[208:211], a[160:163], v[44:47]
    buffer_load_dwordx4 v222, s[64:67], s57 offen offset:0 lds
    s_mov_b32 s20, 0x3f0003
    v_mfma_f32_16x16x32_bf16 v[76:79], a[208:211], a[164:167], v[76:79]
    ds_read_b128 a[148:151], v216 offset:4096
    s_mov_b32 s21, 0x3fff03ff
    v_mfma_f32_16x16x32_bf16 v[108:111], a[208:211], a[168:171], v[108:111]
    ds_read_b128 a[152:155], v216 offset:6144
    s_mov_b32 s22, 0x7f0007
    v_mfma_f32_16x16x32_bf16 v[16:19], a[212:215], a[156:159], v[16:19]
    ds_read_b64_tr_b16 a[172:173], v228 offset:32768
    s_mov_b32 s23, 0x7fff07ff
    v_mfma_f32_16x16x32_bf16 v[48:51], a[212:215], a[160:163], v[48:51]
    buffer_load_dwordx4 v223, s[64:67], s57 offen offset:1024 lds
    s_mov_b32 s37, 0x3f800000
    v_mfma_f32_16x16x32_bf16 v[80:83], a[212:215], a[164:167], v[80:83]
    ds_read_b64_tr_b16 a[174:175], v228 offset:33792
    s_mov_b32 s43, 0x26800000
    v_mfma_f32_16x16x32_bf16 v[112:115], a[212:215], a[168:171], v[112:115]
    ds_read_b64_tr_b16 a[176:177], v229 offset:32768
    s_mov_b32 s58, 0x3fb8aa3b
    v_mfma_f32_16x16x32_bf16 v[20:23], a[216:219], a[156:159], v[20:23]
    ds_read_b64_tr_b16 a[178:179], v229 offset:33792
    v_mov_b32 v142, 0x3f803f80
    v_mfma_f32_16x16x32_bf16 v[52:55], a[216:219], a[160:163], v[52:55]
    buffer_load_dwordx4 v224, s[64:67], s57 offen offset:2048 lds
    v_mov_b32 v5, 0xf149f2ca
    v_mfma_f32_16x16x32_bf16 v[84:87], a[216:219], a[164:167], v[84:87]
    ds_read_b64_tr_b16 a[180:181], v230 offset:32768
    v_add_u32 v1, 0x10000, v2
    v_mfma_f32_16x16x32_bf16 v[116:119], a[216:219], a[168:171], v[116:119]
    ds_read_b64_tr_b16 a[182:183], v230 offset:33792
    v_accvgpr_write_b32 a128, v142
    v_mfma_f32_16x16x32_bf16 v[24:27], a[220:223], a[156:159], v[24:27]
    ds_read_b64_tr_b16 a[184:185], v231 offset:32768
    v_accvgpr_write_b32 a129, v142
    v_mfma_f32_16x16x32_bf16 v[56:59], a[220:223], a[160:163], v[56:59]
    buffer_load_dwordx4 v225, s[64:67], s57 offen offset:3072 lds
    v_accvgpr_write_b32 a130, v142
    v_mfma_f32_16x16x32_bf16 v[88:91], a[220:223], a[164:167], v[88:91]
    s_add_u32 m0, s54, 135168
    ds_read_b64_tr_b16 a[186:187], v231 offset:33792
    v_accvgpr_write_b32 a131, v142
    v_mfma_f32_16x16x32_bf16 v[120:123], a[220:223], a[168:171], v[120:123]
    s_add_u32 s57, s47, s49
    ds_read_b64_tr_b16 a[188:189], v232 offset:32768
    v_accvgpr_write_b32 a236, 0
    v_mfma_f32_16x16x32_bf16 v[28:31], a[224:227], a[156:159], v[28:31]
    ds_read_b64_tr_b16 a[190:191], v232 offset:33792
    v_accvgpr_write_b32 a237, 0
    v_mfma_f32_16x16x32_bf16 v[60:63], a[224:227], a[160:163], v[60:63]
    buffer_load_dwordx4 v222, s[64:67], s57 offen offset:0 lds
    v_accvgpr_write_b32 a238, 0
    v_mfma_f32_16x16x32_bf16 v[92:95], a[224:227], a[164:167], v[92:95]
    ds_read_b64_tr_b16 a[192:193], v233 offset:32768
    v_accvgpr_write_b32 a239, 0
    v_mfma_f32_16x16x32_bf16 v[124:127], a[224:227], a[168:171], v[124:127]
    ds_read_b64_tr_b16 a[194:195], v233 offset:33792
    s_mov_b32 s60, s72
    v_mfma_f32_16x16x32_bf16 v[32:35], a[228:231], a[156:159], v[32:35]
    ds_read_b64_tr_b16 a[196:197], v234 offset:32768
    s_and_b32 s61, s73, 0xffff
    v_mfma_f32_16x16x32_bf16 v[64:67], a[228:231], a[160:163], v[64:67]
    buffer_load_dwordx4 v223, s[64:67], s57 offen offset:1024 lds
    s_mov_b32 s62, 0x400000
    v_mfma_f32_16x16x32_bf16 v[96:99], a[228:231], a[164:167], v[96:99]
    ds_read_b64_tr_b16 a[198:199], v234 offset:33792
    s_mov_b32 s63, 0x20000
    v_mfma_f32_16x16x32_bf16 v[128:131], a[228:231], a[168:171], v[128:131]
    ds_read_b64_tr_b16 a[200:201], v235 offset:32768
    v_mfma_f32_16x16x32_bf16 v[36:39], a[232:235], a[156:159], v[36:39]
    ds_read_b64_tr_b16 a[202:203], v235 offset:33792
    v_mfma_f32_16x16x32_bf16 v[68:71], a[232:235], a[160:163], v[68:71]
    v_mfma_f32_16x16x32_bf16 v[100:103], a[232:235], a[164:167], v[100:103]
    v_mfma_f32_16x16x32_bf16 v[132:135], a[232:235], a[168:171], v[132:135]
    s_waitcnt lgkmcnt(8)
    v_mfma_f32_16x16x32_bf16 v[8:11], a[172:175], a[140:143], v[8:11]
    ds_read_b128 a[156:159], v217 offset:0
    v_mfma_f32_16x16x32_bf16 v[40:43], a[172:175], a[144:147], v[40:43]
    ds_read_b128 a[160:163], v217 offset:2048
    v_mfma_f32_16x16x32_bf16 v[72:75], a[172:175], a[148:151], v[72:75]
    ds_read_b128 a[164:167], v217 offset:4096
    v_mfma_f32_16x16x32_bf16 v[104:107], a[172:175], a[152:155], v[104:107]
    buffer_load_dwordx4 v224, s[64:67], s57 offen offset:2048 lds
    v_mfma_f32_16x16x32_bf16 v[12:15], a[176:179], a[140:143], v[12:15]
    ds_read_b128 a[168:171], v217 offset:6144
    v_mfma_f32_16x16x32_bf16 v[44:47], a[176:179], a[144:147], v[44:47]
    ds_read_b64_tr_b16 a[204:205], v228 offset:40960
    v_mfma_f32_16x16x32_bf16 v[76:79], a[176:179], a[148:151], v[76:79]
    ds_read_b64_tr_b16 a[206:207], v228 offset:41984
    v_mfma_f32_16x16x32_bf16 v[108:111], a[176:179], a[152:155], v[108:111]
    buffer_load_dwordx4 v225, s[64:67], s57 offen offset:3072 lds
    v_mfma_f32_16x16x32_bf16 v[16:19], a[180:183], a[140:143], v[16:19]
    s_add_u32 m0, s55, 49152
    ds_read_b64_tr_b16 a[208:209], v229 offset:40960
    v_mfma_f32_16x16x32_bf16 v[48:51], a[180:183], a[144:147], v[48:51]
    s_lshl_b32 s57, s49, 12
    ds_read_b64_tr_b16 a[210:211], v229 offset:41984
    v_mfma_f32_16x16x32_bf16 v[80:83], a[180:183], a[148:151], v[80:83]
    s_add_u32 s57, s57, s52
    ds_read_b64_tr_b16 a[212:213], v230 offset:40960
    v_mfma_f32_16x16x32_bf16 v[112:115], a[180:183], a[152:155], v[112:115]
    buffer_load_dwordx4 v252, s[68:71], s57 offen offset:0 lds
    v_mfma_f32_16x16x32_bf16 v[20:23], a[184:187], a[140:143], v[20:23]
    ds_read_b64_tr_b16 a[214:215], v230 offset:41984
    v_mfma_f32_16x16x32_bf16 v[52:55], a[184:187], a[144:147], v[52:55]
    ds_read_b64_tr_b16 a[216:217], v231 offset:40960
    v_mfma_f32_16x16x32_bf16 v[84:87], a[184:187], a[148:151], v[84:87]
    s_waitcnt lgkmcnt(11)
    ds_read_b64_tr_b16 a[218:219], v231 offset:41984
    v_mfma_f32_16x16x32_bf16 v[116:119], a[184:187], a[152:155], v[116:119]
    buffer_load_dwordx4 v253, s[68:71], s57 offen offset:1024 lds
    v_mfma_f32_16x16x32_bf16 v[24:27], a[188:191], a[140:143], v[24:27]
    ds_read_b64_tr_b16 a[220:221], v232 offset:40960
    v_mfma_f32_16x16x32_bf16 v[56:59], a[188:191], a[144:147], v[56:59]
    ds_read_b64_tr_b16 a[222:223], v232 offset:41984
    v_mfma_f32_16x16x32_bf16 v[88:91], a[188:191], a[148:151], v[88:91]
    ds_read_b64_tr_b16 a[224:225], v233 offset:40960
    v_mfma_f32_16x16x32_bf16 v[120:123], a[188:191], a[152:155], v[120:123]
    buffer_load_dwordx4 v254, s[68:71], s57 offen offset:2048 lds
    v_mfma_f32_16x16x32_bf16 v[28:31], a[192:195], a[140:143], v[28:31]
    ds_read_b64_tr_b16 a[226:227], v233 offset:41984
    v_mfma_f32_16x16x32_bf16 v[60:63], a[192:195], a[144:147], v[60:63]
    ds_read_b64_tr_b16 a[228:229], v234 offset:40960
    v_mfma_f32_16x16x32_bf16 v[92:95], a[192:195], a[148:151], v[92:95]
    ds_read_b64_tr_b16 a[230:231], v234 offset:41984
    v_mfma_f32_16x16x32_bf16 v[124:127], a[192:195], a[152:155], v[124:127]
    buffer_load_dwordx4 v255, s[68:71], s57 offen offset:3072 lds
    v_mfma_f32_16x16x32_bf16 v[32:35], a[196:199], a[140:143], v[32:35]
    ds_read_b64_tr_b16 a[232:233], v235 offset:40960
    v_mfma_f32_16x16x32_bf16 v[64:67], a[196:199], a[144:147], v[64:67]
    ds_read_b64_tr_b16 a[234:235], v235 offset:41984
    v_mfma_f32_16x16x32_bf16 v[96:99], a[196:199], a[148:151], v[96:99]
    v_mfma_f32_16x16x32_bf16 v[128:131], a[196:199], a[152:155], v[128:131]
    v_mfma_f32_16x16x32_bf16 v[36:39], a[200:203], a[140:143], v[36:39]
    v_mfma_f32_16x16x32_bf16 v[68:71], a[200:203], a[144:147], v[68:71]
    v_mfma_f32_16x16x32_bf16 v[100:103], a[200:203], a[148:151], v[100:103]
    v_mfma_f32_16x16x32_bf16 v[132:135], a[200:203], a[152:155], v[132:135]
    s_waitcnt lgkmcnt(8)
    v_mfma_f32_16x16x32_bf16 v[8:11], a[204:207], a[156:159], v[8:11]
    s_waitcnt lgkmcnt(0)
    v_mfma_f32_16x16x32_bf16 v[40:43], a[204:207], a[160:163], v[40:43]
    s_waitcnt vmcnt(12)
    v_mfma_f32_16x16x32_bf16 v[72:75], a[204:207], a[164:167], v[72:75]
    s_barrier
    v_mfma_f32_16x16x32_bf16 v[104:107], a[204:207], a[168:171], v[104:107]
    s_add_u32 m0, s54, 81920
    ds_read_b128 a[140:143], v218 offset:0
    v_mfma_f32_16x16x32_bf16 v[12:15], a[208:211], a[156:159], v[12:15]
    s_add_u32 s49, s53, 640
    s_and_b32 s49, s49, 1023
    s_add_u32 s57, s46, s49
    ds_read_b128 a[144:147], v218 offset:2048
    v_mfma_f32_16x16x32_bf16 v[44:47], a[208:211], a[160:163], v[44:47]
    buffer_load_dwordx4 v222, s[64:67], s57 offen offset:0 lds
    v_mfma_f32_16x16x32_bf16 v[76:79], a[208:211], a[164:167], v[76:79]
    ds_read_b128 a[148:151], v218 offset:4096
    v_mfma_f32_16x16x32_bf16 v[108:111], a[208:211], a[168:171], v[108:111]
    ds_read_b128 a[152:155], v218 offset:6144
    v_mfma_f32_16x16x32_bf16 v[16:19], a[212:215], a[156:159], v[16:19]
    ds_read_b64_tr_b16 a[172:173], v228 offset:0
    v_mfma_f32_16x16x32_bf16 v[48:51], a[212:215], a[160:163], v[48:51]
    buffer_load_dwordx4 v223, s[64:67], s57 offen offset:1024 lds
    v_mfma_f32_16x16x32_bf16 v[80:83], a[212:215], a[164:167], v[80:83]
    ds_read_b64_tr_b16 a[174:175], v228 offset:1024
    v_mfma_f32_16x16x32_bf16 v[112:115], a[212:215], a[168:171], v[112:115]
    ds_read_b64_tr_b16 a[176:177], v229 offset:0
    v_mfma_f32_16x16x32_bf16 v[20:23], a[216:219], a[156:159], v[20:23]
    ds_read_b64_tr_b16 a[178:179], v229 offset:1024
    v_mfma_f32_16x16x32_bf16 v[52:55], a[216:219], a[160:163], v[52:55]
    buffer_load_dwordx4 v224, s[64:67], s57 offen offset:2048 lds
    v_mfma_f32_16x16x32_bf16 v[84:87], a[216:219], a[164:167], v[84:87]
    ds_read_b64_tr_b16 a[180:181], v230 offset:0
    v_mfma_f32_16x16x32_bf16 v[116:119], a[216:219], a[168:171], v[116:119]
    ds_read_b64_tr_b16 a[182:183], v230 offset:1024
    v_mfma_f32_16x16x32_bf16 v[24:27], a[220:223], a[156:159], v[24:27]
    ds_read_b64_tr_b16 a[184:185], v231 offset:0
    v_mfma_f32_16x16x32_bf16 v[56:59], a[220:223], a[160:163], v[56:59]
    buffer_load_dwordx4 v225, s[64:67], s57 offen offset:3072 lds
    v_mfma_f32_16x16x32_bf16 v[88:91], a[220:223], a[164:167], v[88:91]
    s_add_u32 m0, s54, 86016
    ds_read_b64_tr_b16 a[186:187], v231 offset:1024
    v_mfma_f32_16x16x32_bf16 v[120:123], a[220:223], a[168:171], v[120:123]
    s_add_u32 s57, s47, s49
    ds_read_b64_tr_b16 a[188:189], v232 offset:0
    v_mfma_f32_16x16x32_bf16 v[28:31], a[224:227], a[156:159], v[28:31]
    ds_read_b64_tr_b16 a[190:191], v232 offset:1024
    v_mfma_f32_16x16x32_bf16 v[60:63], a[224:227], a[160:163], v[60:63]
    buffer_load_dwordx4 v222, s[64:67], s57 offen offset:0 lds
    v_mfma_f32_16x16x32_bf16 v[92:95], a[224:227], a[164:167], v[92:95]
    ds_read_b64_tr_b16 a[192:193], v233 offset:0
    v_mfma_f32_16x16x32_bf16 v[124:127], a[224:227], a[168:171], v[124:127]
    ds_read_b64_tr_b16 a[194:195], v233 offset:1024
    v_mfma_f32_16x16x32_bf16 v[32:35], a[228:231], a[156:159], v[32:35]
    ds_read_b64_tr_b16 a[196:197], v234 offset:0
    v_mfma_f32_16x16x32_bf16 v[64:67], a[228:231], a[160:163], v[64:67]
    buffer_load_dwordx4 v223, s[64:67], s57 offen offset:1024 lds
    v_mfma_f32_16x16x32_bf16 v[96:99], a[228:231], a[164:167], v[96:99]
    ds_read_b64_tr_b16 a[198:199], v234 offset:1024
    v_mfma_f32_16x16x32_bf16 v[128:131], a[228:231], a[168:171], v[128:131]
    ds_read_b64_tr_b16 a[200:201], v235 offset:0
    v_mfma_f32_16x16x32_bf16 v[36:39], a[232:235], a[156:159], v[36:39]
    ds_read_b64_tr_b16 a[202:203], v235 offset:1024
    v_mfma_f32_16x16x32_bf16 v[68:71], a[232:235], a[160:163], v[68:71]
    v_mfma_f32_16x16x32_bf16 v[100:103], a[232:235], a[164:167], v[100:103]
    v_mfma_f32_16x16x32_bf16 v[132:135], a[232:235], a[168:171], v[132:135]
    s_waitcnt lgkmcnt(8)
    v_mfma_f32_16x16x32_bf16 v[8:11], a[172:175], a[140:143], v[8:11]
    ds_read_b128 a[156:159], v219 offset:0
    v_mfma_f32_16x16x32_bf16 v[40:43], a[172:175], a[144:147], v[40:43]
    ds_read_b128 a[160:163], v219 offset:2048
    v_mfma_f32_16x16x32_bf16 v[72:75], a[172:175], a[148:151], v[72:75]
    ds_read_b128 a[164:167], v219 offset:4096
    v_mfma_f32_16x16x32_bf16 v[104:107], a[172:175], a[152:155], v[104:107]
    buffer_load_dwordx4 v224, s[64:67], s57 offen offset:2048 lds
    v_mfma_f32_16x16x32_bf16 v[12:15], a[176:179], a[140:143], v[12:15]
    ds_read_b128 a[168:171], v219 offset:6144
    v_mfma_f32_16x16x32_bf16 v[44:47], a[176:179], a[144:147], v[44:47]
    ds_read_b64_tr_b16 a[204:205], v228 offset:8192
    v_mfma_f32_16x16x32_bf16 v[76:79], a[176:179], a[148:151], v[76:79]
    ds_read_b64_tr_b16 a[206:207], v228 offset:9216
    v_mfma_f32_16x16x32_bf16 v[108:111], a[176:179], a[152:155], v[108:111]
    buffer_load_dwordx4 v225, s[64:67], s57 offen offset:3072 lds
    v_mfma_f32_16x16x32_bf16 v[16:19], a[180:183], a[140:143], v[16:19]
    s_add_u32 m0, s55, 65536
    ds_read_b64_tr_b16 a[208:209], v229 offset:8192
    v_mfma_f32_16x16x32_bf16 v[48:51], a[180:183], a[144:147], v[48:51]
    s_lshl_b32 s57, s49, 12
    ds_read_b64_tr_b16 a[210:211], v229 offset:9216
    v_mfma_f32_16x16x32_bf16 v[80:83], a[180:183], a[148:151], v[80:83]
    s_add_u32 s57, s57, s52
    ds_read_b64_tr_b16 a[212:213], v230 offset:8192
    v_mfma_f32_16x16x32_bf16 v[112:115], a[180:183], a[152:155], v[112:115]
    buffer_load_dwordx4 v252, s[68:71], s57 offen offset:0 lds
    v_mfma_f32_16x16x32_bf16 v[20:23], a[184:187], a[140:143], v[20:23]
    ds_read_b64_tr_b16 a[214:215], v230 offset:9216
    v_mfma_f32_16x16x32_bf16 v[52:55], a[184:187], a[144:147], v[52:55]
    ds_read_b64_tr_b16 a[216:217], v231 offset:8192
    v_mfma_f32_16x16x32_bf16 v[84:87], a[184:187], a[148:151], v[84:87]
    s_waitcnt lgkmcnt(11)
    ds_read_b64_tr_b16 a[218:219], v231 offset:9216
    v_mfma_f32_16x16x32_bf16 v[116:119], a[184:187], a[152:155], v[116:119]
    buffer_load_dwordx4 v253, s[68:71], s57 offen offset:1024 lds
    v_mfma_f32_16x16x32_bf16 v[24:27], a[188:191], a[140:143], v[24:27]
    ds_read_b64_tr_b16 a[220:221], v232 offset:8192
    v_mfma_f32_16x16x32_bf16 v[56:59], a[188:191], a[144:147], v[56:59]
    ds_read_b64_tr_b16 a[222:223], v232 offset:9216
    v_mfma_f32_16x16x32_bf16 v[88:91], a[188:191], a[148:151], v[88:91]
    ds_read_b64_tr_b16 a[224:225], v233 offset:8192
    v_mfma_f32_16x16x32_bf16 v[120:123], a[188:191], a[152:155], v[120:123]
    buffer_load_dwordx4 v254, s[68:71], s57 offen offset:2048 lds
    v_mfma_f32_16x16x32_bf16 v[28:31], a[192:195], a[140:143], v[28:31]
    ds_read_b64_tr_b16 a[226:227], v233 offset:9216
    v_mfma_f32_16x16x32_bf16 v[60:63], a[192:195], a[144:147], v[60:63]
    ds_read_b64_tr_b16 a[228:229], v234 offset:8192
    v_mfma_f32_16x16x32_bf16 v[92:95], a[192:195], a[148:151], v[92:95]
    ds_read_b64_tr_b16 a[230:231], v234 offset:9216
    v_mfma_f32_16x16x32_bf16 v[124:127], a[192:195], a[152:155], v[124:127]
    buffer_load_dwordx4 v255, s[68:71], s57 offen offset:3072 lds
    v_mfma_f32_16x16x32_bf16 v[32:35], a[196:199], a[140:143], v[32:35]
    ds_read_b64_tr_b16 a[232:233], v235 offset:8192
    v_mfma_f32_16x16x32_bf16 v[64:67], a[196:199], a[144:147], v[64:67]
    ds_read_b64_tr_b16 a[234:235], v235 offset:9216
    v_mfma_f32_16x16x32_bf16 v[96:99], a[196:199], a[148:151], v[96:99]
    v_mfma_f32_16x16x32_bf16 v[128:131], a[196:199], a[152:155], v[128:131]
    v_mfma_f32_16x16x32_bf16 v[36:39], a[200:203], a[140:143], v[36:39]
    v_mfma_f32_16x16x32_bf16 v[68:71], a[200:203], a[144:147], v[68:71]
    v_mfma_f32_16x16x32_bf16 v[100:103], a[200:203], a[148:151], v[100:103]
    v_mfma_f32_16x16x32_bf16 v[132:135], a[200:203], a[152:155], v[132:135]
    s_waitcnt lgkmcnt(8)
    v_mfma_f32_16x16x32_bf16 v[8:11], a[204:207], a[156:159], v[8:11]
    s_waitcnt lgkmcnt(0)
    v_mfma_f32_16x16x32_bf16 v[40:43], a[204:207], a[160:163], v[40:43]
    s_waitcnt vmcnt(12)
    v_mfma_f32_16x16x32_bf16 v[72:75], a[204:207], a[164:167], v[72:75]
    s_barrier
    v_mfma_f32_16x16x32_bf16 v[104:107], a[204:207], a[168:171], v[104:107]
    s_add_u32 m0, s54, 0
    ds_read_b128 a[140:143], v216 offset:49152
    v_mfma_f32_16x16x32_bf16 v[12:15], a[208:211], a[156:159], v[12:15]
    s_add_u32 s49, s53, 768
    s_and_b32 s49, s49, 1023
    s_add_u32 s57, s46, s49
    ds_read_b128 a[144:147], v216 offset:51200
    v_mfma_f32_16x16x32_bf16 v[44:47], a[208:211], a[160:163], v[44:47]
    buffer_load_dwordx4 v222, s[64:67], s57 offen offset:0 lds
    v_mfma_f32_16x16x32_bf16 v[76:79], a[208:211], a[164:167], v[76:79]
    ds_read_b128 a[148:151], v216 offset:53248
    v_mfma_f32_16x16x32_bf16 v[108:111], a[208:211], a[168:171], v[108:111]
    ds_read_b128 a[152:155], v216 offset:55296
    v_mfma_f32_16x16x32_bf16 v[16:19], a[212:215], a[156:159], v[16:19]
    ds_read_b64_tr_b16 a[172:173], v228 offset:16384
    v_mfma_f32_16x16x32_bf16 v[48:51], a[212:215], a[160:163], v[48:51]
    buffer_load_dwordx4 v223, s[64:67], s57 offen offset:1024 lds
    v_mfma_f32_16x16x32_bf16 v[80:83], a[212:215], a[164:167], v[80:83]
    ds_read_b64_tr_b16 a[174:175], v228 offset:17408
    v_mfma_f32_16x16x32_bf16 v[112:115], a[212:215], a[168:171], v[112:115]
    ds_read_b64_tr_b16 a[176:177], v229 offset:16384
    v_mfma_f32_16x16x32_bf16 v[20:23], a[216:219], a[156:159], v[20:23]
    ds_read_b64_tr_b16 a[178:179], v229 offset:17408
    v_mfma_f32_16x16x32_bf16 v[52:55], a[216:219], a[160:163], v[52:55]
    buffer_load_dwordx4 v224, s[64:67], s57 offen offset:2048 lds
    v_mfma_f32_16x16x32_bf16 v[84:87], a[216:219], a[164:167], v[84:87]
    ds_read_b64_tr_b16 a[180:181], v230 offset:16384
    v_mfma_f32_16x16x32_bf16 v[116:119], a[216:219], a[168:171], v[116:119]
    ds_read_b64_tr_b16 a[182:183], v230 offset:17408
    v_mfma_f32_16x16x32_bf16 v[24:27], a[220:223], a[156:159], v[24:27]
    ds_read_b64_tr_b16 a[184:185], v231 offset:16384
    v_mfma_f32_16x16x32_bf16 v[56:59], a[220:223], a[160:163], v[56:59]
    buffer_load_dwordx4 v225, s[64:67], s57 offen offset:3072 lds
    v_mfma_f32_16x16x32_bf16 v[88:91], a[220:223], a[164:167], v[88:91]
    s_add_u32 m0, s54, 4096
    ds_read_b64_tr_b16 a[186:187], v231 offset:17408
    v_mfma_f32_16x16x32_bf16 v[120:123], a[220:223], a[168:171], v[120:123]
    s_add_u32 s57, s47, s49
    ds_read_b64_tr_b16 a[188:189], v232 offset:16384
    v_mfma_f32_16x16x32_bf16 v[28:31], a[224:227], a[156:159], v[28:31]
    ds_read_b64_tr_b16 a[190:191], v232 offset:17408
    v_mfma_f32_16x16x32_bf16 v[60:63], a[224:227], a[160:163], v[60:63]
    buffer_load_dwordx4 v222, s[64:67], s57 offen offset:0 lds
    v_mfma_f32_16x16x32_bf16 v[92:95], a[224:227], a[164:167], v[92:95]
    ds_read_b64_tr_b16 a[192:193], v233 offset:16384
    v_mfma_f32_16x16x32_bf16 v[124:127], a[224:227], a[168:171], v[124:127]
    ds_read_b64_tr_b16 a[194:195], v233 offset:17408
    v_mfma_f32_16x16x32_bf16 v[32:35], a[228:231], a[156:159], v[32:35]
    ds_read_b64_tr_b16 a[196:197], v234 offset:16384
    v_mfma_f32_16x16x32_bf16 v[64:67], a[228:231], a[160:163], v[64:67]
    buffer_load_dwordx4 v223, s[64:67], s57 offen offset:1024 lds
    v_mfma_f32_16x16x32_bf16 v[96:99], a[228:231], a[164:167], v[96:99]
    ds_read_b64_tr_b16 a[198:199], v234 offset:17408
    v_mfma_f32_16x16x32_bf16 v[128:131], a[228:231], a[168:171], v[128:131]
    ds_read_b64_tr_b16 a[200:201], v235 offset:16384
    v_mfma_f32_16x16x32_bf16 v[36:39], a[232:235], a[156:159], v[36:39]
    ds_read_b64_tr_b16 a[202:203], v235 offset:17408
    v_mfma_f32_16x16x32_bf16 v[68:71], a[232:235], a[160:163], v[68:71]
    v_mfma_f32_16x16x32_bf16 v[100:103], a[232:235], a[164:167], v[100:103]
    v_mfma_f32_16x16x32_bf16 v[132:135], a[232:235], a[168:171], v[132:135]
    s_waitcnt lgkmcnt(8)
    v_mfma_f32_16x16x32_bf16 v[8:11], a[172:175], a[140:143], v[8:11]
    ds_read_b128 a[156:159], v217 offset:49152
    v_mfma_f32_16x16x32_bf16 v[40:43], a[172:175], a[144:147], v[40:43]
    ds_read_b128 a[160:163], v217 offset:51200
    v_mfma_f32_16x16x32_bf16 v[72:75], a[172:175], a[148:151], v[72:75]
    ds_read_b128 a[164:167], v217 offset:53248
    v_mfma_f32_16x16x32_bf16 v[104:107], a[172:175], a[152:155], v[104:107]
    buffer_load_dwordx4 v224, s[64:67], s57 offen offset:2048 lds
    v_mfma_f32_16x16x32_bf16 v[12:15], a[176:179], a[140:143], v[12:15]
    ds_read_b128 a[168:171], v217 offset:55296
    v_mfma_f32_16x16x32_bf16 v[44:47], a[176:179], a[144:147], v[44:47]
    ds_read_b64_tr_b16 a[204:205], v228 offset:24576
    v_mfma_f32_16x16x32_bf16 v[76:79], a[176:179], a[148:151], v[76:79]
    ds_read_b64_tr_b16 a[206:207], v228 offset:25600
    v_mfma_f32_16x16x32_bf16 v[108:111], a[176:179], a[152:155], v[108:111]
    buffer_load_dwordx4 v225, s[64:67], s57 offen offset:3072 lds
    v_mfma_f32_16x16x32_bf16 v[16:19], a[180:183], a[140:143], v[16:19]
    s_add_u32 m0, s55, 32768
    ds_read_b64_tr_b16 a[208:209], v229 offset:24576
    v_mfma_f32_16x16x32_bf16 v[48:51], a[180:183], a[144:147], v[48:51]
    s_lshl_b32 s57, s49, 12
    ds_read_b64_tr_b16 a[210:211], v229 offset:25600
    v_mfma_f32_16x16x32_bf16 v[80:83], a[180:183], a[148:151], v[80:83]
    s_add_u32 s57, s57, s52
    ds_read_b64_tr_b16 a[212:213], v230 offset:24576
    v_mfma_f32_16x16x32_bf16 v[112:115], a[180:183], a[152:155], v[112:115]
    buffer_load_dwordx4 v252, s[68:71], s57 offen offset:0 lds
    v_mfma_f32_16x16x32_bf16 v[20:23], a[184:187], a[140:143], v[20:23]
    ds_read_b64_tr_b16 a[214:215], v230 offset:25600
    v_mfma_f32_16x16x32_bf16 v[52:55], a[184:187], a[144:147], v[52:55]
    ds_read_b64_tr_b16 a[216:217], v231 offset:24576
    v_mfma_f32_16x16x32_bf16 v[84:87], a[184:187], a[148:151], v[84:87]
    s_waitcnt lgkmcnt(11)
    ds_read_b64_tr_b16 a[218:219], v231 offset:25600
    v_mfma_f32_16x16x32_bf16 v[116:119], a[184:187], a[152:155], v[116:119]
    buffer_load_dwordx4 v253, s[68:71], s57 offen offset:1024 lds
    v_mfma_f32_16x16x32_bf16 v[24:27], a[188:191], a[140:143], v[24:27]
    ds_read_b64_tr_b16 a[220:221], v232 offset:24576
    v_mfma_f32_16x16x32_bf16 v[56:59], a[188:191], a[144:147], v[56:59]
    ds_read_b64_tr_b16 a[222:223], v232 offset:25600
    v_mfma_f32_16x16x32_bf16 v[88:91], a[188:191], a[148:151], v[88:91]
    ds_read_b64_tr_b16 a[224:225], v233 offset:24576
    v_mfma_f32_16x16x32_bf16 v[120:123], a[188:191], a[152:155], v[120:123]
    buffer_load_dwordx4 v254, s[68:71], s57 offen offset:2048 lds
    v_mfma_f32_16x16x32_bf16 v[28:31], a[192:195], a[140:143], v[28:31]
    ds_read_b64_tr_b16 a[226:227], v233 offset:25600
    v_mfma_f32_16x16x32_bf16 v[60:63], a[192:195], a[144:147], v[60:63]
    ds_read_b64_tr_b16 a[228:229], v234 offset:24576
    v_mfma_f32_16x16x32_bf16 v[92:95], a[192:195], a[148:151], v[92:95]
    ds_read_b64_tr_b16 a[230:231], v234 offset:25600
    v_mfma_f32_16x16x32_bf16 v[124:127], a[192:195], a[152:155], v[124:127]
    buffer_load_dwordx4 v255, s[68:71], s57 offen offset:3072 lds
    v_mfma_f32_16x16x32_bf16 v[32:35], a[196:199], a[140:143], v[32:35]
    ds_read_b64_tr_b16 a[232:233], v235 offset:24576
    v_mfma_f32_16x16x32_bf16 v[64:67], a[196:199], a[144:147], v[64:67]
    ds_read_b64_tr_b16 a[234:235], v235 offset:25600
    v_mfma_f32_16x16x32_bf16 v[96:99], a[196:199], a[148:151], v[96:99]
    v_mfma_f32_16x16x32_bf16 v[128:131], a[196:199], a[152:155], v[128:131]
    v_mfma_f32_16x16x32_bf16 v[36:39], a[200:203], a[140:143], v[36:39]
    v_mfma_f32_16x16x32_bf16 v[68:71], a[200:203], a[144:147], v[68:71]
    v_mfma_f32_16x16x32_bf16 v[100:103], a[200:203], a[148:151], v[100:103]
    v_mfma_f32_16x16x32_bf16 v[132:135], a[200:203], a[152:155], v[132:135]
    s_waitcnt lgkmcnt(8)
    v_mfma_f32_16x16x32_bf16 v[8:11], a[204:207], a[156:159], v[8:11]
    s_waitcnt lgkmcnt(0)
    v_mfma_f32_16x16x32_bf16 v[40:43], a[204:207], a[160:163], v[40:43]
    s_waitcnt vmcnt(12)
    v_mfma_f32_16x16x32_bf16 v[72:75], a[204:207], a[164:167], v[72:75]
    s_barrier
    v_mfma_f32_16x16x32_bf16 v[104:107], a[204:207], a[168:171], v[104:107]
    ds_read_b128 a[140:143], v216 offset:0
    v_mfma_f32_16x16x32_bf16 v[12:15], a[208:211], a[156:159], v[12:15]
    ds_read_b128 a[144:147], v216 offset:2048
    v_mfma_f32_16x16x32_bf16 v[44:47], a[208:211], a[160:163], v[44:47]
    buffer_load_dword v239, v236, s[12:15], s29 offen sc1
    v_mfma_f32_16x16x32_bf16 v[76:79], a[208:211], a[164:167], v[76:79]
    s_add_u32 m0, s54, 131072
    ds_read_b128 a[148:151], v216 offset:4096
    v_mfma_f32_16x16x32_bf16 v[108:111], a[208:211], a[168:171], v[108:111]
    s_add_u32 s49, s53, 896
    ds_read_b128 a[152:155], v216 offset:6144
    v_mfma_f32_16x16x32_bf16 v[16:19], a[212:215], a[156:159], v[16:19]
    s_and_b32 s49, s49, 1023
    s_add_u32 s57, s46, s49
    ds_read_b64_tr_b16 a[172:173], v228 offset:32768
    v_mfma_f32_16x16x32_bf16 v[48:51], a[212:215], a[160:163], v[48:51]
    buffer_load_dwordx4 v222, s[64:67], s57 offen offset:0 lds
    v_mfma_f32_16x16x32_bf16 v[80:83], a[212:215], a[164:167], v[80:83]
    ds_read_b64_tr_b16 a[174:175], v228 offset:33792
    v_mfma_f32_16x16x32_bf16 v[112:115], a[212:215], a[168:171], v[112:115]
    ds_read_b64_tr_b16 a[176:177], v229 offset:32768
    v_mfma_f32_16x16x32_bf16 v[20:23], a[216:219], a[156:159], v[20:23]
    ds_read_b64_tr_b16 a[178:179], v229 offset:33792
    v_mfma_f32_16x16x32_bf16 v[52:55], a[216:219], a[160:163], v[52:55]
    buffer_load_dwordx4 v223, s[64:67], s57 offen offset:1024 lds
    v_mfma_f32_16x16x32_bf16 v[84:87], a[216:219], a[164:167], v[84:87]
    ds_read_b64_tr_b16 a[180:181], v230 offset:32768
    v_mfma_f32_16x16x32_bf16 v[116:119], a[216:219], a[168:171], v[116:119]
    ds_read_b64_tr_b16 a[182:183], v230 offset:33792
    v_mfma_f32_16x16x32_bf16 v[24:27], a[220:223], a[156:159], v[24:27]
    ds_read_b64_tr_b16 a[184:185], v231 offset:32768
    v_mfma_f32_16x16x32_bf16 v[56:59], a[220:223], a[160:163], v[56:59]
    buffer_load_dwordx4 v224, s[64:67], s57 offen offset:2048 lds
    v_mfma_f32_16x16x32_bf16 v[88:91], a[220:223], a[164:167], v[88:91]
    ds_read_b64_tr_b16 a[186:187], v231 offset:33792
    v_mfma_f32_16x16x32_bf16 v[120:123], a[220:223], a[168:171], v[120:123]
    ds_read_b64_tr_b16 a[188:189], v232 offset:32768
    v_mfma_f32_16x16x32_bf16 v[28:31], a[224:227], a[156:159], v[28:31]
    ds_read_b64_tr_b16 a[190:191], v232 offset:33792
    v_mfma_f32_16x16x32_bf16 v[60:63], a[224:227], a[160:163], v[60:63]
    buffer_load_dwordx4 v225, s[64:67], s57 offen offset:3072 lds
    v_mfma_f32_16x16x32_bf16 v[92:95], a[224:227], a[164:167], v[92:95]
    s_add_u32 m0, s54, 135168
    ds_read_b64_tr_b16 a[192:193], v233 offset:32768
    v_mfma_f32_16x16x32_bf16 v[124:127], a[224:227], a[168:171], v[124:127]
    s_add_u32 s57, s47, s49
    ds_read_b64_tr_b16 a[194:195], v233 offset:33792
    v_mfma_f32_16x16x32_bf16 v[32:35], a[228:231], a[156:159], v[32:35]
    ds_read_b64_tr_b16 a[196:197], v234 offset:32768
    v_mfma_f32_16x16x32_bf16 v[64:67], a[228:231], a[160:163], v[64:67]
    buffer_load_dwordx4 v222, s[64:67], s57 offen offset:0 lds
    v_mfma_f32_16x16x32_bf16 v[96:99], a[228:231], a[164:167], v[96:99]
    ds_read_b64_tr_b16 a[198:199], v234 offset:33792
    v_mfma_f32_16x16x32_bf16 v[128:131], a[228:231], a[168:171], v[128:131]
    ds_read_b64_tr_b16 a[200:201], v235 offset:32768
    v_mfma_f32_16x16x32_bf16 v[36:39], a[232:235], a[156:159], v[36:39]
    ds_read_b64_tr_b16 a[202:203], v235 offset:33792
    v_mfma_f32_16x16x32_bf16 v[68:71], a[232:235], a[160:163], v[68:71]
    v_mfma_f32_16x16x32_bf16 v[100:103], a[232:235], a[164:167], v[100:103]
    v_mfma_f32_16x16x32_bf16 v[132:135], a[232:235], a[168:171], v[132:135]
    s_waitcnt lgkmcnt(8)
    v_mfma_f32_16x16x32_bf16 v[8:11], a[172:175], a[140:143], v[8:11]
    ds_read_b128 a[156:159], v217 offset:0
    v_mfma_f32_16x16x32_bf16 v[40:43], a[172:175], a[144:147], v[40:43]
    ds_read_b128 a[160:163], v217 offset:2048
    v_mfma_f32_16x16x32_bf16 v[72:75], a[172:175], a[148:151], v[72:75]
    ds_read_b128 a[164:167], v217 offset:4096
    v_mfma_f32_16x16x32_bf16 v[104:107], a[172:175], a[152:155], v[104:107]
    buffer_load_dwordx4 v223, s[64:67], s57 offen offset:1024 lds
    v_mfma_f32_16x16x32_bf16 v[12:15], a[176:179], a[140:143], v[12:15]
    ds_read_b128 a[168:171], v217 offset:6144
    v_mfma_f32_16x16x32_bf16 v[44:47], a[176:179], a[144:147], v[44:47]
    ds_read_b64_tr_b16 a[204:205], v228 offset:40960
    v_mfma_f32_16x16x32_bf16 v[76:79], a[176:179], a[148:151], v[76:79]
    ds_read_b64_tr_b16 a[206:207], v228 offset:41984
    v_mfma_f32_16x16x32_bf16 v[108:111], a[176:179], a[152:155], v[108:111]
    buffer_load_dwordx4 v224, s[64:67], s57 offen offset:2048 lds
    v_mfma_f32_16x16x32_bf16 v[16:19], a[180:183], a[140:143], v[16:19]
    ds_read_b64_tr_b16 a[208:209], v229 offset:40960
    v_mfma_f32_16x16x32_bf16 v[48:51], a[180:183], a[144:147], v[48:51]
    ds_read_b64_tr_b16 a[210:211], v229 offset:41984
    v_mfma_f32_16x16x32_bf16 v[80:83], a[180:183], a[148:151], v[80:83]
    ds_read_b64_tr_b16 a[212:213], v230 offset:40960
    v_mfma_f32_16x16x32_bf16 v[112:115], a[180:183], a[152:155], v[112:115]
    buffer_load_dwordx4 v225, s[64:67], s57 offen offset:3072 lds
    v_mfma_f32_16x16x32_bf16 v[20:23], a[184:187], a[140:143], v[20:23]
    ds_read_b64_tr_b16 a[214:215], v230 offset:41984
    v_mfma_f32_16x16x32_bf16 v[52:55], a[184:187], a[144:147], v[52:55]
    ds_read_b64_tr_b16 a[216:217], v231 offset:40960
    v_mfma_f32_16x16x32_bf16 v[84:87], a[184:187], a[148:151], v[84:87]
    s_waitcnt lgkmcnt(11)
    ds_read_b64_tr_b16 a[218:219], v231 offset:41984
    v_mfma_f32_16x16x32_bf16 v[116:119], a[184:187], a[152:155], v[116:119]
    v_mfma_f32_16x16x32_bf16 v[24:27], a[188:191], a[140:143], v[24:27]
    ds_read_b64_tr_b16 a[220:221], v232 offset:40960
    v_mfma_f32_16x16x32_bf16 v[56:59], a[188:191], a[144:147], v[56:59]
    ds_read_b64_tr_b16 a[222:223], v232 offset:41984
    v_mfma_f32_16x16x32_bf16 v[88:91], a[188:191], a[148:151], v[88:91]
    ds_read_b64_tr_b16 a[224:225], v233 offset:40960
    v_mfma_f32_16x16x32_bf16 v[120:123], a[188:191], a[152:155], v[120:123]
    v_mfma_f32_16x16x32_bf16 v[28:31], a[192:195], a[140:143], v[28:31]
    ds_read_b64_tr_b16 a[226:227], v233 offset:41984
    v_mfma_f32_16x16x32_bf16 v[60:63], a[192:195], a[144:147], v[60:63]
    ds_read_b64_tr_b16 a[228:229], v234 offset:40960
    v_mfma_f32_16x16x32_bf16 v[92:95], a[192:195], a[148:151], v[92:95]
    ds_read_b64_tr_b16 a[230:231], v234 offset:41984
    v_mfma_f32_16x16x32_bf16 v[124:127], a[192:195], a[152:155], v[124:127]
    v_mfma_f32_16x16x32_bf16 v[32:35], a[196:199], a[140:143], v[32:35]
    ds_read_b64_tr_b16 a[232:233], v235 offset:40960
    v_mfma_f32_16x16x32_bf16 v[64:67], a[196:199], a[144:147], v[64:67]
    ds_read_b64_tr_b16 a[234:235], v235 offset:41984
    v_mfma_f32_16x16x32_bf16 v[96:99], a[196:199], a[148:151], v[96:99]
    v_mfma_f32_16x16x32_bf16 v[128:131], a[196:199], a[152:155], v[128:131]
    v_mfma_f32_16x16x32_bf16 v[36:39], a[200:203], a[140:143], v[36:39]
    v_mfma_f32_16x16x32_bf16 v[68:71], a[200:203], a[144:147], v[68:71]
    v_mfma_f32_16x16x32_bf16 v[100:103], a[200:203], a[148:151], v[100:103]
    v_mfma_f32_16x16x32_bf16 v[132:135], a[200:203], a[152:155], v[132:135]
    s_waitcnt lgkmcnt(8)
    v_mfma_f32_16x16x32_bf16 v[8:11], a[204:207], a[156:159], v[8:11]
    s_waitcnt lgkmcnt(0)
    v_mfma_f32_16x16x32_bf16 v[40:43], a[204:207], a[160:163], v[40:43]
    s_waitcnt vmcnt(8)
    s_cmp_lg_u32 s24, 0
    s_cbranch_scc1 L2_nopoll
    s_mov_b32 s34, 0
SP_concat_3:
    v_cmp_gt_u32 vcc, 8, v239
    s_nop 3
    s_and_b64 vcc, vcc, s[50:51]
    s_cbranch_scc0 SD_concat_4
    s_add_u32 s34, s34, 1
    s_cmp_ge_u32 s34, 200000
    s_cbranch_scc1 SD_concat_4
    s_sleep 4
    buffer_load_dword v239, v236, s[12:15], s29 offen sc1
    s_waitcnt vmcnt(0)
    s_branch SP_concat_3
SD_concat_4:
L2_nopoll:
    v_mfma_f32_16x16x32_bf16 v[72:75], a[204:207], a[164:167], v[72:75]
    s_barrier
    v_mfma_f32_16x16x32_bf16 v[104:107], a[204:207], a[168:171], v[104:107]
    s_add_u32 m0, s55, 65536
    ds_read_b128 a[140:143], v218 offset:0
    v_mfma_f32_16x16x32_bf16 v[12:15], a[208:211], a[156:159], v[12:15]
    s_lshl_b32 s57, s49, 12
    s_add_u32 s57, s57, s52
    ds_read_b128 a[144:147], v218 offset:2048
    v_mfma_f32_16x16x32_bf16 v[44:47], a[208:211], a[160:163], v[44:47]
    buffer_load_dwordx4 v252, s[68:71], s57 offen offset:0 lds
    v_mfma_f32_16x16x32_bf16 v[76:79], a[208:211], a[164:167], v[76:79]
    ds_read_b128 a[148:151], v218 offset:4096
    v_mfma_f32_16x16x32_bf16 v[108:111], a[208:211], a[168:171], v[108:111]
    ds_read_b128 a[152:155], v218 offset:6144
    v_mfma_f32_16x16x32_bf16 v[16:19], a[212:215], a[156:159], v[16:19]
    ds_read_b64_tr_b16 a[172:173], v228 offset:0
    v_mfma_f32_16x16x32_bf16 v[48:51], a[212:215], a[160:163], v[48:51]
    buffer_load_dwordx4 v253, s[68:71], s57 offen offset:1024 lds
    v_mfma_f32_16x16x32_bf16 v[80:83], a[212:215], a[164:167], v[80:83]
    ds_read_b64_tr_b16 a[174:175], v228 offset:1024
    v_mfma_f32_16x16x32_bf16 v[112:115], a[212:215], a[168:171], v[112:115]
    ds_read_b64_tr_b16 a[176:177], v229 offset:0
    v_mfma_f32_16x16x32_bf16 v[20:23], a[216:219], a[156:159], v[20:23]
    ds_read_b64_tr_b16 a[178:179], v229 offset:1024
    v_mfma_f32_16x16x32_bf16 v[52:55], a[216:219], a[160:163], v[52:55]
    buffer_load_dwordx4 v254, s[68:71], s57 offen offset:2048 lds
    v_mfma_f32_16x16x32_bf16 v[84:87], a[216:219], a[164:167], v[84:87]
    ds_read_b64_tr_b16 a[180:181], v230 offset:0
    v_mfma_f32_16x16x32_bf16 v[116:119], a[216:219], a[168:171], v[116:119]
    ds_read_b64_tr_b16 a[182:183], v230 offset:1024
    v_mfma_f32_16x16x32_bf16 v[24:27], a[220:223], a[156:159], v[24:27]
    ds_read_b64_tr_b16 a[184:185], v231 offset:0
    v_mfma_f32_16x16x32_bf16 v[56:59], a[220:223], a[160:163], v[56:59]
    buffer_load_dwordx4 v255, s[68:71], s57 offen offset:3072 lds
    v_mfma_f32_16x16x32_bf16 v[88:91], a[220:223], a[164:167], v[88:91]
    s_cmp_eq_u32 s24, 3
    ds_read_b64_tr_b16 a[186:187], v231 offset:1024
    v_mfma_f32_16x16x32_bf16 v[120:123], a[220:223], a[168:171], v[120:123]
    s_cselect_b32 s27, 0x40000000, s54
    ds_read_b64_tr_b16 a[188:189], v232 offset:0
    v_mfma_f32_16x16x32_bf16 v[28:31], a[224:227], a[156:159], v[28:31]
    s_cselect_b32 s28, -8192, s54
    s_add_u32 m0, s28, 106496
    ds_read_b64_tr_b16 a[190:191], v232 offset:1024
    v_mfma_f32_16x16x32_bf16 v[60:63], a[224:227], a[160:163], v[60:63]
    buffer_load_dwordx4 v2, s[8:11], s27 offen offset:0 sc1 lds
    v_mfma_f32_16x16x32_bf16 v[92:95], a[224:227], a[164:167], v[92:95]
    ds_read_b64_tr_b16 a[192:193], v233 offset:0
    v_mfma_f32_16x16x32_bf16 v[124:127], a[224:227], a[168:171], v[124:127]
    ds_read_b64_tr_b16 a[194:195], v233 offset:1024
    v_mfma_f32_16x16x32_bf16 v[32:35], a[228:231], a[156:159], v[32:35]
    ds_read_b64_tr_b16 a[196:197], v234 offset:0
    v_mfma_f32_16x16x32_bf16 v[64:67], a[228:231], a[160:163], v[64:67]
    buffer_load_dwordx4 v2, s[8:11], s27 offen offset:1024 sc1 lds
    v_mfma_f32_16x16x32_bf16 v[96:99], a[228:231], a[164:167], v[96:99]
    ds_read_b64_tr_b16 a[198:199], v234 offset:1024
    v_mfma_f32_16x16x32_bf16 v[128:131], a[228:231], a[168:171], v[128:131]
    ds_read_b64_tr_b16 a[200:201], v235 offset:0
    v_mfma_f32_16x16x32_bf16 v[36:39], a[232:235], a[156:159], v[36:39]
    ds_read_b64_tr_b16 a[202:203], v235 offset:1024
    v_mfma_f32_16x16x32_bf16 v[68:71], a[232:235], a[160:163], v[68:71]
    buffer_load_dwordx4 v2, s[8:11], s27 offen offset:2048 sc1 lds
    v_mfma_f32_16x16x32_bf16 v[100:103], a[232:235], a[164:167], v[100:103]
    buffer_load_dwordx4 v2, s[8:11], s27 offen offset:3072 sc1 lds
    v_mfma_f32_16x16x32_bf16 v[132:135], a[232:235], a[168:171], v[132:135]
    s_waitcnt lgkmcnt(8)
    v_mfma_f32_16x16x32_bf16 v[8:11], a[172:175], a[140:143], v[8:11]
    s_add_u32 m0, s28, 110592
    ds_read_b128 a[156:159], v219 offset:0
    s_lshr_b32 s55, s25, 1
    v_mfma_f32_16x16x32_bf16 v[40:43], a[172:175], a[144:147], v[40:43]
    ds_read_b128 a[160:163], v219 offset:2048
    s_mul_i32 s53, s55, 43
    v_mfma_f32_16x16x32_bf16 v[72:75], a[172:175], a[148:151], v[72:75]
    ds_read_b128 a[164:167], v219 offset:4096
    s_lshr_b32 s53, s53, 7
    v_mfma_f32_16x16x32_bf16 v[104:107], a[172:175], a[152:155], v[104:107]
    buffer_load_dwordx4 v3, s[8:11], s27 offen offset:0 sc1 lds
    s_lshr_b32 s3, s55, 1
    v_mfma_f32_16x16x32_bf16 v[12:15], a[176:179], a[140:143], v[12:15]
    ds_read_b128 a[168:171], v219 offset:6144
    s_sub_u32 s3, s3, 2
    v_mfma_f32_16x16x32_bf16 v[44:47], a[176:179], a[144:147], v[44:47]
    ds_read_b64_tr_b16 a[204:205], v228 offset:8192
    v_mfma_f32_16x16x32_bf16 v[76:79], a[176:179], a[148:151], v[76:79]
    ds_read_b64_tr_b16 a[206:207], v228 offset:9216
    v_mfma_f32_16x16x32_bf16 v[108:111], a[176:179], a[152:155], v[108:111]
    buffer_load_dwordx4 v3, s[8:11], s27 offen offset:1024 sc1 lds
    v_mfma_f32_16x16x32_bf16 v[16:19], a[180:183], a[140:143], v[16:19]
    ds_read_b64_tr_b16 a[208:209], v229 offset:8192
    v_mfma_f32_16x16x32_bf16 v[48:51], a[180:183], a[144:147], v[48:51]
    ds_read_b64_tr_b16 a[210:211], v229 offset:9216
    v_mfma_f32_16x16x32_bf16 v[80:83], a[180:183], a[148:151], v[80:83]
    ds_read_b64_tr_b16 a[212:213], v230 offset:8192
    v_mfma_f32_16x16x32_bf16 v[112:115], a[180:183], a[152:155], v[112:115]
    buffer_load_dwordx4 v3, s[8:11], s27 offen offset:2048 sc1 lds
    v_mfma_f32_16x16x32_bf16 v[20:23], a[184:187], a[140:143], v[20:23]
    ds_read_b64_tr_b16 a[214:215], v230 offset:9216
    v_mfma_f32_16x16x32_bf16 v[52:55], a[184:187], a[144:147], v[52:55]
    ds_read_b64_tr_b16 a[216:217], v231 offset:8192
    v_mfma_f32_16x16x32_bf16 v[84:87], a[184:187], a[148:151], v[84:87]
    s_waitcnt lgkmcnt(11)
    ds_read_b64_tr_b16 a[218:219], v231 offset:9216
    v_mfma_f32_16x16x32_bf16 v[116:119], a[184:187], a[152:155], v[116:119]
    buffer_load_dwordx4 v3, s[8:11], s27 offen offset:3072 sc1 lds
    v_mfma_f32_16x16x32_bf16 v[24:27], a[188:191], a[140:143], v[24:27]
    ds_read_b64_tr_b16 a[220:221], v232 offset:8192
    v_mfma_f32_16x16x32_bf16 v[56:59], a[188:191], a[144:147], v[56:59]
    ds_read_b64_tr_b16 a[222:223], v232 offset:9216
    v_mfma_f32_16x16x32_bf16 v[88:91], a[188:191], a[148:151], v[88:91]
    ds_read_b64_tr_b16 a[224:225], v233 offset:8192
    v_mfma_f32_16x16x32_bf16 v[120:123], a[188:191], a[152:155], v[120:123]
    s_cmp_lt_u32 s55, 12
    s_cselect_b32 s53, s53, s3
    s_add_u32 s53, s53, 26
    v_mfma_f32_16x16x32_bf16 v[28:31], a[192:195], a[140:143], v[28:31]
    ds_read_b64_tr_b16 a[226:227], v233 offset:9216
    s_mov_b32 s50, 0
    v_mfma_f32_16x16x32_bf16 v[60:63], a[192:195], a[144:147], v[60:63]
    ds_read_b64_tr_b16 a[228:229], v234 offset:8192
    s_bitset1_b32 s50, s53
    v_mfma_f32_16x16x32_bf16 v[92:95], a[192:195], a[148:151], v[92:95]
    ds_read_b64_tr_b16 a[230:231], v234 offset:9216
    s_lshr_b32 s55, s25, 2
    v_mfma_f32_16x16x32_bf16 v[124:127], a[192:195], a[152:155], v[124:127]
    s_lshr_b32 s3, s55, 1
    s_add_u32 s3, s3, 2
    s_min_u32 s55, s55, s3
    v_mfma_f32_16x16x32_bf16 v[32:35], a[196:199], a[140:143], v[32:35]
    ds_read_b64_tr_b16 a[232:233], v235 offset:8192
    s_add_u32 s55, s55, 26
    v_mfma_f32_16x16x32_bf16 v[64:67], a[196:199], a[144:147], v[64:67]
    ds_read_b64_tr_b16 a[234:235], v235 offset:9216
    s_bitset1_b32 s50, s55
    v_mfma_f32_16x16x32_bf16 v[96:99], a[196:199], a[148:151], v[96:99]
    v_cndmask_b32 v140, v141, v140, s[50:51]
    s_mov_b32 s59, 0x3701000
    v_mfma_f32_16x16x32_bf16 v[128:131], a[196:199], a[152:155], v[128:131]
    s_mov_b32 s35, 0
    s_mov_b32 s34, s26
    s_lshr_b32 s3, s2, 3
    v_mfma_f32_16x16x32_bf16 v[36:39], a[200:203], a[140:143], v[36:39]
    s_lshl_b32 s3, s3, 2
    s_add_u32 s3, s3, s24
    s_lshl_b32 s46, s3, 15
    v_mfma_f32_16x16x32_bf16 v[68:71], a[200:203], a[144:147], v[68:71]
    s_add_u32 s46, s46, -7808
    v_min_u32 v252, 7, v0
    v_lshlrev_b32 v252, 10, v252
    v_mfma_f32_16x16x32_bf16 v[100:103], a[200:203], a[148:151], v[100:103]
    s_bfe_u32 s57, s3, 0x20004
    s_lshl_b32 s57, s57, 20
    s_and_b32 s55, s3, 15
    v_mfma_f32_16x16x32_bf16 v[132:135], a[200:203], a[152:155], v[132:135]
    s_waitcnt lgkmcnt(8)
    s_lshl_b32 s55, s55, 12
    s_add_u32 s57, s57, s55
    v_mfma_f32_16x16x32_bf16 v[8:11], a[204:207], a[156:159], v[8:11]
    s_waitcnt lgkmcnt(0)
    s_and_b32 s52, s2, 7
    s_lshl_b32 s52, s52, 1
    v_mfma_f32_16x16x32_bf16 v[40:43], a[204:207], a[160:163], v[40:43]
    s_waitcnt vmcnt(8)
    s_lshr_b32 s3, s3, 6
    s_add_u32 s52, s52, s3
    v_mfma_f32_16x16x32_bf16 v[72:75], a[204:207], a[164:167], v[72:75]
    s_barrier
    s_add_u32 s52, s52, 14
    s_lshr_b32 s3, s2, 3
    v_mfma_f32_16x16x32_bf16 v[104:107], a[204:207], a[168:171], v[104:107]
    s_lshl_b32 s42, s24, 14
    ds_read_b128 a[140:143], v216 offset:49152
    s_lshl_b32 s3, s3, 2
    v_mfma_f32_16x16x32_bf16 v[12:15], a[208:211], a[156:159], v[12:15]
    s_add_u32 s29, s42, 24576
    s_add_u32 m0, s42, 0
    s_sub_u32 s27, s29, s32
    s_min_u32 s27, s29, s27
    ds_read_b128 a[144:147], v216 offset:51200
    v_mfma_f32_16x16x32_bf16 v[44:47], a[208:211], a[160:163], v[44:47]
    buffer_load_dwordx4 v2, s[8:11], s27 offen offset:0 sc1 lds
    s_add_u32 s3, s3, s24
    v_mfma_f32_16x16x32_bf16 v[76:79], a[208:211], a[164:167], v[76:79]
    ds_read_b128 a[148:151], v216 offset:53248
    s_lshl_b32 s57, s3, 12
    v_mfma_f32_16x16x32_bf16 v[108:111], a[208:211], a[168:171], v[108:111]
    ds_read_b128 a[152:155], v216 offset:55296
    s_bfe_u32 s3, s2, 0x20001
    v_mfma_f32_16x16x32_bf16 v[16:19], a[212:215], a[156:159], v[16:19]
    ds_read_b64_tr_b16 a[172:173], v228 offset:32768
    s_lshl_b32 s3, s3, 20
    v_mfma_f32_16x16x32_bf16 v[48:51], a[212:215], a[160:163], v[48:51]
    buffer_load_dwordx4 v2, s[8:11], s27 offen offset:1024 sc1 lds
    s_add_u32 s57, s57, s3
    v_mfma_f32_16x16x32_bf16 v[80:83], a[212:215], a[164:167], v[80:83]
    ds_read_b64_tr_b16 a[174:175], v228 offset:33792
    s_mov_b32 s52, 0
    v_mfma_f32_16x16x32_bf16 v[112:115], a[212:215], a[168:171], v[112:115]
    ds_read_b64_tr_b16 a[176:177], v229 offset:32768
    v_and_b32 v253, 31, v0
    v_mfma_f32_16x16x32_bf16 v[20:23], a[216:219], a[156:159], v[20:23]
    ds_read_b64_tr_b16 a[178:179], v229 offset:33792
    v_lshlrev_b32 v253, 7, v253
    v_mfma_f32_16x16x32_bf16 v[52:55], a[216:219], a[160:163], v[52:55]
    buffer_load_dwordx4 v2, s[8:11], s27 offen offset:2048 sc1 lds
    s_mov_b32 s53, 15
    v_mfma_f32_16x16x32_bf16 v[84:87], a[216:219], a[164:167], v[84:87]
    ds_read_b64_tr_b16 a[180:181], v230 offset:32768
    v_mfma_f32_16x16x32_bf16 v[116:119], a[216:219], a[168:171], v[116:119]
    ds_read_b64_tr_b16 a[182:183], v230 offset:33792
    v_mfma_f32_16x16x32_bf16 v[24:27], a[220:223], a[156:159], v[24:27]
    ds_read_b64_tr_b16 a[184:185], v231 offset:32768
    v_mfma_f32_16x16x32_bf16 v[56:59], a[220:223], a[160:163], v[56:59]
    buffer_load_dwordx4 v2, s[8:11], s27 offen offset:3072 sc1 lds
    v_mfma_f32_16x16x32_bf16 v[88:91], a[220:223], a[164:167], v[88:91]
    s_add_u32 m0, s42, 4096
    ds_read_b64_tr_b16 a[186:187], v231 offset:33792
    v_mfma_f32_16x16x32_bf16 v[120:123], a[220:223], a[168:171], v[120:123]
    ds_read_b64_tr_b16 a[188:189], v232 offset:32768
    v_mfma_f32_16x16x32_bf16 v[28:31], a[224:227], a[156:159], v[28:31]
    ds_read_b64_tr_b16 a[190:191], v232 offset:33792
    v_mfma_f32_16x16x32_bf16 v[60:63], a[224:227], a[160:163], v[60:63]
    buffer_load_dwordx4 v3, s[8:11], s27 offen offset:0 sc1 lds
    v_mfma_f32_16x16x32_bf16 v[92:95], a[224:227], a[164:167], v[92:95]
    ds_read_b64_tr_b16 a[192:193], v233 offset:32768
    v_mfma_f32_16x16x32_bf16 v[124:127], a[224:227], a[168:171], v[124:127]
    ds_read_b64_tr_b16 a[194:195], v233 offset:33792
    v_mfma_f32_16x16x32_bf16 v[32:35], a[228:231], a[156:159], v[32:35]
    ds_read_b64_tr_b16 a[196:197], v234 offset:32768
    v_mfma_f32_16x16x32_bf16 v[64:67], a[228:231], a[160:163], v[64:67]
    buffer_load_dwordx4 v3, s[8:11], s27 offen offset:1024 sc1 lds
    v_mfma_f32_16x16x32_bf16 v[96:99], a[228:231], a[164:167], v[96:99]
    ds_read_b64_tr_b16 a[198:199], v234 offset:33792
    v_mfma_f32_16x16x32_bf16 v[128:131], a[228:231], a[168:171], v[128:131]
    ds_read_b64_tr_b16 a[200:201], v235 offset:32768
    v_mfma_f32_16x16x32_bf16 v[36:39], a[232:235], a[156:159], v[36:39]
    ds_read_b64_tr_b16 a[202:203], v235 offset:33792
    v_mfma_f32_16x16x32_bf16 v[68:71], a[232:235], a[160:163], v[68:71]
    buffer_load_dwordx4 v3, s[8:11], s27 offen offset:2048 sc1 lds
    v_mfma_f32_16x16x32_bf16 v[100:103], a[232:235], a[164:167], v[100:103]
    buffer_load_dwordx4 v3, s[8:11], s27 offen offset:3072 sc1 lds
    v_mfma_f32_16x16x32_bf16 v[132:135], a[232:235], a[168:171], v[132:135]
    s_waitcnt lgkmcnt(8)
    v_mfma_f32_16x16x32_bf16 v[8:11], a[172:175], a[140:143], v[8:11]
    s_add_u32 m0, s42, 8192
    ds_read_b128 a[156:159], v217 offset:49152
    v_mfma_f32_16x16x32_bf16 v[40:43], a[172:175], a[144:147], v[40:43]
    s_add_u32 s29, s29, 8192
    ds_read_b128 a[160:163], v217 offset:51200
    v_mfma_f32_16x16x32_bf16 v[72:75], a[172:175], a[148:151], v[72:75]
    s_sub_u32 s27, s29, s32
    s_min_u32 s27, s29, s27
    ds_read_b128 a[164:167], v217 offset:53248
    v_mfma_f32_16x16x32_bf16 v[104:107], a[172:175], a[152:155], v[104:107]
    buffer_load_dwordx4 v2, s[8:11], s27 offen offset:0 sc1 lds
    v_mfma_f32_16x16x32_bf16 v[12:15], a[176:179], a[140:143], v[12:15]
    ds_read_b128 a[168:171], v217 offset:55296
    v_mfma_f32_16x16x32_bf16 v[44:47], a[176:179], a[144:147], v[44:47]
    ds_read_b64_tr_b16 a[204:205], v228 offset:40960
    v_mfma_f32_16x16x32_bf16 v[76:79], a[176:179], a[148:151], v[76:79]
    ds_read_b64_tr_b16 a[206:207], v228 offset:41984
    v_mfma_f32_16x16x32_bf16 v[108:111], a[176:179], a[152:155], v[108:111]
    buffer_load_dwordx4 v2, s[8:11], s27 offen offset:1024 sc1 lds
    v_mfma_f32_16x16x32_bf16 v[16:19], a[180:183], a[140:143], v[16:19]
    ds_read_b64_tr_b16 a[208:209], v229 offset:40960
    v_mfma_f32_16x16x32_bf16 v[48:51], a[180:183], a[144:147], v[48:51]
    ds_read_b64_tr_b16 a[210:211], v229 offset:41984
    v_mfma_f32_16x16x32_bf16 v[80:83], a[180:183], a[148:151], v[80:83]
    ds_read_b64_tr_b16 a[212:213], v230 offset:40960
    v_mfma_f32_16x16x32_bf16 v[112:115], a[180:183], a[152:155], v[112:115]
    buffer_load_dwordx4 v2, s[8:11], s27 offen offset:2048 sc1 lds
    v_mfma_f32_16x16x32_bf16 v[20:23], a[184:187], a[140:143], v[20:23]
    ds_read_b64_tr_b16 a[214:215], v230 offset:41984
    v_mfma_f32_16x16x32_bf16 v[52:55], a[184:187], a[144:147], v[52:55]
    ds_read_b64_tr_b16 a[216:217], v231 offset:40960
    v_mfma_f32_16x16x32_bf16 v[84:87], a[184:187], a[148:151], v[84:87]
    s_waitcnt lgkmcnt(11)
    ds_read_b64_tr_b16 a[218:219], v231 offset:41984
    v_mfma_f32_16x16x32_bf16 v[116:119], a[184:187], a[152:155], v[116:119]
    buffer_load_dwordx4 v2, s[8:11], s27 offen offset:3072 sc1 lds
    v_mfma_f32_16x16x32_bf16 v[24:27], a[188:191], a[140:143], v[24:27]
    s_add_u32 m0, s42, 12288
    ds_read_b64_tr_b16 a[220:221], v232 offset:40960
    v_mfma_f32_16x16x32_bf16 v[56:59], a[188:191], a[144:147], v[56:59]
    ds_read_b64_tr_b16 a[222:223], v232 offset:41984
    v_mfma_f32_16x16x32_bf16 v[88:91], a[188:191], a[148:151], v[88:91]
    ds_read_b64_tr_b16 a[224:225], v233 offset:40960
    v_mfma_f32_16x16x32_bf16 v[120:123], a[188:191], a[152:155], v[120:123]
    buffer_load_dwordx4 v3, s[8:11], s27 offen offset:0 sc1 lds
    v_mfma_f32_16x16x32_bf16 v[28:31], a[192:195], a[140:143], v[28:31]
    ds_read_b64_tr_b16 a[226:227], v233 offset:41984
    v_mfma_f32_16x16x32_bf16 v[60:63], a[192:195], a[144:147], v[60:63]
    ds_read_b64_tr_b16 a[228:229], v234 offset:40960
    v_mfma_f32_16x16x32_bf16 v[92:95], a[192:195], a[148:151], v[92:95]
    ds_read_b64_tr_b16 a[230:231], v234 offset:41984
    v_mfma_f32_16x16x32_bf16 v[124:127], a[192:195], a[152:155], v[124:127]
    buffer_load_dwordx4 v3, s[8:11], s27 offen offset:1024 sc1 lds
    v_mfma_f32_16x16x32_bf16 v[32:35], a[196:199], a[140:143], v[32:35]
    ds_read_b64_tr_b16 a[232:233], v235 offset:40960
    v_mfma_f32_16x16x32_bf16 v[64:67], a[196:199], a[144:147], v[64:67]
    ds_read_b64_tr_b16 a[234:235], v235 offset:41984
    v_mfma_f32_16x16x32_bf16 v[96:99], a[196:199], a[148:151], v[96:99]
    v_mfma_f32_16x16x32_bf16 v[128:131], a[196:199], a[152:155], v[128:131]
    buffer_load_dwordx4 v3, s[8:11], s27 offen offset:2048 sc1 lds
    v_mfma_f32_16x16x32_bf16 v[36:39], a[200:203], a[140:143], v[36:39]
    v_mfma_f32_16x16x32_bf16 v[68:71], a[200:203], a[144:147], v[68:71]
    buffer_load_dwordx4 v3, s[8:11], s27 offen offset:3072 sc1 lds
    v_mfma_f32_16x16x32_bf16 v[100:103], a[200:203], a[148:151], v[100:103]
    s_add_u32 s29, s29, 57344
    v_mfma_f32_16x16x32_bf16 v[132:135], a[200:203], a[152:155], v[132:135]
    s_waitcnt lgkmcnt(8)
    v_mfma_f32_16x16x32_bf16 v[8:11], a[204:207], a[156:159], v[8:11]
    s_waitcnt lgkmcnt(0)
    v_mfma_f32_16x16x32_bf16 v[40:43], a[204:207], a[160:163], v[40:43]
    s_waitcnt vmcnt(16)
    v_mfma_f32_16x16x32_bf16 v[12:15], a[208:211], a[156:159], v[12:15]
    s_barrier
    v_mfma_f32_16x16x32_bf16 v[44:47], a[208:211], a[160:163], v[44:47]
    s_xor_b32 s42, s42, 0x10000
    ds_read_b128 a[0:3], v1 offset:40960
    v_cvt_pk_bf16_f32 v152, v8, v9
    v_cvt_pk_bf16_f32 v153, v10, v11
    v_mfma_f32_16x16x32_bf16 v[16:19], a[212:215], a[156:159], v[16:19]
    s_and_b32 s27, s2, 1
    ds_read_b128 a[4:7], v1 offset:41984
    v_cvt_pk_bf16_f32 v168, v40, v41
    v_cvt_pk_bf16_f32 v169, v42, v43
    v_mfma_f32_16x16x32_bf16 v[48:51], a[212:215], a[160:163], v[48:51]
    s_lshl_b32 s27, s27, 5
    ds_read_b128 a[8:11], v1 offset:43008
    v_cvt_pk_bf16_f32 v154, v12, v13
    v_cvt_pk_bf16_f32 v155, v14, v15
    v_mfma_f32_16x16x32_bf16 v[20:23], a[216:219], a[156:159], v[20:23]
    s_lshr_b32 s28, s2, 3
    ds_read_b128 a[12:15], v1 offset:44032
    v_cvt_pk_bf16_f32 v170, v44, v45
    v_cvt_pk_bf16_f32 v171, v46, v47
    v_mfma_f32_16x16x32_bf16 v[52:55], a[216:219], a[160:163], v[52:55]
    s_add_u32 s27, s27, s28
    ds_read_b128 a[16:19], v1 offset:45056
    v_cvt_pk_bf16_f32 v156, v16, v17
    v_cvt_pk_bf16_f32 v157, v18, v19
    v_mfma_f32_16x16x32_bf16 v[24:27], a[220:223], a[156:159], v[24:27]
    s_lshl_b32 s27, s27, 2
    ds_read_b128 a[20:23], v1 offset:46080
    v_cvt_pk_bf16_f32 v172, v48, v49
    v_cvt_pk_bf16_f32 v173, v50, v51
    v_mfma_f32_16x16x32_bf16 v[56:59], a[220:223], a[160:163], v[56:59]
    s_bfe_u32 s28, s2, 0x20001
    ds_read_b128 a[24:27], v1 offset:47104
    v_cvt_pk_bf16_f32 v158, v20, v21
    v_cvt_pk_bf16_f32 v159, v22, v23
    v_mfma_f32_16x16x32_bf16 v[28:31], a[224:227], a[156:159], v[28:31]
    s_add_u32 s27, s27, s28
    s_mul_i32 s27, s27, 49152
    s_lshl_b32 s28, s24, 12
    s_add_u32 s27, s27, s28
    s_add_u32 s27, s27, 0x3800000
    v_mov_b32 v144, -1
    v_mov_b32 v145, -1
    v_mov_b32 v146, -1
    v_mov_b32 v147, -1
    ds_read_b128 a[28:31], v1 offset:48128
    v_mfma_f32_16x16x32_bf16 v[60:63], a[224:227], a[160:163], v[60:63]
    buffer_store_dwordx4 v[144:147], v2, s[12:15], s27 offen offset:0 sc1
    v_cvt_pk_bf16_f32 v174, v52, v53
    v_cvt_pk_bf16_f32 v175, v54, v55
    v_mfma_f32_16x16x32_bf16 v[32:35], a[228:231], a[156:159], v[32:35]
    ds_read_b128 a[32:35], v1 offset:49152
    v_cvt_pk_bf16_f32 v160, v24, v25
    v_cvt_pk_bf16_f32 v161, v26, v27
    v_mfma_f32_16x16x32_bf16 v[64:67], a[228:231], a[160:163], v[64:67]
    buffer_store_dwordx4 v[144:147], v2, s[12:15], s27 offen offset:1024 sc1
    v_cvt_pk_bf16_f32 v176, v56, v57
    v_cvt_pk_bf16_f32 v177, v58, v59
    v_mfma_f32_16x16x32_bf16 v[36:39], a[232:235], a[156:159], v[36:39]
    s_add_u32 s27, s27, 16384
    ds_read_b128 a[36:39], v1 offset:50176
    v_cvt_pk_bf16_f32 v162, v28, v29
    v_cvt_pk_bf16_f32 v163, v30, v31
    v_mfma_f32_16x16x32_bf16 v[68:71], a[232:235], a[160:163], v[68:71]
    buffer_store_dwordx4 v[144:147], v2, s[12:15], s27 offen offset:0 sc1
    v_cvt_pk_bf16_f32 v178, v60, v61
    v_cvt_pk_bf16_f32 v179, v62, v63
    v_mfma_f32_16x16x32_bf16 v[72:75], a[204:207], a[164:167], v[72:75]
    ds_read_b128 a[40:43], v1 offset:51200
    v_cvt_pk_bf16_f32 v164, v32, v33
    v_cvt_pk_bf16_f32 v165, v34, v35
    v_mfma_f32_16x16x32_bf16 v[104:107], a[204:207], a[168:171], v[104:107]
    buffer_store_dwordx4 v[144:147], v2, s[12:15], s27 offen offset:1024 sc1
    v_cvt_pk_bf16_f32 v180, v64, v65
    v_cvt_pk_bf16_f32 v181, v66, v67
    v_mfma_f32_16x16x32_bf16 v[76:79], a[208:211], a[164:167], v[76:79]
    s_add_u32 s27, s27, 16384
    ds_read_b128 a[44:47], v1 offset:52224
    v_cvt_pk_bf16_f32 v166, v36, v37
    v_cvt_pk_bf16_f32 v167, v38, v39
    v_mfma_f32_16x16x32_bf16 v[108:111], a[208:211], a[168:171], v[108:111]
    buffer_store_dwordx4 v[144:147], v2, s[12:15], s27 offen offset:0 sc1
    v_cvt_pk_bf16_f32 v182, v68, v69
    v_cvt_pk_bf16_f32 v183, v70, v71
    v_mfma_f32_16x16x32_bf16 v[80:83], a[212:215], a[164:167], v[80:83]
    v_mfma_f32_16x16x32_bf16 v[112:115], a[212:215], a[168:171], v[112:115]
    v_mfma_f32_16x16x32_bf16 v[84:87], a[216:219], a[164:167], v[84:87]
    v_mfma_f32_16x16x32_bf16 v[116:119], a[216:219], a[168:171], v[116:119]
    v_mfma_f32_16x16x32_bf16 v[88:91], a[220:223], a[164:167], v[88:91]
    v_mfma_f32_16x16x32_bf16 v[120:123], a[220:223], a[168:171], v[120:123]
    v_mfma_f32_16x16x32_bf16 v[92:95], a[224:227], a[164:167], v[92:95]
    v_mfma_f32_16x16x32_bf16 v[124:127], a[224:227], a[168:171], v[124:127]
    v_mfma_f32_16x16x32_bf16 v[96:99], a[228:231], a[164:167], v[96:99]
    v_mfma_f32_16x16x32_bf16 v[128:131], a[228:231], a[168:171], v[128:131]
    v_mfma_f32_16x16x32_bf16 v[100:103], a[232:235], a[164:167], v[100:103]
    v_mfma_f32_16x16x32_bf16 v[132:135], a[232:235], a[168:171], v[132:135]
    buffer_store_dwordx4 v[144:147], v2, s[12:15], s27 offen offset:1024 sc1
    ds_read_b128 a[48:51], v1 offset:53248
    ds_read_b128 a[52:55], v1 offset:54272
    ds_read_b128 a[56:59], v1 offset:55296
    ds_read_b128 a[60:63], v1 offset:56320
    ds_read_b128 a[64:67], v1 offset:57344
    ds_read_b128 a[68:71], v1 offset:58368
    ds_read_b128 a[72:75], v1 offset:59392
    ds_read_b128 a[76:79], v1 offset:60416
    ds_read_b128 a[80:83], v1 offset:61440
    ds_read_b128 a[84:87], v1 offset:62464
    ds_read_b128 a[88:91], v1 offset:63488
    ds_read_b128 a[92:95], v1 offset:64512
    v_mov_b32 v1, v2
    v_mov_b32 v218, v140
    s_waitcnt lgkmcnt(15)
    v_mfma_f32_16x16x32_bf16 v[8:11], a[0:3], v[152:155], 0
    v_cvt_pk_bf16_f32 v184, v72, v73
    v_cvt_pk_bf16_f32 v185, v74, v75
    v_mfma_f32_16x16x32_bf16 v[12:15], a[0:3], v[168:171], 0
    v_cvt_pk_bf16_f32 v200, v104, v105
    v_cvt_pk_bf16_f32 v201, v106, v107
    v_mfma_f32_16x16x32_bf16 v[8:11], a[4:7], v[156:159], v[8:11]
    v_cvt_pk_bf16_f32 v186, v76, v77
    v_cvt_pk_bf16_f32 v187, v78, v79
    v_mfma_f32_16x16x32_bf16 v[12:15], a[4:7], v[172:175], v[12:15]
    v_cvt_pk_bf16_f32 v202, v108, v109
    v_cvt_pk_bf16_f32 v203, v110, v111
    v_mfma_f32_16x16x32_bf16 v[8:11], a[8:11], v[160:163], v[8:11]
    v_cvt_pk_bf16_f32 v188, v80, v81
    v_cvt_pk_bf16_f32 v189, v82, v83
    v_mfma_f32_16x16x32_bf16 v[12:15], a[8:11], v[176:179], v[12:15]
    v_cvt_pk_bf16_f32 v204, v112, v113
    v_cvt_pk_bf16_f32 v205, v114, v115
    v_mfma_f32_16x16x32_bf16 v[8:11], a[12:15], v[164:167], v[8:11]
    v_cvt_pk_bf16_f32 v190, v84, v85
    v_cvt_pk_bf16_f32 v191, v86, v87
    v_mfma_f32_16x16x32_bf16 v[12:15], a[12:15], v[180:183], v[12:15]
    v_cvt_pk_bf16_f32 v206, v116, v117
    v_cvt_pk_bf16_f32 v207, v118, v119
    v_mfma_f32_16x16x32_bf16 v[16:19], a[16:19], v[152:155], 0
    v_cvt_pk_bf16_f32 v192, v88, v89
    v_cvt_pk_bf16_f32 v193, v90, v91
    v_mfma_f32_16x16x32_bf16 v[20:23], a[16:19], v[168:171], 0
    v_cvt_pk_bf16_f32 v208, v120, v121
    v_cvt_pk_bf16_f32 v209, v122, v123
    v_mfma_f32_16x16x32_bf16 v[16:19], a[20:23], v[156:159], v[16:19]
    v_cvt_pk_bf16_f32 v194, v92, v93
    v_cvt_pk_bf16_f32 v195, v94, v95
    v_mfma_f32_16x16x32_bf16 v[20:23], a[20:23], v[172:175], v[20:23]
    v_cvt_pk_bf16_f32 v210, v124, v125
    v_cvt_pk_bf16_f32 v211, v126, v127
    v_mfma_f32_16x16x32_bf16 v[16:19], a[24:27], v[160:163], v[16:19]
    v_cvt_pk_bf16_f32 v196, v96, v97
    v_cvt_pk_bf16_f32 v197, v98, v99
    v_mfma_f32_16x16x32_bf16 v[20:23], a[24:27], v[176:179], v[20:23]
    v_cvt_pk_bf16_f32 v212, v128, v129
    v_cvt_pk_bf16_f32 v213, v130, v131
    v_mfma_f32_16x16x32_bf16 v[16:19], a[28:31], v[164:167], v[16:19]
    v_cvt_pk_bf16_f32 v198, v100, v101
    v_cvt_pk_bf16_f32 v199, v102, v103
    v_mfma_f32_16x16x32_bf16 v[20:23], a[28:31], v[180:183], v[20:23]
    v_cvt_pk_bf16_f32 v214, v132, v133
    v_cvt_pk_bf16_f32 v215, v134, v135
    s_waitcnt lgkmcnt(0)
L2_block:
    v_mov_b32 v64, 0
    v_mov_b32 v65, 0
    v_mov_b32 v66, 0
    v_mov_b32 v67, 0
    v_mov_b32 v68, 0
    v_mov_b32 v69, 0
    v_mov_b32 v70, 0
    v_mov_b32 v71, 0
    s_lshl_b32 s28, s34, 2
    s_add_u32 s28, s28, s24
    s_cmp_gt_u32 s28, 1
    s_cbranch_scc1 L2_nomask
    s_cmp_eq_u32 s28, 1
    s_cbranch_scc1 L2_mask1
    v_cndmask_b32 v8, v8, v5, s[16:17]
    v_cndmask_b32 v9, v9, v5, s[18:19]
    v_cndmask_b32 v10, v10, v5, s[20:21]
    v_cndmask_b32 v11, v11, v5, s[22:23]
    v_mov_b32 v16, v5
    v_mov_b32 v17, v5
    v_mov_b32 v18, v5
    v_mov_b32 v19, v5
L2_mask1:
    v_cndmask_b32 v16, v16, v5, s[16:17]
    v_cndmask_b32 v17, v17, v5, s[18:19]
    v_cndmask_b32 v18, v18, v5, s[20:21]
    v_cndmask_b32 v19, v19, v5, s[22:23]
L2_nomask:
    v_max3_f32 v6, v8, v9, v10
    v_max3_f32 v80, v12, v13, v14
    v_mfma_f32_16x16x32_bf16 v[96:99], a[236:239], a[236:239], 0
    s_lshl_b32 s36, s34, 3
    v_max3_f32 v6, v6, v11, v16
    v_max3_f32 v80, v80, v15, v20
    v_mfma_f32_16x16x32_bf16 v[112:115], a[236:239], a[236:239], 0
    s_add_u32 s36, s36, s24
    v_max3_f32 v6, v6, v17, v18
    v_max3_f32 v80, v80, v21, v22
    v_mfma_f32_16x16x32_bf16 v[128:131], a[236:239], a[236:239], 0
    s_lshl_b32 s36, s36, 17
    v_max_f32 v6, v6, v19
    v_max_f32 v80, v80, v23
    v_mfma_f32_16x16x32_bf16 v[144:147], a[236:239], a[236:239], 0
    s_lshl_b32 s28, s25, 12
    v_mov_b32 v216, v6
    v_mov_b32 v217, v80
    v_mfma_f32_16x16x32_bf16 v[88:91], a[236:239], a[236:239], 0
    s_add_u32 s36, s36, s28
    v_permlane16_swap_b32 v6, v216
    v_permlane16_swap_b32 v80, v217
    v_mfma_f32_16x16x32_bf16 v[104:107], a[236:239], a[236:239], 0
    s_add_u32 s36, s36, 0x2000000
    v_max_f32 v6, v6, v216
    v_max_f32 v80, v80, v217
    v_mfma_f32_16x16x32_bf16 v[120:123], a[236:239], a[236:239], 0
    s_mov_b32 s33, 0
    v_mov_b32 v216, v6
    v_mov_b32 v217, v80
    v_mfma_f32_16x16x32_bf16 v[136:139], a[236:239], a[236:239], 0
    s_and_b32 s33, s33, 0xfffffff8
    v_permlane32_swap_b32 v6, v216
    v_permlane32_swap_b32 v80, v217
    v_mfma_f32_16x16x32_bf16 v[100:103], a[236:239], a[236:239], 0
    v_max_f32 v6, v6, v216
    v_max_f32 v80, v80, v217
    v_mfma_f32_16x16x32_bf16 v[116:119], a[236:239], a[236:239], 0
    v_sub_f32 v56, 0xc2c80000, v6
    v_sub_f32 v60, 0xc2c80000, v80
    v_mfma_f32_16x16x32_bf16 v[132:135], a[236:239], a[236:239], 0
    v_add_f32 v8, v8, v56
    v_add_f32 v12, v12, v60
    v_mfma_f32_16x16x32_bf16 v[148:151], a[236:239], a[236:239], 0
    v_add_f32 v9, v9, v56
    v_add_f32 v13, v13, v60
    v_mfma_f32_16x16x32_bf16 v[92:95], a[236:239], a[236:239], 0
    v_add_f32 v10, v10, v56
    v_add_f32 v14, v14, v60
    v_mfma_f32_16x16x32_bf16 v[108:111], a[236:239], a[236:239], 0
    v_add_f32 v11, v11, v56
    v_add_f32 v15, v15, v60
    v_mfma_f32_16x16x32_bf16 v[124:127], a[236:239], a[236:239], 0
    v_add_f32 v16, v16, v56
    v_add_f32 v20, v20, v60
    v_mfma_f32_16x16x32_bf16 v[140:143], a[236:239], a[236:239], 0
    v_add_f32 v17, v17, v56
    v_add_f32 v21, v21, v60
    v_add_f32 v18, v18, v56
    v_add_f32 v22, v22, v60
    v_add_f32 v19, v19, v56
    v_add_f32 v23, v23, v60
    v_mov_b32 v57, v56
    v_mov_b32 v61, v60
    v_mov_b32 v58, v56
    v_mov_b32 v62, v60
    v_mov_b32 v59, v56
    v_mov_b32 v63, v60
    v_exp_f32 v80, v8
    v_exp_f32 v81, v9
    v_exp_f32 v82, v10
    v_exp_f32 v83, v11
    v_cvt_pk_bf16_f32 v40, v80, v81
    v_cvt_pk_bf16_f32 v41, v82, v83
    v_exp_f32 v84, v12
    v_exp_f32 v85, v13
    v_exp_f32 v86, v14
    v_exp_f32 v87, v15
    v_cvt_pk_bf16_f32 v44, v84, v85
    v_cvt_pk_bf16_f32 v45, v86, v87
    v_exp_f32 v80, v16
    v_exp_f32 v81, v17
    v_exp_f32 v82, v18
    v_exp_f32 v83, v19
    v_cvt_pk_bf16_f32 v42, v80, v81
    v_cvt_pk_bf16_f32 v43, v82, v83
    s_waitcnt vmcnt(6)
    s_cmp_eq_u32 s34, 0
    s_cbranch_scc1 L2_tail
L2_loop:
    v_mfma_f32_16x16x32_bf16 v[24:27], a[32:35], v[152:155], v[56:59]
    s_barrier
    v_exp_f32 v84, v20
    v_mfma_f32_16x16x32_bf16 v[28:31], a[32:35], v[168:171], v[60:63]
    ds_read_b128 a[0:3], v1 offset:8192
    v_mfma_f32_16x16x32_bf16 v[24:27], a[36:39], v[156:159], v[24:27]
    s_add_u32 m0, s42, 0
    v_exp_f32 v85, v21
    v_mfma_f32_16x16x32_bf16 v[28:31], a[36:39], v[172:175], v[28:31]
    s_sub_u32 s27, s29, s32
    ds_read_b128 a[4:7], v1 offset:9216
    v_cvt_pk_bf16_f32 v46, v84, v85
    v_mfma_f32_16x16x32_bf16 v[24:27], a[40:43], v[160:163], v[24:27]
    s_min_u32 s27, s29, s27
    v_exp_f32 v86, v22
    v_mfma_f32_16x16x32_bf16 v[28:31], a[40:43], v[176:179], v[28:31]
    ds_read_b128 a[8:11], v1 offset:10240
    buffer_load_dwordx4 v2, s[8:11], s27 offen offset:0 sc1 lds
    v_mfma_f32_16x16x32_bf16 v[24:27], a[44:47], v[164:167], v[24:27]
    v_exp_f32 v87, v23
    v_mfma_f32_16x16x32_bf16 v[28:31], a[44:47], v[180:183], v[28:31]
    ds_read_b128 a[12:15], v1 offset:11264
    v_cvt_pk_bf16_f32 v47, v86, v87
    v_mfma_f32_16x16x32_bf16 v[32:35], a[48:51], v[152:155], v[56:59]
    ds_read_b128 a[16:19], v1 offset:12288
    v_mfma_f32_16x16x32_bf16 v[36:39], a[48:51], v[168:171], v[60:63]
    buffer_load_dwordx4 v2, s[8:11], s27 offen offset:1024 sc1 lds
    v_mfma_f32_16x16x32_bf16 v[72:75], a[128:131], v[40:43], v[64:67]
    s_bitcmp1_b32 s33, s34
    v_exp_f32 v80, v24
    v_mfma_f32_16x16x32_bf16 v[76:79], a[128:131], v[44:47], v[68:71]
    s_cselect_b32 s47, -1.0, s37
    ds_read_b128 a[20:23], v1 offset:13312
    v_mfma_f32_16x16x32_bf16 v[32:35], a[52:55], v[156:159], v[32:35]
    v_exp_f32 v81, v25
    v_mfma_f32_16x16x32_bf16 v[36:39], a[52:55], v[172:175], v[36:39]
    ds_read_b128 a[24:27], v1 offset:14336
    v_cvt_pk_bf16_f32 v48, v80, v81
    v_mfma_f32_16x16x32_bf16 v[32:35], a[56:59], v[160:163], v[32:35]
    v_max_f32 v6, v72, v76
    v_cmp_lt_f32 vcc, s47, v6
    v_mfma_f32_16x16x32_bf16 v[36:39], a[56:59], v[176:179], v[36:39]
    ds_read_b128 a[28:31], v1 offset:15360
    buffer_load_dwordx4 v2, s[8:11], s27 offen offset:2048 sc1 lds
    v_mfma_f32_16x16x32_bf16 v[32:35], a[60:63], v[164:167], v[32:35]
    v_exp_f32 v82, v26
    v_mfma_f32_16x16x32_bf16 v[36:39], a[60:63], v[180:183], v[36:39]
    s_cbranch_vccnz FB_concat_5
BK_concat_6:
    ds_read_b128 a[96:99], v1 offset:0
    buffer_load_dwordx4 v2, s[8:11], s27 offen offset:3072 sc1 lds
    v_mfma_f32_16x16x32_bf16 v[88:91], a[64:67], v[40:43], v[88:91]
    v_exp_f32 v83, v27
    v_mfma_f32_16x16x32_bf16 v[92:95], a[64:67], v[44:47], v[92:95]
    ds_read_b128 a[100:103], v1 offset:1024
    v_cvt_pk_bf16_f32 v49, v82, v83
    v_mfma_f32_16x16x32_bf16 v[96:99], a[68:71], v[40:43], v[96:99]
    v_exp_f32 v84, v28
    v_mfma_f32_16x16x32_bf16 v[100:103], a[68:71], v[44:47], v[100:103]
    v_exp_f32 v85, v29
    v_mfma_f32_16x16x32_bf16 v[104:107], a[72:75], v[40:43], v[104:107]
    v_exp_f32 v86, v30
    v_mfma_f32_16x16x32_bf16 v[108:111], a[72:75], v[44:47], v[108:111]
    ds_read_b128 a[104:107], v1 offset:2048
    v_cvt_pk_bf16_f32 v52, v84, v85
    v_mfma_f32_16x16x32_bf16 v[112:115], a[76:79], v[40:43], v[112:115]
    v_exp_f32 v87, v31
    v_mfma_f32_16x16x32_bf16 v[116:119], a[76:79], v[44:47], v[116:119]
    ds_read_b128 a[108:111], v1 offset:3072
    v_cvt_pk_bf16_f32 v53, v86, v87
    v_mfma_f32_16x16x32_bf16 v[120:123], a[80:83], v[40:43], v[120:123]
    s_add_u32 m0, s42, 4096
    v_exp_f32 v80, v32
    v_mfma_f32_16x16x32_bf16 v[124:127], a[80:83], v[44:47], v[124:127]
    ds_read_b128 a[112:115], v1 offset:4096
    buffer_load_dwordx4 v3, s[8:11], s27 offen offset:0 sc1 lds
    v_mfma_f32_16x16x32_bf16 v[128:131], a[84:87], v[40:43], v[128:131]
    v_exp_f32 v81, v33
    v_mfma_f32_16x16x32_bf16 v[132:135], a[84:87], v[44:47], v[132:135]
    ds_read_b128 a[116:119], v1 offset:5120
    v_cvt_pk_bf16_f32 v50, v80, v81
    v_mfma_f32_16x16x32_bf16 v[136:139], a[88:91], v[40:43], v[136:139]
    v_exp_f32 v82, v34
    v_mfma_f32_16x16x32_bf16 v[140:143], a[88:91], v[44:47], v[140:143]
    ds_read_b128 a[120:123], v1 offset:6144
    buffer_load_dwordx4 v3, s[8:11], s27 offen offset:1024 sc1 lds
    v_mfma_f32_16x16x32_bf16 v[144:147], a[92:95], v[40:43], v[144:147]
    v_exp_f32 v83, v35
    v_mfma_f32_16x16x32_bf16 v[148:151], a[92:95], v[44:47], v[148:151]
    s_waitcnt lgkmcnt(7)
    ds_read_b128 a[124:127], v1 offset:7168
    v_cvt_pk_bf16_f32 v51, v82, v83
    v_mfma_f32_16x16x32_bf16 v[8:11], a[0:3], v[152:155], v[56:59]
    v_exp_f32 v84, v36
    v_mfma_f32_16x16x32_bf16 v[12:15], a[0:3], v[168:171], v[60:63]
    ds_read_b128 a[32:35], v1 offset:16384
    buffer_load_dwordx4 v3, s[8:11], s27 offen offset:2048 sc1 lds
    v_mfma_f32_16x16x32_bf16 v[8:11], a[4:7], v[156:159], v[8:11]
    v_exp_f32 v85, v37
    v_mfma_f32_16x16x32_bf16 v[12:15], a[4:7], v[172:175], v[12:15]
    ds_read_b128 a[36:39], v1 offset:17408
    v_cvt_pk_bf16_f32 v54, v84, v85
    v_mfma_f32_16x16x32_bf16 v[8:11], a[8:11], v[160:163], v[8:11]
    v_exp_f32 v86, v38
    v_mfma_f32_16x16x32_bf16 v[12:15], a[8:11], v[176:179], v[12:15]
    ds_read_b128 a[40:43], v1 offset:18432
    buffer_load_dwordx4 v3, s[8:11], s27 offen offset:3072 sc1 lds
    v_mfma_f32_16x16x32_bf16 v[8:11], a[12:15], v[164:167], v[8:11]
    v_exp_f32 v87, v39
    v_mfma_f32_16x16x32_bf16 v[12:15], a[12:15], v[180:183], v[12:15]
    s_add_u32 m0, s42, 8192
    ds_read_b128 a[44:47], v1 offset:19456
    v_cvt_pk_bf16_f32 v55, v86, v87
    v_mfma_f32_16x16x32_bf16 v[16:19], a[16:19], v[152:155], v[56:59]
    s_add_u32 s29, s29, 8192
    ds_read_b128 a[48:51], v1 offset:20480
    v_mfma_f32_16x16x32_bf16 v[20:23], a[16:19], v[168:171], v[60:63]
    s_sub_u32 s27, s29, s32
    v_mfma_f32_16x16x32_bf16 v[64:67], a[128:131], v[48:51], v[72:75]
    s_min_u32 s27, s29, s27
    v_exp_f32 v80, v8
    v_mfma_f32_16x16x32_bf16 v[68:71], a[128:131], v[52:55], v[76:79]
    ds_read_b128 a[52:55], v1 offset:21504
    buffer_load_dwordx4 v2, s[8:11], s27 offen offset:0 sc1 lds
    v_mfma_f32_16x16x32_bf16 v[16:19], a[20:23], v[156:159], v[16:19]
    v_exp_f32 v81, v9
    v_mfma_f32_16x16x32_bf16 v[20:23], a[20:23], v[172:175], v[20:23]
    ds_read_b128 a[56:59], v1 offset:22528
    v_cvt_pk_bf16_f32 v40, v80, v81
    v_mfma_f32_16x16x32_bf16 v[16:19], a[24:27], v[160:163], v[16:19]
    v_max_f32 v6, v64, v68
    v_cmp_lt_f32 vcc, s37, v6
    v_mfma_f32_16x16x32_bf16 v[20:23], a[24:27], v[176:179], v[20:23]
    ds_read_b128 a[60:63], v1 offset:23552
    buffer_load_dwordx4 v2, s[8:11], s27 offen offset:1024 sc1 lds
    v_mfma_f32_16x16x32_bf16 v[16:19], a[28:31], v[164:167], v[16:19]
    s_waitcnt lgkmcnt(8)
    v_exp_f32 v82, v10
    v_mfma_f32_16x16x32_bf16 v[20:23], a[28:31], v[180:183], v[20:23]
    s_cbranch_vccnz FB_concat_7
BK_concat_8:
    ds_read_b128 a[64:67], v1 offset:24576
    v_mfma_f32_16x16x32_bf16 v[88:91], a[96:99], v[48:51], v[88:91]
    v_exp_f32 v83, v11
    v_mfma_f32_16x16x32_bf16 v[92:95], a[96:99], v[52:55], v[92:95]
    ds_read_b128 a[68:71], v1 offset:25600
    v_cvt_pk_bf16_f32 v41, v82, v83
    v_mfma_f32_16x16x32_bf16 v[96:99], a[100:103], v[48:51], v[96:99]
    v_exp_f32 v84, v12
    v_mfma_f32_16x16x32_bf16 v[100:103], a[100:103], v[52:55], v[100:103]
    v_exp_f32 v85, v13
    v_mfma_f32_16x16x32_bf16 v[104:107], a[104:107], v[48:51], v[104:107]
    v_exp_f32 v86, v14
    v_mfma_f32_16x16x32_bf16 v[108:111], a[104:107], v[52:55], v[108:111]
    ds_read_b128 a[72:75], v1 offset:26624
    v_cvt_pk_bf16_f32 v44, v84, v85
    v_mfma_f32_16x16x32_bf16 v[112:115], a[108:111], v[48:51], v[112:115]
    v_exp_f32 v87, v15
    v_mfma_f32_16x16x32_bf16 v[116:119], a[108:111], v[52:55], v[116:119]
    ds_read_b128 a[76:79], v1 offset:27648
    v_cvt_pk_bf16_f32 v45, v86, v87
    v_mfma_f32_16x16x32_bf16 v[120:123], a[112:115], v[48:51], v[120:123]
    v_exp_f32 v80, v16
    v_mfma_f32_16x16x32_bf16 v[124:127], a[112:115], v[52:55], v[124:127]
    ds_read_b128 a[80:83], v1 offset:28672
    buffer_load_dwordx4 v2, s[8:11], s27 offen offset:2048 sc1 lds
    v_mfma_f32_16x16x32_bf16 v[128:131], a[116:119], v[48:51], v[128:131]
    v_exp_f32 v81, v17
    v_mfma_f32_16x16x32_bf16 v[132:135], a[116:119], v[52:55], v[132:135]
    ds_read_b128 a[84:87], v1 offset:29696
    v_cvt_pk_bf16_f32 v42, v80, v81
    v_mfma_f32_16x16x32_bf16 v[136:139], a[120:123], v[48:51], v[136:139]
    v_exp_f32 v82, v18
    v_mfma_f32_16x16x32_bf16 v[140:143], a[120:123], v[52:55], v[140:143]
    ds_read_b128 a[88:91], v1 offset:30720
    buffer_load_dwordx4 v2, s[8:11], s27 offen offset:3072 sc1 lds
    v_mfma_f32_16x16x32_bf16 v[144:147], a[124:127], v[48:51], v[144:147]
    v_exp_f32 v83, v19
    v_mfma_f32_16x16x32_bf16 v[148:151], a[124:127], v[52:55], v[148:151]
    s_waitcnt lgkmcnt(7)
    ds_read_b128 a[92:95], v1 offset:31744
    v_cvt_pk_bf16_f32 v43, v82, v83
    v_mfma_f32_16x16x32_bf16 v[24:27], a[32:35], v[152:155], v[56:59]
    v_exp_f32 v84, v20
    v_mfma_f32_16x16x32_bf16 v[28:31], a[32:35], v[168:171], v[60:63]
    ds_read_b128 a[0:3], v1 offset:40960
    v_mfma_f32_16x16x32_bf16 v[24:27], a[36:39], v[156:159], v[24:27]
    v_exp_f32 v85, v21
    v_mfma_f32_16x16x32_bf16 v[28:31], a[36:39], v[172:175], v[28:31]
    ds_read_b128 a[4:7], v1 offset:41984
    v_cvt_pk_bf16_f32 v46, v84, v85
    v_mfma_f32_16x16x32_bf16 v[24:27], a[40:43], v[160:163], v[24:27]
    s_add_u32 m0, s42, 12288
    v_exp_f32 v86, v22
    v_mfma_f32_16x16x32_bf16 v[28:31], a[40:43], v[176:179], v[28:31]
    ds_read_b128 a[8:11], v1 offset:43008
    buffer_load_dwordx4 v3, s[8:11], s27 offen offset:0 sc1 lds
    v_mfma_f32_16x16x32_bf16 v[24:27], a[44:47], v[164:167], v[24:27]
    v_exp_f32 v87, v23
    v_mfma_f32_16x16x32_bf16 v[28:31], a[44:47], v[180:183], v[28:31]
    ds_read_b128 a[12:15], v1 offset:44032
    v_cvt_pk_bf16_f32 v47, v86, v87
    v_mfma_f32_16x16x32_bf16 v[32:35], a[48:51], v[152:155], v[56:59]
    ds_read_b128 a[16:19], v1 offset:45056
    v_mfma_f32_16x16x32_bf16 v[36:39], a[48:51], v[168:171], v[60:63]
    buffer_load_dwordx4 v3, s[8:11], s27 offen offset:1024 sc1 lds
    v_mfma_f32_16x16x32_bf16 v[72:75], a[128:131], v[40:43], v[64:67]
    v_exp_f32 v80, v24
    v_mfma_f32_16x16x32_bf16 v[76:79], a[128:131], v[44:47], v[68:71]
    ds_read_b128 a[20:23], v1 offset:46080
    buffer_load_dwordx4 v3, s[8:11], s27 offen offset:2048 sc1 lds
    v_mfma_f32_16x16x32_bf16 v[32:35], a[52:55], v[156:159], v[32:35]
    v_exp_f32 v81, v25
    v_mfma_f32_16x16x32_bf16 v[36:39], a[52:55], v[172:175], v[36:39]
    ds_read_b128 a[24:27], v1 offset:47104
    v_cvt_pk_bf16_f32 v48, v80, v81
    v_mfma_f32_16x16x32_bf16 v[32:35], a[56:59], v[160:163], v[32:35]
    v_max_f32 v6, v72, v76
    v_cmp_lt_f32 vcc, s37, v6
    v_mfma_f32_16x16x32_bf16 v[36:39], a[56:59], v[176:179], v[36:39]
    ds_read_b128 a[28:31], v1 offset:48128
    buffer_load_dwordx4 v3, s[8:11], s27 offen offset:3072 sc1 lds
    v_mfma_f32_16x16x32_bf16 v[32:35], a[60:63], v[164:167], v[32:35]
    s_waitcnt lgkmcnt(8)
    v_exp_f32 v82, v26
    v_mfma_f32_16x16x32_bf16 v[36:39], a[60:63], v[180:183], v[36:39]
    s_cbranch_vccnz FB_concat_9
BK_concat_10:
    ds_read_b128 a[96:99], v1 offset:32768
    v_mfma_f32_16x16x32_bf16 v[88:91], a[64:67], v[40:43], v[88:91]
    s_lshl_b32 s55, s53, 3
    v_exp_f32 v83, v27
    v_mfma_f32_16x16x32_bf16 v[92:95], a[64:67], v[44:47], v[92:95]
    s_add_u32 s55, s55, s52
    ds_read_b128 a[100:103], v1 offset:33792
    v_cvt_pk_bf16_f32 v49, v82, v83
    v_mfma_f32_16x16x32_bf16 v[96:99], a[68:71], v[40:43], v[96:99]
    s_and_b32 s55, s55, 15
    v_exp_f32 v84, v28
    v_mfma_f32_16x16x32_bf16 v[100:103], a[68:71], v[44:47], v[100:103]
    s_lshl_b32 s55, s55, 16
    v_exp_f32 v85, v29
    v_mfma_f32_16x16x32_bf16 v[104:107], a[72:75], v[40:43], v[104:107]
    s_add_u32 s55, s55, s57
    v_exp_f32 v86, v30
    v_mfma_f32_16x16x32_bf16 v[108:111], a[72:75], v[44:47], v[108:111]
    s_cmp_le_u32 s53, 2
    ds_read_b128 a[104:107], v1 offset:34816
    v_cvt_pk_bf16_f32 v52, v84, v85
    v_mfma_f32_16x16x32_bf16 v[112:115], a[76:79], v[40:43], v[112:115]
    s_cselect_b32 s55, s55, 0x40000000
    v_exp_f32 v87, v31
    v_mfma_f32_16x16x32_bf16 v[116:119], a[76:79], v[44:47], v[116:119]
    ds_read_b128 a[108:111], v1 offset:35840
    v_cvt_pk_bf16_f32 v53, v86, v87
    v_mfma_f32_16x16x32_bf16 v[120:123], a[80:83], v[40:43], v[120:123]
    s_add_u32 s29, s29, 57344
    v_exp_f32 v80, v32
    v_mfma_f32_16x16x32_bf16 v[124:127], a[80:83], v[44:47], v[124:127]
    s_xor_b32 s42, s42, 0x10000
    ds_read_b128 a[112:115], v1 offset:36864
    buffer_load_dword v254, v253, s[60:63], s55 offen
    v_mfma_f32_16x16x32_bf16 v[128:131], a[84:87], v[40:43], v[128:131]
    v_exp_f32 v81, v33
    v_mfma_f32_16x16x32_bf16 v[132:135], a[84:87], v[44:47], v[132:135]
    ds_read_b128 a[116:119], v1 offset:37888
    v_cvt_pk_bf16_f32 v50, v80, v81
    v_mfma_f32_16x16x32_bf16 v[136:139], a[88:91], v[40:43], v[136:139]
    v_exp_f32 v82, v34
    v_mfma_f32_16x16x32_bf16 v[140:143], a[88:91], v[44:47], v[140:143]
    ds_read_b128 a[120:123], v1 offset:38912
    v_mfma_f32_16x16x32_bf16 v[144:147], a[92:95], v[40:43], v[144:147]
    v_exp_f32 v83, v35
    v_mfma_f32_16x16x32_bf16 v[148:151], a[92:95], v[44:47], v[148:151]
    s_waitcnt lgkmcnt(7)
    ds_read_b128 a[124:127], v1 offset:39936
    v_cvt_pk_bf16_f32 v51, v82, v83
    v_mfma_f32_16x16x32_bf16 v[8:11], a[0:3], v[152:155], v[56:59]
    v_exp_f32 v84, v36
    v_mfma_f32_16x16x32_bf16 v[12:15], a[0:3], v[168:171], v[60:63]
    ds_read_b128 a[32:35], v1 offset:49152
    ds_read_b128 a[36:39], v1 offset:50176
    v_mfma_f32_16x16x32_bf16 v[8:11], a[4:7], v[156:159], v[8:11]
    v_exp_f32 v85, v37
    v_mfma_f32_16x16x32_bf16 v[12:15], a[4:7], v[172:175], v[12:15]
    ds_read_b128 a[40:43], v1 offset:51200
    v_cvt_pk_bf16_f32 v54, v84, v85
    v_mfma_f32_16x16x32_bf16 v[8:11], a[8:11], v[160:163], v[8:11]
    v_exp_f32 v86, v38
    v_mfma_f32_16x16x32_bf16 v[12:15], a[8:11], v[176:179], v[12:15]
    ds_read_b128 a[44:47], v1 offset:52224
    ds_read_b128 a[48:51], v1 offset:53248
    v_mfma_f32_16x16x32_bf16 v[8:11], a[12:15], v[164:167], v[8:11]
    v_exp_f32 v87, v39
    v_mfma_f32_16x16x32_bf16 v[12:15], a[12:15], v[180:183], v[12:15]
    ds_read_b128 a[52:55], v1 offset:54272
    v_cvt_pk_bf16_f32 v55, v86, v87
    v_mfma_f32_16x16x32_bf16 v[16:19], a[16:19], v[152:155], v[56:59]
    ds_read_b128 a[56:59], v1 offset:55296
    v_mfma_f32_16x16x32_bf16 v[20:23], a[16:19], v[168:171], v[60:63]
    ds_read_b128 a[60:63], v1 offset:56320
    v_mfma_f32_16x16x32_bf16 v[64:67], a[128:131], v[48:51], v[72:75]
    v_exp_f32 v80, v8
    v_mfma_f32_16x16x32_bf16 v[68:71], a[128:131], v[52:55], v[76:79]
    ds_read_b128 a[64:67], v1 offset:57344
    v_mfma_f32_16x16x32_bf16 v[16:19], a[20:23], v[156:159], v[16:19]
    v_exp_f32 v81, v9
    v_mfma_f32_16x16x32_bf16 v[20:23], a[20:23], v[172:175], v[20:23]
    ds_read_b128 a[68:71], v1 offset:58368
    v_cvt_pk_bf16_f32 v40, v80, v81
    v_mfma_f32_16x16x32_bf16 v[16:19], a[24:27], v[160:163], v[16:19]
    s_nop 0
    v_max_f32 v6, v64, v68
    v_cmp_lt_f32 vcc, s37, v6
    v_mfma_f32_16x16x32_bf16 v[20:23], a[24:27], v[176:179], v[20:23]
    ds_read_b128 a[72:75], v1 offset:59392
    ds_read_b128 a[76:79], v1 offset:60416
    v_mfma_f32_16x16x32_bf16 v[16:19], a[28:31], v[164:167], v[16:19]
    s_waitcnt lgkmcnt(12)
    v_exp_f32 v82, v10
    v_mfma_f32_16x16x32_bf16 v[20:23], a[28:31], v[180:183], v[20:23]
    s_cbranch_vccnz FB_concat_11
BK_concat_12:
    ds_read_b128 a[80:83], v1 offset:61440
    v_mfma_f32_16x16x32_bf16 v[88:91], a[96:99], v[48:51], v[88:91]
    v_exp_f32 v83, v11
    v_mfma_f32_16x16x32_bf16 v[92:95], a[96:99], v[52:55], v[92:95]
    ds_read_b128 a[84:87], v1 offset:62464
    v_cvt_pk_bf16_f32 v41, v82, v83
    v_mfma_f32_16x16x32_bf16 v[96:99], a[100:103], v[48:51], v[96:99]
    v_exp_f32 v84, v12
    v_mfma_f32_16x16x32_bf16 v[100:103], a[100:103], v[52:55], v[100:103]
    v_exp_f32 v85, v13
    v_mfma_f32_16x16x32_bf16 v[104:107], a[104:107], v[48:51], v[104:107]
    v_exp_f32 v86, v14
    v_mfma_f32_16x16x32_bf16 v[108:111], a[104:107], v[52:55], v[108:111]
    ds_read_b128 a[88:91], v1 offset:63488
    v_cvt_pk_bf16_f32 v44, v84, v85
    v_mfma_f32_16x16x32_bf16 v[112:115], a[108:111], v[48:51], v[112:115]
    v_exp_f32 v87, v15
    v_mfma_f32_16x16x32_bf16 v[116:119], a[108:111], v[52:55], v[116:119]
    ds_read_b128 a[92:95], v1 offset:64512
    v_cvt_pk_bf16_f32 v45, v86, v87
    v_mfma_f32_16x16x32_bf16 v[120:123], a[112:115], v[48:51], v[120:123]
    v_exp_f32 v80, v16
    v_mfma_f32_16x16x32_bf16 v[124:127], a[112:115], v[52:55], v[124:127]
    v_xor_b32 v1, 0x10000, v1
    v_mfma_f32_16x16x32_bf16 v[128:131], a[116:119], v[48:51], v[128:131]
    v_exp_f32 v81, v17
    v_mfma_f32_16x16x32_bf16 v[132:135], a[116:119], v[52:55], v[132:135]
    s_sub_u32 s53, s53, 1
    v_cvt_pk_bf16_f32 v42, v80, v81
    v_mfma_f32_16x16x32_bf16 v[136:139], a[120:123], v[48:51], v[136:139]
    s_sub_u32 s34, s34, 1
    v_exp_f32 v82, v18
    v_mfma_f32_16x16x32_bf16 v[140:143], a[120:123], v[52:55], v[140:143]
    s_cmp_lg_u32 s34, 0
    v_mfma_f32_16x16x32_bf16 v[144:147], a[124:127], v[48:51], v[144:147]
    v_exp_f32 v83, v19
    v_mfma_f32_16x16x32_bf16 v[148:151], a[124:127], v[52:55], v[148:151]
    s_waitcnt vmcnt(1) lgkmcnt(0)
    v_cvt_pk_bf16_f32 v43, v82, v83
    s_cbranch_scc1 L2_loop
L2_tail:
    s_cmp_lg_u32 s35, 0
    s_cbranch_scc1 L2_ftail
    buffer_load_dword v219, v218, s[12:15], s59 offen sc1
    s_cmp_eq_u32 s24, 0
    s_cbranch_scc1 L2_tail0
    s_cmp_eq_u32 s24, 1
    s_cbranch_scc1 L2_tail1
    s_cmp_eq_u32 s24, 2
    s_cbranch_scc1 L2_tail2
    v_mfma_f32_16x16x32_bf16 v[24:27], a[32:35], v[152:155], v[56:59]
    s_barrier
    ds_read_b128 a[0:3], v1 offset:8192
    ds_read_b128 a[4:7], v1 offset:9216
    ds_read_b128 a[8:11], v1 offset:10240
    ds_read_b128 a[12:15], v1 offset:11264
    ds_read_b128 a[96:99], v1 offset:0
    ds_read_b128 a[100:103], v1 offset:1024
    ds_read_b128 a[104:107], v1 offset:2048
    ds_read_b128 a[108:111], v1 offset:3072
    s_add_u32 m0, s42, 0
    v_mfma_f32_16x16x32_bf16 v[28:31], a[32:35], v[168:171], v[60:63]
    s_sub_u32 s27, s29, s32
    v_exp_f32 v84, v20
    v_mfma_f32_16x16x32_bf16 v[24:27], a[36:39], v[156:159], v[24:27]
    s_min_u32 s27, s29, s27
    ds_read_b128 a[112:115], v1 offset:4096
    ds_read_b128 a[116:119], v1 offset:5120
    v_mfma_f32_16x16x32_bf16 v[28:31], a[36:39], v[172:175], v[28:31]
    v_exp_f32 v85, v21
    v_mfma_f32_16x16x32_bf16 v[24:27], a[40:43], v[160:163], v[24:27]
    buffer_load_dwordx4 v2, s[8:11], s27 offen offset:0 sc1 lds
    v_mfma_f32_16x16x32_bf16 v[28:31], a[40:43], v[176:179], v[28:31]
    v_exp_f32 v86, v22
    v_mfma_f32_16x16x32_bf16 v[24:27], a[44:47], v[164:167], v[24:27]
    ds_read_b128 a[120:123], v1 offset:6144
    ds_read_b128 a[124:127], v1 offset:7168
    v_mfma_f32_16x16x32_bf16 v[28:31], a[44:47], v[180:183], v[28:31]
    v_exp_f32 v87, v23
    v_mfma_f32_16x16x32_bf16 v[32:35], a[48:51], v[152:155], v[56:59]
    buffer_load_dwordx4 v2, s[8:11], s27 offen offset:1024 sc1 lds
    v_cvt_pk_bf16_f32 v46, v84, v85
    v_mfma_f32_16x16x32_bf16 v[36:39], a[48:51], v[168:171], v[60:63]
    ds_read_b128 a[172:175], v1 offset:24576
    v_cvt_pk_bf16_f32 v47, v86, v87
    v_mfma_f32_16x16x32_bf16 v[32:35], a[52:55], v[156:159], v[32:35]
    ds_read_b128 a[176:179], v1 offset:25600
    ds_read_b128 a[180:183], v1 offset:26624
    v_mfma_f32_16x16x32_bf16 v[72:75], a[128:131], v[40:43], v[64:67]
    ds_read_b128 a[184:187], v1 offset:27648
    ds_read_b128 a[188:191], v1 offset:28672
    v_mfma_f32_16x16x32_bf16 v[76:79], a[128:131], v[44:47], v[68:71]
    buffer_load_dwordx4 v2, s[8:11], s27 offen offset:2048 sc1 lds
    v_mfma_f32_16x16x32_bf16 v[36:39], a[52:55], v[172:175], v[36:39]
    ds_read_b128 a[192:195], v1 offset:29696
    v_mfma_f32_16x16x32_bf16 v[32:35], a[56:59], v[160:163], v[32:35]
    ds_read_b128 a[196:199], v1 offset:30720
    v_mfma_f32_16x16x32_bf16 v[36:39], a[56:59], v[176:179], v[36:39]
    ds_read_b128 a[200:203], v1 offset:31744
    v_mfma_f32_16x16x32_bf16 v[32:35], a[60:63], v[164:167], v[32:35]
    buffer_load_dwordx4 v2, s[8:11], s27 offen offset:3072 sc1 lds
    v_max_f32 v6, v72, v76
    v_mfma_f32_16x16x32_bf16 v[36:39], a[60:63], v[180:183], v[36:39]
    s_add_u32 m0, s42, 4096
    v_cmp_lt_f32 vcc, s37, v6
    s_nop 0
    s_cbranch_vccnz FB_concat_13
BK_concat_14:
    v_mfma_f32_16x16x32_bf16 v[88:91], a[64:67], v[40:43], v[88:91]
    buffer_load_dwordx4 v3, s[8:11], s27 offen offset:0 sc1 lds
    v_mfma_f32_16x16x32_bf16 v[92:95], a[64:67], v[44:47], v[92:95]
    v_exp_f32 v80, v24
    v_mfma_f32_16x16x32_bf16 v[96:99], a[68:71], v[40:43], v[96:99]
    buffer_load_dwordx4 v3, s[8:11], s27 offen offset:1024 sc1 lds
    v_mfma_f32_16x16x32_bf16 v[100:103], a[68:71], v[44:47], v[100:103]
    v_exp_f32 v81, v25
    v_mfma_f32_16x16x32_bf16 v[104:107], a[72:75], v[40:43], v[104:107]
    buffer_load_dwordx4 v3, s[8:11], s27 offen offset:2048 sc1 lds
    v_mfma_f32_16x16x32_bf16 v[108:111], a[72:75], v[44:47], v[108:111]
    v_exp_f32 v82, v26
    v_mfma_f32_16x16x32_bf16 v[112:115], a[76:79], v[40:43], v[112:115]
    buffer_load_dwordx4 v3, s[8:11], s27 offen offset:3072 sc1 lds
    v_cvt_pk_bf16_f32 v48, v80, v81
    v_mfma_f32_16x16x32_bf16 v[116:119], a[76:79], v[44:47], v[116:119]
    s_add_u32 m0, s42, 8192
    v_exp_f32 v83, v27
    v_mfma_f32_16x16x32_bf16 v[120:123], a[80:83], v[40:43], v[120:123]
    s_add_u32 s29, s29, 8192
    s_sub_u32 s27, s29, s32
    v_cvt_pk_bf16_f32 v49, v82, v83
    v_mfma_f32_16x16x32_bf16 v[124:127], a[80:83], v[44:47], v[124:127]
    s_min_u32 s27, s29, s27
    v_exp_f32 v84, v28
    v_mfma_f32_16x16x32_bf16 v[128:131], a[84:87], v[40:43], v[128:131]
    buffer_load_dwordx4 v2, s[8:11], s27 offen offset:0 sc1 lds
    v_mfma_f32_16x16x32_bf16 v[132:135], a[84:87], v[44:47], v[132:135]
    v_exp_f32 v85, v29
    v_mfma_f32_16x16x32_bf16 v[136:139], a[88:91], v[40:43], v[136:139]
    buffer_load_dwordx4 v2, s[8:11], s27 offen offset:1024 sc1 lds
    v_mfma_f32_16x16x32_bf16 v[140:143], a[88:91], v[44:47], v[140:143]
    v_exp_f32 v86, v30
    v_mfma_f32_16x16x32_bf16 v[144:147], a[92:95], v[40:43], v[144:147]
    buffer_load_dwordx4 v2, s[8:11], s27 offen offset:2048 sc1 lds
    v_cvt_pk_bf16_f32 v52, v84, v85
    v_mfma_f32_16x16x32_bf16 v[148:151], a[92:95], v[44:47], v[148:151]
    v_exp_f32 v87, v31
    s_waitcnt lgkmcnt(15)
    v_cvt_pk_bf16_f32 v53, v86, v87
    v_cndmask_b32 v32, v32, v5, s[16:17]
    v_cndmask_b32 v33, v33, v5, s[18:19]
    v_cndmask_b32 v34, v34, v5, s[20:21]
    v_cndmask_b32 v35, v35, v5, s[22:23]
    v_exp_f32 v80, v32
    v_exp_f32 v81, v33
    v_exp_f32 v82, v34
    v_cvt_pk_bf16_f32 v50, v80, v81
    v_exp_f32 v83, v35
    s_nop 0
    v_cvt_pk_bf16_f32 v51, v82, v83
    v_exp_f32 v84, v36
    v_exp_f32 v85, v37
    v_exp_f32 v86, v38
    v_cvt_pk_bf16_f32 v54, v84, v85
    v_exp_f32 v87, v39
    s_nop 0
    v_cvt_pk_bf16_f32 v55, v86, v87
    v_mfma_f32_16x16x32_bf16 v[64:67], a[128:131], v[48:51], v[72:75]
    buffer_load_dwordx4 v2, s[8:11], s27 offen offset:3072 sc1 lds
    v_mfma_f32_16x16x32_bf16 v[68:71], a[128:131], v[52:55], v[76:79]
    s_add_u32 m0, s42, 12288
    v_mfma_f32_16x16x32_bf16 v[12:15], a[0:3], v[168:171], v[60:63]
    buffer_load_dwordx4 v3, s[8:11], s27 offen offset:0 sc1 lds
    v_mfma_f32_16x16x32_bf16 v[12:15], a[4:7], v[172:175], v[12:15]
    buffer_load_dwordx4 v3, s[8:11], s27 offen offset:1024 sc1 lds
    v_mfma_f32_16x16x32_bf16 v[12:15], a[8:11], v[176:179], v[12:15]
    buffer_load_dwordx4 v3, s[8:11], s27 offen offset:2048 sc1 lds
    v_mfma_f32_16x16x32_bf16 v[12:15], a[12:15], v[180:183], v[12:15]
    buffer_load_dwordx4 v3, s[8:11], s27 offen offset:3072 sc1 lds
    v_max_f32 v6, v64, v68
    v_cmp_lt_f32 vcc, s37, v6
    s_waitcnt lgkmcnt(8)
    s_cbranch_vccnz FB_concat_15
BK_concat_16:
    v_mfma_f32_16x16x32_bf16 v[88:91], a[96:99], v[48:51], v[88:91]
    s_add_u32 s29, s29, 57344
    ds_read_b128 a[32:35], v1 offset:49152
    ds_read_b128 a[36:39], v1 offset:50176
    v_mfma_f32_16x16x32_bf16 v[92:95], a[96:99], v[52:55], v[92:95]
    s_xor_b32 s42, s42, 0x10000
    v_rcp_f32 v217, v64
    v_mfma_f32_16x16x32_bf16 v[96:99], a[100:103], v[48:51], v[96:99]
    ds_read_b128 a[40:43], v1 offset:51200
    v_cndmask_b32 v12, v12, v5, s[16:17]
    v_mfma_f32_16x16x32_bf16 v[100:103], a[100:103], v[52:55], v[100:103]
    ds_read_b128 a[44:47], v1 offset:52224
    v_cndmask_b32 v13, v13, v5, s[18:19]
    v_mfma_f32_16x16x32_bf16 v[104:107], a[104:107], v[48:51], v[104:107]
    ds_read_b128 a[48:51], v1 offset:53248
    v_cndmask_b32 v14, v14, v5, s[20:21]
    v_mfma_f32_16x16x32_bf16 v[108:111], a[104:107], v[52:55], v[108:111]
    ds_read_b128 a[52:55], v1 offset:54272
    v_cndmask_b32 v15, v15, v5, s[22:23]
    v_mfma_f32_16x16x32_bf16 v[112:115], a[108:111], v[48:51], v[112:115]
    v_exp_f32 v84, v12
    v_mfma_f32_16x16x32_bf16 v[116:119], a[108:111], v[52:55], v[116:119]
    v_exp_f32 v85, v13
    v_mfma_f32_16x16x32_bf16 v[120:123], a[112:115], v[48:51], v[120:123]
    v_exp_f32 v86, v14
    v_mfma_f32_16x16x32_bf16 v[124:127], a[112:115], v[52:55], v[124:127]
    ds_read_b128 a[56:59], v1 offset:55296
    v_cvt_pk_bf16_f32 v44, v84, v85
    v_mfma_f32_16x16x32_bf16 v[128:131], a[116:119], v[48:51], v[128:131]
    v_exp_f32 v87, v15
    v_mfma_f32_16x16x32_bf16 v[132:135], a[116:119], v[52:55], v[132:135]
    ds_read_b128 a[60:63], v1 offset:56320
    v_cvt_pk_bf16_f32 v45, v86, v87
    v_mfma_f32_16x16x32_bf16 v[136:139], a[120:123], v[48:51], v[136:139]
    ds_read_b128 a[64:67], v1 offset:57344
    v_mov_b32 v20, v5
    v_mfma_f32_16x16x32_bf16 v[140:143], a[120:123], v[52:55], v[140:143]
    ds_read_b128 a[68:71], v1 offset:58368
    v_mov_b32 v21, v5
    v_mfma_f32_16x16x32_bf16 v[144:147], a[124:127], v[48:51], v[144:147]
    ds_read_b128 a[72:75], v1 offset:59392
    v_mov_b32 v22, v5
    v_mfma_f32_16x16x32_bf16 v[148:151], a[124:127], v[52:55], v[148:151]
    ds_read_b128 a[76:79], v1 offset:60416
    v_mov_b32 v23, v5
    v_mov_b32 v46, 0
    v_mov_b32 v47, 0
    s_nop 1
    v_mfma_f32_16x16x32_bf16 v[76:79], a[128:131], v[44:47], v[68:71]
    ds_read_b128 a[80:83], v1 offset:61440
    ds_read_b128 a[84:87], v1 offset:62464
    v_mul_f32 v217, s43, v217
    v_mul_f32 v88, v88, v217
    v_mul_f32 v89, v89, v217
    v_mul_f32 v90, v90, v217
    v_mul_f32 v91, v91, v217
    v_cvt_pk_bf16_f32 v88, v88, v89
    v_cmp_lt_f32 vcc, s37, v76
    s_waitcnt lgkmcnt(14)
    s_cbranch_vccnz FB_concat_17
BK_concat_18:
    v_mfma_f32_16x16x32_bf16 v[92:95], a[172:175], v[44:47], v[92:95]
    ds_read_b128 a[88:91], v1 offset:63488
    ds_read_b128 a[92:95], v1 offset:64512
    v_mfma_f32_16x16x32_bf16 v[100:103], a[176:179], v[44:47], v[100:103]
    ds_read_b128 a[0:3], v1 offset:40960
    ds_read_b128 a[4:7], v1 offset:41984
    v_mfma_f32_16x16x32_bf16 v[108:111], a[180:183], v[44:47], v[108:111]
    ds_read_b128 a[8:11], v1 offset:43008
    ds_read_b128 a[12:15], v1 offset:44032
    v_mfma_f32_16x16x32_bf16 v[116:119], a[184:187], v[44:47], v[116:119]
    ds_read_b128 a[16:19], v1 offset:45056
    ds_read_b128 a[20:23], v1 offset:46080
    v_mfma_f32_16x16x32_bf16 v[124:127], a[188:191], v[44:47], v[124:127]
    ds_read_b128 a[24:27], v1 offset:47104
    ds_read_b128 a[28:31], v1 offset:48128
    v_mfma_f32_16x16x32_bf16 v[132:135], a[192:195], v[44:47], v[132:135]
    v_xor_b32 v1, 0x10000, v1
    v_cvt_pk_bf16_f32 v89, v90, v91
    v_mfma_f32_16x16x32_bf16 v[140:143], a[196:199], v[44:47], v[140:143]
    v_mul_f32 v96, v96, v217
    v_mul_f32 v97, v97, v217
    v_mfma_f32_16x16x32_bf16 v[148:151], a[200:203], v[44:47], v[148:151]
    v_mul_f32 v98, v98, v217
    v_mul_f32 v99, v99, v217
    v_cvt_pk_bf16_f32 v90, v96, v97
    v_mov_b32 v152, v184
    v_cvt_pk_bf16_f32 v91, v98, v99
    v_mov_b32 v153, v185
    buffer_store_dwordx4 v[88:91], v2, s[12:15], s36 offen offset:0 sc1
    v_mov_b32 v154, v186
    v_mul_f32 v104, v104, v217
    v_mov_b32 v155, v187
    v_mul_f32 v105, v105, v217
    v_mov_b32 v156, v188
    v_mul_f32 v106, v106, v217
    v_mov_b32 v157, v189
    v_mul_f32 v107, v107, v217
    v_mov_b32 v158, v190
    v_cvt_pk_bf16_f32 v104, v104, v105
    v_mov_b32 v159, v191
    v_cvt_pk_bf16_f32 v105, v106, v107
    v_mov_b32 v160, v192
    v_mul_f32 v112, v112, v217
    v_mov_b32 v161, v193
    v_mul_f32 v113, v113, v217
    v_mov_b32 v162, v194
    v_mul_f32 v114, v114, v217
    v_mov_b32 v163, v195
    v_mul_f32 v115, v115, v217
    v_mov_b32 v164, v196
    v_cvt_pk_bf16_f32 v106, v112, v113
    v_mov_b32 v165, v197
    v_cvt_pk_bf16_f32 v107, v114, v115
    v_mov_b32 v166, v198
    buffer_store_dwordx4 v[104:107], v2, s[12:15], s36 offen offset:1024 sc1
    v_mov_b32 v167, v199
    v_mul_f32 v120, v120, v217
    v_mov_b32 v168, v200
    v_mul_f32 v121, v121, v217
    v_mov_b32 v169, v201
    v_mul_f32 v122, v122, v217
    v_mov_b32 v170, v202
    v_mul_f32 v123, v123, v217
    v_mov_b32 v171, v203
    v_cvt_pk_bf16_f32 v120, v120, v121
    v_mov_b32 v172, v204
    v_cvt_pk_bf16_f32 v121, v122, v123
    v_mov_b32 v173, v205
    v_mul_f32 v128, v128, v217
    v_mov_b32 v174, v206
    v_mul_f32 v129, v129, v217
    v_mov_b32 v175, v207
    v_mul_f32 v130, v130, v217
    v_mov_b32 v176, v208
    v_mul_f32 v131, v131, v217
    v_mov_b32 v177, v209
    v_cvt_pk_bf16_f32 v122, v128, v129
    v_mov_b32 v178, v210
    v_cvt_pk_bf16_f32 v123, v130, v131
    v_mov_b32 v179, v211
    buffer_store_dwordx4 v[120:123], v2, s[12:15], s36 offen offset:2048 sc1
    v_mov_b32 v180, v212
    v_mul_f32 v136, v136, v217
    v_mov_b32 v181, v213
    v_mul_f32 v137, v137, v217
    v_mov_b32 v182, v214
    v_mul_f32 v138, v138, v217
    v_mov_b32 v183, v215
    v_mul_f32 v139, v139, v217
    v_cvt_pk_bf16_f32 v136, v136, v137
    v_cvt_pk_bf16_f32 v137, v138, v139
    v_mul_f32 v144, v144, v217
    v_mul_f32 v145, v145, v217
    v_mul_f32 v146, v146, v217
    v_mul_f32 v147, v147, v217
    v_cvt_pk_bf16_f32 v138, v144, v145
    v_cvt_pk_bf16_f32 v139, v146, v147
    buffer_store_dwordx4 v[136:139], v2, s[12:15], s36 offen offset:3072 sc1
    v_rcp_f32 v7, v76
    s_nop 0
    v_mul_f32 v7, s43, v7
    s_waitcnt vmcnt(4)
    s_waitcnt lgkmcnt(0)
    s_branch L2_epi
L2_tail2:
    v_mfma_f32_16x16x32_bf16 v[24:27], a[32:35], v[152:155], v[56:59]
    s_barrier
    ds_read_b128 a[0:3], v1 offset:8192
    ds_read_b128 a[4:7], v1 offset:9216
    ds_read_b128 a[8:11], v1 offset:10240
    ds_read_b128 a[12:15], v1 offset:11264
    ds_read_b128 a[16:19], v1 offset:12288
    ds_read_b128 a[20:23], v1 offset:13312
    ds_read_b128 a[24:27], v1 offset:14336
    ds_read_b128 a[28:31], v1 offset:15360
    s_add_u32 m0, s42, 0
    v_mfma_f32_16x16x32_bf16 v[28:31], a[32:35], v[168:171], v[60:63]
    s_sub_u32 s27, s29, s32
    v_exp_f32 v84, v20
    v_mfma_f32_16x16x32_bf16 v[24:27], a[36:39], v[156:159], v[24:27]
    s_min_u32 s27, s29, s27
    ds_read_b128 a[96:99], v1 offset:0
    ds_read_b128 a[100:103], v1 offset:1024
    v_mfma_f32_16x16x32_bf16 v[28:31], a[36:39], v[172:175], v[28:31]
    v_exp_f32 v85, v21
    v_mfma_f32_16x16x32_bf16 v[24:27], a[40:43], v[160:163], v[24:27]
    buffer_load_dwordx4 v2, s[8:11], s27 offen offset:0 sc1 lds
    v_mfma_f32_16x16x32_bf16 v[28:31], a[40:43], v[176:179], v[28:31]
    v_exp_f32 v86, v22
    v_mfma_f32_16x16x32_bf16 v[24:27], a[44:47], v[164:167], v[24:27]
    ds_read_b128 a[104:107], v1 offset:2048
    ds_read_b128 a[108:111], v1 offset:3072
    v_exp_f32 v87, v23
    v_cvt_pk_bf16_f32 v46, v84, v85
    v_cvt_pk_bf16_f32 v47, v86, v87
    v_mfma_f32_16x16x32_bf16 v[72:75], a[128:131], v[40:43], v[64:67]
    ds_read_b128 a[112:115], v1 offset:4096
    ds_read_b128 a[116:119], v1 offset:5120
    v_mfma_f32_16x16x32_bf16 v[76:79], a[128:131], v[44:47], v[68:71]
    buffer_load_dwordx4 v2, s[8:11], s27 offen offset:1024 sc1 lds
    v_mfma_f32_16x16x32_bf16 v[28:31], a[44:47], v[180:183], v[28:31]
    ds_read_b128 a[120:123], v1 offset:6144
    v_mfma_f32_16x16x32_bf16 v[36:39], a[48:51], v[168:171], v[60:63]
    ds_read_b128 a[124:127], v1 offset:7168
    v_mfma_f32_16x16x32_bf16 v[36:39], a[52:55], v[172:175], v[36:39]
    ds_read_b128 a[172:175], v1 offset:24576
    v_mfma_f32_16x16x32_bf16 v[36:39], a[56:59], v[176:179], v[36:39]
    buffer_load_dwordx4 v2, s[8:11], s27 offen offset:2048 sc1 lds
    v_max_f32 v6, v72, v76
    v_mfma_f32_16x16x32_bf16 v[36:39], a[60:63], v[180:183], v[36:39]
    ds_read_b128 a[176:179], v1 offset:25600
    v_cmp_lt_f32 vcc, s37, v6
    s_nop 0
    s_cbranch_vccnz FB_concat_19
BK_concat_20:
    v_mfma_f32_16x16x32_bf16 v[88:91], a[64:67], v[40:43], v[88:91]
    ds_read_b128 a[180:183], v1 offset:26624
    v_cndmask_b32 v24, v24, v5, s[16:17]
    v_mfma_f32_16x16x32_bf16 v[92:95], a[64:67], v[44:47], v[92:95]
    ds_read_b128 a[184:187], v1 offset:27648
    v_cndmask_b32 v25, v25, v5, s[18:19]
    v_mfma_f32_16x16x32_bf16 v[96:99], a[68:71], v[40:43], v[96:99]
    buffer_load_dwordx4 v2, s[8:11], s27 offen offset:3072 sc1 lds
    v_cndmask_b32 v26, v26, v5, s[20:21]
    v_mfma_f32_16x16x32_bf16 v[100:103], a[68:71], v[44:47], v[100:103]
    s_add_u32 m0, s42, 4096
    ds_read_b128 a[188:191], v1 offset:28672
    v_cndmask_b32 v27, v27, v5, s[22:23]
    v_mfma_f32_16x16x32_bf16 v[104:107], a[72:75], v[40:43], v[104:107]
    ds_read_b128 a[192:195], v1 offset:29696
    ds_read_b128 a[196:199], v1 offset:30720
    v_mfma_f32_16x16x32_bf16 v[108:111], a[72:75], v[44:47], v[108:111]
    v_exp_f32 v80, v24
    v_mfma_f32_16x16x32_bf16 v[112:115], a[76:79], v[40:43], v[112:115]
    buffer_load_dwordx4 v3, s[8:11], s27 offen offset:0 sc1 lds
    v_mfma_f32_16x16x32_bf16 v[116:119], a[76:79], v[44:47], v[116:119]
    v_exp_f32 v81, v25
    v_mfma_f32_16x16x32_bf16 v[120:123], a[80:83], v[40:43], v[120:123]
    ds_read_b128 a[200:203], v1 offset:31744
    v_mfma_f32_16x16x32_bf16 v[124:127], a[80:83], v[44:47], v[124:127]
    v_exp_f32 v82, v26
    v_mfma_f32_16x16x32_bf16 v[128:131], a[84:87], v[40:43], v[128:131]
    buffer_load_dwordx4 v3, s[8:11], s27 offen offset:1024 sc1 lds
    v_cvt_pk_bf16_f32 v48, v80, v81
    v_mfma_f32_16x16x32_bf16 v[132:135], a[84:87], v[44:47], v[132:135]
    v_exp_f32 v83, v27
    v_mfma_f32_16x16x32_bf16 v[136:139], a[88:91], v[40:43], v[136:139]
    buffer_load_dwordx4 v3, s[8:11], s27 offen offset:2048 sc1 lds
    v_cvt_pk_bf16_f32 v49, v82, v83
    v_mfma_f32_16x16x32_bf16 v[140:143], a[88:91], v[44:47], v[140:143]
    v_exp_f32 v84, v28
    v_mfma_f32_16x16x32_bf16 v[144:147], a[92:95], v[40:43], v[144:147]
    buffer_load_dwordx4 v3, s[8:11], s27 offen offset:3072 sc1 lds
    v_mfma_f32_16x16x32_bf16 v[148:151], a[92:95], v[44:47], v[148:151]
    s_add_u32 m0, s42, 8192
    v_exp_f32 v85, v29
    s_waitcnt lgkmcnt(15)
    v_mfma_f32_16x16x32_bf16 v[12:15], a[0:3], v[168:171], v[60:63]
    s_add_u32 s29, s29, 8192
    ds_read_b128 a[32:35], v1 offset:49152
    ds_read_b128 a[36:39], v1 offset:50176
    v_mfma_f32_16x16x32_bf16 v[12:15], a[4:7], v[172:175], v[12:15]
    s_sub_u32 s27, s29, s32
    v_exp_f32 v86, v30
    v_mfma_f32_16x16x32_bf16 v[12:15], a[8:11], v[176:179], v[12:15]
    s_min_u32 s27, s29, s27
    buffer_load_dwordx4 v2, s[8:11], s27 offen offset:0 sc1 lds
    v_cvt_pk_bf16_f32 v52, v84, v85
    v_exp_f32 v87, v31
    s_nop 0
    v_cvt_pk_bf16_f32 v53, v86, v87
    v_mov_b32 v32, v5
    v_mov_b32 v33, v5
    v_mov_b32 v34, v5
    v_mov_b32 v35, v5
    v_mov_b32 v50, 0
    v_mov_b32 v51, 0
    v_exp_f32 v84, v36
    v_exp_f32 v85, v37
    v_exp_f32 v86, v38
    v_cvt_pk_bf16_f32 v54, v84, v85
    v_exp_f32 v87, v39
    s_nop 0
    v_cvt_pk_bf16_f32 v55, v86, v87
    v_mfma_f32_16x16x32_bf16 v[64:67], a[128:131], v[48:51], v[72:75]
    buffer_load_dwordx4 v2, s[8:11], s27 offen offset:1024 sc1 lds
    v_mfma_f32_16x16x32_bf16 v[68:71], a[128:131], v[52:55], v[76:79]
    buffer_load_dwordx4 v2, s[8:11], s27 offen offset:2048 sc1 lds
    v_mfma_f32_16x16x32_bf16 v[12:15], a[12:15], v[180:183], v[12:15]
    buffer_load_dwordx4 v2, s[8:11], s27 offen offset:3072 sc1 lds
    v_mfma_f32_16x16x32_bf16 v[20:23], a[16:19], v[168:171], v[60:63]
    s_add_u32 m0, s42, 12288
    v_mfma_f32_16x16x32_bf16 v[20:23], a[20:23], v[172:175], v[20:23]
    buffer_load_dwordx4 v3, s[8:11], s27 offen offset:0 sc1 lds
    v_mfma_f32_16x16x32_bf16 v[20:23], a[24:27], v[176:179], v[20:23]
    buffer_load_dwordx4 v3, s[8:11], s27 offen offset:1024 sc1 lds
    v_max_f32 v6, v64, v68
    v_mfma_f32_16x16x32_bf16 v[20:23], a[28:31], v[180:183], v[20:23]
    buffer_load_dwordx4 v3, s[8:11], s27 offen offset:2048 sc1 lds
    v_cmp_lt_f32 vcc, s37, v6
    s_waitcnt lgkmcnt(10)
    s_cbranch_vccnz FB_concat_21
BK_concat_22:
    v_mfma_f32_16x16x32_bf16 v[88:91], a[96:99], v[48:51], v[88:91]
    buffer_load_dwordx4 v3, s[8:11], s27 offen offset:3072 sc1 lds
    v_mov_b32 v152, v184
    v_mfma_f32_16x16x32_bf16 v[92:95], a[96:99], v[52:55], v[92:95]
    s_add_u32 s29, s29, 57344
    v_rcp_f32 v217, v64
    v_mfma_f32_16x16x32_bf16 v[96:99], a[100:103], v[48:51], v[96:99]
    s_xor_b32 s42, s42, 0x10000
    v_exp_f32 v84, v12
    v_mfma_f32_16x16x32_bf16 v[100:103], a[100:103], v[52:55], v[100:103]
    v_exp_f32 v85, v13
    v_mfma_f32_16x16x32_bf16 v[104:107], a[104:107], v[48:51], v[104:107]
    v_exp_f32 v86, v14
    v_mfma_f32_16x16x32_bf16 v[108:111], a[104:107], v[52:55], v[108:111]
    ds_read_b128 a[40:43], v1 offset:51200
    v_cvt_pk_bf16_f32 v44, v84, v85
    v_mfma_f32_16x16x32_bf16 v[112:115], a[108:111], v[48:51], v[112:115]
    v_exp_f32 v87, v15
    v_mfma_f32_16x16x32_bf16 v[116:119], a[108:111], v[52:55], v[116:119]
    ds_read_b128 a[44:47], v1 offset:52224
    v_cvt_pk_bf16_f32 v45, v86, v87
    v_mfma_f32_16x16x32_bf16 v[120:123], a[112:115], v[48:51], v[120:123]
    ds_read_b128 a[48:51], v1 offset:53248
    v_cndmask_b32 v20, v20, v5, s[16:17]
    v_mfma_f32_16x16x32_bf16 v[124:127], a[112:115], v[52:55], v[124:127]
    ds_read_b128 a[52:55], v1 offset:54272
    v_cndmask_b32 v21, v21, v5, s[18:19]
    v_mfma_f32_16x16x32_bf16 v[128:131], a[116:119], v[48:51], v[128:131]
    ds_read_b128 a[56:59], v1 offset:55296
    v_cndmask_b32 v22, v22, v5, s[20:21]
    v_mfma_f32_16x16x32_bf16 v[132:135], a[116:119], v[52:55], v[132:135]
    ds_read_b128 a[60:63], v1 offset:56320
    v_cndmask_b32 v23, v23, v5, s[22:23]
    v_mfma_f32_16x16x32_bf16 v[136:139], a[120:123], v[48:51], v[136:139]
    v_exp_f32 v84, v20
    v_mfma_f32_16x16x32_bf16 v[140:143], a[120:123], v[52:55], v[140:143]
    v_exp_f32 v85, v21
    v_mfma_f32_16x16x32_bf16 v[144:147], a[124:127], v[48:51], v[144:147]
    v_exp_f32 v86, v22
    v_mfma_f32_16x16x32_bf16 v[148:151], a[124:127], v[52:55], v[148:151]
    ds_read_b128 a[64:67], v1 offset:57344
    v_cvt_pk_bf16_f32 v46, v84, v85
    v_exp_f32 v87, v23
    v_mul_f32 v217, s43, v217
    v_cvt_pk_bf16_f32 v47, v86, v87
    s_nop 1
    v_mfma_f32_16x16x32_bf16 v[76:79], a[128:131], v[44:47], v[68:71]
    ds_read_b128 a[68:71], v1 offset:58368
    ds_read_b128 a[72:75], v1 offset:59392
    v_mul_f32 v88, v88, v217
    v_mul_f32 v89, v89, v217
    v_mul_f32 v90, v90, v217
    v_mul_f32 v91, v91, v217
    v_cvt_pk_bf16_f32 v88, v88, v89
    v_cvt_pk_bf16_f32 v89, v90, v91
    v_cmp_lt_f32 vcc, s37, v76
    s_waitcnt lgkmcnt(11)
    s_cbranch_vccnz FB_concat_23
BK_concat_24:
    v_mfma_f32_16x16x32_bf16 v[92:95], a[172:175], v[44:47], v[92:95]
    ds_read_b128 a[76:79], v1 offset:60416
    ds_read_b128 a[80:83], v1 offset:61440
    v_mfma_f32_16x16x32_bf16 v[100:103], a[176:179], v[44:47], v[100:103]
    ds_read_b128 a[84:87], v1 offset:62464
    ds_read_b128 a[88:91], v1 offset:63488
    v_mfma_f32_16x16x32_bf16 v[108:111], a[180:183], v[44:47], v[108:111]
    ds_read_b128 a[92:95], v1 offset:64512
    ds_read_b128 a[0:3], v1 offset:40960
    v_mfma_f32_16x16x32_bf16 v[116:119], a[184:187], v[44:47], v[116:119]
    ds_read_b128 a[4:7], v1 offset:41984
    ds_read_b128 a[8:11], v1 offset:43008
    v_mfma_f32_16x16x32_bf16 v[124:127], a[188:191], v[44:47], v[124:127]
    ds_read_b128 a[12:15], v1 offset:44032
    ds_read_b128 a[16:19], v1 offset:45056
    v_mfma_f32_16x16x32_bf16 v[132:135], a[192:195], v[44:47], v[132:135]
    ds_read_b128 a[20:23], v1 offset:46080
    ds_read_b128 a[24:27], v1 offset:47104
    v_mfma_f32_16x16x32_bf16 v[140:143], a[196:199], v[44:47], v[140:143]
    ds_read_b128 a[28:31], v1 offset:48128
    v_xor_b32 v1, 0x10000, v1
    v_mfma_f32_16x16x32_bf16 v[148:151], a[200:203], v[44:47], v[148:151]
    v_mul_f32 v96, v96, v217
    v_mul_f32 v97, v97, v217
    v_mul_f32 v98, v98, v217
    v_mov_b32 v153, v185
    v_mul_f32 v99, v99, v217
    v_mov_b32 v154, v186
    v_cvt_pk_bf16_f32 v90, v96, v97
    v_mov_b32 v155, v187
    v_cvt_pk_bf16_f32 v91, v98, v99
    v_mov_b32 v156, v188
    buffer_store_dwordx4 v[88:91], v2, s[12:15], s36 offen offset:0 sc1
    v_mov_b32 v157, v189
    v_mul_f32 v104, v104, v217
    v_mov_b32 v158, v190
    v_mul_f32 v105, v105, v217
    v_mov_b32 v159, v191
    v_mul_f32 v106, v106, v217
    v_mov_b32 v160, v192
    v_mul_f32 v107, v107, v217
    v_mov_b32 v161, v193
    v_cvt_pk_bf16_f32 v104, v104, v105
    v_mov_b32 v162, v194
    v_cvt_pk_bf16_f32 v105, v106, v107
    v_mov_b32 v163, v195
    v_mul_f32 v112, v112, v217
    v_mov_b32 v164, v196
    v_mul_f32 v113, v113, v217
    v_mov_b32 v165, v197
    v_mul_f32 v114, v114, v217
    v_mov_b32 v166, v198
    v_mul_f32 v115, v115, v217
    v_mov_b32 v167, v199
    v_cvt_pk_bf16_f32 v106, v112, v113
    v_mov_b32 v168, v200
    v_cvt_pk_bf16_f32 v107, v114, v115
    v_mov_b32 v169, v201
    buffer_store_dwordx4 v[104:107], v2, s[12:15], s36 offen offset:1024 sc1
    v_mov_b32 v170, v202
    v_mul_f32 v120, v120, v217
    v_mov_b32 v171, v203
    v_mul_f32 v121, v121, v217
    v_mov_b32 v172, v204
    v_mul_f32 v122, v122, v217
    v_mov_b32 v173, v205
    v_mul_f32 v123, v123, v217
    v_mov_b32 v174, v206
    v_cvt_pk_bf16_f32 v120, v120, v121
    v_mov_b32 v175, v207
    v_cvt_pk_bf16_f32 v121, v122, v123
    v_mov_b32 v176, v208
    v_mul_f32 v128, v128, v217
    v_mov_b32 v177, v209
    v_mul_f32 v129, v129, v217
    v_mov_b32 v178, v210
    v_mul_f32 v130, v130, v217
    v_mov_b32 v179, v211
    v_mul_f32 v131, v131, v217
    v_mov_b32 v180, v212
    v_cvt_pk_bf16_f32 v122, v128, v129
    v_mov_b32 v181, v213
    v_cvt_pk_bf16_f32 v123, v130, v131
    v_mov_b32 v182, v214
    buffer_store_dwordx4 v[120:123], v2, s[12:15], s36 offen offset:2048 sc1
    v_mov_b32 v183, v215
    v_mul_f32 v136, v136, v217
    v_mul_f32 v137, v137, v217
    v_mul_f32 v138, v138, v217
    v_mul_f32 v139, v139, v217
    v_cvt_pk_bf16_f32 v136, v136, v137
    v_cvt_pk_bf16_f32 v137, v138, v139
    v_mul_f32 v144, v144, v217
    v_mul_f32 v145, v145, v217
    v_mul_f32 v146, v146, v217
    v_mul_f32 v147, v147, v217
    v_cvt_pk_bf16_f32 v138, v144, v145
    v_cvt_pk_bf16_f32 v139, v146, v147
    buffer_store_dwordx4 v[136:139], v2, s[12:15], s36 offen offset:3072 sc1
    v_rcp_f32 v7, v76
    s_nop 0
    v_mul_f32 v7, s43, v7
    s_waitcnt vmcnt(4)
    s_waitcnt lgkmcnt(0)
    s_branch L2_epi
L2_tail1:
    v_mfma_f32_16x16x32_bf16 v[28:31], a[32:35], v[168:171], v[60:63]
    s_barrier
    ds_read_b128 a[0:3], v1 offset:8192
    ds_read_b128 a[4:7], v1 offset:9216
    ds_read_b128 a[8:11], v1 offset:10240
    ds_read_b128 a[12:15], v1 offset:11264
    ds_read_b128 a[16:19], v1 offset:12288
    ds_read_b128 a[20:23], v1 offset:13312
    ds_read_b128 a[24:27], v1 offset:14336
    ds_read_b128 a[28:31], v1 offset:15360
    s_add_u32 m0, s42, 0
    v_mfma_f32_16x16x32_bf16 v[28:31], a[36:39], v[172:175], v[28:31]
    s_sub_u32 s27, s29, s32
    v_exp_f32 v84, v20
    v_mfma_f32_16x16x32_bf16 v[28:31], a[40:43], v[176:179], v[28:31]
    s_min_u32 s27, s29, s27
    ds_read_b128 a[96:99], v1 offset:0
    ds_read_b128 a[100:103], v1 offset:1024
    v_exp_f32 v85, v21
    v_exp_f32 v86, v22
    v_exp_f32 v87, v23
    v_cvt_pk_bf16_f32 v46, v84, v85
    v_cvt_pk_bf16_f32 v47, v86, v87
    v_cndmask_b32 v16, v16, v5, s[16:17]
    v_cndmask_b32 v17, v17, v5, s[18:19]
    v_cndmask_b32 v18, v18, v5, s[20:21]
    v_cndmask_b32 v19, v19, v5, s[22:23]
    v_exp_f32 v80, v16
    v_exp_f32 v81, v17
    v_exp_f32 v82, v18
    v_cvt_pk_bf16_f32 v42, v80, v81
    v_exp_f32 v83, v19
    ds_read_b128 a[104:107], v1 offset:2048
    v_cvt_pk_bf16_f32 v43, v82, v83
    s_nop 1
    v_mfma_f32_16x16x32_bf16 v[72:75], a[128:131], v[40:43], v[64:67]
    ds_read_b128 a[108:111], v1 offset:3072
    ds_read_b128 a[112:115], v1 offset:4096
    v_mfma_f32_16x16x32_bf16 v[76:79], a[128:131], v[44:47], v[68:71]
    buffer_load_dwordx4 v2, s[8:11], s27 offen offset:0 sc1 lds
    v_mfma_f32_16x16x32_bf16 v[28:31], a[44:47], v[180:183], v[28:31]
    ds_read_b128 a[116:119], v1 offset:5120
    v_mfma_f32_16x16x32_bf16 v[36:39], a[48:51], v[168:171], v[60:63]
    ds_read_b128 a[120:123], v1 offset:6144
    v_mfma_f32_16x16x32_bf16 v[36:39], a[52:55], v[172:175], v[36:39]
    ds_read_b128 a[124:127], v1 offset:7168
    v_mfma_f32_16x16x32_bf16 v[36:39], a[56:59], v[176:179], v[36:39]
    buffer_load_dwordx4 v2, s[8:11], s27 offen offset:1024 sc1 lds
    v_max_f32 v6, v72, v76
    v_mfma_f32_16x16x32_bf16 v[36:39], a[60:63], v[180:183], v[36:39]
    ds_read_b128 a[140:143], v1 offset:16384
    v_cmp_lt_f32 vcc, s37, v6
    s_nop 0
    s_cbranch_vccnz FB_concat_25
BK_concat_26:
    v_mfma_f32_16x16x32_bf16 v[88:91], a[64:67], v[40:43], v[88:91]
    ds_read_b128 a[144:147], v1 offset:17408
    ds_read_b128 a[148:151], v1 offset:18432
    v_mfma_f32_16x16x32_bf16 v[92:95], a[64:67], v[44:47], v[92:95]
    v_rcp_f32 v217, v72
    v_mfma_f32_16x16x32_bf16 v[96:99], a[68:71], v[40:43], v[96:99]
    buffer_load_dwordx4 v2, s[8:11], s27 offen offset:2048 sc1 lds
    v_mfma_f32_16x16x32_bf16 v[100:103], a[68:71], v[44:47], v[100:103]
    v_exp_f32 v84, v28
    v_mfma_f32_16x16x32_bf16 v[104:107], a[72:75], v[40:43], v[104:107]
    ds_read_b128 a[152:155], v1 offset:19456
    ds_read_b128 a[172:175], v1 offset:24576
    v_mfma_f32_16x16x32_bf16 v[108:111], a[72:75], v[44:47], v[108:111]
    v_exp_f32 v85, v29
    v_mfma_f32_16x16x32_bf16 v[112:115], a[76:79], v[40:43], v[112:115]
    buffer_load_dwordx4 v2, s[8:11], s27 offen offset:3072 sc1 lds
    v_mfma_f32_16x16x32_bf16 v[116:119], a[76:79], v[44:47], v[116:119]
    s_add_u32 m0, s42, 4096
    v_exp_f32 v86, v30
    v_mfma_f32_16x16x32_bf16 v[120:123], a[80:83], v[40:43], v[120:123]
    ds_read_b128 a[176:179], v1 offset:25600
    v_cvt_pk_bf16_f32 v52, v84, v85
    v_mfma_f32_16x16x32_bf16 v[124:127], a[80:83], v[44:47], v[124:127]
    v_exp_f32 v87, v31
    v_mfma_f32_16x16x32_bf16 v[128:131], a[84:87], v[40:43], v[128:131]
    buffer_load_dwordx4 v3, s[8:11], s27 offen offset:0 sc1 lds
    v_cvt_pk_bf16_f32 v53, v86, v87
    v_mfma_f32_16x16x32_bf16 v[132:135], a[84:87], v[44:47], v[132:135]
    v_exp_f32 v84, v36
    v_mfma_f32_16x16x32_bf16 v[136:139], a[88:91], v[40:43], v[136:139]
    ds_read_b128 a[180:183], v1 offset:26624
    ds_read_b128 a[184:187], v1 offset:27648
    v_mfma_f32_16x16x32_bf16 v[140:143], a[88:91], v[44:47], v[140:143]
    v_exp_f32 v85, v37
    v_mfma_f32_16x16x32_bf16 v[144:147], a[92:95], v[40:43], v[144:147]
    buffer_load_dwordx4 v3, s[8:11], s27 offen offset:1024 sc1 lds
    v_mfma_f32_16x16x32_bf16 v[148:151], a[92:95], v[44:47], v[148:151]
    v_exp_f32 v86, v38
    s_waitcnt lgkmcnt(15)
    v_mfma_f32_16x16x32_bf16 v[12:15], a[0:3], v[168:171], v[60:63]
    ds_read_b128 a[188:191], v1 offset:28672
    v_cvt_pk_bf16_f32 v54, v84, v85
    v_mfma_f32_16x16x32_bf16 v[12:15], a[4:7], v[172:175], v[12:15]
    v_exp_f32 v87, v39
    v_mfma_f32_16x16x32_bf16 v[12:15], a[8:11], v[176:179], v[12:15]
    buffer_load_dwordx4 v3, s[8:11], s27 offen offset:2048 sc1 lds
    v_cvt_pk_bf16_f32 v55, v86, v87
    s_nop 1
    v_mfma_f32_16x16x32_bf16 v[68:71], a[128:131], v[52:55], v[76:79]
    ds_read_b128 a[192:195], v1 offset:29696
    ds_read_b128 a[196:199], v1 offset:30720
    v_mfma_f32_16x16x32_bf16 v[12:15], a[12:15], v[180:183], v[12:15]
    ds_read_b128 a[200:203], v1 offset:31744
    v_mfma_f32_16x16x32_bf16 v[20:23], a[16:19], v[168:171], v[60:63]
    ds_read_b128 a[204:207], v1 offset:32768
    v_mfma_f32_16x16x32_bf16 v[20:23], a[20:23], v[172:175], v[20:23]
    buffer_load_dwordx4 v3, s[8:11], s27 offen offset:3072 sc1 lds
    v_cmp_lt_f32 vcc, s37, v68
    v_mfma_f32_16x16x32_bf16 v[20:23], a[24:27], v[176:179], v[20:23]
    s_add_u32 m0, s42, 8192
    ds_read_b128 a[208:211], v1 offset:33792
    ds_read_b128 a[212:215], v1 offset:34816
    v_mfma_f32_16x16x32_bf16 v[20:23], a[28:31], v[180:183], v[20:23]
    s_add_u32 s29, s29, 8192
    ds_read_b128 a[216:219], v1 offset:35840
    ds_read_b128 a[220:223], v1 offset:36864
    s_waitcnt lgkmcnt(15)
    s_cbranch_vccnz FB_concat_27
BK_concat_28:
    v_mfma_f32_16x16x32_bf16 v[92:95], a[96:99], v[52:55], v[92:95]
    s_sub_u32 s27, s29, s32
    v_exp_f32 v84, v12
    v_mfma_f32_16x16x32_bf16 v[100:103], a[100:103], v[52:55], v[100:103]
    s_min_u32 s27, s29, s27
    buffer_load_dwordx4 v2, s[8:11], s27 offen offset:0 sc1 lds
    v_mfma_f32_16x16x32_bf16 v[108:111], a[104:107], v[52:55], v[108:111]
    v_exp_f32 v85, v13
    v_mfma_f32_16x16x32_bf16 v[116:119], a[108:111], v[52:55], v[116:119]
    ds_read_b128 a[224:227], v1 offset:37888
    ds_read_b128 a[228:231], v1 offset:38912
    v_mfma_f32_16x16x32_bf16 v[124:127], a[112:115], v[52:55], v[124:127]
    v_exp_f32 v86, v14
    v_mfma_f32_16x16x32_bf16 v[132:135], a[116:119], v[52:55], v[132:135]
    buffer_load_dwordx4 v2, s[8:11], s27 offen offset:1024 sc1 lds
    v_cvt_pk_bf16_f32 v44, v84, v85
    v_mfma_f32_16x16x32_bf16 v[140:143], a[120:123], v[52:55], v[140:143]
    v_exp_f32 v87, v15
    v_mfma_f32_16x16x32_bf16 v[148:151], a[124:127], v[52:55], v[148:151]
    ds_read_b128 a[232:235], v1 offset:39936
    v_cvt_pk_bf16_f32 v45, v86, v87
    s_waitcnt lgkmcnt(15)
    v_exp_f32 v84, v20
    v_exp_f32 v85, v21
    v_exp_f32 v86, v22
    v_cvt_pk_bf16_f32 v46, v84, v85
    v_exp_f32 v87, v23
    s_nop 0
    v_cvt_pk_bf16_f32 v47, v86, v87
    s_nop 1
    v_mfma_f32_16x16x32_bf16 v[76:79], a[128:131], v[44:47], v[68:71]
    buffer_load_dwordx4 v2, s[8:11], s27 offen offset:2048 sc1 lds
    v_mfma_f32_16x16x32_bf16 v[28:31], a[140:143], v[168:171], v[60:63]
    buffer_load_dwordx4 v2, s[8:11], s27 offen offset:3072 sc1 lds
    v_mfma_f32_16x16x32_bf16 v[28:31], a[144:147], v[172:175], v[28:31]
    s_add_u32 m0, s42, 12288
    v_mfma_f32_16x16x32_bf16 v[28:31], a[148:151], v[176:179], v[28:31]
    buffer_load_dwordx4 v3, s[8:11], s27 offen offset:0 sc1 lds
    v_mfma_f32_16x16x32_bf16 v[28:31], a[152:155], v[180:183], v[28:31]
    buffer_load_dwordx4 v3, s[8:11], s27 offen offset:1024 sc1 lds
    v_cmp_lt_f32 vcc, s37, v76
    s_waitcnt lgkmcnt(8)
    s_cbranch_vccnz FB_concat_29
BK_concat_30:
    v_mfma_f32_16x16x32_bf16 v[92:95], a[172:175], v[44:47], v[92:95]
    buffer_load_dwordx4 v3, s[8:11], s27 offen offset:2048 sc1 lds
    v_mov_b32 v152, v184
    v_mfma_f32_16x16x32_bf16 v[100:103], a[176:179], v[44:47], v[100:103]
    buffer_load_dwordx4 v3, s[8:11], s27 offen offset:3072 sc1 lds
    v_cndmask_b32 v28, v28, v5, s[16:17]
    v_mfma_f32_16x16x32_bf16 v[108:111], a[180:183], v[44:47], v[108:111]
    s_add_u32 s29, s29, 57344
    ds_read_b128 a[32:35], v1 offset:49152
    s_xor_b32 s42, s42, 0x10000
    v_mfma_f32_16x16x32_bf16 v[116:119], a[184:187], v[44:47], v[116:119]
    ds_read_b128 a[36:39], v1 offset:50176
    v_cndmask_b32 v29, v29, v5, s[18:19]
    v_mfma_f32_16x16x32_bf16 v[124:127], a[188:191], v[44:47], v[124:127]
    ds_read_b128 a[40:43], v1 offset:51200
    v_cndmask_b32 v30, v30, v5, s[20:21]
    v_mfma_f32_16x16x32_bf16 v[132:135], a[192:195], v[44:47], v[132:135]
    ds_read_b128 a[44:47], v1 offset:52224
    v_cndmask_b32 v31, v31, v5, s[22:23]
    v_mfma_f32_16x16x32_bf16 v[140:143], a[196:199], v[44:47], v[140:143]
    v_exp_f32 v84, v28
    v_mfma_f32_16x16x32_bf16 v[148:151], a[200:203], v[44:47], v[148:151]
    v_exp_f32 v85, v29
    v_exp_f32 v86, v30
    v_cvt_pk_bf16_f32 v52, v84, v85
    v_exp_f32 v87, v31
    v_mul_f32 v217, s43, v217
    v_cvt_pk_bf16_f32 v53, v86, v87
    v_mov_b32 v36, v5
    v_mov_b32 v37, v5
    v_mov_b32 v38, v5
    v_mov_b32 v39, v5
    v_mov_b32 v54, 0
    v_mov_b32 v55, 0
    s_nop 1
    v_mfma_f32_16x16x32_bf16 v[68:71], a[128:131], v[52:55], v[76:79]
    ds_read_b128 a[48:51], v1 offset:53248
    ds_read_b128 a[52:55], v1 offset:54272
    v_mul_f32 v88, v88, v217
    v_mul_f32 v89, v89, v217
    v_mul_f32 v90, v90, v217
    v_mul_f32 v91, v91, v217
    v_cvt_pk_bf16_f32 v88, v88, v89
    v_cvt_pk_bf16_f32 v89, v90, v91
    v_cmp_lt_f32 vcc, s37, v68
    s_waitcnt lgkmcnt(6)
    s_cbranch_vccnz FB_concat_31
BK_concat_32:
    v_mfma_f32_16x16x32_bf16 v[92:95], a[204:207], v[52:55], v[92:95]
    ds_read_b128 a[56:59], v1 offset:55296
    ds_read_b128 a[60:63], v1 offset:56320
    v_mfma_f32_16x16x32_bf16 v[100:103], a[208:211], v[52:55], v[100:103]
    ds_read_b128 a[64:67], v1 offset:57344
    ds_read_b128 a[68:71], v1 offset:58368
    v_mfma_f32_16x16x32_bf16 v[108:111], a[212:215], v[52:55], v[108:111]
    ds_read_b128 a[72:75], v1 offset:59392
    ds_read_b128 a[76:79], v1 offset:60416
    v_mfma_f32_16x16x32_bf16 v[116:119], a[216:219], v[52:55], v[116:119]
    ds_read_b128 a[80:83], v1 offset:61440
    ds_read_b128 a[84:87], v1 offset:62464
    v_mfma_f32_16x16x32_bf16 v[124:127], a[220:223], v[52:55], v[124:127]
    ds_read_b128 a[88:91], v1 offset:63488
    ds_read_b128 a[92:95], v1 offset:64512
    v_mfma_f32_16x16x32_bf16 v[132:135], a[224:227], v[52:55], v[132:135]
    ds_read_b128 a[0:3], v1 offset:40960
    ds_read_b128 a[4:7], v1 offset:41984
    v_mfma_f32_16x16x32_bf16 v[140:143], a[228:231], v[52:55], v[140:143]
    ds_read_b128 a[8:11], v1 offset:43008
    ds_read_b128 a[12:15], v1 offset:44032
    v_mfma_f32_16x16x32_bf16 v[148:151], a[232:235], v[52:55], v[148:151]
    ds_read_b128 a[16:19], v1 offset:45056
    ds_read_b128 a[20:23], v1 offset:46080
    ds_read_b128 a[24:27], v1 offset:47104
    v_mul_f32 v96, v96, v217
    v_mov_b32 v153, v185
    ds_read_b128 a[28:31], v1 offset:48128
    v_mul_f32 v97, v97, v217
    v_mov_b32 v154, v186
    v_xor_b32 v1, 0x10000, v1
    v_mul_f32 v98, v98, v217
    v_mov_b32 v155, v187
    v_mul_f32 v99, v99, v217
    v_mov_b32 v156, v188
    v_cvt_pk_bf16_f32 v90, v96, v97
    v_mov_b32 v157, v189
    v_cvt_pk_bf16_f32 v91, v98, v99
    v_mov_b32 v158, v190
    buffer_store_dwordx4 v[88:91], v2, s[12:15], s36 offen offset:0 sc1
    v_mov_b32 v159, v191
    v_mul_f32 v104, v104, v217
    v_mov_b32 v160, v192
    v_mul_f32 v105, v105, v217
    v_mov_b32 v161, v193
    v_mul_f32 v106, v106, v217
    v_mov_b32 v162, v194
    v_mul_f32 v107, v107, v217
    v_mov_b32 v163, v195
    v_cvt_pk_bf16_f32 v104, v104, v105
    v_mov_b32 v164, v196
    v_cvt_pk_bf16_f32 v105, v106, v107
    v_mov_b32 v165, v197
    v_mul_f32 v112, v112, v217
    v_mov_b32 v166, v198
    v_mul_f32 v113, v113, v217
    v_mov_b32 v167, v199
    v_mul_f32 v114, v114, v217
    v_mov_b32 v168, v200
    v_mul_f32 v115, v115, v217
    v_mov_b32 v169, v201
    v_cvt_pk_bf16_f32 v106, v112, v113
    v_mov_b32 v170, v202
    v_cvt_pk_bf16_f32 v107, v114, v115
    v_mov_b32 v171, v203
    buffer_store_dwordx4 v[104:107], v2, s[12:15], s36 offen offset:1024 sc1
    v_mov_b32 v172, v204
    v_mul_f32 v120, v120, v217
    v_mov_b32 v173, v205
    v_mul_f32 v121, v121, v217
    v_mov_b32 v174, v206
    v_mul_f32 v122, v122, v217
    v_mov_b32 v175, v207
    v_mul_f32 v123, v123, v217
    v_mov_b32 v176, v208
    v_cvt_pk_bf16_f32 v120, v120, v121
    v_mov_b32 v177, v209
    v_cvt_pk_bf16_f32 v121, v122, v123
    v_mov_b32 v178, v210
    v_mul_f32 v128, v128, v217
    v_mov_b32 v179, v211
    v_mul_f32 v129, v129, v217
    v_mov_b32 v180, v212
    v_mul_f32 v130, v130, v217
    v_mov_b32 v181, v213
    v_mul_f32 v131, v131, v217
    v_mov_b32 v182, v214
    v_cvt_pk_bf16_f32 v122, v128, v129
    v_mov_b32 v183, v215
    v_cvt_pk_bf16_f32 v123, v130, v131
    buffer_store_dwordx4 v[120:123], v2, s[12:15], s36 offen offset:2048 sc1
    v_mul_f32 v136, v136, v217
    v_mul_f32 v137, v137, v217
    v_mul_f32 v138, v138, v217
    v_mul_f32 v139, v139, v217
    v_cvt_pk_bf16_f32 v136, v136, v137
    v_cvt_pk_bf16_f32 v137, v138, v139
    v_mul_f32 v144, v144, v217
    v_mul_f32 v145, v145, v217
    v_mul_f32 v146, v146, v217
    v_mul_f32 v147, v147, v217
    v_cvt_pk_bf16_f32 v138, v144, v145
    v_cvt_pk_bf16_f32 v139, v146, v147
    buffer_store_dwordx4 v[136:139], v2, s[12:15], s36 offen offset:3072 sc1
    v_rcp_f32 v7, v68
    s_nop 0
    v_mul_f32 v7, s43, v7
    s_waitcnt vmcnt(4)
    s_waitcnt lgkmcnt(0)
    s_branch L2_epi
L2_tail0:
    v_mfma_f32_16x16x32_bf16 v[28:31], a[32:35], v[168:171], v[60:63]
    s_barrier
    ds_read_b128 a[0:3], v1 offset:8192
    ds_read_b128 a[4:7], v1 offset:9216
    ds_read_b128 a[8:11], v1 offset:10240
    ds_read_b128 a[12:15], v1 offset:11264
    ds_read_b128 a[16:19], v1 offset:12288
    ds_read_b128 a[20:23], v1 offset:13312
    ds_read_b128 a[24:27], v1 offset:14336
    ds_read_b128 a[28:31], v1 offset:15360
    s_add_u32 m0, s42, 0
    v_mfma_f32_16x16x32_bf16 v[28:31], a[36:39], v[172:175], v[28:31]
    s_sub_u32 s27, s29, s32
    v_exp_f32 v84, v20
    v_mfma_f32_16x16x32_bf16 v[28:31], a[40:43], v[176:179], v[28:31]
    s_min_u32 s27, s29, s27
    ds_read_b128 a[96:99], v1 offset:0
    ds_read_b128 a[100:103], v1 offset:1024
    v_exp_f32 v85, v21
    v_exp_f32 v86, v22
    v_exp_f32 v87, v23
    v_cvt_pk_bf16_f32 v46, v84, v85
    v_cvt_pk_bf16_f32 v47, v86, v87
    v_cndmask_b32 v8, v8, v5, s[16:17]
    v_cndmask_b32 v9, v9, v5, s[18:19]
    v_cndmask_b32 v10, v10, v5, s[20:21]
    v_cndmask_b32 v11, v11, v5, s[22:23]
    v_exp_f32 v80, v8
    v_exp_f32 v81, v9
    v_exp_f32 v82, v10
    v_cvt_pk_bf16_f32 v40, v80, v81
    v_exp_f32 v83, v11
    ds_read_b128 a[104:107], v1 offset:2048
    v_cvt_pk_bf16_f32 v41, v82, v83
    v_mov_b32 v16, v5
    v_mov_b32 v17, v5
    v_mov_b32 v18, v5
    v_mov_b32 v19, v5
    v_mov_b32 v42, 0
    v_mov_b32 v43, 0
    s_nop 1
    v_mfma_f32_16x16x32_bf16 v[72:75], a[128:131], v[40:43], v[64:67]
    ds_read_b128 a[108:111], v1 offset:3072
    ds_read_b128 a[112:115], v1 offset:4096
    v_mfma_f32_16x16x32_bf16 v[76:79], a[128:131], v[44:47], v[68:71]
    buffer_load_dwordx4 v2, s[8:11], s27 offen offset:0 sc1 lds
    v_mfma_f32_16x16x32_bf16 v[28:31], a[44:47], v[180:183], v[28:31]
    ds_read_b128 a[116:119], v1 offset:5120
    v_mfma_f32_16x16x32_bf16 v[36:39], a[48:51], v[168:171], v[60:63]
    ds_read_b128 a[120:123], v1 offset:6144
    v_mfma_f32_16x16x32_bf16 v[36:39], a[52:55], v[172:175], v[36:39]
    ds_read_b128 a[124:127], v1 offset:7168
    v_mfma_f32_16x16x32_bf16 v[36:39], a[56:59], v[176:179], v[36:39]
    buffer_load_dwordx4 v2, s[8:11], s27 offen offset:1024 sc1 lds
    v_max_f32 v6, v72, v76
    v_mfma_f32_16x16x32_bf16 v[36:39], a[60:63], v[180:183], v[36:39]
    ds_read_b128 a[140:143], v1 offset:16384
    v_cmp_lt_f32 vcc, s37, v6
    s_nop 0
    s_cbranch_vccnz FB_concat_33
BK_concat_34:
    v_mfma_f32_16x16x32_bf16 v[88:91], a[64:67], v[40:43], v[88:91]
    ds_read_b128 a[144:147], v1 offset:17408
    ds_read_b128 a[148:151], v1 offset:18432
    v_mfma_f32_16x16x32_bf16 v[92:95], a[64:67], v[44:47], v[92:95]
    v_rcp_f32 v217, v72
    v_mfma_f32_16x16x32_bf16 v[96:99], a[68:71], v[40:43], v[96:99]
    buffer_load_dwordx4 v2, s[8:11], s27 offen offset:2048 sc1 lds
    v_mfma_f32_16x16x32_bf16 v[100:103], a[68:71], v[44:47], v[100:103]
    v_exp_f32 v84, v28
    v_mfma_f32_16x16x32_bf16 v[104:107], a[72:75], v[40:43], v[104:107]
    ds_read_b128 a[152:155], v1 offset:19456
    ds_read_b128 a[156:159], v1 offset:20480
    v_mfma_f32_16x16x32_bf16 v[108:111], a[72:75], v[44:47], v[108:111]
    v_exp_f32 v85, v29
    v_mfma_f32_16x16x32_bf16 v[112:115], a[76:79], v[40:43], v[112:115]
    buffer_load_dwordx4 v2, s[8:11], s27 offen offset:3072 sc1 lds
    v_mfma_f32_16x16x32_bf16 v[116:119], a[76:79], v[44:47], v[116:119]
    s_add_u32 m0, s42, 4096
    v_exp_f32 v86, v30
    v_mfma_f32_16x16x32_bf16 v[120:123], a[80:83], v[40:43], v[120:123]
    ds_read_b128 a[160:163], v1 offset:21504
    v_cvt_pk_bf16_f32 v52, v84, v85
    v_mfma_f32_16x16x32_bf16 v[124:127], a[80:83], v[44:47], v[124:127]
    v_exp_f32 v87, v31
    v_mfma_f32_16x16x32_bf16 v[128:131], a[84:87], v[40:43], v[128:131]
    buffer_load_dwordx4 v3, s[8:11], s27 offen offset:0 sc1 lds
    v_cvt_pk_bf16_f32 v53, v86, v87
    v_mfma_f32_16x16x32_bf16 v[132:135], a[84:87], v[44:47], v[132:135]
    v_exp_f32 v84, v36
    v_mfma_f32_16x16x32_bf16 v[136:139], a[88:91], v[40:43], v[136:139]
    ds_read_b128 a[164:167], v1 offset:22528
    ds_read_b128 a[168:171], v1 offset:23552
    v_mfma_f32_16x16x32_bf16 v[140:143], a[88:91], v[44:47], v[140:143]
    v_exp_f32 v85, v37
    v_mfma_f32_16x16x32_bf16 v[144:147], a[92:95], v[40:43], v[144:147]
    buffer_load_dwordx4 v3, s[8:11], s27 offen offset:1024 sc1 lds
    v_mfma_f32_16x16x32_bf16 v[148:151], a[92:95], v[44:47], v[148:151]
    v_exp_f32 v86, v38
    s_waitcnt lgkmcnt(15)
    v_mfma_f32_16x16x32_bf16 v[12:15], a[0:3], v[168:171], v[60:63]
    ds_read_b128 a[172:175], v1 offset:24576
    v_cvt_pk_bf16_f32 v54, v84, v85
    v_mfma_f32_16x16x32_bf16 v[12:15], a[4:7], v[172:175], v[12:15]
    v_exp_f32 v87, v39
    v_mfma_f32_16x16x32_bf16 v[12:15], a[8:11], v[176:179], v[12:15]
    buffer_load_dwordx4 v3, s[8:11], s27 offen offset:2048 sc1 lds
    v_cvt_pk_bf16_f32 v55, v86, v87
    s_nop 1
    v_mfma_f32_16x16x32_bf16 v[68:71], a[128:131], v[52:55], v[76:79]
    ds_read_b128 a[176:179], v1 offset:25600
    ds_read_b128 a[180:183], v1 offset:26624
    v_mfma_f32_16x16x32_bf16 v[12:15], a[12:15], v[180:183], v[12:15]
    ds_read_b128 a[184:187], v1 offset:27648
    v_mfma_f32_16x16x32_bf16 v[20:23], a[16:19], v[168:171], v[60:63]
    ds_read_b128 a[188:191], v1 offset:28672
    v_mfma_f32_16x16x32_bf16 v[20:23], a[20:23], v[172:175], v[20:23]
    buffer_load_dwordx4 v3, s[8:11], s27 offen offset:3072 sc1 lds
    v_cmp_lt_f32 vcc, s37, v68
    v_mfma_f32_16x16x32_bf16 v[20:23], a[24:27], v[176:179], v[20:23]
    s_add_u32 m0, s42, 8192
    ds_read_b128 a[192:195], v1 offset:29696
    ds_read_b128 a[196:199], v1 offset:30720
    v_mfma_f32_16x16x32_bf16 v[20:23], a[28:31], v[180:183], v[20:23]
    s_add_u32 s29, s29, 8192
    ds_read_b128 a[200:203], v1 offset:31744
    ds_read_b128 a[204:207], v1 offset:32768
    s_waitcnt lgkmcnt(15)
    s_cbranch_vccnz FB_concat_35
BK_concat_36:
    v_mfma_f32_16x16x32_bf16 v[92:95], a[96:99], v[52:55], v[92:95]
    s_sub_u32 s27, s29, s32
    v_exp_f32 v84, v12
    v_mfma_f32_16x16x32_bf16 v[100:103], a[100:103], v[52:55], v[100:103]
    s_min_u32 s27, s29, s27
    buffer_load_dwordx4 v2, s[8:11], s27 offen offset:0 sc1 lds
    v_mfma_f32_16x16x32_bf16 v[108:111], a[104:107], v[52:55], v[108:111]
    v_exp_f32 v85, v13
    v_mfma_f32_16x16x32_bf16 v[116:119], a[108:111], v[52:55], v[116:119]
    ds_read_b128 a[208:211], v1 offset:33792
    ds_read_b128 a[212:215], v1 offset:34816
    v_mfma_f32_16x16x32_bf16 v[124:127], a[112:115], v[52:55], v[124:127]
    v_exp_f32 v86, v14
    v_mfma_f32_16x16x32_bf16 v[132:135], a[116:119], v[52:55], v[132:135]
    buffer_load_dwordx4 v2, s[8:11], s27 offen offset:1024 sc1 lds
    v_cvt_pk_bf16_f32 v44, v84, v85
    v_mfma_f32_16x16x32_bf16 v[140:143], a[120:123], v[52:55], v[140:143]
    v_exp_f32 v87, v15
    v_mfma_f32_16x16x32_bf16 v[148:151], a[124:127], v[52:55], v[148:151]
    ds_read_b128 a[216:219], v1 offset:35840
    v_cvt_pk_bf16_f32 v45, v86, v87
    s_waitcnt lgkmcnt(12)
    v_mfma_f32_16x16x32_bf16 v[28:31], a[140:143], v[168:171], v[60:63]
    v_exp_f32 v84, v20
    v_mfma_f32_16x16x32_bf16 v[28:31], a[144:147], v[172:175], v[28:31]
    buffer_load_dwordx4 v2, s[8:11], s27 offen offset:2048 sc1 lds
    v_mfma_f32_16x16x32_bf16 v[28:31], a[148:151], v[176:179], v[28:31]
    v_exp_f32 v85, v21
    v_exp_f32 v86, v22
    v_cvt_pk_bf16_f32 v46, v84, v85
    v_exp_f32 v87, v23
    ds_read_b128 a[220:223], v1 offset:36864
    v_cvt_pk_bf16_f32 v47, v86, v87
    s_nop 1
    v_mfma_f32_16x16x32_bf16 v[76:79], a[128:131], v[44:47], v[68:71]
    ds_read_b128 a[224:227], v1 offset:37888
    ds_read_b128 a[228:231], v1 offset:38912
    v_mfma_f32_16x16x32_bf16 v[28:31], a[152:155], v[180:183], v[28:31]
    ds_read_b128 a[232:235], v1 offset:39936
    v_mfma_f32_16x16x32_bf16 v[36:39], a[156:159], v[168:171], v[60:63]
    buffer_load_dwordx4 v2, s[8:11], s27 offen offset:3072 sc1 lds
    v_mfma_f32_16x16x32_bf16 v[36:39], a[160:163], v[172:175], v[36:39]
    s_add_u32 m0, s42, 12288
    v_cmp_lt_f32 vcc, s37, v76
    v_mfma_f32_16x16x32_bf16 v[36:39], a[164:167], v[176:179], v[36:39]
    buffer_load_dwordx4 v3, s[8:11], s27 offen offset:0 sc1 lds
    v_mfma_f32_16x16x32_bf16 v[36:39], a[168:171], v[180:183], v[36:39]
    buffer_load_dwordx4 v3, s[8:11], s27 offen offset:1024 sc1 lds
    s_waitcnt lgkmcnt(8)
    s_cbranch_vccnz FB_concat_37
BK_concat_38:
    v_mfma_f32_16x16x32_bf16 v[92:95], a[172:175], v[44:47], v[92:95]
    buffer_load_dwordx4 v3, s[8:11], s27 offen offset:2048 sc1 lds
    v_mov_b32 v152, v184
    v_mfma_f32_16x16x32_bf16 v[100:103], a[176:179], v[44:47], v[100:103]
    v_exp_f32 v84, v28
    v_mfma_f32_16x16x32_bf16 v[108:111], a[180:183], v[44:47], v[108:111]
    buffer_load_dwordx4 v3, s[8:11], s27 offen offset:3072 sc1 lds
    v_mov_b32 v153, v185
    v_mfma_f32_16x16x32_bf16 v[116:119], a[184:187], v[44:47], v[116:119]
    s_add_u32 s29, s29, 57344
    v_exp_f32 v85, v29
    v_mfma_f32_16x16x32_bf16 v[124:127], a[188:191], v[44:47], v[124:127]
    s_xor_b32 s42, s42, 0x10000
    v_exp_f32 v86, v30
    v_mfma_f32_16x16x32_bf16 v[132:135], a[192:195], v[44:47], v[132:135]
    ds_read_b128 a[32:35], v1 offset:49152
    v_cvt_pk_bf16_f32 v52, v84, v85
    v_mfma_f32_16x16x32_bf16 v[140:143], a[196:199], v[44:47], v[140:143]
    v_exp_f32 v87, v31
    v_mfma_f32_16x16x32_bf16 v[148:151], a[200:203], v[44:47], v[148:151]
    ds_read_b128 a[36:39], v1 offset:50176
    v_cvt_pk_bf16_f32 v53, v86, v87
    v_cndmask_b32 v36, v36, v5, s[16:17]
    v_cndmask_b32 v37, v37, v5, s[18:19]
    v_cndmask_b32 v38, v38, v5, s[20:21]
    v_cndmask_b32 v39, v39, v5, s[22:23]
    v_exp_f32 v84, v36
    v_exp_f32 v85, v37
    v_exp_f32 v86, v38
    v_cvt_pk_bf16_f32 v54, v84, v85
    v_exp_f32 v87, v39
    v_mul_f32 v217, s43, v217
    v_cvt_pk_bf16_f32 v55, v86, v87
    s_nop 1
    v_mfma_f32_16x16x32_bf16 v[68:71], a[128:131], v[52:55], v[76:79]
    ds_read_b128 a[40:43], v1 offset:51200
    ds_read_b128 a[44:47], v1 offset:52224
    v_mul_f32 v88, v88, v217
    v_mul_f32 v89, v89, v217
    v_mul_f32 v90, v90, v217
    v_mul_f32 v91, v91, v217
    v_cvt_pk_bf16_f32 v88, v88, v89
    v_cvt_pk_bf16_f32 v89, v90, v91
    v_cmp_lt_f32 vcc, s37, v68
    s_waitcnt lgkmcnt(4)
    s_cbranch_vccnz FB_concat_39
BK_concat_40:
    v_mfma_f32_16x16x32_bf16 v[92:95], a[204:207], v[52:55], v[92:95]
    ds_read_b128 a[48:51], v1 offset:53248
    ds_read_b128 a[52:55], v1 offset:54272
    v_mfma_f32_16x16x32_bf16 v[100:103], a[208:211], v[52:55], v[100:103]
    ds_read_b128 a[56:59], v1 offset:55296
    ds_read_b128 a[60:63], v1 offset:56320
    v_mfma_f32_16x16x32_bf16 v[108:111], a[212:215], v[52:55], v[108:111]
    ds_read_b128 a[64:67], v1 offset:57344
    ds_read_b128 a[68:71], v1 offset:58368
    v_mfma_f32_16x16x32_bf16 v[116:119], a[216:219], v[52:55], v[116:119]
    ds_read_b128 a[72:75], v1 offset:59392
    ds_read_b128 a[76:79], v1 offset:60416
    v_mfma_f32_16x16x32_bf16 v[124:127], a[220:223], v[52:55], v[124:127]
    ds_read_b128 a[80:83], v1 offset:61440
    ds_read_b128 a[84:87], v1 offset:62464
    v_mfma_f32_16x16x32_bf16 v[132:135], a[224:227], v[52:55], v[132:135]
    ds_read_b128 a[88:91], v1 offset:63488
    ds_read_b128 a[92:95], v1 offset:64512
    v_mfma_f32_16x16x32_bf16 v[140:143], a[228:231], v[52:55], v[140:143]
    ds_read_b128 a[0:3], v1 offset:40960
    ds_read_b128 a[4:7], v1 offset:41984
    v_mfma_f32_16x16x32_bf16 v[148:151], a[232:235], v[52:55], v[148:151]
    ds_read_b128 a[8:11], v1 offset:43008
    ds_read_b128 a[12:15], v1 offset:44032
    ds_read_b128 a[16:19], v1 offset:45056
    v_mul_f32 v96, v96, v217
    v_mov_b32 v154, v186
    ds_read_b128 a[20:23], v1 offset:46080
    v_mul_f32 v97, v97, v217
    v_mov_b32 v155, v187
    ds_read_b128 a[24:27], v1 offset:47104
    v_mul_f32 v98, v98, v217
    v_mov_b32 v156, v188
    ds_read_b128 a[28:31], v1 offset:48128
    v_mul_f32 v99, v99, v217
    v_mov_b32 v157, v189
    v_xor_b32 v1, 0x10000, v1
    v_cvt_pk_bf16_f32 v90, v96, v97
    v_mov_b32 v158, v190
    v_cvt_pk_bf16_f32 v91, v98, v99
    v_mov_b32 v159, v191
    buffer_store_dwordx4 v[88:91], v2, s[12:15], s36 offen offset:0 sc1
    v_mov_b32 v160, v192
    v_mul_f32 v104, v104, v217
    v_mov_b32 v161, v193
    v_mul_f32 v105, v105, v217
    v_mov_b32 v162, v194
    v_mul_f32 v106, v106, v217
    v_mov_b32 v163, v195
    v_mul_f32 v107, v107, v217
    v_mov_b32 v164, v196
    v_cvt_pk_bf16_f32 v104, v104, v105
    v_mov_b32 v165, v197
    v_cvt_pk_bf16_f32 v105, v106, v107
    v_mov_b32 v166, v198
    v_mul_f32 v112, v112, v217
    v_mov_b32 v167, v199
    v_mul_f32 v113, v113, v217
    v_mov_b32 v168, v200
    v_mul_f32 v114, v114, v217
    v_mov_b32 v169, v201
    v_mul_f32 v115, v115, v217
    v_mov_b32 v170, v202
    v_cvt_pk_bf16_f32 v106, v112, v113
    v_mov_b32 v171, v203
    v_cvt_pk_bf16_f32 v107, v114, v115
    v_mov_b32 v172, v204
    buffer_store_dwordx4 v[104:107], v2, s[12:15], s36 offen offset:1024 sc1
    v_mov_b32 v173, v205
    v_mul_f32 v120, v120, v217
    v_mov_b32 v174, v206
    v_mul_f32 v121, v121, v217
    v_mov_b32 v175, v207
    v_mul_f32 v122, v122, v217
    v_mov_b32 v176, v208
    v_mul_f32 v123, v123, v217
    v_mov_b32 v177, v209
    v_cvt_pk_bf16_f32 v120, v120, v121
    v_mov_b32 v178, v210
    v_cvt_pk_bf16_f32 v121, v122, v123
    v_mov_b32 v179, v211
    v_mul_f32 v128, v128, v217
    v_mov_b32 v180, v212
    v_mul_f32 v129, v129, v217
    v_mov_b32 v181, v213
    v_mul_f32 v130, v130, v217
    v_mov_b32 v182, v214
    v_mul_f32 v131, v131, v217
    v_mov_b32 v183, v215
    v_cvt_pk_bf16_f32 v122, v128, v129
    v_cvt_pk_bf16_f32 v123, v130, v131
    buffer_store_dwordx4 v[120:123], v2, s[12:15], s36 offen offset:2048 sc1
    v_mul_f32 v136, v136, v217
    v_mul_f32 v137, v137, v217
    v_mul_f32 v138, v138, v217
    v_mul_f32 v139, v139, v217
    v_cvt_pk_bf16_f32 v136, v136, v137
    v_cvt_pk_bf16_f32 v137, v138, v139
    v_mul_f32 v144, v144, v217
    v_mul_f32 v145, v145, v217
    v_mul_f32 v146, v146, v217
    v_mul_f32 v147, v147, v217
    v_cvt_pk_bf16_f32 v138, v144, v145
    v_cvt_pk_bf16_f32 v139, v146, v147
    buffer_store_dwordx4 v[136:139], v2, s[12:15], s36 offen offset:3072 sc1
    v_rcp_f32 v7, v68
    s_nop 0
    v_mul_f32 v7, s43, v7
    s_waitcnt vmcnt(4)
    s_waitcnt lgkmcnt(0)
L2_epi:
    v_mfma_f32_16x16x32_bf16 v[8:11], a[0:3], v[152:155], 0
    v_mul_f32 v92, v92, v7
    v_mul_f32 v93, v93, v7
    v_mfma_f32_16x16x32_bf16 v[12:15], a[0:3], v[168:171], 0
    v_mul_f32 v94, v94, v7
    v_mul_f32 v95, v95, v7
    v_mfma_f32_16x16x32_bf16 v[8:11], a[4:7], v[156:159], v[8:11]
    v_cvt_pk_bf16_f32 v92, v92, v93
    v_cvt_pk_bf16_f32 v93, v94, v95
    v_mfma_f32_16x16x32_bf16 v[12:15], a[4:7], v[172:175], v[12:15]
    v_mul_f32 v100, v100, v7
    v_mul_f32 v101, v101, v7
    v_mfma_f32_16x16x32_bf16 v[8:11], a[8:11], v[160:163], v[8:11]
    v_mul_f32 v102, v102, v7
    v_mul_f32 v103, v103, v7
    v_mfma_f32_16x16x32_bf16 v[12:15], a[8:11], v[176:179], v[12:15]
    v_cvt_pk_bf16_f32 v94, v100, v101
    v_cvt_pk_bf16_f32 v95, v102, v103
    v_mfma_f32_16x16x32_bf16 v[8:11], a[12:15], v[164:167], v[8:11]
    buffer_store_dwordx4 v[92:95], v4, s[12:15], s36 offen offset:0 sc1
    v_mul_f32 v108, v108, v7
    v_mfma_f32_16x16x32_bf16 v[12:15], a[12:15], v[180:183], v[12:15]
    v_mul_f32 v109, v109, v7
    v_mul_f32 v110, v110, v7
    v_mfma_f32_16x16x32_bf16 v[16:19], a[16:19], v[152:155], 0
    v_mul_f32 v111, v111, v7
    v_cvt_pk_bf16_f32 v108, v108, v109
    v_mfma_f32_16x16x32_bf16 v[20:23], a[16:19], v[168:171], 0
    v_cvt_pk_bf16_f32 v109, v110, v111
    v_mul_f32 v116, v116, v7
    v_mfma_f32_16x16x32_bf16 v[16:19], a[20:23], v[156:159], v[16:19]
    v_mul_f32 v117, v117, v7
    v_mul_f32 v118, v118, v7
    v_mfma_f32_16x16x32_bf16 v[20:23], a[20:23], v[172:175], v[20:23]
    v_mul_f32 v119, v119, v7
    v_cvt_pk_bf16_f32 v110, v116, v117
    v_mfma_f32_16x16x32_bf16 v[16:19], a[24:27], v[160:163], v[16:19]
    v_cvt_pk_bf16_f32 v111, v118, v119
    v_mfma_f32_16x16x32_bf16 v[20:23], a[24:27], v[176:179], v[20:23]
    buffer_store_dwordx4 v[108:111], v4, s[12:15], s36 offen offset:1024 sc1
    v_mul_f32 v124, v124, v7
    v_mfma_f32_16x16x32_bf16 v[16:19], a[28:31], v[164:167], v[16:19]
    v_mul_f32 v125, v125, v7
    v_mul_f32 v126, v126, v7
    v_mfma_f32_16x16x32_bf16 v[20:23], a[28:31], v[180:183], v[20:23]
    v_mul_f32 v127, v127, v7
    v_cvt_pk_bf16_f32 v124, v124, v125
    s_mov_b32 s34, 0
SP_concat_41:
    v_cmp_gt_u32 vcc, 8, v219
    s_nop 3
    s_and_b64 vcc, vcc, s[50:51]
    s_cbranch_scc0 SD_concat_42
    s_add_u32 s34, s34, 1
    s_cmp_ge_u32 s34, 200000
    s_cbranch_scc1 SD_concat_42
    s_sleep 4
    buffer_load_dword v219, v218, s[12:15], s59 offen sc1
    s_waitcnt vmcnt(0)
    s_branch SP_concat_41
SD_concat_42:
    s_mov_b32 s35, 1
    s_sub_u32 s34, 15, s26
    v_mov_b32 v64, 0
    v_mov_b32 v65, 0
    v_mov_b32 v66, 0
    v_mov_b32 v67, 0
    v_mov_b32 v68, 0
    v_mov_b32 v69, 0
    v_mov_b32 v70, 0
    v_mov_b32 v71, 0
    v_max3_f32 v6, v8, v9, v10
    v_max3_f32 v80, v12, v13, v14
    v_mfma_f32_16x16x32_bf16 v[96:99], a[236:239], a[236:239], 0
    v_cvt_pk_bf16_f32 v125, v126, v127
    v_lshrrev_b32 v210, 4, v0
    v_max3_f32 v6, v6, v11, v16
    v_max3_f32 v80, v80, v15, v20
    v_mfma_f32_16x16x32_bf16 v[112:115], a[236:239], a[236:239], 0
    v_mul_f32 v132, v132, v7
    v_lshlrev_b32 v211, 10, v210
    v_max3_f32 v6, v6, v17, v18
    v_max3_f32 v80, v80, v21, v22
    v_mfma_f32_16x16x32_bf16 v[128:131], a[236:239], a[236:239], 0
    v_mul_f32 v133, v133, v7
    v_lshlrev_b32 v210, 1, v210
    v_max_f32 v6, v6, v19
    v_max_f32 v80, v80, v23
    v_mfma_f32_16x16x32_bf16 v[144:147], a[236:239], a[236:239], 0
    v_mul_f32 v134, v134, v7
    v_and_b32 v212, 15, v0
    v_mov_b32 v216, v6
    v_mov_b32 v217, v80
    v_mfma_f32_16x16x32_bf16 v[88:91], a[236:239], a[236:239], 0
    v_mul_f32 v135, v135, v7
    v_xor_b32 v210, v210, v212
    v_permlane16_swap_b32 v6, v216
    v_permlane16_swap_b32 v80, v217
    v_mfma_f32_16x16x32_bf16 v[104:107], a[236:239], a[236:239], 0
    v_cvt_pk_bf16_f32 v126, v132, v133
    v_lshl_add_u32 v192, v210, 4, v211
    v_max_f32 v6, v6, v216
    v_max_f32 v80, v80, v217
    v_mfma_f32_16x16x32_bf16 v[120:123], a[236:239], a[236:239], 0
    v_cvt_pk_bf16_f32 v127, v134, v135
    v_xor_b32 v193, 128, v192
    v_mov_b32 v216, v6
    v_mov_b32 v217, v80
    v_mfma_f32_16x16x32_bf16 v[136:139], a[236:239], a[236:239], 0
    buffer_store_dwordx4 v[124:127], v4, s[12:15], s36 offen offset:2048 sc1
    v_add_u32 v193, 3072, v193
    v_permlane32_swap_b32 v6, v216
    v_permlane32_swap_b32 v80, v217
    v_mul_f32 v140, v140, v7
    v_add_u32 v194, 6144, v192
    v_max_f32 v6, v6, v216
    v_max_f32 v80, v80, v217
    v_mul_f32 v141, v141, v7
    v_add_u32 v195, 6144, v193
    v_sub_f32 v56, 0xc2c80000, v6
    v_sub_f32 v60, 0xc2c80000, v80
    v_mul_f32 v142, v142, v7
    v_lshlrev_b32 v200, 4, v0
    v_add_f32 v8, v8, v56
    v_add_f32 v12, v12, v60
    v_mul_f32 v143, v143, v7
    v_add_f32 v9, v9, v56
    v_add_f32 v13, v13, v60
    v_cvt_pk_bf16_f32 v140, v140, v141
    v_add_f32 v10, v10, v56
    v_add_f32 v14, v14, v60
    v_cvt_pk_bf16_f32 v141, v142, v143
    v_add_f32 v11, v11, v56
    v_add_f32 v15, v15, v60
    v_mul_f32 v148, v148, v7
    v_add_f32 v16, v16, v56
    v_add_f32 v20, v20, v60
    v_mul_f32 v149, v149, v7
    v_add_f32 v17, v17, v56
    v_add_f32 v21, v21, v60
    v_mul_f32 v150, v150, v7
    v_add_f32 v18, v18, v56
    v_add_f32 v22, v22, v60
    v_mul_f32 v151, v151, v7
    v_add_f32 v19, v19, v56
    v_add_f32 v23, v23, v60
    v_cvt_pk_bf16_f32 v142, v148, v149
    v_mov_b32 v57, v56
    v_mov_b32 v61, v60
    v_cvt_pk_bf16_f32 v143, v150, v151
    v_mov_b32 v58, v56
    v_mov_b32 v62, v60
    buffer_store_dwordx4 v[140:143], v4, s[12:15], s36 offen offset:3072 sc1
    v_mov_b32 v59, v56
    v_mov_b32 v63, v60
    s_lshl_b32 s28, s24, 10
    v_mfma_f32_16x16x32_bf16 v[100:103], a[236:239], a[236:239], 0
    s_add_u32 m0, s28, 159744
    v_exp_f32 v80, v8
    v_mfma_f32_16x16x32_bf16 v[116:119], a[236:239], a[236:239], 0
    s_lshl_b32 s36, s25, 9
    v_exp_f32 v81, v9
    v_mfma_f32_16x16x32_bf16 v[132:135], a[236:239], a[236:239], 0
    buffer_load_dwordx4 v2, s[4:7], s36 offen lds
    v_exp_f32 v82, v10
    v_mfma_f32_16x16x32_bf16 v[148:151], a[236:239], a[236:239], 0
    s_lshl_b32 s36, s25, 12
    v_exp_f32 v83, v11
    v_mfma_f32_16x16x32_bf16 v[92:95], a[236:239], a[236:239], 0
    s_add_u32 s36, s36, s28
    v_cvt_pk_bf16_f32 v40, v80, v81
    v_mfma_f32_16x16x32_bf16 v[108:111], a[236:239], a[236:239], 0
    s_add_u32 s36, s36, 0x3600000
    v_cvt_pk_bf16_f32 v41, v82, v83
    v_mfma_f32_16x16x32_bf16 v[124:127], a[236:239], a[236:239], 0
    buffer_load_dwordx4 v[220:223], v2, s[12:15], s36 offen sc1
    v_exp_f32 v84, v12
    v_mfma_f32_16x16x32_bf16 v[140:143], a[236:239], a[236:239], 0
    s_add_u32 s36, s36, 0x20000
    v_exp_f32 v85, v13
    buffer_load_dwordx4 v[224:227], v2, s[12:15], s36 offen sc1
    v_exp_f32 v86, v14
    s_add_u32 s36, s36, 0x20000
    v_exp_f32 v87, v15
    buffer_load_dwordx4 v[228:231], v2, s[12:15], s36 offen sc1
    v_cvt_pk_bf16_f32 v44, v84, v85
    s_add_u32 s36, s36, 0x20000
    v_cvt_pk_bf16_f32 v45, v86, v87
    buffer_load_dwordx4 v[232:235], v2, s[12:15], s36 offen sc1
    v_exp_f32 v80, v16
    s_add_u32 s36, s36, 0x20000
    v_exp_f32 v81, v17
    buffer_load_dwordx4 v[236:239], v2, s[12:15], s36 offen sc1
    v_exp_f32 v82, v18
    s_add_u32 s36, s36, 0x20000
    v_exp_f32 v83, v19
    buffer_load_dwordx4 v[240:243], v2, s[12:15], s36 offen sc1
    v_cvt_pk_bf16_f32 v42, v80, v81
    s_add_u32 s36, s36, 0x20000
    v_cvt_pk_bf16_f32 v43, v82, v83
    buffer_load_dwordx4 v[244:247], v2, s[12:15], s36 offen sc1
    s_add_u32 s36, s36, 0x20000
    buffer_load_dwordx4 v[248:251], v2, s[12:15], s36 offen sc1
    s_lshl_b32 s36, s26, 2
    s_add_u32 s36, s36, s24
    s_lshl_b32 s36, s36, 16
    s_lshl_b32 s28, s25, 10
    s_add_u32 s36, s36, s28
    s_add_u32 s36, s36, 0x3200000
    buffer_load_dwordx4 a[132:135], v2, s[12:15], s36 offen sc1
    s_add_u32 s36, s36, 0x8000
    buffer_load_dwordx4 a[136:139], v2, s[12:15], s36 offen sc1
    s_lshl_b32 s36, s34, 3
    s_add_u32 s36, s36, s24
    s_lshl_b32 s36, s36, 17
    s_lshl_b32 s28, s25, 12
    s_add_u32 s36, s36, s28
    s_add_u32 s36, s36, 0x2000000
    s_mov_b32 s33, 0
    s_sub_u32 s3, s34, 2
    s_max_i32 s3, s3, 0
    s_bitset1_b32 s33, s3
    s_and_b32 s33, s33, 0xfffffff8
    s_branch L2_loop
L2_ftail:
    s_lshr_b32 s52, s2, 5
    s_mul_i32 s52, s52, 2
    s_bfe_u32 s41, s2, 0x20001
    s_lshl_b32 s48, s24, 14
    s_lshl_b32 s47, s41, 20
    s_add_u32 s47, s47, s48
    s_bfe_u32 s55, s2, 0x20003
    s_lshl_b32 s35, s55, 8
    s_add_u32 s47, s47, s35
    s_cmp_eq_u32 s24, 0
    s_cbranch_scc1 L2_ftail0
    s_cmp_eq_u32 s24, 1
    s_cbranch_scc1 L2_ftail1
    s_cmp_eq_u32 s24, 2
    s_cbranch_scc1 L2_ftail2
    v_mfma_f32_16x16x32_bf16 v[24:27], a[32:35], v[152:155], v[56:59]
    s_barrier
    ds_read_b128 a[0:3], v1 offset:8192
    ds_read_b128 a[4:7], v1 offset:9216
    ds_read_b128 a[8:11], v1 offset:10240
    ds_read_b128 a[12:15], v1 offset:11264
    ds_read_b128 a[96:99], v1 offset:0
    ds_read_b128 a[100:103], v1 offset:1024
    ds_read_b128 a[104:107], v1 offset:2048
    ds_read_b128 a[108:111], v1 offset:3072
    s_add_u32 m0, s48, 65536
    v_mfma_f32_16x16x32_bf16 v[28:31], a[32:35], v[168:171], v[60:63]
    s_add_u32 s53, s52, 0
    v_exp_f32 v84, v20
    v_mfma_f32_16x16x32_bf16 v[24:27], a[36:39], v[156:159], v[24:27]
    s_and_b32 s53, s53, 15
    ds_read_b128 a[112:115], v1 offset:4096
    ds_read_b128 a[116:119], v1 offset:5120
    v_mfma_f32_16x16x32_bf16 v[28:31], a[36:39], v[172:175], v[28:31]
    s_lshl_b32 s53, s53, 16
    v_exp_f32 v85, v21
    v_mfma_f32_16x16x32_bf16 v[24:27], a[40:43], v[160:163], v[24:27]
    s_add_u32 s53, s53, s47
    buffer_load_dwordx4 v192, s[60:63], s53 offen offset:0 lds
    v_add_f32 v220, v220, v236
    v_mfma_f32_16x16x32_bf16 v[28:31], a[40:43], v[176:179], v[28:31]
    v_exp_f32 v86, v22
    v_mfma_f32_16x16x32_bf16 v[24:27], a[44:47], v[164:167], v[24:27]
    ds_read_b128 a[120:123], v1 offset:6144
    ds_read_b128 a[124:127], v1 offset:7168
    v_mfma_f32_16x16x32_bf16 v[28:31], a[44:47], v[180:183], v[28:31]
    v_exp_f32 v87, v23
    v_mfma_f32_16x16x32_bf16 v[32:35], a[48:51], v[152:155], v[56:59]
    buffer_load_dwordx4 v193, s[60:63], s53 offen offset:1024 lds
    v_cvt_pk_bf16_f32 v46, v84, v85
    v_mfma_f32_16x16x32_bf16 v[36:39], a[48:51], v[168:171], v[60:63]
    ds_read_b128 a[172:175], v1 offset:24576
    v_cvt_pk_bf16_f32 v47, v86, v87
    v_mfma_f32_16x16x32_bf16 v[32:35], a[52:55], v[156:159], v[32:35]
    ds_read_b128 a[176:179], v1 offset:25600
    ds_read_b128 a[180:183], v1 offset:26624
    v_mfma_f32_16x16x32_bf16 v[72:75], a[128:131], v[40:43], v[64:67]
    ds_read_b128 a[184:187], v1 offset:27648
    ds_read_b128 a[188:191], v1 offset:28672
    v_mfma_f32_16x16x32_bf16 v[76:79], a[128:131], v[44:47], v[68:71]
    buffer_load_dwordx4 v194, s[60:63], s53 offen offset:2048 lds
    v_add_f32 v221, v221, v237
    v_mfma_f32_16x16x32_bf16 v[36:39], a[52:55], v[172:175], v[36:39]
    ds_read_b128 a[192:195], v1 offset:29696
    v_add_f32 v222, v222, v238
    v_mfma_f32_16x16x32_bf16 v[32:35], a[56:59], v[160:163], v[32:35]
    ds_read_b128 a[196:199], v1 offset:30720
    v_add_f32 v223, v223, v239
    v_mfma_f32_16x16x32_bf16 v[36:39], a[56:59], v[176:179], v[36:39]
    ds_read_b128 a[200:203], v1 offset:31744
    v_max_f32 v6, v72, v76
    v_mfma_f32_16x16x32_bf16 v[32:35], a[60:63], v[164:167], v[32:35]
    buffer_load_dwordx4 v195, s[60:63], s53 offen offset:3072 lds
    v_cmp_lt_f32 vcc, s37, v6
    v_mfma_f32_16x16x32_bf16 v[36:39], a[60:63], v[180:183], v[36:39]
    s_add_u32 m0, s48, 69632
    s_add_u32 s53, s52, 1
    v_add_f32 v224, v224, v240
    s_cbranch_vccnz FB_concat_43
BK_concat_44:
    v_mfma_f32_16x16x32_bf16 v[88:91], a[64:67], v[40:43], v[88:91]
    s_and_b32 s53, s53, 15
    s_lshl_b32 s53, s53, 16
    v_add_f32 v225, v225, v241
    v_mfma_f32_16x16x32_bf16 v[92:95], a[64:67], v[44:47], v[92:95]
    s_add_u32 s53, s53, s47
    v_exp_f32 v80, v24
    v_mfma_f32_16x16x32_bf16 v[96:99], a[68:71], v[40:43], v[96:99]
    buffer_load_dwordx4 v192, s[60:63], s53 offen offset:0 lds
    v_add_f32 v226, v226, v242
    v_mfma_f32_16x16x32_bf16 v[100:103], a[68:71], v[44:47], v[100:103]
    v_exp_f32 v81, v25
    v_mfma_f32_16x16x32_bf16 v[104:107], a[72:75], v[40:43], v[104:107]
    buffer_load_dwordx4 v193, s[60:63], s53 offen offset:1024 lds
    v_add_f32 v227, v227, v243
    v_mfma_f32_16x16x32_bf16 v[108:111], a[72:75], v[44:47], v[108:111]
    v_exp_f32 v82, v26
    v_mfma_f32_16x16x32_bf16 v[112:115], a[76:79], v[40:43], v[112:115]
    buffer_load_dwordx4 v194, s[60:63], s53 offen offset:2048 lds
    v_cvt_pk_bf16_f32 v48, v80, v81
    v_mfma_f32_16x16x32_bf16 v[116:119], a[76:79], v[44:47], v[116:119]
    v_exp_f32 v83, v27
    v_mfma_f32_16x16x32_bf16 v[120:123], a[80:83], v[40:43], v[120:123]
    buffer_load_dwordx4 v195, s[60:63], s53 offen offset:3072 lds
    v_cvt_pk_bf16_f32 v49, v82, v83
    v_mfma_f32_16x16x32_bf16 v[124:127], a[80:83], v[44:47], v[124:127]
    s_add_u32 m0, s48, 73728
    v_exp_f32 v84, v28
    v_mfma_f32_16x16x32_bf16 v[128:131], a[84:87], v[40:43], v[128:131]
    s_add_u32 s53, s52, 2
    s_and_b32 s53, s53, 15
    v_add_f32 v228, v228, v244
    v_mfma_f32_16x16x32_bf16 v[132:135], a[84:87], v[44:47], v[132:135]
    s_lshl_b32 s53, s53, 16
    v_exp_f32 v85, v29
    v_mfma_f32_16x16x32_bf16 v[136:139], a[88:91], v[40:43], v[136:139]
    s_add_u32 s53, s53, s47
    buffer_load_dwordx4 v192, s[60:63], s53 offen offset:0 lds
    v_add_f32 v229, v229, v245
    v_mfma_f32_16x16x32_bf16 v[140:143], a[88:91], v[44:47], v[140:143]
    v_exp_f32 v86, v30
    v_mfma_f32_16x16x32_bf16 v[144:147], a[92:95], v[40:43], v[144:147]
    buffer_load_dwordx4 v193, s[60:63], s53 offen offset:1024 lds
    v_cvt_pk_bf16_f32 v52, v84, v85
    v_mfma_f32_16x16x32_bf16 v[148:151], a[92:95], v[44:47], v[148:151]
    v_exp_f32 v87, v31
    s_waitcnt lgkmcnt(15)
    v_cvt_pk_bf16_f32 v53, v86, v87
    v_cndmask_b32 v32, v32, v5, s[16:17]
    v_cndmask_b32 v33, v33, v5, s[18:19]
    v_cndmask_b32 v34, v34, v5, s[20:21]
    v_cndmask_b32 v35, v35, v5, s[22:23]
    v_exp_f32 v80, v32
    v_exp_f32 v81, v33
    v_exp_f32 v82, v34
    v_cvt_pk_bf16_f32 v50, v80, v81
    v_exp_f32 v83, v35
    v_add_f32 v230, v230, v246
    v_cvt_pk_bf16_f32 v51, v82, v83
    v_exp_f32 v84, v36
    v_exp_f32 v85, v37
    v_exp_f32 v86, v38
    v_cvt_pk_bf16_f32 v54, v84, v85
    v_exp_f32 v87, v39
    v_add_f32 v231, v231, v247
    v_cvt_pk_bf16_f32 v55, v86, v87
    v_mfma_f32_16x16x32_bf16 v[64:67], a[128:131], v[48:51], v[72:75]
    buffer_load_dwordx4 v194, s[60:63], s53 offen offset:2048 lds
    v_add_f32 v232, v232, v248
    v_mfma_f32_16x16x32_bf16 v[68:71], a[128:131], v[52:55], v[76:79]
    buffer_load_dwordx4 v195, s[60:63], s53 offen offset:3072 lds
    v_add_f32 v233, v233, v249
    v_mfma_f32_16x16x32_bf16 v[12:15], a[0:3], v[168:171], v[60:63]
    s_add_u32 m0, s48, 77824
    s_add_u32 s53, s52, 3
    v_add_f32 v234, v234, v250
    v_mfma_f32_16x16x32_bf16 v[12:15], a[4:7], v[172:175], v[12:15]
    s_and_b32 s53, s53, 15
    s_lshl_b32 s53, s53, 16
    v_max_f32 v6, v64, v68
    v_mfma_f32_16x16x32_bf16 v[12:15], a[8:11], v[176:179], v[12:15]
    s_add_u32 s53, s53, s47
    buffer_load_dwordx4 v192, s[60:63], s53 offen offset:0 lds
    v_cmp_lt_f32 vcc, s37, v6
    v_mfma_f32_16x16x32_bf16 v[12:15], a[12:15], v[180:183], v[12:15]
    buffer_load_dwordx4 v193, s[60:63], s53 offen offset:1024 lds
    v_add_f32 v235, v235, v251
    s_waitcnt lgkmcnt(8)
    s_cbranch_vccnz FB_concat_45
BK_concat_46:
    v_mfma_f32_16x16x32_bf16 v[88:91], a[96:99], v[48:51], v[88:91]
    buffer_load_dwordx4 v194, s[60:63], s53 offen offset:2048 lds
    v_add_f32 v220, v220, v228
    v_mfma_f32_16x16x32_bf16 v[92:95], a[96:99], v[52:55], v[92:95]
    v_rcp_f32 v217, v64
    v_mfma_f32_16x16x32_bf16 v[96:99], a[100:103], v[48:51], v[96:99]
    buffer_load_dwordx4 v195, s[60:63], s53 offen offset:3072 lds
    v_cndmask_b32 v12, v12, v5, s[16:17]
    v_mfma_f32_16x16x32_bf16 v[100:103], a[100:103], v[52:55], v[100:103]
    v_cndmask_b32 v13, v13, v5, s[18:19]
    v_cndmask_b32 v14, v14, v5, s[20:21]
    v_mfma_f32_16x16x32_bf16 v[104:107], a[104:107], v[48:51], v[104:107]
    v_cndmask_b32 v15, v15, v5, s[22:23]
    v_add_f32 v221, v221, v229
    v_mfma_f32_16x16x32_bf16 v[108:111], a[104:107], v[52:55], v[108:111]
    v_exp_f32 v84, v12
    v_mfma_f32_16x16x32_bf16 v[112:115], a[108:111], v[48:51], v[112:115]
    v_exp_f32 v85, v13
    v_mfma_f32_16x16x32_bf16 v[116:119], a[108:111], v[52:55], v[116:119]
    v_exp_f32 v86, v14
    v_mfma_f32_16x16x32_bf16 v[120:123], a[112:115], v[48:51], v[120:123]
    v_cvt_pk_bf16_f32 v44, v84, v85
    v_add_f32 v222, v222, v230
    v_mfma_f32_16x16x32_bf16 v[124:127], a[112:115], v[52:55], v[124:127]
    v_exp_f32 v87, v15
    v_mfma_f32_16x16x32_bf16 v[128:131], a[116:119], v[48:51], v[128:131]
    v_cvt_pk_bf16_f32 v45, v86, v87
    v_mov_b32 v20, v5
    v_mfma_f32_16x16x32_bf16 v[132:135], a[116:119], v[52:55], v[132:135]
    v_mov_b32 v21, v5
    v_mov_b32 v22, v5
    v_mfma_f32_16x16x32_bf16 v[136:139], a[120:123], v[48:51], v[136:139]
    v_mov_b32 v23, v5
    v_mov_b32 v46, 0
    v_mfma_f32_16x16x32_bf16 v[140:143], a[120:123], v[52:55], v[140:143]
    v_mov_b32 v47, 0
    v_add_f32 v223, v223, v231
    v_mfma_f32_16x16x32_bf16 v[144:147], a[124:127], v[48:51], v[144:147]
    v_add_f32 v224, v224, v232
    v_add_f32 v225, v225, v233
    v_mfma_f32_16x16x32_bf16 v[148:151], a[124:127], v[52:55], v[148:151]
    v_add_f32 v226, v226, v234
    v_add_f32 v227, v227, v235
    v_mfma_f32_16x16x32_bf16 v[76:79], a[128:131], v[44:47], v[68:71]
    v_mul_f32 v217, s43, v217
    v_mul_f32 v88, v88, v217
    v_mul_f32 v89, v89, v217
    v_mul_f32 v90, v90, v217
    v_mul_f32 v91, v91, v217
    v_cvt_pk_bf16_f32 v88, v88, v89
    v_cvt_pk_bf16_f32 v89, v90, v91
    v_mul_f32 v96, v96, v217
    v_cmp_lt_f32 vcc, s37, v76
    s_waitcnt lgkmcnt(0)
    s_cbranch_vccnz FB_concat_47
BK_concat_48:
    v_mfma_f32_16x16x32_bf16 v[92:95], a[172:175], v[44:47], v[92:95]
    v_mul_f32 v97, v97, v217
    v_mul_f32 v98, v98, v217
    v_mfma_f32_16x16x32_bf16 v[100:103], a[176:179], v[44:47], v[100:103]
    v_mul_f32 v99, v99, v217
    v_cvt_pk_bf16_f32 v90, v96, v97
    v_mfma_f32_16x16x32_bf16 v[108:111], a[180:183], v[44:47], v[108:111]
    v_cvt_pk_bf16_f32 v91, v98, v99
    v_add_f32 v220, v220, v224
    v_mfma_f32_16x16x32_bf16 v[116:119], a[184:187], v[44:47], v[116:119]
    buffer_store_dwordx4 v[88:91], v2, s[12:15], s36 offen offset:0 sc1
    v_mul_f32 v104, v104, v217
    v_mfma_f32_16x16x32_bf16 v[124:127], a[188:191], v[44:47], v[124:127]
    v_mul_f32 v105, v105, v217
    v_mul_f32 v106, v106, v217
    v_mfma_f32_16x16x32_bf16 v[132:135], a[192:195], v[44:47], v[132:135]
    v_mul_f32 v107, v107, v217
    v_cvt_pk_bf16_f32 v104, v104, v105
    v_mfma_f32_16x16x32_bf16 v[140:143], a[196:199], v[44:47], v[140:143]
    v_cvt_pk_bf16_f32 v105, v106, v107
    v_mul_f32 v112, v112, v217
    v_mfma_f32_16x16x32_bf16 v[148:151], a[200:203], v[44:47], v[148:151]
    v_mul_f32 v113, v113, v217
    v_mul_f32 v114, v114, v217
    v_mul_f32 v115, v115, v217
    v_add_f32 v221, v221, v225
    v_cvt_pk_bf16_f32 v106, v112, v113
    v_add_f32 v222, v222, v226
    v_cvt_pk_bf16_f32 v107, v114, v115
    v_add_f32 v223, v223, v227
    buffer_store_dwordx4 v[104:107], v2, s[12:15], s36 offen offset:1024 sc1
    v_cvt_pk_bf16_f32 v220, v220, v221
    v_mul_f32 v120, v120, v217
    v_cvt_pk_bf16_f32 v221, v222, v223
    v_mul_f32 v121, v121, v217
    v_lshlrev_b32 v224, 3, v0
    v_mul_f32 v122, v122, v217
    s_lshl_b32 s28, s24, 9
    v_mul_f32 v123, v123, v217
    s_add_u32 s28, s28, 155648
    v_cvt_pk_bf16_f32 v120, v120, v121
    v_add_u32 v224, s28, v224
    v_cvt_pk_bf16_f32 v121, v122, v123
    ds_write_b64 v224, v[220:221]
    v_mul_f32 v128, v128, v217
    v_mul_f32 v129, v129, v217
    v_mul_f32 v130, v130, v217
    v_mul_f32 v131, v131, v217
    v_cvt_pk_bf16_f32 v122, v128, v129
    v_cvt_pk_bf16_f32 v123, v130, v131
    buffer_store_dwordx4 v[120:123], v2, s[12:15], s36 offen offset:2048 sc1
    v_mul_f32 v136, v136, v217
    v_mul_f32 v137, v137, v217
    v_mul_f32 v138, v138, v217
    v_mul_f32 v139, v139, v217
    v_cvt_pk_bf16_f32 v136, v136, v137
    v_cvt_pk_bf16_f32 v137, v138, v139
    v_mul_f32 v144, v144, v217
    v_mul_f32 v145, v145, v217
    v_mul_f32 v146, v146, v217
    v_mul_f32 v147, v147, v217
    v_cvt_pk_bf16_f32 v138, v144, v145
    v_cvt_pk_bf16_f32 v139, v146, v147
    buffer_store_dwordx4 v[136:139], v2, s[12:15], s36 offen offset:3072 sc1
    v_rcp_f32 v7, v76
    s_nop 0
    v_mul_f32 v7, s43, v7
    s_branch L2_fin
L2_ftail2:
    v_mfma_f32_16x16x32_bf16 v[24:27], a[32:35], v[152:155], v[56:59]
    s_barrier
    ds_read_b128 a[0:3], v1 offset:8192
    ds_read_b128 a[4:7], v1 offset:9216
    ds_read_b128 a[8:11], v1 offset:10240
    ds_read_b128 a[12:15], v1 offset:11264
    ds_read_b128 a[16:19], v1 offset:12288
    ds_read_b128 a[20:23], v1 offset:13312
    ds_read_b128 a[24:27], v1 offset:14336
    ds_read_b128 a[28:31], v1 offset:15360
    s_add_u32 m0, s48, 65536
    v_mfma_f32_16x16x32_bf16 v[28:31], a[32:35], v[168:171], v[60:63]
    s_add_u32 s53, s52, 0
    v_exp_f32 v84, v20
    v_mfma_f32_16x16x32_bf16 v[24:27], a[36:39], v[156:159], v[24:27]
    s_and_b32 s53, s53, 15
    ds_read_b128 a[96:99], v1 offset:0
    ds_read_b128 a[100:103], v1 offset:1024
    v_mfma_f32_16x16x32_bf16 v[28:31], a[36:39], v[172:175], v[28:31]
    s_lshl_b32 s53, s53, 16
    v_exp_f32 v85, v21
    v_mfma_f32_16x16x32_bf16 v[24:27], a[40:43], v[160:163], v[24:27]
    s_add_u32 s53, s53, s47
    buffer_load_dwordx4 v192, s[60:63], s53 offen offset:0 lds
    v_add_f32 v220, v220, v236
    v_mfma_f32_16x16x32_bf16 v[28:31], a[40:43], v[176:179], v[28:31]
    v_exp_f32 v86, v22
    v_mfma_f32_16x16x32_bf16 v[24:27], a[44:47], v[164:167], v[24:27]
    ds_read_b128 a[104:107], v1 offset:2048
    ds_read_b128 a[108:111], v1 offset:3072
    v_exp_f32 v87, v23
    v_cvt_pk_bf16_f32 v46, v84, v85
    v_cvt_pk_bf16_f32 v47, v86, v87
    v_mfma_f32_16x16x32_bf16 v[72:75], a[128:131], v[40:43], v[64:67]
    ds_read_b128 a[112:115], v1 offset:4096
    ds_read_b128 a[116:119], v1 offset:5120
    v_mfma_f32_16x16x32_bf16 v[76:79], a[128:131], v[44:47], v[68:71]
    buffer_load_dwordx4 v193, s[60:63], s53 offen offset:1024 lds
    v_add_f32 v221, v221, v237
    v_mfma_f32_16x16x32_bf16 v[28:31], a[44:47], v[180:183], v[28:31]
    ds_read_b128 a[120:123], v1 offset:6144
    v_add_f32 v222, v222, v238
    v_mfma_f32_16x16x32_bf16 v[36:39], a[48:51], v[168:171], v[60:63]
    ds_read_b128 a[124:127], v1 offset:7168
    v_add_f32 v223, v223, v239
    v_mfma_f32_16x16x32_bf16 v[36:39], a[52:55], v[172:175], v[36:39]
    ds_read_b128 a[172:175], v1 offset:24576
    v_max_f32 v6, v72, v76
    v_mfma_f32_16x16x32_bf16 v[36:39], a[56:59], v[176:179], v[36:39]
    buffer_load_dwordx4 v194, s[60:63], s53 offen offset:2048 lds
    v_cmp_lt_f32 vcc, s37, v6
    v_mfma_f32_16x16x32_bf16 v[36:39], a[60:63], v[180:183], v[36:39]
    ds_read_b128 a[176:179], v1 offset:25600
    ds_read_b128 a[180:183], v1 offset:26624
    s_cbranch_vccnz FB_concat_49
BK_concat_50:
    v_mfma_f32_16x16x32_bf16 v[88:91], a[64:67], v[40:43], v[88:91]
    ds_read_b128 a[184:187], v1 offset:27648
    v_cndmask_b32 v24, v24, v5, s[16:17]
    v_mfma_f32_16x16x32_bf16 v[92:95], a[64:67], v[44:47], v[92:95]
    ds_read_b128 a[188:191], v1 offset:28672
    v_cndmask_b32 v25, v25, v5, s[18:19]
    v_mfma_f32_16x16x32_bf16 v[96:99], a[68:71], v[40:43], v[96:99]
    buffer_load_dwordx4 v195, s[60:63], s53 offen offset:3072 lds
    v_cndmask_b32 v26, v26, v5, s[20:21]
    v_mfma_f32_16x16x32_bf16 v[100:103], a[68:71], v[44:47], v[100:103]
    s_add_u32 m0, s48, 69632
    ds_read_b128 a[192:195], v1 offset:29696
    s_add_u32 s53, s52, 1
    v_mfma_f32_16x16x32_bf16 v[104:107], a[72:75], v[40:43], v[104:107]
    s_and_b32 s53, s53, 15
    ds_read_b128 a[196:199], v1 offset:30720
    s_lshl_b32 s53, s53, 16
    v_mfma_f32_16x16x32_bf16 v[108:111], a[72:75], v[44:47], v[108:111]
    s_add_u32 s53, s53, s47
    ds_read_b128 a[200:203], v1 offset:31744
    v_cndmask_b32 v27, v27, v5, s[22:23]
    v_mfma_f32_16x16x32_bf16 v[112:115], a[76:79], v[40:43], v[112:115]
    buffer_load_dwordx4 v192, s[60:63], s53 offen offset:0 lds
    v_add_f32 v224, v224, v240
    v_mfma_f32_16x16x32_bf16 v[116:119], a[76:79], v[44:47], v[116:119]
    v_exp_f32 v80, v24
    v_mfma_f32_16x16x32_bf16 v[120:123], a[80:83], v[40:43], v[120:123]
    buffer_load_dwordx4 v193, s[60:63], s53 offen offset:1024 lds
    v_add_f32 v225, v225, v241
    v_mfma_f32_16x16x32_bf16 v[124:127], a[80:83], v[44:47], v[124:127]
    v_exp_f32 v81, v25
    v_mfma_f32_16x16x32_bf16 v[128:131], a[84:87], v[40:43], v[128:131]
    buffer_load_dwordx4 v194, s[60:63], s53 offen offset:2048 lds
    v_add_f32 v226, v226, v242
    v_mfma_f32_16x16x32_bf16 v[132:135], a[84:87], v[44:47], v[132:135]
    v_exp_f32 v82, v26
    v_mfma_f32_16x16x32_bf16 v[136:139], a[88:91], v[40:43], v[136:139]
    buffer_load_dwordx4 v195, s[60:63], s53 offen offset:3072 lds
    v_cvt_pk_bf16_f32 v48, v80, v81
    v_mfma_f32_16x16x32_bf16 v[140:143], a[88:91], v[44:47], v[140:143]
    s_add_u32 m0, s48, 73728
    v_exp_f32 v83, v27
    v_mfma_f32_16x16x32_bf16 v[144:147], a[92:95], v[40:43], v[144:147]
    s_add_u32 s53, s52, 2
    s_and_b32 s53, s53, 15
    v_cvt_pk_bf16_f32 v49, v82, v83
    v_mfma_f32_16x16x32_bf16 v[148:151], a[92:95], v[44:47], v[148:151]
    s_lshl_b32 s53, s53, 16
    v_exp_f32 v84, v28
    s_waitcnt lgkmcnt(15)
    v_mfma_f32_16x16x32_bf16 v[12:15], a[0:3], v[168:171], v[60:63]
    s_add_u32 s53, s53, s47
    buffer_load_dwordx4 v192, s[60:63], s53 offen offset:0 lds
    v_add_f32 v227, v227, v243
    v_mfma_f32_16x16x32_bf16 v[12:15], a[4:7], v[172:175], v[12:15]
    v_exp_f32 v85, v29
    v_mfma_f32_16x16x32_bf16 v[12:15], a[8:11], v[176:179], v[12:15]
    buffer_load_dwordx4 v193, s[60:63], s53 offen offset:1024 lds
    v_add_f32 v228, v228, v244
    v_exp_f32 v86, v30
    v_cvt_pk_bf16_f32 v52, v84, v85
    v_exp_f32 v87, v31
    v_add_f32 v229, v229, v245
    v_cvt_pk_bf16_f32 v53, v86, v87
    v_mov_b32 v32, v5
    v_mov_b32 v33, v5
    v_mov_b32 v34, v5
    v_mov_b32 v35, v5
    v_mov_b32 v50, 0
    v_mov_b32 v51, 0
    v_exp_f32 v84, v36
    v_exp_f32 v85, v37
    v_exp_f32 v86, v38
    v_cvt_pk_bf16_f32 v54, v84, v85
    v_exp_f32 v87, v39
    v_add_f32 v230, v230, v246
    v_cvt_pk_bf16_f32 v55, v86, v87
    v_mfma_f32_16x16x32_bf16 v[64:67], a[128:131], v[48:51], v[72:75]
    buffer_load_dwordx4 v194, s[60:63], s53 offen offset:2048 lds
    v_add_f32 v231, v231, v247
    v_mfma_f32_16x16x32_bf16 v[68:71], a[128:131], v[52:55], v[76:79]
    buffer_load_dwordx4 v195, s[60:63], s53 offen offset:3072 lds
    v_add_f32 v232, v232, v248
    v_mfma_f32_16x16x32_bf16 v[12:15], a[12:15], v[180:183], v[12:15]
    s_add_u32 m0, s48, 77824
    s_add_u32 s53, s52, 3
    v_add_f32 v233, v233, v249
    v_mfma_f32_16x16x32_bf16 v[20:23], a[16:19], v[168:171], v[60:63]
    s_and_b32 s53, s53, 15
    s_lshl_b32 s53, s53, 16
    v_max_f32 v6, v64, v68
    v_mfma_f32_16x16x32_bf16 v[20:23], a[20:23], v[172:175], v[20:23]
    s_add_u32 s53, s53, s47
    buffer_load_dwordx4 v192, s[60:63], s53 offen offset:0 lds
    v_cmp_lt_f32 vcc, s37, v6
    v_mfma_f32_16x16x32_bf16 v[20:23], a[24:27], v[176:179], v[20:23]
    buffer_load_dwordx4 v193, s[60:63], s53 offen offset:1024 lds
    v_add_f32 v234, v234, v250
    v_mfma_f32_16x16x32_bf16 v[20:23], a[28:31], v[180:183], v[20:23]
    buffer_load_dwordx4 v194, s[60:63], s53 offen offset:2048 lds
    v_add_f32 v235, v235, v251
    s_waitcnt lgkmcnt(8)
    s_cbranch_vccnz FB_concat_51
BK_concat_52:
    v_mfma_f32_16x16x32_bf16 v[88:91], a[96:99], v[48:51], v[88:91]
    buffer_load_dwordx4 v195, s[60:63], s53 offen offset:3072 lds
    v_add_f32 v220, v220, v228
    v_mfma_f32_16x16x32_bf16 v[92:95], a[96:99], v[52:55], v[92:95]
    v_rcp_f32 v217, v64
    v_mfma_f32_16x16x32_bf16 v[96:99], a[100:103], v[48:51], v[96:99]
    v_exp_f32 v84, v12
    v_mfma_f32_16x16x32_bf16 v[100:103], a[100:103], v[52:55], v[100:103]
    v_exp_f32 v85, v13
    v_mfma_f32_16x16x32_bf16 v[104:107], a[104:107], v[48:51], v[104:107]
    v_exp_f32 v86, v14
    v_mfma_f32_16x16x32_bf16 v[108:111], a[104:107], v[52:55], v[108:111]
    v_cvt_pk_bf16_f32 v44, v84, v85
    v_add_f32 v221, v221, v229
    v_mfma_f32_16x16x32_bf16 v[112:115], a[108:111], v[48:51], v[112:115]
    v_exp_f32 v87, v15
    v_mfma_f32_16x16x32_bf16 v[116:119], a[108:111], v[52:55], v[116:119]
    v_cvt_pk_bf16_f32 v45, v86, v87
    v_cndmask_b32 v20, v20, v5, s[16:17]
    v_mfma_f32_16x16x32_bf16 v[120:123], a[112:115], v[48:51], v[120:123]
    v_cndmask_b32 v21, v21, v5, s[18:19]
    v_cndmask_b32 v22, v22, v5, s[20:21]
    v_mfma_f32_16x16x32_bf16 v[124:127], a[112:115], v[52:55], v[124:127]
    v_cndmask_b32 v23, v23, v5, s[22:23]
    v_add_f32 v222, v222, v230
    v_mfma_f32_16x16x32_bf16 v[128:131], a[116:119], v[48:51], v[128:131]
    v_exp_f32 v84, v20
    v_mfma_f32_16x16x32_bf16 v[132:135], a[116:119], v[52:55], v[132:135]
    v_exp_f32 v85, v21
    v_mfma_f32_16x16x32_bf16 v[136:139], a[120:123], v[48:51], v[136:139]
    v_exp_f32 v86, v22
    v_mfma_f32_16x16x32_bf16 v[140:143], a[120:123], v[52:55], v[140:143]
    v_cvt_pk_bf16_f32 v46, v84, v85
    v_add_f32 v223, v223, v231
    v_mfma_f32_16x16x32_bf16 v[144:147], a[124:127], v[48:51], v[144:147]
    v_exp_f32 v87, v23
    v_mfma_f32_16x16x32_bf16 v[148:151], a[124:127], v[52:55], v[148:151]
    v_cvt_pk_bf16_f32 v47, v86, v87
    v_add_f32 v224, v224, v232
    s_nop 0
    v_mfma_f32_16x16x32_bf16 v[76:79], a[128:131], v[44:47], v[68:71]
    v_mul_f32 v217, s43, v217
    v_mul_f32 v88, v88, v217
    v_mul_f32 v89, v89, v217
    v_mul_f32 v90, v90, v217
    v_mul_f32 v91, v91, v217
    v_cvt_pk_bf16_f32 v88, v88, v89
    v_cvt_pk_bf16_f32 v89, v90, v91
    v_mul_f32 v96, v96, v217
    v_cmp_lt_f32 vcc, s37, v76
    s_waitcnt lgkmcnt(0)
    s_cbranch_vccnz FB_concat_53
BK_concat_54:
    v_mfma_f32_16x16x32_bf16 v[92:95], a[172:175], v[44:47], v[92:95]
    v_mul_f32 v97, v97, v217
    v_mul_f32 v98, v98, v217
    v_mfma_f32_16x16x32_bf16 v[100:103], a[176:179], v[44:47], v[100:103]
    v_mul_f32 v99, v99, v217
    v_cvt_pk_bf16_f32 v90, v96, v97
    v_mfma_f32_16x16x32_bf16 v[108:111], a[180:183], v[44:47], v[108:111]
    v_cvt_pk_bf16_f32 v91, v98, v99
    v_add_f32 v225, v225, v233
    v_mfma_f32_16x16x32_bf16 v[116:119], a[184:187], v[44:47], v[116:119]
    buffer_store_dwordx4 v[88:91], v2, s[12:15], s36 offen offset:0 sc1
    v_mul_f32 v104, v104, v217
    v_mfma_f32_16x16x32_bf16 v[124:127], a[188:191], v[44:47], v[124:127]
    v_mul_f32 v105, v105, v217
    v_mul_f32 v106, v106, v217
    v_mfma_f32_16x16x32_bf16 v[132:135], a[192:195], v[44:47], v[132:135]
    v_mul_f32 v107, v107, v217
    v_cvt_pk_bf16_f32 v104, v104, v105
    v_mfma_f32_16x16x32_bf16 v[140:143], a[196:199], v[44:47], v[140:143]
    v_cvt_pk_bf16_f32 v105, v106, v107
    v_mul_f32 v112, v112, v217
    v_mfma_f32_16x16x32_bf16 v[148:151], a[200:203], v[44:47], v[148:151]
    v_mul_f32 v113, v113, v217
    v_mul_f32 v114, v114, v217
    v_mul_f32 v115, v115, v217
    v_add_f32 v226, v226, v234
    v_cvt_pk_bf16_f32 v106, v112, v113
    v_add_f32 v227, v227, v235
    v_cvt_pk_bf16_f32 v107, v114, v115
    v_add_f32 v220, v220, v224
    buffer_store_dwordx4 v[104:107], v2, s[12:15], s36 offen offset:1024 sc1
    v_add_f32 v221, v221, v225
    v_mul_f32 v120, v120, v217
    v_add_f32 v222, v222, v226
    v_mul_f32 v121, v121, v217
    v_add_f32 v223, v223, v227
    v_mul_f32 v122, v122, v217
    v_cvt_pk_bf16_f32 v220, v220, v221
    v_mul_f32 v123, v123, v217
    v_cvt_pk_bf16_f32 v221, v222, v223
    v_cvt_pk_bf16_f32 v120, v120, v121
    v_lshlrev_b32 v224, 3, v0
    v_cvt_pk_bf16_f32 v121, v122, v123
    s_lshl_b32 s28, s24, 9
    v_mul_f32 v128, v128, v217
    s_add_u32 s28, s28, 155648
    v_mul_f32 v129, v129, v217
    v_add_u32 v224, s28, v224
    v_mul_f32 v130, v130, v217
    ds_write_b64 v224, v[220:221]
    v_mul_f32 v131, v131, v217
    v_cvt_pk_bf16_f32 v122, v128, v129
    v_cvt_pk_bf16_f32 v123, v130, v131
    buffer_store_dwordx4 v[120:123], v2, s[12:15], s36 offen offset:2048 sc1
    v_mul_f32 v136, v136, v217
    v_mul_f32 v137, v137, v217
    v_mul_f32 v138, v138, v217
    v_mul_f32 v139, v139, v217
    v_cvt_pk_bf16_f32 v136, v136, v137
    v_cvt_pk_bf16_f32 v137, v138, v139
    v_mul_f32 v144, v144, v217
    v_mul_f32 v145, v145, v217
    v_mul_f32 v146, v146, v217
    v_mul_f32 v147, v147, v217
    v_cvt_pk_bf16_f32 v138, v144, v145
    v_cvt_pk_bf16_f32 v139, v146, v147
    buffer_store_dwordx4 v[136:139], v2, s[12:15], s36 offen offset:3072 sc1
    v_rcp_f32 v7, v76
    s_nop 0
    v_mul_f32 v7, s43, v7
    s_branch L2_fin
L2_ftail1:
    v_mfma_f32_16x16x32_bf16 v[28:31], a[32:35], v[168:171], v[60:63]
    s_barrier
    ds_read_b128 a[0:3], v1 offset:8192
    ds_read_b128 a[4:7], v1 offset:9216
    ds_read_b128 a[8:11], v1 offset:10240
    ds_read_b128 a[12:15], v1 offset:11264
    ds_read_b128 a[16:19], v1 offset:12288
    ds_read_b128 a[20:23], v1 offset:13312
    ds_read_b128 a[24:27], v1 offset:14336
    ds_read_b128 a[28:31], v1 offset:15360
    s_add_u32 m0, s48, 65536
    v_mfma_f32_16x16x32_bf16 v[28:31], a[36:39], v[172:175], v[28:31]
    s_add_u32 s53, s52, 0
    v_exp_f32 v84, v20
    v_mfma_f32_16x16x32_bf16 v[28:31], a[40:43], v[176:179], v[28:31]
    s_and_b32 s53, s53, 15
    ds_read_b128 a[96:99], v1 offset:0
    ds_read_b128 a[100:103], v1 offset:1024
    v_exp_f32 v85, v21
    v_exp_f32 v86, v22
    v_exp_f32 v87, v23
    v_cvt_pk_bf16_f32 v46, v84, v85
    v_cvt_pk_bf16_f32 v47, v86, v87
    v_cndmask_b32 v16, v16, v5, s[16:17]
    v_cndmask_b32 v17, v17, v5, s[18:19]
    v_cndmask_b32 v18, v18, v5, s[20:21]
    v_cndmask_b32 v19, v19, v5, s[22:23]
    v_exp_f32 v80, v16
    v_exp_f32 v81, v17
    v_exp_f32 v82, v18
    v_cvt_pk_bf16_f32 v42, v80, v81
    v_exp_f32 v83, v19
    v_add_f32 v220, v220, v236
    v_cvt_pk_bf16_f32 v43, v82, v83
    s_nop 1
    v_mfma_f32_16x16x32_bf16 v[72:75], a[128:131], v[40:43], v[64:67]
    s_lshl_b32 s53, s53, 16
    ds_read_b128 a[104:107], v1 offset:2048
    ds_read_b128 a[108:111], v1 offset:3072
    v_mfma_f32_16x16x32_bf16 v[76:79], a[128:131], v[44:47], v[68:71]
    s_add_u32 s53, s53, s47
    buffer_load_dwordx4 v192, s[60:63], s53 offen offset:0 lds
    v_add_f32 v221, v221, v237
    v_mfma_f32_16x16x32_bf16 v[28:31], a[44:47], v[180:183], v[28:31]
    ds_read_b128 a[112:115], v1 offset:4096
    v_add_f32 v222, v222, v238
    v_mfma_f32_16x16x32_bf16 v[36:39], a[48:51], v[168:171], v[60:63]
    ds_read_b128 a[116:119], v1 offset:5120
    v_max_f32 v6, v72, v76
    v_mfma_f32_16x16x32_bf16 v[36:39], a[52:55], v[172:175], v[36:39]
    ds_read_b128 a[120:123], v1 offset:6144
    v_cmp_lt_f32 vcc, s37, v6
    v_mfma_f32_16x16x32_bf16 v[36:39], a[56:59], v[176:179], v[36:39]
    buffer_load_dwordx4 v193, s[60:63], s53 offen offset:1024 lds
    v_add_f32 v223, v223, v239
    v_mfma_f32_16x16x32_bf16 v[36:39], a[60:63], v[180:183], v[36:39]
    ds_read_b128 a[124:127], v1 offset:7168
    ds_read_b128 a[140:143], v1 offset:16384
    s_cbranch_vccnz FB_concat_55
BK_concat_56:
    v_mfma_f32_16x16x32_bf16 v[88:91], a[64:67], v[40:43], v[88:91]
    ds_read_b128 a[144:147], v1 offset:17408
    ds_read_b128 a[148:151], v1 offset:18432
    v_mfma_f32_16x16x32_bf16 v[92:95], a[64:67], v[44:47], v[92:95]
    v_rcp_f32 v217, v72
    v_mfma_f32_16x16x32_bf16 v[96:99], a[68:71], v[40:43], v[96:99]
    buffer_load_dwordx4 v194, s[60:63], s53 offen offset:2048 lds
    v_add_f32 v224, v224, v240
    v_mfma_f32_16x16x32_bf16 v[100:103], a[68:71], v[44:47], v[100:103]
    v_exp_f32 v84, v28
    v_mfma_f32_16x16x32_bf16 v[104:107], a[72:75], v[40:43], v[104:107]
    ds_read_b128 a[152:155], v1 offset:19456
    ds_read_b128 a[172:175], v1 offset:24576
    v_mfma_f32_16x16x32_bf16 v[108:111], a[72:75], v[44:47], v[108:111]
    v_exp_f32 v85, v29
    v_mfma_f32_16x16x32_bf16 v[112:115], a[76:79], v[40:43], v[112:115]
    buffer_load_dwordx4 v195, s[60:63], s53 offen offset:3072 lds
    v_add_f32 v225, v225, v241
    v_mfma_f32_16x16x32_bf16 v[116:119], a[76:79], v[44:47], v[116:119]
    s_add_u32 m0, s48, 69632
    v_exp_f32 v86, v30
    v_mfma_f32_16x16x32_bf16 v[120:123], a[80:83], v[40:43], v[120:123]
    s_add_u32 s53, s52, 1
    ds_read_b128 a[176:179], v1 offset:25600
    s_and_b32 s53, s53, 15
    v_mfma_f32_16x16x32_bf16 v[124:127], a[80:83], v[44:47], v[124:127]
    s_lshl_b32 s53, s53, 16
    ds_read_b128 a[180:183], v1 offset:26624
    s_add_u32 s53, s53, s47
    v_mfma_f32_16x16x32_bf16 v[128:131], a[84:87], v[40:43], v[128:131]
    buffer_load_dwordx4 v192, s[60:63], s53 offen offset:0 lds
    v_cvt_pk_bf16_f32 v52, v84, v85
    v_mfma_f32_16x16x32_bf16 v[132:135], a[84:87], v[44:47], v[132:135]
    v_exp_f32 v87, v31
    v_mfma_f32_16x16x32_bf16 v[136:139], a[88:91], v[40:43], v[136:139]
    ds_read_b128 a[184:187], v1 offset:27648
    v_cvt_pk_bf16_f32 v53, v86, v87
    v_mfma_f32_16x16x32_bf16 v[140:143], a[88:91], v[44:47], v[140:143]
    v_exp_f32 v84, v36
    v_mfma_f32_16x16x32_bf16 v[144:147], a[92:95], v[40:43], v[144:147]
    buffer_load_dwordx4 v193, s[60:63], s53 offen offset:1024 lds
    v_add_f32 v226, v226, v242
    v_mfma_f32_16x16x32_bf16 v[148:151], a[92:95], v[44:47], v[148:151]
    v_exp_f32 v85, v37
    s_waitcnt lgkmcnt(15)
    v_mfma_f32_16x16x32_bf16 v[12:15], a[0:3], v[168:171], v[60:63]
    ds_read_b128 a[188:191], v1 offset:28672
    ds_read_b128 a[192:195], v1 offset:29696
    v_mfma_f32_16x16x32_bf16 v[12:15], a[4:7], v[172:175], v[12:15]
    v_exp_f32 v86, v38
    v_mfma_f32_16x16x32_bf16 v[12:15], a[8:11], v[176:179], v[12:15]
    buffer_load_dwordx4 v194, s[60:63], s53 offen offset:2048 lds
    v_cvt_pk_bf16_f32 v54, v84, v85
    v_exp_f32 v87, v39
    v_mul_f32 v217, s43, v217
    v_cvt_pk_bf16_f32 v55, v86, v87
    s_nop 1
    v_mfma_f32_16x16x32_bf16 v[68:71], a[128:131], v[52:55], v[76:79]
    ds_read_b128 a[196:199], v1 offset:30720
    ds_read_b128 a[200:203], v1 offset:31744
    v_mfma_f32_16x16x32_bf16 v[12:15], a[12:15], v[180:183], v[12:15]
    ds_read_b128 a[204:207], v1 offset:32768
    v_mul_f32 v88, v88, v217
    v_mfma_f32_16x16x32_bf16 v[20:23], a[16:19], v[168:171], v[60:63]
    ds_read_b128 a[208:211], v1 offset:33792
    v_mul_f32 v89, v89, v217
    v_mfma_f32_16x16x32_bf16 v[20:23], a[20:23], v[172:175], v[20:23]
    buffer_load_dwordx4 v195, s[60:63], s53 offen offset:3072 lds
    v_cmp_lt_f32 vcc, s37, v68
    v_mfma_f32_16x16x32_bf16 v[20:23], a[24:27], v[176:179], v[20:23]
    s_add_u32 m0, s48, 73728
    ds_read_b128 a[212:215], v1 offset:34816
    ds_read_b128 a[216:219], v1 offset:35840
    v_mfma_f32_16x16x32_bf16 v[20:23], a[28:31], v[180:183], v[20:23]
    s_add_u32 s53, s52, 2
    ds_read_b128 a[220:223], v1 offset:36864
    ds_read_b128 a[224:227], v1 offset:37888
    s_waitcnt lgkmcnt(15)
    s_cbranch_vccnz FB_concat_57
BK_concat_58:
    v_mfma_f32_16x16x32_bf16 v[92:95], a[96:99], v[52:55], v[92:95]
    s_and_b32 s53, s53, 15
    v_exp_f32 v84, v12
    v_mfma_f32_16x16x32_bf16 v[100:103], a[100:103], v[52:55], v[100:103]
    s_lshl_b32 s53, s53, 16
    ds_read_b128 a[228:231], v1 offset:38912
    ds_read_b128 a[232:235], v1 offset:39936
    v_mfma_f32_16x16x32_bf16 v[108:111], a[104:107], v[52:55], v[108:111]
    s_add_u32 s53, s53, s47
    v_exp_f32 v85, v13
    v_mfma_f32_16x16x32_bf16 v[116:119], a[108:111], v[52:55], v[116:119]
    buffer_load_dwordx4 v192, s[60:63], s53 offen offset:0 lds
    v_mul_f32 v90, v90, v217
    v_mfma_f32_16x16x32_bf16 v[124:127], a[112:115], v[52:55], v[124:127]
    v_exp_f32 v86, v14
    v_mfma_f32_16x16x32_bf16 v[132:135], a[116:119], v[52:55], v[132:135]
    buffer_load_dwordx4 v193, s[60:63], s53 offen offset:1024 lds
    v_cvt_pk_bf16_f32 v44, v84, v85
    v_mfma_f32_16x16x32_bf16 v[140:143], a[120:123], v[52:55], v[140:143]
    v_exp_f32 v87, v15
    v_mfma_f32_16x16x32_bf16 v[148:151], a[124:127], v[52:55], v[148:151]
    buffer_load_dwordx4 v194, s[60:63], s53 offen offset:2048 lds
    v_cvt_pk_bf16_f32 v45, v86, v87
    s_waitcnt lgkmcnt(15)
    v_exp_f32 v84, v20
    v_exp_f32 v85, v21
    v_exp_f32 v86, v22
    v_cvt_pk_bf16_f32 v46, v84, v85
    v_exp_f32 v87, v23
    v_mul_f32 v91, v91, v217
    v_cvt_pk_bf16_f32 v47, v86, v87
    s_nop 1
    v_mfma_f32_16x16x32_bf16 v[76:79], a[128:131], v[44:47], v[68:71]
    buffer_load_dwordx4 v195, s[60:63], s53 offen offset:3072 lds
    v_cvt_pk_bf16_f32 v88, v88, v89
    v_mfma_f32_16x16x32_bf16 v[28:31], a[140:143], v[168:171], v[60:63]
    s_add_u32 m0, s48, 77824
    s_add_u32 s53, s52, 3
    v_cvt_pk_bf16_f32 v89, v90, v91
    v_mfma_f32_16x16x32_bf16 v[28:31], a[144:147], v[172:175], v[28:31]
    s_and_b32 s53, s53, 15
    s_lshl_b32 s53, s53, 16
    v_cmp_lt_f32 vcc, s37, v76
    v_mfma_f32_16x16x32_bf16 v[28:31], a[148:151], v[176:179], v[28:31]
    s_add_u32 s53, s53, s47
    buffer_load_dwordx4 v192, s[60:63], s53 offen offset:0 lds
    v_mul_f32 v96, v96, v217
    v_mfma_f32_16x16x32_bf16 v[28:31], a[152:155], v[180:183], v[28:31]
    buffer_load_dwordx4 v193, s[60:63], s53 offen offset:1024 lds
    v_mul_f32 v97, v97, v217
    s_waitcnt lgkmcnt(8)
    s_cbranch_vccnz FB_concat_59
BK_concat_60:
    v_mfma_f32_16x16x32_bf16 v[92:95], a[172:175], v[44:47], v[92:95]
    buffer_load_dwordx4 v194, s[60:63], s53 offen offset:2048 lds
    v_mul_f32 v98, v98, v217
    v_mfma_f32_16x16x32_bf16 v[100:103], a[176:179], v[44:47], v[100:103]
    buffer_load_dwordx4 v195, s[60:63], s53 offen offset:3072 lds
    v_cndmask_b32 v28, v28, v5, s[16:17]
    v_mfma_f32_16x16x32_bf16 v[108:111], a[180:183], v[44:47], v[108:111]
    v_cndmask_b32 v29, v29, v5, s[18:19]
    v_cndmask_b32 v30, v30, v5, s[20:21]
    v_mfma_f32_16x16x32_bf16 v[116:119], a[184:187], v[44:47], v[116:119]
    v_cndmask_b32 v31, v31, v5, s[22:23]
    v_mul_f32 v99, v99, v217
    v_mfma_f32_16x16x32_bf16 v[124:127], a[188:191], v[44:47], v[124:127]
    v_exp_f32 v84, v28
    v_mfma_f32_16x16x32_bf16 v[132:135], a[192:195], v[44:47], v[132:135]
    v_exp_f32 v85, v29
    v_mfma_f32_16x16x32_bf16 v[140:143], a[196:199], v[44:47], v[140:143]
    v_exp_f32 v86, v30
    v_mfma_f32_16x16x32_bf16 v[148:151], a[200:203], v[44:47], v[148:151]
    v_cvt_pk_bf16_f32 v52, v84, v85
    v_cvt_pk_bf16_f32 v90, v96, v97
    v_exp_f32 v87, v31
    v_cvt_pk_bf16_f32 v91, v98, v99
    v_cvt_pk_bf16_f32 v53, v86, v87
    v_mov_b32 v36, v5
    v_mov_b32 v37, v5
    v_mov_b32 v38, v5
    v_mov_b32 v39, v5
    v_mov_b32 v54, 0
    v_mov_b32 v55, 0
    s_nop 1
    v_mfma_f32_16x16x32_bf16 v[68:71], a[128:131], v[52:55], v[76:79]
    buffer_store_dwordx4 v[88:91], v2, s[12:15], s36 offen offset:0 sc1
    v_mul_f32 v104, v104, v217
    v_mul_f32 v105, v105, v217
    v_mul_f32 v106, v106, v217
    v_mul_f32 v107, v107, v217
    v_cvt_pk_bf16_f32 v104, v104, v105
    v_cvt_pk_bf16_f32 v105, v106, v107
    v_mul_f32 v112, v112, v217
    v_cmp_lt_f32 vcc, s37, v68
    s_waitcnt lgkmcnt(0)
    s_cbranch_vccnz FB_concat_61
BK_concat_62:
    v_mfma_f32_16x16x32_bf16 v[92:95], a[204:207], v[52:55], v[92:95]
    v_mul_f32 v113, v113, v217
    v_mul_f32 v114, v114, v217
    v_mfma_f32_16x16x32_bf16 v[100:103], a[208:211], v[52:55], v[100:103]
    v_mul_f32 v115, v115, v217
    v_cvt_pk_bf16_f32 v106, v112, v113
    v_mfma_f32_16x16x32_bf16 v[108:111], a[212:215], v[52:55], v[108:111]
    v_cvt_pk_bf16_f32 v107, v114, v115
    v_add_f32 v227, v227, v243
    v_mfma_f32_16x16x32_bf16 v[116:119], a[216:219], v[52:55], v[116:119]
    buffer_store_dwordx4 v[104:107], v2, s[12:15], s36 offen offset:1024 sc1
    v_mul_f32 v120, v120, v217
    v_mfma_f32_16x16x32_bf16 v[124:127], a[220:223], v[52:55], v[124:127]
    v_mul_f32 v121, v121, v217
    v_mul_f32 v122, v122, v217
    v_mfma_f32_16x16x32_bf16 v[132:135], a[224:227], v[52:55], v[132:135]
    v_mul_f32 v123, v123, v217
    v_cvt_pk_bf16_f32 v120, v120, v121
    v_mfma_f32_16x16x32_bf16 v[140:143], a[228:231], v[52:55], v[140:143]
    v_cvt_pk_bf16_f32 v121, v122, v123
    v_mul_f32 v128, v128, v217
    v_mfma_f32_16x16x32_bf16 v[148:151], a[232:235], v[52:55], v[148:151]
    v_mul_f32 v129, v129, v217
    v_mul_f32 v130, v130, v217
    v_mul_f32 v131, v131, v217
    v_add_f32 v228, v228, v244
    v_cvt_pk_bf16_f32 v122, v128, v129
    v_add_f32 v229, v229, v245
    v_cvt_pk_bf16_f32 v123, v130, v131
    v_add_f32 v230, v230, v246
    buffer_store_dwordx4 v[120:123], v2, s[12:15], s36 offen offset:2048 sc1
    v_add_f32 v231, v231, v247
    v_mul_f32 v136, v136, v217
    v_add_f32 v232, v232, v248
    v_mul_f32 v137, v137, v217
    v_add_f32 v233, v233, v249
    v_mul_f32 v138, v138, v217
    v_add_f32 v234, v234, v250
    v_mul_f32 v139, v139, v217
    v_add_f32 v235, v235, v251
    v_cvt_pk_bf16_f32 v136, v136, v137
    v_add_f32 v220, v220, v228
    v_cvt_pk_bf16_f32 v137, v138, v139
    v_add_f32 v221, v221, v229
    v_mul_f32 v144, v144, v217
    v_add_f32 v222, v222, v230
    v_mul_f32 v145, v145, v217
    v_add_f32 v223, v223, v231
    v_mul_f32 v146, v146, v217
    v_add_f32 v224, v224, v232
    v_mul_f32 v147, v147, v217
    v_add_f32 v225, v225, v233
    v_cvt_pk_bf16_f32 v138, v144, v145
    v_add_f32 v226, v226, v234
    v_cvt_pk_bf16_f32 v139, v146, v147
    v_add_f32 v227, v227, v235
    buffer_store_dwordx4 v[136:139], v2, s[12:15], s36 offen offset:3072 sc1
    v_add_f32 v220, v220, v224
    v_add_f32 v221, v221, v225
    v_add_f32 v222, v222, v226
    v_add_f32 v223, v223, v227
    v_cvt_pk_bf16_f32 v220, v220, v221
    v_cvt_pk_bf16_f32 v221, v222, v223
    v_lshlrev_b32 v224, 3, v0
    s_lshl_b32 s28, s24, 9
    s_add_u32 s28, s28, 155648
    v_add_u32 v224, s28, v224
    ds_write_b64 v224, v[220:221]
    v_rcp_f32 v7, v68
    s_nop 0
    v_mul_f32 v7, s43, v7
    s_branch L2_fin
L2_ftail0:
    v_mfma_f32_16x16x32_bf16 v[28:31], a[32:35], v[168:171], v[60:63]
    s_barrier
    ds_read_b128 a[0:3], v1 offset:8192
    ds_read_b128 a[4:7], v1 offset:9216
    ds_read_b128 a[8:11], v1 offset:10240
    ds_read_b128 a[12:15], v1 offset:11264
    ds_read_b128 a[16:19], v1 offset:12288
    ds_read_b128 a[20:23], v1 offset:13312
    ds_read_b128 a[24:27], v1 offset:14336
    ds_read_b128 a[28:31], v1 offset:15360
    s_add_u32 m0, s48, 65536
    v_mfma_f32_16x16x32_bf16 v[28:31], a[36:39], v[172:175], v[28:31]
    s_add_u32 s53, s52, 0
    v_exp_f32 v84, v20
    v_mfma_f32_16x16x32_bf16 v[28:31], a[40:43], v[176:179], v[28:31]
    s_and_b32 s53, s53, 15
    ds_read_b128 a[96:99], v1 offset:0
    ds_read_b128 a[100:103], v1 offset:1024
    v_exp_f32 v85, v21
    v_exp_f32 v86, v22
    v_exp_f32 v87, v23
    v_cvt_pk_bf16_f32 v46, v84, v85
    v_cvt_pk_bf16_f32 v47, v86, v87
    v_cndmask_b32 v8, v8, v5, s[16:17]
    v_cndmask_b32 v9, v9, v5, s[18:19]
    v_cndmask_b32 v10, v10, v5, s[20:21]
    v_cndmask_b32 v11, v11, v5, s[22:23]
    v_exp_f32 v80, v8
    v_exp_f32 v81, v9
    v_exp_f32 v82, v10
    v_cvt_pk_bf16_f32 v40, v80, v81
    v_exp_f32 v83, v11
    v_add_f32 v220, v220, v236
    v_cvt_pk_bf16_f32 v41, v82, v83
    v_mov_b32 v16, v5
    v_mov_b32 v17, v5
    v_mov_b32 v18, v5
    v_mov_b32 v19, v5
    v_mov_b32 v42, 0
    v_mov_b32 v43, 0
    s_nop 1
    v_mfma_f32_16x16x32_bf16 v[72:75], a[128:131], v[40:43], v[64:67]
    s_lshl_b32 s53, s53, 16
    ds_read_b128 a[104:107], v1 offset:2048
    ds_read_b128 a[108:111], v1 offset:3072
    v_mfma_f32_16x16x32_bf16 v[76:79], a[128:131], v[44:47], v[68:71]
    s_add_u32 s53, s53, s47
    buffer_load_dwordx4 v192, s[60:63], s53 offen offset:0 lds
    v_add_f32 v221, v221, v237
    v_mfma_f32_16x16x32_bf16 v[28:31], a[44:47], v[180:183], v[28:31]
    ds_read_b128 a[112:115], v1 offset:4096
    v_add_f32 v222, v222, v238
    v_mfma_f32_16x16x32_bf16 v[36:39], a[48:51], v[168:171], v[60:63]
    ds_read_b128 a[116:119], v1 offset:5120
    v_max_f32 v6, v72, v76
    v_mfma_f32_16x16x32_bf16 v[36:39], a[52:55], v[172:175], v[36:39]
    ds_read_b128 a[120:123], v1 offset:6144
    v_cmp_lt_f32 vcc, s37, v6
    v_mfma_f32_16x16x32_bf16 v[36:39], a[56:59], v[176:179], v[36:39]
    buffer_load_dwordx4 v193, s[60:63], s53 offen offset:1024 lds
    v_add_f32 v223, v223, v239
    v_mfma_f32_16x16x32_bf16 v[36:39], a[60:63], v[180:183], v[36:39]
    ds_read_b128 a[124:127], v1 offset:7168
    ds_read_b128 a[140:143], v1 offset:16384
    s_cbranch_vccnz FB_concat_63
BK_concat_64:
    v_mfma_f32_16x16x32_bf16 v[88:91], a[64:67], v[40:43], v[88:91]
    ds_read_b128 a[144:147], v1 offset:17408
    ds_read_b128 a[148:151], v1 offset:18432
    v_mfma_f32_16x16x32_bf16 v[92:95], a[64:67], v[44:47], v[92:95]
    v_rcp_f32 v217, v72
    v_mfma_f32_16x16x32_bf16 v[96:99], a[68:71], v[40:43], v[96:99]
    buffer_load_dwordx4 v194, s[60:63], s53 offen offset:2048 lds
    v_add_f32 v224, v224, v240
    v_mfma_f32_16x16x32_bf16 v[100:103], a[68:71], v[44:47], v[100:103]
    v_exp_f32 v84, v28
    v_mfma_f32_16x16x32_bf16 v[104:107], a[72:75], v[40:43], v[104:107]
    ds_read_b128 a[152:155], v1 offset:19456
    ds_read_b128 a[156:159], v1 offset:20480
    v_mfma_f32_16x16x32_bf16 v[108:111], a[72:75], v[44:47], v[108:111]
    v_exp_f32 v85, v29
    v_mfma_f32_16x16x32_bf16 v[112:115], a[76:79], v[40:43], v[112:115]
    buffer_load_dwordx4 v195, s[60:63], s53 offen offset:3072 lds
    v_add_f32 v225, v225, v241
    v_mfma_f32_16x16x32_bf16 v[116:119], a[76:79], v[44:47], v[116:119]
    s_add_u32 m0, s48, 69632
    v_exp_f32 v86, v30
    v_mfma_f32_16x16x32_bf16 v[120:123], a[80:83], v[40:43], v[120:123]
    s_add_u32 s53, s52, 1
    ds_read_b128 a[160:163], v1 offset:21504
    s_and_b32 s53, s53, 15
    v_mfma_f32_16x16x32_bf16 v[124:127], a[80:83], v[44:47], v[124:127]
    s_lshl_b32 s53, s53, 16
    ds_read_b128 a[164:167], v1 offset:22528
    s_add_u32 s53, s53, s47
    v_mfma_f32_16x16x32_bf16 v[128:131], a[84:87], v[40:43], v[128:131]
    buffer_load_dwordx4 v192, s[60:63], s53 offen offset:0 lds
    v_cvt_pk_bf16_f32 v52, v84, v85
    v_mfma_f32_16x16x32_bf16 v[132:135], a[84:87], v[44:47], v[132:135]
    v_exp_f32 v87, v31
    v_mfma_f32_16x16x32_bf16 v[136:139], a[88:91], v[40:43], v[136:139]
    ds_read_b128 a[168:171], v1 offset:23552
    v_cvt_pk_bf16_f32 v53, v86, v87
    v_mfma_f32_16x16x32_bf16 v[140:143], a[88:91], v[44:47], v[140:143]
    v_exp_f32 v84, v36
    v_mfma_f32_16x16x32_bf16 v[144:147], a[92:95], v[40:43], v[144:147]
    buffer_load_dwordx4 v193, s[60:63], s53 offen offset:1024 lds
    v_add_f32 v226, v226, v242
    v_mfma_f32_16x16x32_bf16 v[148:151], a[92:95], v[44:47], v[148:151]
    v_exp_f32 v85, v37
    s_waitcnt lgkmcnt(15)
    v_mfma_f32_16x16x32_bf16 v[12:15], a[0:3], v[168:171], v[60:63]
    ds_read_b128 a[172:175], v1 offset:24576
    ds_read_b128 a[176:179], v1 offset:25600
    v_mfma_f32_16x16x32_bf16 v[12:15], a[4:7], v[172:175], v[12:15]
    v_exp_f32 v86, v38
    v_mfma_f32_16x16x32_bf16 v[12:15], a[8:11], v[176:179], v[12:15]
    buffer_load_dwordx4 v194, s[60:63], s53 offen offset:2048 lds
    v_cvt_pk_bf16_f32 v54, v84, v85
    v_exp_f32 v87, v39
    v_mul_f32 v217, s43, v217
    v_cvt_pk_bf16_f32 v55, v86, v87
    s_nop 1
    v_mfma_f32_16x16x32_bf16 v[68:71], a[128:131], v[52:55], v[76:79]
    ds_read_b128 a[180:183], v1 offset:26624
    ds_read_b128 a[184:187], v1 offset:27648
    v_mfma_f32_16x16x32_bf16 v[12:15], a[12:15], v[180:183], v[12:15]
    ds_read_b128 a[188:191], v1 offset:28672
    v_mul_f32 v88, v88, v217
    v_mfma_f32_16x16x32_bf16 v[20:23], a[16:19], v[168:171], v[60:63]
    ds_read_b128 a[192:195], v1 offset:29696
    v_mul_f32 v89, v89, v217
    v_mfma_f32_16x16x32_bf16 v[20:23], a[20:23], v[172:175], v[20:23]
    buffer_load_dwordx4 v195, s[60:63], s53 offen offset:3072 lds
    v_cmp_lt_f32 vcc, s37, v68
    v_mfma_f32_16x16x32_bf16 v[20:23], a[24:27], v[176:179], v[20:23]
    s_add_u32 m0, s48, 73728
    ds_read_b128 a[196:199], v1 offset:30720
    ds_read_b128 a[200:203], v1 offset:31744
    v_mfma_f32_16x16x32_bf16 v[20:23], a[28:31], v[180:183], v[20:23]
    s_add_u32 s53, s52, 2
    ds_read_b128 a[204:207], v1 offset:32768
    ds_read_b128 a[208:211], v1 offset:33792
    s_waitcnt lgkmcnt(15)
    s_cbranch_vccnz FB_concat_65
BK_concat_66:
    v_mfma_f32_16x16x32_bf16 v[92:95], a[96:99], v[52:55], v[92:95]
    s_and_b32 s53, s53, 15
    v_exp_f32 v84, v12
    v_mfma_f32_16x16x32_bf16 v[100:103], a[100:103], v[52:55], v[100:103]
    s_lshl_b32 s53, s53, 16
    ds_read_b128 a[212:215], v1 offset:34816
    ds_read_b128 a[216:219], v1 offset:35840
    v_mfma_f32_16x16x32_bf16 v[108:111], a[104:107], v[52:55], v[108:111]
    s_add_u32 s53, s53, s47
    v_exp_f32 v85, v13
    v_mfma_f32_16x16x32_bf16 v[116:119], a[108:111], v[52:55], v[116:119]
    ds_read_b128 a[220:223], v1 offset:36864
    ds_read_b128 a[224:227], v1 offset:37888
    v_mfma_f32_16x16x32_bf16 v[124:127], a[112:115], v[52:55], v[124:127]
    v_exp_f32 v86, v14
    v_mfma_f32_16x16x32_bf16 v[132:135], a[116:119], v[52:55], v[132:135]
    buffer_load_dwordx4 v192, s[60:63], s53 offen offset:0 lds
    v_cvt_pk_bf16_f32 v44, v84, v85
    v_mfma_f32_16x16x32_bf16 v[140:143], a[120:123], v[52:55], v[140:143]
    v_exp_f32 v87, v15
    v_mfma_f32_16x16x32_bf16 v[148:151], a[124:127], v[52:55], v[148:151]
    ds_read_b128 a[228:231], v1 offset:38912
    v_cvt_pk_bf16_f32 v45, v86, v87
    s_waitcnt lgkmcnt(15)
    v_mfma_f32_16x16x32_bf16 v[28:31], a[140:143], v[168:171], v[60:63]
    v_exp_f32 v84, v20
    v_mfma_f32_16x16x32_bf16 v[28:31], a[144:147], v[172:175], v[28:31]
    buffer_load_dwordx4 v193, s[60:63], s53 offen offset:1024 lds
    v_mul_f32 v90, v90, v217
    v_mfma_f32_16x16x32_bf16 v[28:31], a[148:151], v[176:179], v[28:31]
    v_exp_f32 v85, v21
    v_exp_f32 v86, v22
    v_cvt_pk_bf16_f32 v46, v84, v85
    v_exp_f32 v87, v23
    v_mul_f32 v91, v91, v217
    v_cvt_pk_bf16_f32 v47, v86, v87
    s_nop 1
    v_mfma_f32_16x16x32_bf16 v[76:79], a[128:131], v[44:47], v[68:71]
    ds_read_b128 a[232:235], v1 offset:39936
    v_cvt_pk_bf16_f32 v88, v88, v89
    v_mfma_f32_16x16x32_bf16 v[28:31], a[152:155], v[180:183], v[28:31]
    buffer_load_dwordx4 v194, s[60:63], s53 offen offset:2048 lds
    v_cvt_pk_bf16_f32 v89, v90, v91
    v_mfma_f32_16x16x32_bf16 v[36:39], a[156:159], v[168:171], v[60:63]
    buffer_load_dwordx4 v195, s[60:63], s53 offen offset:3072 lds
    v_mul_f32 v96, v96, v217
    v_mfma_f32_16x16x32_bf16 v[36:39], a[160:163], v[172:175], v[36:39]
    s_add_u32 m0, s48, 77824
    s_add_u32 s53, s52, 3
    v_cmp_lt_f32 vcc, s37, v76
    v_mfma_f32_16x16x32_bf16 v[36:39], a[164:167], v[176:179], v[36:39]
    s_and_b32 s53, s53, 15
    s_lshl_b32 s53, s53, 16
    v_mul_f32 v97, v97, v217
    v_mfma_f32_16x16x32_bf16 v[36:39], a[168:171], v[180:183], v[36:39]
    s_add_u32 s53, s53, s47
    buffer_load_dwordx4 v192, s[60:63], s53 offen offset:0 lds
    v_mul_f32 v98, v98, v217
    s_waitcnt lgkmcnt(8)
    s_cbranch_vccnz FB_concat_67
BK_concat_68:
    v_mfma_f32_16x16x32_bf16 v[92:95], a[172:175], v[44:47], v[92:95]
    buffer_load_dwordx4 v193, s[60:63], s53 offen offset:1024 lds
    v_mul_f32 v99, v99, v217
    v_mfma_f32_16x16x32_bf16 v[100:103], a[176:179], v[44:47], v[100:103]
    v_exp_f32 v84, v28
    v_mfma_f32_16x16x32_bf16 v[108:111], a[180:183], v[44:47], v[108:111]
    buffer_load_dwordx4 v194, s[60:63], s53 offen offset:2048 lds
    v_cvt_pk_bf16_f32 v90, v96, v97
    v_mfma_f32_16x16x32_bf16 v[116:119], a[184:187], v[44:47], v[116:119]
    v_exp_f32 v85, v29
    v_mfma_f32_16x16x32_bf16 v[124:127], a[188:191], v[44:47], v[124:127]
    buffer_load_dwordx4 v195, s[60:63], s53 offen offset:3072 lds
    v_cvt_pk_bf16_f32 v91, v98, v99
    v_mfma_f32_16x16x32_bf16 v[132:135], a[192:195], v[44:47], v[132:135]
    v_exp_f32 v86, v30
    v_mfma_f32_16x16x32_bf16 v[140:143], a[196:199], v[44:47], v[140:143]
    v_cvt_pk_bf16_f32 v52, v84, v85
    v_add_f32 v227, v227, v243
    v_mfma_f32_16x16x32_bf16 v[148:151], a[200:203], v[44:47], v[148:151]
    v_exp_f32 v87, v31
    buffer_store_dwordx4 v[88:91], v2, s[12:15], s36 offen offset:0 sc1
    v_cvt_pk_bf16_f32 v53, v86, v87
    v_cndmask_b32 v36, v36, v5, s[16:17]
    v_cndmask_b32 v37, v37, v5, s[18:19]
    v_cndmask_b32 v38, v38, v5, s[20:21]
    v_cndmask_b32 v39, v39, v5, s[22:23]
    v_exp_f32 v84, v36
    v_exp_f32 v85, v37
    v_exp_f32 v86, v38
    v_cvt_pk_bf16_f32 v54, v84, v85
    v_exp_f32 v87, v39
    v_mul_f32 v104, v104, v217
    v_cvt_pk_bf16_f32 v55, v86, v87
    s_nop 1
    v_mfma_f32_16x16x32_bf16 v[68:71], a[128:131], v[52:55], v[76:79]
    v_mul_f32 v105, v105, v217
    v_mul_f32 v106, v106, v217
    v_mul_f32 v107, v107, v217
    v_cvt_pk_bf16_f32 v104, v104, v105
    v_cvt_pk_bf16_f32 v105, v106, v107
    v_mul_f32 v112, v112, v217
    v_mul_f32 v113, v113, v217
    v_mul_f32 v114, v114, v217
    v_cmp_lt_f32 vcc, s37, v68
    s_waitcnt lgkmcnt(0)
    s_cbranch_vccnz FB_concat_69
BK_concat_70:
    v_mfma_f32_16x16x32_bf16 v[92:95], a[204:207], v[52:55], v[92:95]
    v_mul_f32 v115, v115, v217
    v_cvt_pk_bf16_f32 v106, v112, v113
    v_mfma_f32_16x16x32_bf16 v[100:103], a[208:211], v[52:55], v[100:103]
    v_cvt_pk_bf16_f32 v107, v114, v115
    v_add_f32 v228, v228, v244
    v_mfma_f32_16x16x32_bf16 v[108:111], a[212:215], v[52:55], v[108:111]
    buffer_store_dwordx4 v[104:107], v2, s[12:15], s36 offen offset:1024 sc1
    v_mul_f32 v120, v120, v217
    v_mfma_f32_16x16x32_bf16 v[116:119], a[216:219], v[52:55], v[116:119]
    v_mul_f32 v121, v121, v217
    v_mul_f32 v122, v122, v217
    v_mfma_f32_16x16x32_bf16 v[124:127], a[220:223], v[52:55], v[124:127]
    v_mul_f32 v123, v123, v217
    v_cvt_pk_bf16_f32 v120, v120, v121
    v_mfma_f32_16x16x32_bf16 v[132:135], a[224:227], v[52:55], v[132:135]
    v_cvt_pk_bf16_f32 v121, v122, v123
    v_mul_f32 v128, v128, v217
    v_mfma_f32_16x16x32_bf16 v[140:143], a[228:231], v[52:55], v[140:143]
    v_mul_f32 v129, v129, v217
    v_mul_f32 v130, v130, v217
    v_mfma_f32_16x16x32_bf16 v[148:151], a[232:235], v[52:55], v[148:151]
    v_mul_f32 v131, v131, v217
    v_cvt_pk_bf16_f32 v122, v128, v129
    v_cvt_pk_bf16_f32 v123, v130, v131
    v_add_f32 v229, v229, v245
    buffer_store_dwordx4 v[120:123], v2, s[12:15], s36 offen offset:2048 sc1
    v_add_f32 v230, v230, v246
    v_mul_f32 v136, v136, v217
    v_add_f32 v231, v231, v247
    v_mul_f32 v137, v137, v217
    v_add_f32 v232, v232, v248
    v_mul_f32 v138, v138, v217
    v_add_f32 v233, v233, v249
    v_mul_f32 v139, v139, v217
    v_add_f32 v234, v234, v250
    v_cvt_pk_bf16_f32 v136, v136, v137
    v_add_f32 v235, v235, v251
    v_cvt_pk_bf16_f32 v137, v138, v139
    v_add_f32 v220, v220, v228
    v_mul_f32 v144, v144, v217
    v_add_f32 v221, v221, v229
    v_mul_f32 v145, v145, v217
    v_add_f32 v222, v222, v230
    v_mul_f32 v146, v146, v217
    v_add_f32 v223, v223, v231
    v_mul_f32 v147, v147, v217
    v_add_f32 v224, v224, v232
    v_cvt_pk_bf16_f32 v138, v144, v145
    v_add_f32 v225, v225, v233
    v_cvt_pk_bf16_f32 v139, v146, v147
    v_add_f32 v226, v226, v234
    buffer_store_dwordx4 v[136:139], v2, s[12:15], s36 offen offset:3072 sc1
    v_add_f32 v227, v227, v235
    v_add_f32 v220, v220, v224
    v_add_f32 v221, v221, v225
    v_add_f32 v222, v222, v226
    v_add_f32 v223, v223, v227
    v_cvt_pk_bf16_f32 v220, v220, v221
    v_cvt_pk_bf16_f32 v221, v222, v223
    v_lshlrev_b32 v224, 3, v0
    s_lshl_b32 s28, s24, 9
    s_add_u32 s28, s28, 155648
    v_add_u32 v224, s28, v224
    ds_write_b64 v224, v[220:221]
    v_rcp_f32 v7, v68
    s_nop 0
    v_mul_f32 v7, s43, v7
L2_fin:
    v_mov_b32 v80, v7
    v_mov_b32 v81, v7
    v_pk_mul_f32 v[92:93], v[92:93], v[80:81]
    v_pk_mul_f32 v[94:95], v[94:95], v[80:81]
    v_cvt_pk_bf16_f32 v92, v92, v93
    v_cvt_pk_bf16_f32 v93, v94, v95
    v_pk_mul_f32 v[100:101], v[100:101], v[80:81]
    v_pk_mul_f32 v[102:103], v[102:103], v[80:81]
    v_cvt_pk_bf16_f32 v94, v100, v101
    v_cvt_pk_bf16_f32 v95, v102, v103
    buffer_store_dwordx4 v[92:95], v4, s[12:15], s36 offen offset:0 sc1
    v_pk_mul_f32 v[108:109], v[108:109], v[80:81]
    v_pk_mul_f32 v[110:111], v[110:111], v[80:81]
    v_cvt_pk_bf16_f32 v108, v108, v109
    v_cvt_pk_bf16_f32 v109, v110, v111
    v_pk_mul_f32 v[116:117], v[116:117], v[80:81]
    v_pk_mul_f32 v[118:119], v[118:119], v[80:81]
    v_cvt_pk_bf16_f32 v110, v116, v117
    v_cvt_pk_bf16_f32 v111, v118, v119
    buffer_store_dwordx4 v[108:111], v4, s[12:15], s36 offen offset:1024 sc1
    v_pk_mul_f32 v[124:125], v[124:125], v[80:81]
    v_pk_mul_f32 v[126:127], v[126:127], v[80:81]
    v_cvt_pk_bf16_f32 v124, v124, v125
    v_cvt_pk_bf16_f32 v125, v126, v127
    v_pk_mul_f32 v[132:133], v[132:133], v[80:81]
    v_pk_mul_f32 v[134:135], v[134:135], v[80:81]
    v_cvt_pk_bf16_f32 v126, v132, v133
    v_cvt_pk_bf16_f32 v127, v134, v135
    buffer_store_dwordx4 v[124:127], v4, s[12:15], s36 offen offset:2048 sc1
    v_pk_mul_f32 v[140:141], v[140:141], v[80:81]
    v_pk_mul_f32 v[142:143], v[142:143], v[80:81]
    v_cvt_pk_bf16_f32 v140, v140, v141
    v_cvt_pk_bf16_f32 v141, v142, v143
    v_pk_mul_f32 v[148:149], v[148:149], v[80:81]
    v_pk_mul_f32 v[150:151], v[150:151], v[80:81]
    v_cvt_pk_bf16_f32 v142, v148, v149
    v_cvt_pk_bf16_f32 v143, v150, v151
    buffer_store_dwordx4 v[140:143], v4, s[12:15], s36 offen offset:3072 sc1
    s_sub_u32 s54, 15, s26
    s_bitcmp1_b32 s2, 5
    s_cselect_b32 s54, s54, s26
    s_and_b32 s34, s2, 1
    s_lshl_b32 s34, s34, 5
    s_lshr_b32 s55, s2, 3
    s_add_u32 s34, s34, s55
    s_mul_i32 s29, s34, 196608
    s_lshl_b32 s55, s24, 12
    s_add_u32 s29, s29, s55
    s_add_u32 s29, s29, 0x3800000
    s_mul_i32 s55, s41, 49152
    s_add_u32 s32, s29, s55
    s_lshl_b32 s34, s34, 8
    s_add_u32 s34, s34, 0x3708000
    s_lshl_b32 s55, s54, 2
    s_add_u32 s55, s55, s24
    s_lshl_b32 s46, s55, 18
    s_lshl_b32 s55, s55, 16
    s_add_u32 s35, s35, s55
    s_lshl_b32 s55, s41, 15
    s_add_u32 s46, s46, s55
    s_add_u32 s46, s46, 0x2000000
    s_lshl_b32 s55, s41, 6
    s_add_u32 s35, s35, s55
    s_sub_u32 s55, 15, s54
    s_min_u32 s54, s54, s55
    s_lshl_b32 s54, s54, 2
    s_add_u32 s54, s54, s41
    s_lshl_b32 s54, s54, 8
    s_add_u32 s54, s54, 0x3704000
    v_add_u32 v201, 0x20000, v200
    v_lshrrev_b32 v217, 2, v0
    v_lshlrev_b32 v218, 8, v217
    v_and_b32 v217, 7, v217
    s_lshl_b32 s55, s41, 1
    v_xor_b32 v217, s55, v217
    v_lshl_add_u32 v218, v217, 5, v218
    v_and_b32 v217, 3, v0
    v_lshl_add_u32 v218, v217, 3, v218
    v_add_u32 v244, 0x10000, v218
    v_xor_b32 v245, 32, v244
    v_xor_b32 v246, 64, v244
    v_xor_b32 v247, 96, v244
    v_xor_b32 v248, 128, v244
    v_xor_b32 v249, 160, v244
    v_xor_b32 v250, 192, v244
    v_xor_b32 v251, 224, v244
    v_mov_b32 v6, 1
    v_min_u32 v7, 1, v0
    v_lshlrev_b32 v7, 29, v7
    v_lshrrev_b32 v234, 5, v0
    v_lshlrev_b32 v234, 7, v234
    v_bfe_u32 v235, v0, 2, 2
    v_lshl_add_u32 v234, v235, 5, v234
    v_and_b32 v235, 3, v0
    v_lshl_add_u32 v234, v235, 3, v234
    s_lshl_b32 s28, s24, 10
    s_add_u32 s28, s28, 159744
    v_add_u32 v234, s28, v234
    ds_read_b64_tr_b16 v[228:229], v234 offset:0
    ds_read_b64_tr_b16 v[230:231], v234 offset:256
    v_bfe_u32 v235, v0, 4, 1
    s_mov_b32 s28, 0x80008000
    v_mul_lo_u32 v234, v235, s28
    v_lshlrev_b32 v235, 14, v235
    v_lshrrev_b32 v233, 5, v0
    v_lshl_add_u32 v235, v233, 8, v235
    v_and_b32 v233, 15, v0
    v_lshl_add_u32 v235, v233, 4, v235
    v_add_u32 v236, 0x8000, v235
    s_and_b32 s28, s25, 1
    s_sub_u32 s44, 0, s28
    s_mov_b32 s45, s44
    s_lshl_b32 s36, s26, 2
    s_add_u32 s36, s36, s24
    s_lshl_b32 s36, s36, 16
    s_lshl_b32 s28, s25, 9
    s_add_u32 s36, s36, s28
    s_add_u32 s36, s36, 0x3000000
    s_waitcnt lgkmcnt(0)
    v_xor_b32 v228, v234, v228
    v_xor_b32 v229, v234, v229
    v_xor_b32 v230, v234, v230
    v_xor_b32 v231, v234, v231
    s_waitcnt vmcnt(0)
    s_barrier
    s_lshl_b32 s27, s26, 2
    s_lshr_b32 s28, s25, 3
    s_add_u32 s27, s27, s28
    s_lshl_b32 s27, s27, 8
    s_add_u32 s27, s27, 0x3704000
    s_cmp_eq_u32 s24, 0
    s_cselect_b32 s27, s27, 0x40000000
    buffer_atomic_add v6, v7, s[12:15], s27 offen
    v_lshlrev_b32 v232, 3, v0
    v_add_u32 v232, 155648, v232
    ds_read_b64 v[220:221], v232 offset:0
    ds_read_b64 v[222:223], v232 offset:512
    ds_read_b64 v[224:225], v232 offset:1024
    ds_read_b64 v[226:227], v232 offset:1536
    s_cmp_eq_u32 s24, 0
    s_cselect_b32 s55, s34, 0x40000000
    buffer_atomic_add v6, v7, s[12:15], s55 offen
    v_mfma_f32_32x32x16_bf16 v[88:103], v[228:231], a[132:135], 0
    v_mfma_f32_32x32x16_bf16 v[120:135], v[228:231], a[136:139], 0
    s_add_u32 m0, s48, 0
    s_add_u32 s53, s52, 4
    s_and_b32 s53, s53, 15
    s_lshl_b32 s53, s53, 16
    s_add_u32 s53, s53, s47
    buffer_load_dwordx4 v192, s[60:63], s53 offen offset:0 lds
    buffer_load_dwordx4 v193, s[60:63], s53 offen offset:1024 lds
    buffer_load_dwordx4 v194, s[60:63], s53 offen offset:2048 lds
    buffer_load_dwordx4 v195, s[60:63], s53 offen offset:3072 lds
    s_nop 1
    v_max3_f32 v112, v88, v89, v90
    v_max3_f32 v144, v120, v121, v122
    v_max3_f32 v112, v112, v91, v92
    v_max3_f32 v144, v144, v123, v124
    v_max3_f32 v112, v112, v93, v94
    v_max3_f32 v144, v144, v125, v126
    v_max_f32 v112, v112, v95
    v_max_f32 v144, v144, v127
    v_max3_f32 v113, v96, v97, v98
    v_max3_f32 v145, v128, v129, v130
    v_max3_f32 v113, v113, v99, v100
    v_max3_f32 v145, v145, v131, v132
    v_max3_f32 v113, v113, v101, v102
    v_max3_f32 v145, v145, v133, v134
    v_max_f32 v113, v113, v103
    v_max_f32 v145, v145, v135
    s_nop 0
    v_permlane32_swap_b32 v112, v113
    v_permlane32_swap_b32 v144, v145
    v_max_f32 v112, v112, v113
    v_max_f32 v144, v144, v145
    v_mul_f32 v112, s58, v112
    v_mul_f32 v144, s58, v144
    v_mov_b32 v113, v112
    v_mov_b32 v145, v144
    s_nop 0
    v_permlane32_swap_b32 v112, v113
    v_permlane32_swap_b32 v144, v145
    v_fma_f32 v88, v88, s58, -v112
    v_fma_f32 v120, v120, s58, -v144
    v_fma_f32 v89, v89, s58, -v112
    v_fma_f32 v121, v121, s58, -v144
    v_fma_f32 v90, v90, s58, -v112
    v_fma_f32 v122, v122, s58, -v144
    v_fma_f32 v91, v91, s58, -v112
    v_fma_f32 v123, v123, s58, -v144
    v_fma_f32 v92, v92, s58, -v112
    v_fma_f32 v124, v124, s58, -v144
    v_fma_f32 v93, v93, s58, -v112
    v_fma_f32 v125, v125, s58, -v144
    v_fma_f32 v94, v94, s58, -v112
    v_fma_f32 v126, v126, s58, -v144
    v_fma_f32 v95, v95, s58, -v112
    v_fma_f32 v127, v127, s58, -v144
    v_fma_f32 v96, v96, s58, -v113
    v_fma_f32 v128, v128, s58, -v145
    v_fma_f32 v97, v97, s58, -v113
    v_fma_f32 v129, v129, s58, -v145
    v_fma_f32 v98, v98, s58, -v113
    v_fma_f32 v130, v130, s58, -v145
    v_fma_f32 v99, v99, s58, -v113
    v_fma_f32 v131, v131, s58, -v145
    v_fma_f32 v100, v100, s58, -v113
    v_fma_f32 v132, v132, s58, -v145
    v_fma_f32 v101, v101, s58, -v113
    v_fma_f32 v133, v133, s58, -v145
    v_fma_f32 v102, v102, s58, -v113
    v_fma_f32 v134, v134, s58, -v145
    v_fma_f32 v103, v103, s58, -v113
    v_fma_f32 v135, v135, s58, -v145
    v_exp_f32 v88, v88
    v_exp_f32 v120, v120
    v_exp_f32 v89, v89
    v_exp_f32 v121, v121
    v_exp_f32 v90, v90
    v_exp_f32 v122, v122
    v_exp_f32 v91, v91
    v_exp_f32 v123, v123
    v_exp_f32 v92, v92
    v_exp_f32 v124, v124
    v_exp_f32 v93, v93
    v_exp_f32 v125, v125
    v_exp_f32 v94, v94
    v_exp_f32 v126, v126
    v_exp_f32 v95, v95
    v_exp_f32 v127, v127
    v_exp_f32 v96, v96
    v_exp_f32 v128, v128
    v_exp_f32 v97, v97
    v_exp_f32 v129, v129
    v_exp_f32 v98, v98
    v_exp_f32 v130, v130
    v_exp_f32 v99, v99
    v_exp_f32 v131, v131
    v_exp_f32 v100, v100
    v_exp_f32 v132, v132
    v_exp_f32 v101, v101
    v_exp_f32 v133, v133
    v_exp_f32 v102, v102
    v_exp_f32 v134, v134
    v_exp_f32 v103, v103
    v_exp_f32 v135, v135
    v_add_f32 v112, v88, v89
    v_add_f32 v144, v120, v121
    v_add_f32 v112, v112, v90
    v_add_f32 v144, v144, v122
    v_add_f32 v112, v112, v91
    v_add_f32 v144, v144, v123
    v_add_f32 v112, v112, v92
    v_add_f32 v144, v144, v124
    buffer_load_dword v216, v7, s[12:15], s54 offen sc1
    v_add_f32 v112, v112, v93
    v_add_f32 v144, v144, v125
    s_add_u32 m0, s48, 4096
    v_add_f32 v112, v112, v94
    v_add_f32 v144, v144, v126
    s_add_u32 s53, s52, 5
    v_add_f32 v112, v112, v95
    v_add_f32 v144, v144, v127
    s_and_b32 s53, s53, 15
    v_add_f32 v113, v96, v97
    v_add_f32 v145, v128, v129
    s_lshl_b32 s53, s53, 16
    v_add_f32 v113, v113, v98
    v_add_f32 v145, v145, v130
    s_add_u32 s53, s53, s47
    v_add_f32 v113, v113, v99
    v_add_f32 v145, v145, v131
    buffer_load_dwordx4 v192, s[60:63], s53 offen offset:0 lds
    v_add_f32 v113, v113, v100
    v_add_f32 v145, v145, v132
    buffer_load_dwordx4 v193, s[60:63], s53 offen offset:1024 lds
    v_add_f32 v113, v113, v101
    v_add_f32 v145, v145, v133
    buffer_load_dwordx4 v194, s[60:63], s53 offen offset:2048 lds
    v_add_f32 v113, v113, v102
    v_add_f32 v145, v145, v134
    buffer_load_dwordx4 v195, s[60:63], s53 offen offset:3072 lds
    v_add_f32 v113, v113, v103
    v_add_f32 v145, v145, v135
    s_add_u32 m0, s48, 8192
    v_permlane32_swap_b32 v112, v113
    v_permlane32_swap_b32 v144, v145
    s_add_u32 s53, s52, 6
    v_add_f32 v112, v112, v113
    v_add_f32 v144, v144, v145
    s_and_b32 s53, s53, 15
    v_rcp_f32 v112, v112
    v_rcp_f32 v144, v144
    s_lshl_b32 s53, s53, 16
    v_mov_b32 v113, v112
    v_mov_b32 v145, v144
    s_add_u32 s53, s53, s47
    v_permlane32_swap_b32 v112, v113
    v_permlane32_swap_b32 v144, v145
    buffer_load_dwordx4 v192, s[60:63], s53 offen offset:0 lds
    v_mul_f32 v88, v88, v112
    v_mul_f32 v120, v120, v144
    buffer_load_dwordx4 v193, s[60:63], s53 offen offset:1024 lds
    v_mul_f32 v89, v89, v112
    v_mul_f32 v121, v121, v144
    buffer_load_dwordx4 v194, s[60:63], s53 offen offset:2048 lds
    v_mul_f32 v90, v90, v112
    v_mul_f32 v122, v122, v144
    buffer_load_dwordx4 v195, s[60:63], s53 offen offset:3072 lds
    v_mul_f32 v91, v91, v112
    v_mul_f32 v123, v123, v144
    v_mul_f32 v92, v92, v112
    v_mul_f32 v124, v124, v144
    v_mul_f32 v93, v93, v112
    v_mul_f32 v125, v125, v144
    v_mul_f32 v94, v94, v112
    v_mul_f32 v126, v126, v144
    v_mul_f32 v95, v95, v112
    v_mul_f32 v127, v127, v144
    v_mul_f32 v96, v96, v113
    v_mul_f32 v128, v128, v145
    v_mul_f32 v97, v97, v113
    v_mul_f32 v129, v129, v145
    v_mul_f32 v98, v98, v113
    v_mul_f32 v130, v130, v145
    v_mul_f32 v99, v99, v113
    v_mul_f32 v131, v131, v145
    v_mul_f32 v100, v100, v113
    v_mul_f32 v132, v132, v145
    v_mul_f32 v101, v101, v113
    v_mul_f32 v133, v133, v145
    v_mul_f32 v102, v102, v113
    v_mul_f32 v134, v134, v145
    v_mul_f32 v103, v103, v113
    v_mul_f32 v135, v135, v145
    v_cvt_pk_bf16_f32 v104, v88, v89
    v_cvt_pk_bf16_f32 v136, v120, v121
    v_cvt_pk_bf16_f32 v105, v90, v91
    v_cvt_pk_bf16_f32 v137, v122, v123
    v_cvt_pk_bf16_f32 v106, v92, v93
    v_cvt_pk_bf16_f32 v138, v124, v125
    v_cvt_pk_bf16_f32 v107, v94, v95
    v_cvt_pk_bf16_f32 v139, v126, v127
    v_cvt_pk_bf16_f32 v108, v96, v97
    v_cvt_pk_bf16_f32 v140, v128, v129
    v_cvt_pk_bf16_f32 v109, v98, v99
    v_cvt_pk_bf16_f32 v141, v130, v131
    v_cvt_pk_bf16_f32 v110, v100, v101
    v_cvt_pk_bf16_f32 v142, v132, v133
    v_cvt_pk_bf16_f32 v111, v102, v103
    v_cvt_pk_bf16_f32 v143, v134, v135
    s_waitcnt lgkmcnt(0)
    s_waitcnt vmcnt(8)
    s_mov_b32 s55, 0
SP_concat_71:
    v_readlane_b32 s27, v216, 0
    s_nop 0
    s_cmp_ge_u32 s27, 8
    s_cbranch_scc1 SD_concat_72
    s_add_u32 s55, s55, 1
    s_cmp_ge_u32 s55, 200000
    s_cbranch_scc1 SD_concat_72
    s_sleep 1
    buffer_load_dword v216, v7, s[12:15], s54 offen sc1
    s_waitcnt vmcnt(0)
    s_branch SP_concat_71
SD_concat_72:
    v_mfma_f32_32x32x16_bf16 v[8:23], v[220:223], v[104:107], 0
    v_mfma_f32_32x32x16_bf16 v[24:39], v[220:223], v[136:139], 0
    s_add_u32 s28, s52, 0
    v_mfma_f32_32x32x16_bf16 v[8:23], v[224:227], v[108:111], v[8:23]
    v_mfma_f32_32x32x16_bf16 v[24:39], v[224:227], v[140:143], v[24:39]
    s_and_b32 s28, s28, 15
    s_lshl_b32 s28, s28, 11
    s_add_u32 s28, s28, s46
    buffer_load_dwordx4 a[0:3], v200, s[12:15], s28 offen offset:0 sc1
    buffer_load_dwordx4 a[4:7], v201, s[12:15], s28 offen offset:0 sc1
    buffer_load_dwordx4 a[8:11], v200, s[12:15], s28 offen offset:1024 sc1
    buffer_load_dwordx4 a[12:15], v201, s[12:15], s28 offen offset:1024 sc1
    s_add_u32 s28, s52, 1
    s_and_b32 s28, s28, 15
    s_lshl_b32 s28, s28, 11
    s_add_u32 s28, s28, s46
    v_cndmask_b32 v238, v16, v8, s[44:45]
    v_cndmask_b32 v239, v32, v24, s[44:45]
    buffer_load_dwordx4 a[16:19], v200, s[12:15], s28 offen offset:0 sc1
    v_add_f32 v238, 0x358637bd, v238
    v_add_f32 v239, 0x358637bd, v239
    buffer_load_dwordx4 a[20:23], v201, s[12:15], s28 offen offset:0 sc1
    v_rcp_f32 v238, v238
    v_rcp_f32 v239, v239
    buffer_load_dwordx4 a[24:27], v200, s[12:15], s28 offen offset:1024 sc1
    v_cndmask_b32 v8, v8, v16, s[44:45]
    v_cndmask_b32 v24, v24, v32, s[44:45]
    buffer_load_dwordx4 a[28:31], v201, s[12:15], s28 offen offset:1024 sc1
    v_cndmask_b32 v9, v9, v17, s[44:45]
    v_cndmask_b32 v25, v25, v33, s[44:45]
    s_add_u32 s28, s52, 2
    v_cndmask_b32 v10, v10, v18, s[44:45]
    v_cndmask_b32 v26, v26, v34, s[44:45]
    s_and_b32 s28, s28, 15
    v_cndmask_b32 v11, v11, v19, s[44:45]
    v_cndmask_b32 v27, v27, v35, s[44:45]
    s_lshl_b32 s28, s28, 11
    v_cndmask_b32 v12, v12, v20, s[44:45]
    v_cndmask_b32 v28, v28, v36, s[44:45]
    s_add_u32 s28, s28, s46
    v_cndmask_b32 v13, v13, v21, s[44:45]
    v_cndmask_b32 v29, v29, v37, s[44:45]
    buffer_load_dwordx4 a[32:35], v200, s[12:15], s28 offen offset:0 sc1
    v_cndmask_b32 v14, v14, v22, s[44:45]
    v_cndmask_b32 v30, v30, v38, s[44:45]
    buffer_load_dwordx4 a[36:39], v201, s[12:15], s28 offen offset:0 sc1
    v_cndmask_b32 v15, v15, v23, s[44:45]
    v_cndmask_b32 v31, v31, v39, s[44:45]
    buffer_load_dwordx4 a[40:43], v200, s[12:15], s28 offen offset:1024 sc1
    v_mul_f32 v8, v8, v238
    v_mul_f32 v24, v24, v239
    buffer_load_dwordx4 a[44:47], v201, s[12:15], s28 offen offset:1024 sc1
    v_mul_f32 v9, v9, v238
    v_mul_f32 v25, v25, v239
    s_add_u32 s28, s52, 3
    v_mul_f32 v10, v10, v238
    v_mul_f32 v26, v26, v239
    s_and_b32 s28, s28, 15
    v_mul_f32 v11, v11, v238
    v_mul_f32 v27, v27, v239
    s_lshl_b32 s28, s28, 11
    v_mul_f32 v12, v12, v238
    v_mul_f32 v28, v28, v239
    s_add_u32 s28, s28, s46
    v_mul_f32 v13, v13, v238
    v_mul_f32 v29, v29, v239
    buffer_load_dwordx4 a[48:51], v200, s[12:15], s28 offen offset:0 sc1
    v_mul_f32 v14, v14, v238
    v_mul_f32 v30, v30, v239
    buffer_load_dwordx4 a[52:55], v201, s[12:15], s28 offen offset:0 sc1
    v_mul_f32 v15, v15, v238
    v_mul_f32 v31, v31, v239
    buffer_load_dwordx4 a[56:59], v200, s[12:15], s28 offen offset:1024 sc1
    v_cvt_pk_bf16_f32 v16, v8, v9
    v_cvt_pk_bf16_f32 v32, v24, v25
    buffer_load_dwordx4 a[60:63], v201, s[12:15], s28 offen offset:1024 sc1
    v_cvt_pk_bf16_f32 v17, v10, v11
    v_cvt_pk_bf16_f32 v33, v26, v27
    s_add_u32 m0, s48, 12288
    v_cvt_pk_bf16_f32 v18, v12, v13
    v_cvt_pk_bf16_f32 v34, v28, v29
    s_add_u32 s53, s52, 7
    v_cvt_pk_bf16_f32 v19, v14, v15
    v_cvt_pk_bf16_f32 v35, v30, v31
    s_and_b32 s53, s53, 15
    buffer_store_dwordx4 v[16:19], v235, s[12:15], s36 offen sc1
    buffer_store_dwordx4 v[32:35], v236, s[12:15], s36 offen sc1
    s_lshl_b32 s53, s53, 16
    s_add_u32 s53, s53, s47
    buffer_load_dwordx4 v192, s[60:63], s53 offen offset:0 lds
    buffer_load_dwordx4 v193, s[60:63], s53 offen offset:1024 lds
    buffer_load_dwordx4 v194, s[60:63], s53 offen offset:2048 lds
    buffer_load_dwordx4 v195, s[60:63], s53 offen offset:3072 lds
    s_barrier
    ds_read_b64_tr_b16 v[72:73], v244 offset:0
    ds_read_b64_tr_b16 v[74:75], v244 offset:16384
    ds_read_b64_tr_b16 v[76:77], v245 offset:0
    ds_read_b64_tr_b16 v[78:79], v245 offset:16384
    ds_read_b64_tr_b16 v[80:81], v246 offset:0
    ds_read_b64_tr_b16 v[82:83], v246 offset:16384
    ds_read_b64_tr_b16 v[84:85], v247 offset:0
    ds_read_b64_tr_b16 v[86:87], v247 offset:16384
    ds_read_b64_tr_b16 v[88:89], v248 offset:0
    ds_read_b64_tr_b16 v[90:91], v248 offset:16384
    ds_read_b64_tr_b16 v[92:93], v249 offset:0
    ds_read_b64_tr_b16 v[94:95], v249 offset:16384
    s_waitcnt vmcnt(18)
    s_waitcnt lgkmcnt(8)
    v_mfma_f32_16x16x32_bf16 v[8:11], v[72:75], a[0:3], 0
    s_add_u32 s28, s52, 4
    ds_read_b64_tr_b16 v[96:97], v250 offset:0
    ds_read_b64_tr_b16 v[98:99], v250 offset:16384
    v_mfma_f32_16x16x32_bf16 v[12:15], v[72:75], a[4:7], 0
    s_and_b32 s28, s28, 15
    s_lshl_b32 s28, s28, 11
    s_add_u32 s28, s28, s46
    buffer_load_dwordx4 a[64:67], v200, s[12:15], s28 offen offset:0 sc1
    v_mfma_f32_16x16x32_bf16 v[16:19], v[76:79], a[0:3], 0
    ds_read_b64_tr_b16 v[100:101], v251 offset:0
    ds_read_b64_tr_b16 v[102:103], v251 offset:16384
    v_mfma_f32_16x16x32_bf16 v[20:23], v[76:79], a[4:7], 0
    s_waitcnt lgkmcnt(8)
    s_and_b32 s40, s2, 7
    s_lshl_b32 s40, s40, 2
    v_mfma_f32_16x16x32_bf16 v[24:27], v[80:83], a[0:3], 0
    ds_read_b64_tr_b16 v[104:105], v244 offset:32768
    ds_read_b64_tr_b16 v[106:107], v244 offset:49152
    v_mfma_f32_16x16x32_bf16 v[28:31], v[80:83], a[4:7], 0
    buffer_load_dwordx4 a[68:71], v201, s[12:15], s28 offen offset:0 sc1
    s_bfe_u32 s3, s2, 0x20003
    v_mfma_f32_16x16x32_bf16 v[32:35], v[84:87], a[0:3], 0
    ds_read_b64_tr_b16 v[108:109], v245 offset:32768
    ds_read_b64_tr_b16 v[110:111], v245 offset:49152
    v_mfma_f32_16x16x32_bf16 v[36:39], v[84:87], a[4:7], 0
    s_waitcnt lgkmcnt(8)
    s_add_u32 s40, s40, s3
    s_lshr_b32 s51, s2, 5
    v_mfma_f32_16x16x32_bf16 v[40:43], v[88:91], a[0:3], 0
    ds_read_b64_tr_b16 v[112:113], v246 offset:32768
    ds_read_b64_tr_b16 v[114:115], v246 offset:49152
    v_mfma_f32_16x16x32_bf16 v[44:47], v[88:91], a[4:7], 0
    buffer_load_dwordx4 a[72:75], v200, s[12:15], s28 offen offset:1024 sc1
    s_lshl_b32 s51, s51, 7
    v_mfma_f32_16x16x32_bf16 v[48:51], v[92:95], a[0:3], 0
    ds_read_b64_tr_b16 v[116:117], v247 offset:32768
    ds_read_b64_tr_b16 v[118:119], v247 offset:49152
    v_mfma_f32_16x16x32_bf16 v[52:55], v[92:95], a[4:7], 0
    s_waitcnt lgkmcnt(8)
    s_lshl_b32 s50, s24, 17
    s_add_u32 s50, s50, s51
    v_mfma_f32_16x16x32_bf16 v[56:59], v[96:99], a[0:3], 0
    ds_read_b64_tr_b16 v[120:121], v248 offset:32768
    ds_read_b64_tr_b16 v[122:123], v248 offset:49152
    v_mfma_f32_16x16x32_bf16 v[60:63], v[96:99], a[4:7], 0
    buffer_load_dwordx4 a[76:79], v201, s[12:15], s28 offen offset:1024 sc1
    s_mov_b32 s16, s38
    v_mfma_f32_16x16x32_bf16 v[64:67], v[100:103], a[0:3], 0
    s_add_u32 s28, s52, 5
    ds_read_b64_tr_b16 v[124:125], v249 offset:32768
    ds_read_b64_tr_b16 v[126:127], v249 offset:49152
    v_mfma_f32_16x16x32_bf16 v[68:71], v[100:103], a[4:7], 0
    s_waitcnt lgkmcnt(8)
    s_and_b32 s28, s28, 15
    s_lshl_b32 s28, s28, 11
    v_mfma_f32_16x16x32_bf16 v[8:11], v[104:107], a[8:11], v[8:11]
    s_add_u32 s28, s28, s46
    ds_read_b64_tr_b16 v[128:129], v250 offset:32768
    ds_read_b64_tr_b16 v[130:131], v250 offset:49152
    v_mfma_f32_16x16x32_bf16 v[12:15], v[104:107], a[12:15], v[12:15]
    buffer_load_dwordx4 a[80:83], v200, s[12:15], s28 offen offset:0 sc1
    s_and_b32 s17, s39, 0xffff
    v_mfma_f32_16x16x32_bf16 v[16:19], v[108:111], a[8:11], v[16:19]
    ds_read_b64_tr_b16 v[132:133], v251 offset:32768
    ds_read_b64_tr_b16 v[134:135], v251 offset:49152
    v_mfma_f32_16x16x32_bf16 v[20:23], v[108:111], a[12:15], v[20:23]
    s_waitcnt lgkmcnt(8)
    s_mov_b32 s18, 0x80000
    s_mov_b32 s19, 0x20000
    v_mfma_f32_16x16x32_bf16 v[24:27], v[112:115], a[8:11], v[24:27]
    ds_read_b64_tr_b16 v[72:73], v244 offset:4096
    ds_read_b64_tr_b16 v[74:75], v244 offset:20480
    v_mfma_f32_16x16x32_bf16 v[28:31], v[112:115], a[12:15], v[28:31]
    buffer_load_dwordx4 a[84:87], v201, s[12:15], s28 offen offset:0 sc1
    s_mov_b32 s20, s74
    v_mfma_f32_16x16x32_bf16 v[32:35], v[116:119], a[8:11], v[32:35]
    ds_read_b64_tr_b16 v[76:77], v245 offset:4096
    ds_read_b64_tr_b16 v[78:79], v245 offset:20480
    v_mfma_f32_16x16x32_bf16 v[36:39], v[116:119], a[12:15], v[36:39]
    s_waitcnt lgkmcnt(8)
    s_and_b32 s21, s75, 0xffff
    s_mov_b32 s22, 0x400000
    v_mfma_f32_16x16x32_bf16 v[40:43], v[120:123], a[8:11], v[40:43]
    ds_read_b64_tr_b16 v[80:81], v246 offset:4096
    ds_read_b64_tr_b16 v[82:83], v246 offset:20480
    v_mfma_f32_16x16x32_bf16 v[44:47], v[120:123], a[12:15], v[44:47]
    buffer_load_dwordx4 a[88:91], v200, s[12:15], s28 offen offset:1024 sc1
    s_mov_b32 s23, 0x20000
    v_mfma_f32_16x16x32_bf16 v[48:51], v[124:127], a[8:11], v[48:51]
    ds_read_b64_tr_b16 v[84:85], v247 offset:4096
    ds_read_b64_tr_b16 v[86:87], v247 offset:20480
    v_mfma_f32_16x16x32_bf16 v[52:55], v[124:127], a[12:15], v[52:55]
    s_waitcnt lgkmcnt(8)
    s_lshr_b32 s59, s40, 2
    s_lshl_b32 s59, s59, 8
    v_mfma_f32_16x16x32_bf16 v[56:59], v[128:131], a[8:11], v[56:59]
    ds_read_b64_tr_b16 v[88:89], v248 offset:4096
    ds_read_b64_tr_b16 v[90:91], v248 offset:20480
    v_mfma_f32_16x16x32_bf16 v[60:63], v[128:131], a[12:15], v[60:63]
    buffer_load_dwordx4 a[92:95], v201, s[12:15], s28 offen offset:1024 sc1
    s_add_u32 s59, s59, 0x3700800
    v_mfma_f32_16x16x32_bf16 v[64:67], v[132:135], a[8:11], v[64:67]
    s_waitcnt vmcnt(22)
    ds_read_b64_tr_b16 v[92:93], v249 offset:4096
    ds_read_b64_tr_b16 v[94:95], v249 offset:20480
    v_mfma_f32_16x16x32_bf16 v[68:71], v[132:135], a[12:15], v[68:71]
    s_waitcnt lgkmcnt(8)
    s_add_u32 s28, s52, 6
    s_and_b32 s28, s28, 15
    v_mfma_f32_16x16x32_bf16 v[8:11], v[72:75], a[16:19], v[8:11]
    s_lshl_b32 s28, s28, 11
    ds_read_b64_tr_b16 v[96:97], v250 offset:4096
    ds_read_b64_tr_b16 v[98:99], v250 offset:20480
    v_mfma_f32_16x16x32_bf16 v[12:15], v[72:75], a[20:23], v[12:15]
    s_add_u32 s28, s28, s46
    buffer_load_dwordx4 a[96:99], v200, s[12:15], s28 offen offset:0 sc1
    s_lshl_b32 s49, s40, 16
    v_mfma_f32_16x16x32_bf16 v[16:19], v[76:79], a[16:19], v[16:19]
    ds_read_b64_tr_b16 v[100:101], v251 offset:4096
    ds_read_b64_tr_b16 v[102:103], v251 offset:20480
    v_mfma_f32_16x16x32_bf16 v[20:23], v[76:79], a[20:23], v[20:23]
    s_waitcnt lgkmcnt(8)
    s_lshl_b32 s3, s24, 12
    s_add_u32 s49, s49, s3
    v_mfma_f32_16x16x32_bf16 v[24:27], v[80:83], a[16:19], v[24:27]
    ds_read_b64_tr_b16 v[104:105], v244 offset:36864
    ds_read_b64_tr_b16 v[106:107], v244 offset:53248
    v_mfma_f32_16x16x32_bf16 v[28:31], v[80:83], a[20:23], v[28:31]
    buffer_load_dwordx4 a[100:103], v201, s[12:15], s28 offen offset:0 sc1
    s_add_u32 s49, s49, 0x3000000
    v_mfma_f32_16x16x32_bf16 v[32:35], v[84:87], a[16:19], v[32:35]
    ds_read_b64_tr_b16 v[108:109], v245 offset:36864
    ds_read_b64_tr_b16 v[110:111], v245 offset:53248
    v_mfma_f32_16x16x32_bf16 v[36:39], v[84:87], a[20:23], v[36:39]
    s_waitcnt lgkmcnt(8)
    s_lshl_b32 s3, s40, 17
    s_add_u32 s51, s51, s3
    v_mfma_f32_16x16x32_bf16 v[40:43], v[88:91], a[16:19], v[40:43]
    ds_read_b64_tr_b16 v[112:113], v246 offset:36864
    ds_read_b64_tr_b16 v[114:115], v246 offset:53248
    v_mfma_f32_16x16x32_bf16 v[44:47], v[88:91], a[20:23], v[44:47]
    buffer_load_dwordx4 a[104:107], v200, s[12:15], s28 offen offset:1024 sc1
    v_add_u32 v202, 0x0, v200
    v_mfma_f32_16x16x32_bf16 v[48:51], v[92:95], a[16:19], v[48:51]
    ds_read_b64_tr_b16 v[116:117], v247 offset:36864
    ds_read_b64_tr_b16 v[118:119], v247 offset:53248
    v_mfma_f32_16x16x32_bf16 v[52:55], v[92:95], a[20:23], v[52:55]
    s_waitcnt lgkmcnt(8)
    v_add_u32 v203, 0x4000, v200
    v_add_u32 v204, 0x8000, v200
    v_mfma_f32_16x16x32_bf16 v[56:59], v[96:99], a[16:19], v[56:59]
    ds_read_b64_tr_b16 v[120:121], v248 offset:36864
    ds_read_b64_tr_b16 v[122:123], v248 offset:53248
    v_mfma_f32_16x16x32_bf16 v[60:63], v[96:99], a[20:23], v[60:63]
    buffer_load_dwordx4 a[108:111], v201, s[12:15], s28 offen offset:1024 sc1
    v_add_u32 v205, 0xc000, v200
    v_mfma_f32_16x16x32_bf16 v[64:67], v[100:103], a[16:19], v[64:67]
    s_add_u32 s28, s52, 7
    ds_read_b64_tr_b16 v[124:125], v249 offset:36864
    ds_read_b64_tr_b16 v[126:127], v249 offset:53248
    v_mfma_f32_16x16x32_bf16 v[68:71], v[100:103], a[20:23], v[68:71]
    s_waitcnt lgkmcnt(8)
    s_and_b32 s28, s28, 15
    s_lshl_b32 s28, s28, 11
    v_mfma_f32_16x16x32_bf16 v[8:11], v[104:107], a[24:27], v[8:11]
    s_add_u32 s28, s28, s46
    ds_read_b64_tr_b16 v[128:129], v250 offset:36864
    ds_read_b64_tr_b16 v[130:131], v250 offset:53248
    v_mfma_f32_16x16x32_bf16 v[12:15], v[104:107], a[28:31], v[12:15]
    buffer_load_dwordx4 a[112:115], v200, s[12:15], s28 offen offset:0 sc1
    v_lshrrev_b32 v217, 3, v0
    v_mfma_f32_16x16x32_bf16 v[16:19], v[108:111], a[24:27], v[16:19]
    ds_read_b64_tr_b16 v[132:133], v251 offset:36864
    ds_read_b64_tr_b16 v[134:135], v251 offset:53248
    v_mfma_f32_16x16x32_bf16 v[20:23], v[108:111], a[28:31], v[20:23]
    s_waitcnt lgkmcnt(8)
    v_lshlrev_b32 v217, 10, v217
    v_lshrrev_b32 v218, 4, v0
    v_mfma_f32_16x16x32_bf16 v[24:27], v[112:115], a[24:27], v[24:27]
    ds_read_b64_tr_b16 v[72:73], v244 offset:8192
    ds_read_b64_tr_b16 v[74:75], v244 offset:24576
    v_mfma_f32_16x16x32_bf16 v[28:31], v[112:115], a[28:31], v[28:31]
    buffer_load_dwordx4 a[116:119], v201, s[12:15], s28 offen offset:0 sc1
    v_lshlrev_b32 v218, 1, v218
    v_mfma_f32_16x16x32_bf16 v[32:35], v[116:119], a[24:27], v[32:35]
    ds_read_b64_tr_b16 v[76:77], v245 offset:8192
    ds_read_b64_tr_b16 v[78:79], v245 offset:24576
    v_mfma_f32_16x16x32_bf16 v[36:39], v[116:119], a[28:31], v[36:39]
    s_waitcnt lgkmcnt(8)
    v_and_b32 v219, 7, v0
    v_xor_b32 v218, v218, v219
    v_mfma_f32_16x16x32_bf16 v[40:43], v[120:123], a[24:27], v[40:43]
    ds_read_b64_tr_b16 v[80:81], v246 offset:8192
    ds_read_b64_tr_b16 v[82:83], v246 offset:24576
    v_mfma_f32_16x16x32_bf16 v[44:47], v[120:123], a[28:31], v[44:47]
    buffer_load_dwordx4 a[120:123], v200, s[12:15], s28 offen offset:1024 sc1
    v_lshl_add_u32 v152, v218, 4, v217
    v_mfma_f32_16x16x32_bf16 v[48:51], v[124:127], a[24:27], v[48:51]
    ds_read_b64_tr_b16 v[84:85], v247 offset:8192
    ds_read_b64_tr_b16 v[86:87], v247 offset:24576
    v_mfma_f32_16x16x32_bf16 v[52:55], v[124:127], a[28:31], v[52:55]
    s_waitcnt lgkmcnt(8)
    v_add_u32 v153, 7168, v152
    v_add_u32 v154, 7168, v153
    v_mfma_f32_16x16x32_bf16 v[56:59], v[128:131], a[24:27], v[56:59]
    ds_read_b64_tr_b16 v[88:89], v248 offset:8192
    ds_read_b64_tr_b16 v[90:91], v248 offset:24576
    v_mfma_f32_16x16x32_bf16 v[60:63], v[128:131], a[28:31], v[60:63]
    buffer_load_dwordx4 a[124:127], v201, s[12:15], s28 offen offset:1024 sc1
    v_add_u32 v155, 7168, v154
    v_mfma_f32_16x16x32_bf16 v[64:67], v[132:135], a[24:27], v[64:67]
    s_waitcnt vmcnt(26)
    ds_read_b64_tr_b16 v[92:93], v249 offset:8192
    ds_read_b64_tr_b16 v[94:95], v249 offset:24576
    v_mfma_f32_16x16x32_bf16 v[68:71], v[132:135], a[28:31], v[68:71]
    s_waitcnt lgkmcnt(8)
    s_add_u32 s28, s52, 8
    s_and_b32 s28, s28, 15
    v_mfma_f32_16x16x32_bf16 v[8:11], v[72:75], a[32:35], v[8:11]
    s_lshl_b32 s28, s28, 11
    ds_read_b64_tr_b16 v[96:97], v250 offset:8192
    ds_read_b64_tr_b16 v[98:99], v250 offset:24576
    v_mfma_f32_16x16x32_bf16 v[12:15], v[72:75], a[36:39], v[12:15]
    s_add_u32 s28, s28, s46
    buffer_load_dwordx4 a[128:131], v200, s[12:15], s28 offen offset:0 sc1
    v_bfe_u32 v217, v0, 2, 3
    v_mfma_f32_16x16x32_bf16 v[16:19], v[76:79], a[32:35], v[16:19]
    ds_read_b64_tr_b16 v[100:101], v251 offset:8192
    ds_read_b64_tr_b16 v[102:103], v251 offset:24576
    v_mfma_f32_16x16x32_bf16 v[20:23], v[76:79], a[36:39], v[20:23]
    s_waitcnt lgkmcnt(8)
    v_lshlrev_b32 v217, 7, v217
    v_bfe_u32 v218, v0, 3, 2
    v_mfma_f32_16x16x32_bf16 v[24:27], v[80:83], a[32:35], v[24:27]
    ds_read_b64_tr_b16 v[104:105], v244 offset:40960
    ds_read_b64_tr_b16 v[106:107], v244 offset:57344
    v_mfma_f32_16x16x32_bf16 v[28:31], v[80:83], a[36:39], v[28:31]
    buffer_load_dwordx4 a[132:135], v201, s[12:15], s28 offen offset:0 sc1
    v_lshl_add_u32 v217, v218, 5, v217
    v_mfma_f32_16x16x32_bf16 v[32:35], v[84:87], a[32:35], v[32:35]
    ds_read_b64_tr_b16 v[108:109], v245 offset:40960
    ds_read_b64_tr_b16 v[110:111], v245 offset:57344
    v_mfma_f32_16x16x32_bf16 v[36:39], v[84:87], a[36:39], v[36:39]
    s_waitcnt lgkmcnt(8)
    v_and_b32 v218, 3, v0
    v_lshl_add_u32 v217, v218, 3, v217
    v_mfma_f32_16x16x32_bf16 v[40:43], v[88:91], a[32:35], v[40:43]
    ds_read_b64_tr_b16 v[112:113], v246 offset:40960
    ds_read_b64_tr_b16 v[114:115], v246 offset:57344
    v_mfma_f32_16x16x32_bf16 v[44:47], v[88:91], a[36:39], v[44:47]
    buffer_load_dwordx4 a[136:139], v200, s[12:15], s28 offen offset:1024 sc1
    v_add_u32 v217, s48, v217
    v_mfma_f32_16x16x32_bf16 v[48:51], v[92:95], a[32:35], v[48:51]
    ds_read_b64_tr_b16 v[116:117], v247 offset:40960
    ds_read_b64_tr_b16 v[118:119], v247 offset:57344
    v_mfma_f32_16x16x32_bf16 v[52:55], v[92:95], a[36:39], v[52:55]
    s_waitcnt lgkmcnt(8)
    v_lshrrev_b32 v218, 5, v0
    v_lshl_add_u32 v206, v218, 11, v217
    v_mfma_f32_16x16x32_bf16 v[56:59], v[96:99], a[32:35], v[56:59]
    ds_read_b64_tr_b16 v[120:121], v248 offset:40960
    ds_read_b64_tr_b16 v[122:123], v248 offset:57344
    v_mfma_f32_16x16x32_bf16 v[60:63], v[96:99], a[36:39], v[60:63]
    buffer_load_dwordx4 a[140:143], v201, s[12:15], s28 offen offset:1024 sc1
    v_add_u32 v206, 0x10000, v206
    v_mfma_f32_16x16x32_bf16 v[64:67], v[100:103], a[32:35], v[64:67]
    s_add_u32 s28, s52, 9
    ds_read_b64_tr_b16 v[124:125], v249 offset:40960
    ds_read_b64_tr_b16 v[126:127], v249 offset:57344
    v_mfma_f32_16x16x32_bf16 v[68:71], v[100:103], a[36:39], v[68:71]
    s_waitcnt lgkmcnt(8)
    s_and_b32 s28, s28, 15
    s_lshl_b32 s28, s28, 11
    v_mfma_f32_16x16x32_bf16 v[8:11], v[104:107], a[40:43], v[8:11]
    s_add_u32 s28, s28, s46
    ds_read_b64_tr_b16 v[128:129], v250 offset:40960
    ds_read_b64_tr_b16 v[130:131], v250 offset:57344
    v_mfma_f32_16x16x32_bf16 v[12:15], v[104:107], a[44:47], v[12:15]
    buffer_load_dwordx4 a[144:147], v200, s[12:15], s28 offen offset:0 sc1
    v_xor_b32 v207, 32, v206
    v_mfma_f32_16x16x32_bf16 v[16:19], v[108:111], a[40:43], v[16:19]
    ds_read_b64_tr_b16 v[132:133], v251 offset:40960
    ds_read_b64_tr_b16 v[134:135], v251 offset:57344
    v_mfma_f32_16x16x32_bf16 v[20:23], v[108:111], a[44:47], v[20:23]
    s_waitcnt lgkmcnt(8)
    v_xor_b32 v208, 64, v206
    v_xor_b32 v209, 96, v206
    v_mfma_f32_16x16x32_bf16 v[24:27], v[112:115], a[40:43], v[24:27]
    ds_read_b64_tr_b16 v[72:73], v244 offset:12288
    ds_read_b64_tr_b16 v[74:75], v244 offset:28672
    v_mfma_f32_16x16x32_bf16 v[28:31], v[112:115], a[44:47], v[28:31]
    buffer_load_dwordx4 a[148:151], v201, s[12:15], s28 offen offset:0 sc1
    v_and_b32 v217, 15, v0
    v_mfma_f32_16x16x32_bf16 v[32:35], v[116:119], a[40:43], v[32:35]
    ds_read_b64_tr_b16 v[76:77], v245 offset:12288
    ds_read_b64_tr_b16 v[78:79], v245 offset:28672
    v_mfma_f32_16x16x32_bf16 v[36:39], v[116:119], a[44:47], v[36:39]
    s_waitcnt lgkmcnt(8)
    v_lshrrev_b32 v218, 4, v0
    v_xor_b32 v218, v218, v217
    v_mfma_f32_16x16x32_bf16 v[40:43], v[120:123], a[40:43], v[40:43]
    ds_read_b64_tr_b16 v[80:81], v246 offset:12288
    ds_read_b64_tr_b16 v[82:83], v246 offset:28672
    v_mfma_f32_16x16x32_bf16 v[44:47], v[120:123], a[44:47], v[44:47]
    buffer_load_dwordx4 a[152:155], v200, s[12:15], s28 offen offset:1024 sc1
    v_lshlrev_b32 v217, 8, v217
    v_mfma_f32_16x16x32_bf16 v[48:51], v[124:127], a[40:43], v[48:51]
    ds_read_b64_tr_b16 v[84:85], v247 offset:12288
    ds_read_b64_tr_b16 v[86:87], v247 offset:28672
    v_mfma_f32_16x16x32_bf16 v[52:55], v[124:127], a[44:47], v[52:55]
    s_waitcnt lgkmcnt(8)
    v_lshl_add_u32 v217, v218, 4, v217
    v_add_u32 v210, s48, v217
    v_mfma_f32_16x16x32_bf16 v[56:59], v[128:131], a[40:43], v[56:59]
    ds_read_b64_tr_b16 v[88:89], v248 offset:12288
    ds_read_b64_tr_b16 v[90:91], v248 offset:28672
    v_mfma_f32_16x16x32_bf16 v[60:63], v[128:131], a[44:47], v[60:63]
    buffer_load_dwordx4 a[156:159], v201, s[12:15], s28 offen offset:1024 sc1
    v_add_u32 v210, 0x10000, v210
    v_mfma_f32_16x16x32_bf16 v[64:67], v[132:135], a[40:43], v[64:67]
    s_waitcnt vmcnt(30)
    ds_read_b64_tr_b16 v[92:93], v249 offset:12288
    ds_read_b64_tr_b16 v[94:95], v249 offset:28672
    v_mfma_f32_16x16x32_bf16 v[68:71], v[132:135], a[44:47], v[68:71]
    s_waitcnt lgkmcnt(8)
    s_add_u32 s28, s52, 10
    s_and_b32 s28, s28, 15
    v_mfma_f32_16x16x32_bf16 v[8:11], v[72:75], a[48:51], v[8:11]
    s_lshl_b32 s28, s28, 11
    ds_read_b64_tr_b16 v[96:97], v250 offset:12288
    ds_read_b64_tr_b16 v[98:99], v250 offset:28672
    v_mfma_f32_16x16x32_bf16 v[12:15], v[72:75], a[52:55], v[12:15]
    s_add_u32 s28, s28, s46
    buffer_load_dwordx4 a[160:163], v200, s[12:15], s28 offen offset:0 sc1
    v_xor_b32 v211, 64, v210
    v_mfma_f32_16x16x32_bf16 v[16:19], v[76:79], a[48:51], v[16:19]
    ds_read_b64_tr_b16 v[100:101], v251 offset:12288
    ds_read_b64_tr_b16 v[102:103], v251 offset:28672
    v_mfma_f32_16x16x32_bf16 v[20:23], v[76:79], a[52:55], v[20:23]
    s_waitcnt lgkmcnt(8)
    v_xor_b32 v212, 128, v210
    v_xor_b32 v213, 192, v210
    v_mfma_f32_16x16x32_bf16 v[24:27], v[80:83], a[48:51], v[24:27]
    ds_read_b64_tr_b16 v[104:105], v244 offset:45056
    ds_read_b64_tr_b16 v[106:107], v244 offset:61440
    v_mfma_f32_16x16x32_bf16 v[28:31], v[80:83], a[52:55], v[28:31]
    buffer_load_dwordx4 a[164:167], v201, s[12:15], s28 offen offset:0 sc1
    v_xor_b32 v244, 0x10000, v244
    v_mfma_f32_16x16x32_bf16 v[32:35], v[84:87], a[48:51], v[32:35]
    ds_read_b64_tr_b16 v[108:109], v245 offset:45056
    ds_read_b64_tr_b16 v[110:111], v245 offset:61440
    v_mfma_f32_16x16x32_bf16 v[36:39], v[84:87], a[52:55], v[36:39]
    s_waitcnt lgkmcnt(8)
    v_xor_b32 v245, 0x10000, v245
    v_mfma_f32_16x16x32_bf16 v[40:43], v[88:91], a[48:51], v[40:43]
    ds_read_b64_tr_b16 v[112:113], v246 offset:45056
    ds_read_b64_tr_b16 v[114:115], v246 offset:61440
    v_mfma_f32_16x16x32_bf16 v[44:47], v[88:91], a[52:55], v[44:47]
    buffer_load_dwordx4 a[168:171], v200, s[12:15], s28 offen offset:1024 sc1
    v_xor_b32 v246, 0x10000, v246
    v_mfma_f32_16x16x32_bf16 v[48:51], v[92:95], a[48:51], v[48:51]
    ds_read_b64_tr_b16 v[116:117], v247 offset:45056
    ds_read_b64_tr_b16 v[118:119], v247 offset:61440
    v_mfma_f32_16x16x32_bf16 v[52:55], v[92:95], a[52:55], v[52:55]
    s_waitcnt lgkmcnt(8)
    v_xor_b32 v247, 0x10000, v247
    v_mfma_f32_16x16x32_bf16 v[56:59], v[96:99], a[48:51], v[56:59]
    ds_read_b64_tr_b16 v[120:121], v248 offset:45056
    ds_read_b64_tr_b16 v[122:123], v248 offset:61440
    v_mfma_f32_16x16x32_bf16 v[60:63], v[96:99], a[52:55], v[60:63]
    buffer_load_dwordx4 a[172:175], v201, s[12:15], s28 offen offset:1024 sc1
    v_xor_b32 v248, 0x10000, v248
    v_mfma_f32_16x16x32_bf16 v[64:67], v[100:103], a[48:51], v[64:67]
    s_add_u32 s28, s52, 11
    ds_read_b64_tr_b16 v[124:125], v249 offset:45056
    ds_read_b64_tr_b16 v[126:127], v249 offset:61440
    v_mfma_f32_16x16x32_bf16 v[68:71], v[100:103], a[52:55], v[68:71]
    s_waitcnt lgkmcnt(8)
    s_and_b32 s28, s28, 15
    s_lshl_b32 s28, s28, 11
    v_xor_b32 v249, 0x10000, v249
    v_mfma_f32_16x16x32_bf16 v[8:11], v[104:107], a[56:59], v[8:11]
    s_add_u32 s28, s28, s46
    ds_read_b64_tr_b16 v[128:129], v250 offset:45056
    ds_read_b64_tr_b16 v[130:131], v250 offset:61440
    v_mfma_f32_16x16x32_bf16 v[12:15], v[104:107], a[60:63], v[12:15]
    buffer_load_dwordx4 a[176:179], v200, s[12:15], s28 offen offset:0 sc1
    v_xor_b32 v250, 0x10000, v250
    v_mfma_f32_16x16x32_bf16 v[16:19], v[108:111], a[56:59], v[16:19]
    ds_read_b64_tr_b16 v[132:133], v251 offset:45056
    ds_read_b64_tr_b16 v[134:135], v251 offset:61440
    v_mfma_f32_16x16x32_bf16 v[20:23], v[108:111], a[60:63], v[20:23]
    s_waitcnt lgkmcnt(8)
    v_xor_b32 v251, 0x10000, v251
    v_mfma_f32_16x16x32_bf16 v[24:27], v[112:115], a[56:59], v[24:27]
    s_waitcnt vmcnt(29)
    s_barrier
    s_lshl_b32 s27, s26, 8
    s_add_u32 s27, s27, 0x3700800
    s_cmp_eq_u32 s24, 0
    s_cselect_b32 s27, s27, 0x40000000
    buffer_atomic_add v6, v7, s[12:15], s27 offen
    ds_read_b64_tr_b16 v[72:73], v244 offset:0
    ds_read_b64_tr_b16 v[74:75], v244 offset:16384
    v_mfma_f32_16x16x32_bf16 v[28:31], v[112:115], a[60:63], v[28:31]
    buffer_load_dwordx4 a[180:183], v201, s[12:15], s28 offen offset:0 sc1
    v_mfma_f32_16x16x32_bf16 v[32:35], v[116:119], a[56:59], v[32:35]
    ds_read_b64_tr_b16 v[76:77], v245 offset:0
    ds_read_b64_tr_b16 v[78:79], v245 offset:16384
    v_mfma_f32_16x16x32_bf16 v[36:39], v[116:119], a[60:63], v[36:39]
    s_waitcnt lgkmcnt(8)
    v_mfma_f32_16x16x32_bf16 v[40:43], v[120:123], a[56:59], v[40:43]
    ds_read_b64_tr_b16 v[80:81], v246 offset:0
    ds_read_b64_tr_b16 v[82:83], v246 offset:16384
    v_mfma_f32_16x16x32_bf16 v[44:47], v[120:123], a[60:63], v[44:47]
    buffer_load_dwordx4 a[184:187], v200, s[12:15], s28 offen offset:1024 sc1
    v_mfma_f32_16x16x32_bf16 v[48:51], v[124:127], a[56:59], v[48:51]
    ds_read_b64_tr_b16 v[84:85], v247 offset:0
    ds_read_b64_tr_b16 v[86:87], v247 offset:16384
    v_mfma_f32_16x16x32_bf16 v[52:55], v[124:127], a[60:63], v[52:55]
    s_waitcnt lgkmcnt(8)
    v_mfma_f32_16x16x32_bf16 v[56:59], v[128:131], a[56:59], v[56:59]
    ds_read_b64_tr_b16 v[88:89], v248 offset:0
    ds_read_b64_tr_b16 v[90:91], v248 offset:16384
    v_mfma_f32_16x16x32_bf16 v[60:63], v[128:131], a[60:63], v[60:63]
    buffer_load_dwordx4 a[188:191], v201, s[12:15], s28 offen offset:1024 sc1
    v_mfma_f32_16x16x32_bf16 v[64:67], v[132:135], a[56:59], v[64:67]
    s_waitcnt vmcnt(29)
    ds_read_b64_tr_b16 v[92:93], v249 offset:0
    ds_read_b64_tr_b16 v[94:95], v249 offset:16384
    v_mfma_f32_16x16x32_bf16 v[68:71], v[132:135], a[60:63], v[68:71]
    s_waitcnt lgkmcnt(8)
    s_add_u32 s28, s52, 12
    s_and_b32 s28, s28, 15
    v_mfma_f32_16x16x32_bf16 v[8:11], v[72:75], a[64:67], v[8:11]
    s_lshl_b32 s28, s28, 11
    ds_read_b64_tr_b16 v[96:97], v250 offset:0
    ds_read_b64_tr_b16 v[98:99], v250 offset:16384
    v_mfma_f32_16x16x32_bf16 v[12:15], v[72:75], a[68:71], v[12:15]
    s_add_u32 s28, s28, s46
    buffer_load_dwordx4 a[192:195], v200, s[12:15], s28 offen offset:0 sc1
    v_mfma_f32_16x16x32_bf16 v[16:19], v[76:79], a[64:67], v[16:19]
    ds_read_b64_tr_b16 v[100:101], v251 offset:0
    ds_read_b64_tr_b16 v[102:103], v251 offset:16384
    v_mfma_f32_16x16x32_bf16 v[20:23], v[76:79], a[68:71], v[20:23]
    s_waitcnt lgkmcnt(8)
    v_mfma_f32_16x16x32_bf16 v[24:27], v[80:83], a[64:67], v[24:27]
    ds_read_b64_tr_b16 v[104:105], v244 offset:32768
    ds_read_b64_tr_b16 v[106:107], v244 offset:49152
    v_mfma_f32_16x16x32_bf16 v[28:31], v[80:83], a[68:71], v[28:31]
    s_barrier
    s_add_u32 m0, s48, 65536
    s_add_u32 s53, s52, 8
    v_mfma_f32_16x16x32_bf16 v[32:35], v[84:87], a[64:67], v[32:35]
    s_and_b32 s53, s53, 15
    ds_read_b64_tr_b16 v[108:109], v245 offset:32768
    ds_read_b64_tr_b16 v[110:111], v245 offset:49152
    v_mfma_f32_16x16x32_bf16 v[36:39], v[84:87], a[68:71], v[36:39]
    s_waitcnt lgkmcnt(8)
    s_lshl_b32 s53, s53, 16
    s_add_u32 s53, s53, s47
    v_mfma_f32_16x16x32_bf16 v[40:43], v[88:91], a[64:67], v[40:43]
    ds_read_b64_tr_b16 v[112:113], v246 offset:32768
    ds_read_b64_tr_b16 v[114:115], v246 offset:49152
    v_mfma_f32_16x16x32_bf16 v[44:47], v[88:91], a[68:71], v[44:47]
    buffer_load_dwordx4 v192, s[60:63], s53 offen offset:0 lds
    v_mfma_f32_16x16x32_bf16 v[48:51], v[92:95], a[64:67], v[48:51]
    ds_read_b64_tr_b16 v[116:117], v247 offset:32768
    ds_read_b64_tr_b16 v[118:119], v247 offset:49152
    v_mfma_f32_16x16x32_bf16 v[52:55], v[92:95], a[68:71], v[52:55]
    s_waitcnt lgkmcnt(8)
    v_mfma_f32_16x16x32_bf16 v[56:59], v[96:99], a[64:67], v[56:59]
    ds_read_b64_tr_b16 v[120:121], v248 offset:32768
    ds_read_b64_tr_b16 v[122:123], v248 offset:49152
    v_mfma_f32_16x16x32_bf16 v[60:63], v[96:99], a[68:71], v[60:63]
    buffer_load_dwordx4 v193, s[60:63], s53 offen offset:1024 lds
    v_mfma_f32_16x16x32_bf16 v[64:67], v[100:103], a[64:67], v[64:67]
    ds_read_b64_tr_b16 v[124:125], v249 offset:32768
    ds_read_b64_tr_b16 v[126:127], v249 offset:49152
    v_mfma_f32_16x16x32_bf16 v[68:71], v[100:103], a[68:71], v[68:71]
    s_waitcnt lgkmcnt(8)
    v_mfma_f32_16x16x32_bf16 v[8:11], v[104:107], a[72:75], v[8:11]
    ds_read_b64_tr_b16 v[128:129], v250 offset:32768
    ds_read_b64_tr_b16 v[130:131], v250 offset:49152
    v_mfma_f32_16x16x32_bf16 v[12:15], v[104:107], a[76:79], v[12:15]
    buffer_load_dwordx4 v194, s[60:63], s53 offen offset:2048 lds
    v_mfma_f32_16x16x32_bf16 v[16:19], v[108:111], a[72:75], v[16:19]
    ds_read_b64_tr_b16 v[132:133], v251 offset:32768
    ds_read_b64_tr_b16 v[134:135], v251 offset:49152
    v_mfma_f32_16x16x32_bf16 v[20:23], v[108:111], a[76:79], v[20:23]
    s_waitcnt lgkmcnt(8)
    v_mfma_f32_16x16x32_bf16 v[24:27], v[112:115], a[72:75], v[24:27]
    ds_read_b64_tr_b16 v[72:73], v244 offset:4096
    ds_read_b64_tr_b16 v[74:75], v244 offset:20480
    v_mfma_f32_16x16x32_bf16 v[28:31], v[112:115], a[76:79], v[28:31]
    buffer_load_dwordx4 v195, s[60:63], s53 offen offset:3072 lds
    v_mfma_f32_16x16x32_bf16 v[32:35], v[116:119], a[72:75], v[32:35]
    s_add_u32 m0, s48, 69632
    ds_read_b64_tr_b16 v[76:77], v245 offset:4096
    ds_read_b64_tr_b16 v[78:79], v245 offset:20480
    v_mfma_f32_16x16x32_bf16 v[36:39], v[116:119], a[76:79], v[36:39]
    s_waitcnt lgkmcnt(8)
    s_add_u32 s53, s52, 9
    s_and_b32 s53, s53, 15
    v_mfma_f32_16x16x32_bf16 v[40:43], v[120:123], a[72:75], v[40:43]
    s_lshl_b32 s53, s53, 16
    ds_read_b64_tr_b16 v[80:81], v246 offset:4096
    ds_read_b64_tr_b16 v[82:83], v246 offset:20480
    v_mfma_f32_16x16x32_bf16 v[44:47], v[120:123], a[76:79], v[44:47]
    s_add_u32 s53, s53, s47
    buffer_load_dwordx4 v192, s[60:63], s53 offen offset:0 lds
    v_mfma_f32_16x16x32_bf16 v[48:51], v[124:127], a[72:75], v[48:51]
    ds_read_b64_tr_b16 v[84:85], v247 offset:4096
    ds_read_b64_tr_b16 v[86:87], v247 offset:20480
    v_mfma_f32_16x16x32_bf16 v[52:55], v[124:127], a[76:79], v[52:55]
    s_waitcnt lgkmcnt(8)
    v_mfma_f32_16x16x32_bf16 v[56:59], v[128:131], a[72:75], v[56:59]
    ds_read_b64_tr_b16 v[88:89], v248 offset:4096
    ds_read_b64_tr_b16 v[90:91], v248 offset:20480
    v_mfma_f32_16x16x32_bf16 v[60:63], v[128:131], a[76:79], v[60:63]
    buffer_load_dwordx4 v193, s[60:63], s53 offen offset:1024 lds
    v_mfma_f32_16x16x32_bf16 v[64:67], v[132:135], a[72:75], v[64:67]
    s_waitcnt vmcnt(32)
    ds_read_b64_tr_b16 v[92:93], v249 offset:4096
    ds_read_b64_tr_b16 v[94:95], v249 offset:20480
    v_mfma_f32_16x16x32_bf16 v[68:71], v[132:135], a[76:79], v[68:71]
    s_waitcnt lgkmcnt(8)
    v_mfma_f32_16x16x32_bf16 v[8:11], v[72:75], a[80:83], v[8:11]
    ds_read_b64_tr_b16 v[96:97], v250 offset:4096
    ds_read_b64_tr_b16 v[98:99], v250 offset:20480
    v_mfma_f32_16x16x32_bf16 v[12:15], v[72:75], a[84:87], v[12:15]
    buffer_load_dwordx4 v194, s[60:63], s53 offen offset:2048 lds
    v_mfma_f32_16x16x32_bf16 v[16:19], v[76:79], a[80:83], v[16:19]
    ds_read_b64_tr_b16 v[100:101], v251 offset:4096
    ds_read_b64_tr_b16 v[102:103], v251 offset:20480
    v_mfma_f32_16x16x32_bf16 v[20:23], v[76:79], a[84:87], v[20:23]
    s_waitcnt lgkmcnt(8)
    v_mfma_f32_16x16x32_bf16 v[24:27], v[80:83], a[80:83], v[24:27]
    ds_read_b64_tr_b16 v[104:105], v244 offset:36864
    ds_read_b64_tr_b16 v[106:107], v244 offset:53248
    v_mfma_f32_16x16x32_bf16 v[28:31], v[80:83], a[84:87], v[28:31]
    buffer_load_dwordx4 v195, s[60:63], s53 offen offset:3072 lds
    v_mfma_f32_16x16x32_bf16 v[32:35], v[84:87], a[80:83], v[32:35]
    s_add_u32 m0, s48, 73728
    ds_read_b64_tr_b16 v[108:109], v245 offset:36864
    ds_read_b64_tr_b16 v[110:111], v245 offset:53248
    v_mfma_f32_16x16x32_bf16 v[36:39], v[84:87], a[84:87], v[36:39]
    s_waitcnt lgkmcnt(8)
    s_add_u32 s53, s52, 10
    s_and_b32 s53, s53, 15
    v_mfma_f32_16x16x32_bf16 v[40:43], v[88:91], a[80:83], v[40:43]
    s_lshl_b32 s53, s53, 16
    ds_read_b64_tr_b16 v[112:113], v246 offset:36864
    ds_read_b64_tr_b16 v[114:115], v246 offset:53248
    v_mfma_f32_16x16x32_bf16 v[44:47], v[88:91], a[84:87], v[44:47]
    s_add_u32 s53, s53, s47
    buffer_load_dwordx4 v192, s[60:63], s53 offen offset:0 lds
    v_mfma_f32_16x16x32_bf16 v[48:51], v[92:95], a[80:83], v[48:51]
    ds_read_b64_tr_b16 v[116:117], v247 offset:36864
    ds_read_b64_tr_b16 v[118:119], v247 offset:53248
    v_mfma_f32_16x16x32_bf16 v[52:55], v[92:95], a[84:87], v[52:55]
    s_waitcnt lgkmcnt(8)
    v_mfma_f32_16x16x32_bf16 v[56:59], v[96:99], a[80:83], v[56:59]
    ds_read_b64_tr_b16 v[120:121], v248 offset:36864
    ds_read_b64_tr_b16 v[122:123], v248 offset:53248
    v_mfma_f32_16x16x32_bf16 v[60:63], v[96:99], a[84:87], v[60:63]
    buffer_load_dwordx4 v193, s[60:63], s53 offen offset:1024 lds
    v_mfma_f32_16x16x32_bf16 v[64:67], v[100:103], a[80:83], v[64:67]
    ds_read_b64_tr_b16 v[124:125], v249 offset:36864
    ds_read_b64_tr_b16 v[126:127], v249 offset:53248
    v_mfma_f32_16x16x32_bf16 v[68:71], v[100:103], a[84:87], v[68:71]
    s_waitcnt lgkmcnt(8)
    v_mfma_f32_16x16x32_bf16 v[8:11], v[104:107], a[88:91], v[8:11]
    ds_read_b64_tr_b16 v[128:129], v250 offset:36864
    ds_read_b64_tr_b16 v[130:131], v250 offset:53248
    v_mfma_f32_16x16x32_bf16 v[12:15], v[104:107], a[92:95], v[12:15]
    buffer_load_dwordx4 v194, s[60:63], s53 offen offset:2048 lds
    v_mfma_f32_16x16x32_bf16 v[16:19], v[108:111], a[88:91], v[16:19]
    ds_read_b64_tr_b16 v[132:133], v251 offset:36864
    ds_read_b64_tr_b16 v[134:135], v251 offset:53248
    v_mfma_f32_16x16x32_bf16 v[20:23], v[108:111], a[92:95], v[20:23]
    s_waitcnt lgkmcnt(8)
    v_mfma_f32_16x16x32_bf16 v[24:27], v[112:115], a[88:91], v[24:27]
    ds_read_b64_tr_b16 v[72:73], v244 offset:8192
    ds_read_b64_tr_b16 v[74:75], v244 offset:24576
    v_mfma_f32_16x16x32_bf16 v[28:31], v[112:115], a[92:95], v[28:31]
    buffer_load_dwordx4 v195, s[60:63], s53 offen offset:3072 lds
    v_mfma_f32_16x16x32_bf16 v[32:35], v[116:119], a[88:91], v[32:35]
    s_add_u32 m0, s48, 77824
    ds_read_b64_tr_b16 v[76:77], v245 offset:8192
    ds_read_b64_tr_b16 v[78:79], v245 offset:24576
    v_mfma_f32_16x16x32_bf16 v[36:39], v[116:119], a[92:95], v[36:39]
    s_waitcnt lgkmcnt(8)
    s_add_u32 s53, s52, 11
    s_and_b32 s53, s53, 15
    v_mfma_f32_16x16x32_bf16 v[40:43], v[120:123], a[88:91], v[40:43]
    s_lshl_b32 s53, s53, 16
    ds_read_b64_tr_b16 v[80:81], v246 offset:8192
    ds_read_b64_tr_b16 v[82:83], v246 offset:24576
    v_mfma_f32_16x16x32_bf16 v[44:47], v[120:123], a[92:95], v[44:47]
    s_add_u32 s53, s53, s47
    buffer_load_dwordx4 v192, s[60:63], s53 offen offset:0 lds
    v_mfma_f32_16x16x32_bf16 v[48:51], v[124:127], a[88:91], v[48:51]
    ds_read_b64_tr_b16 v[84:85], v247 offset:8192
    ds_read_b64_tr_b16 v[86:87], v247 offset:24576
    v_mfma_f32_16x16x32_bf16 v[52:55], v[124:127], a[92:95], v[52:55]
    s_waitcnt lgkmcnt(8)
    v_mfma_f32_16x16x32_bf16 v[56:59], v[128:131], a[88:91], v[56:59]
    ds_read_b64_tr_b16 v[88:89], v248 offset:8192
    ds_read_b64_tr_b16 v[90:91], v248 offset:24576
    v_mfma_f32_16x16x32_bf16 v[60:63], v[128:131], a[92:95], v[60:63]
    buffer_load_dwordx4 v193, s[60:63], s53 offen offset:1024 lds
    v_mfma_f32_16x16x32_bf16 v[64:67], v[132:135], a[88:91], v[64:67]
    s_waitcnt vmcnt(36)
    ds_read_b64_tr_b16 v[92:93], v249 offset:8192
    ds_read_b64_tr_b16 v[94:95], v249 offset:24576
    v_mfma_f32_16x16x32_bf16 v[68:71], v[132:135], a[92:95], v[68:71]
    s_waitcnt lgkmcnt(8)
    v_mfma_f32_16x16x32_bf16 v[8:11], v[72:75], a[96:99], v[8:11]
    ds_read_b64_tr_b16 v[96:97], v250 offset:8192
    ds_read_b64_tr_b16 v[98:99], v250 offset:24576
    v_mfma_f32_16x16x32_bf16 v[12:15], v[72:75], a[100:103], v[12:15]
    buffer_load_dwordx4 v194, s[60:63], s53 offen offset:2048 lds
    v_mfma_f32_16x16x32_bf16 v[16:19], v[76:79], a[96:99], v[16:19]
    ds_read_b64_tr_b16 v[100:101], v251 offset:8192
    ds_read_b64_tr_b16 v[102:103], v251 offset:24576
    v_mfma_f32_16x16x32_bf16 v[20:23], v[76:79], a[100:103], v[20:23]
    s_waitcnt lgkmcnt(8)
    v_mfma_f32_16x16x32_bf16 v[24:27], v[80:83], a[96:99], v[24:27]
    ds_read_b64_tr_b16 v[104:105], v244 offset:40960
    ds_read_b64_tr_b16 v[106:107], v244 offset:57344
    v_mfma_f32_16x16x32_bf16 v[28:31], v[80:83], a[100:103], v[28:31]
    buffer_load_dwordx4 v195, s[60:63], s53 offen offset:3072 lds
    v_mfma_f32_16x16x32_bf16 v[32:35], v[84:87], a[96:99], v[32:35]
    ds_read_b64_tr_b16 v[108:109], v245 offset:40960
    ds_read_b64_tr_b16 v[110:111], v245 offset:57344
    v_mfma_f32_16x16x32_bf16 v[36:39], v[84:87], a[100:103], v[36:39]
    s_waitcnt lgkmcnt(8)
    v_mfma_f32_16x16x32_bf16 v[40:43], v[88:91], a[96:99], v[40:43]
    ds_read_b64_tr_b16 v[112:113], v246 offset:40960
    ds_read_b64_tr_b16 v[114:115], v246 offset:57344
    v_mfma_f32_16x16x32_bf16 v[44:47], v[88:91], a[100:103], v[44:47]
    buffer_load_dwordx4 a[196:199], v201, s[12:15], s28 offen offset:0 sc1
    v_mfma_f32_16x16x32_bf16 v[48:51], v[92:95], a[96:99], v[48:51]
    ds_read_b64_tr_b16 v[116:117], v247 offset:40960
    ds_read_b64_tr_b16 v[118:119], v247 offset:57344
    v_mfma_f32_16x16x32_bf16 v[52:55], v[92:95], a[100:103], v[52:55]
    s_waitcnt lgkmcnt(8)
    v_mfma_f32_16x16x32_bf16 v[56:59], v[96:99], a[96:99], v[56:59]
    ds_read_b64_tr_b16 v[120:121], v248 offset:40960
    ds_read_b64_tr_b16 v[122:123], v248 offset:57344
    v_mfma_f32_16x16x32_bf16 v[60:63], v[96:99], a[100:103], v[60:63]
    buffer_load_dwordx4 a[200:203], v200, s[12:15], s28 offen offset:1024 sc1
    v_mfma_f32_16x16x32_bf16 v[64:67], v[100:103], a[96:99], v[64:67]
    ds_read_b64_tr_b16 v[124:125], v249 offset:40960
    ds_read_b64_tr_b16 v[126:127], v249 offset:57344
    v_mfma_f32_16x16x32_bf16 v[68:71], v[100:103], a[100:103], v[68:71]
    s_waitcnt lgkmcnt(8)
    v_mfma_f32_16x16x32_bf16 v[8:11], v[104:107], a[104:107], v[8:11]
    ds_read_b64_tr_b16 v[128:129], v250 offset:40960
    ds_read_b64_tr_b16 v[130:131], v250 offset:57344
    v_mfma_f32_16x16x32_bf16 v[12:15], v[104:107], a[108:111], v[12:15]
    buffer_load_dwordx4 a[204:207], v201, s[12:15], s28 offen offset:1024 sc1
    v_mfma_f32_16x16x32_bf16 v[16:19], v[108:111], a[104:107], v[16:19]
    s_add_u32 s28, s52, 13
    ds_read_b64_tr_b16 v[132:133], v251 offset:40960
    ds_read_b64_tr_b16 v[134:135], v251 offset:57344
    v_mfma_f32_16x16x32_bf16 v[20:23], v[108:111], a[108:111], v[20:23]
    s_waitcnt lgkmcnt(8)
    s_and_b32 s28, s28, 15
    s_lshl_b32 s28, s28, 11
    v_mfma_f32_16x16x32_bf16 v[24:27], v[112:115], a[104:107], v[24:27]
    s_add_u32 s28, s28, s46
    ds_read_b64_tr_b16 v[72:73], v244 offset:12288
    ds_read_b64_tr_b16 v[74:75], v244 offset:28672
    v_mfma_f32_16x16x32_bf16 v[28:31], v[112:115], a[108:111], v[28:31]
    buffer_load_dwordx4 a[208:211], v200, s[12:15], s28 offen offset:0 sc1
    v_mfma_f32_16x16x32_bf16 v[32:35], v[116:119], a[104:107], v[32:35]
    ds_read_b64_tr_b16 v[76:77], v245 offset:12288
    ds_read_b64_tr_b16 v[78:79], v245 offset:28672
    v_mfma_f32_16x16x32_bf16 v[36:39], v[116:119], a[108:111], v[36:39]
    s_waitcnt lgkmcnt(8)
    v_mfma_f32_16x16x32_bf16 v[40:43], v[120:123], a[104:107], v[40:43]
    ds_read_b64_tr_b16 v[80:81], v246 offset:12288
    ds_read_b64_tr_b16 v[82:83], v246 offset:28672
    v_mfma_f32_16x16x32_bf16 v[44:47], v[120:123], a[108:111], v[44:47]
    buffer_load_dwordx4 a[212:215], v201, s[12:15], s28 offen offset:0 sc1
    v_mfma_f32_16x16x32_bf16 v[48:51], v[124:127], a[104:107], v[48:51]
    ds_read_b64_tr_b16 v[84:85], v247 offset:12288
    ds_read_b64_tr_b16 v[86:87], v247 offset:28672
    v_mfma_f32_16x16x32_bf16 v[52:55], v[124:127], a[108:111], v[52:55]
    s_waitcnt lgkmcnt(8)
    v_mfma_f32_16x16x32_bf16 v[56:59], v[128:131], a[104:107], v[56:59]
    ds_read_b64_tr_b16 v[88:89], v248 offset:12288
    ds_read_b64_tr_b16 v[90:91], v248 offset:28672
    v_mfma_f32_16x16x32_bf16 v[60:63], v[128:131], a[108:111], v[60:63]
    buffer_load_dwordx4 a[216:219], v200, s[12:15], s28 offen offset:1024 sc1
    v_mfma_f32_16x16x32_bf16 v[64:67], v[132:135], a[104:107], v[64:67]
    s_waitcnt vmcnt(40)
    ds_read_b64_tr_b16 v[92:93], v249 offset:12288
    ds_read_b64_tr_b16 v[94:95], v249 offset:28672
    v_mfma_f32_16x16x32_bf16 v[68:71], v[132:135], a[108:111], v[68:71]
    s_waitcnt lgkmcnt(8)
    v_mfma_f32_16x16x32_bf16 v[8:11], v[72:75], a[112:115], v[8:11]
    ds_read_b64_tr_b16 v[96:97], v250 offset:12288
    ds_read_b64_tr_b16 v[98:99], v250 offset:28672
    v_mfma_f32_16x16x32_bf16 v[12:15], v[72:75], a[116:119], v[12:15]
    buffer_load_dwordx4 a[220:223], v201, s[12:15], s28 offen offset:1024 sc1
    v_mfma_f32_16x16x32_bf16 v[16:19], v[76:79], a[112:115], v[16:19]
    s_add_u32 s28, s52, 14
    ds_read_b64_tr_b16 v[100:101], v251 offset:12288
    ds_read_b64_tr_b16 v[102:103], v251 offset:28672
    v_mfma_f32_16x16x32_bf16 v[20:23], v[76:79], a[116:119], v[20:23]
    s_waitcnt lgkmcnt(8)
    s_and_b32 s28, s28, 15
    s_lshl_b32 s28, s28, 11
    v_mfma_f32_16x16x32_bf16 v[24:27], v[80:83], a[112:115], v[24:27]
    s_add_u32 s28, s28, s46
    ds_read_b64_tr_b16 v[104:105], v244 offset:45056
    ds_read_b64_tr_b16 v[106:107], v244 offset:61440
    v_mfma_f32_16x16x32_bf16 v[28:31], v[80:83], a[116:119], v[28:31]
    buffer_load_dwordx4 a[224:227], v200, s[12:15], s28 offen offset:0 sc1
    v_xor_b32 v244, 0x10000, v244
    v_mfma_f32_16x16x32_bf16 v[32:35], v[84:87], a[112:115], v[32:35]
    ds_read_b64_tr_b16 v[108:109], v245 offset:45056
    ds_read_b64_tr_b16 v[110:111], v245 offset:61440
    v_mfma_f32_16x16x32_bf16 v[36:39], v[84:87], a[116:119], v[36:39]
    s_waitcnt lgkmcnt(8)
    v_xor_b32 v245, 0x10000, v245
    v_mfma_f32_16x16x32_bf16 v[40:43], v[88:91], a[112:115], v[40:43]
    ds_read_b64_tr_b16 v[112:113], v246 offset:45056
    ds_read_b64_tr_b16 v[114:115], v246 offset:61440
    v_mfma_f32_16x16x32_bf16 v[44:47], v[88:91], a[116:119], v[44:47]
    buffer_load_dwordx4 a[228:231], v201, s[12:15], s28 offen offset:0 sc1
    v_xor_b32 v246, 0x10000, v246
    v_mfma_f32_16x16x32_bf16 v[48:51], v[92:95], a[112:115], v[48:51]
    ds_read_b64_tr_b16 v[116:117], v247 offset:45056
    ds_read_b64_tr_b16 v[118:119], v247 offset:61440
    v_mfma_f32_16x16x32_bf16 v[52:55], v[92:95], a[116:119], v[52:55]
    s_waitcnt lgkmcnt(8)
    v_xor_b32 v247, 0x10000, v247
    v_mfma_f32_16x16x32_bf16 v[56:59], v[96:99], a[112:115], v[56:59]
    ds_read_b64_tr_b16 v[120:121], v248 offset:45056
    ds_read_b64_tr_b16 v[122:123], v248 offset:61440
    v_mfma_f32_16x16x32_bf16 v[60:63], v[96:99], a[116:119], v[60:63]
    buffer_load_dwordx4 a[232:235], v200, s[12:15], s28 offen offset:1024 sc1
    v_xor_b32 v248, 0x10000, v248
    v_mfma_f32_16x16x32_bf16 v[64:67], v[100:103], a[112:115], v[64:67]
    ds_read_b64_tr_b16 v[124:125], v249 offset:45056
    ds_read_b64_tr_b16 v[126:127], v249 offset:61440
    v_mfma_f32_16x16x32_bf16 v[68:71], v[100:103], a[116:119], v[68:71]
    s_waitcnt lgkmcnt(8)
    v_xor_b32 v249, 0x10000, v249
    v_mfma_f32_16x16x32_bf16 v[8:11], v[104:107], a[120:123], v[8:11]
    ds_read_b64_tr_b16 v[128:129], v250 offset:45056
    ds_read_b64_tr_b16 v[130:131], v250 offset:61440
    v_mfma_f32_16x16x32_bf16 v[12:15], v[104:107], a[124:127], v[12:15]
    buffer_load_dwordx4 a[236:239], v201, s[12:15], s28 offen offset:1024 sc1
    v_xor_b32 v250, 0x10000, v250
    v_mfma_f32_16x16x32_bf16 v[16:19], v[108:111], a[120:123], v[16:19]
    s_add_u32 s28, s52, 15
    ds_read_b64_tr_b16 v[132:133], v251 offset:45056
    ds_read_b64_tr_b16 v[134:135], v251 offset:61440
    v_mfma_f32_16x16x32_bf16 v[20:23], v[108:111], a[124:127], v[20:23]
    s_waitcnt lgkmcnt(8)
    s_and_b32 s28, s28, 15
    s_lshl_b32 s28, s28, 11
    v_xor_b32 v251, 0x10000, v251
    v_mfma_f32_16x16x32_bf16 v[24:27], v[112:115], a[120:123], v[24:27]
    s_waitcnt vmcnt(11)
    s_barrier
    ds_read_b64_tr_b16 v[72:73], v244 offset:0
    ds_read_b64_tr_b16 v[74:75], v244 offset:16384
    v_mfma_f32_16x16x32_bf16 v[28:31], v[112:115], a[124:127], v[28:31]
    s_add_u32 s28, s28, s46
    buffer_load_dwordx4 a[240:243], v200, s[12:15], s28 offen offset:0 sc1
    v_mfma_f32_16x16x32_bf16 v[32:35], v[116:119], a[120:123], v[32:35]
    ds_read_b64_tr_b16 v[76:77], v245 offset:0
    ds_read_b64_tr_b16 v[78:79], v245 offset:16384
    v_mfma_f32_16x16x32_bf16 v[36:39], v[116:119], a[124:127], v[36:39]
    s_waitcnt lgkmcnt(8)
    v_mfma_f32_16x16x32_bf16 v[40:43], v[120:123], a[120:123], v[40:43]
    ds_read_b64_tr_b16 v[80:81], v246 offset:0
    ds_read_b64_tr_b16 v[82:83], v246 offset:16384
    v_mfma_f32_16x16x32_bf16 v[44:47], v[120:123], a[124:127], v[44:47]
    buffer_load_dwordx4 a[244:247], v201, s[12:15], s28 offen offset:0 sc1
    v_mfma_f32_16x16x32_bf16 v[48:51], v[124:127], a[120:123], v[48:51]
    ds_read_b64_tr_b16 v[84:85], v247 offset:0
    ds_read_b64_tr_b16 v[86:87], v247 offset:16384
    v_mfma_f32_16x16x32_bf16 v[52:55], v[124:127], a[124:127], v[52:55]
    s_waitcnt lgkmcnt(8)
    v_mfma_f32_16x16x32_bf16 v[56:59], v[128:131], a[120:123], v[56:59]
    ds_read_b64_tr_b16 v[88:89], v248 offset:0
    ds_read_b64_tr_b16 v[90:91], v248 offset:16384
    v_mfma_f32_16x16x32_bf16 v[60:63], v[128:131], a[124:127], v[60:63]
    buffer_load_dwordx4 a[248:251], v200, s[12:15], s28 offen offset:1024 sc1
    v_mfma_f32_16x16x32_bf16 v[64:67], v[132:135], a[120:123], v[64:67]
    ds_read_b64_tr_b16 v[92:93], v249 offset:0
    ds_read_b64_tr_b16 v[94:95], v249 offset:16384
    v_mfma_f32_16x16x32_bf16 v[68:71], v[132:135], a[124:127], v[68:71]
    s_waitcnt lgkmcnt(8)
    v_mfma_f32_16x16x32_bf16 v[8:11], v[72:75], a[128:131], v[8:11]
    ds_read_b64_tr_b16 v[96:97], v250 offset:0
    ds_read_b64_tr_b16 v[98:99], v250 offset:16384
    v_mfma_f32_16x16x32_bf16 v[12:15], v[72:75], a[132:135], v[12:15]
    buffer_load_dwordx4 a[252:255], v201, s[12:15], s28 offen offset:1024 sc1
    v_mfma_f32_16x16x32_bf16 v[16:19], v[76:79], a[128:131], v[16:19]
    ds_read_b64_tr_b16 v[100:101], v251 offset:0
    ds_read_b64_tr_b16 v[102:103], v251 offset:16384
    v_mfma_f32_16x16x32_bf16 v[20:23], v[76:79], a[132:135], v[20:23]
    s_waitcnt lgkmcnt(8)
    v_mfma_f32_16x16x32_bf16 v[24:27], v[80:83], a[128:131], v[24:27]
    ds_read_b64_tr_b16 v[104:105], v244 offset:32768
    ds_read_b64_tr_b16 v[106:107], v244 offset:49152
    v_mfma_f32_16x16x32_bf16 v[28:31], v[80:83], a[132:135], v[28:31]
    s_barrier
    buffer_load_dword v216, v7, s[12:15], s59 offen sc1
    buffer_load_dword v214, v7, s[12:15], s34 offen sc1
    v_mfma_f32_16x16x32_bf16 v[32:35], v[84:87], a[128:131], v[32:35]
    s_add_u32 m0, s48, 0
    ds_read_b64_tr_b16 v[108:109], v245 offset:32768
    ds_read_b64_tr_b16 v[110:111], v245 offset:49152
    v_mfma_f32_16x16x32_bf16 v[36:39], v[84:87], a[132:135], v[36:39]
    s_waitcnt lgkmcnt(8)
    s_add_u32 s53, s52, 12
    s_and_b32 s53, s53, 15
    v_mfma_f32_16x16x32_bf16 v[40:43], v[88:91], a[128:131], v[40:43]
    s_lshl_b32 s53, s53, 16
    ds_read_b64_tr_b16 v[112:113], v246 offset:32768
    ds_read_b64_tr_b16 v[114:115], v246 offset:49152
    v_mfma_f32_16x16x32_bf16 v[44:47], v[88:91], a[132:135], v[44:47]
    s_add_u32 s53, s53, s47
    buffer_load_dwordx4 v192, s[60:63], s53 offen offset:0 lds
    v_mfma_f32_16x16x32_bf16 v[48:51], v[92:95], a[128:131], v[48:51]
    ds_read_b64_tr_b16 v[116:117], v247 offset:32768
    ds_read_b64_tr_b16 v[118:119], v247 offset:49152
    v_mfma_f32_16x16x32_bf16 v[52:55], v[92:95], a[132:135], v[52:55]
    s_waitcnt lgkmcnt(8)
    v_mfma_f32_16x16x32_bf16 v[56:59], v[96:99], a[128:131], v[56:59]
    ds_read_b64_tr_b16 v[120:121], v248 offset:32768
    ds_read_b64_tr_b16 v[122:123], v248 offset:49152
    v_mfma_f32_16x16x32_bf16 v[60:63], v[96:99], a[132:135], v[60:63]
    buffer_load_dwordx4 v193, s[60:63], s53 offen offset:1024 lds
    v_mfma_f32_16x16x32_bf16 v[64:67], v[100:103], a[128:131], v[64:67]
    ds_read_b64_tr_b16 v[124:125], v249 offset:32768
    ds_read_b64_tr_b16 v[126:127], v249 offset:49152
    v_mfma_f32_16x16x32_bf16 v[68:71], v[100:103], a[132:135], v[68:71]
    s_waitcnt lgkmcnt(8)
    v_mfma_f32_16x16x32_bf16 v[8:11], v[104:107], a[136:139], v[8:11]
    ds_read_b64_tr_b16 v[128:129], v250 offset:32768
    ds_read_b64_tr_b16 v[130:131], v250 offset:49152
    v_mfma_f32_16x16x32_bf16 v[12:15], v[104:107], a[140:143], v[12:15]
    buffer_load_dwordx4 v194, s[60:63], s53 offen offset:2048 lds
    v_mfma_f32_16x16x32_bf16 v[16:19], v[108:111], a[136:139], v[16:19]
    ds_read_b64_tr_b16 v[132:133], v251 offset:32768
    ds_read_b64_tr_b16 v[134:135], v251 offset:49152
    v_mfma_f32_16x16x32_bf16 v[20:23], v[108:111], a[140:143], v[20:23]
    s_waitcnt lgkmcnt(8)
    v_mfma_f32_16x16x32_bf16 v[24:27], v[112:115], a[136:139], v[24:27]
    ds_read_b64_tr_b16 v[72:73], v244 offset:4096
    ds_read_b64_tr_b16 v[74:75], v244 offset:20480
    v_mfma_f32_16x16x32_bf16 v[28:31], v[112:115], a[140:143], v[28:31]
    buffer_load_dwordx4 v195, s[60:63], s53 offen offset:3072 lds
    v_mfma_f32_16x16x32_bf16 v[32:35], v[116:119], a[136:139], v[32:35]
    s_add_u32 m0, s48, 4096
    ds_read_b64_tr_b16 v[76:77], v245 offset:4096
    ds_read_b64_tr_b16 v[78:79], v245 offset:20480
    v_mfma_f32_16x16x32_bf16 v[36:39], v[116:119], a[140:143], v[36:39]
    s_waitcnt lgkmcnt(8)
    s_add_u32 s53, s52, 13
    s_and_b32 s53, s53, 15
    v_mfma_f32_16x16x32_bf16 v[40:43], v[120:123], a[136:139], v[40:43]
    s_lshl_b32 s53, s53, 16
    ds_read_b64_tr_b16 v[80:81], v246 offset:4096
    ds_read_b64_tr_b16 v[82:83], v246 offset:20480
    v_mfma_f32_16x16x32_bf16 v[44:47], v[120:123], a[140:143], v[44:47]
    s_add_u32 s53, s53, s47
    buffer_load_dwordx4 v192, s[60:63], s53 offen offset:0 lds
    v_mfma_f32_16x16x32_bf16 v[48:51], v[124:127], a[136:139], v[48:51]
    ds_read_b64_tr_b16 v[84:85], v247 offset:4096
    ds_read_b64_tr_b16 v[86:87], v247 offset:20480
    v_mfma_f32_16x16x32_bf16 v[52:55], v[124:127], a[140:143], v[52:55]
    s_waitcnt lgkmcnt(8)
    v_mfma_f32_16x16x32_bf16 v[56:59], v[128:131], a[136:139], v[56:59]
    ds_read_b64_tr_b16 v[88:89], v248 offset:4096
    ds_read_b64_tr_b16 v[90:91], v248 offset:20480
    v_mfma_f32_16x16x32_bf16 v[60:63], v[128:131], a[140:143], v[60:63]
    buffer_load_dwordx4 v193, s[60:63], s53 offen offset:1024 lds
    v_mfma_f32_16x16x32_bf16 v[64:67], v[132:135], a[136:139], v[64:67]
    ds_read_b64_tr_b16 v[92:93], v249 offset:4096
    ds_read_b64_tr_b16 v[94:95], v249 offset:20480
    v_mfma_f32_16x16x32_bf16 v[68:71], v[132:135], a[140:143], v[68:71]
    s_waitcnt lgkmcnt(8)
    v_mfma_f32_16x16x32_bf16 v[8:11], v[72:75], a[144:147], v[8:11]
    ds_read_b64_tr_b16 v[96:97], v250 offset:4096
    ds_read_b64_tr_b16 v[98:99], v250 offset:20480
    v_mfma_f32_16x16x32_bf16 v[12:15], v[72:75], a[148:151], v[12:15]
    buffer_load_dwordx4 v194, s[60:63], s53 offen offset:2048 lds
    v_mfma_f32_16x16x32_bf16 v[16:19], v[76:79], a[144:147], v[16:19]
    ds_read_b64_tr_b16 v[100:101], v251 offset:4096
    ds_read_b64_tr_b16 v[102:103], v251 offset:20480
    v_mfma_f32_16x16x32_bf16 v[20:23], v[76:79], a[148:151], v[20:23]
    s_waitcnt lgkmcnt(8)
    v_mfma_f32_16x16x32_bf16 v[24:27], v[80:83], a[144:147], v[24:27]
    ds_read_b64_tr_b16 v[104:105], v244 offset:36864
    ds_read_b64_tr_b16 v[106:107], v244 offset:53248
    v_mfma_f32_16x16x32_bf16 v[28:31], v[80:83], a[148:151], v[28:31]
    buffer_load_dwordx4 v195, s[60:63], s53 offen offset:3072 lds
    v_mfma_f32_16x16x32_bf16 v[32:35], v[84:87], a[144:147], v[32:35]
    s_add_u32 m0, s48, 8192
    ds_read_b64_tr_b16 v[108:109], v245 offset:36864
    ds_read_b64_tr_b16 v[110:111], v245 offset:53248
    v_mfma_f32_16x16x32_bf16 v[36:39], v[84:87], a[148:151], v[36:39]
    s_waitcnt lgkmcnt(8)
    s_add_u32 s53, s52, 14
    s_and_b32 s53, s53, 15
    v_mfma_f32_16x16x32_bf16 v[40:43], v[88:91], a[144:147], v[40:43]
    s_lshl_b32 s53, s53, 16
    ds_read_b64_tr_b16 v[112:113], v246 offset:36864
    ds_read_b64_tr_b16 v[114:115], v246 offset:53248
    v_mfma_f32_16x16x32_bf16 v[44:47], v[88:91], a[148:151], v[44:47]
    s_add_u32 s53, s53, s47
    buffer_load_dwordx4 v192, s[60:63], s53 offen offset:0 lds
    v_mfma_f32_16x16x32_bf16 v[48:51], v[92:95], a[144:147], v[48:51]
    ds_read_b64_tr_b16 v[116:117], v247 offset:36864
    ds_read_b64_tr_b16 v[118:119], v247 offset:53248
    v_mfma_f32_16x16x32_bf16 v[52:55], v[92:95], a[148:151], v[52:55]
    s_waitcnt lgkmcnt(8)
    v_mfma_f32_16x16x32_bf16 v[56:59], v[96:99], a[144:147], v[56:59]
    ds_read_b64_tr_b16 v[120:121], v248 offset:36864
    ds_read_b64_tr_b16 v[122:123], v248 offset:53248
    v_mfma_f32_16x16x32_bf16 v[60:63], v[96:99], a[148:151], v[60:63]
    buffer_load_dwordx4 v193, s[60:63], s53 offen offset:1024 lds
    v_mfma_f32_16x16x32_bf16 v[64:67], v[100:103], a[144:147], v[64:67]
    ds_read_b64_tr_b16 v[124:125], v249 offset:36864
    ds_read_b64_tr_b16 v[126:127], v249 offset:53248
    v_mfma_f32_16x16x32_bf16 v[68:71], v[100:103], a[148:151], v[68:71]
    s_waitcnt lgkmcnt(8)
    v_mfma_f32_16x16x32_bf16 v[8:11], v[104:107], a[152:155], v[8:11]
    ds_read_b64_tr_b16 v[128:129], v250 offset:36864
    ds_read_b64_tr_b16 v[130:131], v250 offset:53248
    v_mfma_f32_16x16x32_bf16 v[12:15], v[104:107], a[156:159], v[12:15]
    buffer_load_dwordx4 v194, s[60:63], s53 offen offset:2048 lds
    v_mfma_f32_16x16x32_bf16 v[16:19], v[108:111], a[152:155], v[16:19]
    ds_read_b64_tr_b16 v[132:133], v251 offset:36864
    ds_read_b64_tr_b16 v[134:135], v251 offset:53248
    v_mfma_f32_16x16x32_bf16 v[20:23], v[108:111], a[156:159], v[20:23]
    s_waitcnt lgkmcnt(8)
    v_mfma_f32_16x16x32_bf16 v[24:27], v[112:115], a[152:155], v[24:27]
    ds_read_b64_tr_b16 v[72:73], v244 offset:8192
    ds_read_b64_tr_b16 v[74:75], v244 offset:24576
    v_mfma_f32_16x16x32_bf16 v[28:31], v[112:115], a[156:159], v[28:31]
    buffer_load_dwordx4 v195, s[60:63], s53 offen offset:3072 lds
    v_mfma_f32_16x16x32_bf16 v[32:35], v[116:119], a[152:155], v[32:35]
    s_add_u32 m0, s48, 12288
    ds_read_b64_tr_b16 v[76:77], v245 offset:8192
    ds_read_b64_tr_b16 v[78:79], v245 offset:24576
    v_mfma_f32_16x16x32_bf16 v[36:39], v[116:119], a[156:159], v[36:39]
    s_waitcnt lgkmcnt(8)
    s_add_u32 s53, s52, 15
    s_and_b32 s53, s53, 15
    v_mfma_f32_16x16x32_bf16 v[40:43], v[120:123], a[152:155], v[40:43]
    s_lshl_b32 s53, s53, 16
    ds_read_b64_tr_b16 v[80:81], v246 offset:8192
    ds_read_b64_tr_b16 v[82:83], v246 offset:24576
    v_mfma_f32_16x16x32_bf16 v[44:47], v[120:123], a[156:159], v[44:47]
    s_add_u32 s53, s53, s47
    buffer_load_dwordx4 v192, s[60:63], s53 offen offset:0 lds
    v_mfma_f32_16x16x32_bf16 v[48:51], v[124:127], a[152:155], v[48:51]
    ds_read_b64_tr_b16 v[84:85], v247 offset:8192
    ds_read_b64_tr_b16 v[86:87], v247 offset:24576
    v_mfma_f32_16x16x32_bf16 v[52:55], v[124:127], a[156:159], v[52:55]
    s_waitcnt lgkmcnt(8)
    v_mfma_f32_16x16x32_bf16 v[56:59], v[128:131], a[152:155], v[56:59]
    ds_read_b64_tr_b16 v[88:89], v248 offset:8192
    ds_read_b64_tr_b16 v[90:91], v248 offset:24576
    v_mfma_f32_16x16x32_bf16 v[60:63], v[128:131], a[156:159], v[60:63]
    buffer_load_dwordx4 v193, s[60:63], s53 offen offset:1024 lds
    v_mfma_f32_16x16x32_bf16 v[64:67], v[132:135], a[152:155], v[64:67]
    ds_read_b64_tr_b16 v[92:93], v249 offset:8192
    ds_read_b64_tr_b16 v[94:95], v249 offset:24576
    v_mfma_f32_16x16x32_bf16 v[68:71], v[132:135], a[156:159], v[68:71]
    s_waitcnt lgkmcnt(8)
    v_mfma_f32_16x16x32_bf16 v[8:11], v[72:75], a[160:163], v[8:11]
    ds_read_b64_tr_b16 v[96:97], v250 offset:8192
    ds_read_b64_tr_b16 v[98:99], v250 offset:24576
    v_mfma_f32_16x16x32_bf16 v[12:15], v[72:75], a[164:167], v[12:15]
    buffer_load_dwordx4 v194, s[60:63], s53 offen offset:2048 lds
    v_mfma_f32_16x16x32_bf16 v[16:19], v[76:79], a[160:163], v[16:19]
    ds_read_b64_tr_b16 v[100:101], v251 offset:8192
    ds_read_b64_tr_b16 v[102:103], v251 offset:24576
    v_mfma_f32_16x16x32_bf16 v[20:23], v[76:79], a[164:167], v[20:23]
    s_waitcnt lgkmcnt(8)
    v_mfma_f32_16x16x32_bf16 v[24:27], v[80:83], a[160:163], v[24:27]
    ds_read_b64_tr_b16 v[104:105], v244 offset:40960
    ds_read_b64_tr_b16 v[106:107], v244 offset:57344
    v_mfma_f32_16x16x32_bf16 v[28:31], v[80:83], a[164:167], v[28:31]
    buffer_load_dwordx4 v195, s[60:63], s53 offen offset:3072 lds
    v_mfma_f32_16x16x32_bf16 v[32:35], v[84:87], a[160:163], v[32:35]
    ds_read_b64_tr_b16 v[108:109], v245 offset:40960
    ds_read_b64_tr_b16 v[110:111], v245 offset:57344
    v_mfma_f32_16x16x32_bf16 v[36:39], v[84:87], a[164:167], v[36:39]
    s_waitcnt lgkmcnt(8)
    v_mfma_f32_16x16x32_bf16 v[40:43], v[88:91], a[160:163], v[40:43]
    ds_read_b64_tr_b16 v[112:113], v246 offset:40960
    ds_read_b64_tr_b16 v[114:115], v246 offset:57344
    v_mfma_f32_16x16x32_bf16 v[44:47], v[88:91], a[164:167], v[44:47]
    v_mfma_f32_16x16x32_bf16 v[48:51], v[92:95], a[160:163], v[48:51]
    ds_read_b64_tr_b16 v[116:117], v247 offset:40960
    ds_read_b64_tr_b16 v[118:119], v247 offset:57344
    v_mfma_f32_16x16x32_bf16 v[52:55], v[92:95], a[164:167], v[52:55]
    s_waitcnt lgkmcnt(8)
    v_mfma_f32_16x16x32_bf16 v[56:59], v[96:99], a[160:163], v[56:59]
    ds_read_b64_tr_b16 v[120:121], v248 offset:40960
    ds_read_b64_tr_b16 v[122:123], v248 offset:57344
    v_mfma_f32_16x16x32_bf16 v[60:63], v[96:99], a[164:167], v[60:63]
    v_mfma_f32_16x16x32_bf16 v[64:67], v[100:103], a[160:163], v[64:67]
    ds_read_b64_tr_b16 v[124:125], v249 offset:40960
    ds_read_b64_tr_b16 v[126:127], v249 offset:57344
    v_mfma_f32_16x16x32_bf16 v[68:71], v[100:103], a[164:167], v[68:71]
    s_waitcnt lgkmcnt(8)
    v_mfma_f32_16x16x32_bf16 v[8:11], v[104:107], a[168:171], v[8:11]
    ds_read_b64_tr_b16 v[128:129], v250 offset:40960
    ds_read_b64_tr_b16 v[130:131], v250 offset:57344
    v_mfma_f32_16x16x32_bf16 v[12:15], v[104:107], a[172:175], v[12:15]
    v_mfma_f32_16x16x32_bf16 v[16:19], v[108:111], a[168:171], v[16:19]
    ds_read_b64_tr_b16 v[132:133], v251 offset:40960
    ds_read_b64_tr_b16 v[134:135], v251 offset:57344
    v_mfma_f32_16x16x32_bf16 v[20:23], v[108:111], a[172:175], v[20:23]
    s_waitcnt lgkmcnt(8)
    v_mfma_f32_16x16x32_bf16 v[24:27], v[112:115], a[168:171], v[24:27]
    ds_read_b64_tr_b16 v[72:73], v244 offset:12288
    ds_read_b64_tr_b16 v[74:75], v244 offset:28672
    v_mfma_f32_16x16x32_bf16 v[28:31], v[112:115], a[172:175], v[28:31]
    s_waitcnt vmcnt(16)
    s_mov_b32 s55, 0
SP_concat_73:
    v_readlane_b32 s27, v216, 0
    s_nop 0
    s_cmp_ge_u32 s27, 32
    s_cbranch_scc1 SD_concat_74
    s_add_u32 s55, s55, 1
    s_cmp_ge_u32 s55, 200000
    s_cbranch_scc1 SD_concat_74
    s_sleep 4
    buffer_load_dword v216, v7, s[12:15], s59 offen sc1
    s_waitcnt vmcnt(0)
    s_branch SP_concat_73
SD_concat_74:
    s_mov_b32 s55, 0
SP_concat_75:
    v_readlane_b32 s27, v214, 0
    s_nop 0
    s_cmp_ge_u32 s27, 4
    s_cbranch_scc1 SD_concat_76
    s_add_u32 s55, s55, 1
    s_cmp_ge_u32 s55, 200000
    s_cbranch_scc1 SD_concat_76
    s_sleep 4
    buffer_load_dword v214, v7, s[12:15], s34 offen sc1
    s_waitcnt vmcnt(0)
    s_branch SP_concat_75
SD_concat_76:
    v_mfma_f32_16x16x32_bf16 v[32:35], v[116:119], a[168:171], v[32:35]
    s_add_u32 s28, s49, 0
    ds_read_b64_tr_b16 v[76:77], v245 offset:12288
    ds_read_b64_tr_b16 v[78:79], v245 offset:28672
    v_mfma_f32_16x16x32_bf16 v[36:39], v[116:119], a[172:175], v[36:39]
    s_waitcnt lgkmcnt(8)
    v_mfma_f32_16x16x32_bf16 v[40:43], v[120:123], a[168:171], v[40:43]
    ds_read_b64_tr_b16 v[80:81], v246 offset:12288
    ds_read_b64_tr_b16 v[82:83], v246 offset:28672
    v_mfma_f32_16x16x32_bf16 v[44:47], v[120:123], a[172:175], v[44:47]
    buffer_load_dwordx4 a[0:3], v202, s[12:15], s28 offen offset:0 sc1
    v_mfma_f32_16x16x32_bf16 v[48:51], v[124:127], a[168:171], v[48:51]
    ds_read_b64_tr_b16 v[84:85], v247 offset:12288
    ds_read_b64_tr_b16 v[86:87], v247 offset:28672
    v_mfma_f32_16x16x32_bf16 v[52:55], v[124:127], a[172:175], v[52:55]
    s_waitcnt lgkmcnt(8)
    v_mfma_f32_16x16x32_bf16 v[56:59], v[128:131], a[168:171], v[56:59]
    ds_read_b64_tr_b16 v[88:89], v248 offset:12288
    ds_read_b64_tr_b16 v[90:91], v248 offset:28672
    v_mfma_f32_16x16x32_bf16 v[60:63], v[128:131], a[172:175], v[60:63]
    buffer_load_dwordx4 a[4:7], v203, s[12:15], s28 offen offset:0 sc1
    v_mfma_f32_16x16x32_bf16 v[64:67], v[132:135], a[168:171], v[64:67]
    ds_read_b64_tr_b16 v[92:93], v249 offset:12288
    ds_read_b64_tr_b16 v[94:95], v249 offset:28672
    v_mfma_f32_16x16x32_bf16 v[68:71], v[132:135], a[172:175], v[68:71]
    s_waitcnt lgkmcnt(8)
    v_mfma_f32_16x16x32_bf16 v[8:11], v[72:75], a[176:179], v[8:11]
    ds_read_b64_tr_b16 v[96:97], v250 offset:12288
    ds_read_b64_tr_b16 v[98:99], v250 offset:28672
    v_mfma_f32_16x16x32_bf16 v[12:15], v[72:75], a[180:183], v[12:15]
    buffer_load_dwordx4 a[8:11], v204, s[12:15], s28 offen offset:0 sc1
    v_mfma_f32_16x16x32_bf16 v[16:19], v[76:79], a[176:179], v[16:19]
    ds_read_b64_tr_b16 v[100:101], v251 offset:12288
    ds_read_b64_tr_b16 v[102:103], v251 offset:28672
    v_mfma_f32_16x16x32_bf16 v[20:23], v[76:79], a[180:183], v[20:23]
    s_waitcnt lgkmcnt(8)
    v_mfma_f32_16x16x32_bf16 v[24:27], v[80:83], a[176:179], v[24:27]
    ds_read_b64_tr_b16 v[104:105], v244 offset:45056
    ds_read_b64_tr_b16 v[106:107], v244 offset:61440
    v_mfma_f32_16x16x32_bf16 v[28:31], v[80:83], a[180:183], v[28:31]
    buffer_load_dwordx4 a[12:15], v205, s[12:15], s28 offen offset:0 sc1
    v_xor_b32 v244, 0x10000, v244
    v_mfma_f32_16x16x32_bf16 v[32:35], v[84:87], a[176:179], v[32:35]
    ds_read_b64_tr_b16 v[108:109], v245 offset:45056
    ds_read_b64_tr_b16 v[110:111], v245 offset:61440
    v_mfma_f32_16x16x32_bf16 v[36:39], v[84:87], a[180:183], v[36:39]
    s_waitcnt lgkmcnt(8)
    v_xor_b32 v245, 0x10000, v245
    v_mfma_f32_16x16x32_bf16 v[40:43], v[88:91], a[176:179], v[40:43]
    ds_read_b64_tr_b16 v[112:113], v246 offset:45056
    ds_read_b64_tr_b16 v[114:115], v246 offset:61440
    v_mfma_f32_16x16x32_bf16 v[44:47], v[88:91], a[180:183], v[44:47]
    buffer_load_dwordx4 a[16:19], v202, s[12:15], s28 offen offset:1024 sc1
    v_xor_b32 v246, 0x10000, v246
    v_mfma_f32_16x16x32_bf16 v[48:51], v[92:95], a[176:179], v[48:51]
    ds_read_b64_tr_b16 v[116:117], v247 offset:45056
    ds_read_b64_tr_b16 v[118:119], v247 offset:61440
    v_mfma_f32_16x16x32_bf16 v[52:55], v[92:95], a[180:183], v[52:55]
    s_waitcnt lgkmcnt(8)
    v_xor_b32 v247, 0x10000, v247
    v_mfma_f32_16x16x32_bf16 v[56:59], v[96:99], a[176:179], v[56:59]
    ds_read_b64_tr_b16 v[120:121], v248 offset:45056
    ds_read_b64_tr_b16 v[122:123], v248 offset:61440
    v_mfma_f32_16x16x32_bf16 v[60:63], v[96:99], a[180:183], v[60:63]
    buffer_load_dwordx4 a[20:23], v203, s[12:15], s28 offen offset:1024 sc1
    v_xor_b32 v248, 0x10000, v248
    v_mfma_f32_16x16x32_bf16 v[64:67], v[100:103], a[176:179], v[64:67]
    ds_read_b64_tr_b16 v[124:125], v249 offset:45056
    ds_read_b64_tr_b16 v[126:127], v249 offset:61440
    v_mfma_f32_16x16x32_bf16 v[68:71], v[100:103], a[180:183], v[68:71]
    s_waitcnt lgkmcnt(8)
    v_xor_b32 v249, 0x10000, v249
    v_mfma_f32_16x16x32_bf16 v[8:11], v[104:107], a[184:187], v[8:11]
    ds_read_b64_tr_b16 v[128:129], v250 offset:45056
    ds_read_b64_tr_b16 v[130:131], v250 offset:61440
    v_mfma_f32_16x16x32_bf16 v[12:15], v[104:107], a[188:191], v[12:15]
    buffer_load_dwordx4 a[24:27], v204, s[12:15], s28 offen offset:1024 sc1
    v_xor_b32 v250, 0x10000, v250
    v_mfma_f32_16x16x32_bf16 v[16:19], v[108:111], a[184:187], v[16:19]
    ds_read_b64_tr_b16 v[132:133], v251 offset:45056
    ds_read_b64_tr_b16 v[134:135], v251 offset:61440
    v_mfma_f32_16x16x32_bf16 v[20:23], v[108:111], a[188:191], v[20:23]
    s_waitcnt lgkmcnt(8)
    v_xor_b32 v251, 0x10000, v251
    v_mfma_f32_16x16x32_bf16 v[24:27], v[112:115], a[184:187], v[24:27]
    s_waitcnt vmcnt(7)
    s_barrier
    ds_read_b64_tr_b16 v[72:73], v246 offset:0
    ds_read_b64_tr_b16 v[74:75], v246 offset:16384
    v_mfma_f32_16x16x32_bf16 v[28:31], v[112:115], a[188:191], v[28:31]
    buffer_load_dwordx4 a[28:31], v205, s[12:15], s28 offen offset:1024 sc1
    v_mfma_f32_16x16x32_bf16 v[32:35], v[116:119], a[184:187], v[32:35]
    s_add_u32 s28, s49, 2048
    ds_read_b64_tr_b16 v[76:77], v247 offset:0
    ds_read_b64_tr_b16 v[78:79], v247 offset:16384
    v_mfma_f32_16x16x32_bf16 v[36:39], v[116:119], a[188:191], v[36:39]
    s_waitcnt lgkmcnt(8)
    v_mfma_f32_16x16x32_bf16 v[40:43], v[120:123], a[184:187], v[40:43]
    ds_read_b64_tr_b16 v[80:81], v248 offset:0
    ds_read_b64_tr_b16 v[82:83], v248 offset:16384
    v_mfma_f32_16x16x32_bf16 v[44:47], v[120:123], a[188:191], v[44:47]
    buffer_load_dwordx4 a[32:35], v202, s[12:15], s28 offen offset:0 sc1
    v_mfma_f32_16x16x32_bf16 v[48:51], v[124:127], a[184:187], v[48:51]
    ds_read_b64_tr_b16 v[84:85], v249 offset:0
    ds_read_b64_tr_b16 v[86:87], v249 offset:16384
    v_mfma_f32_16x16x32_bf16 v[52:55], v[124:127], a[188:191], v[52:55]
    s_waitcnt lgkmcnt(8)
    v_mfma_f32_16x16x32_bf16 v[56:59], v[128:131], a[184:187], v[56:59]
    ds_read_b64_tr_b16 v[88:89], v250 offset:0
    ds_read_b64_tr_b16 v[90:91], v250 offset:16384
    v_mfma_f32_16x16x32_bf16 v[60:63], v[128:131], a[188:191], v[60:63]
    buffer_load_dwordx4 a[36:39], v203, s[12:15], s28 offen offset:0 sc1
    v_mfma_f32_16x16x32_bf16 v[64:67], v[132:135], a[184:187], v[64:67]
    ds_read_b64_tr_b16 v[92:93], v251 offset:0
    ds_read_b64_tr_b16 v[94:95], v251 offset:16384
    v_mfma_f32_16x16x32_bf16 v[68:71], v[132:135], a[188:191], v[68:71]
    s_waitcnt lgkmcnt(8)
    v_mfma_f32_16x16x32_bf16 v[24:27], v[72:75], a[192:195], v[24:27]
    ds_read_b64_tr_b16 v[96:97], v246 offset:32768
    ds_read_b64_tr_b16 v[98:99], v246 offset:49152
    v_mfma_f32_16x16x32_bf16 v[28:31], v[72:75], a[196:199], v[28:31]
    buffer_load_dwordx4 a[40:43], v204, s[12:15], s28 offen offset:0 sc1
    v_mfma_f32_16x16x32_bf16 v[32:35], v[76:79], a[192:195], v[32:35]
    ds_read_b64_tr_b16 v[100:101], v247 offset:32768
    ds_read_b64_tr_b16 v[102:103], v247 offset:49152
    v_mfma_f32_16x16x32_bf16 v[36:39], v[76:79], a[196:199], v[36:39]
    s_waitcnt lgkmcnt(8)
    v_mfma_f32_16x16x32_bf16 v[40:43], v[80:83], a[192:195], v[40:43]
    ds_read_b64_tr_b16 v[104:105], v248 offset:32768
    ds_read_b64_tr_b16 v[106:107], v248 offset:49152
    v_mfma_f32_16x16x32_bf16 v[44:47], v[80:83], a[196:199], v[44:47]
    s_barrier
    buffer_load_dwordx4 a[44:47], v205, s[12:15], s28 offen offset:0 sc1
    v_mfma_f32_16x16x32_bf16 v[48:51], v[84:87], a[192:195], v[48:51]
    ds_read_b64_tr_b16 v[108:109], v249 offset:32768
    ds_read_b64_tr_b16 v[110:111], v249 offset:49152
    v_mfma_f32_16x16x32_bf16 v[52:55], v[84:87], a[196:199], v[52:55]
    s_waitcnt lgkmcnt(8)
    v_mfma_f32_16x16x32_bf16 v[56:59], v[88:91], a[192:195], v[56:59]
    ds_read_b64_tr_b16 v[112:113], v250 offset:32768
    ds_read_b64_tr_b16 v[114:115], v250 offset:49152
    v_mfma_f32_16x16x32_bf16 v[60:63], v[88:91], a[196:199], v[60:63]
    buffer_load_dwordx4 a[48:51], v202, s[12:15], s28 offen offset:1024 sc1
    v_mfma_f32_16x16x32_bf16 v[64:67], v[92:95], a[192:195], v[64:67]
    ds_read_b64_tr_b16 v[116:117], v251 offset:32768
    ds_read_b64_tr_b16 v[118:119], v251 offset:49152
    v_mfma_f32_16x16x32_bf16 v[68:71], v[92:95], a[196:199], v[68:71]
    s_waitcnt lgkmcnt(8)
    v_mfma_f32_16x16x32_bf16 v[24:27], v[96:99], a[200:203], v[24:27]
    ds_read_b64_tr_b16 v[120:121], v246 offset:4096
    ds_read_b64_tr_b16 v[122:123], v246 offset:20480
    v_mfma_f32_16x16x32_bf16 v[28:31], v[96:99], a[204:207], v[28:31]
    buffer_load_dwordx4 a[52:55], v203, s[12:15], s28 offen offset:1024 sc1
    v_mfma_f32_16x16x32_bf16 v[32:35], v[100:103], a[200:203], v[32:35]
    ds_read_b64_tr_b16 v[124:125], v247 offset:4096
    ds_read_b64_tr_b16 v[126:127], v247 offset:20480
    v_mfma_f32_16x16x32_bf16 v[36:39], v[100:103], a[204:207], v[36:39]
    s_waitcnt lgkmcnt(8)
    v_mfma_f32_16x16x32_bf16 v[40:43], v[104:107], a[200:203], v[40:43]
    ds_read_b64_tr_b16 v[128:129], v248 offset:4096
    ds_read_b64_tr_b16 v[130:131], v248 offset:20480
    v_mfma_f32_16x16x32_bf16 v[44:47], v[104:107], a[204:207], v[44:47]
    buffer_load_dwordx4 a[56:59], v204, s[12:15], s28 offen offset:1024 sc1
    v_mfma_f32_16x16x32_bf16 v[48:51], v[108:111], a[200:203], v[48:51]
    ds_read_b64_tr_b16 v[132:133], v249 offset:4096
    ds_read_b64_tr_b16 v[134:135], v249 offset:20480
    v_mfma_f32_16x16x32_bf16 v[52:55], v[108:111], a[204:207], v[52:55]
    s_waitcnt lgkmcnt(8)
    v_mfma_f32_16x16x32_bf16 v[56:59], v[112:115], a[200:203], v[56:59]
    ds_read_b64_tr_b16 v[72:73], v250 offset:4096
    ds_read_b64_tr_b16 v[74:75], v250 offset:20480
    v_mfma_f32_16x16x32_bf16 v[60:63], v[112:115], a[204:207], v[60:63]
    buffer_load_dwordx4 a[60:63], v205, s[12:15], s28 offen offset:1024 sc1
    v_mfma_f32_16x16x32_bf16 v[64:67], v[116:119], a[200:203], v[64:67]
    s_add_u32 m0, s48, 65536
    ds_read_b64_tr_b16 v[76:77], v251 offset:4096
    ds_read_b64_tr_b16 v[78:79], v251 offset:20480
    v_mfma_f32_16x16x32_bf16 v[68:71], v[116:119], a[204:207], v[68:71]
    s_waitcnt lgkmcnt(8)
    s_add_u32 s53, s50, 0
    v_mfma_f32_16x16x32_bf16 v[24:27], v[120:123], a[208:211], v[24:27]
    ds_read_b64_tr_b16 v[80:81], v246 offset:36864
    ds_read_b64_tr_b16 v[82:83], v246 offset:53248
    v_mfma_f32_16x16x32_bf16 v[28:31], v[120:123], a[212:215], v[28:31]
    buffer_load_dwordx4 v152, s[16:19], s53 offen offset:0 lds
    v_mfma_f32_16x16x32_bf16 v[32:35], v[124:127], a[208:211], v[32:35]
    ds_read_b64_tr_b16 v[84:85], v247 offset:36864
    ds_read_b64_tr_b16 v[86:87], v247 offset:53248
    v_mfma_f32_16x16x32_bf16 v[36:39], v[124:127], a[212:215], v[36:39]
    s_waitcnt lgkmcnt(8)
    v_mfma_f32_16x16x32_bf16 v[40:43], v[128:131], a[208:211], v[40:43]
    ds_read_b64_tr_b16 v[88:89], v248 offset:36864
    ds_read_b64_tr_b16 v[90:91], v248 offset:53248
    v_mfma_f32_16x16x32_bf16 v[44:47], v[128:131], a[212:215], v[44:47]
    buffer_load_dwordx4 v153, s[16:19], s53 offen offset:1024 lds
    v_mfma_f32_16x16x32_bf16 v[48:51], v[132:135], a[208:211], v[48:51]
    ds_read_b64_tr_b16 v[92:93], v249 offset:36864
    ds_read_b64_tr_b16 v[94:95], v249 offset:53248
    v_mfma_f32_16x16x32_bf16 v[52:55], v[132:135], a[212:215], v[52:55]
    s_waitcnt lgkmcnt(8)
    v_mfma_f32_16x16x32_bf16 v[56:59], v[72:75], a[208:211], v[56:59]
    ds_read_b64_tr_b16 v[96:97], v250 offset:36864
    ds_read_b64_tr_b16 v[98:99], v250 offset:53248
    v_mfma_f32_16x16x32_bf16 v[60:63], v[72:75], a[212:215], v[60:63]
    buffer_load_dwordx4 v154, s[16:19], s53 offen offset:2048 lds
    v_mfma_f32_16x16x32_bf16 v[64:67], v[76:79], a[208:211], v[64:67]
    ds_read_b64_tr_b16 v[100:101], v251 offset:36864
    ds_read_b64_tr_b16 v[102:103], v251 offset:53248
    v_mfma_f32_16x16x32_bf16 v[68:71], v[76:79], a[212:215], v[68:71]
    s_waitcnt lgkmcnt(8)
    v_mfma_f32_16x16x32_bf16 v[24:27], v[80:83], a[216:219], v[24:27]
    ds_read_b64_tr_b16 v[104:105], v246 offset:8192
    ds_read_b64_tr_b16 v[106:107], v246 offset:24576
    v_mfma_f32_16x16x32_bf16 v[28:31], v[80:83], a[220:223], v[28:31]
    buffer_load_dwordx4 v155, s[16:19], s53 offen offset:3072 lds
    v_mfma_f32_16x16x32_bf16 v[32:35], v[84:87], a[216:219], v[32:35]
    s_add_u32 m0, s48, 69632
    ds_read_b64_tr_b16 v[108:109], v247 offset:8192
    ds_read_b64_tr_b16 v[110:111], v247 offset:24576
    v_mfma_f32_16x16x32_bf16 v[36:39], v[84:87], a[220:223], v[36:39]
    s_waitcnt lgkmcnt(8)
    s_add_u32 s53, s50, 32768
    v_mfma_f32_16x16x32_bf16 v[40:43], v[88:91], a[216:219], v[40:43]
    ds_read_b64_tr_b16 v[112:113], v248 offset:8192
    ds_read_b64_tr_b16 v[114:115], v248 offset:24576
    v_mfma_f32_16x16x32_bf16 v[44:47], v[88:91], a[220:223], v[44:47]
    buffer_load_dwordx4 v152, s[16:19], s53 offen offset:0 lds
    v_mfma_f32_16x16x32_bf16 v[48:51], v[92:95], a[216:219], v[48:51]
    ds_read_b64_tr_b16 v[116:117], v249 offset:8192
    ds_read_b64_tr_b16 v[118:119], v249 offset:24576
    v_mfma_f32_16x16x32_bf16 v[52:55], v[92:95], a[220:223], v[52:55]
    s_waitcnt lgkmcnt(8)
    v_mfma_f32_16x16x32_bf16 v[56:59], v[96:99], a[216:219], v[56:59]
    ds_read_b64_tr_b16 v[120:121], v250 offset:8192
    ds_read_b64_tr_b16 v[122:123], v250 offset:24576
    v_mfma_f32_16x16x32_bf16 v[60:63], v[96:99], a[220:223], v[60:63]
    buffer_load_dwordx4 v153, s[16:19], s53 offen offset:1024 lds
    v_mfma_f32_16x16x32_bf16 v[64:67], v[100:103], a[216:219], v[64:67]
    ds_read_b64_tr_b16 v[124:125], v251 offset:8192
    ds_read_b64_tr_b16 v[126:127], v251 offset:24576
    v_mfma_f32_16x16x32_bf16 v[68:71], v[100:103], a[220:223], v[68:71]
    s_waitcnt lgkmcnt(8)
    v_mfma_f32_16x16x32_bf16 v[24:27], v[104:107], a[224:227], v[24:27]
    ds_read_b64_tr_b16 v[128:129], v246 offset:40960
    ds_read_b64_tr_b16 v[130:131], v246 offset:57344
    v_mfma_f32_16x16x32_bf16 v[28:31], v[104:107], a[228:231], v[28:31]
    buffer_load_dwordx4 v154, s[16:19], s53 offen offset:2048 lds
    v_mfma_f32_16x16x32_bf16 v[32:35], v[108:111], a[224:227], v[32:35]
    ds_read_b64_tr_b16 v[132:133], v247 offset:40960
    ds_read_b64_tr_b16 v[134:135], v247 offset:57344
    v_mfma_f32_16x16x32_bf16 v[36:39], v[108:111], a[228:231], v[36:39]
    s_waitcnt lgkmcnt(8)
    v_mfma_f32_16x16x32_bf16 v[40:43], v[112:115], a[224:227], v[40:43]
    ds_read_b64_tr_b16 v[72:73], v248 offset:40960
    ds_read_b64_tr_b16 v[74:75], v248 offset:57344
    v_mfma_f32_16x16x32_bf16 v[44:47], v[112:115], a[228:231], v[44:47]
    buffer_load_dwordx4 v155, s[16:19], s53 offen offset:3072 lds
    v_mfma_f32_16x16x32_bf16 v[48:51], v[116:119], a[224:227], v[48:51]
    s_add_u32 m0, s48, 73728
    ds_read_b64_tr_b16 v[76:77], v249 offset:40960
    ds_read_b64_tr_b16 v[78:79], v249 offset:57344
    v_mfma_f32_16x16x32_bf16 v[52:55], v[116:119], a[228:231], v[52:55]
    s_waitcnt lgkmcnt(8)
    s_add_u32 s53, s50, 65536
    v_mfma_f32_16x16x32_bf16 v[56:59], v[120:123], a[224:227], v[56:59]
    ds_read_b64_tr_b16 v[80:81], v250 offset:40960
    ds_read_b64_tr_b16 v[82:83], v250 offset:57344
    v_mfma_f32_16x16x32_bf16 v[60:63], v[120:123], a[228:231], v[60:63]
    buffer_load_dwordx4 v152, s[16:19], s53 offen offset:0 lds
    v_mfma_f32_16x16x32_bf16 v[64:67], v[124:127], a[224:227], v[64:67]
    ds_read_b64_tr_b16 v[84:85], v251 offset:40960
    ds_read_b64_tr_b16 v[86:87], v251 offset:57344
    v_mfma_f32_16x16x32_bf16 v[68:71], v[124:127], a[228:231], v[68:71]
    s_waitcnt lgkmcnt(8)
    v_mfma_f32_16x16x32_bf16 v[24:27], v[128:131], a[232:235], v[24:27]
    ds_read_b64_tr_b16 v[88:89], v246 offset:12288
    ds_read_b64_tr_b16 v[90:91], v246 offset:28672
    v_mfma_f32_16x16x32_bf16 v[28:31], v[128:131], a[236:239], v[28:31]
    buffer_load_dwordx4 v153, s[16:19], s53 offen offset:1024 lds
    v_mfma_f32_16x16x32_bf16 v[32:35], v[132:135], a[232:235], v[32:35]
    ds_read_b64_tr_b16 v[92:93], v247 offset:12288
    ds_read_b64_tr_b16 v[94:95], v247 offset:28672
    v_mfma_f32_16x16x32_bf16 v[36:39], v[132:135], a[236:239], v[36:39]
    s_waitcnt lgkmcnt(8)
    v_mfma_f32_16x16x32_bf16 v[40:43], v[72:75], a[232:235], v[40:43]
    ds_read_b64_tr_b16 v[96:97], v248 offset:12288
    ds_read_b64_tr_b16 v[98:99], v248 offset:28672
    v_mfma_f32_16x16x32_bf16 v[44:47], v[72:75], a[236:239], v[44:47]
    buffer_load_dwordx4 v154, s[16:19], s53 offen offset:2048 lds
    v_mfma_f32_16x16x32_bf16 v[48:51], v[76:79], a[232:235], v[48:51]
    ds_read_b64_tr_b16 v[100:101], v249 offset:12288
    ds_read_b64_tr_b16 v[102:103], v249 offset:28672
    v_mfma_f32_16x16x32_bf16 v[52:55], v[76:79], a[236:239], v[52:55]
    s_waitcnt lgkmcnt(8)
    v_mfma_f32_16x16x32_bf16 v[56:59], v[80:83], a[232:235], v[56:59]
    ds_read_b64_tr_b16 v[104:105], v250 offset:12288
    ds_read_b64_tr_b16 v[106:107], v250 offset:28672
    v_mfma_f32_16x16x32_bf16 v[60:63], v[80:83], a[236:239], v[60:63]
    buffer_load_dwordx4 v155, s[16:19], s53 offen offset:3072 lds
    v_mfma_f32_16x16x32_bf16 v[64:67], v[84:87], a[232:235], v[64:67]
    s_add_u32 m0, s48, 77824
    ds_read_b64_tr_b16 v[108:109], v251 offset:12288
    ds_read_b64_tr_b16 v[110:111], v251 offset:28672
    v_mfma_f32_16x16x32_bf16 v[68:71], v[84:87], a[236:239], v[68:71]
    s_waitcnt lgkmcnt(8)
    s_add_u32 s53, s50, 98304
    v_mfma_f32_16x16x32_bf16 v[24:27], v[88:91], a[240:243], v[24:27]
    ds_read_b64_tr_b16 v[112:113], v246 offset:45056
    ds_read_b64_tr_b16 v[114:115], v246 offset:61440
    v_mfma_f32_16x16x32_bf16 v[28:31], v[88:91], a[244:247], v[28:31]
    buffer_load_dwordx4 v152, s[16:19], s53 offen offset:0 lds
    v_mfma_f32_16x16x32_bf16 v[32:35], v[92:95], a[240:243], v[32:35]
    ds_read_b64_tr_b16 v[116:117], v247 offset:45056
    ds_read_b64_tr_b16 v[118:119], v247 offset:61440
    v_mfma_f32_16x16x32_bf16 v[36:39], v[92:95], a[244:247], v[36:39]
    s_waitcnt lgkmcnt(8)
    v_mfma_f32_16x16x32_bf16 v[40:43], v[96:99], a[240:243], v[40:43]
    ds_read_b64_tr_b16 v[120:121], v248 offset:45056
    ds_read_b64_tr_b16 v[122:123], v248 offset:61440
    v_mfma_f32_16x16x32_bf16 v[44:47], v[96:99], a[244:247], v[44:47]
    buffer_load_dwordx4 v153, s[16:19], s53 offen offset:1024 lds
    v_mfma_f32_16x16x32_bf16 v[48:51], v[100:103], a[240:243], v[48:51]
    ds_read_b64_tr_b16 v[124:125], v249 offset:45056
    ds_read_b64_tr_b16 v[126:127], v249 offset:61440
    v_mfma_f32_16x16x32_bf16 v[52:55], v[100:103], a[244:247], v[52:55]
    s_waitcnt lgkmcnt(8)
    v_mfma_f32_16x16x32_bf16 v[56:59], v[104:107], a[240:243], v[56:59]
    ds_read_b64_tr_b16 v[128:129], v250 offset:45056
    ds_read_b64_tr_b16 v[130:131], v250 offset:61440
    v_mfma_f32_16x16x32_bf16 v[60:63], v[104:107], a[244:247], v[60:63]
    buffer_load_dwordx4 v154, s[16:19], s53 offen offset:2048 lds
    v_mfma_f32_16x16x32_bf16 v[64:67], v[108:111], a[240:243], v[64:67]
    ds_read_b64_tr_b16 v[132:133], v251 offset:45056
    ds_read_b64_tr_b16 v[134:135], v251 offset:61440
    v_mfma_f32_16x16x32_bf16 v[68:71], v[108:111], a[244:247], v[68:71]
    s_waitcnt lgkmcnt(8)
    v_mfma_f32_16x16x32_bf16 v[24:27], v[112:115], a[248:251], v[24:27]
    ds_read_b64_tr_b16 v[72:73], v244 offset:0
    ds_read_b64_tr_b16 v[74:75], v244 offset:16384
    v_mfma_f32_16x16x32_bf16 v[28:31], v[112:115], a[252:255], v[28:31]
    buffer_load_dwordx4 v155, s[16:19], s53 offen offset:3072 lds
    v_mfma_f32_16x16x32_bf16 v[32:35], v[116:119], a[248:251], v[32:35]
    ds_read_b64_tr_b16 v[76:77], v245 offset:0
    ds_read_b64_tr_b16 v[78:79], v245 offset:16384
    v_mfma_f32_16x16x32_bf16 v[36:39], v[116:119], a[252:255], v[36:39]
    s_waitcnt lgkmcnt(8)
    v_mfma_f32_16x16x32_bf16 v[40:43], v[120:123], a[248:251], v[40:43]
    ds_read_b64_tr_b16 v[80:81], v244 offset:32768
    ds_read_b64_tr_b16 v[82:83], v244 offset:49152
    v_mfma_f32_16x16x32_bf16 v[44:47], v[120:123], a[252:255], v[44:47]
    v_mfma_f32_16x16x32_bf16 v[48:51], v[124:127], a[248:251], v[48:51]
    ds_read_b64_tr_b16 v[84:85], v245 offset:32768
    ds_read_b64_tr_b16 v[86:87], v245 offset:49152
    v_mfma_f32_16x16x32_bf16 v[52:55], v[124:127], a[252:255], v[52:55]
    s_waitcnt lgkmcnt(8)
    v_mfma_f32_16x16x32_bf16 v[56:59], v[128:131], a[248:251], v[56:59]
    ds_read_b64_tr_b16 v[88:89], v244 offset:4096
    ds_read_b64_tr_b16 v[90:91], v244 offset:20480
    v_mfma_f32_16x16x32_bf16 v[60:63], v[128:131], a[252:255], v[60:63]
    v_mfma_f32_16x16x32_bf16 v[64:67], v[132:135], a[248:251], v[64:67]
    ds_read_b64_tr_b16 v[92:93], v245 offset:4096
    ds_read_b64_tr_b16 v[94:95], v245 offset:20480
    v_mfma_f32_16x16x32_bf16 v[68:71], v[132:135], a[252:255], v[68:71]
    s_waitcnt lgkmcnt(8)
    s_xor_b32 s55, s41, 1
    s_mul_i32 s55, s55, 49152
    s_add_u32 s55, s55, s29
    s_add_u32 s55, s55, 0
    v_cvt_pk_bf16_f32 v24, v24, v25
    v_cvt_pk_bf16_f32 v25, v26, v27
    v_cvt_pk_bf16_f32 v26, v28, v29
    v_cvt_pk_bf16_f32 v27, v30, v31
    v_cvt_pk_bf16_f32 v28, v32, v33
    v_cvt_pk_bf16_f32 v29, v34, v35
    v_cvt_pk_bf16_f32 v30, v36, v37
    v_cvt_pk_bf16_f32 v31, v38, v39
    buffer_store_dwordx4 v[24:27], v200, s[12:15], s55 offen offset:0 sc1
    buffer_store_dwordx4 v[28:31], v200, s[12:15], s55 offen offset:1024 sc1
    s_xor_b32 s55, s41, 2
    s_mul_i32 s55, s55, 49152
    s_add_u32 s55, s55, s29
    s_add_u32 s55, s55, 16384
    v_cvt_pk_bf16_f32 v40, v40, v41
    v_cvt_pk_bf16_f32 v41, v42, v43
    v_cvt_pk_bf16_f32 v42, v44, v45
    v_cvt_pk_bf16_f32 v43, v46, v47
    v_cvt_pk_bf16_f32 v44, v48, v49
    v_cvt_pk_bf16_f32 v45, v50, v51
    v_cvt_pk_bf16_f32 v46, v52, v53
    v_cvt_pk_bf16_f32 v47, v54, v55
    buffer_store_dwordx4 v[40:43], v200, s[12:15], s55 offen offset:0 sc1
    buffer_store_dwordx4 v[44:47], v200, s[12:15], s55 offen offset:1024 sc1
    s_xor_b32 s55, s41, 3
    s_mul_i32 s55, s55, 49152
    s_add_u32 s55, s55, s29
    s_add_u32 s55, s55, 32768
    v_cvt_pk_bf16_f32 v56, v56, v57
    v_cvt_pk_bf16_f32 v57, v58, v59
    v_cvt_pk_bf16_f32 v58, v60, v61
    v_cvt_pk_bf16_f32 v59, v62, v63
    v_cvt_pk_bf16_f32 v60, v64, v65
    v_cvt_pk_bf16_f32 v61, v66, v67
    v_cvt_pk_bf16_f32 v62, v68, v69
    v_cvt_pk_bf16_f32 v63, v70, v71
    buffer_store_dwordx4 v[56:59], v200, s[12:15], s55 offen offset:0 sc1
    buffer_store_dwordx4 v[60:63], v200, s[12:15], s55 offen offset:1024 sc1
    v_mfma_f32_16x16x32_bf16 v[8:11], v[72:75], a[192:195], v[8:11]
    ds_read_b64_tr_b16 v[96:97], v244 offset:36864
    ds_read_b64_tr_b16 v[98:99], v244 offset:53248
    v_mfma_f32_16x16x32_bf16 v[12:15], v[72:75], a[196:199], v[12:15]
    v_mfma_f32_16x16x32_bf16 v[16:19], v[76:79], a[192:195], v[16:19]
    ds_read_b64_tr_b16 v[100:101], v245 offset:36864
    ds_read_b64_tr_b16 v[102:103], v245 offset:53248
    v_mfma_f32_16x16x32_bf16 v[20:23], v[76:79], a[196:199], v[20:23]
    s_waitcnt lgkmcnt(8)
    v_mfma_f32_16x16x32_bf16 v[8:11], v[80:83], a[200:203], v[8:11]
    ds_read_b64_tr_b16 v[104:105], v244 offset:8192
    ds_read_b64_tr_b16 v[106:107], v244 offset:24576
    v_mfma_f32_16x16x32_bf16 v[12:15], v[80:83], a[204:207], v[12:15]
    v_mfma_f32_16x16x32_bf16 v[16:19], v[84:87], a[200:203], v[16:19]
    ds_read_b64_tr_b16 v[108:109], v245 offset:8192
    ds_read_b64_tr_b16 v[110:111], v245 offset:24576
    v_mfma_f32_16x16x32_bf16 v[20:23], v[84:87], a[204:207], v[20:23]
    s_waitcnt lgkmcnt(8)
    v_mfma_f32_16x16x32_bf16 v[8:11], v[88:91], a[208:211], v[8:11]
    ds_read_b64_tr_b16 v[112:113], v244 offset:40960
    ds_read_b64_tr_b16 v[114:115], v244 offset:57344
    v_mfma_f32_16x16x32_bf16 v[12:15], v[88:91], a[212:215], v[12:15]
    v_mfma_f32_16x16x32_bf16 v[16:19], v[92:95], a[208:211], v[16:19]
    ds_read_b64_tr_b16 v[116:117], v245 offset:40960
    ds_read_b64_tr_b16 v[118:119], v245 offset:57344
    v_mfma_f32_16x16x32_bf16 v[20:23], v[92:95], a[212:215], v[20:23]
    s_waitcnt lgkmcnt(8)
    v_mfma_f32_16x16x32_bf16 v[8:11], v[96:99], a[216:219], v[8:11]
    ds_read_b64_tr_b16 v[120:121], v244 offset:12288
    ds_read_b64_tr_b16 v[122:123], v244 offset:28672
    v_mfma_f32_16x16x32_bf16 v[12:15], v[96:99], a[220:223], v[12:15]
    v_mfma_f32_16x16x32_bf16 v[16:19], v[100:103], a[216:219], v[16:19]
    ds_read_b64_tr_b16 v[124:125], v245 offset:12288
    ds_read_b64_tr_b16 v[126:127], v245 offset:28672
    v_mfma_f32_16x16x32_bf16 v[20:23], v[100:103], a[220:223], v[20:23]
    s_waitcnt lgkmcnt(8)
    v_mfma_f32_16x16x32_bf16 v[8:11], v[104:107], a[224:227], v[8:11]
    ds_read_b64_tr_b16 v[128:129], v244 offset:45056
    ds_read_b64_tr_b16 v[130:131], v244 offset:61440
    v_mfma_f32_16x16x32_bf16 v[12:15], v[104:107], a[228:231], v[12:15]
    v_mfma_f32_16x16x32_bf16 v[16:19], v[108:111], a[224:227], v[16:19]
    ds_read_b64_tr_b16 v[132:133], v245 offset:45056
    ds_read_b64_tr_b16 v[134:135], v245 offset:61440
    v_mfma_f32_16x16x32_bf16 v[20:23], v[108:111], a[228:231], v[20:23]
    s_waitcnt lgkmcnt(8)
    v_mfma_f32_16x16x32_bf16 v[8:11], v[112:115], a[232:235], v[8:11]
    v_mfma_f32_16x16x32_bf16 v[12:15], v[112:115], a[236:239], v[12:15]
    v_mfma_f32_16x16x32_bf16 v[16:19], v[116:119], a[232:235], v[16:19]
    v_mfma_f32_16x16x32_bf16 v[20:23], v[116:119], a[236:239], v[20:23]
    s_waitcnt lgkmcnt(4)
    v_mfma_f32_16x16x32_bf16 v[8:11], v[120:123], a[240:243], v[8:11]
    v_mfma_f32_16x16x32_bf16 v[12:15], v[120:123], a[244:247], v[12:15]
    v_mfma_f32_16x16x32_bf16 v[16:19], v[124:127], a[240:243], v[16:19]
    v_mfma_f32_16x16x32_bf16 v[20:23], v[124:127], a[244:247], v[20:23]
    s_waitcnt lgkmcnt(0)
    v_mfma_f32_16x16x32_bf16 v[8:11], v[128:131], a[248:251], v[8:11]
    v_mfma_f32_16x16x32_bf16 v[12:15], v[128:131], a[252:255], v[12:15]
    v_mfma_f32_16x16x32_bf16 v[16:19], v[132:135], a[248:251], v[16:19]
    v_mfma_f32_16x16x32_bf16 v[20:23], v[132:135], a[252:255], v[20:23]
    s_waitcnt vmcnt(6)
    ds_read_b64_tr_b16 v[72:73], v206 offset:0
    ds_read_b64_tr_b16 v[74:75], v206 offset:1024
    ds_read_b64_tr_b16 v[76:77], v207 offset:0
    ds_read_b64_tr_b16 v[78:79], v207 offset:1024
    ds_read_b64_tr_b16 v[80:81], v208 offset:0
    ds_read_b64_tr_b16 v[82:83], v208 offset:1024
    ds_read_b64_tr_b16 v[84:85], v209 offset:0
    ds_read_b64_tr_b16 v[86:87], v209 offset:1024
    s_waitcnt lgkmcnt(4)
    v_mfma_f32_16x16x32_bf16 v[136:139], v[72:75], a[0:3], 0
    ds_read_b64_tr_b16 v[88:89], v206 offset:4096
    v_lshrrev_b32 v217, 3, v0
    v_mfma_f32_16x16x32_bf16 v[140:143], v[72:75], a[4:7], 0
    v_and_b32 v218, 7, v0
    v_lshlrev_b32 v219, 1, v218
    v_mfma_f32_16x16x32_bf16 v[144:147], v[72:75], a[8:11], 0
    ds_read_b64_tr_b16 v[90:91], v206 offset:5120
    v_xor_b32 v219, v219, v217
    v_mfma_f32_16x16x32_bf16 v[148:151], v[72:75], a[12:15], 0
    s_lshl_b32 s27, s24, 4
    v_add_u32 v217, s27, v217
    v_lshlrev_b32 v202, 11, v217
    v_mfma_f32_16x16x32_bf16 v[152:155], v[76:79], a[0:3], 0
    ds_read_b64_tr_b16 v[92:93], v207 offset:4096
    v_lshl_add_u32 v202, v218, 4, v202
    v_mfma_f32_16x16x32_bf16 v[156:159], v[76:79], a[4:7], 0
    v_add_u32 v203, 0x4000, v202
    v_lshlrev_b32 v217, 8, v217
    v_mfma_f32_16x16x32_bf16 v[160:163], v[76:79], a[8:11], 0
    ds_read_b64_tr_b16 v[94:95], v207 offset:5120
    v_lshl_add_u32 v240, v219, 4, v217
    v_mfma_f32_16x16x32_bf16 v[164:167], v[76:79], a[12:15], 0
    s_waitcnt lgkmcnt(4)
    v_add_u32 v240, 0x10000, v240
    v_xor_b32 v241, 16, v240
    v_mfma_f32_16x16x32_bf16 v[168:171], v[80:83], a[0:3], 0
    ds_read_b64_tr_b16 v[96:97], v208 offset:4096
    v_xor_b32 v242, 0x880, v240
    v_mfma_f32_16x16x32_bf16 v[172:175], v[80:83], a[4:7], 0
    v_xor_b32 v243, 0x890, v240
    v_and_b32 v217, 15, v0
    v_mfma_f32_16x16x32_bf16 v[176:179], v[80:83], a[8:11], 0
    ds_read_b64_tr_b16 v[98:99], v208 offset:5120
    v_lshlrev_b32 v217, 11, v217
    v_mfma_f32_16x16x32_bf16 v[180:183], v[80:83], a[12:15], 0
    v_lshrrev_b32 v218, 4, v0
    v_lshl_add_u32 v204, v218, 3, v217
    v_mfma_f32_16x16x32_bf16 v[184:187], v[84:87], a[0:3], 0
    ds_read_b64_tr_b16 v[100:101], v209 offset:4096
    v_add_u32 v205, 0x8000, v204
    v_mfma_f32_16x16x32_bf16 v[188:191], v[84:87], a[4:7], 0
    s_cmp_eq_u32 s24, 0
    s_cselect_b32 s27, s34, 0x40000000
    v_mfma_f32_16x16x32_bf16 v[192:195], v[84:87], a[8:11], 0
    ds_read_b64_tr_b16 v[102:103], v209 offset:5120
    v_mfma_f32_16x16x32_bf16 v[196:199], v[84:87], a[12:15], 0
    s_waitcnt lgkmcnt(4)
    v_mfma_f32_16x16x32_bf16 v[136:139], v[88:91], a[16:19], v[136:139]
    ds_read_b64_tr_b16 v[104:105], v206 offset:8192
    v_mfma_f32_16x16x32_bf16 v[140:143], v[88:91], a[20:23], v[140:143]
    v_mfma_f32_16x16x32_bf16 v[144:147], v[88:91], a[24:27], v[144:147]
    ds_read_b64_tr_b16 v[106:107], v206 offset:9216
    v_mfma_f32_16x16x32_bf16 v[148:151], v[88:91], a[28:31], v[148:151]
    v_mfma_f32_16x16x32_bf16 v[152:155], v[92:95], a[16:19], v[152:155]
    ds_read_b64_tr_b16 v[108:109], v207 offset:8192
    v_mfma_f32_16x16x32_bf16 v[156:159], v[92:95], a[20:23], v[156:159]
    v_mfma_f32_16x16x32_bf16 v[160:163], v[92:95], a[24:27], v[160:163]
    ds_read_b64_tr_b16 v[110:111], v207 offset:9216
    v_mfma_f32_16x16x32_bf16 v[164:167], v[92:95], a[28:31], v[164:167]
    s_waitcnt lgkmcnt(4)
    v_mfma_f32_16x16x32_bf16 v[168:171], v[96:99], a[16:19], v[168:171]
    ds_read_b64_tr_b16 v[112:113], v208 offset:8192
    v_mfma_f32_16x16x32_bf16 v[172:175], v[96:99], a[20:23], v[172:175]
    v_mfma_f32_16x16x32_bf16 v[176:179], v[96:99], a[24:27], v[176:179]
    ds_read_b64_tr_b16 v[114:115], v208 offset:9216
    v_mfma_f32_16x16x32_bf16 v[180:183], v[96:99], a[28:31], v[180:183]
    v_mfma_f32_16x16x32_bf16 v[184:187], v[100:103], a[16:19], v[184:187]
    ds_read_b64_tr_b16 v[116:117], v209 offset:8192
    v_mfma_f32_16x16x32_bf16 v[188:191], v[100:103], a[20:23], v[188:191]
    v_mfma_f32_16x16x32_bf16 v[192:195], v[100:103], a[24:27], v[192:195]
    ds_read_b64_tr_b16 v[118:119], v209 offset:9216
    v_mfma_f32_16x16x32_bf16 v[196:199], v[100:103], a[28:31], v[196:199]
    s_waitcnt lgkmcnt(4)
    v_mfma_f32_16x16x32_bf16 v[136:139], v[104:107], a[32:35], v[136:139]
    ds_read_b64_tr_b16 v[120:121], v206 offset:12288
    v_mfma_f32_16x16x32_bf16 v[140:143], v[104:107], a[36:39], v[140:143]
    v_mfma_f32_16x16x32_bf16 v[144:147], v[104:107], a[40:43], v[144:147]
    ds_read_b64_tr_b16 v[122:123], v206 offset:13312
    v_mfma_f32_16x16x32_bf16 v[148:151], v[104:107], a[44:47], v[148:151]
    v_mfma_f32_16x16x32_bf16 v[152:155], v[108:111], a[32:35], v[152:155]
    ds_read_b64_tr_b16 v[124:125], v207 offset:12288
    v_mfma_f32_16x16x32_bf16 v[156:159], v[108:111], a[36:39], v[156:159]
    v_mfma_f32_16x16x32_bf16 v[160:163], v[108:111], a[40:43], v[160:163]
    ds_read_b64_tr_b16 v[126:127], v207 offset:13312
    v_mfma_f32_16x16x32_bf16 v[164:167], v[108:111], a[44:47], v[164:167]
    s_waitcnt lgkmcnt(4)
    v_mfma_f32_16x16x32_bf16 v[168:171], v[112:115], a[32:35], v[168:171]
    ds_read_b64_tr_b16 v[128:129], v208 offset:12288
    v_mfma_f32_16x16x32_bf16 v[172:175], v[112:115], a[36:39], v[172:175]
    v_mfma_f32_16x16x32_bf16 v[176:179], v[112:115], a[40:43], v[176:179]
    ds_read_b64_tr_b16 v[130:131], v208 offset:13312
    v_mfma_f32_16x16x32_bf16 v[180:183], v[112:115], a[44:47], v[180:183]
    v_mfma_f32_16x16x32_bf16 v[184:187], v[116:119], a[32:35], v[184:187]
    ds_read_b64_tr_b16 v[132:133], v209 offset:12288
    v_mfma_f32_16x16x32_bf16 v[188:191], v[116:119], a[36:39], v[188:191]
    v_mfma_f32_16x16x32_bf16 v[192:195], v[116:119], a[40:43], v[192:195]
    ds_read_b64_tr_b16 v[134:135], v209 offset:13312
    v_mfma_f32_16x16x32_bf16 v[196:199], v[116:119], a[44:47], v[196:199]
    s_waitcnt lgkmcnt(4)
    v_mfma_f32_16x16x32_bf16 v[136:139], v[120:123], a[48:51], v[136:139]
    v_mfma_f32_16x16x32_bf16 v[140:143], v[120:123], a[52:55], v[140:143]
    v_mfma_f32_16x16x32_bf16 v[144:147], v[120:123], a[56:59], v[144:147]
    v_mfma_f32_16x16x32_bf16 v[148:151], v[120:123], a[60:63], v[148:151]
    v_mfma_f32_16x16x32_bf16 v[152:155], v[124:127], a[48:51], v[152:155]
    v_mfma_f32_16x16x32_bf16 v[156:159], v[124:127], a[52:55], v[156:159]
    v_mfma_f32_16x16x32_bf16 v[160:163], v[124:127], a[56:59], v[160:163]
    v_mfma_f32_16x16x32_bf16 v[164:167], v[124:127], a[60:63], v[164:167]
    s_waitcnt lgkmcnt(0)
    v_mfma_f32_16x16x32_bf16 v[168:171], v[128:131], a[48:51], v[168:171]
    v_mfma_f32_16x16x32_bf16 v[172:175], v[128:131], a[52:55], v[172:175]
    v_mfma_f32_16x16x32_bf16 v[176:179], v[128:131], a[56:59], v[176:179]
    v_mfma_f32_16x16x32_bf16 v[180:183], v[128:131], a[60:63], v[180:183]
    v_mfma_f32_16x16x32_bf16 v[184:187], v[132:135], a[48:51], v[184:187]
    v_mfma_f32_16x16x32_bf16 v[188:191], v[132:135], a[52:55], v[188:191]
    v_mfma_f32_16x16x32_bf16 v[192:195], v[132:135], a[56:59], v[192:195]
    v_mfma_f32_16x16x32_bf16 v[196:199], v[132:135], a[60:63], v[196:199]
    ds_write_b128 v210, v[136:139] offset:0
    ds_write_b128 v210, v[140:143] offset:4096
    ds_write_b128 v210, v[144:147] offset:8192
    ds_write_b128 v210, v[148:151] offset:12288
    ds_write_b128 v211, v[152:155] offset:0
    ds_write_b128 v211, v[156:159] offset:4096
    ds_write_b128 v211, v[160:163] offset:8192
    ds_write_b128 v211, v[164:167] offset:12288
    ds_write_b128 v212, v[168:171] offset:0
    ds_write_b128 v212, v[172:175] offset:4096
    ds_write_b128 v212, v[176:179] offset:8192
    ds_write_b128 v212, v[180:183] offset:12288
    ds_write_b128 v213, v[184:187] offset:0
    ds_write_b128 v213, v[188:191] offset:4096
    ds_write_b128 v213, v[192:195] offset:8192
    ds_write_b128 v213, v[196:199] offset:12288
    s_add_u32 s28, s32, 0
    buffer_load_dwordx4 v[24:27], v200, s[12:15], s28 offen offset:0 sc1
    buffer_load_dwordx4 v[28:31], v200, s[12:15], s28 offen offset:1024 sc1
    s_add_u32 s28, s32, 16384
    buffer_load_dwordx4 v[40:43], v200, s[12:15], s28 offen offset:0 sc1
    buffer_load_dwordx4 v[44:47], v200, s[12:15], s28 offen offset:1024 sc1
    s_add_u32 s28, s32, 32768
    buffer_load_dwordx4 v[56:59], v200, s[12:15], s28 offen offset:0 sc1
    buffer_load_dwordx4 v[60:63], v200, s[12:15], s28 offen offset:1024 sc1
    s_waitcnt lgkmcnt(0)
    s_barrier
    ds_read_b128 v[72:75], v240 offset:0
    ds_read_b128 v[76:79], v241 offset:0
    ds_read_b128 v[80:83], v242 offset:0
    ds_read_b128 v[84:87], v243 offset:0
    ds_read_b128 v[88:91], v240 offset:16384
    ds_read_b128 v[92:95], v241 offset:16384
    ds_read_b128 v[96:99], v242 offset:16384
    ds_read_b128 v[100:103], v243 offset:16384
    ds_read_b128 v[104:107], v240 offset:32768
    ds_read_b128 v[108:111], v241 offset:32768
    ds_read_b128 v[112:115], v242 offset:32768
    ds_read_b128 v[116:119], v243 offset:32768
    ds_read_b128 v[120:123], v240 offset:49152
    ds_read_b128 v[124:127], v241 offset:49152
    ds_read_b128 v[128:131], v242 offset:49152
    ds_read_b128 v[132:135], v243 offset:49152
    s_waitcnt lgkmcnt(0)
    v_add_f32 v72, v72, v88
    v_add_f32 v73, v73, v89
    v_add_f32 v74, v74, v90
    v_add_f32 v75, v75, v91
    v_add_f32 v76, v76, v92
    v_add_f32 v77, v77, v93
    v_add_f32 v78, v78, v94
    v_add_f32 v79, v79, v95
    v_add_f32 v80, v80, v96
    v_add_f32 v81, v81, v97
    v_add_f32 v82, v82, v98
    v_add_f32 v83, v83, v99
    v_add_f32 v84, v84, v100
    v_add_f32 v85, v85, v101
    v_add_f32 v86, v86, v102
    v_add_f32 v87, v87, v103
    v_add_f32 v104, v104, v120
    v_add_f32 v105, v105, v121
    v_add_f32 v106, v106, v122
    v_add_f32 v107, v107, v123
    v_add_f32 v108, v108, v124
    v_add_f32 v109, v109, v125
    v_add_f32 v110, v110, v126
    v_add_f32 v111, v111, v127
    v_add_f32 v112, v112, v128
    v_add_f32 v113, v113, v129
    v_add_f32 v114, v114, v130
    v_add_f32 v115, v115, v131
    v_add_f32 v116, v116, v132
    v_add_f32 v117, v117, v133
    v_add_f32 v118, v118, v134
    v_add_f32 v119, v119, v135
    v_add_f32 v72, v72, v104
    v_add_f32 v73, v73, v105
    v_add_f32 v74, v74, v106
    v_add_f32 v75, v75, v107
    v_add_f32 v76, v76, v108
    v_add_f32 v77, v77, v109
    v_add_f32 v78, v78, v110
    v_add_f32 v79, v79, v111
    v_add_f32 v80, v80, v112
    v_add_f32 v81, v81, v113
    v_add_f32 v82, v82, v114
    v_add_f32 v83, v83, v115
    v_add_f32 v84, v84, v116
    v_add_f32 v85, v85, v117
    v_add_f32 v86, v86, v118
    v_add_f32 v87, v87, v119
    v_cvt_pk_bf16_f32 v144, v72, v73
    v_cvt_pk_bf16_f32 v145, v74, v75
    v_cvt_pk_bf16_f32 v146, v76, v77
    v_cvt_pk_bf16_f32 v147, v78, v79
    v_cvt_pk_bf16_f32 v148, v80, v81
    v_cvt_pk_bf16_f32 v149, v82, v83
    v_cvt_pk_bf16_f32 v150, v84, v85
    v_cvt_pk_bf16_f32 v151, v86, v87
    buffer_store_dwordx4 v[144:147], v202, s[20:23], s51 offen nt
    buffer_store_dwordx4 v[148:151], v203, s[20:23], s51 offen nt
    s_waitcnt vmcnt(2)
    s_mov_b32 s55, 0
L3_chk:
    v_max3_u32 v217, v24, v25, v26
    v_max3_u32 v218, v27, v28, v29
    v_max3_u32 v218, v218, v30, v31
    v_max3_u32 v217, v217, v40, v41
    v_max3_u32 v218, v218, v42, v43
    v_max3_u32 v217, v217, v44, v45
    v_max3_u32 v218, v218, v46, v47
    v_max3_u32 v217, v217, v56, v57
    v_max3_u32 v218, v218, v58, v59
    v_max3_u32 v217, v217, v60, v61
    v_max3_u32 v218, v218, v62, v63
    v_max_u32 v217, v217, v218
    v_cmp_eq_u32 vcc, -1, v217
    s_nop 1
    s_cbranch_vccz L3_ok
    s_add_u32 s55, s55, 1
    s_cmp_ge_u32 s55, 200000
    s_cbranch_scc1 L3_ok
    s_add_u32 s28, s32, 0
    buffer_load_dwordx4 v[24:27], v200, s[12:15], s28 offen offset:0 sc1
    buffer_load_dwordx4 v[28:31], v200, s[12:15], s28 offen offset:1024 sc1
    s_add_u32 s28, s32, 16384
    buffer_load_dwordx4 v[40:43], v200, s[12:15], s28 offen offset:0 sc1
    buffer_load_dwordx4 v[44:47], v200, s[12:15], s28 offen offset:1024 sc1
    s_add_u32 s28, s32, 32768
    buffer_load_dwordx4 v[56:59], v200, s[12:15], s28 offen offset:0 sc1
    buffer_load_dwordx4 v[60:63], v200, s[12:15], s28 offen offset:1024 sc1
    s_waitcnt vmcnt(0)
    s_branch L3_chk
L3_ok:
    v_lshlrev_b32 v32, 16, v24
    v_and_b32 v24, 0xffff0000, v24
    v_add_f32 v8, v8, v32
    v_add_f32 v9, v9, v24
    v_lshlrev_b32 v33, 16, v25
    v_and_b32 v25, 0xffff0000, v25
    v_add_f32 v10, v10, v33
    v_add_f32 v11, v11, v25
    v_lshlrev_b32 v34, 16, v26
    v_and_b32 v26, 0xffff0000, v26
    v_add_f32 v12, v12, v34
    v_add_f32 v13, v13, v26
    v_lshlrev_b32 v35, 16, v27
    v_and_b32 v27, 0xffff0000, v27
    v_add_f32 v14, v14, v35
    v_add_f32 v15, v15, v27
    v_lshlrev_b32 v36, 16, v28
    v_and_b32 v28, 0xffff0000, v28
    v_add_f32 v16, v16, v36
    v_add_f32 v17, v17, v28
    v_lshlrev_b32 v37, 16, v29
    v_and_b32 v29, 0xffff0000, v29
    v_add_f32 v18, v18, v37
    v_add_f32 v19, v19, v29
    v_lshlrev_b32 v38, 16, v30
    v_and_b32 v30, 0xffff0000, v30
    v_add_f32 v20, v20, v38
    v_add_f32 v21, v21, v30
    v_lshlrev_b32 v39, 16, v31
    v_and_b32 v31, 0xffff0000, v31
    v_add_f32 v22, v22, v39
    v_add_f32 v23, v23, v31
    v_lshlrev_b32 v48, 16, v40
    v_and_b32 v40, 0xffff0000, v40
    v_add_f32 v8, v8, v48
    v_add_f32 v9, v9, v40
    v_lshlrev_b32 v49, 16, v41
    v_and_b32 v41, 0xffff0000, v41
    v_add_f32 v10, v10, v49
    v_add_f32 v11, v11, v41
    v_lshlrev_b32 v50, 16, v42
    v_and_b32 v42, 0xffff0000, v42
    v_add_f32 v12, v12, v50
    v_add_f32 v13, v13, v42
    v_lshlrev_b32 v51, 16, v43
    v_and_b32 v43, 0xffff0000, v43
    v_add_f32 v14, v14, v51
    v_add_f32 v15, v15, v43
    v_lshlrev_b32 v52, 16, v44
    v_and_b32 v44, 0xffff0000, v44
    v_add_f32 v16, v16, v52
    v_add_f32 v17, v17, v44
    v_lshlrev_b32 v53, 16, v45
    v_and_b32 v45, 0xffff0000, v45
    v_add_f32 v18, v18, v53
    v_add_f32 v19, v19, v45
    v_lshlrev_b32 v54, 16, v46
    v_and_b32 v46, 0xffff0000, v46
    v_add_f32 v20, v20, v54
    v_add_f32 v21, v21, v46
    v_lshlrev_b32 v55, 16, v47
    v_and_b32 v47, 0xffff0000, v47
    v_add_f32 v22, v22, v55
    v_add_f32 v23, v23, v47
    v_lshlrev_b32 v64, 16, v56
    v_and_b32 v56, 0xffff0000, v56
    v_add_f32 v8, v8, v64
    v_add_f32 v9, v9, v56
    v_lshlrev_b32 v65, 16, v57
    v_and_b32 v57, 0xffff0000, v57
    v_add_f32 v10, v10, v65
    v_add_f32 v11, v11, v57
    v_lshlrev_b32 v66, 16, v58
    v_and_b32 v58, 0xffff0000, v58
    v_add_f32 v12, v12, v66
    v_add_f32 v13, v13, v58
    v_lshlrev_b32 v67, 16, v59
    v_and_b32 v59, 0xffff0000, v59
    v_add_f32 v14, v14, v67
    v_add_f32 v15, v15, v59
    v_lshlrev_b32 v68, 16, v60
    v_and_b32 v60, 0xffff0000, v60
    v_add_f32 v16, v16, v68
    v_add_f32 v17, v17, v60
    v_lshlrev_b32 v69, 16, v61
    v_and_b32 v61, 0xffff0000, v61
    v_add_f32 v18, v18, v69
    v_add_f32 v19, v19, v61
    v_lshlrev_b32 v70, 16, v62
    v_and_b32 v62, 0xffff0000, v62
    v_add_f32 v20, v20, v70
    v_add_f32 v21, v21, v62
    v_lshlrev_b32 v71, 16, v63
    v_and_b32 v63, 0xffff0000, v63
    v_add_f32 v22, v22, v71
    v_add_f32 v23, v23, v63
    v_cvt_pk_bf16_f32 v160, v8, v9
    v_cvt_pk_bf16_f32 v161, v10, v11
    v_cvt_pk_bf16_f32 v162, v12, v13
    v_cvt_pk_bf16_f32 v163, v14, v15
    v_cvt_pk_bf16_f32 v164, v16, v17
    v_cvt_pk_bf16_f32 v165, v18, v19
    v_cvt_pk_bf16_f32 v166, v20, v21
    v_cvt_pk_bf16_f32 v167, v22, v23
    buffer_store_dwordx2 v[160:161], v204, s[20:23], s35 offen offset:1024 nt
    buffer_store_dwordx2 v[162:163], v205, s[20:23], s35 offen offset:1024 nt
    buffer_store_dwordx2 v[164:165], v204, s[20:23], s35 offen offset:1056 nt
    buffer_store_dwordx2 v[166:167], v205, s[20:23], s35 offen offset:1056 nt
L_exit:
    s_endpgm
FB_concat_5:
    s_call_b64 s[30:31], L2_fix0
    s_branch BK_concat_6
FB_concat_7:
    s_call_b64 s[30:31], L2_fix1
    s_branch BK_concat_8
FB_concat_9:
    s_call_b64 s[30:31], L2_fix0
    s_branch BK_concat_10
FB_concat_11:
    s_call_b64 s[30:31], L2_fix1
    s_branch BK_concat_12
FB_concat_13:
    s_call_b64 s[30:31], L2_fix0
    s_branch BK_concat_14
FB_concat_15:
    s_call_b64 s[30:31], L2_fix1
    s_branch BK_concat_16
FB_concat_17:
    s_call_b64 s[30:31], L2_fix2
    s_branch BK_concat_18
FB_concat_19:
    s_call_b64 s[30:31], L2_fix0
    s_branch BK_concat_20
FB_concat_21:
    s_call_b64 s[30:31], L2_fix1
    s_branch BK_concat_22
FB_concat_23:
    s_call_b64 s[30:31], L2_fix2
    s_branch BK_concat_24
FB_concat_25:
    s_call_b64 s[30:31], L2_fix0
    s_branch BK_concat_26
FB_concat_27:
    s_call_b64 s[30:31], L2_fix3
    s_branch BK_concat_28
FB_concat_29:
    s_call_b64 s[30:31], L2_fix2
    s_branch BK_concat_30
FB_concat_31:
    s_call_b64 s[30:31], L2_fix3
    s_branch BK_concat_32
FB_concat_33:
    s_call_b64 s[30:31], L2_fix0
    s_branch BK_concat_34
FB_concat_35:
    s_call_b64 s[30:31], L2_fix3
    s_branch BK_concat_36
FB_concat_37:
    s_call_b64 s[30:31], L2_fix2
    s_branch BK_concat_38
FB_concat_39:
    s_call_b64 s[30:31], L2_fix3
    s_branch BK_concat_40
FB_concat_43:
    s_call_b64 s[30:31], L2_fix0
    s_branch BK_concat_44
FB_concat_45:
    s_call_b64 s[30:31], L2_fix1
    s_branch BK_concat_46
FB_concat_47:
    s_call_b64 s[30:31], L2_fix2
    s_branch BK_concat_48
FB_concat_49:
    s_call_b64 s[30:31], L2_fix0
    s_branch BK_concat_50
FB_concat_51:
    s_call_b64 s[30:31], L2_fix1
    s_branch BK_concat_52
FB_concat_53:
    s_call_b64 s[30:31], L2_fix2
    s_branch BK_concat_54
FB_concat_55:
    s_call_b64 s[30:31], L2_fix0
    s_branch BK_concat_56
FB_concat_57:
    s_call_b64 s[30:31], L2_fix3
    s_branch BK_concat_58
FB_concat_59:
    s_call_b64 s[30:31], L2_fix2
    s_branch BK_concat_60
FB_concat_61:
    s_call_b64 s[30:31], L2_fix3
    s_branch BK_concat_62
FB_concat_63:
    s_call_b64 s[30:31], L2_fix0
    s_branch BK_concat_64
FB_concat_65:
    s_call_b64 s[30:31], L2_fix3
    s_branch BK_concat_66
FB_concat_67:
    s_call_b64 s[30:31], L2_fix2
    s_branch BK_concat_68
FB_concat_69:
    s_call_b64 s[30:31], L2_fix3
    s_branch BK_concat_70
L2_fix0:
    s_nop 7
    v_max3_f32 v80, v8, v9, v10
    v_max3_f32 v84, v12, v13, v14
    v_max3_f32 v80, v80, v11, v16
    v_max3_f32 v84, v84, v15, v20
    v_max3_f32 v80, v80, v17, v18
    v_max3_f32 v84, v84, v21, v22
    v_max_f32 v80, v80, v19
    v_max_f32 v84, v84, v23
    v_mov_b32 v81, v80
    v_mov_b32 v85, v84
    s_nop 0
    v_permlane16_swap_b32 v80, v81
    v_permlane16_swap_b32 v84, v85
    v_max_f32 v80, v80, v81
    v_max_f32 v84, v84, v85
    v_mov_b32 v81, v80
    v_mov_b32 v85, v84
    s_nop 0
    v_permlane32_swap_b32 v80, v81
    v_permlane32_swap_b32 v84, v85
    v_max_f32 v80, v80, v81
    v_max_f32 v84, v84, v85
    v_log_f32 v81, v64
    v_log_f32 v85, v68
    v_max_f32 v80, v80, v81
    v_max_f32 v84, v84, v85
    v_ceil_f32 v80, v80
    v_ceil_f32 v84, v84
    v_add_f32 v80, 0x42c80000, v80
    v_add_f32 v84, 0x42c80000, v84
    v_max_f32 v80, 0, v80
    v_max_f32 v84, 0, v84
    v_exp_f32 v82, -v80
    v_exp_f32 v86, -v84
    v_sub_f32 v56, v56, v80
    v_sub_f32 v60, v60, v84
    v_mov_b32 v83, v82
    v_mov_b32 v87, v86
    v_sub_f32 v8, v8, v80
    v_sub_f32 v12, v12, v84
    v_sub_f32 v24, v24, v80
    v_sub_f32 v28, v28, v84
    v_sub_f32 v9, v9, v80
    v_sub_f32 v13, v13, v84
    v_sub_f32 v25, v25, v80
    v_sub_f32 v29, v29, v84
    v_sub_f32 v10, v10, v80
    v_sub_f32 v14, v14, v84
    v_sub_f32 v26, v26, v80
    v_sub_f32 v30, v30, v84
    v_sub_f32 v11, v11, v80
    v_sub_f32 v15, v15, v84
    v_sub_f32 v27, v27, v80
    v_sub_f32 v31, v31, v84
    v_sub_f32 v16, v16, v80
    v_sub_f32 v20, v20, v84
    v_sub_f32 v32, v32, v80
    v_sub_f32 v36, v36, v84
    v_sub_f32 v17, v17, v80
    v_sub_f32 v21, v21, v84
    v_sub_f32 v33, v33, v80
    v_sub_f32 v37, v37, v84
    v_sub_f32 v18, v18, v80
    v_sub_f32 v22, v22, v84
    v_sub_f32 v34, v34, v80
    v_sub_f32 v38, v38, v84
    v_sub_f32 v19, v19, v80
    v_sub_f32 v23, v23, v84
    v_sub_f32 v35, v35, v80
    v_sub_f32 v39, v39, v84
    v_mov_b32 v57, v56
    v_mov_b32 v61, v60
    v_mov_b32 v58, v56
    v_mov_b32 v62, v60
    v_mov_b32 v59, v56
    v_mov_b32 v63, v60
    v_pk_mul_f32 v[64:65], v[64:65], v[82:83]
    v_pk_mul_f32 v[68:69], v[68:69], v[86:87]
    v_pk_mul_f32 v[66:67], v[66:67], v[82:83]
    v_pk_mul_f32 v[70:71], v[70:71], v[86:87]
    v_pk_mul_f32 v[88:89], v[88:89], v[82:83]
    v_pk_mul_f32 v[92:93], v[92:93], v[86:87]
    v_pk_mul_f32 v[90:91], v[90:91], v[82:83]
    v_pk_mul_f32 v[94:95], v[94:95], v[86:87]
    v_pk_mul_f32 v[96:97], v[96:97], v[82:83]
    v_pk_mul_f32 v[100:101], v[100:101], v[86:87]
    v_pk_mul_f32 v[98:99], v[98:99], v[82:83]
    v_pk_mul_f32 v[102:103], v[102:103], v[86:87]
    v_pk_mul_f32 v[104:105], v[104:105], v[82:83]
    v_pk_mul_f32 v[108:109], v[108:109], v[86:87]
    v_pk_mul_f32 v[106:107], v[106:107], v[82:83]
    v_pk_mul_f32 v[110:111], v[110:111], v[86:87]
    v_pk_mul_f32 v[112:113], v[112:113], v[82:83]
    v_pk_mul_f32 v[116:117], v[116:117], v[86:87]
    v_pk_mul_f32 v[114:115], v[114:115], v[82:83]
    v_pk_mul_f32 v[118:119], v[118:119], v[86:87]
    v_pk_mul_f32 v[120:121], v[120:121], v[82:83]
    v_pk_mul_f32 v[124:125], v[124:125], v[86:87]
    v_pk_mul_f32 v[122:123], v[122:123], v[82:83]
    v_pk_mul_f32 v[126:127], v[126:127], v[86:87]
    v_pk_mul_f32 v[128:129], v[128:129], v[82:83]
    v_pk_mul_f32 v[132:133], v[132:133], v[86:87]
    v_pk_mul_f32 v[130:131], v[130:131], v[82:83]
    v_pk_mul_f32 v[134:135], v[134:135], v[86:87]
    v_pk_mul_f32 v[136:137], v[136:137], v[82:83]
    v_pk_mul_f32 v[140:141], v[140:141], v[86:87]
    v_pk_mul_f32 v[138:139], v[138:139], v[82:83]
    v_pk_mul_f32 v[142:143], v[142:143], v[86:87]
    v_pk_mul_f32 v[144:145], v[144:145], v[82:83]
    v_pk_mul_f32 v[148:149], v[148:149], v[86:87]
    v_pk_mul_f32 v[146:147], v[146:147], v[82:83]
    v_pk_mul_f32 v[150:151], v[150:151], v[86:87]
    v_exp_f32 v80, v8
    v_exp_f32 v81, v9
    v_exp_f32 v82, v10
    v_exp_f32 v83, v11
    v_cvt_pk_bf16_f32 v40, v80, v81
    v_cvt_pk_bf16_f32 v41, v82, v83
    v_exp_f32 v84, v12
    v_exp_f32 v85, v13
    v_exp_f32 v86, v14
    v_exp_f32 v87, v15
    v_cvt_pk_bf16_f32 v44, v84, v85
    v_cvt_pk_bf16_f32 v45, v86, v87
    v_exp_f32 v80, v16
    v_exp_f32 v81, v17
    v_exp_f32 v82, v18
    v_exp_f32 v83, v19
    v_cvt_pk_bf16_f32 v42, v80, v81
    v_cvt_pk_bf16_f32 v43, v82, v83
    v_exp_f32 v84, v20
    v_exp_f32 v85, v21
    v_exp_f32 v86, v22
    v_exp_f32 v87, v23
    v_cvt_pk_bf16_f32 v46, v84, v85
    v_cvt_pk_bf16_f32 v47, v86, v87
    v_mfma_f32_16x16x32_bf16 v[72:75], a[128:131], v[40:43], v[64:67]
    s_nop 0
    v_mfma_f32_16x16x32_bf16 v[76:79], a[128:131], v[44:47], v[68:71]
    v_exp_f32 v80, v24
    v_exp_f32 v81, v25
    s_nop 0
    v_cvt_pk_bf16_f32 v48, v80, v81
    v_exp_f32 v82, v26
    s_nop 4
    s_setpc_b64 s[30:31]
L2_fix1:
    s_nop 7
    v_max3_f32 v80, v24, v25, v26
    v_max3_f32 v84, v28, v29, v30
    v_max3_f32 v80, v80, v27, v32
    v_max3_f32 v84, v84, v31, v36
    v_max3_f32 v80, v80, v33, v34
    v_max3_f32 v84, v84, v37, v38
    v_max_f32 v80, v80, v35
    v_max_f32 v84, v84, v39
    v_mov_b32 v81, v80
    v_mov_b32 v85, v84
    s_nop 0
    v_permlane16_swap_b32 v80, v81
    v_permlane16_swap_b32 v84, v85
    v_max_f32 v80, v80, v81
    v_max_f32 v84, v84, v85
    v_mov_b32 v81, v80
    v_mov_b32 v85, v84
    s_nop 0
    v_permlane32_swap_b32 v80, v81
    v_permlane32_swap_b32 v84, v85
    v_max_f32 v80, v80, v81
    v_max_f32 v84, v84, v85
    v_log_f32 v81, v72
    v_log_f32 v85, v76
    v_max_f32 v80, v80, v81
    v_max_f32 v84, v84, v85
    v_ceil_f32 v80, v80
    v_ceil_f32 v84, v84
    v_add_f32 v80, 0x42c80000, v80
    v_add_f32 v84, 0x42c80000, v84
    v_max_f32 v80, 0, v80
    v_max_f32 v84, 0, v84
    v_exp_f32 v82, -v80
    v_exp_f32 v86, -v84
    v_sub_f32 v56, v56, v80
    v_sub_f32 v60, v60, v84
    v_mov_b32 v83, v82
    v_mov_b32 v87, v86
    v_sub_f32 v24, v24, v80
    v_sub_f32 v28, v28, v84
    v_sub_f32 v8, v8, v80
    v_sub_f32 v12, v12, v84
    v_sub_f32 v25, v25, v80
    v_sub_f32 v29, v29, v84
    v_sub_f32 v9, v9, v80
    v_sub_f32 v13, v13, v84
    v_sub_f32 v26, v26, v80
    v_sub_f32 v30, v30, v84
    v_sub_f32 v10, v10, v80
    v_sub_f32 v14, v14, v84
    v_sub_f32 v27, v27, v80
    v_sub_f32 v31, v31, v84
    v_sub_f32 v11, v11, v80
    v_sub_f32 v15, v15, v84
    v_sub_f32 v32, v32, v80
    v_sub_f32 v36, v36, v84
    v_sub_f32 v16, v16, v80
    v_sub_f32 v20, v20, v84
    v_sub_f32 v33, v33, v80
    v_sub_f32 v37, v37, v84
    v_sub_f32 v17, v17, v80
    v_sub_f32 v21, v21, v84
    v_sub_f32 v34, v34, v80
    v_sub_f32 v38, v38, v84
    v_sub_f32 v18, v18, v80
    v_sub_f32 v22, v22, v84
    v_sub_f32 v35, v35, v80
    v_sub_f32 v39, v39, v84
    v_sub_f32 v19, v19, v80
    v_sub_f32 v23, v23, v84
    v_mov_b32 v57, v56
    v_mov_b32 v61, v60
    v_mov_b32 v58, v56
    v_mov_b32 v62, v60
    v_mov_b32 v59, v56
    v_mov_b32 v63, v60
    v_pk_mul_f32 v[72:73], v[72:73], v[82:83]
    v_pk_mul_f32 v[76:77], v[76:77], v[86:87]
    v_pk_mul_f32 v[74:75], v[74:75], v[82:83]
    v_pk_mul_f32 v[78:79], v[78:79], v[86:87]
    v_pk_mul_f32 v[88:89], v[88:89], v[82:83]
    v_pk_mul_f32 v[92:93], v[92:93], v[86:87]
    v_pk_mul_f32 v[90:91], v[90:91], v[82:83]
    v_pk_mul_f32 v[94:95], v[94:95], v[86:87]
    v_pk_mul_f32 v[96:97], v[96:97], v[82:83]
    v_pk_mul_f32 v[100:101], v[100:101], v[86:87]
    v_pk_mul_f32 v[98:99], v[98:99], v[82:83]
    v_pk_mul_f32 v[102:103], v[102:103], v[86:87]
    v_pk_mul_f32 v[104:105], v[104:105], v[82:83]
    v_pk_mul_f32 v[108:109], v[108:109], v[86:87]
    v_pk_mul_f32 v[106:107], v[106:107], v[82:83]
    v_pk_mul_f32 v[110:111], v[110:111], v[86:87]
    v_pk_mul_f32 v[112:113], v[112:113], v[82:83]
    v_pk_mul_f32 v[116:117], v[116:117], v[86:87]
    v_pk_mul_f32 v[114:115], v[114:115], v[82:83]
    v_pk_mul_f32 v[118:119], v[118:119], v[86:87]
    v_pk_mul_f32 v[120:121], v[120:121], v[82:83]
    v_pk_mul_f32 v[124:125], v[124:125], v[86:87]
    v_pk_mul_f32 v[122:123], v[122:123], v[82:83]
    v_pk_mul_f32 v[126:127], v[126:127], v[86:87]
    v_pk_mul_f32 v[128:129], v[128:129], v[82:83]
    v_pk_mul_f32 v[132:133], v[132:133], v[86:87]
    v_pk_mul_f32 v[130:131], v[130:131], v[82:83]
    v_pk_mul_f32 v[134:135], v[134:135], v[86:87]
    v_pk_mul_f32 v[136:137], v[136:137], v[82:83]
    v_pk_mul_f32 v[140:141], v[140:141], v[86:87]
    v_pk_mul_f32 v[138:139], v[138:139], v[82:83]
    v_pk_mul_f32 v[142:143], v[142:143], v[86:87]
    v_pk_mul_f32 v[144:145], v[144:145], v[82:83]
    v_pk_mul_f32 v[148:149], v[148:149], v[86:87]
    v_pk_mul_f32 v[146:147], v[146:147], v[82:83]
    v_pk_mul_f32 v[150:151], v[150:151], v[86:87]
    v_exp_f32 v80, v24
    v_exp_f32 v81, v25
    v_exp_f32 v82, v26
    v_exp_f32 v83, v27
    v_cvt_pk_bf16_f32 v48, v80, v81
    v_cvt_pk_bf16_f32 v49, v82, v83
    v_exp_f32 v84, v28
    v_exp_f32 v85, v29
    v_exp_f32 v86, v30
    v_exp_f32 v87, v31
    v_cvt_pk_bf16_f32 v52, v84, v85
    v_cvt_pk_bf16_f32 v53, v86, v87
    v_exp_f32 v80, v32
    v_exp_f32 v81, v33
    v_exp_f32 v82, v34
    v_exp_f32 v83, v35
    v_cvt_pk_bf16_f32 v50, v80, v81
    v_cvt_pk_bf16_f32 v51, v82, v83
    v_exp_f32 v84, v36
    v_exp_f32 v85, v37
    v_exp_f32 v86, v38
    v_exp_f32 v87, v39
    v_cvt_pk_bf16_f32 v54, v84, v85
    v_cvt_pk_bf16_f32 v55, v86, v87
    v_mfma_f32_16x16x32_bf16 v[64:67], a[128:131], v[48:51], v[72:75]
    s_nop 0
    v_mfma_f32_16x16x32_bf16 v[68:71], a[128:131], v[52:55], v[76:79]
    v_exp_f32 v80, v8
    v_exp_f32 v81, v9
    s_nop 0
    v_cvt_pk_bf16_f32 v40, v80, v81
    v_exp_f32 v82, v10
    s_nop 4
    s_setpc_b64 s[30:31]
L2_fix2:
    s_nop 7
    v_max3_f32 v84, v12, v13, v14
    v_max3_f32 v84, v84, v15, v20
    v_max3_f32 v84, v84, v21, v22
    v_max_f32 v84, v84, v23
    v_mov_b32 v85, v84
    s_nop 1
    v_permlane16_swap_b32 v84, v85
    v_max_f32 v84, v84, v85
    v_mov_b32 v85, v84
    s_nop 1
    v_permlane32_swap_b32 v84, v85
    v_max_f32 v84, v84, v85
    v_log_f32 v85, v68
    s_nop 0
    v_max_f32 v84, v84, v85
    v_ceil_f32 v84, v84
    v_add_f32 v84, 0x42c80000, v84
    v_max_f32 v84, 0, v84
    v_exp_f32 v86, -v84
    v_sub_f32 v60, v60, v84
    v_mov_b32 v87, v86
    v_sub_f32 v12, v12, v84
    v_sub_f32 v28, v28, v84
    v_sub_f32 v13, v13, v84
    v_sub_f32 v29, v29, v84
    v_sub_f32 v14, v14, v84
    v_sub_f32 v30, v30, v84
    v_sub_f32 v15, v15, v84
    v_sub_f32 v31, v31, v84
    v_sub_f32 v20, v20, v84
    v_sub_f32 v36, v36, v84
    v_sub_f32 v21, v21, v84
    v_sub_f32 v37, v37, v84
    v_sub_f32 v22, v22, v84
    v_sub_f32 v38, v38, v84
    v_sub_f32 v23, v23, v84
    v_sub_f32 v39, v39, v84
    v_mov_b32 v61, v60
    v_mov_b32 v62, v60
    v_mov_b32 v63, v60
    v_pk_mul_f32 v[68:69], v[68:69], v[86:87]
    v_pk_mul_f32 v[70:71], v[70:71], v[86:87]
    v_pk_mul_f32 v[92:93], v[92:93], v[86:87]
    v_pk_mul_f32 v[94:95], v[94:95], v[86:87]
    v_pk_mul_f32 v[100:101], v[100:101], v[86:87]
    v_pk_mul_f32 v[102:103], v[102:103], v[86:87]
    v_pk_mul_f32 v[108:109], v[108:109], v[86:87]
    v_pk_mul_f32 v[110:111], v[110:111], v[86:87]
    v_pk_mul_f32 v[116:117], v[116:117], v[86:87]
    v_pk_mul_f32 v[118:119], v[118:119], v[86:87]
    v_pk_mul_f32 v[124:125], v[124:125], v[86:87]
    v_pk_mul_f32 v[126:127], v[126:127], v[86:87]
    v_pk_mul_f32 v[132:133], v[132:133], v[86:87]
    v_pk_mul_f32 v[134:135], v[134:135], v[86:87]
    v_pk_mul_f32 v[140:141], v[140:141], v[86:87]
    v_pk_mul_f32 v[142:143], v[142:143], v[86:87]
    v_pk_mul_f32 v[148:149], v[148:149], v[86:87]
    v_pk_mul_f32 v[150:151], v[150:151], v[86:87]
    v_exp_f32 v84, v12
    v_exp_f32 v85, v13
    v_exp_f32 v86, v14
    v_cvt_pk_bf16_f32 v44, v84, v85
    v_exp_f32 v87, v15
    s_nop 0
    v_cvt_pk_bf16_f32 v45, v86, v87
    v_exp_f32 v84, v20
    v_exp_f32 v85, v21
    v_exp_f32 v86, v22
    v_cvt_pk_bf16_f32 v46, v84, v85
    v_exp_f32 v87, v23
    s_nop 0
    v_cvt_pk_bf16_f32 v47, v86, v87
    s_nop 1
    v_mfma_f32_16x16x32_bf16 v[76:79], a[128:131], v[44:47], v[68:71]
    s_nop 8
    s_setpc_b64 s[30:31]
L2_fix3:
    s_nop 7
    v_max3_f32 v84, v28, v29, v30
    v_max3_f32 v84, v84, v31, v36
    v_max3_f32 v84, v84, v37, v38
    v_max_f32 v84, v84, v39
    v_mov_b32 v85, v84
    s_nop 1
    v_permlane16_swap_b32 v84, v85
    v_max_f32 v84, v84, v85
    v_mov_b32 v85, v84
    s_nop 1
    v_permlane32_swap_b32 v84, v85
    v_max_f32 v84, v84, v85
    v_log_f32 v85, v76
    s_nop 0
    v_max_f32 v84, v84, v85
    v_ceil_f32 v84, v84
    v_add_f32 v84, 0x42c80000, v84
    v_max_f32 v84, 0, v84
    v_exp_f32 v86, -v84
    v_sub_f32 v60, v60, v84
    v_mov_b32 v87, v86
    v_sub_f32 v28, v28, v84
    v_sub_f32 v12, v12, v84
    v_sub_f32 v29, v29, v84
    v_sub_f32 v13, v13, v84
    v_sub_f32 v30, v30, v84
    v_sub_f32 v14, v14, v84
    v_sub_f32 v31, v31, v84
    v_sub_f32 v15, v15, v84
    v_sub_f32 v36, v36, v84
    v_sub_f32 v20, v20, v84
    v_sub_f32 v37, v37, v84
    v_sub_f32 v21, v21, v84
    v_sub_f32 v38, v38, v84
    v_sub_f32 v22, v22, v84
    v_sub_f32 v39, v39, v84
    v_sub_f32 v23, v23, v84
    v_mov_b32 v61, v60
    v_mov_b32 v62, v60
    v_mov_b32 v63, v60
    v_pk_mul_f32 v[76:77], v[76:77], v[86:87]
    v_pk_mul_f32 v[78:79], v[78:79], v[86:87]
    v_pk_mul_f32 v[92:93], v[92:93], v[86:87]
    v_pk_mul_f32 v[94:95], v[94:95], v[86:87]
    v_pk_mul_f32 v[100:101], v[100:101], v[86:87]
    v_pk_mul_f32 v[102:103], v[102:103], v[86:87]
    v_pk_mul_f32 v[108:109], v[108:109], v[86:87]
    v_pk_mul_f32 v[110:111], v[110:111], v[86:87]
    v_pk_mul_f32 v[116:117], v[116:117], v[86:87]
    v_pk_mul_f32 v[118:119], v[118:119], v[86:87]
    v_pk_mul_f32 v[124:125], v[124:125], v[86:87]
    v_pk_mul_f32 v[126:127], v[126:127], v[86:87]
    v_pk_mul_f32 v[132:133], v[132:133], v[86:87]
    v_pk_mul_f32 v[134:135], v[134:135], v[86:87]
    v_pk_mul_f32 v[140:141], v[140:141], v[86:87]
    v_pk_mul_f32 v[142:143], v[142:143], v[86:87]
    v_pk_mul_f32 v[148:149], v[148:149], v[86:87]
    v_pk_mul_f32 v[150:151], v[150:151], v[86:87]
    v_exp_f32 v84, v28
    v_exp_f32 v85, v29
    v_exp_f32 v86, v30
    v_cvt_pk_bf16_f32 v52, v84, v85
    v_exp_f32 v87, v31
    s_nop 0
    v_cvt_pk_bf16_f32 v53, v86, v87
    v_exp_f32 v84, v36
    v_exp_f32 v85, v37
    v_exp_f32 v86, v38
    v_cvt_pk_bf16_f32 v54, v84, v85
    v_exp_f32 v87, v39
    s_nop 0
    v_cvt_pk_bf16_f32 v55, v86, v87
    s_nop 1
    v_mfma_f32_16x16x32_bf16 v[68:71], a[128:131], v[52:55], v[76:79]
    s_nop 8
    s_setpc_b64 s[30:31]
L_code_end:
    s_endpgm
.section .rodata,"a"
.p2align 6
.amdhsa_kernel concat_heads__linear_kernel_hedgehog__compressed_kv_cla__prompt_kernel
  .amdhsa_next_free_vgpr 512
  .amdhsa_next_free_sgpr 102
  .amdhsa_accum_offset 256
  .amdhsa_group_segment_fixed_size 0
  .amdhsa_kernarg_size 104
  .amdhsa_user_sgpr_count 2
  .amdhsa_user_sgpr_kernarg_segment_ptr 1
  .amdhsa_system_sgpr_workgroup_id_x 1
.end_amdhsa_kernel
```
